```python
import torch

def _softmax(x, axis=-1):
    return torch.softmax(x, dim=axis)

def _gelu(x):
    return torch.nn.functional.gelu(x, approximate='tanh')

def _silu(x):
    return torch.nn.functional.silu(x)

def _sigmoid(x):
    return torch.sigmoid(x)

def _layernorm(x, axis=-1, eps=1e-05):
    m = x.mean(dim=axis, keepdim=True)
    v = x.var(dim=axis, keepdim=True, unbiased=False)
    return (x - m) / torch.sqrt(v + eps)

def _scatter_add(tgt, idx, src, axis=0):
    return tgt.clone().index_add_(axis, idx, src)

def _segment_sum(src, seg, n):
    out = torch.zeros((n,) + src.shape[1:], dtype=src.dtype)
    return out.index_add_(0, seg, src)

def _pad(x, pw):
    flat = tuple((v for pair in reversed(pw) for v in pair))
    return torch.nn.functional.pad(x, flat)
kernel_name = 'standalone__factorization_afm__recsys'

def setup_inputs():

    _w = lambda a: (lambda t: t.to(torch.bfloat16) if t.is_floating_point() else t)(torch.as_tensor(a))
    B, F, D, V = (1024, 26, 128, min(1000000, 100000))
    A = D
    ii, jj = tuple(torch.triu_indices(F, F, 1).unbind(0))
    return {'idx': _w((lambda lo, hi, *s: torch.randint(lo, hi, s))(0, V, B, F).to(torch.int64)), 'table': _w((lambda *s: torch.randn(*s, dtype=torch.bfloat16) * 0.8)(V, D)), 'ii': _w(ii.to(torch.int64)), 'jj': _w(jj.to(torch.int64)), 'W': _w((lambda *s: torch.randn(*s, dtype=torch.bfloat16) * 0.4)(D, A) * (1.0 / D ** 0.5)), 'b': _w((lambda *s: torch.randn(*s, dtype=torch.bfloat16) * 0.4)(A)), 'h': _w((lambda *s: torch.randn(*s, dtype=torch.bfloat16) * 0.4)(A)), 'p': _w((lambda *s: torch.randn(*s, dtype=torch.bfloat16) * 0.8)(D))}

def reference(idx, table, ii, jj, W, b, h, p):
    emb = table[idx]
    ei = emb[:, ii, :].clone()
    ej = emb[:, jj, :].clone()
    pair = ei * ej
    hid = pair @ W + b
    hid = 0.5 * (hid + torch.abs(hid))
    e = hid @ h
    alpha = _softmax(e, axis=-1)
    pooled = torch.einsum('bp,bpd->bd', alpha, pair)
    return pooled @ p
```

```asm
; @launch grid=(256,1,1) block=(256,1,1) lds=63744
.amdgcn_target "amdgcn-amd-amdhsa--gfx950"
.text
.globl standalone__factorization_afm__recsys_kernel
.p2align 8
.type standalone__factorization_afm__recsys_kernel,@function
standalone__factorization_afm__recsys_kernel:
    s_load_dwordx16 s[16:31], s[0:1], 0
    s_load_dwordx2 s[36:37], s[0:1], 64
    s_cmp_ge_u32 s2, 256
    s_cbranch_scc1 L_end
    s_getpc_b64 s[10:11]
L_pc:
    v_lshlrev_b32 v75, 7, v0
    v_min_u32 v75, L_end-L_pc, v75
    global_load_dword v78, v75, s[10:11]
    v_lshrrev_b32 v76, 6, v0
    v_and_b32 v48, 15, v0
    v_readfirstlane_b32 s3, v76
    v_bfe_u32 v49, v0, 4, 2
    v_and_b32 v50, 63, v0
    s_lshl_b32 s4, s2, 2
    s_add_u32 s4, s4, s3
    s_mul_i32 s6, s4, 104
    v_lshl_add_u32 v51, v49, 2, s6
    v_min_u32 v52, 1, v49
    v_lshl_add_u32 v52, v52, 2, s6
    s_lshl_b32 s7, s3, 13
    v_lshlrev_b32 v55, 4, v49
    v_lshl_add_u32 v53, v48, 8, v55
    s_add_u32 s8, s7, 4096
    v_add_u32 v53, s8, v53
    v_lshlrev_b32 v54, 2, v50
    s_mul_i32 s5, s3, 7168
    s_add_u32 s5, s5, 32768
    s_mov_b32 s42, 25600000
    s_mov_b32 s43, 0x00020000
    s_mov_b32 s38, 2048
    s_mov_b32 s39, 0x00020000
    v_xor_b32 v75, v48, v49
    v_lshlrev_b32 v56, 4, v75
    v_xor_b32 v57, 64, v56
    v_xor_b32 v58, 128, v56
    v_xor_b32 v59, 192, v56
    v_lshl_add_u32 v216, v48, 8, v56
    v_add_u32 v216, s5, v216
    v_xor_b32 v217, 64, v216
    v_xor_b32 v218, 128, v216
    v_xor_b32 v219, 192, v216
    v_and_b32 v75, 3, v48
    v_lshrrev_b32 v76, 3, v48
    v_lshl_add_u32 v75, v76, 2, v75
    v_lshlrev_b32 v75, 1, v75
    v_xor_b32 v75, v75, v49
    v_lshlrev_b32 v75, 4, v75
    v_lshl_add_u32 v75, v48, 8, v75
    v_add_u32 v60, s7, v75
    v_xor_b32 v61, 64, v60
    v_xor_b32 v62, 128, v60
    v_xor_b32 v63, 192, v60
    s_waitcnt lgkmcnt(0)
    global_load_dword v208, v51, s[16:17] offset:0 nt
    global_load_dword v209, v51, s[16:17] offset:16 nt
    global_load_dword v210, v51, s[16:17] offset:32 nt
    global_load_dword v211, v51, s[16:17] offset:48 nt
    global_load_dword v212, v51, s[16:17] offset:64 nt
    global_load_dword v213, v51, s[16:17] offset:80 nt
    global_load_dword v214, v52, s[16:17] offset:96 nt
    global_load_dwordx4 v[80:83], v53, s[24:25] offset:-4096
    global_load_dwordx4 v[84:87], v53, s[24:25] offset:-4032
    global_load_dwordx4 v[88:91], v53, s[24:25] offset:-3968
    global_load_dwordx4 v[92:95], v53, s[24:25] offset:-3904
    global_load_dwordx4 v[96:99], v53, s[24:25] offset:0
    global_load_dwordx4 v[100:103], v53, s[24:25] offset:64
    global_load_dwordx4 v[104:107], v53, s[24:25] offset:128
    global_load_dwordx4 v[108:111], v53, s[24:25] offset:192
    global_load_dwordx4 v[144:147], v55, s[28:29] offset:0
    global_load_dwordx4 v[148:151], v55, s[28:29] offset:64
    global_load_dwordx4 v[152:155], v55, s[28:29] offset:128
    global_load_dwordx4 v[156:159], v55, s[28:29] offset:192
    global_load_dword v220, v54, s[28:29]
    global_load_dword v221, v54, s[30:31]
    global_load_dword v223, v54, s[26:27]
    s_mov_b32 s40, s18
    s_mov_b32 s41, s19
    v_lshrrev_b32 v75, 2, v48
    v_lshl_add_u32 v76, v49, 3, v75
    v_lshlrev_b32 v76, 8, v76
    v_and_b32 v77, 1, v49
    v_lshl_add_u32 v77, v77, 2, v75
    v_lshl_add_u32 v76, v77, 5, v76
    v_and_b32 v77, 3, v48
    v_lshl_add_u32 v224, v77, 3, v76
    v_xor_b32 v225, 32, v224
    v_xor_b32 v226, 64, v224
    v_xor_b32 v227, 96, v224
    v_xor_b32 v228, 128, v224
    v_xor_b32 v229, 160, v224
    v_xor_b32 v230, 192, v224
    v_xor_b32 v231, 224, v224
    v_and_b32 v75, 1, v50
    v_lshlrev_b32 v75, 2, v75
    v_bfe_u32 v76, v50, 1, 2
    v_and_b32 v77, 0x38, v50
    v_or3_b32 v76, v75, v76, v77
    v_lshlrev_b32 v69, 2, v76
    v_and_b32 v76, 0x32, v50
    v_bfe_u32 v77, v50, 3, 1
    v_or3_b32 v75, v75, v76, v77
    v_and_b32 v76, 4, v50
    v_lshl_or_b32 v75, v76, 1, v75
    v_lshlrev_b32 v68, 2, v75
    v_and_b32 v75, 2, v48
    v_lshlrev_b32 v75, 3, v75
    v_and_b32 v76, 12, v48
    v_and_b32 v77, 1, v48
    v_lshl_or_b32 v75, v77, 1, v75
    s_lshl_b32 s8, s3, 6
    v_or3_b32 v70, v75, v76, s8
    s_mov_b32 s12, 0xaaaa
    v_mov_b32 v1, 0x4444
    v_mad_u32_u24 v1, v77, s12, v1
    v_lshlrev_b32 v77, 4, v77
    v_lshl_or_b32 v77, v49, 5, v77
    v_and_b32 v75, 2, v48
    v_lshl_or_b32 v77, v75, 7, v77
    v_lshrrev_b32 v75, 2, v48
    v_mov_b32 v76, 1024
    v_cmp_eq_u32 s[44:45], 0, v75
    v_cmp_eq_u32 s[46:47], 1, v75
    v_cmp_eq_u32 s[48:49], 2, v75
    v_cmp_eq_u32 s[50:51], 3, v75
    v_cndmask_b32 v64, v76, v77, s[44:45]
    v_cndmask_b32 v65, v76, v77, s[46:47]
    v_cndmask_b32 v66, v76, v77, s[48:49]
    v_cndmask_b32 v67, v76, v77, s[50:51]
    v_lshlrev_b32 v71, 3, v50
    v_min_u32 v75, 1, v49
    v_lshlrev_b32 v75, 9, v75
    v_lshl_add_u32 v72, v50, 4, v75
    v_mov_b32 v160, 0
    v_mov_b32 v161, 0
    v_mov_b32 v162, 0
    v_mov_b32 v163, 0
    ds_write_b128 v72, v[160:163] offset:61696
    s_waitcnt vmcnt(15)
    s_add_u32 m0, s5, 0
    v_lshl_add_u32 v208, v208, 8, v56
    buffer_load_dwordx4 v208, s[40:43], 0 offen nt lds
    s_add_u32 m0, s5, 1024
    v_lshl_add_u32 v209, v209, 8, v57
    buffer_load_dwordx4 v209, s[40:43], 0 offen nt lds
    s_add_u32 m0, s5, 2048
    v_lshl_add_u32 v210, v210, 8, v58
    buffer_load_dwordx4 v210, s[40:43], 0 offen nt lds
    s_add_u32 m0, s5, 3072
    v_lshl_add_u32 v211, v211, 8, v59
    buffer_load_dwordx4 v211, s[40:43], 0 offen nt lds
    s_add_u32 m0, s5, 4096
    v_lshl_add_u32 v212, v212, 8, v56
    buffer_load_dwordx4 v212, s[40:43], 0 offen nt lds
    s_add_u32 m0, s5, 5120
    v_lshl_add_u32 v213, v213, 8, v57
    buffer_load_dwordx4 v213, s[40:43], 0 offen nt lds
    s_add_u32 m0, s5, 6144
    v_lshl_add_u32 v214, v214, 8, v58
    buffer_load_dwordx4 v214, s[40:43], 0 offen nt lds
    s_waitcnt vmcnt(14)
    ds_write_b128 v60, v[80:83] offset:0
    ds_write_b128 v61, v[84:87] offset:0
    ds_write_b128 v62, v[88:91] offset:0
    ds_write_b128 v63, v[92:95] offset:0
    ds_write_b128 v60, v[96:99] offset:4096
    ds_write_b128 v61, v[100:103] offset:4096
    ds_write_b128 v62, v[104:107] offset:4096
    ds_write_b128 v63, v[108:111] offset:4096
    s_waitcnt vmcnt(10)
    v_mfma_f32_16x16x32_bf16 v[176:179], v[144:147], v[80:83], 0
    v_mfma_f32_16x16x32_bf16 v[176:179], v[148:151], v[84:87], v[176:179]
    v_mfma_f32_16x16x32_bf16 v[176:179], v[152:155], v[88:91], v[176:179]
    v_mfma_f32_16x16x32_bf16 v[176:179], v[156:159], v[92:95], v[176:179]
    v_mfma_f32_16x16x32_bf16 v[180:183], v[144:147], v[96:99], 0
    v_mfma_f32_16x16x32_bf16 v[180:183], v[148:151], v[100:103], v[180:183]
    v_mfma_f32_16x16x32_bf16 v[180:183], v[152:155], v[104:107], v[180:183]
    v_mfma_f32_16x16x32_bf16 v[180:183], v[156:159], v[108:111], v[180:183]
    s_waitcnt vmcnt(7)
    ds_write_b32 v68, v220 offset:61440
    ds_write_b32 v69, v221 offset:62208
    v_lshlrev_b32 v222, 16, v223
    v_and_b32 v223, 0xffff0000, v223
    ds_write_b64 v71, v[222:223] offset:63232
    v_and_b32 v75, 7, v48
    v_lshlrev_b32 v75, 2, v75
    v_cmp_gt_u32 vcc, 8, v48
    v_cvt_pk_bf16_f32 v77, v176, v180
    ds_write_b16 v70, v77 offset:61952
    ds_write_b16_d16_hi v70, v77 offset:61984
    s_add_u32 s8, s5, 4096
    s_waitcnt lgkmcnt(0)
    s_barrier
    ds_read_b64_tr_b16 a[0:1], v224 offset:0
    ds_read_b64_tr_b16 a[2:3], v224 offset:1024
    ds_read_b64_tr_b16 a[16:17], v225 offset:0
    ds_read_b64_tr_b16 a[18:19], v225 offset:1024
    ds_read_b64_tr_b16 a[32:33], v226 offset:0
    ds_read_b64_tr_b16 a[34:35], v226 offset:1024
    ds_read_b64_tr_b16 a[48:49], v227 offset:0
    ds_read_b64_tr_b16 a[50:51], v227 offset:1024
    ds_read_b64_tr_b16 a[64:65], v228 offset:0
    ds_read_b64_tr_b16 a[66:67], v228 offset:1024
    ds_read_b64_tr_b16 a[80:81], v229 offset:0
    ds_read_b64_tr_b16 a[82:83], v229 offset:1024
    ds_read_b64_tr_b16 a[96:97], v230 offset:0
    ds_read_b64_tr_b16 a[98:99], v230 offset:1024
    ds_read_b64_tr_b16 a[112:113], v231 offset:0
    ds_read_b64_tr_b16 a[114:115], v231 offset:1024
    ds_read_b128 v[112:115], v55 offset:63232
    ds_read_b128 v[116:119], v55 offset:63296
    ds_read_b128 v[120:123], v55 offset:63360
    ds_read_b128 v[124:127], v55 offset:63424
    ds_read_b128 v[128:131], v55 offset:63488
    ds_read_b128 v[132:135], v55 offset:63552
    ds_read_b128 v[136:139], v55 offset:63616
    ds_read_b128 v[140:143], v55 offset:63680
    ds_read_b64_tr_b16 a[4:5], v224 offset:8192
    ds_read_b64_tr_b16 a[6:7], v224 offset:9216
    ds_read_b64_tr_b16 a[20:21], v225 offset:8192
    ds_read_b64_tr_b16 a[22:23], v225 offset:9216
    ds_read_b64_tr_b16 a[36:37], v226 offset:8192
    ds_read_b64_tr_b16 a[38:39], v226 offset:9216
    ds_read_b64_tr_b16 a[52:53], v227 offset:8192
    ds_read_b64_tr_b16 a[54:55], v227 offset:9216
    ds_read_b64_tr_b16 a[68:69], v228 offset:8192
    ds_read_b64_tr_b16 a[70:71], v228 offset:9216
    ds_read_b64_tr_b16 a[84:85], v229 offset:8192
    ds_read_b64_tr_b16 a[86:87], v229 offset:9216
    ds_read_b64_tr_b16 a[100:101], v230 offset:8192
    ds_read_b64_tr_b16 a[102:103], v230 offset:9216
    ds_read_b64_tr_b16 a[116:117], v231 offset:8192
    ds_read_b64_tr_b16 a[118:119], v231 offset:9216
    ds_read_b64_tr_b16 a[8:9], v224 offset:16384
    ds_read_b64_tr_b16 a[10:11], v224 offset:17408
    ds_read_b64_tr_b16 a[24:25], v225 offset:16384
    ds_read_b64_tr_b16 a[26:27], v225 offset:17408
    ds_read_b64_tr_b16 a[40:41], v226 offset:16384
    ds_read_b64_tr_b16 a[42:43], v226 offset:17408
    ds_read_b64_tr_b16 a[56:57], v227 offset:16384
    ds_read_b64_tr_b16 a[58:59], v227 offset:17408
    ds_read_b64_tr_b16 a[72:73], v228 offset:16384
    ds_read_b64_tr_b16 a[74:75], v228 offset:17408
    ds_read_b64_tr_b16 a[88:89], v229 offset:16384
    ds_read_b64_tr_b16 a[90:91], v229 offset:17408
    ds_read_b64_tr_b16 a[104:105], v230 offset:16384
    ds_read_b64_tr_b16 a[106:107], v230 offset:17408
    ds_read_b64_tr_b16 a[120:121], v231 offset:16384
    ds_read_b64_tr_b16 a[122:123], v231 offset:17408
    ds_read_b64_tr_b16 a[12:13], v224 offset:24576
    ds_read_b64_tr_b16 a[14:15], v224 offset:25600
    ds_read_b64_tr_b16 a[28:29], v225 offset:24576
    ds_read_b64_tr_b16 a[30:31], v225 offset:25600
    ds_read_b64_tr_b16 a[44:45], v226 offset:24576
    ds_read_b64_tr_b16 a[46:47], v226 offset:25600
    ds_read_b64_tr_b16 a[60:61], v227 offset:24576
    ds_read_b64_tr_b16 a[62:63], v227 offset:25600
    ds_read_b64_tr_b16 a[76:77], v228 offset:24576
    ds_read_b64_tr_b16 a[78:79], v228 offset:25600
    ds_read_b64_tr_b16 a[92:93], v229 offset:24576
    ds_read_b64_tr_b16 a[94:95], v229 offset:25600
    ds_read_b64_tr_b16 a[108:109], v230 offset:24576
    ds_read_b64_tr_b16 a[110:111], v230 offset:25600
    ds_read_b64_tr_b16 a[124:125], v231 offset:24576
    ds_read_b64_tr_b16 a[126:127], v231 offset:25600
    ds_read_b128 a[128:131], v64 offset:61440
    ds_read_b128 a[132:135], v64 offset:61568
    ds_read_b128 a[136:139], v64 offset:61952
    ds_read_b128 a[140:143], v64 offset:62080
    ds_read_b128 a[144:147], v65 offset:61440
    ds_read_b128 a[148:151], v65 offset:61568
    ds_read_b128 a[152:155], v65 offset:61952
    ds_read_b128 a[156:159], v65 offset:62080
    ds_read_b128 a[160:163], v66 offset:61440
    ds_read_b128 a[164:167], v66 offset:61568
    ds_read_b128 a[168:171], v66 offset:61952
    ds_read_b128 a[172:175], v66 offset:62080
    ds_read_b128 a[176:179], v67 offset:61440
    ds_read_b128 a[180:183], v67 offset:61568
    ds_read_b128 a[184:187], v67 offset:61952
    ds_read_b128 a[188:191], v67 offset:62080
    v_mov_b32 v76, 0x50689745
    v_mov_b32 v77, 0x38297176
    v_cndmask_b32 v76, v76, v77, vcc
    v_bfe_u32 v76, v76, v75, 4
    v_xor_b32 v77, v76, v49
    v_lshlrev_b32 v77, 4, v77
    v_lshl_add_u32 v77, v76, 8, v77
    v_add_u32 v2, s8, v77
    v_xor_b32 v3, 64, v2
    v_xor_b32 v4, 128, v2
    v_xor_b32 v5, 192, v2
    v_mov_b32 v76, 0x31892621
    v_mov_b32 v77, 0x5360447
    v_cndmask_b32 v76, v76, v77, vcc
    v_bfe_u32 v76, v76, v75, 4
    v_xor_b32 v77, v76, v49
    v_lshlrev_b32 v77, 4, v77
    v_lshl_add_u32 v77, v76, 8, v77
    v_add_u32 v6, s8, v77
    v_xor_b32 v7, 64, v6
    v_xor_b32 v8, 128, v6
    v_xor_b32 v9, 192, v6
    v_mov_b32 v76, 0xff800000
    v_mov_b32 v232, 0
    v_mov_b32 v233, 0
    v_mov_b32 v234, 0
    v_mov_b32 v235, 0
    s_mov_b32 s12, 0xffffffff
    s_mov_b32 s13, 0xffffff
    v_cndmask_b32 v236, v76, 0, s[12:13]
    v_mov_b32 v237, 0
    v_mov_b32 v238, 0
    v_mov_b32 v239, 0
    v_mov_b32 v240, 0
    v_mov_b32 v241, 0
    v_mov_b32 v242, 0
    v_mov_b32 v243, 0
    v_mov_b32 v244, 0
    v_mov_b32 v245, 0
    v_mov_b32 v246, 0
    v_mov_b32 v247, 0
    s_mov_b32 s12, 0xffffffff
    s_mov_b32 s13, 0xffffdfff
    v_cndmask_b32 v248, v76, 0, s[12:13]
    v_mov_b32 v249, 0
    v_mov_b32 v250, 0
    v_mov_b32 v251, 0
    s_mov_b32 s12, 0xfbfe
    s_mov_b32 s13, 0x0
    v_cndmask_b32 v252, v76, 0, s[12:13]
    v_mov_b32 v253, 0
    v_mov_b32 v254, 0
    v_mov_b32 v255, 0
    v_mov_b32 v10, 0x3f38aa3b
    v_cmp_eq_u32 vcc, 63, v50
    s_lshl_b32 s8, s4, 1
    v_mov_b32 v75, s8
    v_mov_b32 v76, 0x7ffffff0
    v_cndmask_b32 v11, v76, v75, vcc
    s_waitcnt vmcnt(3)
    ds_read_b128 v[32:35], v216
    ds_read_b128 v[36:39], v217
    ds_read_b128 v[40:43], v218
    ds_read_b128 v[44:47], v219
    s_waitcnt lgkmcnt(3)
    v_lshlrev_b32 v16, 16, v32
    v_and_b32 v17, 0xffff0000, v32
    v_lshlrev_b32 v18, 16, v33
    v_and_b32 v19, 0xffff0000, v33
    v_lshlrev_b32 v20, 16, v34
    v_and_b32 v21, 0xffff0000, v34
    v_lshlrev_b32 v22, 16, v35
    v_and_b32 v23, 0xffff0000, v35
    v_mul_f32_dpp v224, v16, v16 row_ror:1 row_mask:0xf bank_mask:0xf
    v_mul_f32_dpp v225, v17, v17 row_ror:1 row_mask:0xf bank_mask:0xf
    v_cvt_pk_bf16_f32 v144, v224, v225
    v_mul_f32_dpp v226, v18, v18 row_ror:1 row_mask:0xf bank_mask:0xf
    v_mul_f32_dpp v227, v19, v19 row_ror:1 row_mask:0xf bank_mask:0xf
    v_cvt_pk_bf16_f32 v145, v226, v227
    v_mul_f32_dpp v228, v20, v20 row_ror:1 row_mask:0xf bank_mask:0xf
    v_mul_f32_dpp v229, v21, v21 row_ror:1 row_mask:0xf bank_mask:0xf
    v_cvt_pk_bf16_f32 v146, v228, v229
    v_mul_f32_dpp v230, v22, v22 row_ror:1 row_mask:0xf bank_mask:0xf
    v_mul_f32_dpp v231, v23, v23 row_ror:1 row_mask:0xf bank_mask:0xf
    v_cvt_pk_bf16_f32 v147, v230, v231
    s_waitcnt lgkmcnt(2)
    v_lshlrev_b32 v24, 16, v36
    v_mfma_f32_16x16x32_bf16 v[176:179], a[0:3], v[144:147], v[112:115]
    v_and_b32 v25, 0xffff0000, v36
    v_lshlrev_b32 v26, 16, v37
    v_mfma_f32_16x16x32_bf16 v[180:183], a[16:19], v[144:147], v[116:119]
    v_and_b32 v27, 0xffff0000, v37
    v_lshlrev_b32 v28, 16, v38
    v_mfma_f32_16x16x32_bf16 v[184:187], a[32:35], v[144:147], v[120:123]
    v_and_b32 v29, 0xffff0000, v38
    v_lshlrev_b32 v30, 16, v39
    v_mfma_f32_16x16x32_bf16 v[188:191], a[48:51], v[144:147], v[124:127]
    v_and_b32 v31, 0xffff0000, v39
    v_mul_f32_dpp v224, v24, v24 row_ror:1 row_mask:0xf bank_mask:0xf
    v_mfma_f32_16x16x32_bf16 v[192:195], a[64:67], v[144:147], v[128:131]
    v_mul_f32_dpp v225, v25, v25 row_ror:1 row_mask:0xf bank_mask:0xf
    v_cvt_pk_bf16_f32 v148, v224, v225
    v_mfma_f32_16x16x32_bf16 v[196:199], a[80:83], v[144:147], v[132:135]
    v_mul_f32_dpp v226, v26, v26 row_ror:1 row_mask:0xf bank_mask:0xf
    v_mul_f32_dpp v227, v27, v27 row_ror:1 row_mask:0xf bank_mask:0xf
    v_mfma_f32_16x16x32_bf16 v[200:203], a[96:99], v[144:147], v[136:139]
    v_cvt_pk_bf16_f32 v149, v226, v227
    v_mul_f32_dpp v228, v28, v28 row_ror:1 row_mask:0xf bank_mask:0xf
    v_mfma_f32_16x16x32_bf16 v[204:207], a[112:115], v[144:147], v[140:143]
    v_mul_f32_dpp v229, v29, v29 row_ror:1 row_mask:0xf bank_mask:0xf
    v_cvt_pk_bf16_f32 v150, v228, v229
    v_mul_f32_dpp v230, v30, v30 row_ror:1 row_mask:0xf bank_mask:0xf
    v_mul_f32_dpp v231, v31, v31 row_ror:1 row_mask:0xf bank_mask:0xf
    v_cvt_pk_bf16_f32 v151, v230, v231
    s_waitcnt lgkmcnt(1)
    v_lshlrev_b32 v32, 16, v40
    v_mfma_f32_16x16x32_bf16 v[204:207], a[116:119], v[148:151], v[204:207]
    v_and_b32 v33, 0xffff0000, v40
    v_lshlrev_b32 v34, 16, v41
    v_smfmac_f32_16x16x64_bf16 v[232:235], a[136:139], v[144:151], v1
    v_and_b32 v35, 0xffff0000, v41
    v_lshlrev_b32 v36, 16, v42
    v_mfma_f32_16x16x32_bf16 v[176:179], a[4:7], v[148:151], v[176:179]
    v_and_b32 v37, 0xffff0000, v42
    v_lshlrev_b32 v38, 16, v43
    v_mfma_f32_16x16x32_bf16 v[180:183], a[20:23], v[148:151], v[180:183]
    v_and_b32 v39, 0xffff0000, v43
    v_mul_f32_dpp v224, v32, v32 row_ror:1 row_mask:0xf bank_mask:0xf
    v_mfma_f32_16x16x32_bf16 v[184:187], a[36:39], v[148:151], v[184:187]
    v_mul_f32_dpp v225, v33, v33 row_ror:1 row_mask:0xf bank_mask:0xf
    v_cvt_pk_bf16_f32 v152, v224, v225
    v_mfma_f32_16x16x32_bf16 v[188:191], a[52:55], v[148:151], v[188:191]
    v_mul_f32_dpp v226, v34, v34 row_ror:1 row_mask:0xf bank_mask:0xf
    v_mul_f32_dpp v227, v35, v35 row_ror:1 row_mask:0xf bank_mask:0xf
    v_mfma_f32_16x16x32_bf16 v[192:195], a[68:71], v[148:151], v[192:195]
    v_cvt_pk_bf16_f32 v153, v226, v227
    v_mul_f32_dpp v228, v36, v36 row_ror:1 row_mask:0xf bank_mask:0xf
    v_mfma_f32_16x16x32_bf16 v[196:199], a[84:87], v[148:151], v[196:199]
    v_mul_f32_dpp v229, v37, v37 row_ror:1 row_mask:0xf bank_mask:0xf
    v_cvt_pk_bf16_f32 v154, v228, v229
    v_mfma_f32_16x16x32_bf16 v[200:203], a[100:103], v[148:151], v[200:203]
    v_mul_f32_dpp v230, v38, v38 row_ror:1 row_mask:0xf bank_mask:0xf
    v_mul_f32_dpp v231, v39, v39 row_ror:1 row_mask:0xf bank_mask:0xf
    v_cvt_pk_bf16_f32 v155, v230, v231
    s_waitcnt lgkmcnt(0)
    v_lshlrev_b32 v40, 16, v44
    v_mfma_f32_16x16x32_bf16 v[200:203], a[104:107], v[152:155], v[200:203]
    v_and_b32 v41, 0xffff0000, v44
    v_lshlrev_b32 v42, 16, v45
    v_mfma_f32_16x16x32_bf16 v[176:179], a[8:11], v[152:155], v[176:179]
    v_and_b32 v43, 0xffff0000, v45
    v_lshlrev_b32 v44, 16, v46
    v_mfma_f32_16x16x32_bf16 v[180:183], a[24:27], v[152:155], v[180:183]
    v_and_b32 v45, 0xffff0000, v46
    v_lshlrev_b32 v46, 16, v47
    v_mfma_f32_16x16x32_bf16 v[184:187], a[40:43], v[152:155], v[184:187]
    v_and_b32 v47, 0xffff0000, v47
    v_mul_f32_dpp v224, v40, v40 row_ror:1 row_mask:0xf bank_mask:0xf
    v_mfma_f32_16x16x32_bf16 v[188:191], a[56:59], v[152:155], v[188:191]
    v_mul_f32_dpp v225, v41, v41 row_ror:1 row_mask:0xf bank_mask:0xf
    v_cvt_pk_bf16_f32 v156, v224, v225
    v_mfma_f32_16x16x32_bf16 v[192:195], a[72:75], v[152:155], v[192:195]
    v_mul_f32_dpp v226, v42, v42 row_ror:1 row_mask:0xf bank_mask:0xf
    v_mul_f32_dpp v227, v43, v43 row_ror:1 row_mask:0xf bank_mask:0xf
    v_mfma_f32_16x16x32_bf16 v[196:199], a[88:91], v[152:155], v[196:199]
    v_cvt_pk_bf16_f32 v157, v226, v227
    v_mul_f32_dpp v228, v44, v44 row_ror:1 row_mask:0xf bank_mask:0xf
    v_mfma_f32_16x16x32_bf16 v[204:207], a[120:123], v[152:155], v[204:207]
    v_mul_f32_dpp v229, v45, v45 row_ror:1 row_mask:0xf bank_mask:0xf
    v_cvt_pk_bf16_f32 v158, v228, v229
    v_mul_f32_dpp v230, v46, v46 row_ror:1 row_mask:0xf bank_mask:0xf
    v_mul_f32_dpp v231, v47, v47 row_ror:1 row_mask:0xf bank_mask:0xf
    v_cvt_pk_bf16_f32 v159, v230, v231
    v_mul_f32_dpp v224, v16, v16 row_ror:2 row_mask:0xf bank_mask:0xf
    v_mul_f32_dpp v225, v17, v17 row_ror:2 row_mask:0xf bank_mask:0xf
    v_mfma_f32_16x16x32_bf16 v[204:207], a[124:127], v[156:159], v[204:207]
    v_cvt_pk_bf16_f32 v160, v224, v225
    v_mul_f32_dpp v226, v18, v18 row_ror:2 row_mask:0xf bank_mask:0xf
    v_smfmac_f32_16x16x64_bf16 v[232:235], a[140:143], v[152:159], v1
    v_mul_f32_dpp v227, v19, v19 row_ror:2 row_mask:0xf bank_mask:0xf
    v_cvt_pk_bf16_f32 v161, v226, v227
    v_mfma_f32_16x16x32_bf16 v[176:179], a[12:15], v[156:159], v[176:179]
    v_mul_f32_dpp v228, v20, v20 row_ror:2 row_mask:0xf bank_mask:0xf
    v_mul_f32_dpp v229, v21, v21 row_ror:2 row_mask:0xf bank_mask:0xf
    v_mfma_f32_16x16x32_bf16 v[180:183], a[28:31], v[156:159], v[180:183]
    v_cvt_pk_bf16_f32 v162, v228, v229
    v_mul_f32_dpp v230, v22, v22 row_ror:2 row_mask:0xf bank_mask:0xf
    v_mfma_f32_16x16x32_bf16 v[184:187], a[44:47], v[156:159], v[184:187]
    v_mul_f32_dpp v231, v23, v23 row_ror:2 row_mask:0xf bank_mask:0xf
    v_cvt_pk_bf16_f32 v163, v230, v231
    v_mfma_f32_16x16x32_bf16 v[188:191], a[60:63], v[156:159], v[188:191]
    v_cvt_pk_bf16_f32 v208, |v176|, |v177|
    v_cvt_pk_bf16_f32 v209, |v178|, |v179|
    v_mfma_f32_16x16x32_bf16 v[192:195], a[76:79], v[156:159], v[192:195]
    v_cvt_pk_bf16_f32 v210, |v180|, |v181|
    v_cvt_pk_bf16_f32 v211, |v182|, |v183|
    v_mfma_f32_16x16x32_bf16 v[196:199], a[92:95], v[156:159], v[196:199]
    v_cvt_pk_bf16_f32 v212, |v184|, |v185|
    v_cvt_pk_bf16_f32 v213, |v186|, |v187|
    v_mfma_f32_16x16x32_bf16 v[200:203], a[108:111], v[156:159], v[200:203]
    v_cvt_pk_bf16_f32 v214, |v188|, |v189|
    v_cvt_pk_bf16_f32 v215, |v190|, |v191|
    v_mfma_f32_16x16x32_bf16 v[176:179], a[0:3], v[160:163], v[112:115]
    v_cvt_pk_bf16_f32 v216, |v192|, |v193|
    v_cvt_pk_bf16_f32 v217, |v194|, |v195|
    v_smfmac_f32_16x16x64_bf16 v[232:235], a[128:131], v[208:215], v1
    v_cvt_pk_bf16_f32 v218, |v196|, |v197|
    v_cvt_pk_bf16_f32 v219, |v198|, |v199|
    v_mfma_f32_16x16x32_bf16 v[180:183], a[16:19], v[160:163], v[116:119]
    v_cvt_pk_bf16_f32 v220, |v200|, |v201|
    v_cvt_pk_bf16_f32 v221, |v202|, |v203|
    v_mfma_f32_16x16x32_bf16 v[184:187], a[32:35], v[160:163], v[120:123]
    v_cvt_pk_bf16_f32 v222, |v204|, |v205|
    v_cvt_pk_bf16_f32 v223, |v206|, |v207|
    v_mfma_f32_16x16x32_bf16 v[188:191], a[48:51], v[160:163], v[124:127]
    v_mul_f32_dpp v224, v24, v24 row_ror:2 row_mask:0xf bank_mask:0xf
    v_mul_f32_dpp v225, v25, v25 row_ror:2 row_mask:0xf bank_mask:0xf
    v_smfmac_f32_16x16x64_bf16 v[232:235], a[132:135], v[216:223], v1
    v_cvt_pk_bf16_f32 v164, v224, v225
    v_mul_f32_dpp v226, v26, v26 row_ror:2 row_mask:0xf bank_mask:0xf
    v_mfma_f32_16x16x32_bf16 v[192:195], a[64:67], v[160:163], v[128:131]
    v_mul_f32_dpp v227, v27, v27 row_ror:2 row_mask:0xf bank_mask:0xf
    v_cvt_pk_bf16_f32 v165, v226, v227
    v_mfma_f32_16x16x32_bf16 v[196:199], a[80:83], v[160:163], v[132:135]
    v_mul_f32_dpp v228, v28, v28 row_ror:2 row_mask:0xf bank_mask:0xf
    v_mul_f32_dpp v229, v29, v29 row_ror:2 row_mask:0xf bank_mask:0xf
    v_mfma_f32_16x16x32_bf16 v[200:203], a[96:99], v[160:163], v[136:139]
    v_cvt_pk_bf16_f32 v166, v228, v229
    v_mul_f32_dpp v230, v30, v30 row_ror:2 row_mask:0xf bank_mask:0xf
    v_mfma_f32_16x16x32_bf16 v[204:207], a[112:115], v[160:163], v[140:143]
    v_mul_f32_dpp v231, v31, v31 row_ror:2 row_mask:0xf bank_mask:0xf
    v_cvt_pk_bf16_f32 v167, v230, v231
    v_mul_f32_dpp v224, v32, v32 row_ror:2 row_mask:0xf bank_mask:0xf
    v_mul_f32_dpp v225, v33, v33 row_ror:2 row_mask:0xf bank_mask:0xf
    v_mfma_f32_16x16x32_bf16 v[204:207], a[116:119], v[164:167], v[204:207]
    v_cvt_pk_bf16_f32 v168, v224, v225
    v_mul_f32_dpp v226, v34, v34 row_ror:2 row_mask:0xf bank_mask:0xf
    v_smfmac_f32_16x16x64_bf16 v[232:235], a[152:155], v[160:167], v1
    v_mul_f32_dpp v227, v35, v35 row_ror:2 row_mask:0xf bank_mask:0xf
    v_cvt_pk_bf16_f32 v169, v226, v227
    v_mfma_f32_16x16x32_bf16 v[176:179], a[4:7], v[164:167], v[176:179]
    v_mul_f32_dpp v228, v36, v36 row_ror:2 row_mask:0xf bank_mask:0xf
    v_mul_f32_dpp v229, v37, v37 row_ror:2 row_mask:0xf bank_mask:0xf
    v_mfma_f32_16x16x32_bf16 v[180:183], a[20:23], v[164:167], v[180:183]
    v_cvt_pk_bf16_f32 v170, v228, v229
    v_mul_f32_dpp v230, v38, v38 row_ror:2 row_mask:0xf bank_mask:0xf
    v_mfma_f32_16x16x32_bf16 v[184:187], a[36:39], v[164:167], v[184:187]
    v_mul_f32_dpp v231, v39, v39 row_ror:2 row_mask:0xf bank_mask:0xf
    v_cvt_pk_bf16_f32 v171, v230, v231
    v_mfma_f32_16x16x32_bf16 v[188:191], a[52:55], v[164:167], v[188:191]
    v_mul_f32_dpp v224, v40, v40 row_ror:2 row_mask:0xf bank_mask:0xf
    v_mul_f32_dpp v225, v41, v41 row_ror:2 row_mask:0xf bank_mask:0xf
    v_mfma_f32_16x16x32_bf16 v[188:191], a[56:59], v[168:171], v[188:191]
    v_cvt_pk_bf16_f32 v172, v224, v225
    v_mul_f32_dpp v226, v42, v42 row_ror:2 row_mask:0xf bank_mask:0xf
    v_mfma_f32_16x16x32_bf16 v[176:179], a[8:11], v[168:171], v[176:179]
    v_mul_f32_dpp v227, v43, v43 row_ror:2 row_mask:0xf bank_mask:0xf
    v_cvt_pk_bf16_f32 v173, v226, v227
    v_mfma_f32_16x16x32_bf16 v[180:183], a[24:27], v[168:171], v[180:183]
    v_mul_f32_dpp v228, v44, v44 row_ror:2 row_mask:0xf bank_mask:0xf
    v_mul_f32_dpp v229, v45, v45 row_ror:2 row_mask:0xf bank_mask:0xf
    v_mfma_f32_16x16x32_bf16 v[184:187], a[40:43], v[168:171], v[184:187]
    v_cvt_pk_bf16_f32 v174, v228, v229
    v_mul_f32_dpp v230, v46, v46 row_ror:2 row_mask:0xf bank_mask:0xf
    v_mfma_f32_16x16x32_bf16 v[192:195], a[68:71], v[164:167], v[192:195]
    v_mul_f32_dpp v231, v47, v47 row_ror:2 row_mask:0xf bank_mask:0xf
    v_cvt_pk_bf16_f32 v175, v230, v231
    v_mfma_f32_16x16x32_bf16 v[192:195], a[72:75], v[168:171], v[192:195]
    v_mul_f32_dpp v224, v16, v16 row_ror:3 row_mask:0xf bank_mask:0xf
    v_mul_f32_dpp v225, v17, v17 row_ror:3 row_mask:0xf bank_mask:0xf
    v_mfma_f32_16x16x32_bf16 v[192:195], a[76:79], v[172:175], v[192:195]
    v_cvt_pk_bf16_f32 v144, v224, v225
    v_mul_f32_dpp v226, v18, v18 row_ror:3 row_mask:0xf bank_mask:0xf
    v_smfmac_f32_16x16x64_bf16 v[232:235], a[156:159], v[168:175], v1
    v_mul_f32_dpp v227, v19, v19 row_ror:3 row_mask:0xf bank_mask:0xf
    v_cvt_pk_bf16_f32 v145, v226, v227
    v_mfma_f32_16x16x32_bf16 v[176:179], a[12:15], v[172:175], v[176:179]
    v_mul_f32_dpp v228, v20, v20 row_ror:3 row_mask:0xf bank_mask:0xf
    v_mul_f32_dpp v229, v21, v21 row_ror:3 row_mask:0xf bank_mask:0xf
    v_mfma_f32_16x16x32_bf16 v[180:183], a[28:31], v[172:175], v[180:183]
    v_cvt_pk_bf16_f32 v146, v228, v229
    v_mul_f32_dpp v230, v22, v22 row_ror:3 row_mask:0xf bank_mask:0xf
    v_mfma_f32_16x16x32_bf16 v[184:187], a[44:47], v[172:175], v[184:187]
    v_mul_f32_dpp v231, v23, v23 row_ror:3 row_mask:0xf bank_mask:0xf
    v_cvt_pk_bf16_f32 v147, v230, v231
    v_mfma_f32_16x16x32_bf16 v[188:191], a[60:63], v[172:175], v[188:191]
    v_cvt_pk_bf16_f32 v208, |v176|, |v177|
    v_cvt_pk_bf16_f32 v209, |v178|, |v179|
    v_mfma_f32_16x16x32_bf16 v[196:199], a[84:87], v[164:167], v[196:199]
    v_cvt_pk_bf16_f32 v210, |v180|, |v181|
    v_cvt_pk_bf16_f32 v211, |v182|, |v183|
    v_mfma_f32_16x16x32_bf16 v[196:199], a[88:91], v[168:171], v[196:199]
    v_cvt_pk_bf16_f32 v212, |v184|, |v185|
    v_cvt_pk_bf16_f32 v213, |v186|, |v187|
    v_mfma_f32_16x16x32_bf16 v[196:199], a[92:95], v[172:175], v[196:199]
    v_cvt_pk_bf16_f32 v214, |v188|, |v189|
    v_cvt_pk_bf16_f32 v215, |v190|, |v191|
    v_mfma_f32_16x16x32_bf16 v[200:203], a[100:103], v[164:167], v[200:203]
    v_cvt_pk_bf16_f32 v216, |v192|, |v193|
    v_cvt_pk_bf16_f32 v217, |v194|, |v195|
    v_mfma_f32_16x16x32_bf16 v[200:203], a[104:107], v[168:171], v[200:203]
    v_mul_f32_dpp v224, v24, v24 row_ror:3 row_mask:0xf bank_mask:0xf
    v_mul_f32_dpp v225, v25, v25 row_ror:3 row_mask:0xf bank_mask:0xf
    v_mfma_f32_16x16x32_bf16 v[200:203], a[108:111], v[172:175], v[200:203]
    v_cvt_pk_bf16_f32 v218, |v196|, |v197|
    v_cvt_pk_bf16_f32 v219, |v198|, |v199|
    v_smfmac_f32_16x16x64_bf16 v[232:235], a[144:147], v[208:215], v1
    v_cvt_pk_bf16_f32 v148, v224, v225
    v_mul_f32_dpp v226, v26, v26 row_ror:3 row_mask:0xf bank_mask:0xf
    v_mfma_f32_16x16x32_bf16 v[204:207], a[120:123], v[168:171], v[204:207]
    v_mul_f32_dpp v227, v27, v27 row_ror:3 row_mask:0xf bank_mask:0xf
    v_cvt_pk_bf16_f32 v149, v226, v227
    v_mfma_f32_16x16x32_bf16 v[204:207], a[124:127], v[172:175], v[204:207]
    v_cvt_pk_bf16_f32 v220, |v200|, |v201|
    v_cvt_pk_bf16_f32 v221, |v202|, |v203|
    v_mfma_f32_16x16x32_bf16 v[176:179], a[0:3], v[144:147], v[112:115]
    v_mul_f32_dpp v228, v28, v28 row_ror:3 row_mask:0xf bank_mask:0xf
    v_mul_f32_dpp v229, v29, v29 row_ror:3 row_mask:0xf bank_mask:0xf
    v_mfma_f32_16x16x32_bf16 v[180:183], a[16:19], v[144:147], v[116:119]
    v_cvt_pk_bf16_f32 v150, v228, v229
    v_mul_f32_dpp v230, v30, v30 row_ror:3 row_mask:0xf bank_mask:0xf
    v_mfma_f32_16x16x32_bf16 v[184:187], a[32:35], v[144:147], v[120:123]
    v_cvt_pk_bf16_f32 v222, |v204|, |v205|
    v_cvt_pk_bf16_f32 v223, |v206|, |v207|
    v_mfma_f32_16x16x32_bf16 v[188:191], a[48:51], v[144:147], v[124:127]
    v_mul_f32_dpp v231, v31, v31 row_ror:3 row_mask:0xf bank_mask:0xf
    v_cvt_pk_bf16_f32 v151, v230, v231
    v_smfmac_f32_16x16x64_bf16 v[232:235], a[148:151], v[216:223], v1
    v_mul_f32_dpp v224, v32, v32 row_ror:3 row_mask:0xf bank_mask:0xf
    v_mul_f32_dpp v225, v33, v33 row_ror:3 row_mask:0xf bank_mask:0xf
    v_mfma_f32_16x16x32_bf16 v[176:179], a[4:7], v[148:151], v[176:179]
    v_cvt_pk_bf16_f32 v152, v224, v225
    v_mul_f32_dpp v226, v34, v34 row_ror:3 row_mask:0xf bank_mask:0xf
    v_smfmac_f32_16x16x64_bf16 v[232:235], a[168:171], v[144:151], v1
    v_mul_f32_dpp v227, v35, v35 row_ror:3 row_mask:0xf bank_mask:0xf
    v_cvt_pk_bf16_f32 v153, v226, v227
    v_mfma_f32_16x16x32_bf16 v[180:183], a[20:23], v[148:151], v[180:183]
    v_mul_f32_dpp v228, v36, v36 row_ror:3 row_mask:0xf bank_mask:0xf
    v_mul_f32_dpp v229, v37, v37 row_ror:3 row_mask:0xf bank_mask:0xf
    v_mfma_f32_16x16x32_bf16 v[184:187], a[36:39], v[148:151], v[184:187]
    v_cvt_pk_bf16_f32 v154, v228, v229
    v_mul_f32_dpp v230, v38, v38 row_ror:3 row_mask:0xf bank_mask:0xf
    v_mfma_f32_16x16x32_bf16 v[188:191], a[52:55], v[148:151], v[188:191]
    v_mul_f32_dpp v231, v39, v39 row_ror:3 row_mask:0xf bank_mask:0xf
    v_cvt_pk_bf16_f32 v155, v230, v231
    v_mfma_f32_16x16x32_bf16 v[192:195], a[64:67], v[144:147], v[128:131]
    v_mul_f32_dpp v224, v40, v40 row_ror:3 row_mask:0xf bank_mask:0xf
    v_mul_f32_dpp v225, v41, v41 row_ror:3 row_mask:0xf bank_mask:0xf
    v_mfma_f32_16x16x32_bf16 v[192:195], a[68:71], v[148:151], v[192:195]
    v_cvt_pk_bf16_f32 v156, v224, v225
    v_mul_f32_dpp v226, v42, v42 row_ror:3 row_mask:0xf bank_mask:0xf
    v_mfma_f32_16x16x32_bf16 v[192:195], a[72:75], v[152:155], v[192:195]
    v_mul_f32_dpp v227, v43, v43 row_ror:3 row_mask:0xf bank_mask:0xf
    v_cvt_pk_bf16_f32 v157, v226, v227
    v_mfma_f32_16x16x32_bf16 v[176:179], a[8:11], v[152:155], v[176:179]
    v_mul_f32_dpp v228, v44, v44 row_ror:3 row_mask:0xf bank_mask:0xf
    v_mul_f32_dpp v229, v45, v45 row_ror:3 row_mask:0xf bank_mask:0xf
    v_mfma_f32_16x16x32_bf16 v[180:183], a[24:27], v[152:155], v[180:183]
    v_cvt_pk_bf16_f32 v158, v228, v229
    v_mul_f32_dpp v230, v46, v46 row_ror:3 row_mask:0xf bank_mask:0xf
    v_mfma_f32_16x16x32_bf16 v[184:187], a[40:43], v[152:155], v[184:187]
    v_mul_f32_dpp v231, v47, v47 row_ror:3 row_mask:0xf bank_mask:0xf
    v_cvt_pk_bf16_f32 v159, v230, v231
    v_mfma_f32_16x16x32_bf16 v[188:191], a[56:59], v[152:155], v[188:191]
    v_mul_f32_dpp v224, v16, v16 row_ror:4 row_mask:0xf bank_mask:0xf
    v_mul_f32_dpp v225, v17, v17 row_ror:4 row_mask:0xf bank_mask:0xf
    v_mfma_f32_16x16x32_bf16 v[188:191], a[60:63], v[156:159], v[188:191]
    v_cvt_pk_bf16_f32 v160, v224, v225
    v_mul_f32_dpp v226, v18, v18 row_ror:4 row_mask:0xf bank_mask:0xf
    v_smfmac_f32_16x16x64_bf16 v[232:235], a[172:175], v[152:159], v1
    v_mul_f32_dpp v227, v19, v19 row_ror:4 row_mask:0xf bank_mask:0xf
    v_cvt_pk_bf16_f32 v161, v226, v227
    v_mfma_f32_16x16x32_bf16 v[176:179], a[12:15], v[156:159], v[176:179]
    v_mul_f32_dpp v228, v20, v20 row_ror:4 row_mask:0xf bank_mask:0xf
    v_mul_f32_dpp v229, v21, v21 row_ror:4 row_mask:0xf bank_mask:0xf
    v_mfma_f32_16x16x32_bf16 v[180:183], a[28:31], v[156:159], v[180:183]
    v_cvt_pk_bf16_f32 v162, v228, v229
    v_mul_f32_dpp v230, v22, v22 row_ror:4 row_mask:0xf bank_mask:0xf
    v_mfma_f32_16x16x32_bf16 v[184:187], a[44:47], v[156:159], v[184:187]
    v_mul_f32_dpp v231, v23, v23 row_ror:4 row_mask:0xf bank_mask:0xf
    v_cvt_pk_bf16_f32 v163, v230, v231
    v_mfma_f32_16x16x32_bf16 v[192:195], a[76:79], v[156:159], v[192:195]
    v_cvt_pk_bf16_f32 v208, |v176|, |v177|
    v_cvt_pk_bf16_f32 v209, |v178|, |v179|
    v_mfma_f32_16x16x32_bf16 v[196:199], a[80:83], v[144:147], v[132:135]
    v_cvt_pk_bf16_f32 v210, |v180|, |v181|
    v_cvt_pk_bf16_f32 v211, |v182|, |v183|
    v_mfma_f32_16x16x32_bf16 v[196:199], a[84:87], v[148:151], v[196:199]
    v_cvt_pk_bf16_f32 v212, |v184|, |v185|
    v_cvt_pk_bf16_f32 v213, |v186|, |v187|
    v_mfma_f32_16x16x32_bf16 v[196:199], a[88:91], v[152:155], v[196:199]
    v_cvt_pk_bf16_f32 v214, |v188|, |v189|
    v_cvt_pk_bf16_f32 v215, |v190|, |v191|
    v_mfma_f32_16x16x32_bf16 v[196:199], a[92:95], v[156:159], v[196:199]
    v_cvt_pk_bf16_f32 v216, |v192|, |v193|
    v_cvt_pk_bf16_f32 v217, |v194|, |v195|
    v_smfmac_f32_16x16x64_bf16 v[232:235], a[160:163], v[208:215], v1
    v_mul_f32_dpp v224, v24, v24 row_ror:4 row_mask:0xf bank_mask:0xf
    v_mul_f32_dpp v225, v25, v25 row_ror:4 row_mask:0xf bank_mask:0xf
    v_mfma_f32_16x16x32_bf16 v[200:203], a[96:99], v[144:147], v[136:139]
    v_cvt_pk_bf16_f32 v164, v224, v225
    v_mul_f32_dpp v226, v26, v26 row_ror:4 row_mask:0xf bank_mask:0xf
    v_mfma_f32_16x16x32_bf16 v[200:203], a[100:103], v[148:151], v[200:203]
    v_cvt_pk_bf16_f32 v218, |v196|, |v197|
    v_cvt_pk_bf16_f32 v219, |v198|, |v199|
    v_mfma_f32_16x16x32_bf16 v[200:203], a[104:107], v[152:155], v[200:203]
    v_mul_f32_dpp v227, v27, v27 row_ror:4 row_mask:0xf bank_mask:0xf
    v_cvt_pk_bf16_f32 v165, v226, v227
    v_mfma_f32_16x16x32_bf16 v[200:203], a[108:111], v[156:159], v[200:203]
    v_mul_f32_dpp v228, v28, v28 row_ror:4 row_mask:0xf bank_mask:0xf
    v_mul_f32_dpp v229, v29, v29 row_ror:4 row_mask:0xf bank_mask:0xf
    v_mfma_f32_16x16x32_bf16 v[204:207], a[112:115], v[144:147], v[140:143]
    v_cvt_pk_bf16_f32 v166, v228, v229
    v_mul_f32_dpp v230, v30, v30 row_ror:4 row_mask:0xf bank_mask:0xf
    v_mfma_f32_16x16x32_bf16 v[204:207], a[116:119], v[148:151], v[204:207]
    v_mul_f32_dpp v231, v31, v31 row_ror:4 row_mask:0xf bank_mask:0xf
    v_cvt_pk_bf16_f32 v167, v230, v231
    v_mfma_f32_16x16x32_bf16 v[204:207], a[120:123], v[152:155], v[204:207]
    v_cvt_pk_bf16_f32 v220, |v200|, |v201|
    v_cvt_pk_bf16_f32 v221, |v202|, |v203|
    v_mfma_f32_16x16x32_bf16 v[204:207], a[124:127], v[156:159], v[204:207]
    v_mul_f32_dpp v224, v32, v32 row_ror:4 row_mask:0xf bank_mask:0xf
    v_mul_f32_dpp v225, v33, v33 row_ror:4 row_mask:0xf bank_mask:0xf
    v_mfma_f32_16x16x32_bf16 v[176:179], a[0:3], v[160:163], v[112:115]
    v_cvt_pk_bf16_f32 v168, v224, v225
    v_mul_f32_dpp v226, v34, v34 row_ror:4 row_mask:0xf bank_mask:0xf
    v_mfma_f32_16x16x32_bf16 v[176:179], a[4:7], v[164:167], v[176:179]
    v_mul_f32_dpp v227, v35, v35 row_ror:4 row_mask:0xf bank_mask:0xf
    v_cvt_pk_bf16_f32 v169, v226, v227
    v_mfma_f32_16x16x32_bf16 v[180:183], a[16:19], v[160:163], v[116:119]
    v_cvt_pk_bf16_f32 v222, |v204|, |v205|
    v_cvt_pk_bf16_f32 v223, |v206|, |v207|
    v_mfma_f32_16x16x32_bf16 v[180:183], a[20:23], v[164:167], v[180:183]
    v_mul_f32_dpp v228, v36, v36 row_ror:4 row_mask:0xf bank_mask:0xf
    v_mul_f32_dpp v229, v37, v37 row_ror:4 row_mask:0xf bank_mask:0xf
    v_smfmac_f32_16x16x64_bf16 v[232:235], a[164:167], v[216:223], v1
    v_cvt_pk_bf16_f32 v170, v228, v229
    v_mul_f32_dpp v230, v38, v38 row_ror:4 row_mask:0xf bank_mask:0xf
    v_mfma_f32_16x16x32_bf16 v[184:187], a[32:35], v[160:163], v[120:123]
    v_mul_f32_dpp v231, v39, v39 row_ror:4 row_mask:0xf bank_mask:0xf
    v_cvt_pk_bf16_f32 v171, v230, v231
    v_mfma_f32_16x16x32_bf16 v[184:187], a[36:39], v[164:167], v[184:187]
    v_mul_f32_dpp v224, v40, v40 row_ror:4 row_mask:0xf bank_mask:0xf
    v_mul_f32_dpp v225, v41, v41 row_ror:4 row_mask:0xf bank_mask:0xf
    v_mfma_f32_16x16x32_bf16 v[184:187], a[40:43], v[168:171], v[184:187]
    v_cvt_pk_bf16_f32 v172, v224, v225
    v_mul_f32_dpp v226, v42, v42 row_ror:4 row_mask:0xf bank_mask:0xf
    v_smfmac_f32_16x16x64_bf16 v[232:235], a[184:187], v[160:167], v1
    v_mul_f32_dpp v227, v43, v43 row_ror:4 row_mask:0xf bank_mask:0xf
    v_cvt_pk_bf16_f32 v173, v226, v227
    v_mfma_f32_16x16x32_bf16 v[176:179], a[8:11], v[168:171], v[176:179]
    v_mul_f32_dpp v228, v44, v44 row_ror:4 row_mask:0xf bank_mask:0xf
    v_mul_f32_dpp v229, v45, v45 row_ror:4 row_mask:0xf bank_mask:0xf
    v_mfma_f32_16x16x32_bf16 v[180:183], a[24:27], v[168:171], v[180:183]
    v_cvt_pk_bf16_f32 v174, v228, v229
    v_mul_f32_dpp v230, v46, v46 row_ror:4 row_mask:0xf bank_mask:0xf
    v_mfma_f32_16x16x32_bf16 v[188:191], a[48:51], v[160:163], v[124:127]
    v_mul_f32_dpp v231, v47, v47 row_ror:4 row_mask:0xf bank_mask:0xf
    v_cvt_pk_bf16_f32 v175, v230, v231
    v_mfma_f32_16x16x32_bf16 v[188:191], a[52:55], v[164:167], v[188:191]
    v_mul_f32_dpp v224, v16, v16 row_ror:5 row_mask:0xf bank_mask:0xf
    v_mul_f32_dpp v225, v17, v17 row_ror:5 row_mask:0xf bank_mask:0xf
    v_mfma_f32_16x16x32_bf16 v[188:191], a[56:59], v[168:171], v[188:191]
    v_cvt_pk_bf16_f32 v144, v224, v225
    v_mul_f32_dpp v226, v18, v18 row_ror:5 row_mask:0xf bank_mask:0xf
    v_mfma_f32_16x16x32_bf16 v[188:191], a[60:63], v[172:175], v[188:191]
    v_mul_f32_dpp v227, v19, v19 row_ror:5 row_mask:0xf bank_mask:0xf
    v_cvt_pk_bf16_f32 v145, v226, v227
    v_smfmac_f32_16x16x64_bf16 v[232:235], a[188:191], v[168:175], v1
    v_mul_f32_dpp v228, v20, v20 row_ror:5 row_mask:0xf bank_mask:0xf
    v_mul_f32_dpp v229, v21, v21 row_ror:5 row_mask:0xf bank_mask:0xf
    v_mfma_f32_16x16x32_bf16 v[176:179], a[12:15], v[172:175], v[176:179]
    v_cvt_pk_bf16_f32 v146, v228, v229
    v_mul_f32_dpp v230, v22, v22 row_ror:5 row_mask:0xf bank_mask:0xf
    v_mfma_f32_16x16x32_bf16 v[180:183], a[28:31], v[172:175], v[180:183]
    v_mul_f32_dpp v231, v23, v23 row_ror:5 row_mask:0xf bank_mask:0xf
    v_cvt_pk_bf16_f32 v147, v230, v231
    v_mfma_f32_16x16x32_bf16 v[184:187], a[44:47], v[172:175], v[184:187]
    v_cvt_pk_bf16_f32 v214, |v188|, |v189|
    v_cvt_pk_bf16_f32 v215, |v190|, |v191|
    v_mfma_f32_16x16x32_bf16 v[192:195], a[64:67], v[160:163], v[128:131]
    v_cvt_pk_bf16_f32 v208, |v176|, |v177|
    v_cvt_pk_bf16_f32 v209, |v178|, |v179|
    v_mfma_f32_16x16x32_bf16 v[192:195], a[68:71], v[164:167], v[192:195]
    v_cvt_pk_bf16_f32 v210, |v180|, |v181|
    v_cvt_pk_bf16_f32 v211, |v182|, |v183|
    v_mfma_f32_16x16x32_bf16 v[192:195], a[72:75], v[168:171], v[192:195]
    v_cvt_pk_bf16_f32 v212, |v184|, |v185|
    v_cvt_pk_bf16_f32 v213, |v186|, |v187|
    v_mfma_f32_16x16x32_bf16 v[192:195], a[76:79], v[172:175], v[192:195]
    v_mul_f32_dpp v224, v24, v24 row_ror:5 row_mask:0xf bank_mask:0xf
    v_mul_f32_dpp v225, v25, v25 row_ror:5 row_mask:0xf bank_mask:0xf
    v_smfmac_f32_16x16x64_bf16 v[232:235], a[176:179], v[208:215], v1
    v_cvt_pk_bf16_f32 v148, v224, v225
    v_mul_f32_dpp v226, v26, v26 row_ror:5 row_mask:0xf bank_mask:0xf
    v_mfma_f32_16x16x32_bf16 v[196:199], a[80:83], v[160:163], v[132:135]
    v_mul_f32_dpp v227, v27, v27 row_ror:5 row_mask:0xf bank_mask:0xf
    v_cvt_pk_bf16_f32 v149, v226, v227
    v_mfma_f32_16x16x32_bf16 v[196:199], a[84:87], v[164:167], v[196:199]
    v_cvt_pk_bf16_f32 v216, |v192|, |v193|
    v_cvt_pk_bf16_f32 v217, |v194|, |v195|
    v_mfma_f32_16x16x32_bf16 v[196:199], a[88:91], v[168:171], v[196:199]
    v_mul_f32_dpp v228, v28, v28 row_ror:5 row_mask:0xf bank_mask:0xf
    v_mul_f32_dpp v229, v29, v29 row_ror:5 row_mask:0xf bank_mask:0xf
    v_mfma_f32_16x16x32_bf16 v[196:199], a[92:95], v[172:175], v[196:199]
    v_cvt_pk_bf16_f32 v150, v228, v229
    v_mul_f32_dpp v230, v30, v30 row_ror:5 row_mask:0xf bank_mask:0xf
    v_mfma_f32_16x16x32_bf16 v[200:203], a[96:99], v[160:163], v[136:139]
    v_mul_f32_dpp v231, v31, v31 row_ror:5 row_mask:0xf bank_mask:0xf
    v_cvt_pk_bf16_f32 v151, v230, v231
    v_mfma_f32_16x16x32_bf16 v[200:203], a[100:103], v[164:167], v[200:203]
    v_mul_f32_dpp v224, v32, v32 row_ror:5 row_mask:0xf bank_mask:0xf
    v_mul_f32_dpp v225, v33, v33 row_ror:5 row_mask:0xf bank_mask:0xf
    v_mfma_f32_16x16x32_bf16 v[200:203], a[104:107], v[168:171], v[200:203]
    v_cvt_pk_bf16_f32 v218, |v196|, |v197|
    v_cvt_pk_bf16_f32 v219, |v198|, |v199|
    v_mfma_f32_16x16x32_bf16 v[200:203], a[108:111], v[172:175], v[200:203]
    v_cvt_pk_bf16_f32 v152, v224, v225
    v_mul_f32_dpp v226, v34, v34 row_ror:5 row_mask:0xf bank_mask:0xf
    v_smfmac_f32_16x16x64_bf16 v[236:239], a[136:139], v[144:151], v1
    v_mul_f32_dpp v227, v35, v35 row_ror:5 row_mask:0xf bank_mask:0xf
    v_cvt_pk_bf16_f32 v153, v226, v227
    v_mfma_f32_16x16x32_bf16 v[204:207], a[112:115], v[160:163], v[140:143]
    v_mul_f32_dpp v228, v36, v36 row_ror:5 row_mask:0xf bank_mask:0xf
    v_mul_f32_dpp v229, v37, v37 row_ror:5 row_mask:0xf bank_mask:0xf
    v_mfma_f32_16x16x32_bf16 v[204:207], a[116:119], v[164:167], v[204:207]
    v_cvt_pk_bf16_f32 v220, |v200|, |v201|
    v_cvt_pk_bf16_f32 v221, |v202|, |v203|
    v_mfma_f32_16x16x32_bf16 v[204:207], a[120:123], v[168:171], v[204:207]
    v_cvt_pk_bf16_f32 v154, v228, v229
    v_mul_f32_dpp v230, v38, v38 row_ror:5 row_mask:0xf bank_mask:0xf
    v_mfma_f32_16x16x32_bf16 v[204:207], a[124:127], v[172:175], v[204:207]
    v_mul_f32_dpp v231, v39, v39 row_ror:5 row_mask:0xf bank_mask:0xf
    v_cvt_pk_bf16_f32 v155, v230, v231
    v_mfma_f32_16x16x32_bf16 v[176:179], a[0:3], v[144:147], v[112:115]
    v_mul_f32_dpp v224, v40, v40 row_ror:5 row_mask:0xf bank_mask:0xf
    v_mul_f32_dpp v225, v41, v41 row_ror:5 row_mask:0xf bank_mask:0xf
    v_mfma_f32_16x16x32_bf16 v[176:179], a[4:7], v[148:151], v[176:179]
    v_cvt_pk_bf16_f32 v156, v224, v225
    v_mul_f32_dpp v226, v42, v42 row_ror:5 row_mask:0xf bank_mask:0xf
    v_mfma_f32_16x16x32_bf16 v[176:179], a[8:11], v[152:155], v[176:179]
    v_cvt_pk_bf16_f32 v222, |v204|, |v205|
    v_cvt_pk_bf16_f32 v223, |v206|, |v207|
    v_mfma_f32_16x16x32_bf16 v[180:183], a[16:19], v[144:147], v[116:119]
    v_mul_f32_dpp v227, v43, v43 row_ror:5 row_mask:0xf bank_mask:0xf
    v_cvt_pk_bf16_f32 v157, v226, v227
    v_mfma_f32_16x16x32_bf16 v[180:183], a[20:23], v[148:151], v[180:183]
    v_mul_f32_dpp v228, v44, v44 row_ror:5 row_mask:0xf bank_mask:0xf
    v_mul_f32_dpp v229, v45, v45 row_ror:5 row_mask:0xf bank_mask:0xf
    v_mfma_f32_16x16x32_bf16 v[180:183], a[24:27], v[152:155], v[180:183]
    v_cvt_pk_bf16_f32 v158, v228, v229
    v_mul_f32_dpp v230, v46, v46 row_ror:5 row_mask:0xf bank_mask:0xf
    v_smfmac_f32_16x16x64_bf16 v[232:235], a[180:183], v[216:223], v1
    v_mul_f32_dpp v231, v47, v47 row_ror:5 row_mask:0xf bank_mask:0xf
    v_cvt_pk_bf16_f32 v159, v230, v231
    v_mfma_f32_16x16x32_bf16 v[184:187], a[32:35], v[144:147], v[120:123]
    v_mul_f32_dpp v224, v16, v16 row_ror:6 row_mask:0xf bank_mask:0xf
    v_mul_f32_dpp v225, v17, v17 row_ror:6 row_mask:0xf bank_mask:0xf
    v_mfma_f32_16x16x32_bf16 v[184:187], a[36:39], v[148:151], v[184:187]
    v_cvt_pk_bf16_f32 v160, v224, v225
    v_mul_f32_dpp v226, v18, v18 row_ror:6 row_mask:0xf bank_mask:0xf
    v_mfma_f32_16x16x32_bf16 v[184:187], a[40:43], v[152:155], v[184:187]
    v_mul_f32_dpp v227, v19, v19 row_ror:6 row_mask:0xf bank_mask:0xf
    v_cvt_pk_bf16_f32 v161, v226, v227
    v_mfma_f32_16x16x32_bf16 v[184:187], a[44:47], v[156:159], v[184:187]
    v_mul_f32_dpp v228, v20, v20 row_ror:6 row_mask:0xf bank_mask:0xf
    v_mul_f32_dpp v229, v21, v21 row_ror:6 row_mask:0xf bank_mask:0xf
    v_smfmac_f32_16x16x64_bf16 v[236:239], a[140:143], v[152:159], v1
    v_cvt_pk_bf16_f32 v162, v228, v229
    v_mul_f32_dpp v230, v22, v22 row_ror:6 row_mask:0xf bank_mask:0xf
    v_mfma_f32_16x16x32_bf16 v[176:179], a[12:15], v[156:159], v[176:179]
    v_mul_f32_dpp v231, v23, v23 row_ror:6 row_mask:0xf bank_mask:0xf
    v_cvt_pk_bf16_f32 v163, v230, v231
    v_mfma_f32_16x16x32_bf16 v[180:183], a[28:31], v[156:159], v[180:183]
    v_cvt_pk_bf16_f32 v212, |v184|, |v185|
    v_cvt_pk_bf16_f32 v213, |v186|, |v187|
    v_mfma_f32_16x16x32_bf16 v[188:191], a[48:51], v[144:147], v[124:127]
    v_mul_f32_dpp v224, v24, v24 row_ror:6 row_mask:0xf bank_mask:0xf
    v_mul_f32_dpp v225, v25, v25 row_ror:6 row_mask:0xf bank_mask:0xf
    v_mfma_f32_16x16x32_bf16 v[188:191], a[52:55], v[148:151], v[188:191]
    v_cvt_pk_bf16_f32 v208, |v176|, |v177|
    v_cvt_pk_bf16_f32 v209, |v178|, |v179|
    v_mfma_f32_16x16x32_bf16 v[188:191], a[56:59], v[152:155], v[188:191]
    v_cvt_pk_bf16_f32 v210, |v180|, |v181|
    v_cvt_pk_bf16_f32 v211, |v182|, |v183|
    v_mfma_f32_16x16x32_bf16 v[188:191], a[60:63], v[156:159], v[188:191]
    v_cvt_pk_bf16_f32 v164, v224, v225
    v_mul_f32_dpp v226, v26, v26 row_ror:6 row_mask:0xf bank_mask:0xf
    v_mfma_f32_16x16x32_bf16 v[192:195], a[64:67], v[144:147], v[128:131]
    v_mul_f32_dpp v227, v27, v27 row_ror:6 row_mask:0xf bank_mask:0xf
    v_cvt_pk_bf16_f32 v165, v226, v227
    v_mfma_f32_16x16x32_bf16 v[192:195], a[68:71], v[148:151], v[192:195]
    v_mul_f32_dpp v228, v28, v28 row_ror:6 row_mask:0xf bank_mask:0xf
    v_mul_f32_dpp v229, v29, v29 row_ror:6 row_mask:0xf bank_mask:0xf
    v_mfma_f32_16x16x32_bf16 v[192:195], a[72:75], v[152:155], v[192:195]
    v_cvt_pk_bf16_f32 v214, |v188|, |v189|
    v_cvt_pk_bf16_f32 v215, |v190|, |v191|
    v_mfma_f32_16x16x32_bf16 v[192:195], a[76:79], v[156:159], v[192:195]
    v_cvt_pk_bf16_f32 v166, v228, v229
    v_mul_f32_dpp v230, v30, v30 row_ror:6 row_mask:0xf bank_mask:0xf
    v_smfmac_f32_16x16x64_bf16 v[236:239], a[128:131], v[208:215], v1
    v_mul_f32_dpp v231, v31, v31 row_ror:6 row_mask:0xf bank_mask:0xf
    v_cvt_pk_bf16_f32 v167, v230, v231
    v_mfma_f32_16x16x32_bf16 v[196:199], a[80:83], v[144:147], v[132:135]
    v_mul_f32_dpp v224, v32, v32 row_ror:6 row_mask:0xf bank_mask:0xf
    v_mul_f32_dpp v225, v33, v33 row_ror:6 row_mask:0xf bank_mask:0xf
    v_mfma_f32_16x16x32_bf16 v[196:199], a[84:87], v[148:151], v[196:199]
    v_cvt_pk_bf16_f32 v216, |v192|, |v193|
    v_cvt_pk_bf16_f32 v217, |v194|, |v195|
    v_mfma_f32_16x16x32_bf16 v[196:199], a[88:91], v[152:155], v[196:199]
    v_cvt_pk_bf16_f32 v168, v224, v225
    v_mul_f32_dpp v226, v34, v34 row_ror:6 row_mask:0xf bank_mask:0xf
    v_mfma_f32_16x16x32_bf16 v[196:199], a[92:95], v[156:159], v[196:199]
    v_mul_f32_dpp v227, v35, v35 row_ror:6 row_mask:0xf bank_mask:0xf
    v_cvt_pk_bf16_f32 v169, v226, v227
    v_mfma_f32_16x16x32_bf16 v[200:203], a[96:99], v[144:147], v[136:139]
    v_mul_f32_dpp v228, v36, v36 row_ror:6 row_mask:0xf bank_mask:0xf
    v_mul_f32_dpp v229, v37, v37 row_ror:6 row_mask:0xf bank_mask:0xf
    v_mfma_f32_16x16x32_bf16 v[200:203], a[100:103], v[148:151], v[200:203]
    v_cvt_pk_bf16_f32 v170, v228, v229
    v_mul_f32_dpp v230, v38, v38 row_ror:6 row_mask:0xf bank_mask:0xf
    v_mfma_f32_16x16x32_bf16 v[200:203], a[104:107], v[152:155], v[200:203]
    v_cvt_pk_bf16_f32 v218, |v196|, |v197|
    v_cvt_pk_bf16_f32 v219, |v198|, |v199|
    v_mfma_f32_16x16x32_bf16 v[200:203], a[108:111], v[156:159], v[200:203]
    v_mul_f32_dpp v231, v39, v39 row_ror:6 row_mask:0xf bank_mask:0xf
    v_cvt_pk_bf16_f32 v171, v230, v231
    v_mfma_f32_16x16x32_bf16 v[204:207], a[112:115], v[144:147], v[140:143]
    v_mul_f32_dpp v224, v40, v40 row_ror:6 row_mask:0xf bank_mask:0xf
    v_mul_f32_dpp v225, v41, v41 row_ror:6 row_mask:0xf bank_mask:0xf
    v_mfma_f32_16x16x32_bf16 v[204:207], a[116:119], v[148:151], v[204:207]
    v_cvt_pk_bf16_f32 v172, v224, v225
    v_mul_f32_dpp v226, v42, v42 row_ror:6 row_mask:0xf bank_mask:0xf
    v_mfma_f32_16x16x32_bf16 v[204:207], a[120:123], v[152:155], v[204:207]
    v_cvt_pk_bf16_f32 v220, |v200|, |v201|
    v_cvt_pk_bf16_f32 v221, |v202|, |v203|
    v_mfma_f32_16x16x32_bf16 v[204:207], a[124:127], v[156:159], v[204:207]
    v_mul_f32_dpp v227, v43, v43 row_ror:6 row_mask:0xf bank_mask:0xf
    v_cvt_pk_bf16_f32 v173, v226, v227
    v_mfma_f32_16x16x32_bf16 v[176:179], a[0:3], v[160:163], v[112:115]
    v_mul_f32_dpp v228, v44, v44 row_ror:6 row_mask:0xf bank_mask:0xf
    v_mul_f32_dpp v229, v45, v45 row_ror:6 row_mask:0xf bank_mask:0xf
    v_mfma_f32_16x16x32_bf16 v[176:179], a[4:7], v[164:167], v[176:179]
    v_cvt_pk_bf16_f32 v174, v228, v229
    v_mul_f32_dpp v230, v46, v46 row_ror:6 row_mask:0xf bank_mask:0xf
    v_mfma_f32_16x16x32_bf16 v[176:179], a[8:11], v[168:171], v[176:179]
    v_cvt_pk_bf16_f32 v222, |v204|, |v205|
    v_cvt_pk_bf16_f32 v223, |v206|, |v207|
    v_mfma_f32_16x16x32_bf16 v[180:183], a[16:19], v[160:163], v[116:119]
    v_mul_f32_dpp v231, v47, v47 row_ror:6 row_mask:0xf bank_mask:0xf
    v_cvt_pk_bf16_f32 v175, v230, v231
    v_mfma_f32_16x16x32_bf16 v[180:183], a[20:23], v[164:167], v[180:183]
    v_mul_f32_dpp v224, v16, v16 row_ror:7 row_mask:0xf bank_mask:0xf
    v_mul_f32_dpp v225, v17, v17 row_ror:7 row_mask:0xf bank_mask:0xf
    v_mfma_f32_16x16x32_bf16 v[180:183], a[24:27], v[168:171], v[180:183]
    v_cvt_pk_bf16_f32 v144, v224, v225
    v_mul_f32_dpp v226, v18, v18 row_ror:7 row_mask:0xf bank_mask:0xf
    v_mfma_f32_16x16x32_bf16 v[180:183], a[28:31], v[172:175], v[180:183]
    v_mul_f32_dpp v227, v19, v19 row_ror:7 row_mask:0xf bank_mask:0xf
    v_cvt_pk_bf16_f32 v145, v226, v227
    v_smfmac_f32_16x16x64_bf16 v[236:239], a[132:135], v[216:223], v1
    v_mul_f32_dpp v228, v20, v20 row_ror:7 row_mask:0xf bank_mask:0xf
    v_mul_f32_dpp v229, v21, v21 row_ror:7 row_mask:0xf bank_mask:0xf
    v_mfma_f32_16x16x32_bf16 v[176:179], a[12:15], v[172:175], v[176:179]
    v_cvt_pk_bf16_f32 v146, v228, v229
    v_mul_f32_dpp v230, v22, v22 row_ror:7 row_mask:0xf bank_mask:0xf
    v_smfmac_f32_16x16x64_bf16 v[236:239], a[152:155], v[160:167], v1
    v_mul_f32_dpp v231, v23, v23 row_ror:7 row_mask:0xf bank_mask:0xf
    v_cvt_pk_bf16_f32 v147, v230, v231
    v_mfma_f32_16x16x32_bf16 v[184:187], a[32:35], v[160:163], v[120:123]
    v_cvt_pk_bf16_f32 v210, |v180|, |v181|
    v_cvt_pk_bf16_f32 v211, |v182|, |v183|
    v_mfma_f32_16x16x32_bf16 v[184:187], a[36:39], v[164:167], v[184:187]
    v_cvt_pk_bf16_f32 v208, |v176|, |v177|
    v_cvt_pk_bf16_f32 v209, |v178|, |v179|
    v_mfma_f32_16x16x32_bf16 v[184:187], a[40:43], v[168:171], v[184:187]
    v_mul_f32_dpp v224, v24, v24 row_ror:7 row_mask:0xf bank_mask:0xf
    v_mul_f32_dpp v225, v25, v25 row_ror:7 row_mask:0xf bank_mask:0xf
    v_mfma_f32_16x16x32_bf16 v[184:187], a[44:47], v[172:175], v[184:187]
    v_cvt_pk_bf16_f32 v148, v224, v225
    v_mul_f32_dpp v226, v26, v26 row_ror:7 row_mask:0xf bank_mask:0xf
    v_smfmac_f32_16x16x64_bf16 v[236:239], a[156:159], v[168:175], v1
    v_mul_f32_dpp v227, v27, v27 row_ror:7 row_mask:0xf bank_mask:0xf
    v_cvt_pk_bf16_f32 v149, v226, v227
    v_mfma_f32_16x16x32_bf16 v[188:191], a[48:51], v[160:163], v[124:127]
    v_mul_f32_dpp v228, v28, v28 row_ror:7 row_mask:0xf bank_mask:0xf
    v_mul_f32_dpp v229, v29, v29 row_ror:7 row_mask:0xf bank_mask:0xf
    v_mfma_f32_16x16x32_bf16 v[188:191], a[52:55], v[164:167], v[188:191]
    v_cvt_pk_bf16_f32 v212, |v184|, |v185|
    v_cvt_pk_bf16_f32 v213, |v186|, |v187|
    v_mfma_f32_16x16x32_bf16 v[188:191], a[56:59], v[168:171], v[188:191]
    v_cvt_pk_bf16_f32 v150, v228, v229
    v_mul_f32_dpp v230, v30, v30 row_ror:7 row_mask:0xf bank_mask:0xf
    v_mfma_f32_16x16x32_bf16 v[188:191], a[60:63], v[172:175], v[188:191]
    v_mul_f32_dpp v231, v31, v31 row_ror:7 row_mask:0xf bank_mask:0xf
    v_cvt_pk_bf16_f32 v151, v230, v231
    v_mfma_f32_16x16x32_bf16 v[192:195], a[64:67], v[160:163], v[128:131]
    v_mul_f32_dpp v224, v32, v32 row_ror:7 row_mask:0xf bank_mask:0xf
    v_mul_f32_dpp v225, v33, v33 row_ror:7 row_mask:0xf bank_mask:0xf
    v_mfma_f32_16x16x32_bf16 v[192:195], a[68:71], v[164:167], v[192:195]
    v_cvt_pk_bf16_f32 v152, v224, v225
    v_mul_f32_dpp v226, v34, v34 row_ror:7 row_mask:0xf bank_mask:0xf
    v_mfma_f32_16x16x32_bf16 v[192:195], a[72:75], v[168:171], v[192:195]
    v_cvt_pk_bf16_f32 v214, |v188|, |v189|
    v_cvt_pk_bf16_f32 v215, |v190|, |v191|
    v_mfma_f32_16x16x32_bf16 v[192:195], a[76:79], v[172:175], v[192:195]
    v_mul_f32_dpp v227, v35, v35 row_ror:7 row_mask:0xf bank_mask:0xf
    v_cvt_pk_bf16_f32 v153, v226, v227
    v_smfmac_f32_16x16x64_bf16 v[236:239], a[144:147], v[208:215], v1
    v_mul_f32_dpp v228, v36, v36 row_ror:7 row_mask:0xf bank_mask:0xf
    v_mul_f32_dpp v229, v37, v37 row_ror:7 row_mask:0xf bank_mask:0xf
    v_mfma_f32_16x16x32_bf16 v[196:199], a[80:83], v[160:163], v[132:135]
    v_cvt_pk_bf16_f32 v154, v228, v229
    v_mul_f32_dpp v230, v38, v38 row_ror:7 row_mask:0xf bank_mask:0xf
    v_mfma_f32_16x16x32_bf16 v[196:199], a[84:87], v[164:167], v[196:199]
    v_cvt_pk_bf16_f32 v216, |v192|, |v193|
    v_cvt_pk_bf16_f32 v217, |v194|, |v195|
    v_mfma_f32_16x16x32_bf16 v[196:199], a[88:91], v[168:171], v[196:199]
    v_mul_f32_dpp v231, v39, v39 row_ror:7 row_mask:0xf bank_mask:0xf
    v_cvt_pk_bf16_f32 v155, v230, v231
    v_mfma_f32_16x16x32_bf16 v[196:199], a[92:95], v[172:175], v[196:199]
    v_mul_f32_dpp v224, v40, v40 row_ror:7 row_mask:0xf bank_mask:0xf
    v_mul_f32_dpp v225, v41, v41 row_ror:7 row_mask:0xf bank_mask:0xf
    v_mfma_f32_16x16x32_bf16 v[200:203], a[96:99], v[160:163], v[136:139]
    v_cvt_pk_bf16_f32 v156, v224, v225
    v_mul_f32_dpp v226, v42, v42 row_ror:7 row_mask:0xf bank_mask:0xf
    v_mfma_f32_16x16x32_bf16 v[200:203], a[100:103], v[164:167], v[200:203]
    v_mul_f32_dpp v227, v43, v43 row_ror:7 row_mask:0xf bank_mask:0xf
    v_cvt_pk_bf16_f32 v157, v226, v227
    v_mfma_f32_16x16x32_bf16 v[200:203], a[104:107], v[168:171], v[200:203]
    v_cvt_pk_bf16_f32 v218, |v196|, |v197|
    v_cvt_pk_bf16_f32 v219, |v198|, |v199|
    v_mfma_f32_16x16x32_bf16 v[200:203], a[108:111], v[172:175], v[200:203]
    v_mul_f32_dpp v228, v44, v44 row_ror:7 row_mask:0xf bank_mask:0xf
    v_mul_f32_dpp v229, v45, v45 row_ror:7 row_mask:0xf bank_mask:0xf
    v_mfma_f32_16x16x32_bf16 v[204:207], a[112:115], v[160:163], v[140:143]
    v_cvt_pk_bf16_f32 v158, v228, v229
    v_mul_f32_dpp v230, v46, v46 row_ror:7 row_mask:0xf bank_mask:0xf
    v_mfma_f32_16x16x32_bf16 v[204:207], a[116:119], v[164:167], v[204:207]
    v_mul_f32_dpp v231, v47, v47 row_ror:7 row_mask:0xf bank_mask:0xf
    v_cvt_pk_bf16_f32 v159, v230, v231
    v_mfma_f32_16x16x32_bf16 v[204:207], a[120:123], v[168:171], v[204:207]
    v_cvt_pk_bf16_f32 v220, |v200|, |v201|
    v_cvt_pk_bf16_f32 v221, |v202|, |v203|
    v_mfma_f32_16x16x32_bf16 v[204:207], a[124:127], v[172:175], v[204:207]
    v_mul_f32_dpp v224, v16, v16 row_ror:8 row_mask:0xf bank_mask:0xf
    v_mul_f32_dpp v225, v17, v17 row_ror:8 row_mask:0xf bank_mask:0xf
    v_mfma_f32_16x16x32_bf16 v[176:179], a[0:3], v[144:147], v[112:115]
    v_cvt_pk_bf16_f32 v160, v224, v225
    v_mul_f32_dpp v226, v18, v18 row_ror:8 row_mask:0xf bank_mask:0xf
    v_mfma_f32_16x16x32_bf16 v[176:179], a[4:7], v[148:151], v[176:179]
    v_mul_f32_dpp v227, v19, v19 row_ror:8 row_mask:0xf bank_mask:0xf
    v_cvt_pk_bf16_f32 v161, v226, v227
    v_mfma_f32_16x16x32_bf16 v[176:179], a[8:11], v[152:155], v[176:179]
    v_cvt_pk_bf16_f32 v222, |v204|, |v205|
    v_cvt_pk_bf16_f32 v223, |v206|, |v207|
    v_mfma_f32_16x16x32_bf16 v[176:179], a[12:15], v[156:159], v[176:179]
    v_mul_f32_dpp v228, v20, v20 row_ror:8 row_mask:0xf bank_mask:0xf
    v_mul_f32_dpp v229, v21, v21 row_ror:8 row_mask:0xf bank_mask:0xf
    v_smfmac_f32_16x16x64_bf16 v[236:239], a[148:151], v[216:223], v1
    v_cvt_pk_bf16_f32 v162, v228, v229
    v_mul_f32_dpp v230, v22, v22 row_ror:8 row_mask:0xf bank_mask:0xf
    v_mfma_f32_16x16x32_bf16 v[180:183], a[16:19], v[144:147], v[116:119]
    v_mul_f32_dpp v231, v23, v23 row_ror:8 row_mask:0xf bank_mask:0xf
    v_cvt_pk_bf16_f32 v163, v230, v231
    v_mfma_f32_16x16x32_bf16 v[180:183], a[20:23], v[148:151], v[180:183]
    v_cvt_pk_bf16_f32 v208, |v176|, |v177|
    v_cvt_pk_bf16_f32 v209, |v178|, |v179|
    v_mfma_f32_16x16x32_bf16 v[180:183], a[24:27], v[152:155], v[180:183]
    v_mul_f32_dpp v224, v24, v24 row_ror:8 row_mask:0xf bank_mask:0xf
    v_mul_f32_dpp v225, v25, v25 row_ror:8 row_mask:0xf bank_mask:0xf
    v_mfma_f32_16x16x32_bf16 v[180:183], a[28:31], v[156:159], v[180:183]
    v_cvt_pk_bf16_f32 v164, v224, v225
    v_mul_f32_dpp v226, v26, v26 row_ror:8 row_mask:0xf bank_mask:0xf
    v_smfmac_f32_16x16x64_bf16 v[236:239], a[168:171], v[144:151], v1
    v_mul_f32_dpp v227, v27, v27 row_ror:8 row_mask:0xf bank_mask:0xf
    v_cvt_pk_bf16_f32 v165, v226, v227
    v_mfma_f32_16x16x32_bf16 v[184:187], a[32:35], v[144:147], v[120:123]
    v_mul_f32_dpp v228, v28, v28 row_ror:8 row_mask:0xf bank_mask:0xf
    v_mul_f32_dpp v229, v29, v29 row_ror:8 row_mask:0xf bank_mask:0xf
    v_mfma_f32_16x16x32_bf16 v[184:187], a[36:39], v[148:151], v[184:187]
    v_cvt_pk_bf16_f32 v210, |v180|, |v181|
    v_cvt_pk_bf16_f32 v211, |v182|, |v183|
    v_mfma_f32_16x16x32_bf16 v[184:187], a[40:43], v[152:155], v[184:187]
    v_cvt_pk_bf16_f32 v166, v228, v229
    v_mul_f32_dpp v230, v30, v30 row_ror:8 row_mask:0xf bank_mask:0xf
    v_mfma_f32_16x16x32_bf16 v[184:187], a[44:47], v[156:159], v[184:187]
    v_mul_f32_dpp v231, v31, v31 row_ror:8 row_mask:0xf bank_mask:0xf
    v_cvt_pk_bf16_f32 v167, v230, v231
    v_smfmac_f32_16x16x64_bf16 v[236:239], a[172:175], v[152:159], v1
    v_mul_f32_dpp v224, v32, v32 row_ror:8 row_mask:0xf bank_mask:0xf
    v_mul_f32_dpp v225, v33, v33 row_ror:8 row_mask:0xf bank_mask:0xf
    v_mfma_f32_16x16x32_bf16 v[188:191], a[48:51], v[144:147], v[124:127]
    v_cvt_pk_bf16_f32 v168, v224, v225
    v_mul_f32_dpp v226, v34, v34 row_ror:8 row_mask:0xf bank_mask:0xf
    v_mfma_f32_16x16x32_bf16 v[188:191], a[52:55], v[148:151], v[188:191]
    v_cvt_pk_bf16_f32 v212, |v184|, |v185|
    v_cvt_pk_bf16_f32 v213, |v186|, |v187|
    v_mfma_f32_16x16x32_bf16 v[188:191], a[56:59], v[152:155], v[188:191]
    v_mul_f32_dpp v227, v35, v35 row_ror:8 row_mask:0xf bank_mask:0xf
    v_cvt_pk_bf16_f32 v169, v226, v227
    v_mfma_f32_16x16x32_bf16 v[188:191], a[60:63], v[156:159], v[188:191]
    v_mul_f32_dpp v228, v36, v36 row_ror:8 row_mask:0xf bank_mask:0xf
    v_mul_f32_dpp v229, v37, v37 row_ror:8 row_mask:0xf bank_mask:0xf
    v_mfma_f32_16x16x32_bf16 v[192:195], a[64:67], v[144:147], v[128:131]
    v_cvt_pk_bf16_f32 v170, v228, v229
    v_mul_f32_dpp v230, v38, v38 row_ror:8 row_mask:0xf bank_mask:0xf
    v_mfma_f32_16x16x32_bf16 v[192:195], a[68:71], v[148:151], v[192:195]
    v_mul_f32_dpp v231, v39, v39 row_ror:8 row_mask:0xf bank_mask:0xf
    v_cvt_pk_bf16_f32 v171, v230, v231
    v_mfma_f32_16x16x32_bf16 v[192:195], a[72:75], v[152:155], v[192:195]
    v_cvt_pk_bf16_f32 v214, |v188|, |v189|
    v_cvt_pk_bf16_f32 v215, |v190|, |v191|
    v_mfma_f32_16x16x32_bf16 v[192:195], a[76:79], v[156:159], v[192:195]
    v_mul_f32_dpp v224, v40, v40 row_ror:8 row_mask:0xf bank_mask:0xf
    v_mul_f32_dpp v225, v41, v41 row_ror:8 row_mask:0xf bank_mask:0xf
    v_smfmac_f32_16x16x64_bf16 v[236:239], a[160:163], v[208:215], v1
    v_cvt_pk_bf16_f32 v172, v224, v225
    v_mul_f32_dpp v226, v42, v42 row_ror:8 row_mask:0xf bank_mask:0xf
    v_mfma_f32_16x16x32_bf16 v[196:199], a[80:83], v[144:147], v[132:135]
    v_mul_f32_dpp v227, v43, v43 row_ror:8 row_mask:0xf bank_mask:0xf
    v_cvt_pk_bf16_f32 v173, v226, v227
    v_mfma_f32_16x16x32_bf16 v[196:199], a[84:87], v[148:151], v[196:199]
    v_cvt_pk_bf16_f32 v216, |v192|, |v193|
    v_cvt_pk_bf16_f32 v217, |v194|, |v195|
    v_mfma_f32_16x16x32_bf16 v[196:199], a[88:91], v[152:155], v[196:199]
    v_mul_f32_dpp v228, v44, v44 row_ror:8 row_mask:0xf bank_mask:0xf
    v_mul_f32_dpp v229, v45, v45 row_ror:8 row_mask:0xf bank_mask:0xf
    v_mfma_f32_16x16x32_bf16 v[196:199], a[92:95], v[156:159], v[196:199]
    v_cvt_pk_bf16_f32 v174, v228, v229
    v_mul_f32_dpp v230, v46, v46 row_ror:8 row_mask:0xf bank_mask:0xf
    v_mfma_f32_16x16x32_bf16 v[200:203], a[96:99], v[144:147], v[136:139]
    v_mul_f32_dpp v231, v47, v47 row_ror:8 row_mask:0xf bank_mask:0xf
    v_cvt_pk_bf16_f32 v175, v230, v231
    v_mfma_f32_16x16x32_bf16 v[200:203], a[100:103], v[148:151], v[200:203]
    s_waitcnt vmcnt(0)
    ds_read_b128 v[64:67], v2
    v_mfma_f32_16x16x32_bf16 v[200:203], a[104:107], v[152:155], v[200:203]
    v_cvt_pk_bf16_f32 v218, |v196|, |v197|
    v_cvt_pk_bf16_f32 v219, |v198|, |v199|
    v_mfma_f32_16x16x32_bf16 v[200:203], a[108:111], v[156:159], v[200:203]
    ds_read_b128 v[68:71], v3
    ds_read_b128 v[72:75], v4
    v_mfma_f32_16x16x32_bf16 v[204:207], a[112:115], v[144:147], v[140:143]
    ds_read_b128 v[76:79], v5
    v_mfma_f32_16x16x32_bf16 v[204:207], a[116:119], v[148:151], v[204:207]
    v_mfma_f32_16x16x32_bf16 v[204:207], a[120:123], v[152:155], v[204:207]
    v_mfma_f32_16x16x32_bf16 v[204:207], a[124:127], v[156:159], v[204:207]
    v_mfma_f32_16x16x32_bf16 v[176:179], a[0:3], v[160:163], v[112:115]
    v_cvt_pk_bf16_f32 v220, |v200|, |v201|
    v_cvt_pk_bf16_f32 v221, |v202|, |v203|
    v_mfma_f32_16x16x32_bf16 v[176:179], a[4:7], v[164:167], v[176:179]
    v_mfma_f32_16x16x32_bf16 v[176:179], a[8:11], v[168:171], v[176:179]
    v_mfma_f32_16x16x32_bf16 v[176:179], a[12:15], v[172:175], v[176:179]
    v_mfma_f32_16x16x32_bf16 v[180:183], a[16:19], v[160:163], v[116:119]
    v_mfma_f32_16x16x32_bf16 v[180:183], a[20:23], v[164:167], v[180:183]
    v_cvt_pk_bf16_f32 v222, |v204|, |v205|
    v_cvt_pk_bf16_f32 v223, |v206|, |v207|
    v_mfma_f32_16x16x32_bf16 v[180:183], a[24:27], v[168:171], v[180:183]
    v_mfma_f32_16x16x32_bf16 v[180:183], a[28:31], v[172:175], v[180:183]
    v_smfmac_f32_16x16x64_bf16 v[236:239], a[164:167], v[216:223], v1
    v_mfma_f32_16x16x32_bf16 v[184:187], a[32:35], v[160:163], v[120:123]
    v_cvt_pk_bf16_f32 v208, |v176|, |v177|
    v_cvt_pk_bf16_f32 v209, |v178|, |v179|
    v_mfma_f32_16x16x32_bf16 v[184:187], a[36:39], v[164:167], v[184:187]
    v_mfma_f32_16x16x32_bf16 v[184:187], a[40:43], v[168:171], v[184:187]
    v_mfma_f32_16x16x32_bf16 v[184:187], a[44:47], v[172:175], v[184:187]
    v_smfmac_f32_16x16x64_bf16 v[236:239], a[184:187], v[160:167], v1
    v_cvt_pk_bf16_f32 v210, |v180|, |v181|
    s_waitcnt lgkmcnt(0)
    v_mfma_f32_16x16x32_bf16 v[188:191], a[48:51], v[160:163], v[124:127]
    v_lshlrev_b32 v48, 16, v64
    v_and_b32 v49, 0xffff0000, v64
    v_mfma_f32_16x16x32_bf16 v[188:191], a[52:55], v[164:167], v[188:191]
    v_lshlrev_b32 v50, 16, v65
    v_and_b32 v51, 0xffff0000, v65
    v_mfma_f32_16x16x32_bf16 v[188:191], a[56:59], v[168:171], v[188:191]
    v_lshlrev_b32 v52, 16, v66
    v_and_b32 v53, 0xffff0000, v66
    v_mfma_f32_16x16x32_bf16 v[188:191], a[60:63], v[172:175], v[188:191]
    v_lshlrev_b32 v54, 16, v67
    v_and_b32 v55, 0xffff0000, v67
    v_smfmac_f32_16x16x64_bf16 v[236:239], a[188:191], v[168:175], v1
    v_mul_f32_dpp v224, v48, v16 row_newbcast:14 row_mask:0xf bank_mask:0xf
    v_mul_f32_dpp v225, v49, v17 row_newbcast:14 row_mask:0xf bank_mask:0xf
    v_mfma_f32_16x16x32_bf16 v[192:195], a[64:67], v[160:163], v[128:131]
    v_cvt_pk_bf16_f32 v144, v224, v225
    v_mul_f32_dpp v226, v50, v18 row_newbcast:14 row_mask:0xf bank_mask:0xf
    v_mfma_f32_16x16x32_bf16 v[192:195], a[68:71], v[164:167], v[192:195]
    v_mul_f32_dpp v227, v51, v19 row_newbcast:14 row_mask:0xf bank_mask:0xf
    v_cvt_pk_bf16_f32 v145, v226, v227
    v_mfma_f32_16x16x32_bf16 v[192:195], a[72:75], v[168:171], v[192:195]
    v_mul_f32_dpp v228, v52, v20 row_newbcast:14 row_mask:0xf bank_mask:0xf
    v_mul_f32_dpp v229, v53, v21 row_newbcast:14 row_mask:0xf bank_mask:0xf
    v_mfma_f32_16x16x32_bf16 v[192:195], a[76:79], v[172:175], v[192:195]
    v_cvt_pk_bf16_f32 v146, v228, v229
    v_mul_f32_dpp v230, v54, v22 row_newbcast:14 row_mask:0xf bank_mask:0xf
    v_mfma_f32_16x16x32_bf16 v[196:199], a[80:83], v[160:163], v[132:135]
    v_mul_f32_dpp v231, v55, v23 row_newbcast:14 row_mask:0xf bank_mask:0xf
    v_cvt_pk_bf16_f32 v147, v230, v231
    v_mfma_f32_16x16x32_bf16 v[196:199], a[84:87], v[164:167], v[196:199]
    v_cvt_pk_bf16_f32 v211, |v182|, |v183|
    v_cvt_pk_bf16_f32 v212, |v184|, |v185|
    v_mfma_f32_16x16x32_bf16 v[196:199], a[88:91], v[168:171], v[196:199]
    v_cvt_pk_bf16_f32 v213, |v186|, |v187|
    v_cvt_pk_bf16_f32 v214, |v188|, |v189|
    v_mfma_f32_16x16x32_bf16 v[196:199], a[92:95], v[172:175], v[196:199]
    v_cvt_pk_bf16_f32 v215, |v190|, |v191|
    v_cvt_pk_bf16_f32 v216, |v192|, |v193|
    v_mfma_f32_16x16x32_bf16 v[200:203], a[96:99], v[160:163], v[136:139]
    v_cvt_pk_bf16_f32 v217, |v194|, |v195|
    v_lshlrev_b32 v56, 16, v68
    v_mfma_f32_16x16x32_bf16 v[200:203], a[100:103], v[164:167], v[200:203]
    v_and_b32 v57, 0xffff0000, v68
    v_lshlrev_b32 v58, 16, v69
    v_mfma_f32_16x16x32_bf16 v[200:203], a[104:107], v[168:171], v[200:203]
    v_cvt_pk_bf16_f32 v218, |v196|, |v197|
    v_cvt_pk_bf16_f32 v219, |v198|, |v199|
    v_mfma_f32_16x16x32_bf16 v[200:203], a[108:111], v[172:175], v[200:203]
    v_and_b32 v59, 0xffff0000, v69
    v_lshlrev_b32 v60, 16, v70
    v_smfmac_f32_16x16x64_bf16 v[236:239], a[176:179], v[208:215], v1
    v_and_b32 v61, 0xffff0000, v70
    v_lshlrev_b32 v62, 16, v71
    v_mfma_f32_16x16x32_bf16 v[204:207], a[112:115], v[160:163], v[140:143]
    v_and_b32 v63, 0xffff0000, v71
    v_mul_f32_dpp v224, v56, v24 row_newbcast:14 row_mask:0xf bank_mask:0xf
    v_mfma_f32_16x16x32_bf16 v[204:207], a[116:119], v[164:167], v[204:207]
    v_cvt_pk_bf16_f32 v220, |v200|, |v201|
    v_cvt_pk_bf16_f32 v221, |v202|, |v203|
    v_mfma_f32_16x16x32_bf16 v[204:207], a[120:123], v[168:171], v[204:207]
    v_mul_f32_dpp v225, v57, v25 row_newbcast:14 row_mask:0xf bank_mask:0xf
    v_cvt_pk_bf16_f32 v148, v224, v225
    v_mfma_f32_16x16x32_bf16 v[204:207], a[124:127], v[172:175], v[204:207]
    v_mul_f32_dpp v226, v58, v26 row_newbcast:14 row_mask:0xf bank_mask:0xf
    v_mul_f32_dpp v227, v59, v27 row_newbcast:14 row_mask:0xf bank_mask:0xf
    v_mfma_f32_16x16x32_bf16 v[176:179], a[0:3], v[144:147], v[112:115]
    v_cvt_pk_bf16_f32 v149, v226, v227
    v_mul_f32_dpp v228, v60, v28 row_newbcast:14 row_mask:0xf bank_mask:0xf
    v_mfma_f32_16x16x32_bf16 v[180:183], a[16:19], v[144:147], v[116:119]
    v_mul_f32_dpp v229, v61, v29 row_newbcast:14 row_mask:0xf bank_mask:0xf
    v_cvt_pk_bf16_f32 v150, v228, v229
    v_mfma_f32_16x16x32_bf16 v[184:187], a[32:35], v[144:147], v[120:123]
    v_cvt_pk_bf16_f32 v222, |v204|, |v205|
    v_cvt_pk_bf16_f32 v223, |v206|, |v207|
    v_mfma_f32_16x16x32_bf16 v[188:191], a[48:51], v[144:147], v[124:127]
    v_mul_f32_dpp v230, v62, v30 row_newbcast:14 row_mask:0xf bank_mask:0xf
    v_mul_f32_dpp v231, v63, v31 row_newbcast:14 row_mask:0xf bank_mask:0xf
    v_smfmac_f32_16x16x64_bf16 v[236:239], a[180:183], v[216:223], v1
    v_cvt_pk_bf16_f32 v151, v230, v231
    v_lshlrev_b32 v64, 16, v72
    v_mfma_f32_16x16x32_bf16 v[192:195], a[64:67], v[144:147], v[128:131]
    v_and_b32 v65, 0xffff0000, v72
    v_lshlrev_b32 v66, 16, v73
    v_mfma_f32_16x16x32_bf16 v[192:195], a[68:71], v[148:151], v[192:195]
    v_and_b32 v67, 0xffff0000, v73
    v_lshlrev_b32 v68, 16, v74
    v_smfmac_f32_16x16x64_bf16 v[240:243], a[136:139], v[144:151], v1
    v_and_b32 v69, 0xffff0000, v74
    v_lshlrev_b32 v70, 16, v75
    v_mfma_f32_16x16x32_bf16 v[176:179], a[4:7], v[148:151], v[176:179]
    v_and_b32 v71, 0xffff0000, v75
    v_mul_f32_dpp v224, v64, v32 row_newbcast:14 row_mask:0xf bank_mask:0xf
    v_mfma_f32_16x16x32_bf16 v[180:183], a[20:23], v[148:151], v[180:183]
    v_mul_f32_dpp v225, v65, v33 row_newbcast:14 row_mask:0xf bank_mask:0xf
    v_cvt_pk_bf16_f32 v152, v224, v225
    v_mfma_f32_16x16x32_bf16 v[184:187], a[36:39], v[148:151], v[184:187]
    v_mul_f32_dpp v226, v66, v34 row_newbcast:14 row_mask:0xf bank_mask:0xf
    v_mul_f32_dpp v227, v67, v35 row_newbcast:14 row_mask:0xf bank_mask:0xf
    v_mfma_f32_16x16x32_bf16 v[188:191], a[52:55], v[148:151], v[188:191]
    v_cvt_pk_bf16_f32 v153, v226, v227
    v_mul_f32_dpp v228, v68, v36 row_newbcast:14 row_mask:0xf bank_mask:0xf
    v_mfma_f32_16x16x32_bf16 v[196:199], a[80:83], v[144:147], v[132:135]
    v_mul_f32_dpp v229, v69, v37 row_newbcast:14 row_mask:0xf bank_mask:0xf
    v_cvt_pk_bf16_f32 v154, v228, v229
    v_mfma_f32_16x16x32_bf16 v[196:199], a[84:87], v[148:151], v[196:199]
    v_mul_f32_dpp v230, v70, v38 row_newbcast:14 row_mask:0xf bank_mask:0xf
    v_mul_f32_dpp v231, v71, v39 row_newbcast:14 row_mask:0xf bank_mask:0xf
    v_mfma_f32_16x16x32_bf16 v[200:203], a[96:99], v[144:147], v[136:139]
    v_cvt_pk_bf16_f32 v155, v230, v231
    v_lshlrev_b32 v72, 16, v76
    v_mfma_f32_16x16x32_bf16 v[200:203], a[100:103], v[148:151], v[200:203]
    v_and_b32 v73, 0xffff0000, v76
    v_lshlrev_b32 v74, 16, v77
    v_mfma_f32_16x16x32_bf16 v[200:203], a[104:107], v[152:155], v[200:203]
    v_and_b32 v75, 0xffff0000, v77
    v_lshlrev_b32 v76, 16, v78
    v_mfma_f32_16x16x32_bf16 v[176:179], a[8:11], v[152:155], v[176:179]
    v_and_b32 v77, 0xffff0000, v78
    v_lshlrev_b32 v78, 16, v79
    v_mfma_f32_16x16x32_bf16 v[180:183], a[24:27], v[152:155], v[180:183]
    v_and_b32 v79, 0xffff0000, v79
    v_mul_f32_dpp v224, v72, v40 row_newbcast:14 row_mask:0xf bank_mask:0xf
    v_mfma_f32_16x16x32_bf16 v[184:187], a[40:43], v[152:155], v[184:187]
    v_mul_f32_dpp v225, v73, v41 row_newbcast:14 row_mask:0xf bank_mask:0xf
    v_cvt_pk_bf16_f32 v156, v224, v225
    v_mfma_f32_16x16x32_bf16 v[188:191], a[56:59], v[152:155], v[188:191]
    v_mul_f32_dpp v226, v74, v42 row_newbcast:14 row_mask:0xf bank_mask:0xf
    v_mul_f32_dpp v227, v75, v43 row_newbcast:14 row_mask:0xf bank_mask:0xf
    v_mfma_f32_16x16x32_bf16 v[192:195], a[72:75], v[152:155], v[192:195]
    v_cvt_pk_bf16_f32 v157, v226, v227
    v_mul_f32_dpp v228, v76, v44 row_newbcast:14 row_mask:0xf bank_mask:0xf
    v_mfma_f32_16x16x32_bf16 v[196:199], a[88:91], v[152:155], v[196:199]
    v_mul_f32_dpp v229, v77, v45 row_newbcast:14 row_mask:0xf bank_mask:0xf
    v_cvt_pk_bf16_f32 v158, v228, v229
    v_mfma_f32_16x16x32_bf16 v[204:207], a[112:115], v[144:147], v[140:143]
    v_mul_f32_dpp v230, v78, v46 row_newbcast:14 row_mask:0xf bank_mask:0xf
    v_mul_f32_dpp v231, v79, v47 row_newbcast:14 row_mask:0xf bank_mask:0xf
    v_mfma_f32_16x16x32_bf16 v[204:207], a[116:119], v[148:151], v[204:207]
    v_cvt_pk_bf16_f32 v159, v230, v231
    v_mul_f32_dpp v224, v48, v16 row_newbcast:2 row_mask:0xf bank_mask:0xf
    v_mfma_f32_16x16x32_bf16 v[204:207], a[120:123], v[152:155], v[204:207]
    v_mul_f32_dpp v225, v49, v17 row_newbcast:2 row_mask:0xf bank_mask:0xf
    v_cvt_pk_bf16_f32 v160, v224, v225
    v_mfma_f32_16x16x32_bf16 v[204:207], a[124:127], v[156:159], v[204:207]
    v_mul_f32_dpp v226, v50, v18 row_newbcast:2 row_mask:0xf bank_mask:0xf
    v_mul_f32_dpp v227, v51, v19 row_newbcast:2 row_mask:0xf bank_mask:0xf
    v_smfmac_f32_16x16x64_bf16 v[240:243], a[140:143], v[152:159], v1
    v_cvt_pk_bf16_f32 v161, v226, v227
    v_mul_f32_dpp v228, v52, v20 row_newbcast:2 row_mask:0xf bank_mask:0xf
    v_mfma_f32_16x16x32_bf16 v[176:179], a[12:15], v[156:159], v[176:179]
    v_mul_f32_dpp v229, v53, v21 row_newbcast:2 row_mask:0xf bank_mask:0xf
    v_cvt_pk_bf16_f32 v162, v228, v229
    v_mfma_f32_16x16x32_bf16 v[180:183], a[28:31], v[156:159], v[180:183]
    v_mul_f32_dpp v230, v54, v22 row_newbcast:2 row_mask:0xf bank_mask:0xf
    v_mul_f32_dpp v231, v55, v23 row_newbcast:2 row_mask:0xf bank_mask:0xf
    v_mfma_f32_16x16x32_bf16 v[184:187], a[44:47], v[156:159], v[184:187]
    v_cvt_pk_bf16_f32 v163, v230, v231
    v_cvt_pk_bf16_f32 v222, |v204|, |v205|
    v_mfma_f32_16x16x32_bf16 v[188:191], a[60:63], v[156:159], v[188:191]
    v_cvt_pk_bf16_f32 v208, |v176|, |v177|
    v_cvt_pk_bf16_f32 v209, |v178|, |v179|
    v_mfma_f32_16x16x32_bf16 v[192:195], a[76:79], v[156:159], v[192:195]
    v_cvt_pk_bf16_f32 v210, |v180|, |v181|
    v_cvt_pk_bf16_f32 v211, |v182|, |v183|
    v_mfma_f32_16x16x32_bf16 v[196:199], a[92:95], v[156:159], v[196:199]
    v_cvt_pk_bf16_f32 v212, |v184|, |v185|
    v_cvt_pk_bf16_f32 v213, |v186|, |v187|
    v_mfma_f32_16x16x32_bf16 v[200:203], a[108:111], v[156:159], v[200:203]
    v_cvt_pk_bf16_f32 v214, |v188|, |v189|
    v_cvt_pk_bf16_f32 v215, |v190|, |v191|
    v_mfma_f32_16x16x32_bf16 v[176:179], a[0:3], v[160:163], v[112:115]
    v_cvt_pk_bf16_f32 v216, |v192|, |v193|
    v_cvt_pk_bf16_f32 v217, |v194|, |v195|
    v_smfmac_f32_16x16x64_bf16 v[240:243], a[128:131], v[208:215], v1
    v_cvt_pk_bf16_f32 v218, |v196|, |v197|
    v_cvt_pk_bf16_f32 v219, |v198|, |v199|
    v_mfma_f32_16x16x32_bf16 v[180:183], a[16:19], v[160:163], v[116:119]
    v_cvt_pk_bf16_f32 v220, |v200|, |v201|
    v_cvt_pk_bf16_f32 v221, |v202|, |v203|
    v_mfma_f32_16x16x32_bf16 v[184:187], a[32:35], v[160:163], v[120:123]
    v_cvt_pk_bf16_f32 v223, |v206|, |v207|
    v_mul_f32_dpp v224, v56, v24 row_newbcast:2 row_mask:0xf bank_mask:0xf
    v_mfma_f32_16x16x32_bf16 v[188:191], a[48:51], v[160:163], v[124:127]
    v_mul_f32_dpp v225, v57, v25 row_newbcast:2 row_mask:0xf bank_mask:0xf
    v_cvt_pk_bf16_f32 v164, v224, v225
    v_smfmac_f32_16x16x64_bf16 v[240:243], a[132:135], v[216:223], v1
    v_mul_f32_dpp v226, v58, v26 row_newbcast:2 row_mask:0xf bank_mask:0xf
    v_mul_f32_dpp v227, v59, v27 row_newbcast:2 row_mask:0xf bank_mask:0xf
    v_mfma_f32_16x16x32_bf16 v[192:195], a[64:67], v[160:163], v[128:131]
    v_cvt_pk_bf16_f32 v165, v226, v227
    v_mul_f32_dpp v228, v60, v28 row_newbcast:2 row_mask:0xf bank_mask:0xf
    v_mfma_f32_16x16x32_bf16 v[196:199], a[80:83], v[160:163], v[132:135]
    v_mul_f32_dpp v229, v61, v29 row_newbcast:2 row_mask:0xf bank_mask:0xf
    v_cvt_pk_bf16_f32 v166, v228, v229
    v_mfma_f32_16x16x32_bf16 v[200:203], a[96:99], v[160:163], v[136:139]
    v_mul_f32_dpp v230, v62, v30 row_newbcast:2 row_mask:0xf bank_mask:0xf
    v_mul_f32_dpp v231, v63, v31 row_newbcast:2 row_mask:0xf bank_mask:0xf
    v_mfma_f32_16x16x32_bf16 v[204:207], a[112:115], v[160:163], v[140:143]
    v_cvt_pk_bf16_f32 v167, v230, v231
    v_mul_f32_dpp v224, v64, v32 row_newbcast:2 row_mask:0xf bank_mask:0xf
    v_mul_f32_dpp v225, v65, v33 row_newbcast:2 row_mask:0xf bank_mask:0xf
    v_mfma_f32_16x16x32_bf16 v[204:207], a[116:119], v[164:167], v[204:207]
    v_cvt_pk_bf16_f32 v168, v224, v225
    v_mul_f32_dpp v226, v66, v34 row_newbcast:2 row_mask:0xf bank_mask:0xf
    v_smfmac_f32_16x16x64_bf16 v[240:243], a[152:155], v[160:167], v1
    v_mul_f32_dpp v227, v67, v35 row_newbcast:2 row_mask:0xf bank_mask:0xf
    v_cvt_pk_bf16_f32 v169, v226, v227
    v_mfma_f32_16x16x32_bf16 v[176:179], a[4:7], v[164:167], v[176:179]
    v_mul_f32_dpp v228, v68, v36 row_newbcast:2 row_mask:0xf bank_mask:0xf
    v_mul_f32_dpp v229, v69, v37 row_newbcast:2 row_mask:0xf bank_mask:0xf
    v_mfma_f32_16x16x32_bf16 v[180:183], a[20:23], v[164:167], v[180:183]
    v_cvt_pk_bf16_f32 v170, v228, v229
    v_mul_f32_dpp v230, v70, v38 row_newbcast:2 row_mask:0xf bank_mask:0xf
    v_mfma_f32_16x16x32_bf16 v[184:187], a[36:39], v[164:167], v[184:187]
    v_mul_f32_dpp v231, v71, v39 row_newbcast:2 row_mask:0xf bank_mask:0xf
    v_cvt_pk_bf16_f32 v171, v230, v231
    v_mfma_f32_16x16x32_bf16 v[188:191], a[52:55], v[164:167], v[188:191]
    v_mul_f32_dpp v224, v72, v40 row_newbcast:2 row_mask:0xf bank_mask:0xf
    v_mul_f32_dpp v225, v73, v41 row_newbcast:2 row_mask:0xf bank_mask:0xf
    v_mfma_f32_16x16x32_bf16 v[188:191], a[56:59], v[168:171], v[188:191]
    v_cvt_pk_bf16_f32 v172, v224, v225
    v_mul_f32_dpp v226, v74, v42 row_newbcast:2 row_mask:0xf bank_mask:0xf
    v_mfma_f32_16x16x32_bf16 v[176:179], a[8:11], v[168:171], v[176:179]
    v_mul_f32_dpp v227, v75, v43 row_newbcast:2 row_mask:0xf bank_mask:0xf
    v_cvt_pk_bf16_f32 v173, v226, v227
    v_mfma_f32_16x16x32_bf16 v[180:183], a[24:27], v[168:171], v[180:183]
    v_mul_f32_dpp v228, v76, v44 row_newbcast:2 row_mask:0xf bank_mask:0xf
    v_mul_f32_dpp v229, v77, v45 row_newbcast:2 row_mask:0xf bank_mask:0xf
    v_mfma_f32_16x16x32_bf16 v[184:187], a[40:43], v[168:171], v[184:187]
    v_cvt_pk_bf16_f32 v174, v228, v229
    v_mul_f32_dpp v230, v78, v46 row_newbcast:2 row_mask:0xf bank_mask:0xf
    v_mfma_f32_16x16x32_bf16 v[192:195], a[68:71], v[164:167], v[192:195]
    v_mul_f32_dpp v231, v79, v47 row_newbcast:2 row_mask:0xf bank_mask:0xf
    v_cvt_pk_bf16_f32 v175, v230, v231
    v_mfma_f32_16x16x32_bf16 v[192:195], a[72:75], v[168:171], v[192:195]
    v_mul_f32_dpp v224, v48, v16 row_newbcast:5 row_mask:0xf bank_mask:0xf
    v_mul_f32_dpp v225, v49, v17 row_newbcast:5 row_mask:0xf bank_mask:0xf
    v_mfma_f32_16x16x32_bf16 v[192:195], a[76:79], v[172:175], v[192:195]
    v_cvt_pk_bf16_f32 v144, v224, v225
    v_mul_f32_dpp v226, v50, v18 row_newbcast:5 row_mask:0xf bank_mask:0xf
    v_smfmac_f32_16x16x64_bf16 v[240:243], a[156:159], v[168:175], v1
    v_mul_f32_dpp v227, v51, v19 row_newbcast:5 row_mask:0xf bank_mask:0xf
    v_cvt_pk_bf16_f32 v145, v226, v227
    v_mfma_f32_16x16x32_bf16 v[176:179], a[12:15], v[172:175], v[176:179]
    v_mul_f32_dpp v228, v52, v20 row_newbcast:5 row_mask:0xf bank_mask:0xf
    v_mul_f32_dpp v229, v53, v21 row_newbcast:5 row_mask:0xf bank_mask:0xf
    v_mfma_f32_16x16x32_bf16 v[180:183], a[28:31], v[172:175], v[180:183]
    v_cvt_pk_bf16_f32 v146, v228, v229
    v_mul_f32_dpp v230, v54, v22 row_newbcast:5 row_mask:0xf bank_mask:0xf
    v_mfma_f32_16x16x32_bf16 v[184:187], a[44:47], v[172:175], v[184:187]
    v_mul_f32_dpp v231, v55, v23 row_newbcast:5 row_mask:0xf bank_mask:0xf
    v_cvt_pk_bf16_f32 v147, v230, v231
    v_mfma_f32_16x16x32_bf16 v[188:191], a[60:63], v[172:175], v[188:191]
    v_cvt_pk_bf16_f32 v208, |v176|, |v177|
    v_cvt_pk_bf16_f32 v209, |v178|, |v179|
    v_mfma_f32_16x16x32_bf16 v[196:199], a[84:87], v[164:167], v[196:199]
    v_cvt_pk_bf16_f32 v210, |v180|, |v181|
    v_cvt_pk_bf16_f32 v211, |v182|, |v183|
    v_mfma_f32_16x16x32_bf16 v[196:199], a[88:91], v[168:171], v[196:199]
    v_cvt_pk_bf16_f32 v212, |v184|, |v185|
    v_cvt_pk_bf16_f32 v213, |v186|, |v187|
    v_mfma_f32_16x16x32_bf16 v[196:199], a[92:95], v[172:175], v[196:199]
    v_cvt_pk_bf16_f32 v214, |v188|, |v189|
    v_cvt_pk_bf16_f32 v215, |v190|, |v191|
    v_mfma_f32_16x16x32_bf16 v[200:203], a[100:103], v[164:167], v[200:203]
    v_cvt_pk_bf16_f32 v216, |v192|, |v193|
    v_cvt_pk_bf16_f32 v217, |v194|, |v195|
    v_mfma_f32_16x16x32_bf16 v[200:203], a[104:107], v[168:171], v[200:203]
    v_mul_f32_dpp v224, v56, v24 row_newbcast:5 row_mask:0xf bank_mask:0xf
    v_mul_f32_dpp v225, v57, v25 row_newbcast:5 row_mask:0xf bank_mask:0xf
    v_mfma_f32_16x16x32_bf16 v[200:203], a[108:111], v[172:175], v[200:203]
    v_cvt_pk_bf16_f32 v218, |v196|, |v197|
    v_cvt_pk_bf16_f32 v219, |v198|, |v199|
    v_smfmac_f32_16x16x64_bf16 v[240:243], a[144:147], v[208:215], v1
    v_cvt_pk_bf16_f32 v148, v224, v225
    v_mul_f32_dpp v226, v58, v26 row_newbcast:5 row_mask:0xf bank_mask:0xf
    v_mfma_f32_16x16x32_bf16 v[204:207], a[120:123], v[168:171], v[204:207]
    v_mul_f32_dpp v227, v59, v27 row_newbcast:5 row_mask:0xf bank_mask:0xf
    v_cvt_pk_bf16_f32 v149, v226, v227
    v_mfma_f32_16x16x32_bf16 v[204:207], a[124:127], v[172:175], v[204:207]
    v_cvt_pk_bf16_f32 v220, |v200|, |v201|
    v_cvt_pk_bf16_f32 v221, |v202|, |v203|
    v_mfma_f32_16x16x32_bf16 v[176:179], a[0:3], v[144:147], v[112:115]
    v_mul_f32_dpp v228, v60, v28 row_newbcast:5 row_mask:0xf bank_mask:0xf
    v_mul_f32_dpp v229, v61, v29 row_newbcast:5 row_mask:0xf bank_mask:0xf
    v_mfma_f32_16x16x32_bf16 v[180:183], a[16:19], v[144:147], v[116:119]
    v_cvt_pk_bf16_f32 v150, v228, v229
    v_mul_f32_dpp v230, v62, v30 row_newbcast:5 row_mask:0xf bank_mask:0xf
    v_mfma_f32_16x16x32_bf16 v[184:187], a[32:35], v[144:147], v[120:123]
    v_cvt_pk_bf16_f32 v222, |v204|, |v205|
    v_cvt_pk_bf16_f32 v223, |v206|, |v207|
    v_mfma_f32_16x16x32_bf16 v[188:191], a[48:51], v[144:147], v[124:127]
    v_mul_f32_dpp v231, v63, v31 row_newbcast:5 row_mask:0xf bank_mask:0xf
    v_cvt_pk_bf16_f32 v151, v230, v231
    v_smfmac_f32_16x16x64_bf16 v[240:243], a[148:151], v[216:223], v1
    v_mul_f32_dpp v224, v64, v32 row_newbcast:5 row_mask:0xf bank_mask:0xf
    v_mul_f32_dpp v225, v65, v33 row_newbcast:5 row_mask:0xf bank_mask:0xf
    v_mfma_f32_16x16x32_bf16 v[176:179], a[4:7], v[148:151], v[176:179]
    v_cvt_pk_bf16_f32 v152, v224, v225
    v_mul_f32_dpp v226, v66, v34 row_newbcast:5 row_mask:0xf bank_mask:0xf
    v_smfmac_f32_16x16x64_bf16 v[240:243], a[168:171], v[144:151], v1
    v_mul_f32_dpp v227, v67, v35 row_newbcast:5 row_mask:0xf bank_mask:0xf
    v_cvt_pk_bf16_f32 v153, v226, v227
    v_mfma_f32_16x16x32_bf16 v[180:183], a[20:23], v[148:151], v[180:183]
    v_mul_f32_dpp v228, v68, v36 row_newbcast:5 row_mask:0xf bank_mask:0xf
    v_mul_f32_dpp v229, v69, v37 row_newbcast:5 row_mask:0xf bank_mask:0xf
    v_mfma_f32_16x16x32_bf16 v[184:187], a[36:39], v[148:151], v[184:187]
    v_cvt_pk_bf16_f32 v154, v228, v229
    v_mul_f32_dpp v230, v70, v38 row_newbcast:5 row_mask:0xf bank_mask:0xf
    v_mfma_f32_16x16x32_bf16 v[188:191], a[52:55], v[148:151], v[188:191]
    v_mul_f32_dpp v231, v71, v39 row_newbcast:5 row_mask:0xf bank_mask:0xf
    v_cvt_pk_bf16_f32 v155, v230, v231
    v_mfma_f32_16x16x32_bf16 v[192:195], a[64:67], v[144:147], v[128:131]
    v_mul_f32_dpp v224, v72, v40 row_newbcast:5 row_mask:0xf bank_mask:0xf
    v_mul_f32_dpp v225, v73, v41 row_newbcast:5 row_mask:0xf bank_mask:0xf
    v_mfma_f32_16x16x32_bf16 v[192:195], a[68:71], v[148:151], v[192:195]
    v_cvt_pk_bf16_f32 v156, v224, v225
    v_mul_f32_dpp v226, v74, v42 row_newbcast:5 row_mask:0xf bank_mask:0xf
    v_mfma_f32_16x16x32_bf16 v[192:195], a[72:75], v[152:155], v[192:195]
    v_mul_f32_dpp v227, v75, v43 row_newbcast:5 row_mask:0xf bank_mask:0xf
    v_cvt_pk_bf16_f32 v157, v226, v227
    v_mfma_f32_16x16x32_bf16 v[176:179], a[8:11], v[152:155], v[176:179]
    v_mul_f32_dpp v228, v76, v44 row_newbcast:5 row_mask:0xf bank_mask:0xf
    v_mul_f32_dpp v229, v77, v45 row_newbcast:5 row_mask:0xf bank_mask:0xf
    v_mfma_f32_16x16x32_bf16 v[180:183], a[24:27], v[152:155], v[180:183]
    v_cvt_pk_bf16_f32 v158, v228, v229
    v_mul_f32_dpp v230, v78, v46 row_newbcast:5 row_mask:0xf bank_mask:0xf
    v_mfma_f32_16x16x32_bf16 v[184:187], a[40:43], v[152:155], v[184:187]
    v_mul_f32_dpp v231, v79, v47 row_newbcast:5 row_mask:0xf bank_mask:0xf
    v_cvt_pk_bf16_f32 v159, v230, v231
    v_mfma_f32_16x16x32_bf16 v[188:191], a[56:59], v[152:155], v[188:191]
    v_mul_f32_dpp v224, v48, v16 row_newbcast:7 row_mask:0xf bank_mask:0xf
    v_mul_f32_dpp v225, v49, v17 row_newbcast:7 row_mask:0xf bank_mask:0xf
    v_mfma_f32_16x16x32_bf16 v[188:191], a[60:63], v[156:159], v[188:191]
    v_cvt_pk_bf16_f32 v160, v224, v225
    v_mul_f32_dpp v226, v50, v18 row_newbcast:7 row_mask:0xf bank_mask:0xf
    v_smfmac_f32_16x16x64_bf16 v[240:243], a[172:175], v[152:159], v1
    v_mul_f32_dpp v227, v51, v19 row_newbcast:7 row_mask:0xf bank_mask:0xf
    v_cvt_pk_bf16_f32 v161, v226, v227
    v_mfma_f32_16x16x32_bf16 v[176:179], a[12:15], v[156:159], v[176:179]
    v_mul_f32_dpp v228, v52, v20 row_newbcast:7 row_mask:0xf bank_mask:0xf
    v_mul_f32_dpp v229, v53, v21 row_newbcast:7 row_mask:0xf bank_mask:0xf
    v_mfma_f32_16x16x32_bf16 v[180:183], a[28:31], v[156:159], v[180:183]
    v_cvt_pk_bf16_f32 v162, v228, v229
    v_mul_f32_dpp v230, v54, v22 row_newbcast:7 row_mask:0xf bank_mask:0xf
    v_mfma_f32_16x16x32_bf16 v[184:187], a[44:47], v[156:159], v[184:187]
    v_mul_f32_dpp v231, v55, v23 row_newbcast:7 row_mask:0xf bank_mask:0xf
    v_cvt_pk_bf16_f32 v163, v230, v231
    v_mfma_f32_16x16x32_bf16 v[192:195], a[76:79], v[156:159], v[192:195]
    v_cvt_pk_bf16_f32 v208, |v176|, |v177|
    v_cvt_pk_bf16_f32 v209, |v178|, |v179|
    v_mfma_f32_16x16x32_bf16 v[196:199], a[80:83], v[144:147], v[132:135]
    v_cvt_pk_bf16_f32 v210, |v180|, |v181|
    v_cvt_pk_bf16_f32 v211, |v182|, |v183|
    v_mfma_f32_16x16x32_bf16 v[196:199], a[84:87], v[148:151], v[196:199]
    v_cvt_pk_bf16_f32 v212, |v184|, |v185|
    v_cvt_pk_bf16_f32 v213, |v186|, |v187|
    v_mfma_f32_16x16x32_bf16 v[196:199], a[88:91], v[152:155], v[196:199]
    v_cvt_pk_bf16_f32 v214, |v188|, |v189|
    v_cvt_pk_bf16_f32 v215, |v190|, |v191|
    v_mfma_f32_16x16x32_bf16 v[196:199], a[92:95], v[156:159], v[196:199]
    v_cvt_pk_bf16_f32 v216, |v192|, |v193|
    v_cvt_pk_bf16_f32 v217, |v194|, |v195|
    v_smfmac_f32_16x16x64_bf16 v[240:243], a[160:163], v[208:215], v1
    v_mul_f32_dpp v224, v56, v24 row_newbcast:7 row_mask:0xf bank_mask:0xf
    v_mul_f32_dpp v225, v57, v25 row_newbcast:7 row_mask:0xf bank_mask:0xf
    v_mfma_f32_16x16x32_bf16 v[200:203], a[96:99], v[144:147], v[136:139]
    v_cvt_pk_bf16_f32 v164, v224, v225
    v_mul_f32_dpp v226, v58, v26 row_newbcast:7 row_mask:0xf bank_mask:0xf
    v_mfma_f32_16x16x32_bf16 v[200:203], a[100:103], v[148:151], v[200:203]
    v_cvt_pk_bf16_f32 v218, |v196|, |v197|
    v_cvt_pk_bf16_f32 v219, |v198|, |v199|
    v_mfma_f32_16x16x32_bf16 v[200:203], a[104:107], v[152:155], v[200:203]
    v_mul_f32_dpp v227, v59, v27 row_newbcast:7 row_mask:0xf bank_mask:0xf
    v_cvt_pk_bf16_f32 v165, v226, v227
    v_mfma_f32_16x16x32_bf16 v[200:203], a[108:111], v[156:159], v[200:203]
    v_mul_f32_dpp v228, v60, v28 row_newbcast:7 row_mask:0xf bank_mask:0xf
    v_mul_f32_dpp v229, v61, v29 row_newbcast:7 row_mask:0xf bank_mask:0xf
    v_mfma_f32_16x16x32_bf16 v[204:207], a[112:115], v[144:147], v[140:143]
    v_cvt_pk_bf16_f32 v166, v228, v229
    v_mul_f32_dpp v230, v62, v30 row_newbcast:7 row_mask:0xf bank_mask:0xf
    v_mfma_f32_16x16x32_bf16 v[204:207], a[116:119], v[148:151], v[204:207]
    v_mul_f32_dpp v231, v63, v31 row_newbcast:7 row_mask:0xf bank_mask:0xf
    v_cvt_pk_bf16_f32 v167, v230, v231
    v_mfma_f32_16x16x32_bf16 v[204:207], a[120:123], v[152:155], v[204:207]
    v_cvt_pk_bf16_f32 v220, |v200|, |v201|
    v_cvt_pk_bf16_f32 v221, |v202|, |v203|
    v_mfma_f32_16x16x32_bf16 v[204:207], a[124:127], v[156:159], v[204:207]
    v_mul_f32_dpp v224, v64, v32 row_newbcast:7 row_mask:0xf bank_mask:0xf
    v_mul_f32_dpp v225, v65, v33 row_newbcast:7 row_mask:0xf bank_mask:0xf
    v_mfma_f32_16x16x32_bf16 v[176:179], a[0:3], v[160:163], v[112:115]
    v_cvt_pk_bf16_f32 v168, v224, v225
    v_mul_f32_dpp v226, v66, v34 row_newbcast:7 row_mask:0xf bank_mask:0xf
    v_mfma_f32_16x16x32_bf16 v[176:179], a[4:7], v[164:167], v[176:179]
    v_mul_f32_dpp v227, v67, v35 row_newbcast:7 row_mask:0xf bank_mask:0xf
    v_cvt_pk_bf16_f32 v169, v226, v227
    v_mfma_f32_16x16x32_bf16 v[180:183], a[16:19], v[160:163], v[116:119]
    v_cvt_pk_bf16_f32 v222, |v204|, |v205|
    v_cvt_pk_bf16_f32 v223, |v206|, |v207|
    v_mfma_f32_16x16x32_bf16 v[180:183], a[20:23], v[164:167], v[180:183]
    v_mul_f32_dpp v228, v68, v36 row_newbcast:7 row_mask:0xf bank_mask:0xf
    v_mul_f32_dpp v229, v69, v37 row_newbcast:7 row_mask:0xf bank_mask:0xf
    v_smfmac_f32_16x16x64_bf16 v[240:243], a[164:167], v[216:223], v1
    v_cvt_pk_bf16_f32 v170, v228, v229
    v_mul_f32_dpp v230, v70, v38 row_newbcast:7 row_mask:0xf bank_mask:0xf
    v_mfma_f32_16x16x32_bf16 v[184:187], a[32:35], v[160:163], v[120:123]
    v_mul_f32_dpp v231, v71, v39 row_newbcast:7 row_mask:0xf bank_mask:0xf
    v_cvt_pk_bf16_f32 v171, v230, v231
    v_mfma_f32_16x16x32_bf16 v[184:187], a[36:39], v[164:167], v[184:187]
    v_mul_f32_dpp v224, v72, v40 row_newbcast:7 row_mask:0xf bank_mask:0xf
    v_mul_f32_dpp v225, v73, v41 row_newbcast:7 row_mask:0xf bank_mask:0xf
    v_mfma_f32_16x16x32_bf16 v[184:187], a[40:43], v[168:171], v[184:187]
    v_cvt_pk_bf16_f32 v172, v224, v225
    v_mul_f32_dpp v226, v74, v42 row_newbcast:7 row_mask:0xf bank_mask:0xf
    v_smfmac_f32_16x16x64_bf16 v[240:243], a[184:187], v[160:167], v1
    v_mul_f32_dpp v227, v75, v43 row_newbcast:7 row_mask:0xf bank_mask:0xf
    v_cvt_pk_bf16_f32 v173, v226, v227
    v_mfma_f32_16x16x32_bf16 v[176:179], a[8:11], v[168:171], v[176:179]
    v_mul_f32_dpp v228, v76, v44 row_newbcast:7 row_mask:0xf bank_mask:0xf
    v_mul_f32_dpp v229, v77, v45 row_newbcast:7 row_mask:0xf bank_mask:0xf
    v_mfma_f32_16x16x32_bf16 v[180:183], a[24:27], v[168:171], v[180:183]
    v_cvt_pk_bf16_f32 v174, v228, v229
    v_mul_f32_dpp v230, v78, v46 row_newbcast:7 row_mask:0xf bank_mask:0xf
    v_mfma_f32_16x16x32_bf16 v[188:191], a[48:51], v[160:163], v[124:127]
    v_mul_f32_dpp v231, v79, v47 row_newbcast:7 row_mask:0xf bank_mask:0xf
    v_cvt_pk_bf16_f32 v175, v230, v231
    v_mfma_f32_16x16x32_bf16 v[188:191], a[52:55], v[164:167], v[188:191]
    v_mul_f32_dpp v224, v48, v16 row_newbcast:9 row_mask:0xf bank_mask:0xf
    v_mul_f32_dpp v225, v49, v17 row_newbcast:9 row_mask:0xf bank_mask:0xf
    v_mfma_f32_16x16x32_bf16 v[188:191], a[56:59], v[168:171], v[188:191]
    v_cvt_pk_bf16_f32 v144, v224, v225
    v_mul_f32_dpp v226, v50, v18 row_newbcast:9 row_mask:0xf bank_mask:0xf
    v_mfma_f32_16x16x32_bf16 v[188:191], a[60:63], v[172:175], v[188:191]
    v_mul_f32_dpp v227, v51, v19 row_newbcast:9 row_mask:0xf bank_mask:0xf
    v_cvt_pk_bf16_f32 v145, v226, v227
    v_smfmac_f32_16x16x64_bf16 v[240:243], a[188:191], v[168:175], v1
    v_mul_f32_dpp v228, v52, v20 row_newbcast:9 row_mask:0xf bank_mask:0xf
    v_mul_f32_dpp v229, v53, v21 row_newbcast:9 row_mask:0xf bank_mask:0xf
    v_mfma_f32_16x16x32_bf16 v[176:179], a[12:15], v[172:175], v[176:179]
    v_cvt_pk_bf16_f32 v146, v228, v229
    v_mul_f32_dpp v230, v54, v22 row_newbcast:9 row_mask:0xf bank_mask:0xf
    v_mfma_f32_16x16x32_bf16 v[180:183], a[28:31], v[172:175], v[180:183]
    v_mul_f32_dpp v231, v55, v23 row_newbcast:9 row_mask:0xf bank_mask:0xf
    v_cvt_pk_bf16_f32 v147, v230, v231
    v_mfma_f32_16x16x32_bf16 v[184:187], a[44:47], v[172:175], v[184:187]
    v_cvt_pk_bf16_f32 v214, |v188|, |v189|
    v_cvt_pk_bf16_f32 v215, |v190|, |v191|
    v_mfma_f32_16x16x32_bf16 v[192:195], a[64:67], v[160:163], v[128:131]
    v_cvt_pk_bf16_f32 v208, |v176|, |v177|
    v_cvt_pk_bf16_f32 v209, |v178|, |v179|
    v_mfma_f32_16x16x32_bf16 v[192:195], a[68:71], v[164:167], v[192:195]
    v_cvt_pk_bf16_f32 v210, |v180|, |v181|
    v_cvt_pk_bf16_f32 v211, |v182|, |v183|
    v_mfma_f32_16x16x32_bf16 v[192:195], a[72:75], v[168:171], v[192:195]
    v_cvt_pk_bf16_f32 v212, |v184|, |v185|
    v_cvt_pk_bf16_f32 v213, |v186|, |v187|
    v_mfma_f32_16x16x32_bf16 v[192:195], a[76:79], v[172:175], v[192:195]
    v_mul_f32_dpp v224, v56, v24 row_newbcast:9 row_mask:0xf bank_mask:0xf
    v_mul_f32_dpp v225, v57, v25 row_newbcast:9 row_mask:0xf bank_mask:0xf
    v_smfmac_f32_16x16x64_bf16 v[240:243], a[176:179], v[208:215], v1
    v_cvt_pk_bf16_f32 v148, v224, v225
    v_mul_f32_dpp v226, v58, v26 row_newbcast:9 row_mask:0xf bank_mask:0xf
    v_mfma_f32_16x16x32_bf16 v[196:199], a[80:83], v[160:163], v[132:135]
    v_mul_f32_dpp v227, v59, v27 row_newbcast:9 row_mask:0xf bank_mask:0xf
    v_cvt_pk_bf16_f32 v149, v226, v227
    v_mfma_f32_16x16x32_bf16 v[196:199], a[84:87], v[164:167], v[196:199]
    v_cvt_pk_bf16_f32 v216, |v192|, |v193|
    v_cvt_pk_bf16_f32 v217, |v194|, |v195|
    v_mfma_f32_16x16x32_bf16 v[196:199], a[88:91], v[168:171], v[196:199]
    v_mul_f32_dpp v228, v60, v28 row_newbcast:9 row_mask:0xf bank_mask:0xf
    v_mul_f32_dpp v229, v61, v29 row_newbcast:9 row_mask:0xf bank_mask:0xf
    v_mfma_f32_16x16x32_bf16 v[196:199], a[92:95], v[172:175], v[196:199]
    v_cvt_pk_bf16_f32 v150, v228, v229
    v_mul_f32_dpp v230, v62, v30 row_newbcast:9 row_mask:0xf bank_mask:0xf
    v_mfma_f32_16x16x32_bf16 v[200:203], a[96:99], v[160:163], v[136:139]
    v_mul_f32_dpp v231, v63, v31 row_newbcast:9 row_mask:0xf bank_mask:0xf
    v_cvt_pk_bf16_f32 v151, v230, v231
    v_mfma_f32_16x16x32_bf16 v[200:203], a[100:103], v[164:167], v[200:203]
    v_mul_f32_dpp v224, v64, v32 row_newbcast:9 row_mask:0xf bank_mask:0xf
    v_mul_f32_dpp v225, v65, v33 row_newbcast:9 row_mask:0xf bank_mask:0xf
    v_mfma_f32_16x16x32_bf16 v[200:203], a[104:107], v[168:171], v[200:203]
    v_cvt_pk_bf16_f32 v218, |v196|, |v197|
    v_cvt_pk_bf16_f32 v219, |v198|, |v199|
    v_mfma_f32_16x16x32_bf16 v[200:203], a[108:111], v[172:175], v[200:203]
    v_cvt_pk_bf16_f32 v152, v224, v225
    v_mul_f32_dpp v226, v66, v34 row_newbcast:9 row_mask:0xf bank_mask:0xf
    v_smfmac_f32_16x16x64_bf16 v[244:247], a[136:139], v[144:151], v1
    v_mul_f32_dpp v227, v67, v35 row_newbcast:9 row_mask:0xf bank_mask:0xf
    v_cvt_pk_bf16_f32 v153, v226, v227
    v_mfma_f32_16x16x32_bf16 v[204:207], a[112:115], v[160:163], v[140:143]
    v_mul_f32_dpp v228, v68, v36 row_newbcast:9 row_mask:0xf bank_mask:0xf
    v_mul_f32_dpp v229, v69, v37 row_newbcast:9 row_mask:0xf bank_mask:0xf
    v_mfma_f32_16x16x32_bf16 v[204:207], a[116:119], v[164:167], v[204:207]
    v_cvt_pk_bf16_f32 v220, |v200|, |v201|
    v_cvt_pk_bf16_f32 v221, |v202|, |v203|
    v_mfma_f32_16x16x32_bf16 v[204:207], a[120:123], v[168:171], v[204:207]
    v_cvt_pk_bf16_f32 v154, v228, v229
    v_mul_f32_dpp v230, v70, v38 row_newbcast:9 row_mask:0xf bank_mask:0xf
    v_mfma_f32_16x16x32_bf16 v[204:207], a[124:127], v[172:175], v[204:207]
    v_mul_f32_dpp v231, v71, v39 row_newbcast:9 row_mask:0xf bank_mask:0xf
    v_cvt_pk_bf16_f32 v155, v230, v231
    v_mfma_f32_16x16x32_bf16 v[176:179], a[0:3], v[144:147], v[112:115]
    v_mul_f32_dpp v224, v72, v40 row_newbcast:9 row_mask:0xf bank_mask:0xf
    v_mul_f32_dpp v225, v73, v41 row_newbcast:9 row_mask:0xf bank_mask:0xf
    v_mfma_f32_16x16x32_bf16 v[176:179], a[4:7], v[148:151], v[176:179]
    v_cvt_pk_bf16_f32 v156, v224, v225
    v_mul_f32_dpp v226, v74, v42 row_newbcast:9 row_mask:0xf bank_mask:0xf
    v_mfma_f32_16x16x32_bf16 v[176:179], a[8:11], v[152:155], v[176:179]
    v_cvt_pk_bf16_f32 v222, |v204|, |v205|
    v_cvt_pk_bf16_f32 v223, |v206|, |v207|
    v_mfma_f32_16x16x32_bf16 v[180:183], a[16:19], v[144:147], v[116:119]
    v_mul_f32_dpp v227, v75, v43 row_newbcast:9 row_mask:0xf bank_mask:0xf
    v_cvt_pk_bf16_f32 v157, v226, v227
    v_mfma_f32_16x16x32_bf16 v[180:183], a[20:23], v[148:151], v[180:183]
    v_mul_f32_dpp v228, v76, v44 row_newbcast:9 row_mask:0xf bank_mask:0xf
    v_mul_f32_dpp v229, v77, v45 row_newbcast:9 row_mask:0xf bank_mask:0xf
    v_mfma_f32_16x16x32_bf16 v[180:183], a[24:27], v[152:155], v[180:183]
    v_cvt_pk_bf16_f32 v158, v228, v229
    v_mul_f32_dpp v230, v78, v46 row_newbcast:9 row_mask:0xf bank_mask:0xf
    v_smfmac_f32_16x16x64_bf16 v[240:243], a[180:183], v[216:223], v1
    v_mul_f32_dpp v231, v79, v47 row_newbcast:9 row_mask:0xf bank_mask:0xf
    v_cvt_pk_bf16_f32 v159, v230, v231
    v_mfma_f32_16x16x32_bf16 v[184:187], a[32:35], v[144:147], v[120:123]
    v_mul_f32_dpp v224, v48, v16 row_newbcast:8 row_mask:0xf bank_mask:0xf
    v_mul_f32_dpp v225, v49, v17 row_newbcast:8 row_mask:0xf bank_mask:0xf
    v_mfma_f32_16x16x32_bf16 v[184:187], a[36:39], v[148:151], v[184:187]
    v_cvt_pk_bf16_f32 v160, v224, v225
    v_mul_f32_dpp v226, v50, v18 row_newbcast:8 row_mask:0xf bank_mask:0xf
    v_mfma_f32_16x16x32_bf16 v[184:187], a[40:43], v[152:155], v[184:187]
    v_mul_f32_dpp v227, v51, v19 row_newbcast:8 row_mask:0xf bank_mask:0xf
    v_cvt_pk_bf16_f32 v161, v226, v227
    v_mfma_f32_16x16x32_bf16 v[184:187], a[44:47], v[156:159], v[184:187]
    v_mul_f32_dpp v228, v52, v20 row_newbcast:8 row_mask:0xf bank_mask:0xf
    v_mul_f32_dpp v229, v53, v21 row_newbcast:8 row_mask:0xf bank_mask:0xf
    v_smfmac_f32_16x16x64_bf16 v[244:247], a[140:143], v[152:159], v1
    v_cvt_pk_bf16_f32 v162, v228, v229
    v_mul_f32_dpp v230, v54, v22 row_newbcast:8 row_mask:0xf bank_mask:0xf
    v_mfma_f32_16x16x32_bf16 v[176:179], a[12:15], v[156:159], v[176:179]
    v_mul_f32_dpp v231, v55, v23 row_newbcast:8 row_mask:0xf bank_mask:0xf
    v_cvt_pk_bf16_f32 v163, v230, v231
    v_mfma_f32_16x16x32_bf16 v[180:183], a[28:31], v[156:159], v[180:183]
    v_cvt_pk_bf16_f32 v212, |v184|, |v185|
    v_cvt_pk_bf16_f32 v213, |v186|, |v187|
    v_mfma_f32_16x16x32_bf16 v[188:191], a[48:51], v[144:147], v[124:127]
    v_mul_f32_dpp v224, v56, v24 row_newbcast:8 row_mask:0xf bank_mask:0xf
    v_mul_f32_dpp v225, v57, v25 row_newbcast:8 row_mask:0xf bank_mask:0xf
    v_mfma_f32_16x16x32_bf16 v[188:191], a[52:55], v[148:151], v[188:191]
    v_cvt_pk_bf16_f32 v208, |v176|, |v177|
    v_cvt_pk_bf16_f32 v209, |v178|, |v179|
    v_mfma_f32_16x16x32_bf16 v[188:191], a[56:59], v[152:155], v[188:191]
    v_cvt_pk_bf16_f32 v210, |v180|, |v181|
    v_cvt_pk_bf16_f32 v211, |v182|, |v183|
    v_mfma_f32_16x16x32_bf16 v[188:191], a[60:63], v[156:159], v[188:191]
    v_cvt_pk_bf16_f32 v164, v224, v225
    v_mul_f32_dpp v226, v58, v26 row_newbcast:8 row_mask:0xf bank_mask:0xf
    v_mfma_f32_16x16x32_bf16 v[192:195], a[64:67], v[144:147], v[128:131]
    v_mul_f32_dpp v227, v59, v27 row_newbcast:8 row_mask:0xf bank_mask:0xf
    v_cvt_pk_bf16_f32 v165, v226, v227
    v_mfma_f32_16x16x32_bf16 v[192:195], a[68:71], v[148:151], v[192:195]
    v_mul_f32_dpp v228, v60, v28 row_newbcast:8 row_mask:0xf bank_mask:0xf
    v_mul_f32_dpp v229, v61, v29 row_newbcast:8 row_mask:0xf bank_mask:0xf
    v_mfma_f32_16x16x32_bf16 v[192:195], a[72:75], v[152:155], v[192:195]
    v_cvt_pk_bf16_f32 v214, |v188|, |v189|
    v_cvt_pk_bf16_f32 v215, |v190|, |v191|
    v_mfma_f32_16x16x32_bf16 v[192:195], a[76:79], v[156:159], v[192:195]
    v_cvt_pk_bf16_f32 v166, v228, v229
    v_mul_f32_dpp v230, v62, v30 row_newbcast:8 row_mask:0xf bank_mask:0xf
    v_smfmac_f32_16x16x64_bf16 v[244:247], a[128:131], v[208:215], v1
    v_mul_f32_dpp v231, v63, v31 row_newbcast:8 row_mask:0xf bank_mask:0xf
    v_cvt_pk_bf16_f32 v167, v230, v231
    v_mfma_f32_16x16x32_bf16 v[196:199], a[80:83], v[144:147], v[132:135]
    v_mul_f32_dpp v224, v64, v32 row_newbcast:8 row_mask:0xf bank_mask:0xf
    v_mul_f32_dpp v225, v65, v33 row_newbcast:8 row_mask:0xf bank_mask:0xf
    v_mfma_f32_16x16x32_bf16 v[196:199], a[84:87], v[148:151], v[196:199]
    v_cvt_pk_bf16_f32 v216, |v192|, |v193|
    v_cvt_pk_bf16_f32 v217, |v194|, |v195|
    v_mfma_f32_16x16x32_bf16 v[196:199], a[88:91], v[152:155], v[196:199]
    v_cvt_pk_bf16_f32 v168, v224, v225
    v_mul_f32_dpp v226, v66, v34 row_newbcast:8 row_mask:0xf bank_mask:0xf
    v_mfma_f32_16x16x32_bf16 v[196:199], a[92:95], v[156:159], v[196:199]
    v_mul_f32_dpp v227, v67, v35 row_newbcast:8 row_mask:0xf bank_mask:0xf
    v_cvt_pk_bf16_f32 v169, v226, v227
    v_mfma_f32_16x16x32_bf16 v[200:203], a[96:99], v[144:147], v[136:139]
    v_mul_f32_dpp v228, v68, v36 row_newbcast:8 row_mask:0xf bank_mask:0xf
    v_mul_f32_dpp v229, v69, v37 row_newbcast:8 row_mask:0xf bank_mask:0xf
    v_mfma_f32_16x16x32_bf16 v[200:203], a[100:103], v[148:151], v[200:203]
    v_cvt_pk_bf16_f32 v170, v228, v229
    v_mul_f32_dpp v230, v70, v38 row_newbcast:8 row_mask:0xf bank_mask:0xf
    v_mfma_f32_16x16x32_bf16 v[200:203], a[104:107], v[152:155], v[200:203]
    v_cvt_pk_bf16_f32 v218, |v196|, |v197|
    v_cvt_pk_bf16_f32 v219, |v198|, |v199|
    v_mfma_f32_16x16x32_bf16 v[200:203], a[108:111], v[156:159], v[200:203]
    v_mul_f32_dpp v231, v71, v39 row_newbcast:8 row_mask:0xf bank_mask:0xf
    v_cvt_pk_bf16_f32 v171, v230, v231
    v_mfma_f32_16x16x32_bf16 v[204:207], a[112:115], v[144:147], v[140:143]
    v_mul_f32_dpp v224, v72, v40 row_newbcast:8 row_mask:0xf bank_mask:0xf
    v_mul_f32_dpp v225, v73, v41 row_newbcast:8 row_mask:0xf bank_mask:0xf
    v_mfma_f32_16x16x32_bf16 v[204:207], a[116:119], v[148:151], v[204:207]
    v_cvt_pk_bf16_f32 v172, v224, v225
    v_mul_f32_dpp v226, v74, v42 row_newbcast:8 row_mask:0xf bank_mask:0xf
    v_mfma_f32_16x16x32_bf16 v[204:207], a[120:123], v[152:155], v[204:207]
    v_cvt_pk_bf16_f32 v220, |v200|, |v201|
    v_cvt_pk_bf16_f32 v221, |v202|, |v203|
    v_mfma_f32_16x16x32_bf16 v[204:207], a[124:127], v[156:159], v[204:207]
    v_mul_f32_dpp v227, v75, v43 row_newbcast:8 row_mask:0xf bank_mask:0xf
    v_cvt_pk_bf16_f32 v173, v226, v227
    v_mfma_f32_16x16x32_bf16 v[176:179], a[0:3], v[160:163], v[112:115]
    v_mul_f32_dpp v228, v76, v44 row_newbcast:8 row_mask:0xf bank_mask:0xf
    v_mul_f32_dpp v229, v77, v45 row_newbcast:8 row_mask:0xf bank_mask:0xf
    v_mfma_f32_16x16x32_bf16 v[176:179], a[4:7], v[164:167], v[176:179]
    v_cvt_pk_bf16_f32 v174, v228, v229
    v_mul_f32_dpp v230, v78, v46 row_newbcast:8 row_mask:0xf bank_mask:0xf
    v_mfma_f32_16x16x32_bf16 v[176:179], a[8:11], v[168:171], v[176:179]
    v_cvt_pk_bf16_f32 v222, |v204|, |v205|
    v_cvt_pk_bf16_f32 v223, |v206|, |v207|
    v_mfma_f32_16x16x32_bf16 v[180:183], a[16:19], v[160:163], v[116:119]
    v_mul_f32_dpp v231, v79, v47 row_newbcast:8 row_mask:0xf bank_mask:0xf
    v_cvt_pk_bf16_f32 v175, v230, v231
    v_mfma_f32_16x16x32_bf16 v[180:183], a[20:23], v[164:167], v[180:183]
    v_mul_f32_dpp v224, v48, v16 row_newbcast:0 row_mask:0xf bank_mask:0xf
    v_mul_f32_dpp v225, v49, v17 row_newbcast:0 row_mask:0xf bank_mask:0xf
    v_mfma_f32_16x16x32_bf16 v[180:183], a[24:27], v[168:171], v[180:183]
    v_cvt_pk_bf16_f32 v144, v224, v225
    v_mul_f32_dpp v226, v50, v18 row_newbcast:0 row_mask:0xf bank_mask:0xf
    v_mfma_f32_16x16x32_bf16 v[180:183], a[28:31], v[172:175], v[180:183]
    v_mul_f32_dpp v227, v51, v19 row_newbcast:0 row_mask:0xf bank_mask:0xf
    v_cvt_pk_bf16_f32 v145, v226, v227
    v_smfmac_f32_16x16x64_bf16 v[244:247], a[132:135], v[216:223], v1
    v_mul_f32_dpp v228, v52, v20 row_newbcast:0 row_mask:0xf bank_mask:0xf
    v_mul_f32_dpp v229, v53, v21 row_newbcast:0 row_mask:0xf bank_mask:0xf
    v_mfma_f32_16x16x32_bf16 v[176:179], a[12:15], v[172:175], v[176:179]
    v_cvt_pk_bf16_f32 v146, v228, v229
    v_mul_f32_dpp v230, v54, v22 row_newbcast:0 row_mask:0xf bank_mask:0xf
    v_smfmac_f32_16x16x64_bf16 v[244:247], a[152:155], v[160:167], v1
    v_mul_f32_dpp v231, v55, v23 row_newbcast:0 row_mask:0xf bank_mask:0xf
    v_cvt_pk_bf16_f32 v147, v230, v231
    v_mfma_f32_16x16x32_bf16 v[184:187], a[32:35], v[160:163], v[120:123]
    v_cvt_pk_bf16_f32 v210, |v180|, |v181|
    v_cvt_pk_bf16_f32 v211, |v182|, |v183|
    v_mfma_f32_16x16x32_bf16 v[184:187], a[36:39], v[164:167], v[184:187]
    v_cvt_pk_bf16_f32 v208, |v176|, |v177|
    v_cvt_pk_bf16_f32 v209, |v178|, |v179|
    v_mfma_f32_16x16x32_bf16 v[184:187], a[40:43], v[168:171], v[184:187]
    v_mul_f32_dpp v224, v56, v24 row_newbcast:0 row_mask:0xf bank_mask:0xf
    v_mul_f32_dpp v225, v57, v25 row_newbcast:0 row_mask:0xf bank_mask:0xf
    v_mfma_f32_16x16x32_bf16 v[184:187], a[44:47], v[172:175], v[184:187]
    v_cvt_pk_bf16_f32 v148, v224, v225
    v_mul_f32_dpp v226, v58, v26 row_newbcast:0 row_mask:0xf bank_mask:0xf
    v_smfmac_f32_16x16x64_bf16 v[244:247], a[156:159], v[168:175], v1
    v_mul_f32_dpp v227, v59, v27 row_newbcast:0 row_mask:0xf bank_mask:0xf
    v_cvt_pk_bf16_f32 v149, v226, v227
    v_mfma_f32_16x16x32_bf16 v[188:191], a[48:51], v[160:163], v[124:127]
    v_mul_f32_dpp v228, v60, v28 row_newbcast:0 row_mask:0xf bank_mask:0xf
    v_mul_f32_dpp v229, v61, v29 row_newbcast:0 row_mask:0xf bank_mask:0xf
    v_mfma_f32_16x16x32_bf16 v[188:191], a[52:55], v[164:167], v[188:191]
    v_cvt_pk_bf16_f32 v212, |v184|, |v185|
    v_cvt_pk_bf16_f32 v213, |v186|, |v187|
    v_mfma_f32_16x16x32_bf16 v[188:191], a[56:59], v[168:171], v[188:191]
    v_cvt_pk_bf16_f32 v150, v228, v229
    v_mul_f32_dpp v230, v62, v30 row_newbcast:0 row_mask:0xf bank_mask:0xf
    v_mfma_f32_16x16x32_bf16 v[188:191], a[60:63], v[172:175], v[188:191]
    v_mul_f32_dpp v231, v63, v31 row_newbcast:0 row_mask:0xf bank_mask:0xf
    v_cvt_pk_bf16_f32 v151, v230, v231
    v_mfma_f32_16x16x32_bf16 v[192:195], a[64:67], v[160:163], v[128:131]
    v_mul_f32_dpp v224, v64, v32 row_newbcast:0 row_mask:0xf bank_mask:0xf
    v_mul_f32_dpp v225, v65, v33 row_newbcast:0 row_mask:0xf bank_mask:0xf
    v_mfma_f32_16x16x32_bf16 v[192:195], a[68:71], v[164:167], v[192:195]
    v_cvt_pk_bf16_f32 v152, v224, v225
    v_mul_f32_dpp v226, v66, v34 row_newbcast:0 row_mask:0xf bank_mask:0xf
    v_mfma_f32_16x16x32_bf16 v[192:195], a[72:75], v[168:171], v[192:195]
    v_cvt_pk_bf16_f32 v214, |v188|, |v189|
    v_cvt_pk_bf16_f32 v215, |v190|, |v191|
    v_mfma_f32_16x16x32_bf16 v[192:195], a[76:79], v[172:175], v[192:195]
    v_mul_f32_dpp v227, v67, v35 row_newbcast:0 row_mask:0xf bank_mask:0xf
    v_cvt_pk_bf16_f32 v153, v226, v227
    v_smfmac_f32_16x16x64_bf16 v[244:247], a[144:147], v[208:215], v1
    v_mul_f32_dpp v228, v68, v36 row_newbcast:0 row_mask:0xf bank_mask:0xf
    v_mul_f32_dpp v229, v69, v37 row_newbcast:0 row_mask:0xf bank_mask:0xf
    v_mfma_f32_16x16x32_bf16 v[196:199], a[80:83], v[160:163], v[132:135]
    v_cvt_pk_bf16_f32 v154, v228, v229
    v_mul_f32_dpp v230, v70, v38 row_newbcast:0 row_mask:0xf bank_mask:0xf
    v_mfma_f32_16x16x32_bf16 v[196:199], a[84:87], v[164:167], v[196:199]
    v_cvt_pk_bf16_f32 v216, |v192|, |v193|
    v_cvt_pk_bf16_f32 v217, |v194|, |v195|
    v_mfma_f32_16x16x32_bf16 v[196:199], a[88:91], v[168:171], v[196:199]
    v_mul_f32_dpp v231, v71, v39 row_newbcast:0 row_mask:0xf bank_mask:0xf
    v_cvt_pk_bf16_f32 v155, v230, v231
    v_mfma_f32_16x16x32_bf16 v[196:199], a[92:95], v[172:175], v[196:199]
    v_mul_f32_dpp v224, v72, v40 row_newbcast:0 row_mask:0xf bank_mask:0xf
    v_mul_f32_dpp v225, v73, v41 row_newbcast:0 row_mask:0xf bank_mask:0xf
    v_mfma_f32_16x16x32_bf16 v[200:203], a[96:99], v[160:163], v[136:139]
    v_cvt_pk_bf16_f32 v156, v224, v225
    v_mul_f32_dpp v226, v74, v42 row_newbcast:0 row_mask:0xf bank_mask:0xf
    v_mfma_f32_16x16x32_bf16 v[200:203], a[100:103], v[164:167], v[200:203]
    v_mul_f32_dpp v227, v75, v43 row_newbcast:0 row_mask:0xf bank_mask:0xf
    v_cvt_pk_bf16_f32 v157, v226, v227
    v_mfma_f32_16x16x32_bf16 v[200:203], a[104:107], v[168:171], v[200:203]
    v_cvt_pk_bf16_f32 v218, |v196|, |v197|
    v_cvt_pk_bf16_f32 v219, |v198|, |v199|
    v_mfma_f32_16x16x32_bf16 v[200:203], a[108:111], v[172:175], v[200:203]
    v_mul_f32_dpp v228, v76, v44 row_newbcast:0 row_mask:0xf bank_mask:0xf
    v_mul_f32_dpp v229, v77, v45 row_newbcast:0 row_mask:0xf bank_mask:0xf
    v_mfma_f32_16x16x32_bf16 v[204:207], a[112:115], v[160:163], v[140:143]
    v_cvt_pk_bf16_f32 v158, v228, v229
    v_mul_f32_dpp v230, v78, v46 row_newbcast:0 row_mask:0xf bank_mask:0xf
    v_mfma_f32_16x16x32_bf16 v[204:207], a[116:119], v[164:167], v[204:207]
    v_mul_f32_dpp v231, v79, v47 row_newbcast:0 row_mask:0xf bank_mask:0xf
    v_cvt_pk_bf16_f32 v159, v230, v231
    v_mfma_f32_16x16x32_bf16 v[204:207], a[120:123], v[168:171], v[204:207]
    v_cvt_pk_bf16_f32 v220, |v200|, |v201|
    v_cvt_pk_bf16_f32 v221, |v202|, |v203|
    v_mfma_f32_16x16x32_bf16 v[204:207], a[124:127], v[172:175], v[204:207]
    v_mul_f32_dpp v224, v48, v16 row_newbcast:1 row_mask:0xf bank_mask:0xf
    v_mul_f32_dpp v225, v49, v17 row_newbcast:1 row_mask:0xf bank_mask:0xf
    v_mfma_f32_16x16x32_bf16 v[176:179], a[0:3], v[144:147], v[112:115]
    v_cvt_pk_bf16_f32 v160, v224, v225
    v_mul_f32_dpp v226, v50, v18 row_newbcast:1 row_mask:0xf bank_mask:0xf
    v_mfma_f32_16x16x32_bf16 v[176:179], a[4:7], v[148:151], v[176:179]
    v_mul_f32_dpp v227, v51, v19 row_newbcast:1 row_mask:0xf bank_mask:0xf
    v_cvt_pk_bf16_f32 v161, v226, v227
    v_mfma_f32_16x16x32_bf16 v[176:179], a[8:11], v[152:155], v[176:179]
    v_cvt_pk_bf16_f32 v222, |v204|, |v205|
    v_cvt_pk_bf16_f32 v223, |v206|, |v207|
    v_mfma_f32_16x16x32_bf16 v[176:179], a[12:15], v[156:159], v[176:179]
    v_mul_f32_dpp v228, v52, v20 row_newbcast:1 row_mask:0xf bank_mask:0xf
    v_mul_f32_dpp v229, v53, v21 row_newbcast:1 row_mask:0xf bank_mask:0xf
    v_smfmac_f32_16x16x64_bf16 v[244:247], a[148:151], v[216:223], v1
    v_cvt_pk_bf16_f32 v162, v228, v229
    v_mul_f32_dpp v230, v54, v22 row_newbcast:1 row_mask:0xf bank_mask:0xf
    v_mfma_f32_16x16x32_bf16 v[180:183], a[16:19], v[144:147], v[116:119]
    v_mul_f32_dpp v231, v55, v23 row_newbcast:1 row_mask:0xf bank_mask:0xf
    v_cvt_pk_bf16_f32 v163, v230, v231
    v_mfma_f32_16x16x32_bf16 v[180:183], a[20:23], v[148:151], v[180:183]
    v_cvt_pk_bf16_f32 v208, |v176|, |v177|
    v_cvt_pk_bf16_f32 v209, |v178|, |v179|
    v_mfma_f32_16x16x32_bf16 v[180:183], a[24:27], v[152:155], v[180:183]
    v_mul_f32_dpp v224, v56, v24 row_newbcast:1 row_mask:0xf bank_mask:0xf
    v_mul_f32_dpp v225, v57, v25 row_newbcast:1 row_mask:0xf bank_mask:0xf
    v_mfma_f32_16x16x32_bf16 v[180:183], a[28:31], v[156:159], v[180:183]
    v_cvt_pk_bf16_f32 v164, v224, v225
    v_mul_f32_dpp v226, v58, v26 row_newbcast:1 row_mask:0xf bank_mask:0xf
    v_smfmac_f32_16x16x64_bf16 v[244:247], a[168:171], v[144:151], v1
    v_mul_f32_dpp v227, v59, v27 row_newbcast:1 row_mask:0xf bank_mask:0xf
    v_cvt_pk_bf16_f32 v165, v226, v227
    v_mfma_f32_16x16x32_bf16 v[184:187], a[32:35], v[144:147], v[120:123]
    v_mul_f32_dpp v228, v60, v28 row_newbcast:1 row_mask:0xf bank_mask:0xf
    v_mul_f32_dpp v229, v61, v29 row_newbcast:1 row_mask:0xf bank_mask:0xf
    v_mfma_f32_16x16x32_bf16 v[184:187], a[36:39], v[148:151], v[184:187]
    v_cvt_pk_bf16_f32 v210, |v180|, |v181|
    v_cvt_pk_bf16_f32 v211, |v182|, |v183|
    v_mfma_f32_16x16x32_bf16 v[184:187], a[40:43], v[152:155], v[184:187]
    v_cvt_pk_bf16_f32 v166, v228, v229
    v_mul_f32_dpp v230, v62, v30 row_newbcast:1 row_mask:0xf bank_mask:0xf
    v_mfma_f32_16x16x32_bf16 v[184:187], a[44:47], v[156:159], v[184:187]
    v_mul_f32_dpp v231, v63, v31 row_newbcast:1 row_mask:0xf bank_mask:0xf
    v_cvt_pk_bf16_f32 v167, v230, v231
    v_smfmac_f32_16x16x64_bf16 v[244:247], a[172:175], v[152:159], v1
    v_mul_f32_dpp v224, v64, v32 row_newbcast:1 row_mask:0xf bank_mask:0xf
    v_mul_f32_dpp v225, v65, v33 row_newbcast:1 row_mask:0xf bank_mask:0xf
    v_mfma_f32_16x16x32_bf16 v[188:191], a[48:51], v[144:147], v[124:127]
    v_cvt_pk_bf16_f32 v168, v224, v225
    v_mul_f32_dpp v226, v66, v34 row_newbcast:1 row_mask:0xf bank_mask:0xf
    v_mfma_f32_16x16x32_bf16 v[188:191], a[52:55], v[148:151], v[188:191]
    v_cvt_pk_bf16_f32 v212, |v184|, |v185|
    v_cvt_pk_bf16_f32 v213, |v186|, |v187|
    v_mfma_f32_16x16x32_bf16 v[188:191], a[56:59], v[152:155], v[188:191]
    v_mul_f32_dpp v227, v67, v35 row_newbcast:1 row_mask:0xf bank_mask:0xf
    v_cvt_pk_bf16_f32 v169, v226, v227
    v_mfma_f32_16x16x32_bf16 v[188:191], a[60:63], v[156:159], v[188:191]
    v_mul_f32_dpp v228, v68, v36 row_newbcast:1 row_mask:0xf bank_mask:0xf
    v_mul_f32_dpp v229, v69, v37 row_newbcast:1 row_mask:0xf bank_mask:0xf
    v_mfma_f32_16x16x32_bf16 v[192:195], a[64:67], v[144:147], v[128:131]
    v_cvt_pk_bf16_f32 v170, v228, v229
    v_mul_f32_dpp v230, v70, v38 row_newbcast:1 row_mask:0xf bank_mask:0xf
    v_mfma_f32_16x16x32_bf16 v[192:195], a[68:71], v[148:151], v[192:195]
    v_mul_f32_dpp v231, v71, v39 row_newbcast:1 row_mask:0xf bank_mask:0xf
    v_cvt_pk_bf16_f32 v171, v230, v231
    v_mfma_f32_16x16x32_bf16 v[192:195], a[72:75], v[152:155], v[192:195]
    v_cvt_pk_bf16_f32 v214, |v188|, |v189|
    v_cvt_pk_bf16_f32 v215, |v190|, |v191|
    v_mfma_f32_16x16x32_bf16 v[192:195], a[76:79], v[156:159], v[192:195]
    v_mul_f32_dpp v224, v72, v40 row_newbcast:1 row_mask:0xf bank_mask:0xf
    v_mul_f32_dpp v225, v73, v41 row_newbcast:1 row_mask:0xf bank_mask:0xf
    v_smfmac_f32_16x16x64_bf16 v[244:247], a[160:163], v[208:215], v1
    v_cvt_pk_bf16_f32 v172, v224, v225
    v_mul_f32_dpp v226, v74, v42 row_newbcast:1 row_mask:0xf bank_mask:0xf
    v_mfma_f32_16x16x32_bf16 v[196:199], a[80:83], v[144:147], v[132:135]
    v_mul_f32_dpp v227, v75, v43 row_newbcast:1 row_mask:0xf bank_mask:0xf
    v_cvt_pk_bf16_f32 v173, v226, v227
    v_mfma_f32_16x16x32_bf16 v[196:199], a[84:87], v[148:151], v[196:199]
    v_cvt_pk_bf16_f32 v216, |v192|, |v193|
    v_cvt_pk_bf16_f32 v217, |v194|, |v195|
    v_mfma_f32_16x16x32_bf16 v[196:199], a[88:91], v[152:155], v[196:199]
    v_mul_f32_dpp v228, v76, v44 row_newbcast:1 row_mask:0xf bank_mask:0xf
    v_mul_f32_dpp v229, v77, v45 row_newbcast:1 row_mask:0xf bank_mask:0xf
    v_mfma_f32_16x16x32_bf16 v[196:199], a[92:95], v[156:159], v[196:199]
    v_cvt_pk_bf16_f32 v174, v228, v229
    v_mul_f32_dpp v230, v78, v46 row_newbcast:1 row_mask:0xf bank_mask:0xf
    v_mfma_f32_16x16x32_bf16 v[200:203], a[96:99], v[144:147], v[136:139]
    v_mul_f32_dpp v231, v79, v47 row_newbcast:1 row_mask:0xf bank_mask:0xf
    v_cvt_pk_bf16_f32 v175, v230, v231
    v_mfma_f32_16x16x32_bf16 v[200:203], a[100:103], v[148:151], v[200:203]
    v_mul_f32_dpp v224, v48, v16 row_newbcast:6 row_mask:0xf bank_mask:0xf
    v_mul_f32_dpp v225, v49, v17 row_newbcast:6 row_mask:0xf bank_mask:0xf
    v_mfma_f32_16x16x32_bf16 v[200:203], a[104:107], v[152:155], v[200:203]
    v_cvt_pk_bf16_f32 v218, |v196|, |v197|
    v_cvt_pk_bf16_f32 v219, |v198|, |v199|
    v_mfma_f32_16x16x32_bf16 v[200:203], a[108:111], v[156:159], v[200:203]
    v_mul_f32_dpp v226, v50, v18 row_newbcast:6 row_mask:0xf bank_mask:0xf
    v_mul_f32_dpp v227, v51, v19 row_newbcast:6 row_mask:0xf bank_mask:0xf
    v_mfma_f32_16x16x32_bf16 v[204:207], a[112:115], v[144:147], v[140:143]
    v_cvt_pk_bf16_f32 v144, v224, v225
    v_cvt_pk_bf16_f32 v145, v226, v227
    v_mfma_f32_16x16x32_bf16 v[204:207], a[116:119], v[148:151], v[204:207]
    v_mul_f32_dpp v228, v52, v20 row_newbcast:6 row_mask:0xf bank_mask:0xf
    v_mul_f32_dpp v229, v53, v21 row_newbcast:6 row_mask:0xf bank_mask:0xf
    v_mfma_f32_16x16x32_bf16 v[204:207], a[120:123], v[152:155], v[204:207]
    v_cvt_pk_bf16_f32 v220, |v200|, |v201|
    v_cvt_pk_bf16_f32 v221, |v202|, |v203|
    v_mfma_f32_16x16x32_bf16 v[204:207], a[124:127], v[156:159], v[204:207]
    v_cvt_pk_bf16_f32 v146, v228, v229
    v_mul_f32_dpp v230, v54, v22 row_newbcast:6 row_mask:0xf bank_mask:0xf
    v_mfma_f32_16x16x32_bf16 v[176:179], a[0:3], v[160:163], v[112:115]
    v_mul_f32_dpp v231, v55, v23 row_newbcast:6 row_mask:0xf bank_mask:0xf
    v_cvt_pk_bf16_f32 v147, v230, v231
    v_mfma_f32_16x16x32_bf16 v[176:179], a[4:7], v[164:167], v[176:179]
    v_mul_f32_dpp v224, v56, v24 row_newbcast:6 row_mask:0xf bank_mask:0xf
    v_mul_f32_dpp v225, v57, v25 row_newbcast:6 row_mask:0xf bank_mask:0xf
    v_mfma_f32_16x16x32_bf16 v[176:179], a[8:11], v[168:171], v[176:179]
    v_cvt_pk_bf16_f32 v222, |v204|, |v205|
    v_cvt_pk_bf16_f32 v223, |v206|, |v207|
    v_mfma_f32_16x16x32_bf16 v[176:179], a[12:15], v[172:175], v[176:179]
    v_cvt_pk_bf16_f32 v148, v224, v225
    v_mul_f32_dpp v226, v58, v26 row_newbcast:6 row_mask:0xf bank_mask:0xf
    v_smfmac_f32_16x16x64_bf16 v[244:247], a[164:167], v[216:223], v1
    v_mul_f32_dpp v227, v59, v27 row_newbcast:6 row_mask:0xf bank_mask:0xf
    v_cvt_pk_bf16_f32 v149, v226, v227
    v_mfma_f32_16x16x32_bf16 v[180:183], a[16:19], v[160:163], v[116:119]
    v_mul_f32_dpp v228, v60, v28 row_newbcast:6 row_mask:0xf bank_mask:0xf
    v_mul_f32_dpp v229, v61, v29 row_newbcast:6 row_mask:0xf bank_mask:0xf
    v_mfma_f32_16x16x32_bf16 v[180:183], a[20:23], v[164:167], v[180:183]
    v_cvt_pk_bf16_f32 v208, |v176|, |v177|
    v_cvt_pk_bf16_f32 v209, |v178|, |v179|
    v_mfma_f32_16x16x32_bf16 v[180:183], a[24:27], v[168:171], v[180:183]
    v_cvt_pk_bf16_f32 v150, v228, v229
    v_mul_f32_dpp v230, v62, v30 row_newbcast:6 row_mask:0xf bank_mask:0xf
    v_mfma_f32_16x16x32_bf16 v[180:183], a[28:31], v[172:175], v[180:183]
    v_mul_f32_dpp v231, v63, v31 row_newbcast:6 row_mask:0xf bank_mask:0xf
    v_cvt_pk_bf16_f32 v151, v230, v231
    v_smfmac_f32_16x16x64_bf16 v[244:247], a[184:187], v[160:167], v1
    v_mul_f32_dpp v224, v64, v32 row_newbcast:6 row_mask:0xf bank_mask:0xf
    v_mul_f32_dpp v225, v65, v33 row_newbcast:6 row_mask:0xf bank_mask:0xf
    v_mfma_f32_16x16x32_bf16 v[184:187], a[32:35], v[160:163], v[120:123]
    v_cvt_pk_bf16_f32 v152, v224, v225
    v_mul_f32_dpp v226, v66, v34 row_newbcast:6 row_mask:0xf bank_mask:0xf
    v_mfma_f32_16x16x32_bf16 v[184:187], a[36:39], v[164:167], v[184:187]
    v_cvt_pk_bf16_f32 v210, |v180|, |v181|
    v_cvt_pk_bf16_f32 v211, |v182|, |v183|
    v_mfma_f32_16x16x32_bf16 v[184:187], a[40:43], v[168:171], v[184:187]
    v_mul_f32_dpp v227, v67, v35 row_newbcast:6 row_mask:0xf bank_mask:0xf
    v_cvt_pk_bf16_f32 v153, v226, v227
    v_mfma_f32_16x16x32_bf16 v[184:187], a[44:47], v[172:175], v[184:187]
    v_mul_f32_dpp v228, v68, v36 row_newbcast:6 row_mask:0xf bank_mask:0xf
    v_mul_f32_dpp v229, v69, v37 row_newbcast:6 row_mask:0xf bank_mask:0xf
    v_smfmac_f32_16x16x64_bf16 v[244:247], a[188:191], v[168:175], v1
    v_cvt_pk_bf16_f32 v154, v228, v229
    v_mul_f32_dpp v230, v70, v38 row_newbcast:6 row_mask:0xf bank_mask:0xf
    v_mfma_f32_16x16x32_bf16 v[188:191], a[48:51], v[160:163], v[124:127]
    v_mul_f32_dpp v231, v71, v39 row_newbcast:6 row_mask:0xf bank_mask:0xf
    v_cvt_pk_bf16_f32 v155, v230, v231
    v_mfma_f32_16x16x32_bf16 v[188:191], a[52:55], v[164:167], v[188:191]
    v_cvt_pk_bf16_f32 v212, |v184|, |v185|
    v_cvt_pk_bf16_f32 v213, |v186|, |v187|
    v_mfma_f32_16x16x32_bf16 v[188:191], a[56:59], v[168:171], v[188:191]
    v_mul_f32_dpp v224, v72, v40 row_newbcast:6 row_mask:0xf bank_mask:0xf
    v_mul_f32_dpp v225, v73, v41 row_newbcast:6 row_mask:0xf bank_mask:0xf
    v_mfma_f32_16x16x32_bf16 v[188:191], a[60:63], v[172:175], v[188:191]
    v_cvt_pk_bf16_f32 v156, v224, v225
    v_mul_f32_dpp v226, v74, v42 row_newbcast:6 row_mask:0xf bank_mask:0xf
    v_smfmac_f32_16x16x64_bf16 v[248:251], a[136:139], v[144:151], v1
    v_mul_f32_dpp v227, v75, v43 row_newbcast:6 row_mask:0xf bank_mask:0xf
    v_cvt_pk_bf16_f32 v157, v226, v227
    v_mfma_f32_16x16x32_bf16 v[192:195], a[64:67], v[160:163], v[128:131]
    v_mul_f32_dpp v228, v76, v44 row_newbcast:6 row_mask:0xf bank_mask:0xf
    v_mul_f32_dpp v229, v77, v45 row_newbcast:6 row_mask:0xf bank_mask:0xf
    v_mfma_f32_16x16x32_bf16 v[192:195], a[68:71], v[164:167], v[192:195]
    v_cvt_pk_bf16_f32 v214, |v188|, |v189|
    v_cvt_pk_bf16_f32 v215, |v190|, |v191|
    v_mfma_f32_16x16x32_bf16 v[192:195], a[72:75], v[168:171], v[192:195]
    v_cvt_pk_bf16_f32 v158, v228, v229
    v_mul_f32_dpp v230, v78, v46 row_newbcast:6 row_mask:0xf bank_mask:0xf
    v_mfma_f32_16x16x32_bf16 v[192:195], a[76:79], v[172:175], v[192:195]
    v_mul_f32_dpp v231, v79, v47 row_newbcast:6 row_mask:0xf bank_mask:0xf
    v_cvt_pk_bf16_f32 v159, v230, v231
    v_smfmac_f32_16x16x64_bf16 v[244:247], a[176:179], v[208:215], v1
    v_mul_f32_dpp v224, v48, v16 row_newbcast:4 row_mask:0xf bank_mask:0xf
    v_mul_f32_dpp v225, v49, v17 row_newbcast:4 row_mask:0xf bank_mask:0xf
    v_mfma_f32_16x16x32_bf16 v[196:199], a[80:83], v[160:163], v[132:135]
    v_mul_f32_dpp v226, v50, v18 row_newbcast:4 row_mask:0xf bank_mask:0xf
    v_mul_f32_dpp v227, v51, v19 row_newbcast:4 row_mask:0xf bank_mask:0xf
    v_mfma_f32_16x16x32_bf16 v[196:199], a[84:87], v[164:167], v[196:199]
    v_cvt_pk_bf16_f32 v216, |v192|, |v193|
    v_cvt_pk_bf16_f32 v217, |v194|, |v195|
    v_mfma_f32_16x16x32_bf16 v[196:199], a[88:91], v[168:171], v[196:199]
    v_mul_f32_dpp v228, v52, v20 row_newbcast:4 row_mask:0xf bank_mask:0xf
    v_mul_f32_dpp v229, v53, v21 row_newbcast:4 row_mask:0xf bank_mask:0xf
    v_mfma_f32_16x16x32_bf16 v[196:199], a[92:95], v[172:175], v[196:199]
    v_mul_f32_dpp v230, v54, v22 row_newbcast:4 row_mask:0xf bank_mask:0xf
    v_mul_f32_dpp v231, v55, v23 row_newbcast:4 row_mask:0xf bank_mask:0xf
    v_smfmac_f32_16x16x64_bf16 v[248:251], a[140:143], v[152:159], v1
    s_waitcnt vmcnt(0)
    ds_read_b128 v[96:99], v6
    v_mfma_f32_16x16x32_bf16 v[200:203], a[96:99], v[160:163], v[136:139]
    ds_read_b128 v[100:103], v7
    ds_read_b128 v[104:107], v8
    v_mfma_f32_16x16x32_bf16 v[200:203], a[100:103], v[164:167], v[200:203]
    v_cvt_pk_bf16_f32 v218, |v196|, |v197|
    v_cvt_pk_bf16_f32 v219, |v198|, |v199|
    v_mfma_f32_16x16x32_bf16 v[200:203], a[104:107], v[168:171], v[200:203]
    ds_read_b128 v[108:111], v9
    v_add_f32 v232, v232, v233
    v_mfma_f32_16x16x32_bf16 v[200:203], a[108:111], v[172:175], v[200:203]
    v_add_f32 v234, v234, v235
    v_add_f32 v236, v236, v237
    v_mfma_f32_16x16x32_bf16 v[204:207], a[112:115], v[160:163], v[140:143]
    v_cvt_pk_bf16_f32 v160, v224, v225
    v_cvt_pk_bf16_f32 v161, v226, v227
    v_mfma_f32_16x16x32_bf16 v[204:207], a[116:119], v[164:167], v[204:207]
    v_cvt_pk_bf16_f32 v162, v228, v229
    v_cvt_pk_bf16_f32 v163, v230, v231
    v_mfma_f32_16x16x32_bf16 v[204:207], a[120:123], v[168:171], v[204:207]
    v_cvt_pk_bf16_f32 v220, |v200|, |v201|
    v_cvt_pk_bf16_f32 v221, |v202|, |v203|
    v_mfma_f32_16x16x32_bf16 v[204:207], a[124:127], v[172:175], v[204:207]
    v_mul_f32_dpp v224, v56, v24 row_newbcast:4 row_mask:0xf bank_mask:0xf
    v_mul_f32_dpp v225, v57, v25 row_newbcast:4 row_mask:0xf bank_mask:0xf
    v_mfma_f32_16x16x32_bf16 v[176:179], a[0:3], v[144:147], v[112:115]
    v_cvt_pk_bf16_f32 v164, v224, v225
    v_mul_f32_dpp v226, v58, v26 row_newbcast:4 row_mask:0xf bank_mask:0xf
    v_mfma_f32_16x16x32_bf16 v[176:179], a[4:7], v[148:151], v[176:179]
    v_mul_f32_dpp v227, v59, v27 row_newbcast:4 row_mask:0xf bank_mask:0xf
    v_cvt_pk_bf16_f32 v165, v226, v227
    v_mfma_f32_16x16x32_bf16 v[176:179], a[8:11], v[152:155], v[176:179]
    v_cvt_pk_bf16_f32 v222, |v204|, |v205|
    v_cvt_pk_bf16_f32 v223, |v206|, |v207|
    v_mfma_f32_16x16x32_bf16 v[176:179], a[12:15], v[156:159], v[176:179]
    v_mul_f32_dpp v228, v60, v28 row_newbcast:4 row_mask:0xf bank_mask:0xf
    v_mul_f32_dpp v229, v61, v29 row_newbcast:4 row_mask:0xf bank_mask:0xf
    v_smfmac_f32_16x16x64_bf16 v[244:247], a[180:183], v[216:223], v1
    v_cvt_pk_bf16_f32 v166, v228, v229
    v_mul_f32_dpp v230, v62, v30 row_newbcast:4 row_mask:0xf bank_mask:0xf
    v_mfma_f32_16x16x32_bf16 v[180:183], a[16:19], v[144:147], v[116:119]
    v_mul_f32_dpp v231, v63, v31 row_newbcast:4 row_mask:0xf bank_mask:0xf
    v_cvt_pk_bf16_f32 v167, v230, v231
    v_mfma_f32_16x16x32_bf16 v[180:183], a[20:23], v[148:151], v[180:183]
    v_cvt_pk_bf16_f32 v208, |v176|, |v177|
    v_cvt_pk_bf16_f32 v209, |v178|, |v179|
    v_mfma_f32_16x16x32_bf16 v[180:183], a[24:27], v[152:155], v[180:183]
    v_mul_f32_dpp v224, v64, v32 row_newbcast:4 row_mask:0xf bank_mask:0xf
    v_mul_f32_dpp v225, v65, v33 row_newbcast:4 row_mask:0xf bank_mask:0xf
    v_mfma_f32_16x16x32_bf16 v[180:183], a[28:31], v[156:159], v[180:183]
    v_cvt_pk_bf16_f32 v168, v224, v225
    v_mul_f32_dpp v226, v66, v34 row_newbcast:4 row_mask:0xf bank_mask:0xf
    v_mfma_f32_16x16x32_bf16 v[184:187], a[32:35], v[144:147], v[120:123]
    v_mul_f32_dpp v227, v67, v35 row_newbcast:4 row_mask:0xf bank_mask:0xf
    v_cvt_pk_bf16_f32 v169, v226, v227
    v_mfma_f32_16x16x32_bf16 v[184:187], a[36:39], v[148:151], v[184:187]
    v_mul_f32_dpp v228, v68, v36 row_newbcast:4 row_mask:0xf bank_mask:0xf
    v_mul_f32_dpp v229, v69, v37 row_newbcast:4 row_mask:0xf bank_mask:0xf
    v_mfma_f32_16x16x32_bf16 v[184:187], a[40:43], v[152:155], v[184:187]
    v_cvt_pk_bf16_f32 v210, |v180|, |v181|
    v_cvt_pk_bf16_f32 v211, |v182|, |v183|
    v_mfma_f32_16x16x32_bf16 v[184:187], a[44:47], v[156:159], v[184:187]
    v_cvt_pk_bf16_f32 v170, v228, v229
    v_mul_f32_dpp v230, v70, v38 row_newbcast:4 row_mask:0xf bank_mask:0xf
    v_mfma_f32_16x16x32_bf16 v[188:191], a[48:51], v[144:147], v[124:127]
    v_mul_f32_dpp v231, v71, v39 row_newbcast:4 row_mask:0xf bank_mask:0xf
    v_cvt_pk_bf16_f32 v171, v230, v231
    v_mfma_f32_16x16x32_bf16 v[188:191], a[52:55], v[148:151], v[188:191]
    v_mul_f32_dpp v224, v72, v40 row_newbcast:4 row_mask:0xf bank_mask:0xf
    v_mul_f32_dpp v225, v73, v41 row_newbcast:4 row_mask:0xf bank_mask:0xf
    v_mfma_f32_16x16x32_bf16 v[188:191], a[56:59], v[152:155], v[188:191]
    v_cvt_pk_bf16_f32 v212, |v184|, |v185|
    v_cvt_pk_bf16_f32 v213, |v186|, |v187|
    v_mfma_f32_16x16x32_bf16 v[188:191], a[60:63], v[156:159], v[188:191]
    v_cvt_pk_bf16_f32 v172, v224, v225
    v_mul_f32_dpp v226, v74, v42 row_newbcast:4 row_mask:0xf bank_mask:0xf
    v_mfma_f32_16x16x32_bf16 v[192:195], a[64:67], v[144:147], v[128:131]
    v_mul_f32_dpp v227, v75, v43 row_newbcast:4 row_mask:0xf bank_mask:0xf
    v_cvt_pk_bf16_f32 v173, v226, v227
    v_mfma_f32_16x16x32_bf16 v[192:195], a[68:71], v[148:151], v[192:195]
    v_mul_f32_dpp v228, v76, v44 row_newbcast:4 row_mask:0xf bank_mask:0xf
    v_mul_f32_dpp v229, v77, v45 row_newbcast:4 row_mask:0xf bank_mask:0xf
    v_mfma_f32_16x16x32_bf16 v[192:195], a[72:75], v[152:155], v[192:195]
    v_cvt_pk_bf16_f32 v214, |v188|, |v189|
    v_cvt_pk_bf16_f32 v215, |v190|, |v191|
    v_mfma_f32_16x16x32_bf16 v[192:195], a[76:79], v[156:159], v[192:195]
    v_cvt_pk_bf16_f32 v174, v228, v229
    v_mul_f32_dpp v230, v78, v46 row_newbcast:4 row_mask:0xf bank_mask:0xf
    v_smfmac_f32_16x16x64_bf16 v[248:251], a[128:131], v[208:215], v1
    v_mul_f32_dpp v231, v79, v47 row_newbcast:4 row_mask:0xf bank_mask:0xf
    v_cvt_pk_bf16_f32 v175, v230, v231
    v_mfma_f32_16x16x32_bf16 v[196:199], a[80:83], v[144:147], v[132:135]
    s_waitcnt lgkmcnt(0)
    v_lshlrev_b32 v80, 16, v96
    v_mfma_f32_16x16x32_bf16 v[196:199], a[84:87], v[148:151], v[196:199]
    v_cvt_pk_bf16_f32 v216, |v192|, |v193|
    v_cvt_pk_bf16_f32 v217, |v194|, |v195|
    v_mfma_f32_16x16x32_bf16 v[196:199], a[88:91], v[152:155], v[196:199]
    v_and_b32 v81, 0xffff0000, v96
    v_lshlrev_b32 v82, 16, v97
    v_mfma_f32_16x16x32_bf16 v[196:199], a[92:95], v[156:159], v[196:199]
    v_and_b32 v83, 0xffff0000, v97
    v_lshlrev_b32 v84, 16, v98
    v_mfma_f32_16x16x32_bf16 v[200:203], a[96:99], v[144:147], v[136:139]
    v_and_b32 v85, 0xffff0000, v98
    v_lshlrev_b32 v86, 16, v99
    v_mfma_f32_16x16x32_bf16 v[200:203], a[100:103], v[148:151], v[200:203]
    v_and_b32 v87, 0xffff0000, v99
    v_mul_f32_dpp v224, v80, v48 row_ror:13 row_mask:0xf bank_mask:0xf
    v_mfma_f32_16x16x32_bf16 v[200:203], a[104:107], v[152:155], v[200:203]
    v_cvt_pk_bf16_f32 v218, |v196|, |v197|
    v_cvt_pk_bf16_f32 v219, |v198|, |v199|
    v_mfma_f32_16x16x32_bf16 v[200:203], a[108:111], v[156:159], v[200:203]
    v_mul_f32_dpp v225, v81, v49 row_ror:13 row_mask:0xf bank_mask:0xf
    v_mul_f32_dpp v226, v82, v50 row_ror:13 row_mask:0xf bank_mask:0xf
    v_mfma_f32_16x16x32_bf16 v[204:207], a[112:115], v[144:147], v[140:143]
    v_cvt_pk_bf16_f32 v144, v224, v225
    v_mul_f32_dpp v227, v83, v51 row_ror:13 row_mask:0xf bank_mask:0xf
    v_mfma_f32_16x16x32_bf16 v[204:207], a[116:119], v[148:151], v[204:207]
    v_cvt_pk_bf16_f32 v145, v226, v227
    v_mul_f32_dpp v228, v84, v52 row_ror:13 row_mask:0xf bank_mask:0xf
    v_mfma_f32_16x16x32_bf16 v[204:207], a[120:123], v[152:155], v[204:207]
    v_cvt_pk_bf16_f32 v220, |v200|, |v201|
    v_cvt_pk_bf16_f32 v221, |v202|, |v203|
    v_mfma_f32_16x16x32_bf16 v[204:207], a[124:127], v[156:159], v[204:207]
    v_mul_f32_dpp v229, v85, v53 row_ror:13 row_mask:0xf bank_mask:0xf
    v_cvt_pk_bf16_f32 v146, v228, v229
    v_mfma_f32_16x16x32_bf16 v[176:179], a[0:3], v[160:163], v[112:115]
    v_mul_f32_dpp v230, v86, v54 row_ror:13 row_mask:0xf bank_mask:0xf
    v_mul_f32_dpp v231, v87, v55 row_ror:13 row_mask:0xf bank_mask:0xf
    v_mfma_f32_16x16x32_bf16 v[176:179], a[4:7], v[164:167], v[176:179]
    v_cvt_pk_bf16_f32 v147, v230, v231
    v_lshlrev_b32 v88, 16, v100
    v_mfma_f32_16x16x32_bf16 v[176:179], a[8:11], v[168:171], v[176:179]
    v_cvt_pk_bf16_f32 v222, |v204|, |v205|
    v_cvt_pk_bf16_f32 v223, |v206|, |v207|
    v_mfma_f32_16x16x32_bf16 v[176:179], a[12:15], v[172:175], v[176:179]
    v_and_b32 v89, 0xffff0000, v100
    v_lshlrev_b32 v90, 16, v101
    v_smfmac_f32_16x16x64_bf16 v[248:251], a[132:135], v[216:223], v1
    v_and_b32 v91, 0xffff0000, v101
    v_lshlrev_b32 v92, 16, v102
    v_mfma_f32_16x16x32_bf16 v[180:183], a[16:19], v[160:163], v[116:119]
    v_and_b32 v93, 0xffff0000, v102
    v_lshlrev_b32 v94, 16, v103
    v_mfma_f32_16x16x32_bf16 v[180:183], a[20:23], v[164:167], v[180:183]
    v_cvt_pk_bf16_f32 v208, |v176|, |v177|
    v_cvt_pk_bf16_f32 v209, |v178|, |v179|
    v_mfma_f32_16x16x32_bf16 v[180:183], a[24:27], v[168:171], v[180:183]
    v_and_b32 v95, 0xffff0000, v103
    v_mul_f32_dpp v224, v88, v56 row_ror:13 row_mask:0xf bank_mask:0xf
    v_mfma_f32_16x16x32_bf16 v[180:183], a[28:31], v[172:175], v[180:183]
    v_mul_f32_dpp v225, v89, v57 row_ror:13 row_mask:0xf bank_mask:0xf
    v_cvt_pk_bf16_f32 v148, v224, v225
    v_smfmac_f32_16x16x64_bf16 v[248:251], a[152:155], v[160:167], v1
    v_mul_f32_dpp v226, v90, v58 row_ror:13 row_mask:0xf bank_mask:0xf
    v_mul_f32_dpp v227, v91, v59 row_ror:13 row_mask:0xf bank_mask:0xf
    v_mfma_f32_16x16x32_bf16 v[184:187], a[32:35], v[160:163], v[120:123]
    v_cvt_pk_bf16_f32 v149, v226, v227
    v_mul_f32_dpp v228, v92, v60 row_ror:13 row_mask:0xf bank_mask:0xf
    v_mfma_f32_16x16x32_bf16 v[184:187], a[36:39], v[164:167], v[184:187]
    v_cvt_pk_bf16_f32 v210, |v180|, |v181|
    v_cvt_pk_bf16_f32 v211, |v182|, |v183|
    v_mfma_f32_16x16x32_bf16 v[184:187], a[40:43], v[168:171], v[184:187]
    v_mul_f32_dpp v229, v93, v61 row_ror:13 row_mask:0xf bank_mask:0xf
    v_cvt_pk_bf16_f32 v150, v228, v229
    v_mfma_f32_16x16x32_bf16 v[184:187], a[44:47], v[172:175], v[184:187]
    v_mul_f32_dpp v230, v94, v62 row_ror:13 row_mask:0xf bank_mask:0xf
    v_mul_f32_dpp v231, v95, v63 row_ror:13 row_mask:0xf bank_mask:0xf
    v_smfmac_f32_16x16x64_bf16 v[248:251], a[156:159], v[168:175], v1
    v_cvt_pk_bf16_f32 v151, v230, v231
    v_lshlrev_b32 v96, 16, v104
    v_mfma_f32_16x16x32_bf16 v[188:191], a[48:51], v[160:163], v[124:127]
    v_and_b32 v97, 0xffff0000, v104
    v_lshlrev_b32 v98, 16, v105
    v_mfma_f32_16x16x32_bf16 v[188:191], a[52:55], v[164:167], v[188:191]
    v_cvt_pk_bf16_f32 v212, |v184|, |v185|
    v_cvt_pk_bf16_f32 v213, |v186|, |v187|
    v_mfma_f32_16x16x32_bf16 v[188:191], a[56:59], v[168:171], v[188:191]
    v_and_b32 v99, 0xffff0000, v105
    v_lshlrev_b32 v100, 16, v106
    v_mfma_f32_16x16x32_bf16 v[188:191], a[60:63], v[172:175], v[188:191]
    v_and_b32 v101, 0xffff0000, v106
    v_lshlrev_b32 v102, 16, v107
    v_mfma_f32_16x16x32_bf16 v[192:195], a[64:67], v[160:163], v[128:131]
    v_and_b32 v103, 0xffff0000, v107
    v_mul_f32_dpp v224, v96, v64 row_ror:13 row_mask:0xf bank_mask:0xf
    v_mfma_f32_16x16x32_bf16 v[192:195], a[68:71], v[164:167], v[192:195]
    v_mul_f32_dpp v225, v97, v65 row_ror:13 row_mask:0xf bank_mask:0xf
    v_cvt_pk_bf16_f32 v152, v224, v225
    v_mfma_f32_16x16x32_bf16 v[192:195], a[72:75], v[168:171], v[192:195]
    v_cvt_pk_bf16_f32 v214, |v188|, |v189|
    v_cvt_pk_bf16_f32 v215, |v190|, |v191|
    v_mfma_f32_16x16x32_bf16 v[192:195], a[76:79], v[172:175], v[192:195]
    v_mul_f32_dpp v226, v98, v66 row_ror:13 row_mask:0xf bank_mask:0xf
    v_mul_f32_dpp v227, v99, v67 row_ror:13 row_mask:0xf bank_mask:0xf
    v_smfmac_f32_16x16x64_bf16 v[248:251], a[144:147], v[208:215], v1
    v_cvt_pk_bf16_f32 v153, v226, v227
    v_mul_f32_dpp v228, v100, v68 row_ror:13 row_mask:0xf bank_mask:0xf
    v_mfma_f32_16x16x32_bf16 v[196:199], a[80:83], v[160:163], v[132:135]
    v_mul_f32_dpp v229, v101, v69 row_ror:13 row_mask:0xf bank_mask:0xf
    v_cvt_pk_bf16_f32 v154, v228, v229
    v_mfma_f32_16x16x32_bf16 v[196:199], a[84:87], v[164:167], v[196:199]
    v_cvt_pk_bf16_f32 v216, |v192|, |v193|
    v_cvt_pk_bf16_f32 v217, |v194|, |v195|
    v_mfma_f32_16x16x32_bf16 v[196:199], a[88:91], v[168:171], v[196:199]
    v_mul_f32_dpp v230, v102, v70 row_ror:13 row_mask:0xf bank_mask:0xf
    v_mul_f32_dpp v231, v103, v71 row_ror:13 row_mask:0xf bank_mask:0xf
    v_mfma_f32_16x16x32_bf16 v[196:199], a[92:95], v[172:175], v[196:199]
    v_cvt_pk_bf16_f32 v155, v230, v231
    v_lshlrev_b32 v104, 16, v108
    v_mfma_f32_16x16x32_bf16 v[200:203], a[96:99], v[160:163], v[136:139]
    v_and_b32 v105, 0xffff0000, v108
    v_lshlrev_b32 v106, 16, v109
    v_mfma_f32_16x16x32_bf16 v[200:203], a[100:103], v[164:167], v[200:203]
    v_and_b32 v107, 0xffff0000, v109
    v_lshlrev_b32 v108, 16, v110
    v_mfma_f32_16x16x32_bf16 v[200:203], a[104:107], v[168:171], v[200:203]
    v_cvt_pk_bf16_f32 v218, |v196|, |v197|
    v_cvt_pk_bf16_f32 v219, |v198|, |v199|
    v_mfma_f32_16x16x32_bf16 v[200:203], a[108:111], v[172:175], v[200:203]
    v_and_b32 v109, 0xffff0000, v110
    v_lshlrev_b32 v110, 16, v111
    v_mfma_f32_16x16x32_bf16 v[204:207], a[112:115], v[160:163], v[140:143]
    v_and_b32 v111, 0xffff0000, v111
    v_mul_f32_dpp v224, v104, v72 row_ror:13 row_mask:0xf bank_mask:0xf
    v_mfma_f32_16x16x32_bf16 v[204:207], a[116:119], v[164:167], v[204:207]
    v_mul_f32_dpp v225, v105, v73 row_ror:13 row_mask:0xf bank_mask:0xf
    v_cvt_pk_bf16_f32 v156, v224, v225
    v_mfma_f32_16x16x32_bf16 v[204:207], a[120:123], v[168:171], v[204:207]
    v_cvt_pk_bf16_f32 v220, |v200|, |v201|
    v_cvt_pk_bf16_f32 v221, |v202|, |v203|
    v_mfma_f32_16x16x32_bf16 v[204:207], a[124:127], v[172:175], v[204:207]
    v_mul_f32_dpp v226, v106, v74 row_ror:13 row_mask:0xf bank_mask:0xf
    v_mul_f32_dpp v227, v107, v75 row_ror:13 row_mask:0xf bank_mask:0xf
    v_mfma_f32_16x16x32_bf16 v[176:179], a[0:3], v[144:147], v[112:115]
    v_cvt_pk_bf16_f32 v157, v226, v227
    v_mul_f32_dpp v228, v108, v76 row_ror:13 row_mask:0xf bank_mask:0xf
    v_mfma_f32_16x16x32_bf16 v[176:179], a[4:7], v[148:151], v[176:179]
    v_mul_f32_dpp v229, v109, v77 row_ror:13 row_mask:0xf bank_mask:0xf
    v_cvt_pk_bf16_f32 v158, v228, v229
    v_mfma_f32_16x16x32_bf16 v[176:179], a[8:11], v[152:155], v[176:179]
    v_cvt_pk_bf16_f32 v222, |v204|, |v205|
    v_cvt_pk_bf16_f32 v223, |v206|, |v207|
    v_mfma_f32_16x16x32_bf16 v[180:183], a[16:19], v[144:147], v[116:119]
    v_mul_f32_dpp v230, v110, v78 row_ror:13 row_mask:0xf bank_mask:0xf
    v_mul_f32_dpp v231, v111, v79 row_ror:13 row_mask:0xf bank_mask:0xf
    v_mfma_f32_16x16x32_bf16 v[180:183], a[20:23], v[148:151], v[180:183]
    v_cvt_pk_bf16_f32 v159, v230, v231
    v_mul_f32_dpp v224, v80, v48 row_ror:5 row_mask:0xf bank_mask:0xf
    v_mfma_f32_16x16x32_bf16 v[180:183], a[24:27], v[152:155], v[180:183]
    v_mul_f32_dpp v225, v81, v49 row_ror:5 row_mask:0xf bank_mask:0xf
    v_cvt_pk_bf16_f32 v160, v224, v225
    v_mfma_f32_16x16x32_bf16 v[180:183], a[28:31], v[156:159], v[180:183]
    v_mul_f32_dpp v226, v82, v50 row_ror:5 row_mask:0xf bank_mask:0xf
    v_mul_f32_dpp v227, v83, v51 row_ror:5 row_mask:0xf bank_mask:0xf
    v_smfmac_f32_16x16x64_bf16 v[248:251], a[148:151], v[216:223], v1
    v_cvt_pk_bf16_f32 v161, v226, v227
    v_mul_f32_dpp v228, v84, v52 row_ror:5 row_mask:0xf bank_mask:0xf
    v_mfma_f32_16x16x32_bf16 v[176:179], a[12:15], v[156:159], v[176:179]
    v_mul_f32_dpp v229, v85, v53 row_ror:5 row_mask:0xf bank_mask:0xf
    v_cvt_pk_bf16_f32 v162, v228, v229
    v_smfmac_f32_16x16x64_bf16 v[248:251], a[168:171], v[144:151], v1
    v_mul_f32_dpp v230, v86, v54 row_ror:5 row_mask:0xf bank_mask:0xf
    v_mul_f32_dpp v231, v87, v55 row_ror:5 row_mask:0xf bank_mask:0xf
    v_mfma_f32_16x16x32_bf16 v[184:187], a[32:35], v[144:147], v[120:123]
    v_cvt_pk_bf16_f32 v163, v230, v231
    v_cvt_pk_bf16_f32 v210, |v180|, |v181|
    v_mfma_f32_16x16x32_bf16 v[184:187], a[36:39], v[148:151], v[184:187]
    v_cvt_pk_bf16_f32 v208, |v176|, |v177|
    v_cvt_pk_bf16_f32 v209, |v178|, |v179|
    v_mfma_f32_16x16x32_bf16 v[184:187], a[40:43], v[152:155], v[184:187]
    v_cvt_pk_bf16_f32 v211, |v182|, |v183|
    v_mul_f32_dpp v224, v88, v56 row_ror:5 row_mask:0xf bank_mask:0xf
    v_mfma_f32_16x16x32_bf16 v[184:187], a[44:47], v[156:159], v[184:187]
    v_mul_f32_dpp v225, v89, v57 row_ror:5 row_mask:0xf bank_mask:0xf
    v_cvt_pk_bf16_f32 v164, v224, v225
    v_smfmac_f32_16x16x64_bf16 v[248:251], a[172:175], v[152:159], v1
    v_mul_f32_dpp v226, v90, v58 row_ror:5 row_mask:0xf bank_mask:0xf
    v_mul_f32_dpp v227, v91, v59 row_ror:5 row_mask:0xf bank_mask:0xf
    v_mfma_f32_16x16x32_bf16 v[188:191], a[48:51], v[144:147], v[124:127]
    v_cvt_pk_bf16_f32 v165, v226, v227
    v_mul_f32_dpp v228, v92, v60 row_ror:5 row_mask:0xf bank_mask:0xf
    v_mfma_f32_16x16x32_bf16 v[188:191], a[52:55], v[148:151], v[188:191]
    v_cvt_pk_bf16_f32 v212, |v184|, |v185|
    v_cvt_pk_bf16_f32 v213, |v186|, |v187|
    v_mfma_f32_16x16x32_bf16 v[188:191], a[56:59], v[152:155], v[188:191]
    v_mul_f32_dpp v229, v93, v61 row_ror:5 row_mask:0xf bank_mask:0xf
    v_cvt_pk_bf16_f32 v166, v228, v229
    v_mfma_f32_16x16x32_bf16 v[188:191], a[60:63], v[156:159], v[188:191]
    v_mul_f32_dpp v230, v94, v62 row_ror:5 row_mask:0xf bank_mask:0xf
    v_mul_f32_dpp v231, v95, v63 row_ror:5 row_mask:0xf bank_mask:0xf
    v_mfma_f32_16x16x32_bf16 v[192:195], a[64:67], v[144:147], v[128:131]
    v_cvt_pk_bf16_f32 v167, v230, v231
    v_mul_f32_dpp v224, v96, v64 row_ror:5 row_mask:0xf bank_mask:0xf
    v_mfma_f32_16x16x32_bf16 v[192:195], a[68:71], v[148:151], v[192:195]
    v_mul_f32_dpp v225, v97, v65 row_ror:5 row_mask:0xf bank_mask:0xf
    v_cvt_pk_bf16_f32 v168, v224, v225
    v_mfma_f32_16x16x32_bf16 v[192:195], a[72:75], v[152:155], v[192:195]
    v_cvt_pk_bf16_f32 v214, |v188|, |v189|
    v_cvt_pk_bf16_f32 v215, |v190|, |v191|
    v_mfma_f32_16x16x32_bf16 v[192:195], a[76:79], v[156:159], v[192:195]
    v_mul_f32_dpp v226, v98, v66 row_ror:5 row_mask:0xf bank_mask:0xf
    v_mul_f32_dpp v227, v99, v67 row_ror:5 row_mask:0xf bank_mask:0xf
    v_smfmac_f32_16x16x64_bf16 v[248:251], a[160:163], v[208:215], v1
    v_cvt_pk_bf16_f32 v169, v226, v227
    v_mul_f32_dpp v228, v100, v68 row_ror:5 row_mask:0xf bank_mask:0xf
    v_mfma_f32_16x16x32_bf16 v[196:199], a[80:83], v[144:147], v[132:135]
    v_mul_f32_dpp v229, v101, v69 row_ror:5 row_mask:0xf bank_mask:0xf
    v_cvt_pk_bf16_f32 v170, v228, v229
    v_mfma_f32_16x16x32_bf16 v[196:199], a[84:87], v[148:151], v[196:199]
    v_cvt_pk_bf16_f32 v216, |v192|, |v193|
    v_cvt_pk_bf16_f32 v217, |v194|, |v195|
    v_mfma_f32_16x16x32_bf16 v[196:199], a[88:91], v[152:155], v[196:199]
    v_mul_f32_dpp v230, v102, v70 row_ror:5 row_mask:0xf bank_mask:0xf
    v_mul_f32_dpp v231, v103, v71 row_ror:5 row_mask:0xf bank_mask:0xf
    v_mfma_f32_16x16x32_bf16 v[196:199], a[92:95], v[156:159], v[196:199]
    v_cvt_pk_bf16_f32 v171, v230, v231
    v_mul_f32_dpp v224, v104, v72 row_ror:5 row_mask:0xf bank_mask:0xf
    v_mfma_f32_16x16x32_bf16 v[200:203], a[96:99], v[144:147], v[136:139]
    v_mul_f32_dpp v225, v105, v73 row_ror:5 row_mask:0xf bank_mask:0xf
    v_cvt_pk_bf16_f32 v172, v224, v225
    v_mfma_f32_16x16x32_bf16 v[200:203], a[100:103], v[148:151], v[200:203]
    v_mul_f32_dpp v226, v106, v74 row_ror:5 row_mask:0xf bank_mask:0xf
    v_mul_f32_dpp v227, v107, v75 row_ror:5 row_mask:0xf bank_mask:0xf
    v_mfma_f32_16x16x32_bf16 v[200:203], a[104:107], v[152:155], v[200:203]
    v_cvt_pk_bf16_f32 v218, |v196|, |v197|
    v_cvt_pk_bf16_f32 v219, |v198|, |v199|
    v_mfma_f32_16x16x32_bf16 v[200:203], a[108:111], v[156:159], v[200:203]
    v_cvt_pk_bf16_f32 v173, v226, v227
    v_mul_f32_dpp v228, v108, v76 row_ror:5 row_mask:0xf bank_mask:0xf
    v_mfma_f32_16x16x32_bf16 v[204:207], a[112:115], v[144:147], v[140:143]
    v_mul_f32_dpp v229, v109, v77 row_ror:5 row_mask:0xf bank_mask:0xf
    v_cvt_pk_bf16_f32 v174, v228, v229
    v_mfma_f32_16x16x32_bf16 v[204:207], a[116:119], v[148:151], v[204:207]
    v_mul_f32_dpp v230, v110, v78 row_ror:5 row_mask:0xf bank_mask:0xf
    v_mul_f32_dpp v231, v111, v79 row_ror:5 row_mask:0xf bank_mask:0xf
    v_mfma_f32_16x16x32_bf16 v[204:207], a[120:123], v[152:155], v[204:207]
    v_cvt_pk_bf16_f32 v220, |v200|, |v201|
    v_cvt_pk_bf16_f32 v221, |v202|, |v203|
    v_mfma_f32_16x16x32_bf16 v[204:207], a[124:127], v[156:159], v[204:207]
    v_cvt_pk_bf16_f32 v175, v230, v231
    v_mul_f32 v224, v80, v48
    v_mfma_f32_16x16x32_bf16 v[176:179], a[0:3], v[160:163], v[112:115]
    v_mul_f32 v225, v81, v49
    v_cvt_pk_bf16_f32 v144, v224, v225
    v_mfma_f32_16x16x32_bf16 v[176:179], a[4:7], v[164:167], v[176:179]
    v_mul_f32 v226, v82, v50
    v_mul_f32 v227, v83, v51
    v_mfma_f32_16x16x32_bf16 v[176:179], a[8:11], v[168:171], v[176:179]
    v_cvt_pk_bf16_f32 v222, |v204|, |v205|
    v_cvt_pk_bf16_f32 v223, |v206|, |v207|
    v_mfma_f32_16x16x32_bf16 v[176:179], a[12:15], v[172:175], v[176:179]
    v_cvt_pk_bf16_f32 v145, v226, v227
    v_mul_f32 v228, v84, v52
    v_smfmac_f32_16x16x64_bf16 v[248:251], a[164:167], v[216:223], v1
    v_mul_f32 v229, v85, v53
    v_cvt_pk_bf16_f32 v146, v228, v229
    v_mfma_f32_16x16x32_bf16 v[180:183], a[16:19], v[160:163], v[116:119]
    v_mul_f32 v230, v86, v54
    v_mul_f32 v231, v87, v55
    v_mfma_f32_16x16x32_bf16 v[180:183], a[20:23], v[164:167], v[180:183]
    v_cvt_pk_bf16_f32 v208, |v176|, |v177|
    v_cvt_pk_bf16_f32 v209, |v178|, |v179|
    v_mfma_f32_16x16x32_bf16 v[180:183], a[24:27], v[168:171], v[180:183]
    v_cvt_pk_bf16_f32 v147, v230, v231
    v_mul_f32 v224, v88, v56
    v_mfma_f32_16x16x32_bf16 v[180:183], a[28:31], v[172:175], v[180:183]
    v_mul_f32 v225, v89, v57
    v_cvt_pk_bf16_f32 v148, v224, v225
    v_smfmac_f32_16x16x64_bf16 v[248:251], a[184:187], v[160:167], v1
    v_mul_f32 v226, v90, v58
    v_mul_f32 v227, v91, v59
    v_mfma_f32_16x16x32_bf16 v[184:187], a[32:35], v[160:163], v[120:123]
    v_cvt_pk_bf16_f32 v149, v226, v227
    v_mul_f32 v228, v92, v60
    v_mfma_f32_16x16x32_bf16 v[184:187], a[36:39], v[164:167], v[184:187]
    v_cvt_pk_bf16_f32 v210, |v180|, |v181|
    v_cvt_pk_bf16_f32 v211, |v182|, |v183|
    v_mfma_f32_16x16x32_bf16 v[184:187], a[40:43], v[168:171], v[184:187]
    v_mul_f32 v229, v93, v61
    v_cvt_pk_bf16_f32 v150, v228, v229
    v_mfma_f32_16x16x32_bf16 v[184:187], a[44:47], v[172:175], v[184:187]
    v_mul_f32 v230, v94, v62
    v_mul_f32 v231, v95, v63
    v_smfmac_f32_16x16x64_bf16 v[248:251], a[188:191], v[168:175], v1
    v_cvt_pk_bf16_f32 v151, v230, v231
    v_mul_f32 v224, v96, v64
    v_mfma_f32_16x16x32_bf16 v[188:191], a[48:51], v[160:163], v[124:127]
    v_mul_f32 v225, v97, v65
    v_cvt_pk_bf16_f32 v152, v224, v225
    v_mfma_f32_16x16x32_bf16 v[188:191], a[52:55], v[164:167], v[188:191]
    v_cvt_pk_bf16_f32 v212, |v184|, |v185|
    v_cvt_pk_bf16_f32 v213, |v186|, |v187|
    v_mfma_f32_16x16x32_bf16 v[188:191], a[56:59], v[168:171], v[188:191]
    v_mul_f32 v226, v98, v66
    v_mul_f32 v227, v99, v67
    v_mfma_f32_16x16x32_bf16 v[188:191], a[60:63], v[172:175], v[188:191]
    v_cvt_pk_bf16_f32 v153, v226, v227
    v_mul_f32 v228, v100, v68
    v_smfmac_f32_16x16x64_bf16 v[252:255], a[136:139], v[144:151], v1
    v_mul_f32 v229, v101, v69
    v_cvt_pk_bf16_f32 v154, v228, v229
    v_mfma_f32_16x16x32_bf16 v[192:195], a[64:67], v[160:163], v[128:131]
    v_mul_f32 v230, v102, v70
    v_mul_f32 v231, v103, v71
    v_mfma_f32_16x16x32_bf16 v[192:195], a[68:71], v[164:167], v[192:195]
    v_cvt_pk_bf16_f32 v214, |v188|, |v189|
    v_cvt_pk_bf16_f32 v215, |v190|, |v191|
    v_mfma_f32_16x16x32_bf16 v[192:195], a[72:75], v[168:171], v[192:195]
    v_cvt_pk_bf16_f32 v155, v230, v231
    v_mul_f32 v224, v104, v72
    v_mfma_f32_16x16x32_bf16 v[192:195], a[76:79], v[172:175], v[192:195]
    v_mul_f32 v225, v105, v73
    v_cvt_pk_bf16_f32 v156, v224, v225
    v_smfmac_f32_16x16x64_bf16 v[248:251], a[176:179], v[208:215], v1
    v_mul_f32 v226, v106, v74
    v_mul_f32 v227, v107, v75
    v_mfma_f32_16x16x32_bf16 v[196:199], a[80:83], v[160:163], v[132:135]
    v_cvt_pk_bf16_f32 v157, v226, v227
    v_mul_f32 v228, v108, v76
    v_mfma_f32_16x16x32_bf16 v[196:199], a[84:87], v[164:167], v[196:199]
    v_cvt_pk_bf16_f32 v216, |v192|, |v193|
    v_cvt_pk_bf16_f32 v217, |v194|, |v195|
    v_mfma_f32_16x16x32_bf16 v[196:199], a[88:91], v[168:171], v[196:199]
    v_mul_f32 v229, v109, v77
    v_cvt_pk_bf16_f32 v158, v228, v229
    v_mfma_f32_16x16x32_bf16 v[196:199], a[92:95], v[172:175], v[196:199]
    v_mul_f32 v230, v110, v78
    v_mul_f32 v231, v111, v79
    v_mfma_f32_16x16x32_bf16 v[200:203], a[96:99], v[160:163], v[136:139]
    v_cvt_pk_bf16_f32 v159, v230, v231
    v_add_f32 v238, v238, v239
    v_mfma_f32_16x16x32_bf16 v[200:203], a[100:103], v[164:167], v[200:203]
    v_add_f32 v240, v240, v241
    v_add_f32 v242, v242, v243
    v_mfma_f32_16x16x32_bf16 v[200:203], a[104:107], v[168:171], v[200:203]
    v_cvt_pk_bf16_f32 v218, |v196|, |v197|
    v_cvt_pk_bf16_f32 v219, |v198|, |v199|
    v_mfma_f32_16x16x32_bf16 v[200:203], a[108:111], v[172:175], v[200:203]
    v_max3_f32 v12, v232, v236, v240
    v_add_f32 v244, v244, v245
    v_smfmac_f32_16x16x64_bf16 v[252:255], a[140:143], v[152:159], v1
    v_add_f32 v246, v246, v247
    v_mfma_f32_16x16x32_bf16 v[204:207], a[112:115], v[160:163], v[140:143]
    v_mfma_f32_16x16x32_bf16 v[204:207], a[116:119], v[164:167], v[204:207]
    v_mfma_f32_16x16x32_bf16 v[204:207], a[120:123], v[168:171], v[204:207]
    v_mfma_f32_16x16x32_bf16 v[204:207], a[124:127], v[172:175], v[204:207]
    v_cvt_pk_bf16_f32 v220, |v200|, |v201|
    v_cvt_pk_bf16_f32 v221, |v202|, |v203|
    v_mfma_f32_16x16x32_bf16 v[176:179], a[0:3], v[144:147], v[112:115]
    v_mfma_f32_16x16x32_bf16 v[176:179], a[4:7], v[148:151], v[176:179]
    v_mfma_f32_16x16x32_bf16 v[176:179], a[8:11], v[152:155], v[176:179]
    v_mfma_f32_16x16x32_bf16 v[176:179], a[12:15], v[156:159], v[176:179]
    v_mfma_f32_16x16x32_bf16 v[180:183], a[16:19], v[144:147], v[116:119]
    v_mfma_f32_16x16x32_bf16 v[180:183], a[20:23], v[148:151], v[180:183]
    v_cvt_pk_bf16_f32 v222, |v204|, |v205|
    v_cvt_pk_bf16_f32 v223, |v206|, |v207|
    v_mfma_f32_16x16x32_bf16 v[180:183], a[24:27], v[152:155], v[180:183]
    v_mfma_f32_16x16x32_bf16 v[180:183], a[28:31], v[156:159], v[180:183]
    v_smfmac_f32_16x16x64_bf16 v[248:251], a[180:183], v[216:223], v1
    v_mfma_f32_16x16x32_bf16 v[184:187], a[32:35], v[144:147], v[120:123]
    v_cvt_pk_bf16_f32 v208, |v176|, |v177|
    v_cvt_pk_bf16_f32 v209, |v178|, |v179|
    v_mfma_f32_16x16x32_bf16 v[184:187], a[36:39], v[148:151], v[184:187]
    v_mfma_f32_16x16x32_bf16 v[184:187], a[40:43], v[152:155], v[184:187]
    v_mfma_f32_16x16x32_bf16 v[184:187], a[44:47], v[156:159], v[184:187]
    v_mfma_f32_16x16x32_bf16 v[188:191], a[48:51], v[144:147], v[124:127]
    v_cvt_pk_bf16_f32 v210, |v180|, |v181|
    v_cvt_pk_bf16_f32 v211, |v182|, |v183|
    v_mfma_f32_16x16x32_bf16 v[188:191], a[52:55], v[148:151], v[188:191]
    v_add_f32 v248, v248, v249
    v_add_f32 v250, v250, v251
    v_mfma_f32_16x16x32_bf16 v[188:191], a[56:59], v[152:155], v[188:191]
    v_max3_f32 v12, v12, v244, v248
    v_cvt_pk_bf16_f32 v212, |v184|, |v185|
    v_mfma_f32_16x16x32_bf16 v[188:191], a[60:63], v[156:159], v[188:191]
    v_cvt_pk_bf16_f32 v213, |v186|, |v187|
    v_mfma_f32_16x16x32_bf16 v[192:195], a[64:67], v[144:147], v[128:131]
    v_mfma_f32_16x16x32_bf16 v[192:195], a[68:71], v[148:151], v[192:195]
    v_mfma_f32_16x16x32_bf16 v[192:195], a[72:75], v[152:155], v[192:195]
    v_mfma_f32_16x16x32_bf16 v[192:195], a[76:79], v[156:159], v[192:195]
    v_mfma_f32_16x16x32_bf16 v[196:199], a[80:83], v[144:147], v[132:135]
    v_mfma_f32_16x16x32_bf16 v[196:199], a[84:87], v[148:151], v[196:199]
    v_mfma_f32_16x16x32_bf16 v[196:199], a[88:91], v[152:155], v[196:199]
    v_cvt_pk_bf16_f32 v214, |v188|, |v189|
    v_cvt_pk_bf16_f32 v215, |v190|, |v191|
    v_mfma_f32_16x16x32_bf16 v[196:199], a[92:95], v[156:159], v[196:199]
    v_mfma_f32_16x16x32_bf16 v[200:203], a[96:99], v[144:147], v[136:139]
    v_mfma_f32_16x16x32_bf16 v[200:203], a[100:103], v[148:151], v[200:203]
    v_cvt_pk_bf16_f32 v216, |v192|, |v193|
    v_cvt_pk_bf16_f32 v217, |v194|, |v195|
    v_mfma_f32_16x16x32_bf16 v[200:203], a[104:107], v[152:155], v[200:203]
    v_mfma_f32_16x16x32_bf16 v[200:203], a[108:111], v[156:159], v[200:203]
    v_smfmac_f32_16x16x64_bf16 v[252:255], a[128:131], v[208:215], v1
    v_mfma_f32_16x16x32_bf16 v[204:207], a[112:115], v[144:147], v[140:143]
    v_cvt_pk_bf16_f32 v218, |v196|, |v197|
    v_cvt_pk_bf16_f32 v219, |v198|, |v199|
    v_mfma_f32_16x16x32_bf16 v[204:207], a[116:119], v[148:151], v[204:207]
    v_mfma_f32_16x16x32_bf16 v[204:207], a[120:123], v[152:155], v[204:207]
    v_mfma_f32_16x16x32_bf16 v[204:207], a[124:127], v[156:159], v[204:207]
    s_nop 0
    v_cvt_pk_bf16_f32 v220, |v200|, |v201|
    v_cvt_pk_bf16_f32 v221, |v202|, |v203|
    s_nop 4
    v_cvt_pk_bf16_f32 v222, |v204|, |v205|
    v_cvt_pk_bf16_f32 v223, |v206|, |v207|
    s_nop 1
    v_smfmac_f32_16x16x64_bf16 v[252:255], a[132:135], v[216:223], v1
    s_nop 7
    v_add_f32 v252, v252, v253
    v_add_f32 v254, v254, v255
    v_max_f32 v12, v12, v252
    s_nop 1
    v_max_f32_dpp v12, v12, v12 row_ror:8 row_mask:0xf bank_mask:0xf
    s_nop 1
    v_max_f32_dpp v12, v12, v12 row_ror:4 row_mask:0xf bank_mask:0xf
    s_nop 1
    v_max_f32_dpp v12, v12, v12 row_ror:2 row_mask:0xf bank_mask:0xf
    s_nop 1
    v_max_f32_dpp v12, v12, v12 row_ror:1 row_mask:0xf bank_mask:0xf
    s_nop 1
    v_max_f32_dpp v12, v12, v12 row_bcast:15 row_mask:0xa bank_mask:0xf
    s_nop 1
    v_max_f32_dpp v12, v12, v12 row_bcast:31 row_mask:0xc bank_mask:0xf
    s_nop 0
    v_readlane_b32 s14, v12, 63
    s_nop 1
    v_mul_f32 v13, s14, v10
    v_fma_f32 v232, v232, v10, -v13
    v_fma_f32 v236, v236, v10, -v13
    v_fma_f32 v240, v240, v10, -v13
    v_fma_f32 v244, v244, v10, -v13
    v_fma_f32 v248, v248, v10, -v13
    v_fma_f32 v252, v252, v10, -v13
    v_exp_f32 v232, v232
    v_exp_f32 v236, v236
    v_exp_f32 v240, v240
    v_exp_f32 v244, v244
    v_exp_f32 v248, v248
    v_exp_f32 v252, v252
    v_add_f32 v14, v232, v236
    v_mul_f32 v15, v232, v234
    v_fmac_f32 v15, v236, v238
    v_add_f32 v14, v14, v240
    v_fmac_f32 v15, v240, v242
    v_add_f32 v14, v14, v244
    v_fmac_f32 v15, v244, v246
    v_add_f32 v14, v14, v248
    v_fmac_f32 v15, v248, v250
    v_add_f32 v14, v14, v252
    v_fmac_f32 v15, v252, v254
    s_nop 0
    v_add_f32_dpp v14, v14, v14 row_ror:8 row_mask:0xf bank_mask:0xf
    v_add_f32_dpp v15, v15, v15 row_ror:8 row_mask:0xf bank_mask:0xf
    s_nop 0
    v_add_f32_dpp v14, v14, v14 row_ror:4 row_mask:0xf bank_mask:0xf
    v_add_f32_dpp v15, v15, v15 row_ror:4 row_mask:0xf bank_mask:0xf
    s_nop 0
    v_add_f32_dpp v14, v14, v14 row_ror:2 row_mask:0xf bank_mask:0xf
    v_add_f32_dpp v15, v15, v15 row_ror:2 row_mask:0xf bank_mask:0xf
    s_nop 0
    v_add_f32_dpp v14, v14, v14 row_ror:1 row_mask:0xf bank_mask:0xf
    v_add_f32_dpp v15, v15, v15 row_ror:1 row_mask:0xf bank_mask:0xf
    s_nop 0
    v_add_f32_dpp v14, v14, v14 row_bcast:15 row_mask:0xa bank_mask:0xf
    v_add_f32_dpp v15, v15, v15 row_bcast:15 row_mask:0xa bank_mask:0xf
    s_nop 0
    v_add_f32_dpp v14, v14, v14 row_bcast:31 row_mask:0xc bank_mask:0xf
    v_add_f32_dpp v15, v15, v15 row_bcast:31 row_mask:0xc bank_mask:0xf
    v_rcp_f32 v14, v14
    s_nop 0
    v_mul_f32 v15, v15, v14
    v_cvt_pk_bf16_f32 v15, v15, v15
    buffer_store_short v15, v11, s[36:39], 0 offen
L_end:
s_endpgm
.section .rodata,"a"
.p2align 6
.amdhsa_kernel standalone__factorization_afm__recsys_kernel
  .amdhsa_next_free_vgpr 448
  .amdhsa_next_free_sgpr 102
  .amdhsa_accum_offset 256
  .amdhsa_group_segment_fixed_size 0
  .amdhsa_kernarg_size 88
  .amdhsa_user_sgpr_count 2
  .amdhsa_user_sgpr_kernarg_segment_ptr 1
  .amdhsa_system_sgpr_workgroup_id_x 1
  .amdhsa_float_denorm_mode_32 3
.end_amdhsa_kernel
```

```asm
; @launch grid=(256,1,1) block=(256,1,1) lds=66816
.amdgcn_target "amdgcn-amd-amdhsa--gfx950"
.text
.globl standalone__factorization_afm__recsys_kernel
.p2align 8
.type standalone__factorization_afm__recsys_kernel,@function
standalone__factorization_afm__recsys_kernel:
    s_load_dwordx16 s[16:31], s[0:1], 0
    s_load_dwordx2 s[36:37], s[0:1], 64
    s_cmp_ge_u32 s2, 256
    s_cbranch_scc1 L_end
    s_getpc_b64 s[10:11]
L_pc:
    v_lshlrev_b32 v67, 7, v0
    v_min_u32 v67, L_end-L_pc, v67
    global_load_dword v70, v67, s[10:11]
    v_lshrrev_b32 v68, 6, v0
    v_and_b32 v50, 15, v0
    v_readfirstlane_b32 s3, v68
    v_bfe_u32 v51, v0, 4, 2
    v_and_b32 v52, 63, v0
    s_lshl_b32 s4, s2, 2
    s_add_u32 s4, s4, s3
    s_mul_i32 s6, s4, 104
    v_mul_u32_u24 v53, 28, v51
    v_min_u32 v53, 76, v53
    v_add_u32 v53, s6, v53
    s_mul_i32 s9, s3, 8448
    v_and_b32 v67, 2, v51
    v_add_u32 v67, v67, v51
    v_lshlrev_b32 v68, 4, v50
    v_lshl_add_u32 v56, v67, 10, v68
    s_bfe_u32 s8, s2, 0x30003
    s_mul_i32 s44, s8, 1056
    s_and_b32 s12, s8, 4
    s_add_u32 s12, s12, s8
    s_lshl_b32 s7, s3, 5
    s_add_u32 s12, s12, s7
    s_lshl_b32 s45, s12, 8
    s_add_u32 m0, s44, s9
    v_lshlrev_b32 v54, 2, v52
    s_mul_i32 s5, s3, 7616
    s_add_u32 s5, s5, 36352
    s_mov_b32 s42, 25600000
    s_mov_b32 s43, 0x00020000
    s_mov_b32 s54, 32768
    s_mov_b32 s55, 0x00020000
    s_mov_b32 s38, 2048
    s_mov_b32 s39, 0x00020000
    s_mov_b32 s35, 0xff800000
    v_xor_b32 v67, v50, v51
    v_lshlrev_b32 v57, 4, v67
    s_lshl_b32 s8, s4, 1
    v_mov_b32 v11, 0x7ffffff0
    v_writelane_b32 v11, s8, 0
    v_lshlrev_b32 v55, 4, v51
    v_lshrrev_b32 v60, 2, v50
    v_and_b32 v61, 3, v50
    s_movk_i32 s12, 1056
    v_and_b32 v67, 2, v60
    v_lshl_add_u32 v67, v67, 1, v61
    v_mad_u32_u24 v67, v67, s12, v55
    v_and_b32 v68, 1, v60
    v_lshl_add_u32 v68, v68, 8, s9
    v_add_u32 v58, v67, v68
    v_and_b32 v67, 1, v51
    v_lshl_add_u32 v67, v67, 2, v60
    v_and_b32 v68, 2, v51
    v_lshlrev_b32 v68, 8, v68
    s_waitcnt lgkmcnt(0)
    global_load_dwordx4 v[208:211], v53, s[16:17] nt
    s_mov_b32 s52, s24
    s_mov_b32 s53, s25
    global_load_dwordx3 v[212:214], v53, s[16:17] offset:16 nt
    buffer_load_dwordx4 v56, s[52:55], s45 offen lds
    s_xor_b32 s46, s44, 1056
    s_add_u32 m0, s46, s9
    s_xor_b32 s46, s45, 256
    buffer_load_dwordx4 v56, s[52:55], s46 offen lds
    s_xor_b32 s46, s44, 2112
    s_add_u32 m0, s46, s9
    s_xor_b32 s46, s45, 512
    buffer_load_dwordx4 v56, s[52:55], s46 offen lds
    s_xor_b32 s46, s44, 3168
    s_add_u32 m0, s46, s9
    s_xor_b32 s46, s45, 768
    v_lshl_add_u32 v68, v61, 3, v68
    v_mad_u32_u24 v59, v67, s12, v68
    v_lshlrev_b32 v65, 3, v52
    v_and_b32 v69, 1, v52
    v_lshlrev_b32 v67, 2, v69
    v_bfe_u32 v68, v52, 1, 2
    buffer_load_dwordx4 v56, s[52:55], s46 offen lds
    s_xor_b32 s46, s44, 4224
    s_add_u32 m0, s46, s9
    s_xor_b32 s46, s45, 2048
    v_and_or_b32 v68, v52, 56, v68
    v_add_lshl_u32 v63, v67, v68, 2
    v_bfe_u32 v68, v52, 3, 1
    v_and_or_b32 v68, v52, 50, v68
    v_or_b32 v67, v67, v68
    v_and_b32 v68, 4, v52
    buffer_load_dwordx4 v56, s[52:55], s46 offen lds
    s_xor_b32 s46, s44, 5280
    s_add_u32 m0, s46, s9
    s_xor_b32 s46, s45, 2304
    v_lshl_or_b32 v67, v68, 1, v67
    v_lshlrev_b32 v62, 2, v67
    v_and_b32 v67, 2, v50
    s_lshl_b32 s8, s3, 6
    v_lshl_add_u32 v68, v67, 3, s8
    v_lshl_add_u32 v68, v60, 2, v68
    buffer_load_dwordx4 v56, s[52:55], s46 offen lds
    s_xor_b32 s46, s44, 6336
    s_add_u32 m0, s46, s9
    s_xor_b32 s46, s45, 2560
    v_lshl_add_u32 v64, v69, 1, v68
    v_lshlrev_b32 v68, 4, v69
    v_lshl_or_b32 v68, v51, 5, v68
    v_lshl_or_b32 v68, v67, 7, v68
    v_mov_b32 v12, 1024
    s_nop 0
    v_mov_b32_dpp v12, v68 quad_perm:[0,1,2,3] row_mask:0xf bank_mask:0x1
    buffer_load_dwordx4 v56, s[52:55], s46 offen lds
    s_xor_b32 s46, s44, 7392
    s_add_u32 m0, s46, s9
    s_xor_b32 s46, s45, 2816
    s_mov_b32 s13, 0xaaaa
    v_mov_b32 v1, 0x4444
    v_mad_u32_u24 v1, v69, s13, v1
    v_mov_b32_dpp v13, v12 row_ror:4 row_mask:0xf bank_mask:0xf
    v_mov_b32_dpp v14, v12 row_ror:8 row_mask:0xf bank_mask:0xf
    v_mov_b32_dpp v15, v12 row_ror:12 row_mask:0xf bank_mask:0xf
    buffer_load_dwordx4 v56, s[52:55], s46 offen lds
    s_mov_b32 s40, s18
    s_mov_b32 s41, s19
    v_mov_b64 v[232:233], 0
    v_mov_b64 v[234:235], 0
    v_min_u32 v67, 1, v51
    v_lshlrev_b32 v67, 9, v67
    v_lshl_add_u32 v66, v52, 4, v67
    ds_write_b128 v66, v[232:235] offset:34048
    global_load_dword v220, v54, s[28:29]
    v_lshl_add_u32 v67, v50, 8, s5
    v_lshl_add_u32 v67, v60, 6, v67
    v_and_or_b32 v216, v57, 48, v67
    v_lshlrev_b32 v69, 2, v50
    s_add_u32 s8, s5, 4352
    s_mov_b32 s12, 0x392b8187
    global_load_dword v221, v54, s[30:31]
    s_mov_b32 s13, 0x5079b845
    v_lshrrev_b64 v[48:49], v69, s[12:13]
    v_and_b32 v67, 15, v48
    v_lshl_add_u32 v68, v67, 8, s8
    v_bfe_u32 v67, v48, 2, 2
    v_lshl_add_u32 v68, v67, 6, v68
    global_load_dword v223, v54, s[26:27]
    s_mov_b32 m0, s5
    s_waitcnt vmcnt(11)
    v_lshl_add_u32 v208, v208, 8, v57
    buffer_load_dwordx4 v208, s[40:43], 0 offen nt lds
    s_add_u32 m0, s5, 1088
    v_lshl_add_u32 v209, v209, 8, v57
    buffer_load_dwordx4 v209, s[40:43], 0 offen nt lds
    s_add_u32 m0, s5, 2176
    v_lshl_add_u32 v210, v210, 8, v57
    buffer_load_dwordx4 v210, s[40:43], 0 offen nt lds
    s_add_u32 m0, s5, 3264
    v_lshl_add_u32 v211, v211, 8, v57
    buffer_load_dwordx4 v211, s[40:43], 0 offen nt lds
    v_xor_b32 v67, v48, v51
    v_and_b32 v67, 3, v67
    v_lshl_add_u32 v2, v67, 4, v68
    s_mov_b32 s12, 0x5370448
    s_mov_b32 s13, 0x319b2721
    v_lshrrev_b64 v[48:49], v69, s[12:13]
    v_and_b32 v67, 15, v48
    v_lshl_add_u32 v68, v67, 8, s8
    v_bfe_u32 v67, v48, 2, 2
    v_lshl_add_u32 v68, v67, 6, v68
    v_xor_b32 v67, v48, v51
    v_and_b32 v67, 3, v67
    v_lshl_add_u32 v6, v67, 4, v68
    v_mov_b64 v[236:237], 0
    v_mov_b64 v[238:239], 0
    v_mov_b64 v[240:241], 0
    v_mov_b64 v[242:243], 0
    v_mov_b64 v[244:245], 0
    v_mov_b64 v[246:247], 0
    v_mov_b64 v[248:249], 0
    v_mov_b64 v[250:251], 0
    v_writelane_b32 v248, s35, 29
    v_writelane_b32 v248, s35, 48
    v_writelane_b32 v248, s35, 58
    v_mov_b64 v[252:253], 0
    v_mov_b64 v[254:255], 0
    v_mov_b32 v10, 0x3f38aa3b
    s_cmp_eq_u32 s3, 0
    s_cbranch_scc1 L_stub0
    s_cmp_eq_u32 s3, 1
    s_cbranch_scc1 L_stub1
    s_cmp_eq_u32 s3, 2
    s_cbranch_scc1 L_stub2
    s_cmp_eq_u32 s3, 3
    s_cbranch_scc1 L_stub3
L_back:
    s_branch L_main2
.p2align 12
L_main:
    s_cbranch_scc1 L_back
L_main2:
    s_waitcnt vmcnt(7)
    ds_read_b128 v[80:83], v58 offset:0
    ds_read_b128 v[84:87], v58 offset:64
    ds_read_b128 v[88:91], v58 offset:128
    ds_read_b128 v[92:95], v58 offset:192
    ds_read_b128 v[96:99], v58 offset:512
    ds_read_b128 v[100:103], v58 offset:576
    ds_read_b128 v[104:107], v58 offset:640
    ds_read_b128 v[108:111], v58 offset:704
    s_waitcnt vmcnt(4)
    ds_write_b32 v54, v220 offset:36096
    ds_read_b128 v[144:147], v55 offset:36096
    ds_read_b128 v[148:151], v55 offset:36160
    ds_read_b128 v[152:155], v55 offset:36224
    ds_read_b128 v[156:159], v55 offset:36288
    v_lshlrev_b32 v222, 16, v223
    v_and_b32 v223, 0xffff0000, v223
    ds_write_b64 v65, v[222:223] offset:35584
    ds_write_b32 v62, v220 offset:33792
    ds_write_b32 v63, v221 offset:34560
    ds_read_b128 v[112:115], v55 offset:35584
    ds_read_b128 v[116:119], v55 offset:35648
    ds_read_b128 v[120:123], v55 offset:35712
    ds_read_b128 v[124:127], v55 offset:35776
    ds_read_b128 v[128:131], v55 offset:35840
    ds_read_b128 v[132:135], v55 offset:35904
    ds_read_b128 v[136:139], v55 offset:35968
    ds_read_b128 v[140:143], v55 offset:36032
    s_barrier
    s_waitcnt lgkmcnt(11)
    v_mfma_f32_16x16x32_bf16 v[176:179], v[144:147], v[80:83], 0
    ds_read_b64_tr_b16 a[0:1], v59 offset:0
    ds_read_b64_tr_b16 a[2:3], v59 offset:256
    v_mfma_f32_16x16x32_bf16 v[176:179], v[148:151], v[84:87], v[176:179]
    ds_read_b64_tr_b16 a[16:17], v59 offset:32
    ds_read_b64_tr_b16 a[18:19], v59 offset:288
    v_mfma_f32_16x16x32_bf16 v[176:179], v[152:155], v[88:91], v[176:179]
    ds_read_b64_tr_b16 a[32:33], v59 offset:64
    ds_read_b64_tr_b16 a[34:35], v59 offset:320
    v_mfma_f32_16x16x32_bf16 v[176:179], v[156:159], v[92:95], v[176:179]
    ds_read_b64_tr_b16 a[48:49], v59 offset:96
    ds_read_b64_tr_b16 a[50:51], v59 offset:352
    v_mfma_f32_16x16x32_bf16 v[180:183], v[144:147], v[96:99], 0
    ds_read_b64_tr_b16 a[64:65], v59 offset:128
    ds_read_b64_tr_b16 a[66:67], v59 offset:384
    v_mfma_f32_16x16x32_bf16 v[180:183], v[148:151], v[100:103], v[180:183]
    ds_read_b64_tr_b16 a[80:81], v59 offset:160
    ds_read_b64_tr_b16 a[82:83], v59 offset:416
    v_mfma_f32_16x16x32_bf16 v[180:183], v[152:155], v[104:107], v[180:183]
    ds_read_b64_tr_b16 a[96:97], v59 offset:192
    ds_read_b64_tr_b16 a[98:99], v59 offset:448
    v_mfma_f32_16x16x32_bf16 v[180:183], v[156:159], v[108:111], v[180:183]
    ds_read_b64_tr_b16 a[112:113], v59 offset:224
    ds_read_b64_tr_b16 a[114:115], v59 offset:480
    ds_read_b64_tr_b16 a[4:5], v59 offset:8448
    ds_read_b64_tr_b16 a[6:7], v59 offset:8704
    ds_read_b64_tr_b16 a[20:21], v59 offset:8480
    ds_read_b64_tr_b16 a[22:23], v59 offset:8736
    ds_read_b64_tr_b16 a[36:37], v59 offset:8512
    ds_read_b64_tr_b16 a[38:39], v59 offset:8768
    ds_read_b64_tr_b16 a[52:53], v59 offset:8544
    v_cvt_pk_bf16_f32 v69, v176, v180
    ds_write_b16 v64, v69 offset:34304
    ds_write_b16_d16_hi v64, v69 offset:34336
    ds_read_b64_tr_b16 a[54:55], v59 offset:8800
    ds_read_b64_tr_b16 a[68:69], v59 offset:8576
    ds_read_b64_tr_b16 a[70:71], v59 offset:8832
    ds_read_b64_tr_b16 a[84:85], v59 offset:8608
    ds_read_b64_tr_b16 a[86:87], v59 offset:8864
    ds_read_b64_tr_b16 a[100:101], v59 offset:8640
    ds_read_b64_tr_b16 a[102:103], v59 offset:8896
    ds_read_b64_tr_b16 a[116:117], v59 offset:8672
    ds_read_b64_tr_b16 a[118:119], v59 offset:8928
    ds_read_b64_tr_b16 a[8:9], v59 offset:16896
    ds_read_b64_tr_b16 a[10:11], v59 offset:17152
    ds_read_b64_tr_b16 a[24:25], v59 offset:16928
    ds_read_b64_tr_b16 a[26:27], v59 offset:17184
    ds_read_b64_tr_b16 a[40:41], v59 offset:16960
    ds_read_b64_tr_b16 a[42:43], v59 offset:17216
    ds_read_b64_tr_b16 a[56:57], v59 offset:16992
    ds_read_b64_tr_b16 a[58:59], v59 offset:17248
    s_waitcnt lgkmcnt(15)
    s_barrier
    ds_read_b128 a[136:139], v12 offset:34304
    ds_read_b128 a[140:143], v12 offset:34432
    ds_read_b64_tr_b16 a[72:73], v59 offset:17024
    ds_read_b64_tr_b16 a[74:75], v59 offset:17280
    ds_read_b64_tr_b16 a[88:89], v59 offset:17056
    ds_read_b64_tr_b16 a[90:91], v59 offset:17312
    ds_read_b64_tr_b16 a[104:105], v59 offset:17088
    ds_read_b64_tr_b16 a[106:107], v59 offset:17344
    ds_read_b64_tr_b16 a[120:121], v59 offset:17120
    ds_read_b64_tr_b16 a[122:123], v59 offset:17376
    ds_read_b64_tr_b16 a[12:13], v59 offset:25344
    ds_read_b64_tr_b16 a[14:15], v59 offset:25600
    ds_read_b64_tr_b16 a[28:29], v59 offset:25376
    ds_read_b64_tr_b16 a[30:31], v59 offset:25632
    ds_read_b64_tr_b16 a[44:45], v59 offset:25408
    ds_read_b64_tr_b16 a[46:47], v59 offset:25664
    ds_read_b64_tr_b16 a[60:61], v59 offset:25440
    ds_read_b64_tr_b16 a[62:63], v59 offset:25696
    ds_read_b64_tr_b16 a[76:77], v59 offset:25472
    ds_read_b64_tr_b16 a[78:79], v59 offset:25728
    ds_read_b64_tr_b16 a[92:93], v59 offset:25504
    ds_read_b64_tr_b16 a[94:95], v59 offset:25760
    ds_read_b64_tr_b16 a[108:109], v59 offset:25536
    ds_read_b64_tr_b16 a[110:111], v59 offset:25792
    ds_read_b64_tr_b16 a[124:125], v59 offset:25568
    ds_read_b64_tr_b16 a[126:127], v59 offset:25824
    s_add_u32 m0, s5, 4352
    v_lshl_add_u32 v212, v212, 8, v57
    buffer_load_dwordx4 v212, s[40:43], 0 offen nt lds
    s_add_u32 m0, s5, 5440
    v_lshl_add_u32 v213, v213, 8, v57
    s_mov_b32 exec_hi, 0xffff0000
    buffer_load_dwordx4 v213, s[40:43], 0 offen nt lds
    s_add_u32 m0, s5, 6528
    v_lshl_add_u32 v214, v214, 8, v57
    buffer_load_dwordx4 v214, s[40:43], 0 offen nt lds
    s_mov_b32 exec_hi, -1
    s_cmp_eq_u32 s3, 4
    s_waitcnt vmcnt(3)
    ds_read_b128 v[32:35], v216 offset:0
    ds_read_b128 v[36:39], v216 offset:64
    ds_read_b128 v[40:43], v216 offset:128
    ds_read_b128 v[44:47], v216 offset:192
    s_waitcnt lgkmcnt(3)
    v_lshlrev_b32 v16, 16, v32
    v_and_b32 v17, 0xffff0000, v32
    v_lshlrev_b32 v18, 16, v33
    v_and_b32 v19, 0xffff0000, v33
    v_lshlrev_b32 v20, 16, v34
    v_and_b32 v21, 0xffff0000, v34
    v_lshlrev_b32 v22, 16, v35
    v_and_b32 v23, 0xffff0000, v35
    v_mul_f32_dpp v224, v16, v16 row_ror:1 row_mask:0xf bank_mask:0xf
    v_mul_f32_dpp v225, v17, v17 row_ror:1 row_mask:0xf bank_mask:0xf
    v_mul_f32_dpp v226, v18, v18 row_ror:1 row_mask:0xf bank_mask:0xf
    v_mul_f32_dpp v227, v19, v19 row_ror:1 row_mask:0xf bank_mask:0xf
    v_mul_f32_dpp v228, v20, v20 row_ror:1 row_mask:0xf bank_mask:0xf
    v_mul_f32_dpp v229, v21, v21 row_ror:1 row_mask:0xf bank_mask:0xf
    v_mul_f32_dpp v230, v22, v22 row_ror:1 row_mask:0xf bank_mask:0xf
    v_mul_f32_dpp v231, v23, v23 row_ror:1 row_mask:0xf bank_mask:0xf
    v_cvt_pk_bf16_f32 v144, v224, v225
    v_cvt_pk_bf16_f32 v145, v226, v227
    v_cvt_pk_bf16_f32 v146, v228, v229
    v_cvt_pk_bf16_f32 v147, v230, v231
    s_waitcnt lgkmcnt(2)
    v_lshlrev_b32 v24, 16, v36
    v_mfma_f32_16x16x32_bf16 v[176:179], a[0:3], v[144:147], v[112:115]
    s_waitcnt lgkmcnt(1)
    v_and_b32 v25, 0xffff0000, v36
    v_lshlrev_b32 v26, 16, v37
    v_mfma_f32_16x16x32_bf16 v[180:183], a[16:19], v[144:147], v[116:119]
    s_waitcnt lgkmcnt(0)
    v_and_b32 v27, 0xffff0000, v37
    v_lshlrev_b32 v28, 16, v38
    v_mfma_f32_16x16x32_bf16 v[184:187], a[32:35], v[144:147], v[120:123]
    v_and_b32 v29, 0xffff0000, v38
    v_lshlrev_b32 v30, 16, v39
    v_mfma_f32_16x16x32_bf16 v[188:191], a[48:51], v[144:147], v[124:127]
    v_and_b32 v31, 0xffff0000, v39
    v_mul_f32_dpp v224, v24, v24 row_ror:1 row_mask:0xf bank_mask:0xf
    v_mfma_f32_16x16x32_bf16 v[192:195], a[64:67], v[144:147], v[128:131]
    v_mul_f32_dpp v225, v25, v25 row_ror:1 row_mask:0xf bank_mask:0xf
    v_mul_f32_dpp v226, v26, v26 row_ror:1 row_mask:0xf bank_mask:0xf
    v_mfma_f32_16x16x32_bf16 v[196:199], a[80:83], v[144:147], v[132:135]
    v_mul_f32_dpp v227, v27, v27 row_ror:1 row_mask:0xf bank_mask:0xf
    v_mul_f32_dpp v228, v28, v28 row_ror:1 row_mask:0xf bank_mask:0xf
    v_mfma_f32_16x16x32_bf16 v[200:203], a[96:99], v[144:147], v[136:139]
    v_mul_f32_dpp v229, v29, v29 row_ror:1 row_mask:0xf bank_mask:0xf
    v_mul_f32_dpp v230, v30, v30 row_ror:1 row_mask:0xf bank_mask:0xf
    v_mfma_f32_16x16x32_bf16 v[204:207], a[112:115], v[144:147], v[140:143]
    v_mul_f32_dpp v231, v31, v31 row_ror:1 row_mask:0xf bank_mask:0xf
    v_cvt_pk_bf16_f32 v148, v224, v225
    v_cvt_pk_bf16_f32 v149, v226, v227
    v_cvt_pk_bf16_f32 v150, v228, v229
    v_cvt_pk_bf16_f32 v151, v230, v231
    v_lshlrev_b32 v32, 16, v40
    v_and_b32 v33, 0xffff0000, v40
    v_mfma_f32_16x16x32_bf16 v[204:207], a[116:119], v[148:151], v[204:207]
    v_lshlrev_b32 v34, 16, v41
    v_and_b32 v35, 0xffff0000, v41
    v_smfmac_f32_16x16x64_bf16 v[232:235], a[136:139], v[144:151], v1
    v_lshlrev_b32 v36, 16, v42
    v_mfma_f32_16x16x32_bf16 v[176:179], a[4:7], v[148:151], v[176:179]
    v_and_b32 v37, 0xffff0000, v42
    v_lshlrev_b32 v38, 16, v43
    v_mfma_f32_16x16x32_bf16 v[180:183], a[20:23], v[148:151], v[180:183]
    v_and_b32 v39, 0xffff0000, v43
    v_mul_f32_dpp v224, v32, v32 row_ror:1 row_mask:0xf bank_mask:0xf
    v_mfma_f32_16x16x32_bf16 v[184:187], a[36:39], v[148:151], v[184:187]
    v_mul_f32_dpp v225, v33, v33 row_ror:1 row_mask:0xf bank_mask:0xf
    v_mul_f32_dpp v226, v34, v34 row_ror:1 row_mask:0xf bank_mask:0xf
    v_mfma_f32_16x16x32_bf16 v[188:191], a[52:55], v[148:151], v[188:191]
    v_mul_f32_dpp v227, v35, v35 row_ror:1 row_mask:0xf bank_mask:0xf
    v_mul_f32_dpp v228, v36, v36 row_ror:1 row_mask:0xf bank_mask:0xf
    v_mfma_f32_16x16x32_bf16 v[192:195], a[68:71], v[148:151], v[192:195]
    v_mul_f32_dpp v229, v37, v37 row_ror:1 row_mask:0xf bank_mask:0xf
    v_mul_f32_dpp v230, v38, v38 row_ror:1 row_mask:0xf bank_mask:0xf
    v_mfma_f32_16x16x32_bf16 v[196:199], a[84:87], v[148:151], v[196:199]
    v_mul_f32_dpp v231, v39, v39 row_ror:1 row_mask:0xf bank_mask:0xf
    v_cvt_pk_bf16_f32 v152, v224, v225
    v_mfma_f32_16x16x32_bf16 v[200:203], a[100:103], v[148:151], v[200:203]
    v_cvt_pk_bf16_f32 v153, v226, v227
    v_cvt_pk_bf16_f32 v154, v228, v229
    v_cvt_pk_bf16_f32 v155, v230, v231
    v_lshlrev_b32 v40, 16, v44
    v_and_b32 v41, 0xffff0000, v44
    v_mfma_f32_16x16x32_bf16 v[200:203], a[104:107], v[152:155], v[200:203]
    v_lshlrev_b32 v42, 16, v45
    v_and_b32 v43, 0xffff0000, v45
    v_mfma_f32_16x16x32_bf16 v[176:179], a[8:11], v[152:155], v[176:179]
    v_lshlrev_b32 v44, 16, v46
    v_and_b32 v45, 0xffff0000, v46
    v_mfma_f32_16x16x32_bf16 v[180:183], a[24:27], v[152:155], v[180:183]
    ds_read_b128 a[128:131], v12 offset:33792
    v_lshlrev_b32 v46, 16, v47
    v_and_b32 v47, 0xffff0000, v47
    v_mfma_f32_16x16x32_bf16 v[184:187], a[40:43], v[152:155], v[184:187]
    v_mul_f32_dpp v224, v40, v40 row_ror:1 row_mask:0xf bank_mask:0xf
    v_mul_f32_dpp v225, v41, v41 row_ror:1 row_mask:0xf bank_mask:0xf
    v_mfma_f32_16x16x32_bf16 v[188:191], a[56:59], v[152:155], v[188:191]
    v_mul_f32_dpp v226, v42, v42 row_ror:1 row_mask:0xf bank_mask:0xf
    v_mul_f32_dpp v227, v43, v43 row_ror:1 row_mask:0xf bank_mask:0xf
    v_mfma_f32_16x16x32_bf16 v[192:195], a[72:75], v[152:155], v[192:195]
    v_mul_f32_dpp v228, v44, v44 row_ror:1 row_mask:0xf bank_mask:0xf
    v_mul_f32_dpp v229, v45, v45 row_ror:1 row_mask:0xf bank_mask:0xf
    v_mfma_f32_16x16x32_bf16 v[196:199], a[88:91], v[152:155], v[196:199]
    v_mul_f32_dpp v230, v46, v46 row_ror:1 row_mask:0xf bank_mask:0xf
    v_mul_f32_dpp v231, v47, v47 row_ror:1 row_mask:0xf bank_mask:0xf
    v_mfma_f32_16x16x32_bf16 v[204:207], a[120:123], v[152:155], v[204:207]
    ds_read_b128 a[132:135], v12 offset:33920
    v_cvt_pk_bf16_f32 v156, v224, v225
    v_cvt_pk_bf16_f32 v157, v226, v227
    v_cvt_pk_bf16_f32 v158, v228, v229
    v_cvt_pk_bf16_f32 v159, v230, v231
    v_mul_f32_dpp v224, v16, v16 row_ror:2 row_mask:0xf bank_mask:0xf
    v_mul_f32_dpp v225, v17, v17 row_ror:2 row_mask:0xf bank_mask:0xf
    v_mfma_f32_16x16x32_bf16 v[204:207], a[124:127], v[156:159], v[204:207]
    v_mul_f32_dpp v226, v18, v18 row_ror:2 row_mask:0xf bank_mask:0xf
    v_mul_f32_dpp v227, v19, v19 row_ror:2 row_mask:0xf bank_mask:0xf
    v_smfmac_f32_16x16x64_bf16 v[232:235], a[140:143], v[152:159], v1
    v_mul_f32_dpp v228, v20, v20 row_ror:2 row_mask:0xf bank_mask:0xf
    v_mfma_f32_16x16x32_bf16 v[176:179], a[12:15], v[156:159], v[176:179]
    s_waitcnt lgkmcnt(0)
    v_mul_f32_dpp v229, v21, v21 row_ror:2 row_mask:0xf bank_mask:0xf
    v_mul_f32_dpp v230, v22, v22 row_ror:2 row_mask:0xf bank_mask:0xf
    v_mfma_f32_16x16x32_bf16 v[180:183], a[28:31], v[156:159], v[180:183]
    v_mul_f32_dpp v231, v23, v23 row_ror:2 row_mask:0xf bank_mask:0xf
    v_cvt_pk_bf16_f32 v160, v224, v225
    v_mfma_f32_16x16x32_bf16 v[184:187], a[44:47], v[156:159], v[184:187]
    ds_read_b128 a[152:155], v13 offset:34304
    v_cvt_pk_bf16_f32 v161, v226, v227
    v_cvt_pk_bf16_f32 v162, v228, v229
    v_mfma_f32_16x16x32_bf16 v[188:191], a[60:63], v[156:159], v[188:191]
    v_cvt_pk_bf16_f32 v163, v230, v231
    v_mul_f32_dpp v224, v24, v24 row_ror:2 row_mask:0xf bank_mask:0xf
    v_mfma_f32_16x16x32_bf16 v[192:195], a[76:79], v[156:159], v[192:195]
    v_mul_f32_dpp v225, v25, v25 row_ror:2 row_mask:0xf bank_mask:0xf
    v_mul_f32_dpp v226, v26, v26 row_ror:2 row_mask:0xf bank_mask:0xf
    v_mfma_f32_16x16x32_bf16 v[196:199], a[92:95], v[156:159], v[196:199]
    v_mul_f32_dpp v227, v27, v27 row_ror:2 row_mask:0xf bank_mask:0xf
    v_mul_f32_dpp v228, v28, v28 row_ror:2 row_mask:0xf bank_mask:0xf
    v_mfma_f32_16x16x32_bf16 v[200:203], a[108:111], v[156:159], v[200:203]
    v_mul_f32_dpp v229, v29, v29 row_ror:2 row_mask:0xf bank_mask:0xf
    v_mul_f32_dpp v230, v30, v30 row_ror:2 row_mask:0xf bank_mask:0xf
    v_mul_f32_dpp v231, v31, v31 row_ror:2 row_mask:0xf bank_mask:0xf
    v_cvt_pk_bf16_f32 v208, |v176|, |v177|
    v_cvt_pk_bf16_f32 v209, |v178|, |v179|
    v_mfma_f32_16x16x32_bf16 v[176:179], a[0:3], v[160:163], v[112:115]
    ds_read_b128 a[156:159], v13 offset:34432
    v_cvt_pk_bf16_f32 v164, v224, v225
    v_cvt_pk_bf16_f32 v165, v226, v227
    v_cvt_pk_bf16_f32 v166, v228, v229
    v_cvt_pk_bf16_f32 v167, v230, v231
    v_mul_f32_dpp v224, v32, v32 row_ror:2 row_mask:0xf bank_mask:0xf
    v_mul_f32_dpp v225, v33, v33 row_ror:2 row_mask:0xf bank_mask:0xf
    v_mfma_f32_16x16x32_bf16 v[176:179], a[4:7], v[164:167], v[176:179]
    v_mul_f32_dpp v226, v34, v34 row_ror:2 row_mask:0xf bank_mask:0xf
    v_mul_f32_dpp v227, v35, v35 row_ror:2 row_mask:0xf bank_mask:0xf
    v_mul_f32_dpp v228, v36, v36 row_ror:2 row_mask:0xf bank_mask:0xf
    v_mul_f32_dpp v229, v37, v37 row_ror:2 row_mask:0xf bank_mask:0xf
    v_mul_f32_dpp v230, v38, v38 row_ror:2 row_mask:0xf bank_mask:0xf
    v_mul_f32_dpp v231, v39, v39 row_ror:2 row_mask:0xf bank_mask:0xf
    v_cvt_pk_bf16_f32 v168, v224, v225
    v_cvt_pk_bf16_f32 v169, v226, v227
    v_cvt_pk_bf16_f32 v170, v228, v229
    v_cvt_pk_bf16_f32 v171, v230, v231
    v_mul_f32_dpp v224, v40, v40 row_ror:2 row_mask:0xf bank_mask:0xf
    v_mul_f32_dpp v225, v41, v41 row_ror:2 row_mask:0xf bank_mask:0xf
    v_mfma_f32_16x16x32_bf16 v[176:179], a[8:11], v[168:171], v[176:179]
    s_waitcnt lgkmcnt(0)
    v_mul_f32_dpp v226, v42, v42 row_ror:2 row_mask:0xf bank_mask:0xf
    v_mul_f32_dpp v227, v43, v43 row_ror:2 row_mask:0xf bank_mask:0xf
    v_mul_f32_dpp v228, v44, v44 row_ror:2 row_mask:0xf bank_mask:0xf
    v_mul_f32_dpp v229, v45, v45 row_ror:2 row_mask:0xf bank_mask:0xf
    v_mul_f32_dpp v230, v46, v46 row_ror:2 row_mask:0xf bank_mask:0xf
    v_mul_f32_dpp v231, v47, v47 row_ror:2 row_mask:0xf bank_mask:0xf
    v_cvt_pk_bf16_f32 v172, v224, v225
    v_cvt_pk_bf16_f32 v173, v226, v227
    v_cvt_pk_bf16_f32 v174, v228, v229
    v_cvt_pk_bf16_f32 v175, v230, v231
    v_cvt_pk_bf16_f32 v210, |v180|, |v181|
    v_cvt_pk_bf16_f32 v211, |v182|, |v183|
    v_mfma_f32_16x16x32_bf16 v[176:179], a[12:15], v[172:175], v[176:179]
    v_cvt_pk_bf16_f32 v212, |v184|, |v185|
    v_cvt_pk_bf16_f32 v213, |v186|, |v187|
    v_mfma_f32_16x16x32_bf16 v[180:183], a[28:31], v[172:175], v[116:119]
    v_cvt_pk_bf16_f32 v214, |v188|, |v189|
    v_cvt_pk_bf16_f32 v215, |v190|, |v191|
    v_mfma_f32_16x16x32_bf16 v[180:183], a[24:27], v[168:171], v[180:183]
    ds_read_b128 a[144:147], v13 offset:33792
    v_cvt_pk_bf16_f32 v216, |v192|, |v193|
    v_cvt_pk_bf16_f32 v217, |v194|, |v195|
    v_mfma_f32_16x16x32_bf16 v[180:183], a[20:23], v[164:167], v[180:183]
    v_cvt_pk_bf16_f32 v218, |v196|, |v197|
    v_cvt_pk_bf16_f32 v219, |v198|, |v199|
    v_mfma_f32_16x16x32_bf16 v[180:183], a[16:19], v[160:163], v[180:183]
    v_cvt_pk_bf16_f32 v220, |v200|, |v201|
    v_cvt_pk_bf16_f32 v221, |v202|, |v203|
    v_smfmac_f32_16x16x64_bf16 v[232:235], a[128:131], v[208:215], v1
    v_cvt_pk_bf16_f32 v222, |v204|, |v205|
    v_mfma_f32_16x16x32_bf16 v[184:187], a[32:35], v[160:163], v[120:123]
    v_cvt_pk_bf16_f32 v223, |v206|, |v207|
    v_mul_f32_dpp v224, v16, v16 row_ror:3 row_mask:0xf bank_mask:0xf
    v_mfma_f32_16x16x32_bf16 v[184:187], a[36:39], v[164:167], v[184:187]
    ds_read_b128 a[148:151], v13 offset:33920
    v_mul_f32_dpp v225, v17, v17 row_ror:3 row_mask:0xf bank_mask:0xf
    v_mul_f32_dpp v226, v18, v18 row_ror:3 row_mask:0xf bank_mask:0xf
    v_mfma_f32_16x16x32_bf16 v[184:187], a[40:43], v[168:171], v[184:187]
    v_mul_f32_dpp v227, v19, v19 row_ror:3 row_mask:0xf bank_mask:0xf
    v_mul_f32_dpp v228, v20, v20 row_ror:3 row_mask:0xf bank_mask:0xf
    v_mfma_f32_16x16x32_bf16 v[184:187], a[44:47], v[172:175], v[184:187]
    v_mul_f32_dpp v229, v21, v21 row_ror:3 row_mask:0xf bank_mask:0xf
    v_mul_f32_dpp v230, v22, v22 row_ror:3 row_mask:0xf bank_mask:0xf
    v_smfmac_f32_16x16x64_bf16 v[232:235], a[132:135], v[216:223], v1
    v_mul_f32_dpp v231, v23, v23 row_ror:3 row_mask:0xf bank_mask:0xf
    v_mfma_f32_16x16x32_bf16 v[188:191], a[60:63], v[172:175], v[124:127]
    s_waitcnt lgkmcnt(0)
    v_cvt_pk_bf16_f32 v144, v224, v225
    v_cvt_pk_bf16_f32 v145, v226, v227
    v_mfma_f32_16x16x32_bf16 v[188:191], a[56:59], v[168:171], v[188:191]
    ds_read_b128 a[168:171], v14 offset:34304
    v_cvt_pk_bf16_f32 v146, v228, v229
    v_cvt_pk_bf16_f32 v147, v230, v231
    v_mfma_f32_16x16x32_bf16 v[188:191], a[52:55], v[164:167], v[188:191]
    v_mul_f32_dpp v224, v24, v24 row_ror:3 row_mask:0xf bank_mask:0xf
    v_mul_f32_dpp v225, v25, v25 row_ror:3 row_mask:0xf bank_mask:0xf
    v_mfma_f32_16x16x32_bf16 v[188:191], a[48:51], v[160:163], v[188:191]
    v_mul_f32_dpp v226, v26, v26 row_ror:3 row_mask:0xf bank_mask:0xf
    v_mul_f32_dpp v227, v27, v27 row_ror:3 row_mask:0xf bank_mask:0xf
    v_smfmac_f32_16x16x64_bf16 v[232:235], a[152:155], v[160:167], v1
    v_mul_f32_dpp v228, v28, v28 row_ror:3 row_mask:0xf bank_mask:0xf
    v_mfma_f32_16x16x32_bf16 v[192:195], a[64:67], v[160:163], v[128:131]
    v_mul_f32_dpp v229, v29, v29 row_ror:3 row_mask:0xf bank_mask:0xf
    v_mul_f32_dpp v230, v30, v30 row_ror:3 row_mask:0xf bank_mask:0xf
    v_mfma_f32_16x16x32_bf16 v[192:195], a[68:71], v[164:167], v[192:195]
    ds_read_b128 a[172:175], v14 offset:34432
    v_mul_f32_dpp v231, v31, v31 row_ror:3 row_mask:0xf bank_mask:0xf
    v_cvt_pk_bf16_f32 v208, |v176|, |v177|
    v_mfma_f32_16x16x32_bf16 v[192:195], a[72:75], v[168:171], v[192:195]
    v_cvt_pk_bf16_f32 v209, |v178|, |v179|
    v_cvt_pk_bf16_f32 v148, v224, v225
    v_mfma_f32_16x16x32_bf16 v[192:195], a[76:79], v[172:175], v[192:195]
    v_cvt_pk_bf16_f32 v149, v226, v227
    v_cvt_pk_bf16_f32 v150, v228, v229
    v_smfmac_f32_16x16x64_bf16 v[232:235], a[156:159], v[168:175], v1
    v_cvt_pk_bf16_f32 v151, v230, v231
    v_mfma_f32_16x16x32_bf16 v[196:199], a[92:95], v[172:175], v[132:135]
    s_waitcnt lgkmcnt(0)
    v_mul_f32_dpp v224, v32, v32 row_ror:3 row_mask:0xf bank_mask:0xf
    v_mul_f32_dpp v225, v33, v33 row_ror:3 row_mask:0xf bank_mask:0xf
    v_mfma_f32_16x16x32_bf16 v[196:199], a[88:91], v[168:171], v[196:199]
    ds_read_b128 a[160:163], v14 offset:33792
    v_mul_f32_dpp v226, v34, v34 row_ror:3 row_mask:0xf bank_mask:0xf
    v_mul_f32_dpp v227, v35, v35 row_ror:3 row_mask:0xf bank_mask:0xf
    v_mfma_f32_16x16x32_bf16 v[196:199], a[84:87], v[164:167], v[196:199]
    v_mul_f32_dpp v228, v36, v36 row_ror:3 row_mask:0xf bank_mask:0xf
    v_mul_f32_dpp v229, v37, v37 row_ror:3 row_mask:0xf bank_mask:0xf
    v_mfma_f32_16x16x32_bf16 v[196:199], a[80:83], v[160:163], v[196:199]
    v_mul_f32_dpp v230, v38, v38 row_ror:3 row_mask:0xf bank_mask:0xf
    v_mul_f32_dpp v231, v39, v39 row_ror:3 row_mask:0xf bank_mask:0xf
    v_mfma_f32_16x16x32_bf16 v[200:203], a[96:99], v[160:163], v[136:139]
    v_cvt_pk_bf16_f32 v152, v224, v225
    v_cvt_pk_bf16_f32 v153, v226, v227
    v_mfma_f32_16x16x32_bf16 v[200:203], a[100:103], v[164:167], v[200:203]
    v_cvt_pk_bf16_f32 v154, v228, v229
    v_cvt_pk_bf16_f32 v155, v230, v231
    v_mfma_f32_16x16x32_bf16 v[200:203], a[104:107], v[168:171], v[200:203]
    ds_read_b128 a[164:167], v14 offset:33920
    v_mul_f32_dpp v224, v40, v40 row_ror:3 row_mask:0xf bank_mask:0xf
    v_mul_f32_dpp v225, v41, v41 row_ror:3 row_mask:0xf bank_mask:0xf
    v_mfma_f32_16x16x32_bf16 v[200:203], a[108:111], v[172:175], v[200:203]
    v_mul_f32_dpp v226, v42, v42 row_ror:3 row_mask:0xf bank_mask:0xf
    v_mul_f32_dpp v227, v43, v43 row_ror:3 row_mask:0xf bank_mask:0xf
    v_mfma_f32_16x16x32_bf16 v[204:207], a[124:127], v[172:175], v[140:143]
    v_mul_f32_dpp v228, v44, v44 row_ror:3 row_mask:0xf bank_mask:0xf
    v_mul_f32_dpp v229, v45, v45 row_ror:3 row_mask:0xf bank_mask:0xf
    v_mfma_f32_16x16x32_bf16 v[204:207], a[120:123], v[168:171], v[204:207]
    v_mul_f32_dpp v230, v46, v46 row_ror:3 row_mask:0xf bank_mask:0xf
    v_mul_f32_dpp v231, v47, v47 row_ror:3 row_mask:0xf bank_mask:0xf
    v_mfma_f32_16x16x32_bf16 v[204:207], a[116:119], v[164:167], v[204:207]
    s_waitcnt lgkmcnt(0)
    v_cvt_pk_bf16_f32 v156, v224, v225
    v_cvt_pk_bf16_f32 v157, v226, v227
    v_mfma_f32_16x16x32_bf16 v[204:207], a[112:115], v[160:163], v[204:207]
    ds_read_b128 a[184:187], v15 offset:34304
    v_cvt_pk_bf16_f32 v158, v228, v229
    v_cvt_pk_bf16_f32 v159, v230, v231
    v_mfma_f32_16x16x32_bf16 v[176:179], a[0:3], v[144:147], v[112:115]
    v_cvt_pk_bf16_f32 v210, |v180|, |v181|
    v_cvt_pk_bf16_f32 v211, |v182|, |v183|
    v_mfma_f32_16x16x32_bf16 v[176:179], a[4:7], v[148:151], v[176:179]
    v_cvt_pk_bf16_f32 v212, |v184|, |v185|
    v_cvt_pk_bf16_f32 v213, |v186|, |v187|
    v_mfma_f32_16x16x32_bf16 v[176:179], a[8:11], v[152:155], v[176:179]
    v_cvt_pk_bf16_f32 v214, |v188|, |v189|
    v_cvt_pk_bf16_f32 v215, |v190|, |v191|
    v_mfma_f32_16x16x32_bf16 v[176:179], a[12:15], v[156:159], v[176:179]
    v_cvt_pk_bf16_f32 v216, |v192|, |v193|
    v_cvt_pk_bf16_f32 v217, |v194|, |v195|
    v_smfmac_f32_16x16x64_bf16 v[232:235], a[144:147], v[208:215], v1
    v_cvt_pk_bf16_f32 v218, |v196|, |v197|
    v_mfma_f32_16x16x32_bf16 v[180:183], a[28:31], v[156:159], v[116:119]
    ds_read_b128 a[188:191], v15 offset:34432
    v_cvt_pk_bf16_f32 v219, |v198|, |v199|
    v_cvt_pk_bf16_f32 v220, |v200|, |v201|
    v_mfma_f32_16x16x32_bf16 v[180:183], a[24:27], v[152:155], v[180:183]
    v_cvt_pk_bf16_f32 v221, |v202|, |v203|
    v_cvt_pk_bf16_f32 v222, |v204|, |v205|
    v_mfma_f32_16x16x32_bf16 v[180:183], a[20:23], v[148:151], v[180:183]
    v_cvt_pk_bf16_f32 v223, |v206|, |v207|
    v_mul_f32_dpp v224, v16, v16 row_ror:4 row_mask:0xf bank_mask:0xf
    v_mfma_f32_16x16x32_bf16 v[180:183], a[16:19], v[144:147], v[180:183]
    v_mul_f32_dpp v225, v17, v17 row_ror:4 row_mask:0xf bank_mask:0xf
    v_mul_f32_dpp v226, v18, v18 row_ror:4 row_mask:0xf bank_mask:0xf
    v_smfmac_f32_16x16x64_bf16 v[232:235], a[148:151], v[216:223], v1
    v_mul_f32_dpp v227, v19, v19 row_ror:4 row_mask:0xf bank_mask:0xf
    v_mfma_f32_16x16x32_bf16 v[184:187], a[32:35], v[144:147], v[120:123]
    s_waitcnt lgkmcnt(0)
    v_mul_f32_dpp v228, v20, v20 row_ror:4 row_mask:0xf bank_mask:0xf
    v_mul_f32_dpp v229, v21, v21 row_ror:4 row_mask:0xf bank_mask:0xf
    v_mfma_f32_16x16x32_bf16 v[184:187], a[36:39], v[148:151], v[184:187]
    ds_read_b128 a[176:179], v15 offset:33792
    v_mul_f32_dpp v230, v22, v22 row_ror:4 row_mask:0xf bank_mask:0xf
    v_mul_f32_dpp v231, v23, v23 row_ror:4 row_mask:0xf bank_mask:0xf
    v_mfma_f32_16x16x32_bf16 v[184:187], a[40:43], v[152:155], v[184:187]
    v_cvt_pk_bf16_f32 v160, v224, v225
    v_cvt_pk_bf16_f32 v161, v226, v227
    v_mfma_f32_16x16x32_bf16 v[184:187], a[44:47], v[156:159], v[184:187]
    v_cvt_pk_bf16_f32 v162, v228, v229
    v_cvt_pk_bf16_f32 v163, v230, v231
    v_smfmac_f32_16x16x64_bf16 v[232:235], a[168:171], v[144:151], v1
    v_mul_f32_dpp v224, v24, v24 row_ror:4 row_mask:0xf bank_mask:0xf
    v_mfma_f32_16x16x32_bf16 v[188:191], a[60:63], v[156:159], v[124:127]
    ds_read_b128 a[180:183], v15 offset:33920
    v_mul_f32_dpp v225, v25, v25 row_ror:4 row_mask:0xf bank_mask:0xf
    v_mul_f32_dpp v226, v26, v26 row_ror:4 row_mask:0xf bank_mask:0xf
    v_mfma_f32_16x16x32_bf16 v[188:191], a[56:59], v[152:155], v[188:191]
    v_mul_f32_dpp v227, v27, v27 row_ror:4 row_mask:0xf bank_mask:0xf
    v_mul_f32_dpp v228, v28, v28 row_ror:4 row_mask:0xf bank_mask:0xf
    v_mfma_f32_16x16x32_bf16 v[188:191], a[52:55], v[148:151], v[188:191]
    v_mul_f32_dpp v229, v29, v29 row_ror:4 row_mask:0xf bank_mask:0xf
    v_mul_f32_dpp v230, v30, v30 row_ror:4 row_mask:0xf bank_mask:0xf
    v_mfma_f32_16x16x32_bf16 v[188:191], a[48:51], v[144:147], v[188:191]
    v_mul_f32_dpp v231, v31, v31 row_ror:4 row_mask:0xf bank_mask:0xf
    v_cvt_pk_bf16_f32 v208, |v176|, |v177|
    v_smfmac_f32_16x16x64_bf16 v[232:235], a[172:175], v[152:159], v1
    v_cvt_pk_bf16_f32 v209, |v178|, |v179|
    v_mfma_f32_16x16x32_bf16 v[192:195], a[64:67], v[144:147], v[128:131]
    s_waitcnt lgkmcnt(0)
    v_cvt_pk_bf16_f32 v164, v224, v225
    v_cvt_pk_bf16_f32 v165, v226, v227
    v_mfma_f32_16x16x32_bf16 v[192:195], a[68:71], v[148:151], v[192:195]
    v_cvt_pk_bf16_f32 v166, v228, v229
    v_cvt_pk_bf16_f32 v167, v230, v231
    v_mfma_f32_16x16x32_bf16 v[192:195], a[72:75], v[152:155], v[192:195]
    v_mul_f32_dpp v224, v32, v32 row_ror:4 row_mask:0xf bank_mask:0xf
    v_mul_f32_dpp v225, v33, v33 row_ror:4 row_mask:0xf bank_mask:0xf
    v_mfma_f32_16x16x32_bf16 v[192:195], a[76:79], v[156:159], v[192:195]
    v_mul_f32_dpp v226, v34, v34 row_ror:4 row_mask:0xf bank_mask:0xf
    v_mul_f32_dpp v227, v35, v35 row_ror:4 row_mask:0xf bank_mask:0xf
    v_mfma_f32_16x16x32_bf16 v[196:199], a[92:95], v[156:159], v[132:135]
    v_mul_f32_dpp v228, v36, v36 row_ror:4 row_mask:0xf bank_mask:0xf
    v_mul_f32_dpp v229, v37, v37 row_ror:4 row_mask:0xf bank_mask:0xf
    v_mfma_f32_16x16x32_bf16 v[196:199], a[88:91], v[152:155], v[196:199]
    v_mul_f32_dpp v230, v38, v38 row_ror:4 row_mask:0xf bank_mask:0xf
    v_mul_f32_dpp v231, v39, v39 row_ror:4 row_mask:0xf bank_mask:0xf
    v_mfma_f32_16x16x32_bf16 v[196:199], a[84:87], v[148:151], v[196:199]
    v_cvt_pk_bf16_f32 v168, v224, v225
    v_cvt_pk_bf16_f32 v169, v226, v227
    v_mfma_f32_16x16x32_bf16 v[196:199], a[80:83], v[144:147], v[196:199]
    v_cvt_pk_bf16_f32 v170, v228, v229
    v_cvt_pk_bf16_f32 v171, v230, v231
    v_mfma_f32_16x16x32_bf16 v[200:203], a[96:99], v[144:147], v[136:139]
    v_mul_f32_dpp v224, v40, v40 row_ror:4 row_mask:0xf bank_mask:0xf
    v_mul_f32_dpp v225, v41, v41 row_ror:4 row_mask:0xf bank_mask:0xf
    v_mfma_f32_16x16x32_bf16 v[200:203], a[100:103], v[148:151], v[200:203]
    v_mul_f32_dpp v226, v42, v42 row_ror:4 row_mask:0xf bank_mask:0xf
    v_mul_f32_dpp v227, v43, v43 row_ror:4 row_mask:0xf bank_mask:0xf
    v_mfma_f32_16x16x32_bf16 v[200:203], a[104:107], v[152:155], v[200:203]
    v_mul_f32_dpp v228, v44, v44 row_ror:4 row_mask:0xf bank_mask:0xf
    v_mul_f32_dpp v229, v45, v45 row_ror:4 row_mask:0xf bank_mask:0xf
    v_mfma_f32_16x16x32_bf16 v[200:203], a[108:111], v[156:159], v[200:203]
    v_mul_f32_dpp v230, v46, v46 row_ror:4 row_mask:0xf bank_mask:0xf
    v_mul_f32_dpp v231, v47, v47 row_ror:4 row_mask:0xf bank_mask:0xf
    v_mfma_f32_16x16x32_bf16 v[204:207], a[124:127], v[156:159], v[140:143]
    v_cvt_pk_bf16_f32 v172, v224, v225
    v_cvt_pk_bf16_f32 v173, v226, v227
    v_mfma_f32_16x16x32_bf16 v[204:207], a[120:123], v[152:155], v[204:207]
    v_cvt_pk_bf16_f32 v174, v228, v229
    v_cvt_pk_bf16_f32 v175, v230, v231
    v_mfma_f32_16x16x32_bf16 v[204:207], a[116:119], v[148:151], v[204:207]
    v_cvt_pk_bf16_f32 v210, |v180|, |v181|
    v_cvt_pk_bf16_f32 v211, |v182|, |v183|
    v_mfma_f32_16x16x32_bf16 v[204:207], a[112:115], v[144:147], v[204:207]
    v_cvt_pk_bf16_f32 v212, |v184|, |v185|
    v_cvt_pk_bf16_f32 v213, |v186|, |v187|
    v_mfma_f32_16x16x32_bf16 v[176:179], a[0:3], v[160:163], v[112:115]
    v_cvt_pk_bf16_f32 v214, |v188|, |v189|
    v_cvt_pk_bf16_f32 v215, |v190|, |v191|
    v_mfma_f32_16x16x32_bf16 v[176:179], a[4:7], v[164:167], v[176:179]
    v_cvt_pk_bf16_f32 v216, |v192|, |v193|
    v_cvt_pk_bf16_f32 v217, |v194|, |v195|
    v_mfma_f32_16x16x32_bf16 v[176:179], a[8:11], v[168:171], v[176:179]
    v_cvt_pk_bf16_f32 v218, |v196|, |v197|
    v_cvt_pk_bf16_f32 v219, |v198|, |v199|
    v_mfma_f32_16x16x32_bf16 v[176:179], a[12:15], v[172:175], v[176:179]
    v_cvt_pk_bf16_f32 v220, |v200|, |v201|
    v_cvt_pk_bf16_f32 v221, |v202|, |v203|
    v_smfmac_f32_16x16x64_bf16 v[232:235], a[160:163], v[208:215], v1
    v_cvt_pk_bf16_f32 v222, |v204|, |v205|
    v_mfma_f32_16x16x32_bf16 v[180:183], a[28:31], v[172:175], v[116:119]
L_stub0:
    s_cbranch_scc1 L_main2
    v_cvt_pk_bf16_f32 v223, |v206|, |v207|
    v_mul_f32_dpp v224, v16, v16 row_ror:5 row_mask:0xf bank_mask:0xf
    v_mfma_f32_16x16x32_bf16 v[180:183], a[24:27], v[168:171], v[180:183]
    v_mul_f32_dpp v225, v17, v17 row_ror:5 row_mask:0xf bank_mask:0xf
    v_mul_f32_dpp v226, v18, v18 row_ror:5 row_mask:0xf bank_mask:0xf
    v_mfma_f32_16x16x32_bf16 v[180:183], a[20:23], v[164:167], v[180:183]
    v_mul_f32_dpp v227, v19, v19 row_ror:5 row_mask:0xf bank_mask:0xf
    v_mul_f32_dpp v228, v20, v20 row_ror:5 row_mask:0xf bank_mask:0xf
    v_mfma_f32_16x16x32_bf16 v[180:183], a[16:19], v[160:163], v[180:183]
    v_mul_f32_dpp v229, v21, v21 row_ror:5 row_mask:0xf bank_mask:0xf
    v_mul_f32_dpp v230, v22, v22 row_ror:5 row_mask:0xf bank_mask:0xf
    v_smfmac_f32_16x16x64_bf16 v[232:235], a[164:167], v[216:223], v1
    v_mul_f32_dpp v231, v23, v23 row_ror:5 row_mask:0xf bank_mask:0xf
    v_mfma_f32_16x16x32_bf16 v[184:187], a[32:35], v[160:163], v[120:123]
    v_cvt_pk_bf16_f32 v144, v224, v225
    v_cvt_pk_bf16_f32 v145, v226, v227
    v_mfma_f32_16x16x32_bf16 v[184:187], a[36:39], v[164:167], v[184:187]
    v_cvt_pk_bf16_f32 v146, v228, v229
    v_cvt_pk_bf16_f32 v147, v230, v231
    v_mfma_f32_16x16x32_bf16 v[184:187], a[40:43], v[168:171], v[184:187]
    v_mul_f32_dpp v224, v24, v24 row_ror:5 row_mask:0xf bank_mask:0xf
    v_mul_f32_dpp v225, v25, v25 row_ror:5 row_mask:0xf bank_mask:0xf
    v_mfma_f32_16x16x32_bf16 v[184:187], a[44:47], v[172:175], v[184:187]
    v_mul_f32_dpp v226, v26, v26 row_ror:5 row_mask:0xf bank_mask:0xf
    v_mul_f32_dpp v227, v27, v27 row_ror:5 row_mask:0xf bank_mask:0xf
    v_smfmac_f32_16x16x64_bf16 v[232:235], a[184:187], v[160:167], v1
    v_mul_f32_dpp v228, v28, v28 row_ror:5 row_mask:0xf bank_mask:0xf
    v_mfma_f32_16x16x32_bf16 v[188:191], a[60:63], v[172:175], v[124:127]
    v_mul_f32_dpp v229, v29, v29 row_ror:5 row_mask:0xf bank_mask:0xf
    v_mul_f32_dpp v230, v30, v30 row_ror:5 row_mask:0xf bank_mask:0xf
    v_mfma_f32_16x16x32_bf16 v[188:191], a[56:59], v[168:171], v[188:191]
    v_mul_f32_dpp v231, v31, v31 row_ror:5 row_mask:0xf bank_mask:0xf
    v_cvt_pk_bf16_f32 v208, |v176|, |v177|
    v_mfma_f32_16x16x32_bf16 v[188:191], a[52:55], v[164:167], v[188:191]
    v_cvt_pk_bf16_f32 v209, |v178|, |v179|
    v_cvt_pk_bf16_f32 v148, v224, v225
    v_mfma_f32_16x16x32_bf16 v[188:191], a[48:51], v[160:163], v[188:191]
    v_cvt_pk_bf16_f32 v149, v226, v227
    v_cvt_pk_bf16_f32 v150, v228, v229
    v_smfmac_f32_16x16x64_bf16 v[232:235], a[188:191], v[168:175], v1
    v_cvt_pk_bf16_f32 v151, v230, v231
    v_mfma_f32_16x16x32_bf16 v[192:195], a[64:67], v[160:163], v[128:131]
    v_mul_f32_dpp v224, v32, v32 row_ror:5 row_mask:0xf bank_mask:0xf
    v_mul_f32_dpp v225, v33, v33 row_ror:5 row_mask:0xf bank_mask:0xf
    v_mfma_f32_16x16x32_bf16 v[192:195], a[68:71], v[164:167], v[192:195]
    v_mul_f32_dpp v226, v34, v34 row_ror:5 row_mask:0xf bank_mask:0xf
    v_mul_f32_dpp v227, v35, v35 row_ror:5 row_mask:0xf bank_mask:0xf
    v_mfma_f32_16x16x32_bf16 v[192:195], a[72:75], v[168:171], v[192:195]
    v_mul_f32_dpp v228, v36, v36 row_ror:5 row_mask:0xf bank_mask:0xf
    v_mul_f32_dpp v229, v37, v37 row_ror:5 row_mask:0xf bank_mask:0xf
    v_mfma_f32_16x16x32_bf16 v[192:195], a[76:79], v[172:175], v[192:195]
    v_mul_f32_dpp v230, v38, v38 row_ror:5 row_mask:0xf bank_mask:0xf
    v_mul_f32_dpp v231, v39, v39 row_ror:5 row_mask:0xf bank_mask:0xf
    v_smfmac_f32_16x16x64_bf16 v[236:239], a[136:139], v[144:151], v1
    v_cvt_pk_bf16_f32 v152, v224, v225
    v_mfma_f32_16x16x32_bf16 v[196:199], a[92:95], v[172:175], v[132:135]
    v_cvt_pk_bf16_f32 v153, v226, v227
    v_cvt_pk_bf16_f32 v154, v228, v229
    v_mfma_f32_16x16x32_bf16 v[196:199], a[88:91], v[168:171], v[196:199]
    v_cvt_pk_bf16_f32 v155, v230, v231
    v_mul_f32_dpp v224, v40, v40 row_ror:5 row_mask:0xf bank_mask:0xf
    v_mfma_f32_16x16x32_bf16 v[196:199], a[84:87], v[164:167], v[196:199]
    v_mul_f32_dpp v225, v41, v41 row_ror:5 row_mask:0xf bank_mask:0xf
    v_mul_f32_dpp v226, v42, v42 row_ror:5 row_mask:0xf bank_mask:0xf
    v_mfma_f32_16x16x32_bf16 v[196:199], a[80:83], v[160:163], v[196:199]
    v_mul_f32_dpp v227, v43, v43 row_ror:5 row_mask:0xf bank_mask:0xf
    v_mul_f32_dpp v228, v44, v44 row_ror:5 row_mask:0xf bank_mask:0xf
    v_mfma_f32_16x16x32_bf16 v[200:203], a[96:99], v[160:163], v[136:139]
    v_mul_f32_dpp v229, v45, v45 row_ror:5 row_mask:0xf bank_mask:0xf
    v_mul_f32_dpp v230, v46, v46 row_ror:5 row_mask:0xf bank_mask:0xf
    v_mfma_f32_16x16x32_bf16 v[200:203], a[100:103], v[164:167], v[200:203]
    v_mul_f32_dpp v231, v47, v47 row_ror:5 row_mask:0xf bank_mask:0xf
    v_cvt_pk_bf16_f32 v156, v224, v225
    v_mfma_f32_16x16x32_bf16 v[200:203], a[104:107], v[168:171], v[200:203]
    v_cvt_pk_bf16_f32 v157, v226, v227
    v_cvt_pk_bf16_f32 v158, v228, v229
    v_mfma_f32_16x16x32_bf16 v[200:203], a[108:111], v[172:175], v[200:203]
    v_cvt_pk_bf16_f32 v159, v230, v231
    v_cvt_pk_bf16_f32 v210, |v180|, |v181|
    v_mfma_f32_16x16x32_bf16 v[204:207], a[124:127], v[172:175], v[140:143]
    v_cvt_pk_bf16_f32 v211, |v182|, |v183|
    v_cvt_pk_bf16_f32 v212, |v184|, |v185|
    v_mfma_f32_16x16x32_bf16 v[204:207], a[120:123], v[168:171], v[204:207]
    v_cvt_pk_bf16_f32 v213, |v186|, |v187|
    v_cvt_pk_bf16_f32 v214, |v188|, |v189|
    v_mfma_f32_16x16x32_bf16 v[204:207], a[116:119], v[164:167], v[204:207]
    v_cvt_pk_bf16_f32 v215, |v190|, |v191|
    v_cvt_pk_bf16_f32 v216, |v192|, |v193|
    v_mfma_f32_16x16x32_bf16 v[204:207], a[112:115], v[160:163], v[204:207]
    v_cvt_pk_bf16_f32 v217, |v194|, |v195|
    v_cvt_pk_bf16_f32 v218, |v196|, |v197|
    v_smfmac_f32_16x16x64_bf16 v[232:235], a[176:179], v[208:215], v1
    v_cvt_pk_bf16_f32 v219, |v198|, |v199|
    v_mfma_f32_16x16x32_bf16 v[176:179], a[0:3], v[144:147], v[112:115]
    v_cvt_pk_bf16_f32 v220, |v200|, |v201|
    v_cvt_pk_bf16_f32 v221, |v202|, |v203|
    v_mfma_f32_16x16x32_bf16 v[176:179], a[4:7], v[148:151], v[176:179]
    v_cvt_pk_bf16_f32 v222, |v204|, |v205|
    v_cvt_pk_bf16_f32 v223, |v206|, |v207|
    v_mfma_f32_16x16x32_bf16 v[176:179], a[8:11], v[152:155], v[176:179]
    v_mul_f32_dpp v224, v16, v16 row_ror:6 row_mask:0xf bank_mask:0xf
    v_mul_f32_dpp v225, v17, v17 row_ror:6 row_mask:0xf bank_mask:0xf
    v_mfma_f32_16x16x32_bf16 v[176:179], a[12:15], v[156:159], v[176:179]
    v_mul_f32_dpp v226, v18, v18 row_ror:6 row_mask:0xf bank_mask:0xf
    v_mul_f32_dpp v227, v19, v19 row_ror:6 row_mask:0xf bank_mask:0xf
    v_smfmac_f32_16x16x64_bf16 v[232:235], a[180:183], v[216:223], v1
    v_mul_f32_dpp v228, v20, v20 row_ror:6 row_mask:0xf bank_mask:0xf
    v_mfma_f32_16x16x32_bf16 v[180:183], a[28:31], v[156:159], v[116:119]
    v_mul_f32_dpp v229, v21, v21 row_ror:6 row_mask:0xf bank_mask:0xf
    v_mul_f32_dpp v230, v22, v22 row_ror:6 row_mask:0xf bank_mask:0xf
    v_mfma_f32_16x16x32_bf16 v[180:183], a[24:27], v[152:155], v[180:183]
    v_mul_f32_dpp v231, v23, v23 row_ror:6 row_mask:0xf bank_mask:0xf
    v_cvt_pk_bf16_f32 v160, v224, v225
    v_mfma_f32_16x16x32_bf16 v[180:183], a[20:23], v[148:151], v[180:183]
    v_cvt_pk_bf16_f32 v161, v226, v227
    v_cvt_pk_bf16_f32 v162, v228, v229
    v_mfma_f32_16x16x32_bf16 v[180:183], a[16:19], v[144:147], v[180:183]
    v_cvt_pk_bf16_f32 v163, v230, v231
    v_mul_f32_dpp v224, v24, v24 row_ror:6 row_mask:0xf bank_mask:0xf
    v_smfmac_f32_16x16x64_bf16 v[236:239], a[140:143], v[152:159], v1
    v_mul_f32_dpp v225, v25, v25 row_ror:6 row_mask:0xf bank_mask:0xf
    v_mfma_f32_16x16x32_bf16 v[184:187], a[32:35], v[144:147], v[120:123]
    v_mul_f32_dpp v226, v26, v26 row_ror:6 row_mask:0xf bank_mask:0xf
    v_mul_f32_dpp v227, v27, v27 row_ror:6 row_mask:0xf bank_mask:0xf
    v_mfma_f32_16x16x32_bf16 v[184:187], a[36:39], v[148:151], v[184:187]
    v_mul_f32_dpp v228, v28, v28 row_ror:6 row_mask:0xf bank_mask:0xf
    v_mul_f32_dpp v229, v29, v29 row_ror:6 row_mask:0xf bank_mask:0xf
    v_mfma_f32_16x16x32_bf16 v[184:187], a[40:43], v[152:155], v[184:187]
    v_mul_f32_dpp v230, v30, v30 row_ror:6 row_mask:0xf bank_mask:0xf
    v_mul_f32_dpp v231, v31, v31 row_ror:6 row_mask:0xf bank_mask:0xf
    v_mfma_f32_16x16x32_bf16 v[184:187], a[44:47], v[156:159], v[184:187]
    v_cvt_pk_bf16_f32 v208, |v176|, |v177|
    v_cvt_pk_bf16_f32 v209, |v178|, |v179|
    v_mfma_f32_16x16x32_bf16 v[188:191], a[60:63], v[156:159], v[124:127]
    v_cvt_pk_bf16_f32 v164, v224, v225
    v_cvt_pk_bf16_f32 v165, v226, v227
    v_mfma_f32_16x16x32_bf16 v[188:191], a[56:59], v[152:155], v[188:191]
    v_cvt_pk_bf16_f32 v166, v228, v229
    v_cvt_pk_bf16_f32 v167, v230, v231
    v_mfma_f32_16x16x32_bf16 v[188:191], a[52:55], v[148:151], v[188:191]
    v_mul_f32_dpp v224, v32, v32 row_ror:6 row_mask:0xf bank_mask:0xf
    v_mul_f32_dpp v225, v33, v33 row_ror:6 row_mask:0xf bank_mask:0xf
    v_mfma_f32_16x16x32_bf16 v[188:191], a[48:51], v[144:147], v[188:191]
    v_mul_f32_dpp v226, v34, v34 row_ror:6 row_mask:0xf bank_mask:0xf
    v_mul_f32_dpp v227, v35, v35 row_ror:6 row_mask:0xf bank_mask:0xf
    v_mfma_f32_16x16x32_bf16 v[192:195], a[64:67], v[144:147], v[128:131]
    v_mul_f32_dpp v228, v36, v36 row_ror:6 row_mask:0xf bank_mask:0xf
    v_mul_f32_dpp v229, v37, v37 row_ror:6 row_mask:0xf bank_mask:0xf
    v_mfma_f32_16x16x32_bf16 v[192:195], a[68:71], v[148:151], v[192:195]
    v_mul_f32_dpp v230, v38, v38 row_ror:6 row_mask:0xf bank_mask:0xf
    v_mul_f32_dpp v231, v39, v39 row_ror:6 row_mask:0xf bank_mask:0xf
    v_mfma_f32_16x16x32_bf16 v[192:195], a[72:75], v[152:155], v[192:195]
    v_cvt_pk_bf16_f32 v168, v224, v225
    v_cvt_pk_bf16_f32 v169, v226, v227
    v_mfma_f32_16x16x32_bf16 v[192:195], a[76:79], v[156:159], v[192:195]
    v_cvt_pk_bf16_f32 v170, v228, v229
    v_cvt_pk_bf16_f32 v171, v230, v231
    v_mfma_f32_16x16x32_bf16 v[196:199], a[92:95], v[156:159], v[132:135]
    v_mul_f32_dpp v224, v40, v40 row_ror:6 row_mask:0xf bank_mask:0xf
    v_mul_f32_dpp v225, v41, v41 row_ror:6 row_mask:0xf bank_mask:0xf
    v_mfma_f32_16x16x32_bf16 v[196:199], a[88:91], v[152:155], v[196:199]
    v_mul_f32_dpp v226, v42, v42 row_ror:6 row_mask:0xf bank_mask:0xf
    v_mul_f32_dpp v227, v43, v43 row_ror:6 row_mask:0xf bank_mask:0xf
    v_mfma_f32_16x16x32_bf16 v[196:199], a[84:87], v[148:151], v[196:199]
    v_mul_f32_dpp v228, v44, v44 row_ror:6 row_mask:0xf bank_mask:0xf
    v_mul_f32_dpp v229, v45, v45 row_ror:6 row_mask:0xf bank_mask:0xf
    v_mfma_f32_16x16x32_bf16 v[196:199], a[80:83], v[144:147], v[196:199]
    s_waitcnt vmcnt(0)
    v_mul_f32_dpp v230, v46, v46 row_ror:6 row_mask:0xf bank_mask:0xf
    v_mul_f32_dpp v231, v47, v47 row_ror:6 row_mask:0xf bank_mask:0xf
    v_mfma_f32_16x16x32_bf16 v[200:203], a[96:99], v[144:147], v[136:139]
    ds_read_b128 v[64:67], v2 offset:0
    v_cvt_pk_bf16_f32 v172, v224, v225
    v_cvt_pk_bf16_f32 v173, v226, v227
    v_mfma_f32_16x16x32_bf16 v[200:203], a[100:103], v[148:151], v[200:203]
    ds_read_b128 v[68:71], v2 offset:64
    v_cvt_pk_bf16_f32 v174, v228, v229
    v_cvt_pk_bf16_f32 v175, v230, v231
    v_mfma_f32_16x16x32_bf16 v[200:203], a[104:107], v[152:155], v[200:203]
    ds_read_b128 v[72:75], v2 offset:128
    v_cvt_pk_bf16_f32 v210, |v180|, |v181|
    v_cvt_pk_bf16_f32 v211, |v182|, |v183|
    v_mfma_f32_16x16x32_bf16 v[200:203], a[108:111], v[156:159], v[200:203]
    ds_read_b128 v[76:79], v2 offset:192
    v_cvt_pk_bf16_f32 v212, |v184|, |v185|
    v_cvt_pk_bf16_f32 v213, |v186|, |v187|
    v_mfma_f32_16x16x32_bf16 v[204:207], a[124:127], v[156:159], v[140:143]
    v_cvt_pk_bf16_f32 v214, |v188|, |v189|
    v_cvt_pk_bf16_f32 v215, |v190|, |v191|
    v_mfma_f32_16x16x32_bf16 v[204:207], a[120:123], v[152:155], v[204:207]
    v_cvt_pk_bf16_f32 v216, |v192|, |v193|
    v_cvt_pk_bf16_f32 v217, |v194|, |v195|
    v_mfma_f32_16x16x32_bf16 v[204:207], a[116:119], v[148:151], v[204:207]
    v_cvt_pk_bf16_f32 v218, |v196|, |v197|
    v_cvt_pk_bf16_f32 v219, |v198|, |v199|
    v_mfma_f32_16x16x32_bf16 v[204:207], a[112:115], v[144:147], v[204:207]
    v_cvt_pk_bf16_f32 v220, |v200|, |v201|
    v_cvt_pk_bf16_f32 v221, |v202|, |v203|
    v_smfmac_f32_16x16x64_bf16 v[236:239], a[128:131], v[208:215], v1
    v_mul_f32_dpp v224, v16, v16 row_ror:7 row_mask:0xf bank_mask:0xf
    v_mfma_f32_16x16x32_bf16 v[176:179], a[0:3], v[160:163], v[112:115]
    v_mul_f32_dpp v225, v17, v17 row_ror:7 row_mask:0xf bank_mask:0xf
    v_mul_f32_dpp v226, v18, v18 row_ror:7 row_mask:0xf bank_mask:0xf
    v_mfma_f32_16x16x32_bf16 v[176:179], a[4:7], v[164:167], v[176:179]
    v_cvt_pk_bf16_f32 v222, |v204|, |v205|
    v_cvt_pk_bf16_f32 v223, |v206|, |v207|
    v_mfma_f32_16x16x32_bf16 v[176:179], a[8:11], v[168:171], v[176:179]
    v_mul_f32_dpp v227, v19, v19 row_ror:7 row_mask:0xf bank_mask:0xf
    v_mul_f32_dpp v228, v20, v20 row_ror:7 row_mask:0xf bank_mask:0xf
    v_mfma_f32_16x16x32_bf16 v[176:179], a[12:15], v[172:175], v[176:179]
    s_waitcnt lgkmcnt(0)
    v_mul_f32_dpp v229, v21, v21 row_ror:7 row_mask:0xf bank_mask:0xf
    v_mul_f32_dpp v230, v22, v22 row_ror:7 row_mask:0xf bank_mask:0xf
    v_smfmac_f32_16x16x64_bf16 v[236:239], a[132:135], v[216:223], v1
    v_mul_f32_dpp v231, v23, v23 row_ror:7 row_mask:0xf bank_mask:0xf
    v_mfma_f32_16x16x32_bf16 v[180:183], a[28:31], v[172:175], v[116:119]
    v_cvt_pk_bf16_f32 v144, v224, v225
    v_cvt_pk_bf16_f32 v145, v226, v227
    v_mfma_f32_16x16x32_bf16 v[180:183], a[24:27], v[168:171], v[180:183]
    v_cvt_pk_bf16_f32 v146, v228, v229
    v_cvt_pk_bf16_f32 v147, v230, v231
    v_mfma_f32_16x16x32_bf16 v[180:183], a[20:23], v[164:167], v[180:183]
    v_mul_f32_dpp v224, v24, v24 row_ror:7 row_mask:0xf bank_mask:0xf
    v_mul_f32_dpp v225, v25, v25 row_ror:7 row_mask:0xf bank_mask:0xf
    v_mfma_f32_16x16x32_bf16 v[180:183], a[16:19], v[160:163], v[180:183]
    v_mul_f32_dpp v226, v26, v26 row_ror:7 row_mask:0xf bank_mask:0xf
    v_mul_f32_dpp v227, v27, v27 row_ror:7 row_mask:0xf bank_mask:0xf
    v_smfmac_f32_16x16x64_bf16 v[236:239], a[152:155], v[160:167], v1
    v_mul_f32_dpp v228, v28, v28 row_ror:7 row_mask:0xf bank_mask:0xf
    v_mfma_f32_16x16x32_bf16 v[184:187], a[32:35], v[160:163], v[120:123]
    v_mul_f32_dpp v229, v29, v29 row_ror:7 row_mask:0xf bank_mask:0xf
    v_mul_f32_dpp v230, v30, v30 row_ror:7 row_mask:0xf bank_mask:0xf
    v_mfma_f32_16x16x32_bf16 v[184:187], a[36:39], v[164:167], v[184:187]
    v_mul_f32_dpp v231, v31, v31 row_ror:7 row_mask:0xf bank_mask:0xf
    v_cvt_pk_bf16_f32 v208, |v176|, |v177|
    v_mfma_f32_16x16x32_bf16 v[184:187], a[40:43], v[168:171], v[184:187]
    v_cvt_pk_bf16_f32 v209, |v178|, |v179|
    v_cvt_pk_bf16_f32 v148, v224, v225
    v_mfma_f32_16x16x32_bf16 v[184:187], a[44:47], v[172:175], v[184:187]
    v_cvt_pk_bf16_f32 v149, v226, v227
    v_cvt_pk_bf16_f32 v150, v228, v229
    v_smfmac_f32_16x16x64_bf16 v[236:239], a[156:159], v[168:175], v1
    v_cvt_pk_bf16_f32 v151, v230, v231
    v_mfma_f32_16x16x32_bf16 v[188:191], a[60:63], v[172:175], v[124:127]
    v_mul_f32_dpp v224, v32, v32 row_ror:7 row_mask:0xf bank_mask:0xf
    v_mul_f32_dpp v225, v33, v33 row_ror:7 row_mask:0xf bank_mask:0xf
    v_mfma_f32_16x16x32_bf16 v[188:191], a[56:59], v[168:171], v[188:191]
    v_mul_f32_dpp v226, v34, v34 row_ror:7 row_mask:0xf bank_mask:0xf
    v_mul_f32_dpp v227, v35, v35 row_ror:7 row_mask:0xf bank_mask:0xf
    v_mfma_f32_16x16x32_bf16 v[188:191], a[52:55], v[164:167], v[188:191]
    v_mul_f32_dpp v228, v36, v36 row_ror:7 row_mask:0xf bank_mask:0xf
    v_mul_f32_dpp v229, v37, v37 row_ror:7 row_mask:0xf bank_mask:0xf
    v_mfma_f32_16x16x32_bf16 v[188:191], a[48:51], v[160:163], v[188:191]
    v_mul_f32_dpp v230, v38, v38 row_ror:7 row_mask:0xf bank_mask:0xf
    v_mul_f32_dpp v231, v39, v39 row_ror:7 row_mask:0xf bank_mask:0xf
    v_mfma_f32_16x16x32_bf16 v[192:195], a[64:67], v[160:163], v[128:131]
    v_cvt_pk_bf16_f32 v152, v224, v225
    v_cvt_pk_bf16_f32 v153, v226, v227
    v_mfma_f32_16x16x32_bf16 v[192:195], a[68:71], v[164:167], v[192:195]
    v_cvt_pk_bf16_f32 v154, v228, v229
    v_cvt_pk_bf16_f32 v155, v230, v231
    v_mfma_f32_16x16x32_bf16 v[192:195], a[72:75], v[168:171], v[192:195]
    v_mul_f32_dpp v224, v40, v40 row_ror:7 row_mask:0xf bank_mask:0xf
    v_mul_f32_dpp v225, v41, v41 row_ror:7 row_mask:0xf bank_mask:0xf
    v_mfma_f32_16x16x32_bf16 v[192:195], a[76:79], v[172:175], v[192:195]
    v_mul_f32_dpp v226, v42, v42 row_ror:7 row_mask:0xf bank_mask:0xf
    v_mul_f32_dpp v227, v43, v43 row_ror:7 row_mask:0xf bank_mask:0xf
    v_mfma_f32_16x16x32_bf16 v[196:199], a[92:95], v[172:175], v[132:135]
    v_mul_f32_dpp v228, v44, v44 row_ror:7 row_mask:0xf bank_mask:0xf
    v_mul_f32_dpp v229, v45, v45 row_ror:7 row_mask:0xf bank_mask:0xf
    v_mfma_f32_16x16x32_bf16 v[196:199], a[88:91], v[168:171], v[196:199]
    v_mul_f32_dpp v230, v46, v46 row_ror:7 row_mask:0xf bank_mask:0xf
    v_mul_f32_dpp v231, v47, v47 row_ror:7 row_mask:0xf bank_mask:0xf
    v_mfma_f32_16x16x32_bf16 v[196:199], a[84:87], v[164:167], v[196:199]
    v_cvt_pk_bf16_f32 v156, v224, v225
    v_cvt_pk_bf16_f32 v157, v226, v227
    v_mfma_f32_16x16x32_bf16 v[196:199], a[80:83], v[160:163], v[196:199]
    v_cvt_pk_bf16_f32 v158, v228, v229
    v_cvt_pk_bf16_f32 v159, v230, v231
    v_mfma_f32_16x16x32_bf16 v[200:203], a[96:99], v[160:163], v[136:139]
    v_cvt_pk_bf16_f32 v210, |v180|, |v181|
    v_cvt_pk_bf16_f32 v211, |v182|, |v183|
    v_mfma_f32_16x16x32_bf16 v[200:203], a[100:103], v[164:167], v[200:203]
    v_cvt_pk_bf16_f32 v212, |v184|, |v185|
    v_cvt_pk_bf16_f32 v213, |v186|, |v187|
    v_mfma_f32_16x16x32_bf16 v[200:203], a[104:107], v[168:171], v[200:203]
    v_cvt_pk_bf16_f32 v214, |v188|, |v189|
    v_cvt_pk_bf16_f32 v215, |v190|, |v191|
    v_mfma_f32_16x16x32_bf16 v[200:203], a[108:111], v[172:175], v[200:203]
    v_cvt_pk_bf16_f32 v216, |v192|, |v193|
    v_cvt_pk_bf16_f32 v217, |v194|, |v195|
    v_smfmac_f32_16x16x64_bf16 v[236:239], a[144:147], v[208:215], v1
    v_cvt_pk_bf16_f32 v218, |v196|, |v197|
    v_mfma_f32_16x16x32_bf16 v[204:207], a[124:127], v[172:175], v[140:143]
    v_cvt_pk_bf16_f32 v219, |v198|, |v199|
    v_lshlrev_b32 v48, 16, v64
    v_mfma_f32_16x16x32_bf16 v[204:207], a[120:123], v[168:171], v[204:207]
    v_cvt_pk_bf16_f32 v220, |v200|, |v201|
    v_cvt_pk_bf16_f32 v221, |v202|, |v203|
    v_mfma_f32_16x16x32_bf16 v[204:207], a[116:119], v[164:167], v[204:207]
    v_and_b32 v49, 0xffff0000, v64
    v_lshlrev_b32 v50, 16, v65
    v_mfma_f32_16x16x32_bf16 v[204:207], a[112:115], v[160:163], v[204:207]
    v_and_b32 v51, 0xffff0000, v65
    v_lshlrev_b32 v52, 16, v66
    v_mfma_f32_16x16x32_bf16 v[176:179], a[0:3], v[144:147], v[112:115]
    v_and_b32 v53, 0xffff0000, v66
    v_lshlrev_b32 v54, 16, v67
    v_mfma_f32_16x16x32_bf16 v[176:179], a[4:7], v[148:151], v[176:179]
    v_and_b32 v55, 0xffff0000, v67
    v_lshlrev_b32 v56, 16, v68
    v_mfma_f32_16x16x32_bf16 v[176:179], a[8:11], v[152:155], v[176:179]
    v_cvt_pk_bf16_f32 v222, |v204|, |v205|
    v_cvt_pk_bf16_f32 v223, |v206|, |v207|
    v_mfma_f32_16x16x32_bf16 v[176:179], a[12:15], v[156:159], v[176:179]
    v_and_b32 v57, 0xffff0000, v68
    v_lshlrev_b32 v58, 16, v69
    v_smfmac_f32_16x16x64_bf16 v[236:239], a[148:151], v[216:223], v1
    v_and_b32 v59, 0xffff0000, v69
    v_mfma_f32_16x16x32_bf16 v[180:183], a[28:31], v[156:159], v[116:119]
    v_lshlrev_b32 v60, 16, v70
    v_and_b32 v61, 0xffff0000, v70
    v_mfma_f32_16x16x32_bf16 v[180:183], a[24:27], v[152:155], v[180:183]
    v_lshlrev_b32 v62, 16, v71
    v_and_b32 v63, 0xffff0000, v71
    v_mfma_f32_16x16x32_bf16 v[180:183], a[20:23], v[148:151], v[180:183]
    v_mul_f32_dpp v224, v48, v16 row_newbcast:14 row_mask:0xf bank_mask:0xf
    v_mul_f32_dpp v225, v49, v17 row_newbcast:14 row_mask:0xf bank_mask:0xf
    v_mfma_f32_16x16x32_bf16 v[180:183], a[16:19], v[144:147], v[180:183]
    v_mul_f32_dpp v226, v50, v18 row_newbcast:14 row_mask:0xf bank_mask:0xf
    v_mul_f32_dpp v227, v51, v19 row_newbcast:14 row_mask:0xf bank_mask:0xf
    v_smfmac_f32_16x16x64_bf16 v[236:239], a[168:171], v[144:151], v1
    v_mul_f32_dpp v228, v52, v20 row_newbcast:14 row_mask:0xf bank_mask:0xf
    v_mfma_f32_16x16x32_bf16 v[184:187], a[32:35], v[144:147], v[120:123]
    v_mul_f32_dpp v229, v53, v21 row_newbcast:14 row_mask:0xf bank_mask:0xf
    v_mul_f32_dpp v230, v54, v22 row_newbcast:14 row_mask:0xf bank_mask:0xf
    v_mfma_f32_16x16x32_bf16 v[184:187], a[36:39], v[148:151], v[184:187]
    v_mul_f32_dpp v231, v55, v23 row_newbcast:14 row_mask:0xf bank_mask:0xf
    v_lshlrev_b32 v64, 16, v72
    v_mfma_f32_16x16x32_bf16 v[184:187], a[40:43], v[152:155], v[184:187]
    v_and_b32 v65, 0xffff0000, v72
    v_lshlrev_b32 v66, 16, v73
    v_mfma_f32_16x16x32_bf16 v[184:187], a[44:47], v[156:159], v[184:187]
    v_and_b32 v67, 0xffff0000, v73
    v_lshlrev_b32 v68, 16, v74
    v_smfmac_f32_16x16x64_bf16 v[236:239], a[172:175], v[152:159], v1
    v_and_b32 v69, 0xffff0000, v74
    v_mfma_f32_16x16x32_bf16 v[188:191], a[60:63], v[156:159], v[124:127]
    v_lshlrev_b32 v70, 16, v75
    v_and_b32 v71, 0xffff0000, v75
    v_mfma_f32_16x16x32_bf16 v[188:191], a[56:59], v[152:155], v[188:191]
    v_cvt_pk_bf16_f32 v160, v224, v225
    v_cvt_pk_bf16_f32 v161, v226, v227
    v_mfma_f32_16x16x32_bf16 v[188:191], a[52:55], v[148:151], v[188:191]
    v_cvt_pk_bf16_f32 v162, v228, v229
    v_cvt_pk_bf16_f32 v163, v230, v231
    v_mfma_f32_16x16x32_bf16 v[188:191], a[48:51], v[144:147], v[188:191]
    v_lshlrev_b32 v72, 16, v76
    v_and_b32 v73, 0xffff0000, v76
    v_mfma_f32_16x16x32_bf16 v[192:195], a[64:67], v[144:147], v[128:131]
    v_lshlrev_b32 v74, 16, v77
    v_and_b32 v75, 0xffff0000, v77
    v_mfma_f32_16x16x32_bf16 v[192:195], a[68:71], v[148:151], v[192:195]
    v_lshlrev_b32 v76, 16, v78
    v_and_b32 v77, 0xffff0000, v78
    v_mfma_f32_16x16x32_bf16 v[192:195], a[72:75], v[152:155], v[192:195]
    v_mul_f32_dpp v224, v56, v24 row_newbcast:14 row_mask:0xf bank_mask:0xf
    v_mul_f32_dpp v225, v57, v25 row_newbcast:14 row_mask:0xf bank_mask:0xf
    v_mfma_f32_16x16x32_bf16 v[192:195], a[76:79], v[156:159], v[192:195]
    v_mul_f32_dpp v226, v58, v26 row_newbcast:14 row_mask:0xf bank_mask:0xf
    v_mul_f32_dpp v227, v59, v27 row_newbcast:14 row_mask:0xf bank_mask:0xf
    v_mfma_f32_16x16x32_bf16 v[196:199], a[92:95], v[156:159], v[132:135]
    v_mul_f32_dpp v228, v60, v28 row_newbcast:14 row_mask:0xf bank_mask:0xf
    v_mul_f32_dpp v229, v61, v29 row_newbcast:14 row_mask:0xf bank_mask:0xf
    v_mfma_f32_16x16x32_bf16 v[196:199], a[88:91], v[152:155], v[196:199]
    v_mul_f32_dpp v230, v62, v30 row_newbcast:14 row_mask:0xf bank_mask:0xf
    v_mul_f32_dpp v231, v63, v31 row_newbcast:14 row_mask:0xf bank_mask:0xf
    v_mfma_f32_16x16x32_bf16 v[196:199], a[84:87], v[148:151], v[196:199]
    v_cvt_pk_bf16_f32 v208, |v176|, |v177|
    v_cvt_pk_bf16_f32 v209, |v178|, |v179|
    v_mfma_f32_16x16x32_bf16 v[196:199], a[80:83], v[144:147], v[196:199]
    v_lshlrev_b32 v78, 16, v79
    v_cvt_pk_bf16_f32 v164, v224, v225
    v_mfma_f32_16x16x32_bf16 v[200:203], a[96:99], v[144:147], v[136:139]
    v_cvt_pk_bf16_f32 v165, v226, v227
    v_cvt_pk_bf16_f32 v166, v228, v229
    v_mfma_f32_16x16x32_bf16 v[200:203], a[100:103], v[148:151], v[200:203]
    v_cvt_pk_bf16_f32 v167, v230, v231
    v_and_b32 v79, 0xffff0000, v79
    v_mfma_f32_16x16x32_bf16 v[200:203], a[104:107], v[152:155], v[200:203]
    v_mul_f32_dpp v224, v64, v32 row_newbcast:14 row_mask:0xf bank_mask:0xf
    v_mul_f32_dpp v225, v65, v33 row_newbcast:14 row_mask:0xf bank_mask:0xf
    v_mfma_f32_16x16x32_bf16 v[200:203], a[108:111], v[156:159], v[200:203]
    v_mul_f32_dpp v226, v66, v34 row_newbcast:14 row_mask:0xf bank_mask:0xf
    v_mul_f32_dpp v227, v67, v35 row_newbcast:14 row_mask:0xf bank_mask:0xf
    v_mfma_f32_16x16x32_bf16 v[204:207], a[124:127], v[156:159], v[140:143]
    v_mul_f32_dpp v228, v68, v36 row_newbcast:14 row_mask:0xf bank_mask:0xf
    v_mul_f32_dpp v229, v69, v37 row_newbcast:14 row_mask:0xf bank_mask:0xf
    v_mfma_f32_16x16x32_bf16 v[204:207], a[120:123], v[152:155], v[204:207]
    v_mul_f32_dpp v230, v70, v38 row_newbcast:14 row_mask:0xf bank_mask:0xf
    v_mul_f32_dpp v231, v71, v39 row_newbcast:14 row_mask:0xf bank_mask:0xf
    v_mfma_f32_16x16x32_bf16 v[204:207], a[116:119], v[148:151], v[204:207]
    v_cvt_pk_bf16_f32 v168, v224, v225
    v_cvt_pk_bf16_f32 v169, v226, v227
    v_mfma_f32_16x16x32_bf16 v[204:207], a[112:115], v[144:147], v[204:207]
    v_cvt_pk_bf16_f32 v170, v228, v229
    v_cvt_pk_bf16_f32 v171, v230, v231
    v_mfma_f32_16x16x32_bf16 v[176:179], a[0:3], v[160:163], v[112:115]
    v_mul_f32_dpp v224, v72, v40 row_newbcast:14 row_mask:0xf bank_mask:0xf
    v_mul_f32_dpp v225, v73, v41 row_newbcast:14 row_mask:0xf bank_mask:0xf
    v_mfma_f32_16x16x32_bf16 v[176:179], a[4:7], v[164:167], v[176:179]
    v_mul_f32_dpp v226, v74, v42 row_newbcast:14 row_mask:0xf bank_mask:0xf
    v_mul_f32_dpp v227, v75, v43 row_newbcast:14 row_mask:0xf bank_mask:0xf
    v_mfma_f32_16x16x32_bf16 v[176:179], a[8:11], v[168:171], v[176:179]
    v_mul_f32_dpp v228, v76, v44 row_newbcast:14 row_mask:0xf bank_mask:0xf
    v_mul_f32_dpp v229, v77, v45 row_newbcast:14 row_mask:0xf bank_mask:0xf
    v_mul_f32_dpp v230, v78, v46 row_newbcast:14 row_mask:0xf bank_mask:0xf
    v_mul_f32_dpp v231, v79, v47 row_newbcast:14 row_mask:0xf bank_mask:0xf
    v_cvt_pk_bf16_f32 v172, v224, v225
    v_cvt_pk_bf16_f32 v173, v226, v227
    v_cvt_pk_bf16_f32 v174, v228, v229
    v_cvt_pk_bf16_f32 v175, v230, v231
    v_cvt_pk_bf16_f32 v210, |v180|, |v181|
    v_cvt_pk_bf16_f32 v211, |v182|, |v183|
    v_mfma_f32_16x16x32_bf16 v[176:179], a[12:15], v[172:175], v[176:179]
    v_cvt_pk_bf16_f32 v212, |v184|, |v185|
    v_cvt_pk_bf16_f32 v213, |v186|, |v187|
    v_mfma_f32_16x16x32_bf16 v[180:183], a[28:31], v[172:175], v[116:119]
    v_cvt_pk_bf16_f32 v214, |v188|, |v189|
    v_cvt_pk_bf16_f32 v215, |v190|, |v191|
    v_mfma_f32_16x16x32_bf16 v[180:183], a[24:27], v[168:171], v[180:183]
    v_cvt_pk_bf16_f32 v216, |v192|, |v193|
    v_cvt_pk_bf16_f32 v217, |v194|, |v195|
    v_mfma_f32_16x16x32_bf16 v[180:183], a[20:23], v[164:167], v[180:183]
    v_cvt_pk_bf16_f32 v218, |v196|, |v197|
    v_cvt_pk_bf16_f32 v219, |v198|, |v199|
    v_mfma_f32_16x16x32_bf16 v[180:183], a[16:19], v[160:163], v[180:183]
    v_cvt_pk_bf16_f32 v220, |v200|, |v201|
    v_cvt_pk_bf16_f32 v221, |v202|, |v203|
    v_smfmac_f32_16x16x64_bf16 v[236:239], a[160:163], v[208:215], v1
    v_cvt_pk_bf16_f32 v222, |v204|, |v205|
    v_mfma_f32_16x16x32_bf16 v[184:187], a[32:35], v[160:163], v[120:123]
    v_cvt_pk_bf16_f32 v223, |v206|, |v207|
    v_mul_f32_dpp v224, v48, v16 row_newbcast:2 row_mask:0xf bank_mask:0xf
    v_mfma_f32_16x16x32_bf16 v[184:187], a[36:39], v[164:167], v[184:187]
    v_mul_f32_dpp v225, v49, v17 row_newbcast:2 row_mask:0xf bank_mask:0xf
    v_mul_f32_dpp v226, v50, v18 row_newbcast:2 row_mask:0xf bank_mask:0xf
    v_mfma_f32_16x16x32_bf16 v[184:187], a[40:43], v[168:171], v[184:187]
    v_mul_f32_dpp v227, v51, v19 row_newbcast:2 row_mask:0xf bank_mask:0xf
    v_mul_f32_dpp v228, v52, v20 row_newbcast:2 row_mask:0xf bank_mask:0xf
    v_mfma_f32_16x16x32_bf16 v[184:187], a[44:47], v[172:175], v[184:187]
    v_mul_f32_dpp v229, v53, v21 row_newbcast:2 row_mask:0xf bank_mask:0xf
    v_mul_f32_dpp v230, v54, v22 row_newbcast:2 row_mask:0xf bank_mask:0xf
    v_smfmac_f32_16x16x64_bf16 v[236:239], a[164:167], v[216:223], v1
    v_mul_f32_dpp v231, v55, v23 row_newbcast:2 row_mask:0xf bank_mask:0xf
    v_mfma_f32_16x16x32_bf16 v[188:191], a[60:63], v[172:175], v[124:127]
    v_cvt_pk_bf16_f32 v144, v224, v225
    v_cvt_pk_bf16_f32 v145, v226, v227
    v_mfma_f32_16x16x32_bf16 v[188:191], a[56:59], v[168:171], v[188:191]
    v_cvt_pk_bf16_f32 v146, v228, v229
    v_cvt_pk_bf16_f32 v147, v230, v231
    v_mfma_f32_16x16x32_bf16 v[188:191], a[52:55], v[164:167], v[188:191]
    v_mul_f32_dpp v224, v56, v24 row_newbcast:2 row_mask:0xf bank_mask:0xf
    v_mul_f32_dpp v225, v57, v25 row_newbcast:2 row_mask:0xf bank_mask:0xf
    v_mfma_f32_16x16x32_bf16 v[188:191], a[48:51], v[160:163], v[188:191]
    v_mul_f32_dpp v226, v58, v26 row_newbcast:2 row_mask:0xf bank_mask:0xf
    v_mul_f32_dpp v227, v59, v27 row_newbcast:2 row_mask:0xf bank_mask:0xf
    v_smfmac_f32_16x16x64_bf16 v[236:239], a[184:187], v[160:167], v1
    v_mul_f32_dpp v228, v60, v28 row_newbcast:2 row_mask:0xf bank_mask:0xf
    v_mfma_f32_16x16x32_bf16 v[192:195], a[64:67], v[160:163], v[128:131]
    v_mul_f32_dpp v229, v61, v29 row_newbcast:2 row_mask:0xf bank_mask:0xf
    v_mul_f32_dpp v230, v62, v30 row_newbcast:2 row_mask:0xf bank_mask:0xf
    v_mfma_f32_16x16x32_bf16 v[192:195], a[68:71], v[164:167], v[192:195]
    v_mul_f32_dpp v231, v63, v31 row_newbcast:2 row_mask:0xf bank_mask:0xf
    v_cvt_pk_bf16_f32 v208, |v176|, |v177|
    v_mfma_f32_16x16x32_bf16 v[192:195], a[72:75], v[168:171], v[192:195]
    v_cvt_pk_bf16_f32 v209, |v178|, |v179|
    v_cvt_pk_bf16_f32 v148, v224, v225
    v_mfma_f32_16x16x32_bf16 v[192:195], a[76:79], v[172:175], v[192:195]
    v_cvt_pk_bf16_f32 v149, v226, v227
    v_cvt_pk_bf16_f32 v150, v228, v229
    v_smfmac_f32_16x16x64_bf16 v[236:239], a[188:191], v[168:175], v1
    v_cvt_pk_bf16_f32 v151, v230, v231
    v_mfma_f32_16x16x32_bf16 v[196:199], a[92:95], v[172:175], v[132:135]
    v_mul_f32_dpp v224, v64, v32 row_newbcast:2 row_mask:0xf bank_mask:0xf
    v_mul_f32_dpp v225, v65, v33 row_newbcast:2 row_mask:0xf bank_mask:0xf
    v_mfma_f32_16x16x32_bf16 v[196:199], a[88:91], v[168:171], v[196:199]
    v_mul_f32_dpp v226, v66, v34 row_newbcast:2 row_mask:0xf bank_mask:0xf
    v_mul_f32_dpp v227, v67, v35 row_newbcast:2 row_mask:0xf bank_mask:0xf
    v_mfma_f32_16x16x32_bf16 v[196:199], a[84:87], v[164:167], v[196:199]
    v_mul_f32_dpp v228, v68, v36 row_newbcast:2 row_mask:0xf bank_mask:0xf
    v_mul_f32_dpp v229, v69, v37 row_newbcast:2 row_mask:0xf bank_mask:0xf
    v_mfma_f32_16x16x32_bf16 v[196:199], a[80:83], v[160:163], v[196:199]
    v_mul_f32_dpp v230, v70, v38 row_newbcast:2 row_mask:0xf bank_mask:0xf
    v_mul_f32_dpp v231, v71, v39 row_newbcast:2 row_mask:0xf bank_mask:0xf
    v_smfmac_f32_16x16x64_bf16 v[240:243], a[136:139], v[144:151], v1
    v_cvt_pk_bf16_f32 v152, v224, v225
    v_mfma_f32_16x16x32_bf16 v[200:203], a[96:99], v[160:163], v[136:139]
    v_cvt_pk_bf16_f32 v153, v226, v227
    v_cvt_pk_bf16_f32 v154, v228, v229
    v_mfma_f32_16x16x32_bf16 v[200:203], a[100:103], v[164:167], v[200:203]
    v_cvt_pk_bf16_f32 v155, v230, v231
    v_mul_f32_dpp v224, v72, v40 row_newbcast:2 row_mask:0xf bank_mask:0xf
    v_mfma_f32_16x16x32_bf16 v[200:203], a[104:107], v[168:171], v[200:203]
    v_mul_f32_dpp v225, v73, v41 row_newbcast:2 row_mask:0xf bank_mask:0xf
    v_mul_f32_dpp v226, v74, v42 row_newbcast:2 row_mask:0xf bank_mask:0xf
    v_mfma_f32_16x16x32_bf16 v[200:203], a[108:111], v[172:175], v[200:203]
    v_mul_f32_dpp v227, v75, v43 row_newbcast:2 row_mask:0xf bank_mask:0xf
    v_mul_f32_dpp v228, v76, v44 row_newbcast:2 row_mask:0xf bank_mask:0xf
    v_mfma_f32_16x16x32_bf16 v[204:207], a[124:127], v[172:175], v[140:143]
    v_mul_f32_dpp v229, v77, v45 row_newbcast:2 row_mask:0xf bank_mask:0xf
    v_mul_f32_dpp v230, v78, v46 row_newbcast:2 row_mask:0xf bank_mask:0xf
    v_mfma_f32_16x16x32_bf16 v[204:207], a[120:123], v[168:171], v[204:207]
    v_mul_f32_dpp v231, v79, v47 row_newbcast:2 row_mask:0xf bank_mask:0xf
    v_cvt_pk_bf16_f32 v156, v224, v225
    v_mfma_f32_16x16x32_bf16 v[204:207], a[116:119], v[164:167], v[204:207]
    v_cvt_pk_bf16_f32 v157, v226, v227
    v_cvt_pk_bf16_f32 v158, v228, v229
    v_mfma_f32_16x16x32_bf16 v[204:207], a[112:115], v[160:163], v[204:207]
L_stub1:
    s_cbranch_scc1 L_main2
    v_cvt_pk_bf16_f32 v159, v230, v231
    v_cvt_pk_bf16_f32 v210, |v180|, |v181|
    v_mfma_f32_16x16x32_bf16 v[176:179], a[0:3], v[144:147], v[112:115]
    v_cvt_pk_bf16_f32 v211, |v182|, |v183|
    v_cvt_pk_bf16_f32 v212, |v184|, |v185|
    v_mfma_f32_16x16x32_bf16 v[176:179], a[4:7], v[148:151], v[176:179]
    v_cvt_pk_bf16_f32 v213, |v186|, |v187|
    v_cvt_pk_bf16_f32 v214, |v188|, |v189|
    v_mfma_f32_16x16x32_bf16 v[176:179], a[8:11], v[152:155], v[176:179]
    v_cvt_pk_bf16_f32 v215, |v190|, |v191|
    v_cvt_pk_bf16_f32 v216, |v192|, |v193|
    v_mfma_f32_16x16x32_bf16 v[176:179], a[12:15], v[156:159], v[176:179]
    v_cvt_pk_bf16_f32 v217, |v194|, |v195|
    v_cvt_pk_bf16_f32 v218, |v196|, |v197|
    v_smfmac_f32_16x16x64_bf16 v[236:239], a[176:179], v[208:215], v1
    v_cvt_pk_bf16_f32 v219, |v198|, |v199|
    v_mfma_f32_16x16x32_bf16 v[180:183], a[28:31], v[156:159], v[116:119]
    v_cvt_pk_bf16_f32 v220, |v200|, |v201|
    v_cvt_pk_bf16_f32 v221, |v202|, |v203|
    v_mfma_f32_16x16x32_bf16 v[180:183], a[24:27], v[152:155], v[180:183]
    v_cvt_pk_bf16_f32 v222, |v204|, |v205|
    v_cvt_pk_bf16_f32 v223, |v206|, |v207|
    v_mfma_f32_16x16x32_bf16 v[180:183], a[20:23], v[148:151], v[180:183]
    v_mul_f32_dpp v224, v48, v16 row_newbcast:5 row_mask:0xf bank_mask:0xf
    v_mul_f32_dpp v225, v49, v17 row_newbcast:5 row_mask:0xf bank_mask:0xf
    v_mfma_f32_16x16x32_bf16 v[180:183], a[16:19], v[144:147], v[180:183]
    v_mul_f32_dpp v226, v50, v18 row_newbcast:5 row_mask:0xf bank_mask:0xf
    v_mul_f32_dpp v227, v51, v19 row_newbcast:5 row_mask:0xf bank_mask:0xf
    v_smfmac_f32_16x16x64_bf16 v[236:239], a[180:183], v[216:223], v1
    v_mul_f32_dpp v228, v52, v20 row_newbcast:5 row_mask:0xf bank_mask:0xf
    v_mfma_f32_16x16x32_bf16 v[184:187], a[32:35], v[144:147], v[120:123]
    v_mul_f32_dpp v229, v53, v21 row_newbcast:5 row_mask:0xf bank_mask:0xf
    v_mul_f32_dpp v230, v54, v22 row_newbcast:5 row_mask:0xf bank_mask:0xf
    v_mfma_f32_16x16x32_bf16 v[184:187], a[36:39], v[148:151], v[184:187]
    v_mul_f32_dpp v231, v55, v23 row_newbcast:5 row_mask:0xf bank_mask:0xf
    v_cvt_pk_bf16_f32 v160, v224, v225
    v_mfma_f32_16x16x32_bf16 v[184:187], a[40:43], v[152:155], v[184:187]
    s_waitcnt vmcnt(0)
    v_cvt_pk_bf16_f32 v161, v226, v227
    v_cvt_pk_bf16_f32 v162, v228, v229
    v_mfma_f32_16x16x32_bf16 v[184:187], a[44:47], v[156:159], v[184:187]
    ds_read_b128 v[96:99], v6 offset:0
    v_cvt_pk_bf16_f32 v163, v230, v231
    v_mul_f32_dpp v224, v56, v24 row_newbcast:5 row_mask:0xf bank_mask:0xf
    v_smfmac_f32_16x16x64_bf16 v[240:243], a[140:143], v[152:159], v1
    v_mul_f32_dpp v225, v57, v25 row_newbcast:5 row_mask:0xf bank_mask:0xf
    v_mfma_f32_16x16x32_bf16 v[188:191], a[60:63], v[156:159], v[124:127]
    ds_read_b128 v[100:103], v6 offset:64
    v_mul_f32_dpp v226, v58, v26 row_newbcast:5 row_mask:0xf bank_mask:0xf
    v_mul_f32_dpp v227, v59, v27 row_newbcast:5 row_mask:0xf bank_mask:0xf
    v_mfma_f32_16x16x32_bf16 v[188:191], a[56:59], v[152:155], v[188:191]
    ds_read_b128 v[104:107], v6 offset:128
    v_mul_f32_dpp v228, v60, v28 row_newbcast:5 row_mask:0xf bank_mask:0xf
    v_mul_f32_dpp v229, v61, v29 row_newbcast:5 row_mask:0xf bank_mask:0xf
    v_mfma_f32_16x16x32_bf16 v[188:191], a[52:55], v[148:151], v[188:191]
    ds_read_b128 v[108:111], v6 offset:192
    v_mul_f32_dpp v230, v62, v30 row_newbcast:5 row_mask:0xf bank_mask:0xf
    v_mul_f32_dpp v231, v63, v31 row_newbcast:5 row_mask:0xf bank_mask:0xf
    v_mfma_f32_16x16x32_bf16 v[188:191], a[48:51], v[144:147], v[188:191]
    v_cvt_pk_bf16_f32 v208, |v176|, |v177|
    v_cvt_pk_bf16_f32 v209, |v178|, |v179|
    v_mfma_f32_16x16x32_bf16 v[192:195], a[64:67], v[144:147], v[128:131]
    v_cvt_pk_bf16_f32 v164, v224, v225
    v_cvt_pk_bf16_f32 v165, v226, v227
    v_mfma_f32_16x16x32_bf16 v[192:195], a[68:71], v[148:151], v[192:195]
    v_cvt_pk_bf16_f32 v166, v228, v229
    v_cvt_pk_bf16_f32 v167, v230, v231
    v_mfma_f32_16x16x32_bf16 v[192:195], a[72:75], v[152:155], v[192:195]
    v_mul_f32_dpp v224, v64, v32 row_newbcast:5 row_mask:0xf bank_mask:0xf
    v_mul_f32_dpp v225, v65, v33 row_newbcast:5 row_mask:0xf bank_mask:0xf
    v_mfma_f32_16x16x32_bf16 v[192:195], a[76:79], v[156:159], v[192:195]
    v_mul_f32_dpp v226, v66, v34 row_newbcast:5 row_mask:0xf bank_mask:0xf
    v_mul_f32_dpp v227, v67, v35 row_newbcast:5 row_mask:0xf bank_mask:0xf
    v_mfma_f32_16x16x32_bf16 v[196:199], a[92:95], v[156:159], v[132:135]
    v_mul_f32_dpp v228, v68, v36 row_newbcast:5 row_mask:0xf bank_mask:0xf
    v_mul_f32_dpp v229, v69, v37 row_newbcast:5 row_mask:0xf bank_mask:0xf
    v_mfma_f32_16x16x32_bf16 v[196:199], a[88:91], v[152:155], v[196:199]
    v_mul_f32_dpp v230, v70, v38 row_newbcast:5 row_mask:0xf bank_mask:0xf
    v_mul_f32_dpp v231, v71, v39 row_newbcast:5 row_mask:0xf bank_mask:0xf
    v_mfma_f32_16x16x32_bf16 v[196:199], a[84:87], v[148:151], v[196:199]
    s_waitcnt lgkmcnt(0)
    v_cvt_pk_bf16_f32 v168, v224, v225
    v_cvt_pk_bf16_f32 v169, v226, v227
    v_mfma_f32_16x16x32_bf16 v[196:199], a[80:83], v[144:147], v[196:199]
    v_cvt_pk_bf16_f32 v170, v228, v229
    v_cvt_pk_bf16_f32 v171, v230, v231
    v_mfma_f32_16x16x32_bf16 v[200:203], a[96:99], v[144:147], v[136:139]
    v_mul_f32_dpp v224, v72, v40 row_newbcast:5 row_mask:0xf bank_mask:0xf
    v_mul_f32_dpp v225, v73, v41 row_newbcast:5 row_mask:0xf bank_mask:0xf
    v_mfma_f32_16x16x32_bf16 v[200:203], a[100:103], v[148:151], v[200:203]
    v_mul_f32_dpp v226, v74, v42 row_newbcast:5 row_mask:0xf bank_mask:0xf
    v_mul_f32_dpp v227, v75, v43 row_newbcast:5 row_mask:0xf bank_mask:0xf
    v_mfma_f32_16x16x32_bf16 v[200:203], a[104:107], v[152:155], v[200:203]
    v_mul_f32_dpp v228, v76, v44 row_newbcast:5 row_mask:0xf bank_mask:0xf
    v_mul_f32_dpp v229, v77, v45 row_newbcast:5 row_mask:0xf bank_mask:0xf
    v_mfma_f32_16x16x32_bf16 v[200:203], a[108:111], v[156:159], v[200:203]
    v_mul_f32_dpp v230, v78, v46 row_newbcast:5 row_mask:0xf bank_mask:0xf
    v_mul_f32_dpp v231, v79, v47 row_newbcast:5 row_mask:0xf bank_mask:0xf
    v_mfma_f32_16x16x32_bf16 v[204:207], a[124:127], v[156:159], v[140:143]
    v_cvt_pk_bf16_f32 v172, v224, v225
    v_cvt_pk_bf16_f32 v173, v226, v227
    v_mfma_f32_16x16x32_bf16 v[204:207], a[120:123], v[152:155], v[204:207]
    v_cvt_pk_bf16_f32 v174, v228, v229
    v_cvt_pk_bf16_f32 v175, v230, v231
    v_mfma_f32_16x16x32_bf16 v[204:207], a[116:119], v[148:151], v[204:207]
    v_cvt_pk_bf16_f32 v210, |v180|, |v181|
    v_cvt_pk_bf16_f32 v211, |v182|, |v183|
    v_mfma_f32_16x16x32_bf16 v[204:207], a[112:115], v[144:147], v[204:207]
    v_cvt_pk_bf16_f32 v212, |v184|, |v185|
    v_cvt_pk_bf16_f32 v213, |v186|, |v187|
    v_mfma_f32_16x16x32_bf16 v[176:179], a[0:3], v[160:163], v[112:115]
    v_cvt_pk_bf16_f32 v214, |v188|, |v189|
    v_cvt_pk_bf16_f32 v215, |v190|, |v191|
    v_mfma_f32_16x16x32_bf16 v[176:179], a[4:7], v[164:167], v[176:179]
    v_cvt_pk_bf16_f32 v216, |v192|, |v193|
    v_cvt_pk_bf16_f32 v217, |v194|, |v195|
    v_mfma_f32_16x16x32_bf16 v[176:179], a[8:11], v[168:171], v[176:179]
    v_cvt_pk_bf16_f32 v218, |v196|, |v197|
    v_cvt_pk_bf16_f32 v219, |v198|, |v199|
    v_mfma_f32_16x16x32_bf16 v[176:179], a[12:15], v[172:175], v[176:179]
    v_cvt_pk_bf16_f32 v220, |v200|, |v201|
    v_cvt_pk_bf16_f32 v221, |v202|, |v203|
    v_smfmac_f32_16x16x64_bf16 v[240:243], a[128:131], v[208:215], v1
    v_cvt_pk_bf16_f32 v222, |v204|, |v205|
    v_mfma_f32_16x16x32_bf16 v[180:183], a[28:31], v[172:175], v[116:119]
    v_cvt_pk_bf16_f32 v223, |v206|, |v207|
    v_mul_f32_dpp v224, v48, v16 row_newbcast:7 row_mask:0xf bank_mask:0xf
    v_mfma_f32_16x16x32_bf16 v[180:183], a[24:27], v[168:171], v[180:183]
    v_mul_f32_dpp v225, v49, v17 row_newbcast:7 row_mask:0xf bank_mask:0xf
    v_mul_f32_dpp v226, v50, v18 row_newbcast:7 row_mask:0xf bank_mask:0xf
    v_mfma_f32_16x16x32_bf16 v[180:183], a[20:23], v[164:167], v[180:183]
    v_mul_f32_dpp v227, v51, v19 row_newbcast:7 row_mask:0xf bank_mask:0xf
    v_mul_f32_dpp v228, v52, v20 row_newbcast:7 row_mask:0xf bank_mask:0xf
    v_mfma_f32_16x16x32_bf16 v[180:183], a[16:19], v[160:163], v[180:183]
    v_mul_f32_dpp v229, v53, v21 row_newbcast:7 row_mask:0xf bank_mask:0xf
    v_mul_f32_dpp v230, v54, v22 row_newbcast:7 row_mask:0xf bank_mask:0xf
    v_smfmac_f32_16x16x64_bf16 v[240:243], a[132:135], v[216:223], v1
    v_mul_f32_dpp v231, v55, v23 row_newbcast:7 row_mask:0xf bank_mask:0xf
    v_mfma_f32_16x16x32_bf16 v[184:187], a[32:35], v[160:163], v[120:123]
    v_cvt_pk_bf16_f32 v144, v224, v225
    v_cvt_pk_bf16_f32 v145, v226, v227
    v_mfma_f32_16x16x32_bf16 v[184:187], a[36:39], v[164:167], v[184:187]
    v_cvt_pk_bf16_f32 v146, v228, v229
    v_cvt_pk_bf16_f32 v147, v230, v231
    v_mfma_f32_16x16x32_bf16 v[184:187], a[40:43], v[168:171], v[184:187]
    v_mul_f32_dpp v224, v56, v24 row_newbcast:7 row_mask:0xf bank_mask:0xf
    v_mul_f32_dpp v225, v57, v25 row_newbcast:7 row_mask:0xf bank_mask:0xf
    v_mfma_f32_16x16x32_bf16 v[184:187], a[44:47], v[172:175], v[184:187]
    v_mul_f32_dpp v226, v58, v26 row_newbcast:7 row_mask:0xf bank_mask:0xf
    v_mul_f32_dpp v227, v59, v27 row_newbcast:7 row_mask:0xf bank_mask:0xf
    v_smfmac_f32_16x16x64_bf16 v[240:243], a[152:155], v[160:167], v1
    v_mul_f32_dpp v228, v60, v28 row_newbcast:7 row_mask:0xf bank_mask:0xf
    v_mfma_f32_16x16x32_bf16 v[188:191], a[60:63], v[172:175], v[124:127]
    v_mul_f32_dpp v229, v61, v29 row_newbcast:7 row_mask:0xf bank_mask:0xf
    v_mul_f32_dpp v230, v62, v30 row_newbcast:7 row_mask:0xf bank_mask:0xf
    v_mfma_f32_16x16x32_bf16 v[188:191], a[56:59], v[168:171], v[188:191]
    v_mul_f32_dpp v231, v63, v31 row_newbcast:7 row_mask:0xf bank_mask:0xf
    v_cvt_pk_bf16_f32 v208, |v176|, |v177|
    v_mfma_f32_16x16x32_bf16 v[188:191], a[52:55], v[164:167], v[188:191]
    v_cvt_pk_bf16_f32 v209, |v178|, |v179|
    v_cvt_pk_bf16_f32 v148, v224, v225
    v_mfma_f32_16x16x32_bf16 v[188:191], a[48:51], v[160:163], v[188:191]
    v_cvt_pk_bf16_f32 v149, v226, v227
    v_cvt_pk_bf16_f32 v150, v228, v229
    v_smfmac_f32_16x16x64_bf16 v[240:243], a[156:159], v[168:175], v1
    v_cvt_pk_bf16_f32 v151, v230, v231
    v_mfma_f32_16x16x32_bf16 v[192:195], a[64:67], v[160:163], v[128:131]
    v_mul_f32_dpp v224, v64, v32 row_newbcast:7 row_mask:0xf bank_mask:0xf
    v_mul_f32_dpp v225, v65, v33 row_newbcast:7 row_mask:0xf bank_mask:0xf
    v_mfma_f32_16x16x32_bf16 v[192:195], a[68:71], v[164:167], v[192:195]
    v_mul_f32_dpp v226, v66, v34 row_newbcast:7 row_mask:0xf bank_mask:0xf
    v_mul_f32_dpp v227, v67, v35 row_newbcast:7 row_mask:0xf bank_mask:0xf
    v_mfma_f32_16x16x32_bf16 v[192:195], a[72:75], v[168:171], v[192:195]
    v_mul_f32_dpp v228, v68, v36 row_newbcast:7 row_mask:0xf bank_mask:0xf
    v_mul_f32_dpp v229, v69, v37 row_newbcast:7 row_mask:0xf bank_mask:0xf
    v_mfma_f32_16x16x32_bf16 v[192:195], a[76:79], v[172:175], v[192:195]
    v_mul_f32_dpp v230, v70, v38 row_newbcast:7 row_mask:0xf bank_mask:0xf
    v_mul_f32_dpp v231, v71, v39 row_newbcast:7 row_mask:0xf bank_mask:0xf
    v_mfma_f32_16x16x32_bf16 v[196:199], a[92:95], v[172:175], v[132:135]
    v_cvt_pk_bf16_f32 v152, v224, v225
    v_cvt_pk_bf16_f32 v153, v226, v227
    v_mfma_f32_16x16x32_bf16 v[196:199], a[88:91], v[168:171], v[196:199]
    v_cvt_pk_bf16_f32 v154, v228, v229
    v_cvt_pk_bf16_f32 v155, v230, v231
    v_mfma_f32_16x16x32_bf16 v[196:199], a[84:87], v[164:167], v[196:199]
    v_mul_f32_dpp v224, v72, v40 row_newbcast:7 row_mask:0xf bank_mask:0xf
    v_mul_f32_dpp v225, v73, v41 row_newbcast:7 row_mask:0xf bank_mask:0xf
    v_mfma_f32_16x16x32_bf16 v[196:199], a[80:83], v[160:163], v[196:199]
    v_mul_f32_dpp v226, v74, v42 row_newbcast:7 row_mask:0xf bank_mask:0xf
    v_mul_f32_dpp v227, v75, v43 row_newbcast:7 row_mask:0xf bank_mask:0xf
    v_mfma_f32_16x16x32_bf16 v[200:203], a[96:99], v[160:163], v[136:139]
    v_mul_f32_dpp v228, v76, v44 row_newbcast:7 row_mask:0xf bank_mask:0xf
    v_mul_f32_dpp v229, v77, v45 row_newbcast:7 row_mask:0xf bank_mask:0xf
    v_mfma_f32_16x16x32_bf16 v[200:203], a[100:103], v[164:167], v[200:203]
    v_mul_f32_dpp v230, v78, v46 row_newbcast:7 row_mask:0xf bank_mask:0xf
    v_mul_f32_dpp v231, v79, v47 row_newbcast:7 row_mask:0xf bank_mask:0xf
    v_mfma_f32_16x16x32_bf16 v[200:203], a[104:107], v[168:171], v[200:203]
    v_cvt_pk_bf16_f32 v156, v224, v225
    v_cvt_pk_bf16_f32 v157, v226, v227
    v_mfma_f32_16x16x32_bf16 v[200:203], a[108:111], v[172:175], v[200:203]
    v_cvt_pk_bf16_f32 v158, v228, v229
    v_cvt_pk_bf16_f32 v159, v230, v231
    v_mfma_f32_16x16x32_bf16 v[204:207], a[124:127], v[172:175], v[140:143]
    v_cvt_pk_bf16_f32 v210, |v180|, |v181|
    v_cvt_pk_bf16_f32 v211, |v182|, |v183|
    v_mfma_f32_16x16x32_bf16 v[204:207], a[120:123], v[168:171], v[204:207]
    v_cvt_pk_bf16_f32 v212, |v184|, |v185|
    v_cvt_pk_bf16_f32 v213, |v186|, |v187|
    v_mfma_f32_16x16x32_bf16 v[204:207], a[116:119], v[164:167], v[204:207]
    v_cvt_pk_bf16_f32 v214, |v188|, |v189|
    v_cvt_pk_bf16_f32 v215, |v190|, |v191|
    v_mfma_f32_16x16x32_bf16 v[204:207], a[112:115], v[160:163], v[204:207]
    v_cvt_pk_bf16_f32 v216, |v192|, |v193|
    v_cvt_pk_bf16_f32 v217, |v194|, |v195|
    v_smfmac_f32_16x16x64_bf16 v[240:243], a[144:147], v[208:215], v1
    v_cvt_pk_bf16_f32 v218, |v196|, |v197|
    v_mfma_f32_16x16x32_bf16 v[176:179], a[0:3], v[144:147], v[112:115]
    v_cvt_pk_bf16_f32 v219, |v198|, |v199|
    v_cvt_pk_bf16_f32 v220, |v200|, |v201|
    v_mfma_f32_16x16x32_bf16 v[176:179], a[4:7], v[148:151], v[176:179]
    v_cvt_pk_bf16_f32 v221, |v202|, |v203|
    v_cvt_pk_bf16_f32 v222, |v204|, |v205|
    v_mfma_f32_16x16x32_bf16 v[176:179], a[8:11], v[152:155], v[176:179]
    v_cvt_pk_bf16_f32 v223, |v206|, |v207|
    v_mul_f32_dpp v224, v48, v16 row_newbcast:9 row_mask:0xf bank_mask:0xf
    v_mfma_f32_16x16x32_bf16 v[176:179], a[12:15], v[156:159], v[176:179]
    v_mul_f32_dpp v225, v49, v17 row_newbcast:9 row_mask:0xf bank_mask:0xf
    v_mul_f32_dpp v226, v50, v18 row_newbcast:9 row_mask:0xf bank_mask:0xf
    v_smfmac_f32_16x16x64_bf16 v[240:243], a[148:151], v[216:223], v1
    v_mul_f32_dpp v227, v51, v19 row_newbcast:9 row_mask:0xf bank_mask:0xf
    v_mfma_f32_16x16x32_bf16 v[180:183], a[28:31], v[156:159], v[116:119]
    v_mul_f32_dpp v228, v52, v20 row_newbcast:9 row_mask:0xf bank_mask:0xf
    v_mul_f32_dpp v229, v53, v21 row_newbcast:9 row_mask:0xf bank_mask:0xf
    v_mfma_f32_16x16x32_bf16 v[180:183], a[24:27], v[152:155], v[180:183]
    v_mul_f32_dpp v230, v54, v22 row_newbcast:9 row_mask:0xf bank_mask:0xf
    v_mul_f32_dpp v231, v55, v23 row_newbcast:9 row_mask:0xf bank_mask:0xf
    v_mfma_f32_16x16x32_bf16 v[180:183], a[20:23], v[148:151], v[180:183]
    v_cvt_pk_bf16_f32 v160, v224, v225
    v_cvt_pk_bf16_f32 v161, v226, v227
    v_mfma_f32_16x16x32_bf16 v[180:183], a[16:19], v[144:147], v[180:183]
    v_cvt_pk_bf16_f32 v162, v228, v229
    v_cvt_pk_bf16_f32 v163, v230, v231
    v_smfmac_f32_16x16x64_bf16 v[240:243], a[168:171], v[144:151], v1
    v_mul_f32_dpp v224, v56, v24 row_newbcast:9 row_mask:0xf bank_mask:0xf
    v_mfma_f32_16x16x32_bf16 v[184:187], a[32:35], v[144:147], v[120:123]
    v_mul_f32_dpp v225, v57, v25 row_newbcast:9 row_mask:0xf bank_mask:0xf
    v_mul_f32_dpp v226, v58, v26 row_newbcast:9 row_mask:0xf bank_mask:0xf
    v_mfma_f32_16x16x32_bf16 v[184:187], a[36:39], v[148:151], v[184:187]
    v_mul_f32_dpp v227, v59, v27 row_newbcast:9 row_mask:0xf bank_mask:0xf
    v_mul_f32_dpp v228, v60, v28 row_newbcast:9 row_mask:0xf bank_mask:0xf
    v_mfma_f32_16x16x32_bf16 v[184:187], a[40:43], v[152:155], v[184:187]
    v_mul_f32_dpp v229, v61, v29 row_newbcast:9 row_mask:0xf bank_mask:0xf
    v_mul_f32_dpp v230, v62, v30 row_newbcast:9 row_mask:0xf bank_mask:0xf
    v_mfma_f32_16x16x32_bf16 v[184:187], a[44:47], v[156:159], v[184:187]
    v_mul_f32_dpp v231, v63, v31 row_newbcast:9 row_mask:0xf bank_mask:0xf
    v_cvt_pk_bf16_f32 v208, |v176|, |v177|
    v_smfmac_f32_16x16x64_bf16 v[240:243], a[172:175], v[152:159], v1
    v_cvt_pk_bf16_f32 v209, |v178|, |v179|
    v_mfma_f32_16x16x32_bf16 v[188:191], a[60:63], v[156:159], v[124:127]
    v_cvt_pk_bf16_f32 v164, v224, v225
    v_cvt_pk_bf16_f32 v165, v226, v227
    v_mfma_f32_16x16x32_bf16 v[188:191], a[56:59], v[152:155], v[188:191]
    v_cvt_pk_bf16_f32 v166, v228, v229
    v_cvt_pk_bf16_f32 v167, v230, v231
    v_mfma_f32_16x16x32_bf16 v[188:191], a[52:55], v[148:151], v[188:191]
    v_mul_f32_dpp v224, v64, v32 row_newbcast:9 row_mask:0xf bank_mask:0xf
    v_mul_f32_dpp v225, v65, v33 row_newbcast:9 row_mask:0xf bank_mask:0xf
    v_mfma_f32_16x16x32_bf16 v[188:191], a[48:51], v[144:147], v[188:191]
    v_mul_f32_dpp v226, v66, v34 row_newbcast:9 row_mask:0xf bank_mask:0xf
    v_mul_f32_dpp v227, v67, v35 row_newbcast:9 row_mask:0xf bank_mask:0xf
    v_mfma_f32_16x16x32_bf16 v[192:195], a[64:67], v[144:147], v[128:131]
    v_mul_f32_dpp v228, v68, v36 row_newbcast:9 row_mask:0xf bank_mask:0xf
    v_mul_f32_dpp v229, v69, v37 row_newbcast:9 row_mask:0xf bank_mask:0xf
    v_mfma_f32_16x16x32_bf16 v[192:195], a[68:71], v[148:151], v[192:195]
    v_mul_f32_dpp v230, v70, v38 row_newbcast:9 row_mask:0xf bank_mask:0xf
    v_mul_f32_dpp v231, v71, v39 row_newbcast:9 row_mask:0xf bank_mask:0xf
    v_mfma_f32_16x16x32_bf16 v[192:195], a[72:75], v[152:155], v[192:195]
    v_cvt_pk_bf16_f32 v168, v224, v225
    v_cvt_pk_bf16_f32 v169, v226, v227
    v_mfma_f32_16x16x32_bf16 v[192:195], a[76:79], v[156:159], v[192:195]
    v_cvt_pk_bf16_f32 v170, v228, v229
    v_cvt_pk_bf16_f32 v171, v230, v231
    v_mfma_f32_16x16x32_bf16 v[196:199], a[92:95], v[156:159], v[132:135]
    v_mul_f32_dpp v224, v72, v40 row_newbcast:9 row_mask:0xf bank_mask:0xf
    v_mul_f32_dpp v225, v73, v41 row_newbcast:9 row_mask:0xf bank_mask:0xf
    v_mfma_f32_16x16x32_bf16 v[196:199], a[88:91], v[152:155], v[196:199]
    v_mul_f32_dpp v226, v74, v42 row_newbcast:9 row_mask:0xf bank_mask:0xf
    v_mul_f32_dpp v227, v75, v43 row_newbcast:9 row_mask:0xf bank_mask:0xf
    v_mfma_f32_16x16x32_bf16 v[196:199], a[84:87], v[148:151], v[196:199]
    v_mul_f32_dpp v228, v76, v44 row_newbcast:9 row_mask:0xf bank_mask:0xf
    v_mul_f32_dpp v229, v77, v45 row_newbcast:9 row_mask:0xf bank_mask:0xf
    v_mfma_f32_16x16x32_bf16 v[196:199], a[80:83], v[144:147], v[196:199]
    v_mul_f32_dpp v230, v78, v46 row_newbcast:9 row_mask:0xf bank_mask:0xf
    v_mul_f32_dpp v231, v79, v47 row_newbcast:9 row_mask:0xf bank_mask:0xf
    v_mfma_f32_16x16x32_bf16 v[200:203], a[96:99], v[144:147], v[136:139]
    v_cvt_pk_bf16_f32 v172, v224, v225
    v_cvt_pk_bf16_f32 v173, v226, v227
    v_mfma_f32_16x16x32_bf16 v[200:203], a[100:103], v[148:151], v[200:203]
    v_cvt_pk_bf16_f32 v174, v228, v229
    v_cvt_pk_bf16_f32 v175, v230, v231
    v_mfma_f32_16x16x32_bf16 v[200:203], a[104:107], v[152:155], v[200:203]
    v_cvt_pk_bf16_f32 v210, |v180|, |v181|
    v_cvt_pk_bf16_f32 v211, |v182|, |v183|
    v_mfma_f32_16x16x32_bf16 v[200:203], a[108:111], v[156:159], v[200:203]
    v_cvt_pk_bf16_f32 v212, |v184|, |v185|
    v_cvt_pk_bf16_f32 v213, |v186|, |v187|
    v_mfma_f32_16x16x32_bf16 v[204:207], a[124:127], v[156:159], v[140:143]
    v_cvt_pk_bf16_f32 v214, |v188|, |v189|
    v_cvt_pk_bf16_f32 v215, |v190|, |v191|
    v_mfma_f32_16x16x32_bf16 v[204:207], a[120:123], v[152:155], v[204:207]
    v_cvt_pk_bf16_f32 v216, |v192|, |v193|
    v_cvt_pk_bf16_f32 v217, |v194|, |v195|
    v_mfma_f32_16x16x32_bf16 v[204:207], a[116:119], v[148:151], v[204:207]
    v_cvt_pk_bf16_f32 v218, |v196|, |v197|
    v_cvt_pk_bf16_f32 v219, |v198|, |v199|
    v_mfma_f32_16x16x32_bf16 v[204:207], a[112:115], v[144:147], v[204:207]
    v_cvt_pk_bf16_f32 v220, |v200|, |v201|
    v_cvt_pk_bf16_f32 v221, |v202|, |v203|
    v_smfmac_f32_16x16x64_bf16 v[240:243], a[160:163], v[208:215], v1
    v_mul_f32_dpp v224, v48, v16 row_newbcast:8 row_mask:0xf bank_mask:0xf
    v_mfma_f32_16x16x32_bf16 v[176:179], a[0:3], v[160:163], v[112:115]
    v_mul_f32_dpp v225, v49, v17 row_newbcast:8 row_mask:0xf bank_mask:0xf
    v_mul_f32_dpp v226, v50, v18 row_newbcast:8 row_mask:0xf bank_mask:0xf
    v_mfma_f32_16x16x32_bf16 v[176:179], a[4:7], v[164:167], v[176:179]
    v_cvt_pk_bf16_f32 v222, |v204|, |v205|
    v_cvt_pk_bf16_f32 v223, |v206|, |v207|
    v_mfma_f32_16x16x32_bf16 v[176:179], a[8:11], v[168:171], v[176:179]
    v_mul_f32_dpp v227, v51, v19 row_newbcast:8 row_mask:0xf bank_mask:0xf
    v_mul_f32_dpp v228, v52, v20 row_newbcast:8 row_mask:0xf bank_mask:0xf
    v_mfma_f32_16x16x32_bf16 v[176:179], a[12:15], v[172:175], v[176:179]
    v_mul_f32_dpp v229, v53, v21 row_newbcast:8 row_mask:0xf bank_mask:0xf
    v_mul_f32_dpp v230, v54, v22 row_newbcast:8 row_mask:0xf bank_mask:0xf
    v_smfmac_f32_16x16x64_bf16 v[240:243], a[164:167], v[216:223], v1
    v_mul_f32_dpp v231, v55, v23 row_newbcast:8 row_mask:0xf bank_mask:0xf
    v_mfma_f32_16x16x32_bf16 v[180:183], a[28:31], v[172:175], v[116:119]
    v_cvt_pk_bf16_f32 v144, v224, v225
    v_cvt_pk_bf16_f32 v145, v226, v227
    v_mfma_f32_16x16x32_bf16 v[180:183], a[24:27], v[168:171], v[180:183]
    v_cvt_pk_bf16_f32 v146, v228, v229
    v_cvt_pk_bf16_f32 v147, v230, v231
    v_mfma_f32_16x16x32_bf16 v[180:183], a[20:23], v[164:167], v[180:183]
    v_mul_f32_dpp v224, v56, v24 row_newbcast:8 row_mask:0xf bank_mask:0xf
    v_mul_f32_dpp v225, v57, v25 row_newbcast:8 row_mask:0xf bank_mask:0xf
    v_mfma_f32_16x16x32_bf16 v[180:183], a[16:19], v[160:163], v[180:183]
    v_mul_f32_dpp v226, v58, v26 row_newbcast:8 row_mask:0xf bank_mask:0xf
    v_mul_f32_dpp v227, v59, v27 row_newbcast:8 row_mask:0xf bank_mask:0xf
    v_smfmac_f32_16x16x64_bf16 v[240:243], a[184:187], v[160:167], v1
    v_mul_f32_dpp v228, v60, v28 row_newbcast:8 row_mask:0xf bank_mask:0xf
    v_mfma_f32_16x16x32_bf16 v[184:187], a[32:35], v[160:163], v[120:123]
    v_mul_f32_dpp v229, v61, v29 row_newbcast:8 row_mask:0xf bank_mask:0xf
    v_mul_f32_dpp v230, v62, v30 row_newbcast:8 row_mask:0xf bank_mask:0xf
    v_mfma_f32_16x16x32_bf16 v[184:187], a[36:39], v[164:167], v[184:187]
    v_mul_f32_dpp v231, v63, v31 row_newbcast:8 row_mask:0xf bank_mask:0xf
    v_cvt_pk_bf16_f32 v208, |v176|, |v177|
    v_mfma_f32_16x16x32_bf16 v[184:187], a[40:43], v[168:171], v[184:187]
    v_cvt_pk_bf16_f32 v209, |v178|, |v179|
    v_cvt_pk_bf16_f32 v148, v224, v225
    v_mfma_f32_16x16x32_bf16 v[184:187], a[44:47], v[172:175], v[184:187]
    v_cvt_pk_bf16_f32 v149, v226, v227
    v_cvt_pk_bf16_f32 v150, v228, v229
    v_smfmac_f32_16x16x64_bf16 v[240:243], a[188:191], v[168:175], v1
    v_cvt_pk_bf16_f32 v151, v230, v231
    v_mfma_f32_16x16x32_bf16 v[188:191], a[60:63], v[172:175], v[124:127]
    v_mul_f32_dpp v224, v64, v32 row_newbcast:8 row_mask:0xf bank_mask:0xf
    v_mul_f32_dpp v225, v65, v33 row_newbcast:8 row_mask:0xf bank_mask:0xf
    v_mfma_f32_16x16x32_bf16 v[188:191], a[56:59], v[168:171], v[188:191]
    v_mul_f32_dpp v226, v66, v34 row_newbcast:8 row_mask:0xf bank_mask:0xf
    v_mul_f32_dpp v227, v67, v35 row_newbcast:8 row_mask:0xf bank_mask:0xf
    v_mfma_f32_16x16x32_bf16 v[188:191], a[52:55], v[164:167], v[188:191]
    v_mul_f32_dpp v228, v68, v36 row_newbcast:8 row_mask:0xf bank_mask:0xf
    v_mul_f32_dpp v229, v69, v37 row_newbcast:8 row_mask:0xf bank_mask:0xf
    v_mfma_f32_16x16x32_bf16 v[188:191], a[48:51], v[160:163], v[188:191]
    v_mul_f32_dpp v230, v70, v38 row_newbcast:8 row_mask:0xf bank_mask:0xf
    v_mul_f32_dpp v231, v71, v39 row_newbcast:8 row_mask:0xf bank_mask:0xf
    v_smfmac_f32_16x16x64_bf16 v[244:247], a[136:139], v[144:151], v1
    v_cvt_pk_bf16_f32 v152, v224, v225
    v_mfma_f32_16x16x32_bf16 v[192:195], a[64:67], v[160:163], v[128:131]
    v_cvt_pk_bf16_f32 v153, v226, v227
    v_cvt_pk_bf16_f32 v154, v228, v229
    v_mfma_f32_16x16x32_bf16 v[192:195], a[68:71], v[164:167], v[192:195]
    v_cvt_pk_bf16_f32 v155, v230, v231
    v_mul_f32_dpp v224, v72, v40 row_newbcast:8 row_mask:0xf bank_mask:0xf
    v_mfma_f32_16x16x32_bf16 v[192:195], a[72:75], v[168:171], v[192:195]
    v_mul_f32_dpp v225, v73, v41 row_newbcast:8 row_mask:0xf bank_mask:0xf
    v_mul_f32_dpp v226, v74, v42 row_newbcast:8 row_mask:0xf bank_mask:0xf
    v_mfma_f32_16x16x32_bf16 v[192:195], a[76:79], v[172:175], v[192:195]
    v_mul_f32_dpp v227, v75, v43 row_newbcast:8 row_mask:0xf bank_mask:0xf
    v_mul_f32_dpp v228, v76, v44 row_newbcast:8 row_mask:0xf bank_mask:0xf
    v_mfma_f32_16x16x32_bf16 v[196:199], a[92:95], v[172:175], v[132:135]
    v_mul_f32_dpp v229, v77, v45 row_newbcast:8 row_mask:0xf bank_mask:0xf
    v_mul_f32_dpp v230, v78, v46 row_newbcast:8 row_mask:0xf bank_mask:0xf
    v_mfma_f32_16x16x32_bf16 v[196:199], a[88:91], v[168:171], v[196:199]
    v_mul_f32_dpp v231, v79, v47 row_newbcast:8 row_mask:0xf bank_mask:0xf
    v_cvt_pk_bf16_f32 v156, v224, v225
    v_mfma_f32_16x16x32_bf16 v[196:199], a[84:87], v[164:167], v[196:199]
    v_cvt_pk_bf16_f32 v157, v226, v227
    v_cvt_pk_bf16_f32 v158, v228, v229
    v_mfma_f32_16x16x32_bf16 v[196:199], a[80:83], v[160:163], v[196:199]
    v_cvt_pk_bf16_f32 v159, v230, v231
    v_cvt_pk_bf16_f32 v210, |v180|, |v181|
    v_mfma_f32_16x16x32_bf16 v[200:203], a[96:99], v[160:163], v[136:139]
    v_cvt_pk_bf16_f32 v211, |v182|, |v183|
    v_cvt_pk_bf16_f32 v212, |v184|, |v185|
    v_mfma_f32_16x16x32_bf16 v[200:203], a[100:103], v[164:167], v[200:203]
    v_cvt_pk_bf16_f32 v213, |v186|, |v187|
    v_cvt_pk_bf16_f32 v214, |v188|, |v189|
    v_mfma_f32_16x16x32_bf16 v[200:203], a[104:107], v[168:171], v[200:203]
    v_cvt_pk_bf16_f32 v215, |v190|, |v191|
    v_cvt_pk_bf16_f32 v216, |v192|, |v193|
    v_mfma_f32_16x16x32_bf16 v[200:203], a[108:111], v[172:175], v[200:203]
    v_cvt_pk_bf16_f32 v217, |v194|, |v195|
    v_cvt_pk_bf16_f32 v218, |v196|, |v197|
    v_smfmac_f32_16x16x64_bf16 v[240:243], a[176:179], v[208:215], v1
    v_cvt_pk_bf16_f32 v219, |v198|, |v199|
    v_mfma_f32_16x16x32_bf16 v[204:207], a[124:127], v[172:175], v[140:143]
    v_mul_f32_dpp v224, v48, v16 row_newbcast:0 row_mask:0xf bank_mask:0xf
    v_mul_f32_dpp v225, v49, v17 row_newbcast:0 row_mask:0xf bank_mask:0xf
    v_mfma_f32_16x16x32_bf16 v[204:207], a[120:123], v[168:171], v[204:207]
    v_cvt_pk_bf16_f32 v220, |v200|, |v201|
    v_cvt_pk_bf16_f32 v221, |v202|, |v203|
    v_mfma_f32_16x16x32_bf16 v[204:207], a[116:119], v[164:167], v[204:207]
    v_mul_f32_dpp v226, v50, v18 row_newbcast:0 row_mask:0xf bank_mask:0xf
    v_mul_f32_dpp v227, v51, v19 row_newbcast:0 row_mask:0xf bank_mask:0xf
    v_mfma_f32_16x16x32_bf16 v[204:207], a[112:115], v[160:163], v[204:207]
    v_mul_f32_dpp v228, v52, v20 row_newbcast:0 row_mask:0xf bank_mask:0xf
    v_mul_f32_dpp v229, v53, v21 row_newbcast:0 row_mask:0xf bank_mask:0xf
    v_smfmac_f32_16x16x64_bf16 v[244:247], a[140:143], v[152:159], v1
    v_mul_f32_dpp v230, v54, v22 row_newbcast:0 row_mask:0xf bank_mask:0xf
    v_mfma_f32_16x16x32_bf16 v[176:179], a[0:3], v[144:147], v[112:115]
    v_mul_f32_dpp v231, v55, v23 row_newbcast:0 row_mask:0xf bank_mask:0xf
    v_cvt_pk_bf16_f32 v160, v224, v225
    v_mfma_f32_16x16x32_bf16 v[176:179], a[4:7], v[148:151], v[176:179]
    v_cvt_pk_bf16_f32 v222, |v204|, |v205|
    v_cvt_pk_bf16_f32 v223, |v206|, |v207|
    v_mfma_f32_16x16x32_bf16 v[176:179], a[8:11], v[152:155], v[176:179]
    v_cvt_pk_bf16_f32 v161, v226, v227
    v_cvt_pk_bf16_f32 v162, v228, v229
    v_mfma_f32_16x16x32_bf16 v[176:179], a[12:15], v[156:159], v[176:179]
    v_cvt_pk_bf16_f32 v163, v230, v231
    v_mul_f32_dpp v224, v56, v24 row_newbcast:0 row_mask:0xf bank_mask:0xf
    v_smfmac_f32_16x16x64_bf16 v[240:243], a[180:183], v[216:223], v1
    v_mul_f32_dpp v225, v57, v25 row_newbcast:0 row_mask:0xf bank_mask:0xf
    v_mfma_f32_16x16x32_bf16 v[180:183], a[28:31], v[156:159], v[116:119]
    v_mul_f32_dpp v226, v58, v26 row_newbcast:0 row_mask:0xf bank_mask:0xf
    v_mul_f32_dpp v227, v59, v27 row_newbcast:0 row_mask:0xf bank_mask:0xf
    v_mfma_f32_16x16x32_bf16 v[180:183], a[24:27], v[152:155], v[180:183]
    v_mul_f32_dpp v228, v60, v28 row_newbcast:0 row_mask:0xf bank_mask:0xf
    v_mul_f32_dpp v229, v61, v29 row_newbcast:0 row_mask:0xf bank_mask:0xf
    v_mfma_f32_16x16x32_bf16 v[180:183], a[20:23], v[148:151], v[180:183]
    v_mul_f32_dpp v230, v62, v30 row_newbcast:0 row_mask:0xf bank_mask:0xf
    v_mul_f32_dpp v231, v63, v31 row_newbcast:0 row_mask:0xf bank_mask:0xf
    v_mfma_f32_16x16x32_bf16 v[180:183], a[16:19], v[144:147], v[180:183]
    v_cvt_pk_bf16_f32 v208, |v176|, |v177|
    v_cvt_pk_bf16_f32 v209, |v178|, |v179|
    v_mfma_f32_16x16x32_bf16 v[184:187], a[32:35], v[144:147], v[120:123]
    v_cvt_pk_bf16_f32 v164, v224, v225
    v_cvt_pk_bf16_f32 v165, v226, v227
    v_mfma_f32_16x16x32_bf16 v[184:187], a[36:39], v[148:151], v[184:187]
    v_cvt_pk_bf16_f32 v166, v228, v229
    v_cvt_pk_bf16_f32 v167, v230, v231
    v_mfma_f32_16x16x32_bf16 v[184:187], a[40:43], v[152:155], v[184:187]
    v_mul_f32_dpp v224, v64, v32 row_newbcast:0 row_mask:0xf bank_mask:0xf
    v_mul_f32_dpp v225, v65, v33 row_newbcast:0 row_mask:0xf bank_mask:0xf
    v_mfma_f32_16x16x32_bf16 v[184:187], a[44:47], v[156:159], v[184:187]
    v_mul_f32_dpp v226, v66, v34 row_newbcast:0 row_mask:0xf bank_mask:0xf
    v_mul_f32_dpp v227, v67, v35 row_newbcast:0 row_mask:0xf bank_mask:0xf
    v_mfma_f32_16x16x32_bf16 v[188:191], a[60:63], v[156:159], v[124:127]
    v_mul_f32_dpp v228, v68, v36 row_newbcast:0 row_mask:0xf bank_mask:0xf
    v_mul_f32_dpp v229, v69, v37 row_newbcast:0 row_mask:0xf bank_mask:0xf
    v_mfma_f32_16x16x32_bf16 v[188:191], a[56:59], v[152:155], v[188:191]
    v_mul_f32_dpp v230, v70, v38 row_newbcast:0 row_mask:0xf bank_mask:0xf
    v_mul_f32_dpp v231, v71, v39 row_newbcast:0 row_mask:0xf bank_mask:0xf
    v_mfma_f32_16x16x32_bf16 v[188:191], a[52:55], v[148:151], v[188:191]
    v_cvt_pk_bf16_f32 v168, v224, v225
    v_cvt_pk_bf16_f32 v169, v226, v227
    v_mfma_f32_16x16x32_bf16 v[188:191], a[48:51], v[144:147], v[188:191]
    v_cvt_pk_bf16_f32 v170, v228, v229
    v_cvt_pk_bf16_f32 v171, v230, v231
    v_mfma_f32_16x16x32_bf16 v[192:195], a[64:67], v[144:147], v[128:131]
    v_mul_f32_dpp v224, v72, v40 row_newbcast:0 row_mask:0xf bank_mask:0xf
    v_mul_f32_dpp v225, v73, v41 row_newbcast:0 row_mask:0xf bank_mask:0xf
    v_mfma_f32_16x16x32_bf16 v[192:195], a[68:71], v[148:151], v[192:195]
    v_mul_f32_dpp v226, v74, v42 row_newbcast:0 row_mask:0xf bank_mask:0xf
    v_mul_f32_dpp v227, v75, v43 row_newbcast:0 row_mask:0xf bank_mask:0xf
    v_mfma_f32_16x16x32_bf16 v[192:195], a[72:75], v[152:155], v[192:195]
    v_mul_f32_dpp v228, v76, v44 row_newbcast:0 row_mask:0xf bank_mask:0xf
    v_mul_f32_dpp v229, v77, v45 row_newbcast:0 row_mask:0xf bank_mask:0xf
    v_mfma_f32_16x16x32_bf16 v[192:195], a[76:79], v[156:159], v[192:195]
    v_mul_f32_dpp v230, v78, v46 row_newbcast:0 row_mask:0xf bank_mask:0xf
    v_mul_f32_dpp v231, v79, v47 row_newbcast:0 row_mask:0xf bank_mask:0xf
    v_mfma_f32_16x16x32_bf16 v[196:199], a[92:95], v[156:159], v[132:135]
    v_cvt_pk_bf16_f32 v172, v224, v225
    v_cvt_pk_bf16_f32 v173, v226, v227
    v_mfma_f32_16x16x32_bf16 v[196:199], a[88:91], v[152:155], v[196:199]
    v_cvt_pk_bf16_f32 v174, v228, v229
    v_cvt_pk_bf16_f32 v175, v230, v231
    v_mfma_f32_16x16x32_bf16 v[196:199], a[84:87], v[148:151], v[196:199]
    v_cvt_pk_bf16_f32 v210, |v180|, |v181|
    v_cvt_pk_bf16_f32 v211, |v182|, |v183|
    v_mfma_f32_16x16x32_bf16 v[196:199], a[80:83], v[144:147], v[196:199]
    v_cvt_pk_bf16_f32 v212, |v184|, |v185|
    v_cvt_pk_bf16_f32 v213, |v186|, |v187|
    v_mfma_f32_16x16x32_bf16 v[200:203], a[96:99], v[144:147], v[136:139]
    v_cvt_pk_bf16_f32 v214, |v188|, |v189|
    v_cvt_pk_bf16_f32 v215, |v190|, |v191|
    v_mfma_f32_16x16x32_bf16 v[200:203], a[100:103], v[148:151], v[200:203]
    v_cvt_pk_bf16_f32 v216, |v192|, |v193|
    v_cvt_pk_bf16_f32 v217, |v194|, |v195|
    v_mfma_f32_16x16x32_bf16 v[200:203], a[104:107], v[152:155], v[200:203]
    v_cvt_pk_bf16_f32 v218, |v196|, |v197|
    v_cvt_pk_bf16_f32 v219, |v198|, |v199|
    v_mfma_f32_16x16x32_bf16 v[200:203], a[108:111], v[156:159], v[200:203]
L_stub2:
    s_cbranch_scc1 L_main2
    v_mul_f32_dpp v224, v48, v16 row_newbcast:1 row_mask:0xf bank_mask:0xf
    v_mul_f32_dpp v225, v49, v17 row_newbcast:1 row_mask:0xf bank_mask:0xf
    v_smfmac_f32_16x16x64_bf16 v[244:247], a[128:131], v[208:215], v1
    v_mul_f32_dpp v226, v50, v18 row_newbcast:1 row_mask:0xf bank_mask:0xf
    v_mfma_f32_16x16x32_bf16 v[204:207], a[124:127], v[156:159], v[140:143]
    v_mul_f32_dpp v227, v51, v19 row_newbcast:1 row_mask:0xf bank_mask:0xf
    v_mul_f32_dpp v228, v52, v20 row_newbcast:1 row_mask:0xf bank_mask:0xf
    v_mfma_f32_16x16x32_bf16 v[204:207], a[120:123], v[152:155], v[204:207]
    v_cvt_pk_bf16_f32 v220, |v200|, |v201|
    v_cvt_pk_bf16_f32 v221, |v202|, |v203|
    v_mfma_f32_16x16x32_bf16 v[204:207], a[116:119], v[148:151], v[204:207]
    v_mul_f32_dpp v229, v53, v21 row_newbcast:1 row_mask:0xf bank_mask:0xf
    v_mul_f32_dpp v230, v54, v22 row_newbcast:1 row_mask:0xf bank_mask:0xf
    v_mfma_f32_16x16x32_bf16 v[204:207], a[112:115], v[144:147], v[204:207]
    v_mul_f32_dpp v231, v55, v23 row_newbcast:1 row_mask:0xf bank_mask:0xf
    v_cvt_pk_bf16_f32 v144, v224, v225
    v_mfma_f32_16x16x32_bf16 v[176:179], a[0:3], v[160:163], v[112:115]
    v_cvt_pk_bf16_f32 v145, v226, v227
    v_cvt_pk_bf16_f32 v146, v228, v229
    v_mfma_f32_16x16x32_bf16 v[176:179], a[4:7], v[164:167], v[176:179]
    v_cvt_pk_bf16_f32 v147, v230, v231
    v_mul_f32_dpp v224, v56, v24 row_newbcast:1 row_mask:0xf bank_mask:0xf
    v_mfma_f32_16x16x32_bf16 v[176:179], a[8:11], v[168:171], v[176:179]
    v_cvt_pk_bf16_f32 v222, |v204|, |v205|
    v_cvt_pk_bf16_f32 v223, |v206|, |v207|
    v_mfma_f32_16x16x32_bf16 v[176:179], a[12:15], v[172:175], v[176:179]
    v_mul_f32_dpp v225, v57, v25 row_newbcast:1 row_mask:0xf bank_mask:0xf
    v_mul_f32_dpp v226, v58, v26 row_newbcast:1 row_mask:0xf bank_mask:0xf
    v_smfmac_f32_16x16x64_bf16 v[244:247], a[132:135], v[216:223], v1
    v_mul_f32_dpp v227, v59, v27 row_newbcast:1 row_mask:0xf bank_mask:0xf
    v_mfma_f32_16x16x32_bf16 v[180:183], a[28:31], v[172:175], v[116:119]
    v_mul_f32_dpp v228, v60, v28 row_newbcast:1 row_mask:0xf bank_mask:0xf
    v_mul_f32_dpp v229, v61, v29 row_newbcast:1 row_mask:0xf bank_mask:0xf
    v_mfma_f32_16x16x32_bf16 v[180:183], a[24:27], v[168:171], v[180:183]
    v_mul_f32_dpp v230, v62, v30 row_newbcast:1 row_mask:0xf bank_mask:0xf
    v_mul_f32_dpp v231, v63, v31 row_newbcast:1 row_mask:0xf bank_mask:0xf
    v_mfma_f32_16x16x32_bf16 v[180:183], a[20:23], v[164:167], v[180:183]
    v_cvt_pk_bf16_f32 v208, |v176|, |v177|
    v_cvt_pk_bf16_f32 v209, |v178|, |v179|
    v_mfma_f32_16x16x32_bf16 v[180:183], a[16:19], v[160:163], v[180:183]
    v_cvt_pk_bf16_f32 v148, v224, v225
    v_cvt_pk_bf16_f32 v149, v226, v227
    v_smfmac_f32_16x16x64_bf16 v[244:247], a[152:155], v[160:167], v1
    v_cvt_pk_bf16_f32 v150, v228, v229
    v_mfma_f32_16x16x32_bf16 v[184:187], a[32:35], v[160:163], v[120:123]
    v_cvt_pk_bf16_f32 v151, v230, v231
    v_mul_f32_dpp v224, v64, v32 row_newbcast:1 row_mask:0xf bank_mask:0xf
    v_mfma_f32_16x16x32_bf16 v[184:187], a[36:39], v[164:167], v[184:187]
    v_mul_f32_dpp v225, v65, v33 row_newbcast:1 row_mask:0xf bank_mask:0xf
    v_mul_f32_dpp v226, v66, v34 row_newbcast:1 row_mask:0xf bank_mask:0xf
    v_mfma_f32_16x16x32_bf16 v[184:187], a[40:43], v[168:171], v[184:187]
    v_mul_f32_dpp v227, v67, v35 row_newbcast:1 row_mask:0xf bank_mask:0xf
    v_mul_f32_dpp v228, v68, v36 row_newbcast:1 row_mask:0xf bank_mask:0xf
    v_mfma_f32_16x16x32_bf16 v[184:187], a[44:47], v[172:175], v[184:187]
    v_mul_f32_dpp v229, v69, v37 row_newbcast:1 row_mask:0xf bank_mask:0xf
    v_mul_f32_dpp v230, v70, v38 row_newbcast:1 row_mask:0xf bank_mask:0xf
    v_smfmac_f32_16x16x64_bf16 v[244:247], a[156:159], v[168:175], v1
    v_mul_f32_dpp v231, v71, v39 row_newbcast:1 row_mask:0xf bank_mask:0xf
    v_mfma_f32_16x16x32_bf16 v[188:191], a[60:63], v[172:175], v[124:127]
    v_cvt_pk_bf16_f32 v152, v224, v225
    v_cvt_pk_bf16_f32 v153, v226, v227
    v_mfma_f32_16x16x32_bf16 v[188:191], a[56:59], v[168:171], v[188:191]
    v_cvt_pk_bf16_f32 v154, v228, v229
    v_cvt_pk_bf16_f32 v155, v230, v231
    v_mfma_f32_16x16x32_bf16 v[188:191], a[52:55], v[164:167], v[188:191]
    v_mul_f32_dpp v224, v72, v40 row_newbcast:1 row_mask:0xf bank_mask:0xf
    v_mul_f32_dpp v225, v73, v41 row_newbcast:1 row_mask:0xf bank_mask:0xf
    v_mfma_f32_16x16x32_bf16 v[188:191], a[48:51], v[160:163], v[188:191]
    v_mul_f32_dpp v226, v74, v42 row_newbcast:1 row_mask:0xf bank_mask:0xf
    v_mul_f32_dpp v227, v75, v43 row_newbcast:1 row_mask:0xf bank_mask:0xf
    v_mfma_f32_16x16x32_bf16 v[192:195], a[64:67], v[160:163], v[128:131]
    v_mul_f32_dpp v228, v76, v44 row_newbcast:1 row_mask:0xf bank_mask:0xf
    v_mul_f32_dpp v229, v77, v45 row_newbcast:1 row_mask:0xf bank_mask:0xf
    v_mfma_f32_16x16x32_bf16 v[192:195], a[68:71], v[164:167], v[192:195]
    v_mul_f32_dpp v230, v78, v46 row_newbcast:1 row_mask:0xf bank_mask:0xf
    v_mul_f32_dpp v231, v79, v47 row_newbcast:1 row_mask:0xf bank_mask:0xf
    v_mfma_f32_16x16x32_bf16 v[192:195], a[72:75], v[168:171], v[192:195]
    v_cvt_pk_bf16_f32 v156, v224, v225
    v_cvt_pk_bf16_f32 v157, v226, v227
    v_mfma_f32_16x16x32_bf16 v[192:195], a[76:79], v[172:175], v[192:195]
    v_cvt_pk_bf16_f32 v158, v228, v229
    v_cvt_pk_bf16_f32 v159, v230, v231
    v_mfma_f32_16x16x32_bf16 v[196:199], a[92:95], v[172:175], v[132:135]
    v_cvt_pk_bf16_f32 v210, |v180|, |v181|
    v_cvt_pk_bf16_f32 v211, |v182|, |v183|
    v_mfma_f32_16x16x32_bf16 v[196:199], a[88:91], v[168:171], v[196:199]
    v_cvt_pk_bf16_f32 v212, |v184|, |v185|
    v_cvt_pk_bf16_f32 v213, |v186|, |v187|
    v_mfma_f32_16x16x32_bf16 v[196:199], a[84:87], v[164:167], v[196:199]
    v_cvt_pk_bf16_f32 v214, |v188|, |v189|
    v_cvt_pk_bf16_f32 v215, |v190|, |v191|
    v_mfma_f32_16x16x32_bf16 v[196:199], a[80:83], v[160:163], v[196:199]
    v_cvt_pk_bf16_f32 v216, |v192|, |v193|
    v_cvt_pk_bf16_f32 v217, |v194|, |v195|
    v_smfmac_f32_16x16x64_bf16 v[244:247], a[144:147], v[208:215], v1
    v_mul_f32_dpp v224, v48, v16 row_newbcast:6 row_mask:0xf bank_mask:0xf
    v_mfma_f32_16x16x32_bf16 v[200:203], a[96:99], v[160:163], v[136:139]
    v_mul_f32_dpp v225, v49, v17 row_newbcast:6 row_mask:0xf bank_mask:0xf
    v_mul_f32_dpp v226, v50, v18 row_newbcast:6 row_mask:0xf bank_mask:0xf
    v_mfma_f32_16x16x32_bf16 v[200:203], a[100:103], v[164:167], v[200:203]
    v_cvt_pk_bf16_f32 v218, |v196|, |v197|
    v_cvt_pk_bf16_f32 v219, |v198|, |v199|
    v_mfma_f32_16x16x32_bf16 v[200:203], a[104:107], v[168:171], v[200:203]
    v_mul_f32_dpp v227, v51, v19 row_newbcast:6 row_mask:0xf bank_mask:0xf
    v_mul_f32_dpp v228, v52, v20 row_newbcast:6 row_mask:0xf bank_mask:0xf
    v_mfma_f32_16x16x32_bf16 v[200:203], a[108:111], v[172:175], v[200:203]
    v_mul_f32_dpp v229, v53, v21 row_newbcast:6 row_mask:0xf bank_mask:0xf
    v_mul_f32_dpp v230, v54, v22 row_newbcast:6 row_mask:0xf bank_mask:0xf
    v_mfma_f32_16x16x32_bf16 v[204:207], a[124:127], v[172:175], v[140:143]
    v_mul_f32_dpp v231, v55, v23 row_newbcast:6 row_mask:0xf bank_mask:0xf
    v_lshlrev_b32 v80, 16, v96
    v_mfma_f32_16x16x32_bf16 v[204:207], a[120:123], v[168:171], v[204:207]
    v_and_b32 v81, 0xffff0000, v96
    v_lshlrev_b32 v82, 16, v97
    v_mfma_f32_16x16x32_bf16 v[204:207], a[116:119], v[164:167], v[204:207]
    v_cvt_pk_bf16_f32 v220, |v200|, |v201|
    v_cvt_pk_bf16_f32 v221, |v202|, |v203|
    v_mfma_f32_16x16x32_bf16 v[204:207], a[112:115], v[160:163], v[204:207]
    v_cvt_pk_bf16_f32 v160, v224, v225
    v_cvt_pk_bf16_f32 v161, v226, v227
    v_mfma_f32_16x16x32_bf16 v[176:179], a[0:3], v[144:147], v[112:115]
    v_cvt_pk_bf16_f32 v162, v228, v229
    v_cvt_pk_bf16_f32 v163, v230, v231
    v_mfma_f32_16x16x32_bf16 v[176:179], a[4:7], v[148:151], v[176:179]
    v_mul_f32_dpp v224, v56, v24 row_newbcast:6 row_mask:0xf bank_mask:0xf
    v_mul_f32_dpp v225, v57, v25 row_newbcast:6 row_mask:0xf bank_mask:0xf
    v_mfma_f32_16x16x32_bf16 v[176:179], a[8:11], v[152:155], v[176:179]
    v_cvt_pk_bf16_f32 v222, |v204|, |v205|
    v_cvt_pk_bf16_f32 v223, |v206|, |v207|
    v_mfma_f32_16x16x32_bf16 v[176:179], a[12:15], v[156:159], v[176:179]
    v_mul_f32_dpp v226, v58, v26 row_newbcast:6 row_mask:0xf bank_mask:0xf
    v_mul_f32_dpp v227, v59, v27 row_newbcast:6 row_mask:0xf bank_mask:0xf
    v_smfmac_f32_16x16x64_bf16 v[244:247], a[148:151], v[216:223], v1
    v_mul_f32_dpp v228, v60, v28 row_newbcast:6 row_mask:0xf bank_mask:0xf
    v_mfma_f32_16x16x32_bf16 v[180:183], a[28:31], v[156:159], v[116:119]
    v_mul_f32_dpp v229, v61, v29 row_newbcast:6 row_mask:0xf bank_mask:0xf
    v_mul_f32_dpp v230, v62, v30 row_newbcast:6 row_mask:0xf bank_mask:0xf
    v_mfma_f32_16x16x32_bf16 v[180:183], a[24:27], v[152:155], v[180:183]
    v_mul_f32_dpp v231, v63, v31 row_newbcast:6 row_mask:0xf bank_mask:0xf
    v_cvt_pk_bf16_f32 v208, |v176|, |v177|
    v_mfma_f32_16x16x32_bf16 v[180:183], a[20:23], v[148:151], v[180:183]
    v_cvt_pk_bf16_f32 v209, |v178|, |v179|
    v_cvt_pk_bf16_f32 v164, v224, v225
    v_mfma_f32_16x16x32_bf16 v[180:183], a[16:19], v[144:147], v[180:183]
    v_cvt_pk_bf16_f32 v165, v226, v227
    v_cvt_pk_bf16_f32 v166, v228, v229
    v_smfmac_f32_16x16x64_bf16 v[244:247], a[168:171], v[144:151], v1
    v_cvt_pk_bf16_f32 v167, v230, v231
    v_mfma_f32_16x16x32_bf16 v[184:187], a[32:35], v[144:147], v[120:123]
    v_mul_f32_dpp v224, v64, v32 row_newbcast:6 row_mask:0xf bank_mask:0xf
    v_mul_f32_dpp v225, v65, v33 row_newbcast:6 row_mask:0xf bank_mask:0xf
    v_mfma_f32_16x16x32_bf16 v[184:187], a[36:39], v[148:151], v[184:187]
    v_mul_f32_dpp v226, v66, v34 row_newbcast:6 row_mask:0xf bank_mask:0xf
    v_mul_f32_dpp v227, v67, v35 row_newbcast:6 row_mask:0xf bank_mask:0xf
    v_mfma_f32_16x16x32_bf16 v[184:187], a[40:43], v[152:155], v[184:187]
    v_mul_f32_dpp v228, v68, v36 row_newbcast:6 row_mask:0xf bank_mask:0xf
    v_mul_f32_dpp v229, v69, v37 row_newbcast:6 row_mask:0xf bank_mask:0xf
    v_mfma_f32_16x16x32_bf16 v[184:187], a[44:47], v[156:159], v[184:187]
    v_mul_f32_dpp v230, v70, v38 row_newbcast:6 row_mask:0xf bank_mask:0xf
    v_mul_f32_dpp v231, v71, v39 row_newbcast:6 row_mask:0xf bank_mask:0xf
    v_smfmac_f32_16x16x64_bf16 v[244:247], a[172:175], v[152:159], v1
    v_cvt_pk_bf16_f32 v168, v224, v225
    v_mfma_f32_16x16x32_bf16 v[188:191], a[60:63], v[156:159], v[124:127]
    v_cvt_pk_bf16_f32 v169, v226, v227
    v_cvt_pk_bf16_f32 v170, v228, v229
    v_mfma_f32_16x16x32_bf16 v[188:191], a[56:59], v[152:155], v[188:191]
    v_cvt_pk_bf16_f32 v171, v230, v231
    v_mul_f32_dpp v224, v72, v40 row_newbcast:6 row_mask:0xf bank_mask:0xf
    v_mfma_f32_16x16x32_bf16 v[188:191], a[52:55], v[148:151], v[188:191]
    v_mul_f32_dpp v225, v73, v41 row_newbcast:6 row_mask:0xf bank_mask:0xf
    v_mul_f32_dpp v226, v74, v42 row_newbcast:6 row_mask:0xf bank_mask:0xf
    v_mfma_f32_16x16x32_bf16 v[188:191], a[48:51], v[144:147], v[188:191]
    v_mul_f32_dpp v227, v75, v43 row_newbcast:6 row_mask:0xf bank_mask:0xf
    v_mul_f32_dpp v228, v76, v44 row_newbcast:6 row_mask:0xf bank_mask:0xf
    v_mfma_f32_16x16x32_bf16 v[192:195], a[64:67], v[144:147], v[128:131]
    v_mul_f32_dpp v229, v77, v45 row_newbcast:6 row_mask:0xf bank_mask:0xf
    v_mul_f32_dpp v230, v78, v46 row_newbcast:6 row_mask:0xf bank_mask:0xf
    v_mfma_f32_16x16x32_bf16 v[192:195], a[68:71], v[148:151], v[192:195]
    v_mul_f32_dpp v231, v79, v47 row_newbcast:6 row_mask:0xf bank_mask:0xf
    v_cvt_pk_bf16_f32 v172, v224, v225
    v_mfma_f32_16x16x32_bf16 v[192:195], a[72:75], v[152:155], v[192:195]
    v_cvt_pk_bf16_f32 v173, v226, v227
    v_cvt_pk_bf16_f32 v174, v228, v229
    v_mfma_f32_16x16x32_bf16 v[192:195], a[76:79], v[156:159], v[192:195]
    v_cvt_pk_bf16_f32 v175, v230, v231
    v_cvt_pk_bf16_f32 v210, |v180|, |v181|
    v_mfma_f32_16x16x32_bf16 v[196:199], a[92:95], v[156:159], v[132:135]
    v_cvt_pk_bf16_f32 v211, |v182|, |v183|
    v_cvt_pk_bf16_f32 v212, |v184|, |v185|
    v_mfma_f32_16x16x32_bf16 v[196:199], a[88:91], v[152:155], v[196:199]
    v_cvt_pk_bf16_f32 v213, |v186|, |v187|
    v_cvt_pk_bf16_f32 v214, |v188|, |v189|
    v_mfma_f32_16x16x32_bf16 v[196:199], a[84:87], v[148:151], v[196:199]
    v_cvt_pk_bf16_f32 v215, |v190|, |v191|
    v_cvt_pk_bf16_f32 v216, |v192|, |v193|
    v_mfma_f32_16x16x32_bf16 v[196:199], a[80:83], v[144:147], v[196:199]
    v_cvt_pk_bf16_f32 v217, |v194|, |v195|
    v_mul_f32_dpp v224, v48, v16 row_newbcast:4 row_mask:0xf bank_mask:0xf
    v_smfmac_f32_16x16x64_bf16 v[244:247], a[160:163], v[208:215], v1
    v_mul_f32_dpp v225, v49, v17 row_newbcast:4 row_mask:0xf bank_mask:0xf
    v_mfma_f32_16x16x32_bf16 v[200:203], a[96:99], v[144:147], v[136:139]
    v_mul_f32_dpp v226, v50, v18 row_newbcast:4 row_mask:0xf bank_mask:0xf
    v_mul_f32_dpp v227, v51, v19 row_newbcast:4 row_mask:0xf bank_mask:0xf
    v_mfma_f32_16x16x32_bf16 v[200:203], a[100:103], v[148:151], v[200:203]
    v_cvt_pk_bf16_f32 v218, |v196|, |v197|
    v_cvt_pk_bf16_f32 v219, |v198|, |v199|
    v_mfma_f32_16x16x32_bf16 v[200:203], a[104:107], v[152:155], v[200:203]
    v_mul_f32_dpp v228, v52, v20 row_newbcast:4 row_mask:0xf bank_mask:0xf
    v_mul_f32_dpp v229, v53, v21 row_newbcast:4 row_mask:0xf bank_mask:0xf
    v_mfma_f32_16x16x32_bf16 v[200:203], a[108:111], v[156:159], v[200:203]
    v_mul_f32_dpp v230, v54, v22 row_newbcast:4 row_mask:0xf bank_mask:0xf
    v_mul_f32_dpp v231, v55, v23 row_newbcast:4 row_mask:0xf bank_mask:0xf
    v_mfma_f32_16x16x32_bf16 v[204:207], a[124:127], v[156:159], v[140:143]
    v_and_b32 v83, 0xffff0000, v97
    v_lshlrev_b32 v84, 16, v98
    v_mfma_f32_16x16x32_bf16 v[204:207], a[120:123], v[152:155], v[204:207]
    v_and_b32 v85, 0xffff0000, v98
    v_lshlrev_b32 v86, 16, v99
    v_mfma_f32_16x16x32_bf16 v[204:207], a[116:119], v[148:151], v[204:207]
    v_cvt_pk_bf16_f32 v220, |v200|, |v201|
    v_cvt_pk_bf16_f32 v221, |v202|, |v203|
    v_mfma_f32_16x16x32_bf16 v[204:207], a[112:115], v[144:147], v[204:207]
    v_cvt_pk_bf16_f32 v144, v224, v225
    v_cvt_pk_bf16_f32 v145, v226, v227
    v_mfma_f32_16x16x32_bf16 v[176:179], a[0:3], v[160:163], v[112:115]
    v_cvt_pk_bf16_f32 v146, v228, v229
    v_cvt_pk_bf16_f32 v147, v230, v231
    v_mfma_f32_16x16x32_bf16 v[176:179], a[4:7], v[164:167], v[176:179]
    v_mul_f32_dpp v224, v56, v24 row_newbcast:4 row_mask:0xf bank_mask:0xf
    v_mul_f32_dpp v225, v57, v25 row_newbcast:4 row_mask:0xf bank_mask:0xf
    v_mfma_f32_16x16x32_bf16 v[176:179], a[8:11], v[168:171], v[176:179]
    v_cvt_pk_bf16_f32 v222, |v204|, |v205|
    v_cvt_pk_bf16_f32 v223, |v206|, |v207|
    v_mfma_f32_16x16x32_bf16 v[176:179], a[12:15], v[172:175], v[176:179]
    v_mul_f32_dpp v226, v58, v26 row_newbcast:4 row_mask:0xf bank_mask:0xf
    v_mul_f32_dpp v227, v59, v27 row_newbcast:4 row_mask:0xf bank_mask:0xf
    v_smfmac_f32_16x16x64_bf16 v[244:247], a[164:167], v[216:223], v1
    v_mul_f32_dpp v228, v60, v28 row_newbcast:4 row_mask:0xf bank_mask:0xf
    v_mfma_f32_16x16x32_bf16 v[180:183], a[28:31], v[172:175], v[116:119]
    v_mul_f32_dpp v229, v61, v29 row_newbcast:4 row_mask:0xf bank_mask:0xf
    v_mul_f32_dpp v230, v62, v30 row_newbcast:4 row_mask:0xf bank_mask:0xf
    v_mfma_f32_16x16x32_bf16 v[180:183], a[24:27], v[168:171], v[180:183]
    v_mul_f32_dpp v231, v63, v31 row_newbcast:4 row_mask:0xf bank_mask:0xf
    v_cvt_pk_bf16_f32 v208, |v176|, |v177|
    v_mfma_f32_16x16x32_bf16 v[180:183], a[20:23], v[164:167], v[180:183]
    v_cvt_pk_bf16_f32 v209, |v178|, |v179|
    v_cvt_pk_bf16_f32 v148, v224, v225
    v_mfma_f32_16x16x32_bf16 v[180:183], a[16:19], v[160:163], v[180:183]
    v_cvt_pk_bf16_f32 v149, v226, v227
    v_cvt_pk_bf16_f32 v150, v228, v229
    v_smfmac_f32_16x16x64_bf16 v[244:247], a[184:187], v[160:167], v1
    v_cvt_pk_bf16_f32 v151, v230, v231
    v_mfma_f32_16x16x32_bf16 v[184:187], a[32:35], v[160:163], v[120:123]
    v_mul_f32_dpp v224, v64, v32 row_newbcast:4 row_mask:0xf bank_mask:0xf
    v_mul_f32_dpp v225, v65, v33 row_newbcast:4 row_mask:0xf bank_mask:0xf
    v_mfma_f32_16x16x32_bf16 v[184:187], a[36:39], v[164:167], v[184:187]
    v_mul_f32_dpp v226, v66, v34 row_newbcast:4 row_mask:0xf bank_mask:0xf
    v_mul_f32_dpp v227, v67, v35 row_newbcast:4 row_mask:0xf bank_mask:0xf
    v_mfma_f32_16x16x32_bf16 v[184:187], a[40:43], v[168:171], v[184:187]
    v_mul_f32_dpp v228, v68, v36 row_newbcast:4 row_mask:0xf bank_mask:0xf
    v_mul_f32_dpp v229, v69, v37 row_newbcast:4 row_mask:0xf bank_mask:0xf
    v_mfma_f32_16x16x32_bf16 v[184:187], a[44:47], v[172:175], v[184:187]
    v_mul_f32_dpp v230, v70, v38 row_newbcast:4 row_mask:0xf bank_mask:0xf
    v_mul_f32_dpp v231, v71, v39 row_newbcast:4 row_mask:0xf bank_mask:0xf
    v_smfmac_f32_16x16x64_bf16 v[244:247], a[188:191], v[168:175], v1
    v_cvt_pk_bf16_f32 v152, v224, v225
    v_mfma_f32_16x16x32_bf16 v[188:191], a[60:63], v[172:175], v[124:127]
    v_cvt_pk_bf16_f32 v153, v226, v227
    v_cvt_pk_bf16_f32 v154, v228, v229
    v_mfma_f32_16x16x32_bf16 v[188:191], a[56:59], v[168:171], v[188:191]
    v_cvt_pk_bf16_f32 v155, v230, v231
    v_mul_f32_dpp v224, v72, v40 row_newbcast:4 row_mask:0xf bank_mask:0xf
    v_mfma_f32_16x16x32_bf16 v[188:191], a[52:55], v[164:167], v[188:191]
    v_mul_f32_dpp v225, v73, v41 row_newbcast:4 row_mask:0xf bank_mask:0xf
    v_mul_f32_dpp v226, v74, v42 row_newbcast:4 row_mask:0xf bank_mask:0xf
    v_mfma_f32_16x16x32_bf16 v[188:191], a[48:51], v[160:163], v[188:191]
    v_mul_f32_dpp v227, v75, v43 row_newbcast:4 row_mask:0xf bank_mask:0xf
    v_mul_f32_dpp v228, v76, v44 row_newbcast:4 row_mask:0xf bank_mask:0xf
    v_smfmac_f32_16x16x64_bf16 v[248:251], a[136:139], v[144:151], v1
    v_mul_f32_dpp v229, v77, v45 row_newbcast:4 row_mask:0xf bank_mask:0xf
    v_mfma_f32_16x16x32_bf16 v[192:195], a[64:67], v[160:163], v[128:131]
    v_mul_f32_dpp v230, v78, v46 row_newbcast:4 row_mask:0xf bank_mask:0xf
    v_mul_f32_dpp v231, v79, v47 row_newbcast:4 row_mask:0xf bank_mask:0xf
    v_mfma_f32_16x16x32_bf16 v[192:195], a[68:71], v[164:167], v[192:195]
    v_cvt_pk_bf16_f32 v156, v224, v225
    v_cvt_pk_bf16_f32 v157, v226, v227
    v_mfma_f32_16x16x32_bf16 v[192:195], a[72:75], v[168:171], v[192:195]
    v_cvt_pk_bf16_f32 v158, v228, v229
    v_cvt_pk_bf16_f32 v159, v230, v231
    v_mfma_f32_16x16x32_bf16 v[192:195], a[76:79], v[172:175], v[192:195]
    v_cvt_pk_bf16_f32 v210, |v180|, |v181|
    v_cvt_pk_bf16_f32 v211, |v182|, |v183|
    v_smfmac_f32_16x16x64_bf16 v[248:251], a[140:143], v[152:159], v1
    v_cvt_pk_bf16_f32 v212, |v184|, |v185|
    v_mfma_f32_16x16x32_bf16 v[196:199], a[92:95], v[172:175], v[132:135]
    v_cvt_pk_bf16_f32 v213, |v186|, |v187|
    v_cvt_pk_bf16_f32 v214, |v188|, |v189|
    v_mfma_f32_16x16x32_bf16 v[196:199], a[88:91], v[168:171], v[196:199]
    v_cvt_pk_bf16_f32 v215, |v190|, |v191|
    v_cvt_pk_bf16_f32 v216, |v192|, |v193|
    v_mfma_f32_16x16x32_bf16 v[196:199], a[84:87], v[164:167], v[196:199]
    v_cvt_pk_bf16_f32 v217, |v194|, |v195|
    v_and_b32 v87, 0xffff0000, v99
    v_mfma_f32_16x16x32_bf16 v[196:199], a[80:83], v[160:163], v[196:199]
    v_lshlrev_b32 v88, 16, v100
    v_and_b32 v89, 0xffff0000, v100
    v_smfmac_f32_16x16x64_bf16 v[244:247], a[176:179], v[208:215], v1
    v_lshlrev_b32 v90, 16, v101
    v_mfma_f32_16x16x32_bf16 v[200:203], a[96:99], v[160:163], v[136:139]
    v_and_b32 v91, 0xffff0000, v101
    v_lshlrev_b32 v92, 16, v102
    v_mfma_f32_16x16x32_bf16 v[200:203], a[100:103], v[164:167], v[200:203]
    v_cvt_pk_bf16_f32 v218, |v196|, |v197|
    v_cvt_pk_bf16_f32 v219, |v198|, |v199|
    v_mfma_f32_16x16x32_bf16 v[200:203], a[104:107], v[168:171], v[200:203]
    v_and_b32 v93, 0xffff0000, v102
    v_lshlrev_b32 v94, 16, v103
    v_mfma_f32_16x16x32_bf16 v[200:203], a[108:111], v[172:175], v[200:203]
    v_and_b32 v95, 0xffff0000, v103
    v_mul_f32_dpp v224, v80, v48 row_ror:13 row_mask:0xf bank_mask:0xf
    v_mfma_f32_16x16x32_bf16 v[204:207], a[124:127], v[172:175], v[140:143]
    v_mul_f32_dpp v225, v81, v49 row_ror:13 row_mask:0xf bank_mask:0xf
    v_mul_f32_dpp v226, v82, v50 row_ror:13 row_mask:0xf bank_mask:0xf
    v_mfma_f32_16x16x32_bf16 v[204:207], a[120:123], v[168:171], v[204:207]
    v_mul_f32_dpp v227, v83, v51 row_ror:13 row_mask:0xf bank_mask:0xf
    v_mul_f32_dpp v228, v84, v52 row_ror:13 row_mask:0xf bank_mask:0xf
    v_mfma_f32_16x16x32_bf16 v[204:207], a[116:119], v[164:167], v[204:207]
    v_cvt_pk_bf16_f32 v220, |v200|, |v201|
    v_cvt_pk_bf16_f32 v221, |v202|, |v203|
    v_mfma_f32_16x16x32_bf16 v[204:207], a[112:115], v[160:163], v[204:207]
    v_mul_f32_dpp v229, v85, v53 row_ror:13 row_mask:0xf bank_mask:0xf
    v_mul_f32_dpp v230, v86, v54 row_ror:13 row_mask:0xf bank_mask:0xf
    v_mfma_f32_16x16x32_bf16 v[176:179], a[0:3], v[144:147], v[112:115]
    v_mul_f32_dpp v231, v87, v55 row_ror:13 row_mask:0xf bank_mask:0xf
    v_lshlrev_b32 v96, 16, v104
    v_mfma_f32_16x16x32_bf16 v[176:179], a[4:7], v[148:151], v[176:179]
    v_and_b32 v97, 0xffff0000, v104
    v_lshlrev_b32 v98, 16, v105
    v_mfma_f32_16x16x32_bf16 v[176:179], a[8:11], v[152:155], v[176:179]
    v_cvt_pk_bf16_f32 v222, |v204|, |v205|
    v_cvt_pk_bf16_f32 v223, |v206|, |v207|
    v_mfma_f32_16x16x32_bf16 v[176:179], a[12:15], v[156:159], v[176:179]
    v_and_b32 v99, 0xffff0000, v105
    v_lshlrev_b32 v100, 16, v106
    v_smfmac_f32_16x16x64_bf16 v[244:247], a[180:183], v[216:223], v1
    v_and_b32 v101, 0xffff0000, v106
    v_mfma_f32_16x16x32_bf16 v[180:183], a[28:31], v[156:159], v[116:119]
    v_lshlrev_b32 v102, 16, v107
    v_and_b32 v103, 0xffff0000, v107
    v_mfma_f32_16x16x32_bf16 v[180:183], a[24:27], v[152:155], v[180:183]
    v_cvt_pk_bf16_f32 v160, v224, v225
    v_cvt_pk_bf16_f32 v161, v226, v227
    v_mfma_f32_16x16x32_bf16 v[180:183], a[20:23], v[148:151], v[180:183]
    v_cvt_pk_bf16_f32 v162, v228, v229
    v_cvt_pk_bf16_f32 v163, v230, v231
    v_mfma_f32_16x16x32_bf16 v[180:183], a[16:19], v[144:147], v[180:183]
    v_lshlrev_b32 v104, 16, v108
    v_and_b32 v105, 0xffff0000, v108
    v_mfma_f32_16x16x32_bf16 v[184:187], a[32:35], v[144:147], v[120:123]
    v_lshlrev_b32 v106, 16, v109
    v_and_b32 v107, 0xffff0000, v109
    v_mfma_f32_16x16x32_bf16 v[184:187], a[36:39], v[148:151], v[184:187]
    v_lshlrev_b32 v108, 16, v110
    v_and_b32 v109, 0xffff0000, v110
    v_mfma_f32_16x16x32_bf16 v[184:187], a[40:43], v[152:155], v[184:187]
    v_mul_f32_dpp v224, v88, v56 row_ror:13 row_mask:0xf bank_mask:0xf
    v_mul_f32_dpp v225, v89, v57 row_ror:13 row_mask:0xf bank_mask:0xf
    v_mfma_f32_16x16x32_bf16 v[184:187], a[44:47], v[156:159], v[184:187]
    v_mul_f32_dpp v226, v90, v58 row_ror:13 row_mask:0xf bank_mask:0xf
    v_mul_f32_dpp v227, v91, v59 row_ror:13 row_mask:0xf bank_mask:0xf
    v_mfma_f32_16x16x32_bf16 v[188:191], a[60:63], v[156:159], v[124:127]
    v_mul_f32_dpp v228, v92, v60 row_ror:13 row_mask:0xf bank_mask:0xf
    v_mul_f32_dpp v229, v93, v61 row_ror:13 row_mask:0xf bank_mask:0xf
    v_mfma_f32_16x16x32_bf16 v[188:191], a[56:59], v[152:155], v[188:191]
    v_mul_f32_dpp v230, v94, v62 row_ror:13 row_mask:0xf bank_mask:0xf
    v_mul_f32_dpp v231, v95, v63 row_ror:13 row_mask:0xf bank_mask:0xf
    v_mfma_f32_16x16x32_bf16 v[188:191], a[52:55], v[148:151], v[188:191]
    v_cvt_pk_bf16_f32 v208, |v176|, |v177|
    v_cvt_pk_bf16_f32 v209, |v178|, |v179|
    v_mfma_f32_16x16x32_bf16 v[188:191], a[48:51], v[144:147], v[188:191]
    v_lshlrev_b32 v110, 16, v111
    v_cvt_pk_bf16_f32 v164, v224, v225
    v_mfma_f32_16x16x32_bf16 v[192:195], a[64:67], v[144:147], v[128:131]
    v_cvt_pk_bf16_f32 v165, v226, v227
    v_cvt_pk_bf16_f32 v166, v228, v229
    v_mfma_f32_16x16x32_bf16 v[192:195], a[68:71], v[148:151], v[192:195]
    v_cvt_pk_bf16_f32 v167, v230, v231
    v_and_b32 v111, 0xffff0000, v111
    v_mfma_f32_16x16x32_bf16 v[192:195], a[72:75], v[152:155], v[192:195]
    v_mul_f32_dpp v224, v96, v64 row_ror:13 row_mask:0xf bank_mask:0xf
    v_mul_f32_dpp v225, v97, v65 row_ror:13 row_mask:0xf bank_mask:0xf
    v_mfma_f32_16x16x32_bf16 v[192:195], a[76:79], v[156:159], v[192:195]
    v_mul_f32_dpp v226, v98, v66 row_ror:13 row_mask:0xf bank_mask:0xf
    v_mul_f32_dpp v227, v99, v67 row_ror:13 row_mask:0xf bank_mask:0xf
    v_mfma_f32_16x16x32_bf16 v[196:199], a[92:95], v[156:159], v[132:135]
    v_mul_f32_dpp v228, v100, v68 row_ror:13 row_mask:0xf bank_mask:0xf
    v_mul_f32_dpp v229, v101, v69 row_ror:13 row_mask:0xf bank_mask:0xf
    v_mfma_f32_16x16x32_bf16 v[196:199], a[88:91], v[152:155], v[196:199]
    v_mul_f32_dpp v230, v102, v70 row_ror:13 row_mask:0xf bank_mask:0xf
    v_mul_f32_dpp v231, v103, v71 row_ror:13 row_mask:0xf bank_mask:0xf
    v_mfma_f32_16x16x32_bf16 v[196:199], a[84:87], v[148:151], v[196:199]
    v_cvt_pk_bf16_f32 v168, v224, v225
    v_cvt_pk_bf16_f32 v169, v226, v227
    v_mfma_f32_16x16x32_bf16 v[196:199], a[80:83], v[144:147], v[196:199]
    v_cvt_pk_bf16_f32 v170, v228, v229
    v_cvt_pk_bf16_f32 v171, v230, v231
    v_mfma_f32_16x16x32_bf16 v[200:203], a[96:99], v[144:147], v[136:139]
    v_mul_f32_dpp v224, v104, v72 row_ror:13 row_mask:0xf bank_mask:0xf
    v_mul_f32_dpp v225, v105, v73 row_ror:13 row_mask:0xf bank_mask:0xf
    v_mfma_f32_16x16x32_bf16 v[200:203], a[100:103], v[148:151], v[200:203]
    v_mul_f32_dpp v226, v106, v74 row_ror:13 row_mask:0xf bank_mask:0xf
    v_mul_f32_dpp v227, v107, v75 row_ror:13 row_mask:0xf bank_mask:0xf
    v_mfma_f32_16x16x32_bf16 v[200:203], a[104:107], v[152:155], v[200:203]
    v_mul_f32_dpp v228, v108, v76 row_ror:13 row_mask:0xf bank_mask:0xf
    v_mul_f32_dpp v229, v109, v77 row_ror:13 row_mask:0xf bank_mask:0xf
    v_mfma_f32_16x16x32_bf16 v[200:203], a[108:111], v[156:159], v[200:203]
    v_mul_f32_dpp v230, v110, v78 row_ror:13 row_mask:0xf bank_mask:0xf
    v_mul_f32_dpp v231, v111, v79 row_ror:13 row_mask:0xf bank_mask:0xf
    v_mfma_f32_16x16x32_bf16 v[204:207], a[124:127], v[156:159], v[140:143]
    v_cvt_pk_bf16_f32 v172, v224, v225
    v_cvt_pk_bf16_f32 v173, v226, v227
    v_mfma_f32_16x16x32_bf16 v[204:207], a[120:123], v[152:155], v[204:207]
    v_cvt_pk_bf16_f32 v174, v228, v229
    v_cvt_pk_bf16_f32 v175, v230, v231
    v_mfma_f32_16x16x32_bf16 v[204:207], a[116:119], v[148:151], v[204:207]
    v_cvt_pk_bf16_f32 v210, |v180|, |v181|
    v_cvt_pk_bf16_f32 v211, |v182|, |v183|
    v_mfma_f32_16x16x32_bf16 v[204:207], a[112:115], v[144:147], v[204:207]
    v_cvt_pk_bf16_f32 v212, |v184|, |v185|
    v_cvt_pk_bf16_f32 v213, |v186|, |v187|
    v_mfma_f32_16x16x32_bf16 v[176:179], a[0:3], v[160:163], v[112:115]
    v_cvt_pk_bf16_f32 v214, |v188|, |v189|
    v_cvt_pk_bf16_f32 v215, |v190|, |v191|
    v_mfma_f32_16x16x32_bf16 v[176:179], a[4:7], v[164:167], v[176:179]
    v_cvt_pk_bf16_f32 v216, |v192|, |v193|
    v_cvt_pk_bf16_f32 v217, |v194|, |v195|
    v_mfma_f32_16x16x32_bf16 v[176:179], a[8:11], v[168:171], v[176:179]
    v_cvt_pk_bf16_f32 v218, |v196|, |v197|
    v_cvt_pk_bf16_f32 v219, |v198|, |v199|
    v_mfma_f32_16x16x32_bf16 v[176:179], a[12:15], v[172:175], v[176:179]
    v_cvt_pk_bf16_f32 v220, |v200|, |v201|
    v_cvt_pk_bf16_f32 v221, |v202|, |v203|
    v_smfmac_f32_16x16x64_bf16 v[248:251], a[128:131], v[208:215], v1
    v_cvt_pk_bf16_f32 v222, |v204|, |v205|
    v_mfma_f32_16x16x32_bf16 v[180:183], a[28:31], v[172:175], v[116:119]
    v_cvt_pk_bf16_f32 v223, |v206|, |v207|
    v_mul_f32_dpp v224, v80, v48 row_ror:5 row_mask:0xf bank_mask:0xf
    v_mfma_f32_16x16x32_bf16 v[180:183], a[24:27], v[168:171], v[180:183]
    v_mul_f32_dpp v225, v81, v49 row_ror:5 row_mask:0xf bank_mask:0xf
    v_mul_f32_dpp v226, v82, v50 row_ror:5 row_mask:0xf bank_mask:0xf
    v_mfma_f32_16x16x32_bf16 v[180:183], a[20:23], v[164:167], v[180:183]
    v_mul_f32_dpp v227, v83, v51 row_ror:5 row_mask:0xf bank_mask:0xf
    v_mul_f32_dpp v228, v84, v52 row_ror:5 row_mask:0xf bank_mask:0xf
    v_mfma_f32_16x16x32_bf16 v[180:183], a[16:19], v[160:163], v[180:183]
    v_mul_f32_dpp v229, v85, v53 row_ror:5 row_mask:0xf bank_mask:0xf
    v_mul_f32_dpp v230, v86, v54 row_ror:5 row_mask:0xf bank_mask:0xf
    v_smfmac_f32_16x16x64_bf16 v[248:251], a[132:135], v[216:223], v1
    v_mul_f32_dpp v231, v87, v55 row_ror:5 row_mask:0xf bank_mask:0xf
    v_mfma_f32_16x16x32_bf16 v[184:187], a[32:35], v[160:163], v[120:123]
    v_cvt_pk_bf16_f32 v144, v224, v225
    v_cvt_pk_bf16_f32 v145, v226, v227
    v_mfma_f32_16x16x32_bf16 v[184:187], a[36:39], v[164:167], v[184:187]
    v_cvt_pk_bf16_f32 v146, v228, v229
    v_cvt_pk_bf16_f32 v147, v230, v231
    v_mfma_f32_16x16x32_bf16 v[184:187], a[40:43], v[168:171], v[184:187]
    v_mul_f32_dpp v224, v88, v56 row_ror:5 row_mask:0xf bank_mask:0xf
    v_mul_f32_dpp v225, v89, v57 row_ror:5 row_mask:0xf bank_mask:0xf
    v_mfma_f32_16x16x32_bf16 v[184:187], a[44:47], v[172:175], v[184:187]
    v_mul_f32_dpp v226, v90, v58 row_ror:5 row_mask:0xf bank_mask:0xf
    v_mul_f32_dpp v227, v91, v59 row_ror:5 row_mask:0xf bank_mask:0xf
    v_smfmac_f32_16x16x64_bf16 v[248:251], a[152:155], v[160:167], v1
    v_mul_f32_dpp v228, v92, v60 row_ror:5 row_mask:0xf bank_mask:0xf
    v_mfma_f32_16x16x32_bf16 v[188:191], a[60:63], v[172:175], v[124:127]
    v_mul_f32_dpp v229, v93, v61 row_ror:5 row_mask:0xf bank_mask:0xf
    v_mul_f32_dpp v230, v94, v62 row_ror:5 row_mask:0xf bank_mask:0xf
    v_mfma_f32_16x16x32_bf16 v[188:191], a[56:59], v[168:171], v[188:191]
    v_mul_f32_dpp v231, v95, v63 row_ror:5 row_mask:0xf bank_mask:0xf
    v_cvt_pk_bf16_f32 v208, |v176|, |v177|
    v_mfma_f32_16x16x32_bf16 v[188:191], a[52:55], v[164:167], v[188:191]
    v_cvt_pk_bf16_f32 v209, |v178|, |v179|
    v_cvt_pk_bf16_f32 v148, v224, v225
    v_mfma_f32_16x16x32_bf16 v[188:191], a[48:51], v[160:163], v[188:191]
    v_cvt_pk_bf16_f32 v149, v226, v227
    v_cvt_pk_bf16_f32 v150, v228, v229
    v_smfmac_f32_16x16x64_bf16 v[248:251], a[156:159], v[168:175], v1
    v_cvt_pk_bf16_f32 v151, v230, v231
    v_mfma_f32_16x16x32_bf16 v[192:195], a[64:67], v[160:163], v[128:131]
    v_mul_f32_dpp v224, v96, v64 row_ror:5 row_mask:0xf bank_mask:0xf
    v_mul_f32_dpp v225, v97, v65 row_ror:5 row_mask:0xf bank_mask:0xf
    v_mfma_f32_16x16x32_bf16 v[192:195], a[68:71], v[164:167], v[192:195]
    v_mul_f32_dpp v226, v98, v66 row_ror:5 row_mask:0xf bank_mask:0xf
    v_mul_f32_dpp v227, v99, v67 row_ror:5 row_mask:0xf bank_mask:0xf
    v_mfma_f32_16x16x32_bf16 v[192:195], a[72:75], v[168:171], v[192:195]
    v_mul_f32_dpp v228, v100, v68 row_ror:5 row_mask:0xf bank_mask:0xf
    v_mul_f32_dpp v229, v101, v69 row_ror:5 row_mask:0xf bank_mask:0xf
    v_mfma_f32_16x16x32_bf16 v[192:195], a[76:79], v[172:175], v[192:195]
    v_mul_f32_dpp v230, v102, v70 row_ror:5 row_mask:0xf bank_mask:0xf
    v_mul_f32_dpp v231, v103, v71 row_ror:5 row_mask:0xf bank_mask:0xf
    v_mfma_f32_16x16x32_bf16 v[196:199], a[92:95], v[172:175], v[132:135]
    v_cvt_pk_bf16_f32 v152, v224, v225
    v_cvt_pk_bf16_f32 v153, v226, v227
    v_mfma_f32_16x16x32_bf16 v[196:199], a[88:91], v[168:171], v[196:199]
    v_cvt_pk_bf16_f32 v154, v228, v229
    v_cvt_pk_bf16_f32 v155, v230, v231
    v_mfma_f32_16x16x32_bf16 v[196:199], a[84:87], v[164:167], v[196:199]
    v_mul_f32_dpp v224, v104, v72 row_ror:5 row_mask:0xf bank_mask:0xf
    v_mul_f32_dpp v225, v105, v73 row_ror:5 row_mask:0xf bank_mask:0xf
    v_mfma_f32_16x16x32_bf16 v[196:199], a[80:83], v[160:163], v[196:199]
    v_mul_f32_dpp v226, v106, v74 row_ror:5 row_mask:0xf bank_mask:0xf
    v_mul_f32_dpp v227, v107, v75 row_ror:5 row_mask:0xf bank_mask:0xf
    v_mfma_f32_16x16x32_bf16 v[200:203], a[96:99], v[160:163], v[136:139]
    v_mul_f32_dpp v228, v108, v76 row_ror:5 row_mask:0xf bank_mask:0xf
    v_mul_f32_dpp v229, v109, v77 row_ror:5 row_mask:0xf bank_mask:0xf
    v_mfma_f32_16x16x32_bf16 v[200:203], a[100:103], v[164:167], v[200:203]
    v_mul_f32_dpp v230, v110, v78 row_ror:5 row_mask:0xf bank_mask:0xf
    v_mul_f32_dpp v231, v111, v79 row_ror:5 row_mask:0xf bank_mask:0xf
    v_mfma_f32_16x16x32_bf16 v[200:203], a[104:107], v[168:171], v[200:203]
    v_cvt_pk_bf16_f32 v156, v224, v225
    v_cvt_pk_bf16_f32 v157, v226, v227
    v_mfma_f32_16x16x32_bf16 v[200:203], a[108:111], v[172:175], v[200:203]
L_stub3:
    s_cbranch_scc1 L_main2
    v_cvt_pk_bf16_f32 v158, v228, v229
    v_cvt_pk_bf16_f32 v159, v230, v231
    v_mfma_f32_16x16x32_bf16 v[204:207], a[124:127], v[172:175], v[140:143]
    v_cvt_pk_bf16_f32 v210, |v180|, |v181|
    v_cvt_pk_bf16_f32 v211, |v182|, |v183|
    v_mfma_f32_16x16x32_bf16 v[204:207], a[120:123], v[168:171], v[204:207]
    v_cvt_pk_bf16_f32 v212, |v184|, |v185|
    v_cvt_pk_bf16_f32 v213, |v186|, |v187|
    v_mfma_f32_16x16x32_bf16 v[204:207], a[116:119], v[164:167], v[204:207]
    v_cvt_pk_bf16_f32 v214, |v188|, |v189|
    v_cvt_pk_bf16_f32 v215, |v190|, |v191|
    v_mfma_f32_16x16x32_bf16 v[204:207], a[112:115], v[160:163], v[204:207]
    v_cvt_pk_bf16_f32 v216, |v192|, |v193|
    v_cvt_pk_bf16_f32 v217, |v194|, |v195|
    v_smfmac_f32_16x16x64_bf16 v[248:251], a[144:147], v[208:215], v1
    v_cvt_pk_bf16_f32 v218, |v196|, |v197|
    v_mfma_f32_16x16x32_bf16 v[176:179], a[0:3], v[144:147], v[112:115]
    v_cvt_pk_bf16_f32 v219, |v198|, |v199|
    v_cvt_pk_bf16_f32 v220, |v200|, |v201|
    v_mfma_f32_16x16x32_bf16 v[176:179], a[4:7], v[148:151], v[176:179]
    v_cvt_pk_bf16_f32 v221, |v202|, |v203|
    v_cvt_pk_bf16_f32 v222, |v204|, |v205|
    v_mfma_f32_16x16x32_bf16 v[176:179], a[8:11], v[152:155], v[176:179]
    v_cvt_pk_bf16_f32 v223, |v206|, |v207|
    v_mul_f32 v224, v80, v48
    v_mfma_f32_16x16x32_bf16 v[176:179], a[12:15], v[156:159], v[176:179]
    v_mul_f32 v225, v81, v49
    v_mul_f32 v226, v82, v50
    v_smfmac_f32_16x16x64_bf16 v[248:251], a[148:151], v[216:223], v1
    v_mul_f32 v227, v83, v51
    v_mfma_f32_16x16x32_bf16 v[180:183], a[28:31], v[156:159], v[116:119]
    v_mul_f32 v228, v84, v52
    v_mul_f32 v229, v85, v53
    v_mfma_f32_16x16x32_bf16 v[180:183], a[24:27], v[152:155], v[180:183]
    v_mul_f32 v230, v86, v54
    v_mul_f32 v231, v87, v55
    v_mfma_f32_16x16x32_bf16 v[180:183], a[20:23], v[148:151], v[180:183]
    v_cvt_pk_bf16_f32 v160, v224, v225
    v_cvt_pk_bf16_f32 v161, v226, v227
    v_mfma_f32_16x16x32_bf16 v[180:183], a[16:19], v[144:147], v[180:183]
    v_cvt_pk_bf16_f32 v162, v228, v229
    v_cvt_pk_bf16_f32 v163, v230, v231
    v_smfmac_f32_16x16x64_bf16 v[248:251], a[168:171], v[144:151], v1
    v_mul_f32 v224, v88, v56
    v_mfma_f32_16x16x32_bf16 v[184:187], a[32:35], v[144:147], v[120:123]
    v_mul_f32 v225, v89, v57
    v_mul_f32 v226, v90, v58
    v_mfma_f32_16x16x32_bf16 v[184:187], a[36:39], v[148:151], v[184:187]
    v_mul_f32 v227, v91, v59
    v_mul_f32 v228, v92, v60
    v_mfma_f32_16x16x32_bf16 v[184:187], a[40:43], v[152:155], v[184:187]
    v_mul_f32 v229, v93, v61
    v_mul_f32 v230, v94, v62
    v_mfma_f32_16x16x32_bf16 v[184:187], a[44:47], v[156:159], v[184:187]
    v_mul_f32 v231, v95, v63
    v_cvt_pk_bf16_f32 v208, |v176|, |v177|
    v_smfmac_f32_16x16x64_bf16 v[248:251], a[172:175], v[152:159], v1
    v_cvt_pk_bf16_f32 v209, |v178|, |v179|
    v_mfma_f32_16x16x32_bf16 v[188:191], a[60:63], v[156:159], v[124:127]
    v_cvt_pk_bf16_f32 v164, v224, v225
    v_cvt_pk_bf16_f32 v165, v226, v227
    v_mfma_f32_16x16x32_bf16 v[188:191], a[56:59], v[152:155], v[188:191]
    v_cvt_pk_bf16_f32 v166, v228, v229
    v_cvt_pk_bf16_f32 v167, v230, v231
    v_mfma_f32_16x16x32_bf16 v[188:191], a[52:55], v[148:151], v[188:191]
    v_mul_f32 v224, v96, v64
    v_mul_f32 v225, v97, v65
    v_mfma_f32_16x16x32_bf16 v[188:191], a[48:51], v[144:147], v[188:191]
    v_mul_f32 v226, v98, v66
    v_mul_f32 v227, v99, v67
    v_mfma_f32_16x16x32_bf16 v[192:195], a[64:67], v[144:147], v[128:131]
    v_mul_f32 v228, v100, v68
    v_mul_f32 v229, v101, v69
    v_mfma_f32_16x16x32_bf16 v[192:195], a[68:71], v[148:151], v[192:195]
    v_mul_f32 v230, v102, v70
    v_mul_f32 v231, v103, v71
    v_mfma_f32_16x16x32_bf16 v[192:195], a[72:75], v[152:155], v[192:195]
    v_cvt_pk_bf16_f32 v168, v224, v225
    v_cvt_pk_bf16_f32 v169, v226, v227
    v_mfma_f32_16x16x32_bf16 v[192:195], a[76:79], v[156:159], v[192:195]
    v_cvt_pk_bf16_f32 v170, v228, v229
    v_cvt_pk_bf16_f32 v171, v230, v231
    v_mfma_f32_16x16x32_bf16 v[196:199], a[92:95], v[156:159], v[132:135]
    v_mul_f32 v224, v104, v72
    v_mul_f32 v225, v105, v73
    v_mfma_f32_16x16x32_bf16 v[196:199], a[88:91], v[152:155], v[196:199]
    v_mul_f32 v226, v106, v74
    v_mul_f32 v227, v107, v75
    v_mfma_f32_16x16x32_bf16 v[196:199], a[84:87], v[148:151], v[196:199]
    v_mul_f32 v228, v108, v76
    v_mul_f32 v229, v109, v77
    v_mfma_f32_16x16x32_bf16 v[196:199], a[80:83], v[144:147], v[196:199]
    v_mul_f32 v230, v110, v78
    v_mul_f32 v231, v111, v79
    v_mfma_f32_16x16x32_bf16 v[200:203], a[96:99], v[144:147], v[136:139]
    v_cvt_pk_bf16_f32 v172, v224, v225
    v_cvt_pk_bf16_f32 v173, v226, v227
    v_mfma_f32_16x16x32_bf16 v[200:203], a[100:103], v[148:151], v[200:203]
    v_cvt_pk_bf16_f32 v174, v228, v229
    v_cvt_pk_bf16_f32 v175, v230, v231
    v_mfma_f32_16x16x32_bf16 v[200:203], a[104:107], v[152:155], v[200:203]
    v_cvt_pk_bf16_f32 v210, |v180|, |v181|
    v_cvt_pk_bf16_f32 v211, |v182|, |v183|
    v_mfma_f32_16x16x32_bf16 v[200:203], a[108:111], v[156:159], v[200:203]
    v_cvt_pk_bf16_f32 v212, |v184|, |v185|
    v_cvt_pk_bf16_f32 v213, |v186|, |v187|
    v_mfma_f32_16x16x32_bf16 v[204:207], a[124:127], v[156:159], v[140:143]
    v_cvt_pk_bf16_f32 v214, |v188|, |v189|
    v_cvt_pk_bf16_f32 v215, |v190|, |v191|
    v_mfma_f32_16x16x32_bf16 v[204:207], a[120:123], v[152:155], v[204:207]
    v_cvt_pk_bf16_f32 v216, |v192|, |v193|
    v_cvt_pk_bf16_f32 v217, |v194|, |v195|
    v_mfma_f32_16x16x32_bf16 v[204:207], a[116:119], v[148:151], v[204:207]
    v_cvt_pk_bf16_f32 v218, |v196|, |v197|
    v_cvt_pk_bf16_f32 v219, |v198|, |v199|
    v_mfma_f32_16x16x32_bf16 v[204:207], a[112:115], v[144:147], v[204:207]
    v_cvt_pk_bf16_f32 v220, |v200|, |v201|
    v_cvt_pk_bf16_f32 v221, |v202|, |v203|
    v_smfmac_f32_16x16x64_bf16 v[248:251], a[160:163], v[208:215], v1
    v_mul_f32_dpp v224, v16, v16 row_ror:8 row_mask:0xf bank_mask:0xf
    v_mfma_f32_16x16x32_bf16 v[176:179], a[0:3], v[160:163], v[112:115]
    v_mul_f32_dpp v225, v17, v17 row_ror:8 row_mask:0xf bank_mask:0xf
    v_mul_f32_dpp v226, v18, v18 row_ror:8 row_mask:0xf bank_mask:0xf
    v_mfma_f32_16x16x32_bf16 v[176:179], a[4:7], v[164:167], v[176:179]
    v_cvt_pk_bf16_f32 v222, |v204|, |v205|
    v_cvt_pk_bf16_f32 v223, |v206|, |v207|
    v_mfma_f32_16x16x32_bf16 v[176:179], a[8:11], v[168:171], v[176:179]
    v_mul_f32_dpp v227, v19, v19 row_ror:8 row_mask:0xf bank_mask:0xf
    v_mul_f32_dpp v228, v20, v20 row_ror:8 row_mask:0xf bank_mask:0xf
    v_mfma_f32_16x16x32_bf16 v[176:179], a[12:15], v[172:175], v[176:179]
    v_mul_f32_dpp v229, v21, v21 row_ror:8 row_mask:0xf bank_mask:0xf
    v_mul_f32_dpp v230, v22, v22 row_ror:8 row_mask:0xf bank_mask:0xf
    v_smfmac_f32_16x16x64_bf16 v[248:251], a[164:167], v[216:223], v1
    v_mul_f32_dpp v231, v23, v23 row_ror:8 row_mask:0xf bank_mask:0xf
    v_mfma_f32_16x16x32_bf16 v[180:183], a[28:31], v[172:175], v[116:119]
    v_cvt_pk_bf16_f32 v144, v224, v225
    v_cvt_pk_bf16_f32 v145, v226, v227
    v_mfma_f32_16x16x32_bf16 v[180:183], a[24:27], v[168:171], v[180:183]
    v_cvt_pk_bf16_f32 v146, v228, v229
    v_cvt_pk_bf16_f32 v147, v230, v231
    v_mfma_f32_16x16x32_bf16 v[180:183], a[20:23], v[164:167], v[180:183]
    v_mul_f32_dpp v224, v24, v24 row_ror:8 row_mask:0xf bank_mask:0xf
    v_mul_f32_dpp v225, v25, v25 row_ror:8 row_mask:0xf bank_mask:0xf
    v_mfma_f32_16x16x32_bf16 v[180:183], a[16:19], v[160:163], v[180:183]
    v_mul_f32_dpp v226, v26, v26 row_ror:8 row_mask:0xf bank_mask:0xf
    v_mul_f32_dpp v227, v27, v27 row_ror:8 row_mask:0xf bank_mask:0xf
    v_smfmac_f32_16x16x64_bf16 v[248:251], a[184:187], v[160:167], v1
    v_mul_f32_dpp v228, v28, v28 row_ror:8 row_mask:0xf bank_mask:0xf
    v_mfma_f32_16x16x32_bf16 v[184:187], a[32:35], v[160:163], v[120:123]
    v_mul_f32_dpp v229, v29, v29 row_ror:8 row_mask:0xf bank_mask:0xf
    v_mul_f32_dpp v230, v30, v30 row_ror:8 row_mask:0xf bank_mask:0xf
    v_mfma_f32_16x16x32_bf16 v[184:187], a[36:39], v[164:167], v[184:187]
    v_mul_f32_dpp v231, v31, v31 row_ror:8 row_mask:0xf bank_mask:0xf
    v_cvt_pk_bf16_f32 v208, |v176|, |v177|
    v_mfma_f32_16x16x32_bf16 v[184:187], a[40:43], v[168:171], v[184:187]
    v_cvt_pk_bf16_f32 v209, |v178|, |v179|
    v_cvt_pk_bf16_f32 v148, v224, v225
    v_mfma_f32_16x16x32_bf16 v[184:187], a[44:47], v[172:175], v[184:187]
    v_cvt_pk_bf16_f32 v149, v226, v227
    v_cvt_pk_bf16_f32 v150, v228, v229
    v_smfmac_f32_16x16x64_bf16 v[248:251], a[188:191], v[168:175], v1
    v_cvt_pk_bf16_f32 v151, v230, v231
    v_mfma_f32_16x16x32_bf16 v[188:191], a[60:63], v[172:175], v[124:127]
    v_mul_f32_dpp v224, v32, v32 row_ror:8 row_mask:0xf bank_mask:0xf
    v_mul_f32_dpp v225, v33, v33 row_ror:8 row_mask:0xf bank_mask:0xf
    v_mfma_f32_16x16x32_bf16 v[188:191], a[56:59], v[168:171], v[188:191]
    v_mul_f32_dpp v226, v34, v34 row_ror:8 row_mask:0xf bank_mask:0xf
    v_mul_f32_dpp v227, v35, v35 row_ror:8 row_mask:0xf bank_mask:0xf
    v_mfma_f32_16x16x32_bf16 v[188:191], a[52:55], v[164:167], v[188:191]
    v_mul_f32_dpp v228, v36, v36 row_ror:8 row_mask:0xf bank_mask:0xf
    v_mul_f32_dpp v229, v37, v37 row_ror:8 row_mask:0xf bank_mask:0xf
    v_mfma_f32_16x16x32_bf16 v[188:191], a[48:51], v[160:163], v[188:191]
    v_mul_f32_dpp v230, v38, v38 row_ror:8 row_mask:0xf bank_mask:0xf
    v_mul_f32_dpp v231, v39, v39 row_ror:8 row_mask:0xf bank_mask:0xf
    v_smfmac_f32_16x16x64_bf16 v[252:255], a[136:139], v[144:151], v1
    v_cvt_pk_bf16_f32 v152, v224, v225
    v_mfma_f32_16x16x32_bf16 v[192:195], a[64:67], v[160:163], v[128:131]
    v_cvt_pk_bf16_f32 v153, v226, v227
    v_cvt_pk_bf16_f32 v154, v228, v229
    v_mfma_f32_16x16x32_bf16 v[192:195], a[68:71], v[164:167], v[192:195]
    v_cvt_pk_bf16_f32 v155, v230, v231
    v_mul_f32_dpp v224, v40, v40 row_ror:8 row_mask:0xf bank_mask:0xf
    v_mfma_f32_16x16x32_bf16 v[192:195], a[72:75], v[168:171], v[192:195]
    v_mul_f32_dpp v225, v41, v41 row_ror:8 row_mask:0xf bank_mask:0xf
    v_mul_f32_dpp v226, v42, v42 row_ror:8 row_mask:0xf bank_mask:0xf
    v_mfma_f32_16x16x32_bf16 v[192:195], a[76:79], v[172:175], v[192:195]
    v_mul_f32_dpp v227, v43, v43 row_ror:8 row_mask:0xf bank_mask:0xf
    v_mul_f32_dpp v228, v44, v44 row_ror:8 row_mask:0xf bank_mask:0xf
    v_mfma_f32_16x16x32_bf16 v[196:199], a[92:95], v[172:175], v[132:135]
    v_mul_f32_dpp v229, v45, v45 row_ror:8 row_mask:0xf bank_mask:0xf
    v_mul_f32_dpp v230, v46, v46 row_ror:8 row_mask:0xf bank_mask:0xf
    v_mfma_f32_16x16x32_bf16 v[196:199], a[88:91], v[168:171], v[196:199]
    v_mul_f32_dpp v231, v47, v47 row_ror:8 row_mask:0xf bank_mask:0xf
    v_cvt_pk_bf16_f32 v156, v224, v225
    v_mfma_f32_16x16x32_bf16 v[196:199], a[84:87], v[164:167], v[196:199]
    v_cvt_pk_bf16_f32 v157, v226, v227
    v_cvt_pk_bf16_f32 v158, v228, v229
    v_mfma_f32_16x16x32_bf16 v[196:199], a[80:83], v[160:163], v[196:199]
    v_cvt_pk_bf16_f32 v159, v230, v231
    v_cvt_pk_bf16_f32 v210, |v180|, |v181|
    v_mfma_f32_16x16x32_bf16 v[200:203], a[96:99], v[160:163], v[136:139]
    v_cvt_pk_bf16_f32 v211, |v182|, |v183|
    v_cvt_pk_bf16_f32 v212, |v184|, |v185|
    v_mfma_f32_16x16x32_bf16 v[200:203], a[100:103], v[164:167], v[200:203]
    v_cvt_pk_bf16_f32 v213, |v186|, |v187|
    v_cvt_pk_bf16_f32 v214, |v188|, |v189|
    v_mfma_f32_16x16x32_bf16 v[200:203], a[104:107], v[168:171], v[200:203]
    v_cvt_pk_bf16_f32 v215, |v190|, |v191|
    v_cvt_pk_bf16_f32 v216, |v192|, |v193|
    v_mfma_f32_16x16x32_bf16 v[200:203], a[108:111], v[172:175], v[200:203]
    v_cvt_pk_bf16_f32 v217, |v194|, |v195|
    v_cvt_pk_bf16_f32 v218, |v196|, |v197|
    v_smfmac_f32_16x16x64_bf16 v[248:251], a[176:179], v[208:215], v1
    v_cvt_pk_bf16_f32 v219, |v198|, |v199|
    v_mfma_f32_16x16x32_bf16 v[204:207], a[124:127], v[172:175], v[140:143]
    v_add_f32 v232, v232, v233
    v_add_f32 v236, v236, v237
    v_mfma_f32_16x16x32_bf16 v[204:207], a[120:123], v[168:171], v[204:207]
    v_cvt_pk_bf16_f32 v220, |v200|, |v201|
    v_cvt_pk_bf16_f32 v221, |v202|, |v203|
    v_mfma_f32_16x16x32_bf16 v[204:207], a[116:119], v[164:167], v[204:207]
    v_add_f32 v240, v240, v241
    v_max3_f32 v12, v232, v236, v240
    v_mfma_f32_16x16x32_bf16 v[204:207], a[112:115], v[160:163], v[204:207]
    v_add_f32 v244, v244, v245
    v_add_f32 v234, v234, v235
    v_smfmac_f32_16x16x64_bf16 v[252:255], a[140:143], v[152:159], v1
    v_add_f32 v238, v238, v239
    v_mfma_f32_16x16x32_bf16 v[176:179], a[0:3], v[144:147], v[112:115]
    v_add_f32 v242, v242, v243
    v_add_f32 v246, v246, v247
    v_mfma_f32_16x16x32_bf16 v[176:179], a[4:7], v[148:151], v[176:179]
    v_cvt_pk_bf16_f32 v222, |v204|, |v205|
    v_cvt_pk_bf16_f32 v223, |v206|, |v207|
    v_mfma_f32_16x16x32_bf16 v[176:179], a[8:11], v[152:155], v[176:179]
    v_mfma_f32_16x16x32_bf16 v[176:179], a[12:15], v[156:159], v[176:179]
    v_smfmac_f32_16x16x64_bf16 v[248:251], a[180:183], v[216:223], v1
    v_mfma_f32_16x16x32_bf16 v[180:183], a[28:31], v[156:159], v[116:119]
    v_mfma_f32_16x16x32_bf16 v[180:183], a[24:27], v[152:155], v[180:183]
    v_mfma_f32_16x16x32_bf16 v[180:183], a[20:23], v[148:151], v[180:183]
    v_mfma_f32_16x16x32_bf16 v[180:183], a[16:19], v[144:147], v[180:183]
    v_mfma_f32_16x16x32_bf16 v[184:187], a[32:35], v[144:147], v[120:123]
    v_mfma_f32_16x16x32_bf16 v[184:187], a[36:39], v[148:151], v[184:187]
    v_mfma_f32_16x16x32_bf16 v[184:187], a[40:43], v[152:155], v[184:187]
    v_cvt_pk_bf16_f32 v208, |v176|, |v177|
    v_add_f32 v248, v248, v249
    v_mfma_f32_16x16x32_bf16 v[184:187], a[44:47], v[156:159], v[184:187]
    v_max3_f32 v12, v12, v244, v248
    v_mul_f32 v2, v12, v10
    v_mfma_f32_16x16x32_bf16 v[188:191], a[60:63], v[156:159], v[124:127]
    v_max_f32_dpp v12, v12, v12 row_ror:8 row_mask:0xf bank_mask:0xf
    v_cvt_pk_bf16_f32 v209, |v178|, |v179|
    v_mfma_f32_16x16x32_bf16 v[188:191], a[56:59], v[152:155], v[188:191]
    v_max_f32_dpp v12, v12, v12 row_ror:4 row_mask:0xf bank_mask:0xf
    v_cvt_pk_bf16_f32 v210, |v180|, |v181|
    v_mfma_f32_16x16x32_bf16 v[188:191], a[52:55], v[148:151], v[188:191]
    v_max_f32_dpp v12, v12, v12 row_ror:2 row_mask:0xf bank_mask:0xf
    v_cvt_pk_bf16_f32 v211, |v182|, |v183|
    v_mfma_f32_16x16x32_bf16 v[188:191], a[48:51], v[144:147], v[188:191]
    v_max_f32_dpp v12, v12, v12 row_ror:1 row_mask:0xf bank_mask:0xf
    v_cvt_pk_bf16_f32 v212, |v184|, |v185|
    v_mfma_f32_16x16x32_bf16 v[192:195], a[64:67], v[144:147], v[128:131]
    v_cvt_pk_bf16_f32 v213, |v186|, |v187|
    v_max_f32_dpp v12, v12, v12 row_bcast:15 row_mask:0xa bank_mask:0xf
    v_mfma_f32_16x16x32_bf16 v[192:195], a[68:71], v[148:151], v[192:195]
    v_fma_f32 v232, v232, v10, -v2
    v_max_f32_dpp v12, v12, v12 row_bcast:31 row_mask:0xc bank_mask:0xf
    v_mfma_f32_16x16x32_bf16 v[192:195], a[72:75], v[152:155], v[192:195]
    v_cvt_pk_bf16_f32 v214, |v188|, |v189|
    v_cvt_pk_bf16_f32 v215, |v190|, |v191|
    v_mfma_f32_16x16x32_bf16 v[192:195], a[76:79], v[156:159], v[192:195]
    v_readlane_b32 s14, v12, 63
    v_fma_f32 v236, v236, v10, -v2
    v_smfmac_f32_16x16x64_bf16 v[252:255], a[128:131], v[208:215], v1
    v_exp_f32 v232, v232
    v_mfma_f32_16x16x32_bf16 v[196:199], a[92:95], v[156:159], v[132:135]
    v_exp_f32 v236, v236
    v_mfma_f32_16x16x32_bf16 v[196:199], a[88:91], v[152:155], v[196:199]
    v_fma_f32 v240, v240, v10, -v2
    v_exp_f32 v240, v240
    v_mfma_f32_16x16x32_bf16 v[196:199], a[84:87], v[148:151], v[196:199]
    v_fma_f32 v244, v244, v10, -v2
    v_cvt_pk_bf16_f32 v216, |v192|, |v193|
    v_mfma_f32_16x16x32_bf16 v[196:199], a[80:83], v[144:147], v[196:199]
    v_cvt_pk_bf16_f32 v217, |v194|, |v195|
    v_mul_f32 v13, s14, v10
    v_mfma_f32_16x16x32_bf16 v[200:203], a[96:99], v[144:147], v[136:139]
    v_exp_f32 v244, v244
    v_mfma_f32_16x16x32_bf16 v[200:203], a[100:103], v[148:151], v[200:203]
    v_fma_f32 v248, v248, v10, -v2
    v_add_f32 v14, v232, v236
    v_mfma_f32_16x16x32_bf16 v[200:203], a[104:107], v[152:155], v[200:203]
    v_cvt_pk_bf16_f32 v218, |v196|, |v197|
    v_cvt_pk_bf16_f32 v219, |v198|, |v199|
    v_mfma_f32_16x16x32_bf16 v[200:203], a[108:111], v[156:159], v[200:203]
    v_sub_f32 v3, v2, v13
    v_exp_f32 v248, v248
    v_mfma_f32_16x16x32_bf16 v[204:207], a[124:127], v[156:159], v[140:143]
    v_mul_f32 v15, v232, v234
    v_add_f32 v14, v14, v240
    v_mfma_f32_16x16x32_bf16 v[204:207], a[120:123], v[152:155], v[204:207]
    v_exp_f32 v3, v3
    v_mfma_f32_16x16x32_bf16 v[204:207], a[116:119], v[148:151], v[204:207]
    v_cvt_pk_bf16_f32 v220, |v200|, |v201|
    v_cvt_pk_bf16_f32 v221, |v202|, |v203|
    v_mfma_f32_16x16x32_bf16 v[204:207], a[112:115], v[144:147], v[204:207]
    v_fmac_f32 v15, v236, v238
    v_add_f32 v14, v14, v244
    v_fmac_f32 v15, v240, v242
    v_add_f32 v14, v14, v248
    v_add_f32 v250, v250, v251
    v_fmac_f32 v15, v244, v246
    v_mul_f32 v14, v14, v3
    v_fmac_f32 v15, v248, v250
    v_cvt_pk_bf16_f32 v222, |v204|, |v205|
    v_cvt_pk_bf16_f32 v223, |v206|, |v207|
    v_mul_f32 v15, v15, v3
    v_add_f32_dpp v14, v14, v14 row_ror:8 row_mask:0xf bank_mask:0xf
    v_smfmac_f32_16x16x64_bf16 v[252:255], a[132:135], v[216:223], v1
    v_add_f32_dpp v15, v15, v15 row_ror:8 row_mask:0xf bank_mask:0xf
    v_add_f32_dpp v14, v14, v14 row_ror:4 row_mask:0xf bank_mask:0xf
    s_nop 0
    v_add_f32_dpp v15, v15, v15 row_ror:4 row_mask:0xf bank_mask:0xf
    v_add_f32_dpp v14, v14, v14 row_ror:2 row_mask:0xf bank_mask:0xf
    s_nop 0
    v_add_f32_dpp v15, v15, v15 row_ror:2 row_mask:0xf bank_mask:0xf
    v_add_f32_dpp v14, v14, v14 row_ror:1 row_mask:0xf bank_mask:0xf
    v_add_f32 v252, v252, v253
    v_max_f32 v6, s14, v252
    v_add_f32_dpp v15, v15, v15 row_ror:1 row_mask:0xf bank_mask:0xf
    v_add_f32 v254, v254, v255
    v_max_f32_dpp v6, v6, v6 row_ror:4 row_mask:0xf bank_mask:0xf
    v_add_f32_dpp v14, v14, v14 row_bcast:15 row_mask:0xa bank_mask:0xf
    v_add_f32_dpp v15, v15, v15 row_bcast:15 row_mask:0xa bank_mask:0xf
    v_max_f32_dpp v6, v6, v6 row_ror:2 row_mask:0xf bank_mask:0xf
    v_add_f32_dpp v14, v14, v14 row_bcast:31 row_mask:0xc bank_mask:0xf
    v_add_f32_dpp v15, v15, v15 row_bcast:31 row_mask:0xc bank_mask:0xf
    v_max_f32_dpp v6, v6, v6 row_ror:1 row_mask:0xf bank_mask:0xf
    v_mul_f32 v4, v6, v10
    v_fma_f32 v252, v252, v10, -v4
    v_exp_f32 v252, v252
    v_readlane_b32 s15, v14, 63
    v_mul_f32 v254, v252, v254
    v_add_f32_dpp v252, v252, v252 row_ror:4 row_mask:0xf bank_mask:0xf
    v_sub_f32 v5, v13, v4
    v_add_f32_dpp v254, v254, v254 row_ror:4 row_mask:0xf bank_mask:0xf
    v_add_f32_dpp v252, v252, v252 row_ror:2 row_mask:0xf bank_mask:0xf
    v_exp_f32 v5, v5
    v_add_f32_dpp v254, v254, v254 row_ror:2 row_mask:0xf bank_mask:0xf
    v_readlane_b32 s34, v15, 63
    v_add_f32_dpp v252, v252, v252 row_ror:1 row_mask:0xf bank_mask:0xf
    v_fmac_f32 v252, s15, v5
    v_add_f32_dpp v254, v254, v254 row_ror:1 row_mask:0xf bank_mask:0xf
    v_rcp_f32 v252, v252
    v_fmac_f32 v254, s34, v5
    v_mul_f32 v254, v254, v252
    v_cvt_pk_bf16_f32 v254, v254, v254
    buffer_store_short v254, v11, s[36:39], 0 offen
L_end:
s_endpgm
.section .rodata,"a"
.p2align 6
.amdhsa_kernel standalone__factorization_afm__recsys_kernel
  .amdhsa_next_free_vgpr 448
  .amdhsa_next_free_sgpr 102
  .amdhsa_accum_offset 256
  .amdhsa_group_segment_fixed_size 0
  .amdhsa_kernarg_size 88
  .amdhsa_user_sgpr_count 2
  .amdhsa_user_sgpr_kernarg_segment_ptr 1
  .amdhsa_system_sgpr_workgroup_id_x 1
  .amdhsa_float_denorm_mode_32 3
.end_amdhsa_kernel
```

```asm
; @launch grid=(256,1,1) block=(256,1,1) lds=66816
.amdgcn_target "amdgcn-amd-amdhsa--gfx950"
.text
.globl standalone__factorization_afm__recsys_kernel
.p2align 8
.type standalone__factorization_afm__recsys_kernel,@function
standalone__factorization_afm__recsys_kernel:
    s_load_dwordx16 s[16:31], s[0:1], 0
    s_load_dwordx2 s[36:37], s[0:1], 64
    s_cmp_ge_u32 s2, 256
    s_cbranch_scc1 L_end
    s_getpc_b64 s[10:11]
L_pc:
    s_lshl_b32 s8, s2, 8
    v_lshrrev_b32 v70, 6, v0
    v_and_b32 v69, 3, v0
    v_lshl_or_b32 v69, v70, 2, v69
    s_and_b32 s8, s8, 0x7800
    v_lshl_or_b32 v69, v69, 7, s8
    v_min_u32 v69, L_end-L_pc, v69
    global_load_dword v72, v69, s[10:11]
    v_lshrrev_b32 v70, 6, v0
    v_and_b32 v50, 15, v0
    v_readfirstlane_b32 s3, v70
    v_bfe_u32 v51, v0, 4, 2
    v_and_b32 v52, 63, v0
    s_and_b32 s4, s2, 7
    s_lshl_b32 s4, s4, 7
    s_lshr_b32 s6, s2, 3
    s_lshl_b32 s6, s6, 2
    s_add_u32 s4, s4, s6
    s_add_u32 s4, s4, s3
    s_mul_i32 s6, s4, 104
    v_and_b32 v53, 0x38, v0
    v_add_u32 v53, s6, v53
    v_mul_u32_u24 v62, 12, v51
    v_min_u32 v62, 28, v62
    v_add_u32 v62, s6, v62
    s_mul_i32 s9, s3, 8448
    v_and_b32 v69, 2, v51
    v_add_u32 v69, v69, v51
    v_lshlrev_b32 v70, 4, v50
    v_lshl_add_u32 v56, v69, 10, v70
    s_bfe_u32 s8, s2, 0x30003
    s_mul_i32 s44, s8, 1056
    s_and_b32 s12, s8, 4
    s_add_u32 s12, s12, s8
    s_lshl_b32 s7, s3, 5
    s_add_u32 s12, s12, s7
    s_lshl_b32 s45, s12, 8
    s_add_u32 m0, s44, s9
    v_lshlrev_b32 v54, 2, v52
    s_mul_i32 s5, s3, 7616
    s_add_u32 s5, s5, 36352
    s_mov_b32 s42, 25600000
    s_mov_b32 s43, 0x00020000
    s_mov_b32 s54, 32768
    s_mov_b32 s55, 0x00020000
    s_mov_b32 s38, 2048
    s_mov_b32 s39, 0x00020000
    s_mov_b32 s35, 0xff800000
    v_xor_b32 v69, v50, v51
    v_lshlrev_b32 v57, 4, v69
    v_and_b32 v63, 0x70, v57
    s_movk_i32 s47, 128
    s_lshl_b32 s8, s4, 1
    v_mov_b32 v11, 0x7ffffff0
    v_writelane_b32 v11, s8, 0
    v_lshlrev_b32 v55, 4, v51
    v_lshrrev_b32 v60, 2, v50
    v_and_b32 v61, 3, v50
    s_movk_i32 s12, 1056
    v_and_b32 v69, 2, v60
    v_lshl_add_u32 v69, v69, 1, v61
    v_mad_u32_u24 v69, v69, s12, v55
    v_and_b32 v70, 1, v60
    v_lshl_add_u32 v70, v70, 8, s9
    v_add_u32 v58, v69, v70
    v_and_b32 v69, 1, v51
    v_lshl_add_u32 v69, v69, 2, v60
    v_and_b32 v70, 2, v51
    v_lshlrev_b32 v70, 8, v70
    s_waitcnt lgkmcnt(0)
    global_load_dwordx2 v[208:209], v53, s[16:17] nt
    s_mov_b32 s52, s24
    s_mov_b32 s53, s25
    global_load_dwordx3 v[212:214], v62, s[16:17] offset:64 nt
    global_load_dword v220, v54, s[28:29]
    global_load_dword v223, v54, s[26:27]
    global_load_dword v221, v54, s[30:31]
    buffer_load_dwordx4 v56, s[52:55], s45 offen lds
    s_xor_b32 s46, s44, 1056
    s_add_u32 m0, s46, s9
    s_xor_b32 s46, s45, 256
    v_lshl_add_u32 v70, v61, 3, v70
    v_mad_u32_u24 v59, v69, s12, v70
    v_lshlrev_b32 v67, 3, v52
    v_and_b32 v71, 1, v52
    v_lshlrev_b32 v69, 2, v71
    v_bfe_u32 v70, v52, 1, 2
    v_and_or_b32 v70, v52, 56, v70
    v_add_lshl_u32 v65, v69, v70, 2
    buffer_load_dwordx4 v56, s[52:55], s46 offen lds
    s_xor_b32 s46, s44, 2112
    s_add_u32 m0, s46, s9
    s_xor_b32 s46, s45, 512
    v_bfe_u32 v70, v52, 3, 1
    v_and_or_b32 v70, v52, 50, v70
    v_or_b32 v69, v69, v70
    v_and_b32 v70, 4, v52
    v_lshl_or_b32 v69, v70, 1, v69
    v_lshlrev_b32 v64, 2, v69
    v_and_b32 v69, 2, v50
    s_lshl_b32 s8, s3, 6
    buffer_load_dwordx4 v56, s[52:55], s46 offen lds
    s_xor_b32 s46, s44, 3168
    s_add_u32 m0, s46, s9
    s_xor_b32 s46, s45, 768
    v_lshl_add_u32 v70, v69, 3, s8
    v_lshl_add_u32 v70, v60, 2, v70
    v_lshl_add_u32 v66, v71, 1, v70
    v_lshlrev_b32 v70, 4, v71
    v_lshl_or_b32 v70, v51, 5, v70
    v_lshl_or_b32 v70, v69, 7, v70
    v_mov_b32 v12, 1024
    s_nop 0
    v_mov_b32_dpp v12, v70 quad_perm:[0,1,2,3] row_mask:0xf bank_mask:0x1
    buffer_load_dwordx4 v56, s[52:55], s46 offen lds
    s_xor_b32 s46, s44, 4224
    s_add_u32 m0, s46, s9
    s_xor_b32 s46, s45, 2048
    s_mov_b32 s13, 0xaaaa
    v_mov_b32 v1, 0x4444
    v_mad_u32_u24 v1, v71, s13, v1
    v_mov_b32_dpp v13, v12 row_ror:4 row_mask:0xf bank_mask:0xf
    v_mov_b32_dpp v14, v12 row_ror:8 row_mask:0xf bank_mask:0xf
    v_mov_b32_dpp v15, v12 row_ror:12 row_mask:0xf bank_mask:0xf
    v_mov_b64 v[232:233], 0
    v_mov_b64 v[234:235], 0
    buffer_load_dwordx4 v56, s[52:55], s46 offen lds
    s_xor_b32 s46, s44, 5280
    s_add_u32 m0, s46, s9
    s_xor_b32 s46, s45, 2304
    v_min_u32 v69, 1, v51
    v_lshlrev_b32 v69, 9, v69
    v_lshl_add_u32 v68, v52, 4, v69
    ds_write_b128 v68, v[232:235] offset:34048
    v_lshl_add_u32 v69, v50, 7, s5
    v_and_b32 v70, 8, v50
    v_lshl_add_u32 v69, v70, 3, v69
    v_lshlrev_b32 v70, 3, v50
    buffer_load_dwordx4 v56, s[52:55], s46 offen lds
    s_xor_b32 s46, s44, 6336
    s_add_u32 m0, s46, s9
    s_xor_b32 s46, s45, 2560
    v_xor_b32 v70, v70, v55
    v_and_or_b32 v216, v70, 48, v69
    v_lshlrev_b32 v71, 2, v50
    s_add_u32 s8, s5, 4352
    s_mov_b32 s12, 0x4a2b9198
    s_mov_b32 s13, 0x608ab956
    v_lshrrev_b64 v[48:49], v71, s[12:13]
    v_and_b32 v69, 15, v48
    buffer_load_dwordx4 v56, s[52:55], s46 offen lds
    s_xor_b32 s46, s44, 7392
    s_add_u32 m0, s46, s9
    s_xor_b32 s46, s45, 2816
    v_lshl_add_u32 v70, v69, 8, s8
    v_bfe_u32 v69, v48, 2, 2
    v_lshl_add_u32 v70, v69, 6, v70
    v_xor_b32 v69, v48, v51
    v_and_b32 v69, 3, v69
    v_lshl_add_u32 v2, v69, 4, v70
    s_mov_b32 s12, 0x6480559
    s_mov_b32 s13, 0x41ab2821
    buffer_load_dwordx4 v56, s[52:55], s46 offen lds
    s_mov_b32 s40, s18
    s_mov_b32 s41, s19
    v_lshrrev_b64 v[48:49], v71, s[12:13]
    v_and_b32 v69, 15, v48
    v_lshl_add_u32 v70, v69, 8, s8
    v_bfe_u32 v69, v48, 2, 2
    v_lshl_add_u32 v70, v69, 6, v70
    v_xor_b32 v69, v48, v51
    v_and_b32 v69, 3, v69
    v_lshl_add_u32 v6, v69, 4, v70
    v_mov_b64 v[236:237], 0
    v_mov_b64 v[238:239], 0
    v_mov_b64 v[240:241], 0
    v_mov_b64 v[242:243], 0
    v_mov_b64 v[244:245], 0
    v_mov_b64 v[246:247], 0
    v_mov_b64 v[248:249], 0
    v_mov_b64 v[250:251], 0
    v_writelane_b32 v248, s35, 29
    v_writelane_b32 v248, s35, 48
    v_writelane_b32 v248, s35, 58
    v_mov_b64 v[252:253], 0
    v_mov_b64 v[254:255], 0
    v_mov_b32 v10, 0x3f38aa3b
    s_mov_b32 m0, s5
    s_waitcnt vmcnt(12)
    v_lshl_add_u32 v208, v208, 8, v63
    buffer_load_dwordx4 v208, s[40:43], 0 offen nt lds
    s_add_u32 m0, s5, 1088
    v_lshl_add_u32 v209, v209, 8, v63
    buffer_load_dwordx4 v209, s[40:43], 0 offen nt lds
    s_cmp_eq_u32 s3, 0
    s_cbranch_scc1 L_stub0
    s_cmp_eq_u32 s3, 1
    s_cbranch_scc1 L_stub1
    s_cmp_eq_u32 s3, 2
    s_cbranch_scc1 L_stub2
    s_cmp_eq_u32 s3, 3
    s_cbranch_scc1 L_stub3
L_back:
    s_branch L_main2
.p2align 12
L_main:
    s_cbranch_scc1 L_back
L_main2:
    s_waitcnt vmcnt(10)
    ds_write_b32 v54, v220 offset:36096
    v_lshlrev_b32 v222, 16, v223
    v_and_b32 v223, 0xffff0000, v223
    ds_write_b64 v67, v[222:223] offset:35584
    ds_write_b32 v64, v220 offset:33792
    ds_write_b32 v65, v221 offset:34560
    ds_read_b128 v[144:147], v55 offset:36096
    ds_read_b128 v[148:151], v55 offset:36160
    ds_read_b128 v[152:155], v55 offset:36224
    ds_read_b128 v[156:159], v55 offset:36288
    ds_read_b128 v[112:115], v55 offset:35584
    ds_read_b128 v[116:119], v55 offset:35648
    ds_read_b128 v[120:123], v55 offset:35712
    ds_read_b128 v[124:127], v55 offset:35776
    ds_read_b128 v[128:131], v55 offset:35840
    ds_read_b128 v[132:135], v55 offset:35904
    ds_read_b128 v[136:139], v55 offset:35968
    ds_read_b128 v[140:143], v55 offset:36032
    ds_read_b128 a[128:131], v12 offset:33792
    ds_read_b128 a[132:135], v12 offset:33920
    s_add_u32 m0, s5, 2176
    s_nop 0
    buffer_load_dwordx4 v208, s[40:43], s47 offen nt lds
    s_add_u32 m0, s5, 3264
    s_nop 0
    buffer_load_dwordx4 v209, s[40:43], s47 offen nt lds
    s_waitcnt vmcnt(4)
    ds_read_b128 v[80:83], v58 offset:0
    ds_read_b128 v[84:87], v58 offset:64
    ds_read_b128 v[88:91], v58 offset:128
    ds_read_b128 v[92:95], v58 offset:192
    ds_read_b128 v[96:99], v58 offset:512
    ds_read_b128 v[100:103], v58 offset:576
    ds_read_b128 v[104:107], v58 offset:640
    ds_read_b128 v[108:111], v58 offset:704
    s_barrier
    ds_read_b64_tr_b16 a[0:1], v59 offset:0
    ds_read_b64_tr_b16 a[2:3], v59 offset:256
    ds_read_b64_tr_b16 a[16:17], v59 offset:32
    ds_read_b64_tr_b16 a[18:19], v59 offset:288
    ds_read_b64_tr_b16 a[32:33], v59 offset:64
    ds_read_b64_tr_b16 a[34:35], v59 offset:320
    ds_read_b64_tr_b16 a[48:49], v59 offset:96
    ds_read_b64_tr_b16 a[50:51], v59 offset:352
    s_waitcnt lgkmcnt(8)
    v_mfma_f32_16x16x32_bf16 v[176:179], v[144:147], v[80:83], 0
    ds_read_b64_tr_b16 a[64:65], v59 offset:128
    ds_read_b64_tr_b16 a[66:67], v59 offset:384
    v_mfma_f32_16x16x32_bf16 v[176:179], v[148:151], v[84:87], v[176:179]
    ds_read_b64_tr_b16 a[80:81], v59 offset:160
    ds_read_b64_tr_b16 a[82:83], v59 offset:416
    v_mfma_f32_16x16x32_bf16 v[176:179], v[152:155], v[88:91], v[176:179]
    ds_read_b64_tr_b16 a[96:97], v59 offset:192
    ds_read_b64_tr_b16 a[98:99], v59 offset:448
    v_mfma_f32_16x16x32_bf16 v[176:179], v[156:159], v[92:95], v[176:179]
    ds_read_b64_tr_b16 a[112:113], v59 offset:224
    ds_read_b64_tr_b16 a[114:115], v59 offset:480
    v_mfma_f32_16x16x32_bf16 v[180:183], v[144:147], v[96:99], 0
    ds_read_b64_tr_b16 a[4:5], v59 offset:8448
    ds_read_b64_tr_b16 a[6:7], v59 offset:8704
    v_mfma_f32_16x16x32_bf16 v[180:183], v[148:151], v[100:103], v[180:183]
    ds_read_b64_tr_b16 a[20:21], v59 offset:8480
    ds_read_b64_tr_b16 a[22:23], v59 offset:8736
    v_mfma_f32_16x16x32_bf16 v[180:183], v[152:155], v[104:107], v[180:183]
    ds_read_b64_tr_b16 a[36:37], v59 offset:8512
    ds_read_b64_tr_b16 a[38:39], v59 offset:8768
    v_mfma_f32_16x16x32_bf16 v[180:183], v[156:159], v[108:111], v[180:183]
    ds_read_b64_tr_b16 a[52:53], v59 offset:8544
    ds_read_b64_tr_b16 a[54:55], v59 offset:8800
    ds_read_b64_tr_b16 a[68:69], v59 offset:8576
    ds_read_b64_tr_b16 a[70:71], v59 offset:8832
    ds_read_b64_tr_b16 a[84:85], v59 offset:8608
    ds_read_b64_tr_b16 a[86:87], v59 offset:8864
    ds_read_b64_tr_b16 a[100:101], v59 offset:8640
    ds_read_b64_tr_b16 a[102:103], v59 offset:8896
    ds_read_b64_tr_b16 a[116:117], v59 offset:8672
    v_cvt_pk_bf16_f32 v71, v176, v180
    ds_write_b16 v66, v71 offset:34304
    ds_write_b16_d16_hi v66, v71 offset:34336
    ds_read_b64_tr_b16 a[118:119], v59 offset:8928
    ds_read_b64_tr_b16 a[8:9], v59 offset:16896
    ds_read_b64_tr_b16 a[10:11], v59 offset:17152
    ds_read_b64_tr_b16 a[24:25], v59 offset:16928
    ds_read_b64_tr_b16 a[26:27], v59 offset:17184
    ds_read_b64_tr_b16 a[40:41], v59 offset:16960
    ds_read_b64_tr_b16 a[42:43], v59 offset:17216
    ds_read_b64_tr_b16 a[56:57], v59 offset:16992
    ds_read_b64_tr_b16 a[58:59], v59 offset:17248
    ds_read_b64_tr_b16 a[72:73], v59 offset:17024
    ds_read_b64_tr_b16 a[74:75], v59 offset:17280
    ds_read_b64_tr_b16 a[88:89], v59 offset:17056
    ds_read_b64_tr_b16 a[90:91], v59 offset:17312
    ds_read_b64_tr_b16 a[104:105], v59 offset:17088
    ds_read_b64_tr_b16 a[106:107], v59 offset:17344
    ds_read_b64_tr_b16 a[120:121], v59 offset:17120
    ds_read_b64_tr_b16 a[122:123], v59 offset:17376
    s_waitcnt lgkmcnt(15)
    s_barrier
    ds_read_b128 a[136:139], v12 offset:34304
    ds_read_b128 a[140:143], v12 offset:34432
    ds_read_b64_tr_b16 a[12:13], v59 offset:25344
    ds_read_b64_tr_b16 a[14:15], v59 offset:25600
    ds_read_b64_tr_b16 a[28:29], v59 offset:25376
    ds_read_b64_tr_b16 a[30:31], v59 offset:25632
    ds_read_b64_tr_b16 a[44:45], v59 offset:25408
    ds_read_b64_tr_b16 a[46:47], v59 offset:25664
    ds_read_b64_tr_b16 a[60:61], v59 offset:25440
    ds_read_b64_tr_b16 a[62:63], v59 offset:25696
    ds_read_b64_tr_b16 a[76:77], v59 offset:25472
    ds_read_b64_tr_b16 a[78:79], v59 offset:25728
    ds_read_b64_tr_b16 a[92:93], v59 offset:25504
    ds_read_b64_tr_b16 a[94:95], v59 offset:25760
    ds_read_b64_tr_b16 a[108:109], v59 offset:25536
    ds_read_b64_tr_b16 a[110:111], v59 offset:25792
    ds_read_b64_tr_b16 a[124:125], v59 offset:25568
    ds_read_b64_tr_b16 a[126:127], v59 offset:25824
    s_waitcnt vmcnt(2)
    ds_read_b128 v[32:35], v216 offset:0
    ds_read_b128 v[36:39], v216 offset:64
    s_mov_b32 exec_hi, 0x0000ffff
    s_add_u32 m0, s5, 4352
    v_lshl_add_u32 v212, v212, 8, v57
    buffer_load_dwordx4 v212, s[40:43], 0 offen nt lds
    s_add_u32 m0, s5, 5440
    v_lshl_add_u32 v213, v213, 8, v57
    buffer_load_dwordx4 v213, s[40:43], 0 offen nt lds
    s_mov_b32 exec_hi, -1
    s_add_u32 m0, s5, 6528
    v_lshl_add_u32 v214, v214, 8, v57
    buffer_load_dwordx4 v214, s[40:43], 0 offen nt lds
    s_cmp_eq_u32 s3, 4
    s_waitcnt lgkmcnt(1)
    v_lshlrev_b32 v16, 16, v32
    v_and_b32 v17, 0xffff0000, v32
    v_lshlrev_b32 v18, 16, v33
    v_and_b32 v19, 0xffff0000, v33
    v_lshlrev_b32 v20, 16, v34
    v_and_b32 v21, 0xffff0000, v34
    v_lshlrev_b32 v22, 16, v35
    v_and_b32 v23, 0xffff0000, v35
    v_mul_f32_dpp v224, v16, v16 row_ror:1 row_mask:0xf bank_mask:0xf
    v_mul_f32_dpp v225, v17, v17 row_ror:1 row_mask:0xf bank_mask:0xf
    v_mul_f32_dpp v226, v18, v18 row_ror:1 row_mask:0xf bank_mask:0xf
    v_mul_f32_dpp v227, v19, v19 row_ror:1 row_mask:0xf bank_mask:0xf
    v_mul_f32_dpp v228, v20, v20 row_ror:1 row_mask:0xf bank_mask:0xf
    v_mul_f32_dpp v229, v21, v21 row_ror:1 row_mask:0xf bank_mask:0xf
    v_mul_f32_dpp v230, v22, v22 row_ror:1 row_mask:0xf bank_mask:0xf
    v_mul_f32_dpp v231, v23, v23 row_ror:1 row_mask:0xf bank_mask:0xf
    v_cvt_pk_bf16_f32 v144, v224, v225
    v_cvt_pk_bf16_f32 v145, v226, v227
    v_cvt_pk_bf16_f32 v146, v228, v229
    v_cvt_pk_bf16_f32 v147, v230, v231
    s_waitcnt lgkmcnt(0)
    v_lshlrev_b32 v24, 16, v36
    v_mfma_f32_16x16x32_bf16 v[176:179], a[0:3], v[144:147], v[112:115]
    v_and_b32 v25, 0xffff0000, v36
    v_lshlrev_b32 v26, 16, v37
    v_mfma_f32_16x16x32_bf16 v[180:183], a[16:19], v[144:147], v[116:119]
    v_and_b32 v27, 0xffff0000, v37
    v_lshlrev_b32 v28, 16, v38
    v_mfma_f32_16x16x32_bf16 v[184:187], a[32:35], v[144:147], v[120:123]
    v_and_b32 v29, 0xffff0000, v38
    v_lshlrev_b32 v30, 16, v39
    v_mfma_f32_16x16x32_bf16 v[188:191], a[48:51], v[144:147], v[124:127]
    v_and_b32 v31, 0xffff0000, v39
    v_mul_f32_dpp v224, v24, v24 row_ror:1 row_mask:0xf bank_mask:0xf
    v_mfma_f32_16x16x32_bf16 v[192:195], a[64:67], v[144:147], v[128:131]
    v_mul_f32_dpp v225, v25, v25 row_ror:1 row_mask:0xf bank_mask:0xf
    v_mul_f32_dpp v226, v26, v26 row_ror:1 row_mask:0xf bank_mask:0xf
    v_mfma_f32_16x16x32_bf16 v[196:199], a[80:83], v[144:147], v[132:135]
    v_mul_f32_dpp v227, v27, v27 row_ror:1 row_mask:0xf bank_mask:0xf
    v_mul_f32_dpp v228, v28, v28 row_ror:1 row_mask:0xf bank_mask:0xf
    v_mfma_f32_16x16x32_bf16 v[200:203], a[96:99], v[144:147], v[136:139]
    v_mul_f32_dpp v229, v29, v29 row_ror:1 row_mask:0xf bank_mask:0xf
    v_mul_f32_dpp v230, v30, v30 row_ror:1 row_mask:0xf bank_mask:0xf
    v_mfma_f32_16x16x32_bf16 v[204:207], a[112:115], v[144:147], v[140:143]
    v_mul_f32_dpp v231, v31, v31 row_ror:1 row_mask:0xf bank_mask:0xf
    v_cvt_pk_bf16_f32 v148, v224, v225
    v_cvt_pk_bf16_f32 v149, v226, v227
    v_cvt_pk_bf16_f32 v150, v228, v229
    v_cvt_pk_bf16_f32 v151, v230, v231
    v_mul_f32_dpp v224, v16, v16 row_ror:2 row_mask:0xf bank_mask:0xf
    v_mul_f32_dpp v225, v17, v17 row_ror:2 row_mask:0xf bank_mask:0xf
    v_mfma_f32_16x16x32_bf16 v[204:207], a[116:119], v[148:151], v[204:207]
    v_mul_f32_dpp v226, v18, v18 row_ror:2 row_mask:0xf bank_mask:0xf
    v_mul_f32_dpp v227, v19, v19 row_ror:2 row_mask:0xf bank_mask:0xf
    v_smfmac_f32_16x16x64_bf16 v[232:235], a[136:139], v[144:151], v1
    v_mul_f32_dpp v228, v20, v20 row_ror:2 row_mask:0xf bank_mask:0xf
    v_mfma_f32_16x16x32_bf16 v[176:179], a[4:7], v[148:151], v[176:179]
    v_mul_f32_dpp v229, v21, v21 row_ror:2 row_mask:0xf bank_mask:0xf
    v_mul_f32_dpp v230, v22, v22 row_ror:2 row_mask:0xf bank_mask:0xf
    v_mfma_f32_16x16x32_bf16 v[180:183], a[20:23], v[148:151], v[180:183]
    s_waitcnt vmcnt(3)
    ds_read_b128 v[40:43], v216 offset:2176
    ds_read_b128 v[44:47], v216 offset:2240
    v_mfma_f32_16x16x32_bf16 v[184:187], a[36:39], v[148:151], v[184:187]
    v_mul_f32_dpp v231, v23, v23 row_ror:2 row_mask:0xf bank_mask:0xf
    v_cvt_pk_bf16_f32 v160, v224, v225
    v_mfma_f32_16x16x32_bf16 v[188:191], a[52:55], v[148:151], v[188:191]
    v_cvt_pk_bf16_f32 v161, v226, v227
    v_cvt_pk_bf16_f32 v162, v228, v229
    v_mfma_f32_16x16x32_bf16 v[192:195], a[68:71], v[148:151], v[192:195]
    v_cvt_pk_bf16_f32 v163, v230, v231
    v_mul_f32_dpp v224, v24, v24 row_ror:2 row_mask:0xf bank_mask:0xf
    v_mfma_f32_16x16x32_bf16 v[196:199], a[84:87], v[148:151], v[196:199]
    v_mul_f32_dpp v225, v25, v25 row_ror:2 row_mask:0xf bank_mask:0xf
    v_mul_f32_dpp v226, v26, v26 row_ror:2 row_mask:0xf bank_mask:0xf
    v_mfma_f32_16x16x32_bf16 v[200:203], a[100:103], v[148:151], v[200:203]
    v_mul_f32_dpp v227, v27, v27 row_ror:2 row_mask:0xf bank_mask:0xf
    v_mul_f32_dpp v228, v28, v28 row_ror:2 row_mask:0xf bank_mask:0xf
    v_mul_f32_dpp v229, v29, v29 row_ror:2 row_mask:0xf bank_mask:0xf
    v_mul_f32_dpp v230, v30, v30 row_ror:2 row_mask:0xf bank_mask:0xf
    v_mul_f32_dpp v231, v31, v31 row_ror:2 row_mask:0xf bank_mask:0xf
    v_cvt_pk_bf16_f32 v164, v224, v225
    v_cvt_pk_bf16_f32 v165, v226, v227
    s_waitcnt lgkmcnt(0)
    v_lshlrev_b32 v32, 16, v40
    v_and_b32 v33, 0xffff0000, v40
    v_lshlrev_b32 v34, 16, v41
    v_and_b32 v35, 0xffff0000, v41
    v_lshlrev_b32 v36, 16, v42
    v_and_b32 v37, 0xffff0000, v42
    v_lshlrev_b32 v38, 16, v43
    v_and_b32 v39, 0xffff0000, v43
    v_cvt_pk_bf16_f32 v166, v228, v229
    v_cvt_pk_bf16_f32 v167, v230, v231
    v_mul_f32_dpp v224, v32, v32 row_ror:1 row_mask:0xf bank_mask:0xf
    v_mul_f32_dpp v225, v33, v33 row_ror:1 row_mask:0xf bank_mask:0xf
    v_mul_f32_dpp v226, v34, v34 row_ror:1 row_mask:0xf bank_mask:0xf
    v_mul_f32_dpp v227, v35, v35 row_ror:1 row_mask:0xf bank_mask:0xf
    v_mul_f32_dpp v228, v36, v36 row_ror:1 row_mask:0xf bank_mask:0xf
    v_mul_f32_dpp v229, v37, v37 row_ror:1 row_mask:0xf bank_mask:0xf
    v_mul_f32_dpp v230, v38, v38 row_ror:1 row_mask:0xf bank_mask:0xf
    v_mul_f32_dpp v231, v39, v39 row_ror:1 row_mask:0xf bank_mask:0xf
    v_cvt_pk_bf16_f32 v152, v224, v225
    v_cvt_pk_bf16_f32 v153, v226, v227
    v_cvt_pk_bf16_f32 v154, v228, v229
    v_cvt_pk_bf16_f32 v155, v230, v231
    v_lshlrev_b32 v40, 16, v44
    v_and_b32 v41, 0xffff0000, v44
    v_mfma_f32_16x16x32_bf16 v[200:203], a[104:107], v[152:155], v[200:203]
    v_lshlrev_b32 v42, 16, v45
    v_and_b32 v43, 0xffff0000, v45
    v_mfma_f32_16x16x32_bf16 v[176:179], a[8:11], v[152:155], v[176:179]
    v_lshlrev_b32 v44, 16, v46
    v_and_b32 v45, 0xffff0000, v46
    v_mfma_f32_16x16x32_bf16 v[180:183], a[24:27], v[152:155], v[180:183]
    v_lshlrev_b32 v46, 16, v47
    v_and_b32 v47, 0xffff0000, v47
    v_mfma_f32_16x16x32_bf16 v[184:187], a[40:43], v[152:155], v[184:187]
    v_mul_f32_dpp v224, v40, v40 row_ror:1 row_mask:0xf bank_mask:0xf
    v_mul_f32_dpp v225, v41, v41 row_ror:1 row_mask:0xf bank_mask:0xf
    v_mfma_f32_16x16x32_bf16 v[188:191], a[56:59], v[152:155], v[188:191]
    ds_read_b128 a[152:155], v13 offset:34304
    v_mul_f32_dpp v226, v42, v42 row_ror:1 row_mask:0xf bank_mask:0xf
    v_mul_f32_dpp v227, v43, v43 row_ror:1 row_mask:0xf bank_mask:0xf
    v_mfma_f32_16x16x32_bf16 v[192:195], a[72:75], v[152:155], v[192:195]
    v_mul_f32_dpp v228, v44, v44 row_ror:1 row_mask:0xf bank_mask:0xf
    v_mul_f32_dpp v229, v45, v45 row_ror:1 row_mask:0xf bank_mask:0xf
    v_mfma_f32_16x16x32_bf16 v[196:199], a[88:91], v[152:155], v[196:199]
    v_mul_f32_dpp v230, v46, v46 row_ror:1 row_mask:0xf bank_mask:0xf
    v_mul_f32_dpp v231, v47, v47 row_ror:1 row_mask:0xf bank_mask:0xf
    v_mfma_f32_16x16x32_bf16 v[204:207], a[120:123], v[152:155], v[204:207]
    v_cvt_pk_bf16_f32 v156, v224, v225
    v_cvt_pk_bf16_f32 v157, v226, v227
    v_cvt_pk_bf16_f32 v158, v228, v229
    v_cvt_pk_bf16_f32 v159, v230, v231
    v_mul_f32_dpp v224, v32, v32 row_ror:2 row_mask:0xf bank_mask:0xf
    v_mul_f32_dpp v225, v33, v33 row_ror:2 row_mask:0xf bank_mask:0xf
    v_mfma_f32_16x16x32_bf16 v[204:207], a[124:127], v[156:159], v[204:207]
    v_mul_f32_dpp v226, v34, v34 row_ror:2 row_mask:0xf bank_mask:0xf
    v_mul_f32_dpp v227, v35, v35 row_ror:2 row_mask:0xf bank_mask:0xf
    v_smfmac_f32_16x16x64_bf16 v[232:235], a[140:143], v[152:159], v1
    v_mul_f32_dpp v228, v36, v36 row_ror:2 row_mask:0xf bank_mask:0xf
    v_mfma_f32_16x16x32_bf16 v[176:179], a[12:15], v[156:159], v[176:179]
    ds_read_b128 a[156:159], v13 offset:34432
    v_mul_f32_dpp v229, v37, v37 row_ror:2 row_mask:0xf bank_mask:0xf
    v_mul_f32_dpp v230, v38, v38 row_ror:2 row_mask:0xf bank_mask:0xf
    v_mfma_f32_16x16x32_bf16 v[180:183], a[28:31], v[156:159], v[180:183]
    v_mul_f32_dpp v231, v39, v39 row_ror:2 row_mask:0xf bank_mask:0xf
    v_cvt_pk_bf16_f32 v168, v224, v225
    v_mfma_f32_16x16x32_bf16 v[184:187], a[44:47], v[156:159], v[184:187]
    v_cvt_pk_bf16_f32 v169, v226, v227
    v_cvt_pk_bf16_f32 v208, |v176|, |v177|
    v_mfma_f32_16x16x32_bf16 v[188:191], a[60:63], v[156:159], v[188:191]
    v_cvt_pk_bf16_f32 v209, |v178|, |v179|
    v_cvt_pk_bf16_f32 v170, v228, v229
    v_mfma_f32_16x16x32_bf16 v[192:195], a[76:79], v[156:159], v[192:195]
    s_waitcnt lgkmcnt(0)
    v_cvt_pk_bf16_f32 v171, v230, v231
    v_mul_f32_dpp v224, v40, v40 row_ror:2 row_mask:0xf bank_mask:0xf
    v_mfma_f32_16x16x32_bf16 v[196:199], a[92:95], v[156:159], v[196:199]
    ds_read_b128 a[144:147], v13 offset:33792
    v_mul_f32_dpp v225, v41, v41 row_ror:2 row_mask:0xf bank_mask:0xf
    v_mul_f32_dpp v226, v42, v42 row_ror:2 row_mask:0xf bank_mask:0xf
    v_mfma_f32_16x16x32_bf16 v[200:203], a[108:111], v[156:159], v[200:203]
    v_mul_f32_dpp v227, v43, v43 row_ror:2 row_mask:0xf bank_mask:0xf
    v_mul_f32_dpp v228, v44, v44 row_ror:2 row_mask:0xf bank_mask:0xf
    v_mfma_f32_16x16x32_bf16 v[176:179], a[0:3], v[160:163], v[112:115]
    v_mul_f32_dpp v229, v45, v45 row_ror:2 row_mask:0xf bank_mask:0xf
    v_mul_f32_dpp v230, v46, v46 row_ror:2 row_mask:0xf bank_mask:0xf
    v_mfma_f32_16x16x32_bf16 v[176:179], a[4:7], v[164:167], v[176:179]
    v_mul_f32_dpp v231, v47, v47 row_ror:2 row_mask:0xf bank_mask:0xf
    v_cvt_pk_bf16_f32 v172, v224, v225
    v_mfma_f32_16x16x32_bf16 v[176:179], a[8:11], v[168:171], v[176:179]
    ds_read_b128 a[148:151], v13 offset:33920
    v_cvt_pk_bf16_f32 v173, v226, v227
    v_cvt_pk_bf16_f32 v174, v228, v229
    v_cvt_pk_bf16_f32 v175, v230, v231
    v_cvt_pk_bf16_f32 v210, |v180|, |v181|
    v_cvt_pk_bf16_f32 v211, |v182|, |v183|
    v_mfma_f32_16x16x32_bf16 v[176:179], a[12:15], v[172:175], v[176:179]
    v_cvt_pk_bf16_f32 v212, |v184|, |v185|
    v_cvt_pk_bf16_f32 v213, |v186|, |v187|
    v_mfma_f32_16x16x32_bf16 v[180:183], a[28:31], v[172:175], v[116:119]
    v_cvt_pk_bf16_f32 v214, |v188|, |v189|
    v_cvt_pk_bf16_f32 v215, |v190|, |v191|
    v_mfma_f32_16x16x32_bf16 v[180:183], a[24:27], v[168:171], v[180:183]
    s_waitcnt lgkmcnt(0)
    v_cvt_pk_bf16_f32 v216, |v192|, |v193|
    v_cvt_pk_bf16_f32 v217, |v194|, |v195|
    v_mfma_f32_16x16x32_bf16 v[180:183], a[20:23], v[164:167], v[180:183]
    v_cvt_pk_bf16_f32 v218, |v196|, |v197|
    v_cvt_pk_bf16_f32 v219, |v198|, |v199|
    v_mfma_f32_16x16x32_bf16 v[180:183], a[16:19], v[160:163], v[180:183]
    ds_read_b128 a[168:171], v14 offset:34304
    v_cvt_pk_bf16_f32 v220, |v200|, |v201|
    v_cvt_pk_bf16_f32 v221, |v202|, |v203|
    v_smfmac_f32_16x16x64_bf16 v[232:235], a[128:131], v[208:215], v1
    v_cvt_pk_bf16_f32 v222, |v204|, |v205|
    v_mfma_f32_16x16x32_bf16 v[184:187], a[32:35], v[160:163], v[120:123]
    v_cvt_pk_bf16_f32 v223, |v206|, |v207|
    v_mul_f32_dpp v224, v16, v16 row_ror:3 row_mask:0xf bank_mask:0xf
    v_mfma_f32_16x16x32_bf16 v[184:187], a[36:39], v[164:167], v[184:187]
    v_mul_f32_dpp v225, v17, v17 row_ror:3 row_mask:0xf bank_mask:0xf
    v_mul_f32_dpp v226, v18, v18 row_ror:3 row_mask:0xf bank_mask:0xf
    v_mfma_f32_16x16x32_bf16 v[184:187], a[40:43], v[168:171], v[184:187]
    v_mul_f32_dpp v227, v19, v19 row_ror:3 row_mask:0xf bank_mask:0xf
    v_mul_f32_dpp v228, v20, v20 row_ror:3 row_mask:0xf bank_mask:0xf
    v_mfma_f32_16x16x32_bf16 v[184:187], a[44:47], v[172:175], v[184:187]
    ds_read_b128 a[172:175], v14 offset:34432
    v_mul_f32_dpp v229, v21, v21 row_ror:3 row_mask:0xf bank_mask:0xf
    v_mul_f32_dpp v230, v22, v22 row_ror:3 row_mask:0xf bank_mask:0xf
    v_smfmac_f32_16x16x64_bf16 v[232:235], a[132:135], v[216:223], v1
    v_mul_f32_dpp v231, v23, v23 row_ror:3 row_mask:0xf bank_mask:0xf
    v_mfma_f32_16x16x32_bf16 v[188:191], a[60:63], v[172:175], v[124:127]
    v_cvt_pk_bf16_f32 v144, v224, v225
    v_cvt_pk_bf16_f32 v145, v226, v227
    v_mfma_f32_16x16x32_bf16 v[188:191], a[56:59], v[168:171], v[188:191]
    v_cvt_pk_bf16_f32 v146, v228, v229
    v_cvt_pk_bf16_f32 v147, v230, v231
    v_mfma_f32_16x16x32_bf16 v[188:191], a[52:55], v[164:167], v[188:191]
    s_waitcnt lgkmcnt(0)
    v_mul_f32_dpp v224, v24, v24 row_ror:3 row_mask:0xf bank_mask:0xf
    v_mul_f32_dpp v225, v25, v25 row_ror:3 row_mask:0xf bank_mask:0xf
    v_mfma_f32_16x16x32_bf16 v[188:191], a[48:51], v[160:163], v[188:191]
    ds_read_b128 a[160:163], v14 offset:33792
    v_mul_f32_dpp v226, v26, v26 row_ror:3 row_mask:0xf bank_mask:0xf
    v_mul_f32_dpp v227, v27, v27 row_ror:3 row_mask:0xf bank_mask:0xf
    v_smfmac_f32_16x16x64_bf16 v[232:235], a[152:155], v[160:167], v1
    v_mul_f32_dpp v228, v28, v28 row_ror:3 row_mask:0xf bank_mask:0xf
    v_mfma_f32_16x16x32_bf16 v[192:195], a[64:67], v[160:163], v[128:131]
    v_mul_f32_dpp v229, v29, v29 row_ror:3 row_mask:0xf bank_mask:0xf
    v_mul_f32_dpp v230, v30, v30 row_ror:3 row_mask:0xf bank_mask:0xf
    v_mfma_f32_16x16x32_bf16 v[192:195], a[68:71], v[164:167], v[192:195]
    v_mul_f32_dpp v231, v31, v31 row_ror:3 row_mask:0xf bank_mask:0xf
    v_cvt_pk_bf16_f32 v208, |v176|, |v177|
    v_mfma_f32_16x16x32_bf16 v[192:195], a[72:75], v[168:171], v[192:195]
    v_cvt_pk_bf16_f32 v209, |v178|, |v179|
    v_cvt_pk_bf16_f32 v148, v224, v225
    v_mfma_f32_16x16x32_bf16 v[192:195], a[76:79], v[172:175], v[192:195]
    ds_read_b128 a[164:167], v14 offset:33920
    v_cvt_pk_bf16_f32 v149, v226, v227
    v_cvt_pk_bf16_f32 v150, v228, v229
    v_smfmac_f32_16x16x64_bf16 v[232:235], a[156:159], v[168:175], v1
    v_cvt_pk_bf16_f32 v151, v230, v231
    v_mfma_f32_16x16x32_bf16 v[196:199], a[92:95], v[172:175], v[132:135]
    v_mul_f32_dpp v224, v32, v32 row_ror:3 row_mask:0xf bank_mask:0xf
    v_mul_f32_dpp v225, v33, v33 row_ror:3 row_mask:0xf bank_mask:0xf
    v_mfma_f32_16x16x32_bf16 v[196:199], a[88:91], v[168:171], v[196:199]
    v_mul_f32_dpp v226, v34, v34 row_ror:3 row_mask:0xf bank_mask:0xf
    v_mul_f32_dpp v227, v35, v35 row_ror:3 row_mask:0xf bank_mask:0xf
    v_mfma_f32_16x16x32_bf16 v[196:199], a[84:87], v[164:167], v[196:199]
    s_waitcnt lgkmcnt(0)
    v_mul_f32_dpp v228, v36, v36 row_ror:3 row_mask:0xf bank_mask:0xf
    v_mul_f32_dpp v229, v37, v37 row_ror:3 row_mask:0xf bank_mask:0xf
    v_mfma_f32_16x16x32_bf16 v[196:199], a[80:83], v[160:163], v[196:199]
    ds_read_b128 a[184:187], v15 offset:34304
    v_mul_f32_dpp v230, v38, v38 row_ror:3 row_mask:0xf bank_mask:0xf
    v_mul_f32_dpp v231, v39, v39 row_ror:3 row_mask:0xf bank_mask:0xf
    v_mfma_f32_16x16x32_bf16 v[200:203], a[96:99], v[160:163], v[136:139]
    v_cvt_pk_bf16_f32 v152, v224, v225
    v_cvt_pk_bf16_f32 v153, v226, v227
    v_mfma_f32_16x16x32_bf16 v[200:203], a[100:103], v[164:167], v[200:203]
    v_cvt_pk_bf16_f32 v154, v228, v229
    v_cvt_pk_bf16_f32 v155, v230, v231
    v_mfma_f32_16x16x32_bf16 v[200:203], a[104:107], v[168:171], v[200:203]
    v_mul_f32_dpp v224, v40, v40 row_ror:3 row_mask:0xf bank_mask:0xf
    v_mul_f32_dpp v225, v41, v41 row_ror:3 row_mask:0xf bank_mask:0xf
    v_mfma_f32_16x16x32_bf16 v[200:203], a[108:111], v[172:175], v[200:203]
    v_mul_f32_dpp v226, v42, v42 row_ror:3 row_mask:0xf bank_mask:0xf
    v_mul_f32_dpp v227, v43, v43 row_ror:3 row_mask:0xf bank_mask:0xf
    v_mfma_f32_16x16x32_bf16 v[204:207], a[124:127], v[172:175], v[140:143]
    ds_read_b128 a[188:191], v15 offset:34432
    v_mul_f32_dpp v228, v44, v44 row_ror:3 row_mask:0xf bank_mask:0xf
    v_mul_f32_dpp v229, v45, v45 row_ror:3 row_mask:0xf bank_mask:0xf
    v_mfma_f32_16x16x32_bf16 v[204:207], a[120:123], v[168:171], v[204:207]
    v_mul_f32_dpp v230, v46, v46 row_ror:3 row_mask:0xf bank_mask:0xf
    v_mul_f32_dpp v231, v47, v47 row_ror:3 row_mask:0xf bank_mask:0xf
    v_mfma_f32_16x16x32_bf16 v[204:207], a[116:119], v[164:167], v[204:207]
    v_cvt_pk_bf16_f32 v156, v224, v225
    v_cvt_pk_bf16_f32 v157, v226, v227
    v_mfma_f32_16x16x32_bf16 v[204:207], a[112:115], v[160:163], v[204:207]
    v_cvt_pk_bf16_f32 v158, v228, v229
    v_cvt_pk_bf16_f32 v159, v230, v231
    v_mfma_f32_16x16x32_bf16 v[176:179], a[0:3], v[144:147], v[112:115]
    s_waitcnt lgkmcnt(0)
    v_cvt_pk_bf16_f32 v210, |v180|, |v181|
    v_cvt_pk_bf16_f32 v211, |v182|, |v183|
    v_mfma_f32_16x16x32_bf16 v[176:179], a[4:7], v[148:151], v[176:179]
    ds_read_b128 a[176:179], v15 offset:33792
    v_cvt_pk_bf16_f32 v212, |v184|, |v185|
    v_cvt_pk_bf16_f32 v213, |v186|, |v187|
    v_mfma_f32_16x16x32_bf16 v[176:179], a[8:11], v[152:155], v[176:179]
    v_cvt_pk_bf16_f32 v214, |v188|, |v189|
    v_cvt_pk_bf16_f32 v215, |v190|, |v191|
    v_mfma_f32_16x16x32_bf16 v[176:179], a[12:15], v[156:159], v[176:179]
    v_cvt_pk_bf16_f32 v216, |v192|, |v193|
    v_cvt_pk_bf16_f32 v217, |v194|, |v195|
    v_smfmac_f32_16x16x64_bf16 v[232:235], a[144:147], v[208:215], v1
    v_cvt_pk_bf16_f32 v218, |v196|, |v197|
    v_mfma_f32_16x16x32_bf16 v[180:183], a[28:31], v[156:159], v[116:119]
    v_cvt_pk_bf16_f32 v219, |v198|, |v199|
    v_cvt_pk_bf16_f32 v220, |v200|, |v201|
    v_mfma_f32_16x16x32_bf16 v[180:183], a[24:27], v[152:155], v[180:183]
    ds_read_b128 a[180:183], v15 offset:33920
    v_cvt_pk_bf16_f32 v221, |v202|, |v203|
    v_cvt_pk_bf16_f32 v222, |v204|, |v205|
    v_mfma_f32_16x16x32_bf16 v[180:183], a[20:23], v[148:151], v[180:183]
    v_cvt_pk_bf16_f32 v223, |v206|, |v207|
    v_mul_f32_dpp v224, v16, v16 row_ror:4 row_mask:0xf bank_mask:0xf
    v_mfma_f32_16x16x32_bf16 v[180:183], a[16:19], v[144:147], v[180:183]
    v_mul_f32_dpp v225, v17, v17 row_ror:4 row_mask:0xf bank_mask:0xf
    v_mul_f32_dpp v226, v18, v18 row_ror:4 row_mask:0xf bank_mask:0xf
    v_smfmac_f32_16x16x64_bf16 v[232:235], a[148:151], v[216:223], v1
    v_mul_f32_dpp v227, v19, v19 row_ror:4 row_mask:0xf bank_mask:0xf
    v_mfma_f32_16x16x32_bf16 v[184:187], a[32:35], v[144:147], v[120:123]
    s_waitcnt lgkmcnt(0)
    v_mul_f32_dpp v228, v20, v20 row_ror:4 row_mask:0xf bank_mask:0xf
    v_mul_f32_dpp v229, v21, v21 row_ror:4 row_mask:0xf bank_mask:0xf
    v_mfma_f32_16x16x32_bf16 v[184:187], a[36:39], v[148:151], v[184:187]
    v_mul_f32_dpp v230, v22, v22 row_ror:4 row_mask:0xf bank_mask:0xf
    v_mul_f32_dpp v231, v23, v23 row_ror:4 row_mask:0xf bank_mask:0xf
    v_mfma_f32_16x16x32_bf16 v[184:187], a[40:43], v[152:155], v[184:187]
    v_cvt_pk_bf16_f32 v160, v224, v225
    v_cvt_pk_bf16_f32 v161, v226, v227
    v_mfma_f32_16x16x32_bf16 v[184:187], a[44:47], v[156:159], v[184:187]
    v_cvt_pk_bf16_f32 v162, v228, v229
    v_cvt_pk_bf16_f32 v163, v230, v231
    v_smfmac_f32_16x16x64_bf16 v[232:235], a[168:171], v[144:151], v1
    v_mul_f32_dpp v224, v24, v24 row_ror:4 row_mask:0xf bank_mask:0xf
    v_mfma_f32_16x16x32_bf16 v[188:191], a[60:63], v[156:159], v[124:127]
    v_mul_f32_dpp v225, v25, v25 row_ror:4 row_mask:0xf bank_mask:0xf
    v_mul_f32_dpp v226, v26, v26 row_ror:4 row_mask:0xf bank_mask:0xf
    v_mfma_f32_16x16x32_bf16 v[188:191], a[56:59], v[152:155], v[188:191]
    v_mul_f32_dpp v227, v27, v27 row_ror:4 row_mask:0xf bank_mask:0xf
    v_mul_f32_dpp v228, v28, v28 row_ror:4 row_mask:0xf bank_mask:0xf
    v_mfma_f32_16x16x32_bf16 v[188:191], a[52:55], v[148:151], v[188:191]
    v_mul_f32_dpp v229, v29, v29 row_ror:4 row_mask:0xf bank_mask:0xf
    v_mul_f32_dpp v230, v30, v30 row_ror:4 row_mask:0xf bank_mask:0xf
    v_mfma_f32_16x16x32_bf16 v[188:191], a[48:51], v[144:147], v[188:191]
    v_mul_f32_dpp v231, v31, v31 row_ror:4 row_mask:0xf bank_mask:0xf
    v_cvt_pk_bf16_f32 v208, |v176|, |v177|
    v_smfmac_f32_16x16x64_bf16 v[232:235], a[172:175], v[152:159], v1
    v_cvt_pk_bf16_f32 v209, |v178|, |v179|
    v_mfma_f32_16x16x32_bf16 v[192:195], a[64:67], v[144:147], v[128:131]
    v_cvt_pk_bf16_f32 v164, v224, v225
    v_cvt_pk_bf16_f32 v165, v226, v227
    v_mfma_f32_16x16x32_bf16 v[192:195], a[68:71], v[148:151], v[192:195]
    v_cvt_pk_bf16_f32 v166, v228, v229
    v_cvt_pk_bf16_f32 v167, v230, v231
    v_mfma_f32_16x16x32_bf16 v[192:195], a[72:75], v[152:155], v[192:195]
    v_mul_f32_dpp v224, v32, v32 row_ror:4 row_mask:0xf bank_mask:0xf
    v_mul_f32_dpp v225, v33, v33 row_ror:4 row_mask:0xf bank_mask:0xf
    v_mfma_f32_16x16x32_bf16 v[192:195], a[76:79], v[156:159], v[192:195]
    v_mul_f32_dpp v226, v34, v34 row_ror:4 row_mask:0xf bank_mask:0xf
    v_mul_f32_dpp v227, v35, v35 row_ror:4 row_mask:0xf bank_mask:0xf
    v_mfma_f32_16x16x32_bf16 v[196:199], a[92:95], v[156:159], v[132:135]
    v_mul_f32_dpp v228, v36, v36 row_ror:4 row_mask:0xf bank_mask:0xf
    v_mul_f32_dpp v229, v37, v37 row_ror:4 row_mask:0xf bank_mask:0xf
    v_mfma_f32_16x16x32_bf16 v[196:199], a[88:91], v[152:155], v[196:199]
    v_mul_f32_dpp v230, v38, v38 row_ror:4 row_mask:0xf bank_mask:0xf
    v_mul_f32_dpp v231, v39, v39 row_ror:4 row_mask:0xf bank_mask:0xf
    v_mfma_f32_16x16x32_bf16 v[196:199], a[84:87], v[148:151], v[196:199]
    v_cvt_pk_bf16_f32 v168, v224, v225
    v_cvt_pk_bf16_f32 v169, v226, v227
    v_mfma_f32_16x16x32_bf16 v[196:199], a[80:83], v[144:147], v[196:199]
    v_cvt_pk_bf16_f32 v170, v228, v229
    v_cvt_pk_bf16_f32 v171, v230, v231
    v_mfma_f32_16x16x32_bf16 v[200:203], a[96:99], v[144:147], v[136:139]
    v_mul_f32_dpp v224, v40, v40 row_ror:4 row_mask:0xf bank_mask:0xf
    v_mul_f32_dpp v225, v41, v41 row_ror:4 row_mask:0xf bank_mask:0xf
    v_mfma_f32_16x16x32_bf16 v[200:203], a[100:103], v[148:151], v[200:203]
    v_mul_f32_dpp v226, v42, v42 row_ror:4 row_mask:0xf bank_mask:0xf
    v_mul_f32_dpp v227, v43, v43 row_ror:4 row_mask:0xf bank_mask:0xf
    v_mfma_f32_16x16x32_bf16 v[200:203], a[104:107], v[152:155], v[200:203]
    v_mul_f32_dpp v228, v44, v44 row_ror:4 row_mask:0xf bank_mask:0xf
    v_mul_f32_dpp v229, v45, v45 row_ror:4 row_mask:0xf bank_mask:0xf
    v_mfma_f32_16x16x32_bf16 v[200:203], a[108:111], v[156:159], v[200:203]
    v_mul_f32_dpp v230, v46, v46 row_ror:4 row_mask:0xf bank_mask:0xf
    v_mul_f32_dpp v231, v47, v47 row_ror:4 row_mask:0xf bank_mask:0xf
    v_mfma_f32_16x16x32_bf16 v[204:207], a[124:127], v[156:159], v[140:143]
    v_cvt_pk_bf16_f32 v172, v224, v225
    v_cvt_pk_bf16_f32 v173, v226, v227
    v_mfma_f32_16x16x32_bf16 v[204:207], a[120:123], v[152:155], v[204:207]
    v_cvt_pk_bf16_f32 v174, v228, v229
    v_cvt_pk_bf16_f32 v175, v230, v231
    v_mfma_f32_16x16x32_bf16 v[204:207], a[116:119], v[148:151], v[204:207]
    v_cvt_pk_bf16_f32 v210, |v180|, |v181|
    v_cvt_pk_bf16_f32 v211, |v182|, |v183|
    v_mfma_f32_16x16x32_bf16 v[204:207], a[112:115], v[144:147], v[204:207]
    v_cvt_pk_bf16_f32 v212, |v184|, |v185|
    v_cvt_pk_bf16_f32 v213, |v186|, |v187|
    v_mfma_f32_16x16x32_bf16 v[176:179], a[0:3], v[160:163], v[112:115]
    v_cvt_pk_bf16_f32 v214, |v188|, |v189|
    v_cvt_pk_bf16_f32 v215, |v190|, |v191|
    v_mfma_f32_16x16x32_bf16 v[176:179], a[4:7], v[164:167], v[176:179]
    v_cvt_pk_bf16_f32 v216, |v192|, |v193|
    v_cvt_pk_bf16_f32 v217, |v194|, |v195|
    v_mfma_f32_16x16x32_bf16 v[176:179], a[8:11], v[168:171], v[176:179]
L_stub0:
    s_cbranch_scc1 L_main2
    v_cvt_pk_bf16_f32 v218, |v196|, |v197|
    v_cvt_pk_bf16_f32 v219, |v198|, |v199|
    v_mfma_f32_16x16x32_bf16 v[176:179], a[12:15], v[172:175], v[176:179]
    v_cvt_pk_bf16_f32 v220, |v200|, |v201|
    v_cvt_pk_bf16_f32 v221, |v202|, |v203|
    v_smfmac_f32_16x16x64_bf16 v[232:235], a[160:163], v[208:215], v1
    v_cvt_pk_bf16_f32 v222, |v204|, |v205|
    v_mfma_f32_16x16x32_bf16 v[180:183], a[28:31], v[172:175], v[116:119]
    v_cvt_pk_bf16_f32 v223, |v206|, |v207|
    v_mul_f32_dpp v224, v16, v16 row_ror:5 row_mask:0xf bank_mask:0xf
    v_mfma_f32_16x16x32_bf16 v[180:183], a[24:27], v[168:171], v[180:183]
    v_mul_f32_dpp v225, v17, v17 row_ror:5 row_mask:0xf bank_mask:0xf
    v_mul_f32_dpp v226, v18, v18 row_ror:5 row_mask:0xf bank_mask:0xf
    v_mfma_f32_16x16x32_bf16 v[180:183], a[20:23], v[164:167], v[180:183]
    v_mul_f32_dpp v227, v19, v19 row_ror:5 row_mask:0xf bank_mask:0xf
    v_mul_f32_dpp v228, v20, v20 row_ror:5 row_mask:0xf bank_mask:0xf
    v_mfma_f32_16x16x32_bf16 v[180:183], a[16:19], v[160:163], v[180:183]
    v_mul_f32_dpp v229, v21, v21 row_ror:5 row_mask:0xf bank_mask:0xf
    v_mul_f32_dpp v230, v22, v22 row_ror:5 row_mask:0xf bank_mask:0xf
    v_smfmac_f32_16x16x64_bf16 v[232:235], a[164:167], v[216:223], v1
    v_mul_f32_dpp v231, v23, v23 row_ror:5 row_mask:0xf bank_mask:0xf
    v_mfma_f32_16x16x32_bf16 v[184:187], a[32:35], v[160:163], v[120:123]
    v_cvt_pk_bf16_f32 v144, v224, v225
    v_cvt_pk_bf16_f32 v145, v226, v227
    v_mfma_f32_16x16x32_bf16 v[184:187], a[36:39], v[164:167], v[184:187]
    v_cvt_pk_bf16_f32 v146, v228, v229
    v_cvt_pk_bf16_f32 v147, v230, v231
    v_mfma_f32_16x16x32_bf16 v[184:187], a[40:43], v[168:171], v[184:187]
    v_mul_f32_dpp v224, v24, v24 row_ror:5 row_mask:0xf bank_mask:0xf
    v_mul_f32_dpp v225, v25, v25 row_ror:5 row_mask:0xf bank_mask:0xf
    v_mfma_f32_16x16x32_bf16 v[184:187], a[44:47], v[172:175], v[184:187]
    v_mul_f32_dpp v226, v26, v26 row_ror:5 row_mask:0xf bank_mask:0xf
    v_mul_f32_dpp v227, v27, v27 row_ror:5 row_mask:0xf bank_mask:0xf
    v_smfmac_f32_16x16x64_bf16 v[232:235], a[184:187], v[160:167], v1
    v_mul_f32_dpp v228, v28, v28 row_ror:5 row_mask:0xf bank_mask:0xf
    v_mfma_f32_16x16x32_bf16 v[188:191], a[60:63], v[172:175], v[124:127]
    v_mul_f32_dpp v229, v29, v29 row_ror:5 row_mask:0xf bank_mask:0xf
    v_mul_f32_dpp v230, v30, v30 row_ror:5 row_mask:0xf bank_mask:0xf
    v_mfma_f32_16x16x32_bf16 v[188:191], a[56:59], v[168:171], v[188:191]
    v_mul_f32_dpp v231, v31, v31 row_ror:5 row_mask:0xf bank_mask:0xf
    v_cvt_pk_bf16_f32 v208, |v176|, |v177|
    v_mfma_f32_16x16x32_bf16 v[188:191], a[52:55], v[164:167], v[188:191]
    v_cvt_pk_bf16_f32 v209, |v178|, |v179|
    v_cvt_pk_bf16_f32 v148, v224, v225
    v_mfma_f32_16x16x32_bf16 v[188:191], a[48:51], v[160:163], v[188:191]
    v_cvt_pk_bf16_f32 v149, v226, v227
    v_cvt_pk_bf16_f32 v150, v228, v229
    v_smfmac_f32_16x16x64_bf16 v[232:235], a[188:191], v[168:175], v1
    v_cvt_pk_bf16_f32 v151, v230, v231
    v_mfma_f32_16x16x32_bf16 v[192:195], a[64:67], v[160:163], v[128:131]
    v_mul_f32_dpp v224, v32, v32 row_ror:5 row_mask:0xf bank_mask:0xf
    v_mul_f32_dpp v225, v33, v33 row_ror:5 row_mask:0xf bank_mask:0xf
    v_mfma_f32_16x16x32_bf16 v[192:195], a[68:71], v[164:167], v[192:195]
    v_mul_f32_dpp v226, v34, v34 row_ror:5 row_mask:0xf bank_mask:0xf
    v_mul_f32_dpp v227, v35, v35 row_ror:5 row_mask:0xf bank_mask:0xf
    v_mfma_f32_16x16x32_bf16 v[192:195], a[72:75], v[168:171], v[192:195]
    v_mul_f32_dpp v228, v36, v36 row_ror:5 row_mask:0xf bank_mask:0xf
    v_mul_f32_dpp v229, v37, v37 row_ror:5 row_mask:0xf bank_mask:0xf
    v_mfma_f32_16x16x32_bf16 v[192:195], a[76:79], v[172:175], v[192:195]
    v_mul_f32_dpp v230, v38, v38 row_ror:5 row_mask:0xf bank_mask:0xf
    v_mul_f32_dpp v231, v39, v39 row_ror:5 row_mask:0xf bank_mask:0xf
    v_smfmac_f32_16x16x64_bf16 v[236:239], a[136:139], v[144:151], v1
    v_cvt_pk_bf16_f32 v152, v224, v225
    v_mfma_f32_16x16x32_bf16 v[196:199], a[92:95], v[172:175], v[132:135]
    v_cvt_pk_bf16_f32 v153, v226, v227
    v_cvt_pk_bf16_f32 v154, v228, v229
    v_mfma_f32_16x16x32_bf16 v[196:199], a[88:91], v[168:171], v[196:199]
    v_cvt_pk_bf16_f32 v155, v230, v231
    v_mul_f32_dpp v224, v40, v40 row_ror:5 row_mask:0xf bank_mask:0xf
    v_mfma_f32_16x16x32_bf16 v[196:199], a[84:87], v[164:167], v[196:199]
    v_mul_f32_dpp v225, v41, v41 row_ror:5 row_mask:0xf bank_mask:0xf
    v_mul_f32_dpp v226, v42, v42 row_ror:5 row_mask:0xf bank_mask:0xf
    v_mfma_f32_16x16x32_bf16 v[196:199], a[80:83], v[160:163], v[196:199]
    v_mul_f32_dpp v227, v43, v43 row_ror:5 row_mask:0xf bank_mask:0xf
    v_mul_f32_dpp v228, v44, v44 row_ror:5 row_mask:0xf bank_mask:0xf
    v_mfma_f32_16x16x32_bf16 v[200:203], a[96:99], v[160:163], v[136:139]
    v_mul_f32_dpp v229, v45, v45 row_ror:5 row_mask:0xf bank_mask:0xf
    v_mul_f32_dpp v230, v46, v46 row_ror:5 row_mask:0xf bank_mask:0xf
    v_mfma_f32_16x16x32_bf16 v[200:203], a[100:103], v[164:167], v[200:203]
    v_mul_f32_dpp v231, v47, v47 row_ror:5 row_mask:0xf bank_mask:0xf
    v_cvt_pk_bf16_f32 v156, v224, v225
    v_mfma_f32_16x16x32_bf16 v[200:203], a[104:107], v[168:171], v[200:203]
    v_cvt_pk_bf16_f32 v157, v226, v227
    v_cvt_pk_bf16_f32 v158, v228, v229
    v_mfma_f32_16x16x32_bf16 v[200:203], a[108:111], v[172:175], v[200:203]
    v_cvt_pk_bf16_f32 v159, v230, v231
    v_cvt_pk_bf16_f32 v210, |v180|, |v181|
    v_mfma_f32_16x16x32_bf16 v[204:207], a[124:127], v[172:175], v[140:143]
    v_cvt_pk_bf16_f32 v211, |v182|, |v183|
    v_cvt_pk_bf16_f32 v212, |v184|, |v185|
    v_mfma_f32_16x16x32_bf16 v[204:207], a[120:123], v[168:171], v[204:207]
    v_cvt_pk_bf16_f32 v213, |v186|, |v187|
    v_cvt_pk_bf16_f32 v214, |v188|, |v189|
    v_mfma_f32_16x16x32_bf16 v[204:207], a[116:119], v[164:167], v[204:207]
    v_cvt_pk_bf16_f32 v215, |v190|, |v191|
    v_cvt_pk_bf16_f32 v216, |v192|, |v193|
    v_mfma_f32_16x16x32_bf16 v[204:207], a[112:115], v[160:163], v[204:207]
    v_cvt_pk_bf16_f32 v217, |v194|, |v195|
    v_cvt_pk_bf16_f32 v218, |v196|, |v197|
    v_smfmac_f32_16x16x64_bf16 v[232:235], a[176:179], v[208:215], v1
    v_cvt_pk_bf16_f32 v219, |v198|, |v199|
    v_mfma_f32_16x16x32_bf16 v[176:179], a[0:3], v[144:147], v[112:115]
    v_cvt_pk_bf16_f32 v220, |v200|, |v201|
    v_cvt_pk_bf16_f32 v221, |v202|, |v203|
    v_mfma_f32_16x16x32_bf16 v[176:179], a[4:7], v[148:151], v[176:179]
    v_cvt_pk_bf16_f32 v222, |v204|, |v205|
    v_cvt_pk_bf16_f32 v223, |v206|, |v207|
    v_mfma_f32_16x16x32_bf16 v[176:179], a[8:11], v[152:155], v[176:179]
    v_mul_f32_dpp v224, v16, v16 row_ror:6 row_mask:0xf bank_mask:0xf
    v_mul_f32_dpp v225, v17, v17 row_ror:6 row_mask:0xf bank_mask:0xf
    v_mfma_f32_16x16x32_bf16 v[176:179], a[12:15], v[156:159], v[176:179]
    v_mul_f32_dpp v226, v18, v18 row_ror:6 row_mask:0xf bank_mask:0xf
    v_mul_f32_dpp v227, v19, v19 row_ror:6 row_mask:0xf bank_mask:0xf
    v_smfmac_f32_16x16x64_bf16 v[232:235], a[180:183], v[216:223], v1
    v_mul_f32_dpp v228, v20, v20 row_ror:6 row_mask:0xf bank_mask:0xf
    v_mfma_f32_16x16x32_bf16 v[180:183], a[28:31], v[156:159], v[116:119]
    v_mul_f32_dpp v229, v21, v21 row_ror:6 row_mask:0xf bank_mask:0xf
    v_mul_f32_dpp v230, v22, v22 row_ror:6 row_mask:0xf bank_mask:0xf
    v_mfma_f32_16x16x32_bf16 v[180:183], a[24:27], v[152:155], v[180:183]
    v_mul_f32_dpp v231, v23, v23 row_ror:6 row_mask:0xf bank_mask:0xf
    v_cvt_pk_bf16_f32 v160, v224, v225
    v_mfma_f32_16x16x32_bf16 v[180:183], a[20:23], v[148:151], v[180:183]
    v_cvt_pk_bf16_f32 v161, v226, v227
    v_cvt_pk_bf16_f32 v162, v228, v229
    v_mfma_f32_16x16x32_bf16 v[180:183], a[16:19], v[144:147], v[180:183]
    v_cvt_pk_bf16_f32 v163, v230, v231
    v_mul_f32_dpp v224, v24, v24 row_ror:6 row_mask:0xf bank_mask:0xf
    v_smfmac_f32_16x16x64_bf16 v[236:239], a[140:143], v[152:159], v1
    v_mul_f32_dpp v225, v25, v25 row_ror:6 row_mask:0xf bank_mask:0xf
    v_mfma_f32_16x16x32_bf16 v[184:187], a[32:35], v[144:147], v[120:123]
    v_mul_f32_dpp v226, v26, v26 row_ror:6 row_mask:0xf bank_mask:0xf
    v_mul_f32_dpp v227, v27, v27 row_ror:6 row_mask:0xf bank_mask:0xf
    v_mfma_f32_16x16x32_bf16 v[184:187], a[36:39], v[148:151], v[184:187]
    v_mul_f32_dpp v228, v28, v28 row_ror:6 row_mask:0xf bank_mask:0xf
    v_mul_f32_dpp v229, v29, v29 row_ror:6 row_mask:0xf bank_mask:0xf
    v_mfma_f32_16x16x32_bf16 v[184:187], a[40:43], v[152:155], v[184:187]
    v_mul_f32_dpp v230, v30, v30 row_ror:6 row_mask:0xf bank_mask:0xf
    v_mul_f32_dpp v231, v31, v31 row_ror:6 row_mask:0xf bank_mask:0xf
    v_mfma_f32_16x16x32_bf16 v[184:187], a[44:47], v[156:159], v[184:187]
    v_cvt_pk_bf16_f32 v208, |v176|, |v177|
    v_cvt_pk_bf16_f32 v209, |v178|, |v179|
    v_mfma_f32_16x16x32_bf16 v[188:191], a[60:63], v[156:159], v[124:127]
    v_cvt_pk_bf16_f32 v164, v224, v225
    v_cvt_pk_bf16_f32 v165, v226, v227
    v_mfma_f32_16x16x32_bf16 v[188:191], a[56:59], v[152:155], v[188:191]
    v_cvt_pk_bf16_f32 v166, v228, v229
    v_cvt_pk_bf16_f32 v167, v230, v231
    v_mfma_f32_16x16x32_bf16 v[188:191], a[52:55], v[148:151], v[188:191]
    v_mul_f32_dpp v224, v32, v32 row_ror:6 row_mask:0xf bank_mask:0xf
    v_mul_f32_dpp v225, v33, v33 row_ror:6 row_mask:0xf bank_mask:0xf
    v_mfma_f32_16x16x32_bf16 v[188:191], a[48:51], v[144:147], v[188:191]
    v_mul_f32_dpp v226, v34, v34 row_ror:6 row_mask:0xf bank_mask:0xf
    v_mul_f32_dpp v227, v35, v35 row_ror:6 row_mask:0xf bank_mask:0xf
    v_mfma_f32_16x16x32_bf16 v[192:195], a[64:67], v[144:147], v[128:131]
    v_mul_f32_dpp v228, v36, v36 row_ror:6 row_mask:0xf bank_mask:0xf
    v_mul_f32_dpp v229, v37, v37 row_ror:6 row_mask:0xf bank_mask:0xf
    v_mfma_f32_16x16x32_bf16 v[192:195], a[68:71], v[148:151], v[192:195]
    v_mul_f32_dpp v230, v38, v38 row_ror:6 row_mask:0xf bank_mask:0xf
    v_mul_f32_dpp v231, v39, v39 row_ror:6 row_mask:0xf bank_mask:0xf
    v_mfma_f32_16x16x32_bf16 v[192:195], a[72:75], v[152:155], v[192:195]
    v_cvt_pk_bf16_f32 v168, v224, v225
    v_cvt_pk_bf16_f32 v169, v226, v227
    v_mfma_f32_16x16x32_bf16 v[192:195], a[76:79], v[156:159], v[192:195]
    v_cvt_pk_bf16_f32 v170, v228, v229
    v_cvt_pk_bf16_f32 v171, v230, v231
    v_mfma_f32_16x16x32_bf16 v[196:199], a[92:95], v[156:159], v[132:135]
    v_mul_f32_dpp v224, v40, v40 row_ror:6 row_mask:0xf bank_mask:0xf
    v_mul_f32_dpp v225, v41, v41 row_ror:6 row_mask:0xf bank_mask:0xf
    v_mfma_f32_16x16x32_bf16 v[196:199], a[88:91], v[152:155], v[196:199]
    v_mul_f32_dpp v226, v42, v42 row_ror:6 row_mask:0xf bank_mask:0xf
    v_mul_f32_dpp v227, v43, v43 row_ror:6 row_mask:0xf bank_mask:0xf
    v_mfma_f32_16x16x32_bf16 v[196:199], a[84:87], v[148:151], v[196:199]
    v_mul_f32_dpp v228, v44, v44 row_ror:6 row_mask:0xf bank_mask:0xf
    v_mul_f32_dpp v229, v45, v45 row_ror:6 row_mask:0xf bank_mask:0xf
    v_mfma_f32_16x16x32_bf16 v[196:199], a[80:83], v[144:147], v[196:199]
    s_waitcnt vmcnt(0)
    v_mul_f32_dpp v230, v46, v46 row_ror:6 row_mask:0xf bank_mask:0xf
    v_mul_f32_dpp v231, v47, v47 row_ror:6 row_mask:0xf bank_mask:0xf
    v_mfma_f32_16x16x32_bf16 v[200:203], a[96:99], v[144:147], v[136:139]
    ds_read_b128 v[64:67], v2 offset:0
    v_cvt_pk_bf16_f32 v172, v224, v225
    v_cvt_pk_bf16_f32 v173, v226, v227
    v_mfma_f32_16x16x32_bf16 v[200:203], a[100:103], v[148:151], v[200:203]
    ds_read_b128 v[68:71], v2 offset:64
    v_cvt_pk_bf16_f32 v174, v228, v229
    v_cvt_pk_bf16_f32 v175, v230, v231
    v_mfma_f32_16x16x32_bf16 v[200:203], a[104:107], v[152:155], v[200:203]
    ds_read_b128 v[72:75], v2 offset:128
    v_cvt_pk_bf16_f32 v210, |v180|, |v181|
    v_cvt_pk_bf16_f32 v211, |v182|, |v183|
    v_mfma_f32_16x16x32_bf16 v[200:203], a[108:111], v[156:159], v[200:203]
    ds_read_b128 v[76:79], v2 offset:192
    v_cvt_pk_bf16_f32 v212, |v184|, |v185|
    v_cvt_pk_bf16_f32 v213, |v186|, |v187|
    v_mfma_f32_16x16x32_bf16 v[204:207], a[124:127], v[156:159], v[140:143]
    v_cvt_pk_bf16_f32 v214, |v188|, |v189|
    v_cvt_pk_bf16_f32 v215, |v190|, |v191|
    v_mfma_f32_16x16x32_bf16 v[204:207], a[120:123], v[152:155], v[204:207]
    v_cvt_pk_bf16_f32 v216, |v192|, |v193|
    v_cvt_pk_bf16_f32 v217, |v194|, |v195|
    v_mfma_f32_16x16x32_bf16 v[204:207], a[116:119], v[148:151], v[204:207]
    v_cvt_pk_bf16_f32 v218, |v196|, |v197|
    v_cvt_pk_bf16_f32 v219, |v198|, |v199|
    v_mfma_f32_16x16x32_bf16 v[204:207], a[112:115], v[144:147], v[204:207]
    v_cvt_pk_bf16_f32 v220, |v200|, |v201|
    v_cvt_pk_bf16_f32 v221, |v202|, |v203|
    v_smfmac_f32_16x16x64_bf16 v[236:239], a[128:131], v[208:215], v1
    v_mul_f32_dpp v224, v16, v16 row_ror:7 row_mask:0xf bank_mask:0xf
    v_mfma_f32_16x16x32_bf16 v[176:179], a[0:3], v[160:163], v[112:115]
    v_mul_f32_dpp v225, v17, v17 row_ror:7 row_mask:0xf bank_mask:0xf
    v_mul_f32_dpp v226, v18, v18 row_ror:7 row_mask:0xf bank_mask:0xf
    v_mfma_f32_16x16x32_bf16 v[176:179], a[4:7], v[164:167], v[176:179]
    v_cvt_pk_bf16_f32 v222, |v204|, |v205|
    v_cvt_pk_bf16_f32 v223, |v206|, |v207|
    v_mfma_f32_16x16x32_bf16 v[176:179], a[8:11], v[168:171], v[176:179]
    v_mul_f32_dpp v227, v19, v19 row_ror:7 row_mask:0xf bank_mask:0xf
    v_mul_f32_dpp v228, v20, v20 row_ror:7 row_mask:0xf bank_mask:0xf
    v_mfma_f32_16x16x32_bf16 v[176:179], a[12:15], v[172:175], v[176:179]
    s_waitcnt lgkmcnt(0)
    v_mul_f32_dpp v229, v21, v21 row_ror:7 row_mask:0xf bank_mask:0xf
    v_mul_f32_dpp v230, v22, v22 row_ror:7 row_mask:0xf bank_mask:0xf
    v_smfmac_f32_16x16x64_bf16 v[236:239], a[132:135], v[216:223], v1
    v_mul_f32_dpp v231, v23, v23 row_ror:7 row_mask:0xf bank_mask:0xf
    v_mfma_f32_16x16x32_bf16 v[180:183], a[28:31], v[172:175], v[116:119]
    v_cvt_pk_bf16_f32 v144, v224, v225
    v_cvt_pk_bf16_f32 v145, v226, v227
    v_mfma_f32_16x16x32_bf16 v[180:183], a[24:27], v[168:171], v[180:183]
    v_cvt_pk_bf16_f32 v146, v228, v229
    v_cvt_pk_bf16_f32 v147, v230, v231
    v_mfma_f32_16x16x32_bf16 v[180:183], a[20:23], v[164:167], v[180:183]
    v_mul_f32_dpp v224, v24, v24 row_ror:7 row_mask:0xf bank_mask:0xf
    v_mul_f32_dpp v225, v25, v25 row_ror:7 row_mask:0xf bank_mask:0xf
    v_mfma_f32_16x16x32_bf16 v[180:183], a[16:19], v[160:163], v[180:183]
    v_mul_f32_dpp v226, v26, v26 row_ror:7 row_mask:0xf bank_mask:0xf
    v_mul_f32_dpp v227, v27, v27 row_ror:7 row_mask:0xf bank_mask:0xf
    v_smfmac_f32_16x16x64_bf16 v[236:239], a[152:155], v[160:167], v1
    v_mul_f32_dpp v228, v28, v28 row_ror:7 row_mask:0xf bank_mask:0xf
    v_mfma_f32_16x16x32_bf16 v[184:187], a[32:35], v[160:163], v[120:123]
    v_mul_f32_dpp v229, v29, v29 row_ror:7 row_mask:0xf bank_mask:0xf
    v_mul_f32_dpp v230, v30, v30 row_ror:7 row_mask:0xf bank_mask:0xf
    v_mfma_f32_16x16x32_bf16 v[184:187], a[36:39], v[164:167], v[184:187]
    v_mul_f32_dpp v231, v31, v31 row_ror:7 row_mask:0xf bank_mask:0xf
    v_cvt_pk_bf16_f32 v208, |v176|, |v177|
    v_mfma_f32_16x16x32_bf16 v[184:187], a[40:43], v[168:171], v[184:187]
    v_cvt_pk_bf16_f32 v209, |v178|, |v179|
    v_cvt_pk_bf16_f32 v148, v224, v225
    v_mfma_f32_16x16x32_bf16 v[184:187], a[44:47], v[172:175], v[184:187]
    v_cvt_pk_bf16_f32 v149, v226, v227
    v_cvt_pk_bf16_f32 v150, v228, v229
    v_smfmac_f32_16x16x64_bf16 v[236:239], a[156:159], v[168:175], v1
    v_cvt_pk_bf16_f32 v151, v230, v231
    v_mfma_f32_16x16x32_bf16 v[188:191], a[60:63], v[172:175], v[124:127]
    v_mul_f32_dpp v224, v32, v32 row_ror:7 row_mask:0xf bank_mask:0xf
    v_mul_f32_dpp v225, v33, v33 row_ror:7 row_mask:0xf bank_mask:0xf
    v_mfma_f32_16x16x32_bf16 v[188:191], a[56:59], v[168:171], v[188:191]
    v_mul_f32_dpp v226, v34, v34 row_ror:7 row_mask:0xf bank_mask:0xf
    v_mul_f32_dpp v227, v35, v35 row_ror:7 row_mask:0xf bank_mask:0xf
    v_mfma_f32_16x16x32_bf16 v[188:191], a[52:55], v[164:167], v[188:191]
    v_mul_f32_dpp v228, v36, v36 row_ror:7 row_mask:0xf bank_mask:0xf
    v_mul_f32_dpp v229, v37, v37 row_ror:7 row_mask:0xf bank_mask:0xf
    v_mfma_f32_16x16x32_bf16 v[188:191], a[48:51], v[160:163], v[188:191]
    v_mul_f32_dpp v230, v38, v38 row_ror:7 row_mask:0xf bank_mask:0xf
    v_mul_f32_dpp v231, v39, v39 row_ror:7 row_mask:0xf bank_mask:0xf
    v_mfma_f32_16x16x32_bf16 v[192:195], a[64:67], v[160:163], v[128:131]
    v_cvt_pk_bf16_f32 v152, v224, v225
    v_cvt_pk_bf16_f32 v153, v226, v227
    v_mfma_f32_16x16x32_bf16 v[192:195], a[68:71], v[164:167], v[192:195]
    v_cvt_pk_bf16_f32 v154, v228, v229
    v_cvt_pk_bf16_f32 v155, v230, v231
    v_mfma_f32_16x16x32_bf16 v[192:195], a[72:75], v[168:171], v[192:195]
    v_mul_f32_dpp v224, v40, v40 row_ror:7 row_mask:0xf bank_mask:0xf
    v_mul_f32_dpp v225, v41, v41 row_ror:7 row_mask:0xf bank_mask:0xf
    v_mfma_f32_16x16x32_bf16 v[192:195], a[76:79], v[172:175], v[192:195]
    v_mul_f32_dpp v226, v42, v42 row_ror:7 row_mask:0xf bank_mask:0xf
    v_mul_f32_dpp v227, v43, v43 row_ror:7 row_mask:0xf bank_mask:0xf
    v_mfma_f32_16x16x32_bf16 v[196:199], a[92:95], v[172:175], v[132:135]
    v_mul_f32_dpp v228, v44, v44 row_ror:7 row_mask:0xf bank_mask:0xf
    v_mul_f32_dpp v229, v45, v45 row_ror:7 row_mask:0xf bank_mask:0xf
    v_mfma_f32_16x16x32_bf16 v[196:199], a[88:91], v[168:171], v[196:199]
    v_mul_f32_dpp v230, v46, v46 row_ror:7 row_mask:0xf bank_mask:0xf
    v_mul_f32_dpp v231, v47, v47 row_ror:7 row_mask:0xf bank_mask:0xf
    v_mfma_f32_16x16x32_bf16 v[196:199], a[84:87], v[164:167], v[196:199]
    v_cvt_pk_bf16_f32 v156, v224, v225
    v_cvt_pk_bf16_f32 v157, v226, v227
    v_mfma_f32_16x16x32_bf16 v[196:199], a[80:83], v[160:163], v[196:199]
    v_cvt_pk_bf16_f32 v158, v228, v229
    v_cvt_pk_bf16_f32 v159, v230, v231
    v_mfma_f32_16x16x32_bf16 v[200:203], a[96:99], v[160:163], v[136:139]
    v_cvt_pk_bf16_f32 v210, |v180|, |v181|
    v_cvt_pk_bf16_f32 v211, |v182|, |v183|
    v_mfma_f32_16x16x32_bf16 v[200:203], a[100:103], v[164:167], v[200:203]
    v_cvt_pk_bf16_f32 v212, |v184|, |v185|
    v_cvt_pk_bf16_f32 v213, |v186|, |v187|
    v_mfma_f32_16x16x32_bf16 v[200:203], a[104:107], v[168:171], v[200:203]
    v_cvt_pk_bf16_f32 v214, |v188|, |v189|
    v_cvt_pk_bf16_f32 v215, |v190|, |v191|
    v_mfma_f32_16x16x32_bf16 v[200:203], a[108:111], v[172:175], v[200:203]
    v_cvt_pk_bf16_f32 v216, |v192|, |v193|
    v_cvt_pk_bf16_f32 v217, |v194|, |v195|
    v_smfmac_f32_16x16x64_bf16 v[236:239], a[144:147], v[208:215], v1
    v_cvt_pk_bf16_f32 v218, |v196|, |v197|
    v_mfma_f32_16x16x32_bf16 v[204:207], a[124:127], v[172:175], v[140:143]
    v_cvt_pk_bf16_f32 v219, |v198|, |v199|
    v_lshlrev_b32 v48, 16, v64
    v_mfma_f32_16x16x32_bf16 v[204:207], a[120:123], v[168:171], v[204:207]
    v_cvt_pk_bf16_f32 v220, |v200|, |v201|
    v_cvt_pk_bf16_f32 v221, |v202|, |v203|
    v_mfma_f32_16x16x32_bf16 v[204:207], a[116:119], v[164:167], v[204:207]
    v_and_b32 v49, 0xffff0000, v64
    v_lshlrev_b32 v50, 16, v65
    v_mfma_f32_16x16x32_bf16 v[204:207], a[112:115], v[160:163], v[204:207]
    v_and_b32 v51, 0xffff0000, v65
    v_lshlrev_b32 v52, 16, v66
    v_mfma_f32_16x16x32_bf16 v[176:179], a[0:3], v[144:147], v[112:115]
    v_and_b32 v53, 0xffff0000, v66
    v_lshlrev_b32 v54, 16, v67
    v_mfma_f32_16x16x32_bf16 v[176:179], a[4:7], v[148:151], v[176:179]
    v_and_b32 v55, 0xffff0000, v67
    v_lshlrev_b32 v56, 16, v68
    v_mfma_f32_16x16x32_bf16 v[176:179], a[8:11], v[152:155], v[176:179]
    v_cvt_pk_bf16_f32 v222, |v204|, |v205|
    v_cvt_pk_bf16_f32 v223, |v206|, |v207|
    v_mfma_f32_16x16x32_bf16 v[176:179], a[12:15], v[156:159], v[176:179]
    v_and_b32 v57, 0xffff0000, v68
    v_lshlrev_b32 v58, 16, v69
    v_smfmac_f32_16x16x64_bf16 v[236:239], a[148:151], v[216:223], v1
    v_and_b32 v59, 0xffff0000, v69
    v_mfma_f32_16x16x32_bf16 v[180:183], a[28:31], v[156:159], v[116:119]
    v_lshlrev_b32 v60, 16, v70
    v_and_b32 v61, 0xffff0000, v70
    v_mfma_f32_16x16x32_bf16 v[180:183], a[24:27], v[152:155], v[180:183]
    v_lshlrev_b32 v62, 16, v71
    v_and_b32 v63, 0xffff0000, v71
    v_mfma_f32_16x16x32_bf16 v[180:183], a[20:23], v[148:151], v[180:183]
    v_mul_f32_dpp v224, v48, v16 row_newbcast:14 row_mask:0xf bank_mask:0xf
    v_mul_f32_dpp v225, v49, v17 row_newbcast:14 row_mask:0xf bank_mask:0xf
    v_mfma_f32_16x16x32_bf16 v[180:183], a[16:19], v[144:147], v[180:183]
    v_mul_f32_dpp v226, v50, v18 row_newbcast:14 row_mask:0xf bank_mask:0xf
    v_mul_f32_dpp v227, v51, v19 row_newbcast:14 row_mask:0xf bank_mask:0xf
    v_smfmac_f32_16x16x64_bf16 v[236:239], a[168:171], v[144:151], v1
    v_mul_f32_dpp v228, v52, v20 row_newbcast:14 row_mask:0xf bank_mask:0xf
    v_mfma_f32_16x16x32_bf16 v[184:187], a[32:35], v[144:147], v[120:123]
    v_mul_f32_dpp v229, v53, v21 row_newbcast:14 row_mask:0xf bank_mask:0xf
    v_mul_f32_dpp v230, v54, v22 row_newbcast:14 row_mask:0xf bank_mask:0xf
    v_mfma_f32_16x16x32_bf16 v[184:187], a[36:39], v[148:151], v[184:187]
    v_mul_f32_dpp v231, v55, v23 row_newbcast:14 row_mask:0xf bank_mask:0xf
    v_lshlrev_b32 v64, 16, v72
    v_mfma_f32_16x16x32_bf16 v[184:187], a[40:43], v[152:155], v[184:187]
    v_and_b32 v65, 0xffff0000, v72
    v_lshlrev_b32 v66, 16, v73
    v_mfma_f32_16x16x32_bf16 v[184:187], a[44:47], v[156:159], v[184:187]
    v_and_b32 v67, 0xffff0000, v73
    v_lshlrev_b32 v68, 16, v74
    v_smfmac_f32_16x16x64_bf16 v[236:239], a[172:175], v[152:159], v1
    v_and_b32 v69, 0xffff0000, v74
    v_mfma_f32_16x16x32_bf16 v[188:191], a[60:63], v[156:159], v[124:127]
    v_lshlrev_b32 v70, 16, v75
    v_and_b32 v71, 0xffff0000, v75
    v_mfma_f32_16x16x32_bf16 v[188:191], a[56:59], v[152:155], v[188:191]
    v_cvt_pk_bf16_f32 v160, v224, v225
    v_cvt_pk_bf16_f32 v161, v226, v227
    v_mfma_f32_16x16x32_bf16 v[188:191], a[52:55], v[148:151], v[188:191]
    v_cvt_pk_bf16_f32 v162, v228, v229
    v_cvt_pk_bf16_f32 v163, v230, v231
    v_mfma_f32_16x16x32_bf16 v[188:191], a[48:51], v[144:147], v[188:191]
    v_lshlrev_b32 v72, 16, v76
    v_and_b32 v73, 0xffff0000, v76
    v_mfma_f32_16x16x32_bf16 v[192:195], a[64:67], v[144:147], v[128:131]
    v_lshlrev_b32 v74, 16, v77
    v_and_b32 v75, 0xffff0000, v77
    v_mfma_f32_16x16x32_bf16 v[192:195], a[68:71], v[148:151], v[192:195]
    v_lshlrev_b32 v76, 16, v78
    v_and_b32 v77, 0xffff0000, v78
    v_mfma_f32_16x16x32_bf16 v[192:195], a[72:75], v[152:155], v[192:195]
    v_mul_f32_dpp v224, v56, v24 row_newbcast:14 row_mask:0xf bank_mask:0xf
    v_mul_f32_dpp v225, v57, v25 row_newbcast:14 row_mask:0xf bank_mask:0xf
    v_mfma_f32_16x16x32_bf16 v[192:195], a[76:79], v[156:159], v[192:195]
    v_mul_f32_dpp v226, v58, v26 row_newbcast:14 row_mask:0xf bank_mask:0xf
    v_mul_f32_dpp v227, v59, v27 row_newbcast:14 row_mask:0xf bank_mask:0xf
    v_mfma_f32_16x16x32_bf16 v[196:199], a[92:95], v[156:159], v[132:135]
    v_mul_f32_dpp v228, v60, v28 row_newbcast:14 row_mask:0xf bank_mask:0xf
    v_mul_f32_dpp v229, v61, v29 row_newbcast:14 row_mask:0xf bank_mask:0xf
    v_mfma_f32_16x16x32_bf16 v[196:199], a[88:91], v[152:155], v[196:199]
    v_mul_f32_dpp v230, v62, v30 row_newbcast:14 row_mask:0xf bank_mask:0xf
    v_mul_f32_dpp v231, v63, v31 row_newbcast:14 row_mask:0xf bank_mask:0xf
    v_mfma_f32_16x16x32_bf16 v[196:199], a[84:87], v[148:151], v[196:199]
    v_cvt_pk_bf16_f32 v208, |v176|, |v177|
    v_cvt_pk_bf16_f32 v209, |v178|, |v179|
    v_mfma_f32_16x16x32_bf16 v[196:199], a[80:83], v[144:147], v[196:199]
    v_lshlrev_b32 v78, 16, v79
    v_cvt_pk_bf16_f32 v164, v224, v225
    v_mfma_f32_16x16x32_bf16 v[200:203], a[96:99], v[144:147], v[136:139]
    v_cvt_pk_bf16_f32 v165, v226, v227
    v_cvt_pk_bf16_f32 v166, v228, v229
    v_mfma_f32_16x16x32_bf16 v[200:203], a[100:103], v[148:151], v[200:203]
    v_cvt_pk_bf16_f32 v167, v230, v231
    v_and_b32 v79, 0xffff0000, v79
    v_mfma_f32_16x16x32_bf16 v[200:203], a[104:107], v[152:155], v[200:203]
    v_mul_f32_dpp v224, v64, v32 row_newbcast:14 row_mask:0xf bank_mask:0xf
    v_mul_f32_dpp v225, v65, v33 row_newbcast:14 row_mask:0xf bank_mask:0xf
    v_mfma_f32_16x16x32_bf16 v[200:203], a[108:111], v[156:159], v[200:203]
    v_mul_f32_dpp v226, v66, v34 row_newbcast:14 row_mask:0xf bank_mask:0xf
    v_mul_f32_dpp v227, v67, v35 row_newbcast:14 row_mask:0xf bank_mask:0xf
    v_mfma_f32_16x16x32_bf16 v[204:207], a[124:127], v[156:159], v[140:143]
    v_mul_f32_dpp v228, v68, v36 row_newbcast:14 row_mask:0xf bank_mask:0xf
    v_mul_f32_dpp v229, v69, v37 row_newbcast:14 row_mask:0xf bank_mask:0xf
    v_mfma_f32_16x16x32_bf16 v[204:207], a[120:123], v[152:155], v[204:207]
    v_mul_f32_dpp v230, v70, v38 row_newbcast:14 row_mask:0xf bank_mask:0xf
    v_mul_f32_dpp v231, v71, v39 row_newbcast:14 row_mask:0xf bank_mask:0xf
    v_mfma_f32_16x16x32_bf16 v[204:207], a[116:119], v[148:151], v[204:207]
    v_cvt_pk_bf16_f32 v168, v224, v225
    v_cvt_pk_bf16_f32 v169, v226, v227
    v_mfma_f32_16x16x32_bf16 v[204:207], a[112:115], v[144:147], v[204:207]
    v_cvt_pk_bf16_f32 v170, v228, v229
    v_cvt_pk_bf16_f32 v171, v230, v231
    v_mfma_f32_16x16x32_bf16 v[176:179], a[0:3], v[160:163], v[112:115]
    v_mul_f32_dpp v224, v72, v40 row_newbcast:14 row_mask:0xf bank_mask:0xf
    v_mul_f32_dpp v225, v73, v41 row_newbcast:14 row_mask:0xf bank_mask:0xf
    v_mfma_f32_16x16x32_bf16 v[176:179], a[4:7], v[164:167], v[176:179]
    v_mul_f32_dpp v226, v74, v42 row_newbcast:14 row_mask:0xf bank_mask:0xf
    v_mul_f32_dpp v227, v75, v43 row_newbcast:14 row_mask:0xf bank_mask:0xf
    v_mfma_f32_16x16x32_bf16 v[176:179], a[8:11], v[168:171], v[176:179]
    v_mul_f32_dpp v228, v76, v44 row_newbcast:14 row_mask:0xf bank_mask:0xf
    v_mul_f32_dpp v229, v77, v45 row_newbcast:14 row_mask:0xf bank_mask:0xf
    v_mul_f32_dpp v230, v78, v46 row_newbcast:14 row_mask:0xf bank_mask:0xf
    v_mul_f32_dpp v231, v79, v47 row_newbcast:14 row_mask:0xf bank_mask:0xf
    v_cvt_pk_bf16_f32 v172, v224, v225
    v_cvt_pk_bf16_f32 v173, v226, v227
    v_cvt_pk_bf16_f32 v174, v228, v229
    v_cvt_pk_bf16_f32 v175, v230, v231
    v_cvt_pk_bf16_f32 v210, |v180|, |v181|
    v_cvt_pk_bf16_f32 v211, |v182|, |v183|
    v_mfma_f32_16x16x32_bf16 v[176:179], a[12:15], v[172:175], v[176:179]
    v_cvt_pk_bf16_f32 v212, |v184|, |v185|
    v_cvt_pk_bf16_f32 v213, |v186|, |v187|
    v_mfma_f32_16x16x32_bf16 v[180:183], a[28:31], v[172:175], v[116:119]
    v_cvt_pk_bf16_f32 v214, |v188|, |v189|
    v_cvt_pk_bf16_f32 v215, |v190|, |v191|
    v_mfma_f32_16x16x32_bf16 v[180:183], a[24:27], v[168:171], v[180:183]
    v_cvt_pk_bf16_f32 v216, |v192|, |v193|
    v_cvt_pk_bf16_f32 v217, |v194|, |v195|
    v_mfma_f32_16x16x32_bf16 v[180:183], a[20:23], v[164:167], v[180:183]
    v_cvt_pk_bf16_f32 v218, |v196|, |v197|
    v_cvt_pk_bf16_f32 v219, |v198|, |v199|
    v_mfma_f32_16x16x32_bf16 v[180:183], a[16:19], v[160:163], v[180:183]
    v_cvt_pk_bf16_f32 v220, |v200|, |v201|
    v_cvt_pk_bf16_f32 v221, |v202|, |v203|
    v_smfmac_f32_16x16x64_bf16 v[236:239], a[160:163], v[208:215], v1
    v_cvt_pk_bf16_f32 v222, |v204|, |v205|
    v_mfma_f32_16x16x32_bf16 v[184:187], a[32:35], v[160:163], v[120:123]
    v_cvt_pk_bf16_f32 v223, |v206|, |v207|
    v_mul_f32_dpp v224, v48, v16 row_newbcast:2 row_mask:0xf bank_mask:0xf
    v_mfma_f32_16x16x32_bf16 v[184:187], a[36:39], v[164:167], v[184:187]
    v_mul_f32_dpp v225, v49, v17 row_newbcast:2 row_mask:0xf bank_mask:0xf
    v_mul_f32_dpp v226, v50, v18 row_newbcast:2 row_mask:0xf bank_mask:0xf
    v_mfma_f32_16x16x32_bf16 v[184:187], a[40:43], v[168:171], v[184:187]
    v_mul_f32_dpp v227, v51, v19 row_newbcast:2 row_mask:0xf bank_mask:0xf
    v_mul_f32_dpp v228, v52, v20 row_newbcast:2 row_mask:0xf bank_mask:0xf
    v_mfma_f32_16x16x32_bf16 v[184:187], a[44:47], v[172:175], v[184:187]
    v_mul_f32_dpp v229, v53, v21 row_newbcast:2 row_mask:0xf bank_mask:0xf
    v_mul_f32_dpp v230, v54, v22 row_newbcast:2 row_mask:0xf bank_mask:0xf
    v_smfmac_f32_16x16x64_bf16 v[236:239], a[164:167], v[216:223], v1
    v_mul_f32_dpp v231, v55, v23 row_newbcast:2 row_mask:0xf bank_mask:0xf
    v_mfma_f32_16x16x32_bf16 v[188:191], a[60:63], v[172:175], v[124:127]
    v_cvt_pk_bf16_f32 v144, v224, v225
    v_cvt_pk_bf16_f32 v145, v226, v227
    v_mfma_f32_16x16x32_bf16 v[188:191], a[56:59], v[168:171], v[188:191]
    v_cvt_pk_bf16_f32 v146, v228, v229
    v_cvt_pk_bf16_f32 v147, v230, v231
    v_mfma_f32_16x16x32_bf16 v[188:191], a[52:55], v[164:167], v[188:191]
    v_mul_f32_dpp v224, v56, v24 row_newbcast:2 row_mask:0xf bank_mask:0xf
    v_mul_f32_dpp v225, v57, v25 row_newbcast:2 row_mask:0xf bank_mask:0xf
    v_mfma_f32_16x16x32_bf16 v[188:191], a[48:51], v[160:163], v[188:191]
    v_mul_f32_dpp v226, v58, v26 row_newbcast:2 row_mask:0xf bank_mask:0xf
    v_mul_f32_dpp v227, v59, v27 row_newbcast:2 row_mask:0xf bank_mask:0xf
    v_smfmac_f32_16x16x64_bf16 v[236:239], a[184:187], v[160:167], v1
    v_mul_f32_dpp v228, v60, v28 row_newbcast:2 row_mask:0xf bank_mask:0xf
    v_mfma_f32_16x16x32_bf16 v[192:195], a[64:67], v[160:163], v[128:131]
    v_mul_f32_dpp v229, v61, v29 row_newbcast:2 row_mask:0xf bank_mask:0xf
    v_mul_f32_dpp v230, v62, v30 row_newbcast:2 row_mask:0xf bank_mask:0xf
    v_mfma_f32_16x16x32_bf16 v[192:195], a[68:71], v[164:167], v[192:195]
    v_mul_f32_dpp v231, v63, v31 row_newbcast:2 row_mask:0xf bank_mask:0xf
    v_cvt_pk_bf16_f32 v208, |v176|, |v177|
    v_mfma_f32_16x16x32_bf16 v[192:195], a[72:75], v[168:171], v[192:195]
    v_cvt_pk_bf16_f32 v209, |v178|, |v179|
    v_cvt_pk_bf16_f32 v148, v224, v225
    v_mfma_f32_16x16x32_bf16 v[192:195], a[76:79], v[172:175], v[192:195]
    v_cvt_pk_bf16_f32 v149, v226, v227
    v_cvt_pk_bf16_f32 v150, v228, v229
    v_smfmac_f32_16x16x64_bf16 v[236:239], a[188:191], v[168:175], v1
    v_cvt_pk_bf16_f32 v151, v230, v231
    v_mfma_f32_16x16x32_bf16 v[196:199], a[92:95], v[172:175], v[132:135]
    v_mul_f32_dpp v224, v64, v32 row_newbcast:2 row_mask:0xf bank_mask:0xf
    v_mul_f32_dpp v225, v65, v33 row_newbcast:2 row_mask:0xf bank_mask:0xf
    v_mfma_f32_16x16x32_bf16 v[196:199], a[88:91], v[168:171], v[196:199]
    v_mul_f32_dpp v226, v66, v34 row_newbcast:2 row_mask:0xf bank_mask:0xf
    v_mul_f32_dpp v227, v67, v35 row_newbcast:2 row_mask:0xf bank_mask:0xf
    v_mfma_f32_16x16x32_bf16 v[196:199], a[84:87], v[164:167], v[196:199]
    v_mul_f32_dpp v228, v68, v36 row_newbcast:2 row_mask:0xf bank_mask:0xf
    v_mul_f32_dpp v229, v69, v37 row_newbcast:2 row_mask:0xf bank_mask:0xf
    v_mfma_f32_16x16x32_bf16 v[196:199], a[80:83], v[160:163], v[196:199]
    v_mul_f32_dpp v230, v70, v38 row_newbcast:2 row_mask:0xf bank_mask:0xf
    v_mul_f32_dpp v231, v71, v39 row_newbcast:2 row_mask:0xf bank_mask:0xf
    v_smfmac_f32_16x16x64_bf16 v[240:243], a[136:139], v[144:151], v1
    v_cvt_pk_bf16_f32 v152, v224, v225
    v_mfma_f32_16x16x32_bf16 v[200:203], a[96:99], v[160:163], v[136:139]
    v_cvt_pk_bf16_f32 v153, v226, v227
    v_cvt_pk_bf16_f32 v154, v228, v229
    v_mfma_f32_16x16x32_bf16 v[200:203], a[100:103], v[164:167], v[200:203]
    v_cvt_pk_bf16_f32 v155, v230, v231
    v_mul_f32_dpp v224, v72, v40 row_newbcast:2 row_mask:0xf bank_mask:0xf
    v_mfma_f32_16x16x32_bf16 v[200:203], a[104:107], v[168:171], v[200:203]
    v_mul_f32_dpp v225, v73, v41 row_newbcast:2 row_mask:0xf bank_mask:0xf
    v_mul_f32_dpp v226, v74, v42 row_newbcast:2 row_mask:0xf bank_mask:0xf
    v_mfma_f32_16x16x32_bf16 v[200:203], a[108:111], v[172:175], v[200:203]
    v_mul_f32_dpp v227, v75, v43 row_newbcast:2 row_mask:0xf bank_mask:0xf
    v_mul_f32_dpp v228, v76, v44 row_newbcast:2 row_mask:0xf bank_mask:0xf
    v_mfma_f32_16x16x32_bf16 v[204:207], a[124:127], v[172:175], v[140:143]
    v_mul_f32_dpp v229, v77, v45 row_newbcast:2 row_mask:0xf bank_mask:0xf
    v_mul_f32_dpp v230, v78, v46 row_newbcast:2 row_mask:0xf bank_mask:0xf
    v_mfma_f32_16x16x32_bf16 v[204:207], a[120:123], v[168:171], v[204:207]
L_stub1:
    s_cbranch_scc1 L_main2
    v_mul_f32_dpp v231, v79, v47 row_newbcast:2 row_mask:0xf bank_mask:0xf
    v_cvt_pk_bf16_f32 v156, v224, v225
    v_mfma_f32_16x16x32_bf16 v[204:207], a[116:119], v[164:167], v[204:207]
    v_cvt_pk_bf16_f32 v157, v226, v227
    v_cvt_pk_bf16_f32 v158, v228, v229
    v_mfma_f32_16x16x32_bf16 v[204:207], a[112:115], v[160:163], v[204:207]
    v_cvt_pk_bf16_f32 v159, v230, v231
    v_cvt_pk_bf16_f32 v210, |v180|, |v181|
    v_mfma_f32_16x16x32_bf16 v[176:179], a[0:3], v[144:147], v[112:115]
    v_cvt_pk_bf16_f32 v211, |v182|, |v183|
    v_cvt_pk_bf16_f32 v212, |v184|, |v185|
    v_mfma_f32_16x16x32_bf16 v[176:179], a[4:7], v[148:151], v[176:179]
    v_cvt_pk_bf16_f32 v213, |v186|, |v187|
    v_cvt_pk_bf16_f32 v214, |v188|, |v189|
    v_mfma_f32_16x16x32_bf16 v[176:179], a[8:11], v[152:155], v[176:179]
    v_cvt_pk_bf16_f32 v215, |v190|, |v191|
    v_cvt_pk_bf16_f32 v216, |v192|, |v193|
    v_mfma_f32_16x16x32_bf16 v[176:179], a[12:15], v[156:159], v[176:179]
    v_cvt_pk_bf16_f32 v217, |v194|, |v195|
    v_cvt_pk_bf16_f32 v218, |v196|, |v197|
    v_smfmac_f32_16x16x64_bf16 v[236:239], a[176:179], v[208:215], v1
    v_cvt_pk_bf16_f32 v219, |v198|, |v199|
    v_mfma_f32_16x16x32_bf16 v[180:183], a[28:31], v[156:159], v[116:119]
    v_cvt_pk_bf16_f32 v220, |v200|, |v201|
    v_cvt_pk_bf16_f32 v221, |v202|, |v203|
    v_mfma_f32_16x16x32_bf16 v[180:183], a[24:27], v[152:155], v[180:183]
    v_cvt_pk_bf16_f32 v222, |v204|, |v205|
    v_cvt_pk_bf16_f32 v223, |v206|, |v207|
    v_mfma_f32_16x16x32_bf16 v[180:183], a[20:23], v[148:151], v[180:183]
    v_mul_f32_dpp v224, v48, v16 row_newbcast:5 row_mask:0xf bank_mask:0xf
    v_mul_f32_dpp v225, v49, v17 row_newbcast:5 row_mask:0xf bank_mask:0xf
    v_mfma_f32_16x16x32_bf16 v[180:183], a[16:19], v[144:147], v[180:183]
    v_mul_f32_dpp v226, v50, v18 row_newbcast:5 row_mask:0xf bank_mask:0xf
    v_mul_f32_dpp v227, v51, v19 row_newbcast:5 row_mask:0xf bank_mask:0xf
    v_smfmac_f32_16x16x64_bf16 v[236:239], a[180:183], v[216:223], v1
    v_mul_f32_dpp v228, v52, v20 row_newbcast:5 row_mask:0xf bank_mask:0xf
    v_mfma_f32_16x16x32_bf16 v[184:187], a[32:35], v[144:147], v[120:123]
    v_mul_f32_dpp v229, v53, v21 row_newbcast:5 row_mask:0xf bank_mask:0xf
    v_mul_f32_dpp v230, v54, v22 row_newbcast:5 row_mask:0xf bank_mask:0xf
    v_mfma_f32_16x16x32_bf16 v[184:187], a[36:39], v[148:151], v[184:187]
    v_mul_f32_dpp v231, v55, v23 row_newbcast:5 row_mask:0xf bank_mask:0xf
    v_cvt_pk_bf16_f32 v160, v224, v225
    v_mfma_f32_16x16x32_bf16 v[184:187], a[40:43], v[152:155], v[184:187]
    s_waitcnt vmcnt(0)
    v_cvt_pk_bf16_f32 v161, v226, v227
    v_cvt_pk_bf16_f32 v162, v228, v229
    v_mfma_f32_16x16x32_bf16 v[184:187], a[44:47], v[156:159], v[184:187]
    ds_read_b128 v[96:99], v6 offset:0
    v_cvt_pk_bf16_f32 v163, v230, v231
    v_mul_f32_dpp v224, v56, v24 row_newbcast:5 row_mask:0xf bank_mask:0xf
    v_smfmac_f32_16x16x64_bf16 v[240:243], a[140:143], v[152:159], v1
    v_mul_f32_dpp v225, v57, v25 row_newbcast:5 row_mask:0xf bank_mask:0xf
    v_mfma_f32_16x16x32_bf16 v[188:191], a[60:63], v[156:159], v[124:127]
    ds_read_b128 v[100:103], v6 offset:64
    v_mul_f32_dpp v226, v58, v26 row_newbcast:5 row_mask:0xf bank_mask:0xf
    v_mul_f32_dpp v227, v59, v27 row_newbcast:5 row_mask:0xf bank_mask:0xf
    v_mfma_f32_16x16x32_bf16 v[188:191], a[56:59], v[152:155], v[188:191]
    ds_read_b128 v[104:107], v6 offset:128
    v_mul_f32_dpp v228, v60, v28 row_newbcast:5 row_mask:0xf bank_mask:0xf
    v_mul_f32_dpp v229, v61, v29 row_newbcast:5 row_mask:0xf bank_mask:0xf
    v_mfma_f32_16x16x32_bf16 v[188:191], a[52:55], v[148:151], v[188:191]
    ds_read_b128 v[108:111], v6 offset:192
    v_mul_f32_dpp v230, v62, v30 row_newbcast:5 row_mask:0xf bank_mask:0xf
    v_mul_f32_dpp v231, v63, v31 row_newbcast:5 row_mask:0xf bank_mask:0xf
    v_mfma_f32_16x16x32_bf16 v[188:191], a[48:51], v[144:147], v[188:191]
    v_cvt_pk_bf16_f32 v208, |v176|, |v177|
    v_cvt_pk_bf16_f32 v209, |v178|, |v179|
    v_mfma_f32_16x16x32_bf16 v[192:195], a[64:67], v[144:147], v[128:131]
    v_cvt_pk_bf16_f32 v164, v224, v225
    v_cvt_pk_bf16_f32 v165, v226, v227
    v_mfma_f32_16x16x32_bf16 v[192:195], a[68:71], v[148:151], v[192:195]
    v_cvt_pk_bf16_f32 v166, v228, v229
    v_cvt_pk_bf16_f32 v167, v230, v231
    v_mfma_f32_16x16x32_bf16 v[192:195], a[72:75], v[152:155], v[192:195]
    v_mul_f32_dpp v224, v64, v32 row_newbcast:5 row_mask:0xf bank_mask:0xf
    v_mul_f32_dpp v225, v65, v33 row_newbcast:5 row_mask:0xf bank_mask:0xf
    v_mfma_f32_16x16x32_bf16 v[192:195], a[76:79], v[156:159], v[192:195]
    v_mul_f32_dpp v226, v66, v34 row_newbcast:5 row_mask:0xf bank_mask:0xf
    v_mul_f32_dpp v227, v67, v35 row_newbcast:5 row_mask:0xf bank_mask:0xf
    v_mfma_f32_16x16x32_bf16 v[196:199], a[92:95], v[156:159], v[132:135]
    v_mul_f32_dpp v228, v68, v36 row_newbcast:5 row_mask:0xf bank_mask:0xf
    v_mul_f32_dpp v229, v69, v37 row_newbcast:5 row_mask:0xf bank_mask:0xf
    v_mfma_f32_16x16x32_bf16 v[196:199], a[88:91], v[152:155], v[196:199]
    v_mul_f32_dpp v230, v70, v38 row_newbcast:5 row_mask:0xf bank_mask:0xf
    v_mul_f32_dpp v231, v71, v39 row_newbcast:5 row_mask:0xf bank_mask:0xf
    v_mfma_f32_16x16x32_bf16 v[196:199], a[84:87], v[148:151], v[196:199]
    s_waitcnt lgkmcnt(0)
    v_cvt_pk_bf16_f32 v168, v224, v225
    v_cvt_pk_bf16_f32 v169, v226, v227
    v_mfma_f32_16x16x32_bf16 v[196:199], a[80:83], v[144:147], v[196:199]
    v_cvt_pk_bf16_f32 v170, v228, v229
    v_cvt_pk_bf16_f32 v171, v230, v231
    v_mfma_f32_16x16x32_bf16 v[200:203], a[96:99], v[144:147], v[136:139]
    v_mul_f32_dpp v224, v72, v40 row_newbcast:5 row_mask:0xf bank_mask:0xf
    v_mul_f32_dpp v225, v73, v41 row_newbcast:5 row_mask:0xf bank_mask:0xf
    v_mfma_f32_16x16x32_bf16 v[200:203], a[100:103], v[148:151], v[200:203]
    v_mul_f32_dpp v226, v74, v42 row_newbcast:5 row_mask:0xf bank_mask:0xf
    v_mul_f32_dpp v227, v75, v43 row_newbcast:5 row_mask:0xf bank_mask:0xf
    v_mfma_f32_16x16x32_bf16 v[200:203], a[104:107], v[152:155], v[200:203]
    v_mul_f32_dpp v228, v76, v44 row_newbcast:5 row_mask:0xf bank_mask:0xf
    v_mul_f32_dpp v229, v77, v45 row_newbcast:5 row_mask:0xf bank_mask:0xf
    v_mfma_f32_16x16x32_bf16 v[200:203], a[108:111], v[156:159], v[200:203]
    v_mul_f32_dpp v230, v78, v46 row_newbcast:5 row_mask:0xf bank_mask:0xf
    v_mul_f32_dpp v231, v79, v47 row_newbcast:5 row_mask:0xf bank_mask:0xf
    v_mfma_f32_16x16x32_bf16 v[204:207], a[124:127], v[156:159], v[140:143]
    v_cvt_pk_bf16_f32 v172, v224, v225
    v_cvt_pk_bf16_f32 v173, v226, v227
    v_mfma_f32_16x16x32_bf16 v[204:207], a[120:123], v[152:155], v[204:207]
    v_cvt_pk_bf16_f32 v174, v228, v229
    v_cvt_pk_bf16_f32 v175, v230, v231
    v_mfma_f32_16x16x32_bf16 v[204:207], a[116:119], v[148:151], v[204:207]
    v_cvt_pk_bf16_f32 v210, |v180|, |v181|
    v_cvt_pk_bf16_f32 v211, |v182|, |v183|
    v_mfma_f32_16x16x32_bf16 v[204:207], a[112:115], v[144:147], v[204:207]
    v_cvt_pk_bf16_f32 v212, |v184|, |v185|
    v_cvt_pk_bf16_f32 v213, |v186|, |v187|
    v_mfma_f32_16x16x32_bf16 v[176:179], a[0:3], v[160:163], v[112:115]
    v_cvt_pk_bf16_f32 v214, |v188|, |v189|
    v_cvt_pk_bf16_f32 v215, |v190|, |v191|
    v_mfma_f32_16x16x32_bf16 v[176:179], a[4:7], v[164:167], v[176:179]
    v_cvt_pk_bf16_f32 v216, |v192|, |v193|
    v_cvt_pk_bf16_f32 v217, |v194|, |v195|
    v_mfma_f32_16x16x32_bf16 v[176:179], a[8:11], v[168:171], v[176:179]
    v_cvt_pk_bf16_f32 v218, |v196|, |v197|
    v_cvt_pk_bf16_f32 v219, |v198|, |v199|
    v_mfma_f32_16x16x32_bf16 v[176:179], a[12:15], v[172:175], v[176:179]
    v_cvt_pk_bf16_f32 v220, |v200|, |v201|
    v_cvt_pk_bf16_f32 v221, |v202|, |v203|
    v_smfmac_f32_16x16x64_bf16 v[240:243], a[128:131], v[208:215], v1
    v_cvt_pk_bf16_f32 v222, |v204|, |v205|
    v_mfma_f32_16x16x32_bf16 v[180:183], a[28:31], v[172:175], v[116:119]
    v_cvt_pk_bf16_f32 v223, |v206|, |v207|
    v_mul_f32_dpp v224, v48, v16 row_newbcast:7 row_mask:0xf bank_mask:0xf
    v_mfma_f32_16x16x32_bf16 v[180:183], a[24:27], v[168:171], v[180:183]
    v_mul_f32_dpp v225, v49, v17 row_newbcast:7 row_mask:0xf bank_mask:0xf
    v_mul_f32_dpp v226, v50, v18 row_newbcast:7 row_mask:0xf bank_mask:0xf
    v_mfma_f32_16x16x32_bf16 v[180:183], a[20:23], v[164:167], v[180:183]
    v_mul_f32_dpp v227, v51, v19 row_newbcast:7 row_mask:0xf bank_mask:0xf
    v_mul_f32_dpp v228, v52, v20 row_newbcast:7 row_mask:0xf bank_mask:0xf
    v_mfma_f32_16x16x32_bf16 v[180:183], a[16:19], v[160:163], v[180:183]
    v_mul_f32_dpp v229, v53, v21 row_newbcast:7 row_mask:0xf bank_mask:0xf
    v_mul_f32_dpp v230, v54, v22 row_newbcast:7 row_mask:0xf bank_mask:0xf
    v_smfmac_f32_16x16x64_bf16 v[240:243], a[132:135], v[216:223], v1
    v_mul_f32_dpp v231, v55, v23 row_newbcast:7 row_mask:0xf bank_mask:0xf
    v_mfma_f32_16x16x32_bf16 v[184:187], a[32:35], v[160:163], v[120:123]
    v_cvt_pk_bf16_f32 v144, v224, v225
    v_cvt_pk_bf16_f32 v145, v226, v227
    v_mfma_f32_16x16x32_bf16 v[184:187], a[36:39], v[164:167], v[184:187]
    v_cvt_pk_bf16_f32 v146, v228, v229
    v_cvt_pk_bf16_f32 v147, v230, v231
    v_mfma_f32_16x16x32_bf16 v[184:187], a[40:43], v[168:171], v[184:187]
    v_mul_f32_dpp v224, v56, v24 row_newbcast:7 row_mask:0xf bank_mask:0xf
    v_mul_f32_dpp v225, v57, v25 row_newbcast:7 row_mask:0xf bank_mask:0xf
    v_mfma_f32_16x16x32_bf16 v[184:187], a[44:47], v[172:175], v[184:187]
    v_mul_f32_dpp v226, v58, v26 row_newbcast:7 row_mask:0xf bank_mask:0xf
    v_mul_f32_dpp v227, v59, v27 row_newbcast:7 row_mask:0xf bank_mask:0xf
    v_smfmac_f32_16x16x64_bf16 v[240:243], a[152:155], v[160:167], v1
    v_mul_f32_dpp v228, v60, v28 row_newbcast:7 row_mask:0xf bank_mask:0xf
    v_mfma_f32_16x16x32_bf16 v[188:191], a[60:63], v[172:175], v[124:127]
    v_mul_f32_dpp v229, v61, v29 row_newbcast:7 row_mask:0xf bank_mask:0xf
    v_mul_f32_dpp v230, v62, v30 row_newbcast:7 row_mask:0xf bank_mask:0xf
    v_mfma_f32_16x16x32_bf16 v[188:191], a[56:59], v[168:171], v[188:191]
    v_mul_f32_dpp v231, v63, v31 row_newbcast:7 row_mask:0xf bank_mask:0xf
    v_cvt_pk_bf16_f32 v208, |v176|, |v177|
    v_mfma_f32_16x16x32_bf16 v[188:191], a[52:55], v[164:167], v[188:191]
    v_cvt_pk_bf16_f32 v209, |v178|, |v179|
    v_cvt_pk_bf16_f32 v148, v224, v225
    v_mfma_f32_16x16x32_bf16 v[188:191], a[48:51], v[160:163], v[188:191]
    v_cvt_pk_bf16_f32 v149, v226, v227
    v_cvt_pk_bf16_f32 v150, v228, v229
    v_smfmac_f32_16x16x64_bf16 v[240:243], a[156:159], v[168:175], v1
    v_cvt_pk_bf16_f32 v151, v230, v231
    v_mfma_f32_16x16x32_bf16 v[192:195], a[64:67], v[160:163], v[128:131]
    v_mul_f32_dpp v224, v64, v32 row_newbcast:7 row_mask:0xf bank_mask:0xf
    v_mul_f32_dpp v225, v65, v33 row_newbcast:7 row_mask:0xf bank_mask:0xf
    v_mfma_f32_16x16x32_bf16 v[192:195], a[68:71], v[164:167], v[192:195]
    v_mul_f32_dpp v226, v66, v34 row_newbcast:7 row_mask:0xf bank_mask:0xf
    v_mul_f32_dpp v227, v67, v35 row_newbcast:7 row_mask:0xf bank_mask:0xf
    v_mfma_f32_16x16x32_bf16 v[192:195], a[72:75], v[168:171], v[192:195]
    v_mul_f32_dpp v228, v68, v36 row_newbcast:7 row_mask:0xf bank_mask:0xf
    v_mul_f32_dpp v229, v69, v37 row_newbcast:7 row_mask:0xf bank_mask:0xf
    v_mfma_f32_16x16x32_bf16 v[192:195], a[76:79], v[172:175], v[192:195]
    v_mul_f32_dpp v230, v70, v38 row_newbcast:7 row_mask:0xf bank_mask:0xf
    v_mul_f32_dpp v231, v71, v39 row_newbcast:7 row_mask:0xf bank_mask:0xf
    v_mfma_f32_16x16x32_bf16 v[196:199], a[92:95], v[172:175], v[132:135]
    v_cvt_pk_bf16_f32 v152, v224, v225
    v_cvt_pk_bf16_f32 v153, v226, v227
    v_mfma_f32_16x16x32_bf16 v[196:199], a[88:91], v[168:171], v[196:199]
    v_cvt_pk_bf16_f32 v154, v228, v229
    v_cvt_pk_bf16_f32 v155, v230, v231
    v_mfma_f32_16x16x32_bf16 v[196:199], a[84:87], v[164:167], v[196:199]
    v_mul_f32_dpp v224, v72, v40 row_newbcast:7 row_mask:0xf bank_mask:0xf
    v_mul_f32_dpp v225, v73, v41 row_newbcast:7 row_mask:0xf bank_mask:0xf
    v_mfma_f32_16x16x32_bf16 v[196:199], a[80:83], v[160:163], v[196:199]
    v_mul_f32_dpp v226, v74, v42 row_newbcast:7 row_mask:0xf bank_mask:0xf
    v_mul_f32_dpp v227, v75, v43 row_newbcast:7 row_mask:0xf bank_mask:0xf
    v_mfma_f32_16x16x32_bf16 v[200:203], a[96:99], v[160:163], v[136:139]
    v_mul_f32_dpp v228, v76, v44 row_newbcast:7 row_mask:0xf bank_mask:0xf
    v_mul_f32_dpp v229, v77, v45 row_newbcast:7 row_mask:0xf bank_mask:0xf
    v_mfma_f32_16x16x32_bf16 v[200:203], a[100:103], v[164:167], v[200:203]
    v_mul_f32_dpp v230, v78, v46 row_newbcast:7 row_mask:0xf bank_mask:0xf
    v_mul_f32_dpp v231, v79, v47 row_newbcast:7 row_mask:0xf bank_mask:0xf
    v_mfma_f32_16x16x32_bf16 v[200:203], a[104:107], v[168:171], v[200:203]
    v_cvt_pk_bf16_f32 v156, v224, v225
    v_cvt_pk_bf16_f32 v157, v226, v227
    v_mfma_f32_16x16x32_bf16 v[200:203], a[108:111], v[172:175], v[200:203]
    v_cvt_pk_bf16_f32 v158, v228, v229
    v_cvt_pk_bf16_f32 v159, v230, v231
    v_mfma_f32_16x16x32_bf16 v[204:207], a[124:127], v[172:175], v[140:143]
    v_cvt_pk_bf16_f32 v210, |v180|, |v181|
    v_cvt_pk_bf16_f32 v211, |v182|, |v183|
    v_mfma_f32_16x16x32_bf16 v[204:207], a[120:123], v[168:171], v[204:207]
    v_cvt_pk_bf16_f32 v212, |v184|, |v185|
    v_cvt_pk_bf16_f32 v213, |v186|, |v187|
    v_mfma_f32_16x16x32_bf16 v[204:207], a[116:119], v[164:167], v[204:207]
    v_cvt_pk_bf16_f32 v214, |v188|, |v189|
    v_cvt_pk_bf16_f32 v215, |v190|, |v191|
    v_mfma_f32_16x16x32_bf16 v[204:207], a[112:115], v[160:163], v[204:207]
    v_cvt_pk_bf16_f32 v216, |v192|, |v193|
    v_cvt_pk_bf16_f32 v217, |v194|, |v195|
    v_smfmac_f32_16x16x64_bf16 v[240:243], a[144:147], v[208:215], v1
    v_cvt_pk_bf16_f32 v218, |v196|, |v197|
    v_mfma_f32_16x16x32_bf16 v[176:179], a[0:3], v[144:147], v[112:115]
    v_cvt_pk_bf16_f32 v219, |v198|, |v199|
    v_cvt_pk_bf16_f32 v220, |v200|, |v201|
    v_mfma_f32_16x16x32_bf16 v[176:179], a[4:7], v[148:151], v[176:179]
    v_cvt_pk_bf16_f32 v221, |v202|, |v203|
    v_cvt_pk_bf16_f32 v222, |v204|, |v205|
    v_mfma_f32_16x16x32_bf16 v[176:179], a[8:11], v[152:155], v[176:179]
    v_cvt_pk_bf16_f32 v223, |v206|, |v207|
    v_mul_f32_dpp v224, v48, v16 row_newbcast:9 row_mask:0xf bank_mask:0xf
    v_mfma_f32_16x16x32_bf16 v[176:179], a[12:15], v[156:159], v[176:179]
    v_mul_f32_dpp v225, v49, v17 row_newbcast:9 row_mask:0xf bank_mask:0xf
    v_mul_f32_dpp v226, v50, v18 row_newbcast:9 row_mask:0xf bank_mask:0xf
    v_smfmac_f32_16x16x64_bf16 v[240:243], a[148:151], v[216:223], v1
    v_mul_f32_dpp v227, v51, v19 row_newbcast:9 row_mask:0xf bank_mask:0xf
    v_mfma_f32_16x16x32_bf16 v[180:183], a[28:31], v[156:159], v[116:119]
    v_mul_f32_dpp v228, v52, v20 row_newbcast:9 row_mask:0xf bank_mask:0xf
    v_mul_f32_dpp v229, v53, v21 row_newbcast:9 row_mask:0xf bank_mask:0xf
    v_mfma_f32_16x16x32_bf16 v[180:183], a[24:27], v[152:155], v[180:183]
    v_mul_f32_dpp v230, v54, v22 row_newbcast:9 row_mask:0xf bank_mask:0xf
    v_mul_f32_dpp v231, v55, v23 row_newbcast:9 row_mask:0xf bank_mask:0xf
    v_mfma_f32_16x16x32_bf16 v[180:183], a[20:23], v[148:151], v[180:183]
    v_cvt_pk_bf16_f32 v160, v224, v225
    v_cvt_pk_bf16_f32 v161, v226, v227
    v_mfma_f32_16x16x32_bf16 v[180:183], a[16:19], v[144:147], v[180:183]
    v_cvt_pk_bf16_f32 v162, v228, v229
    v_cvt_pk_bf16_f32 v163, v230, v231
    v_smfmac_f32_16x16x64_bf16 v[240:243], a[168:171], v[144:151], v1
    v_mul_f32_dpp v224, v56, v24 row_newbcast:9 row_mask:0xf bank_mask:0xf
    v_mfma_f32_16x16x32_bf16 v[184:187], a[32:35], v[144:147], v[120:123]
    v_mul_f32_dpp v225, v57, v25 row_newbcast:9 row_mask:0xf bank_mask:0xf
    v_mul_f32_dpp v226, v58, v26 row_newbcast:9 row_mask:0xf bank_mask:0xf
    v_mfma_f32_16x16x32_bf16 v[184:187], a[36:39], v[148:151], v[184:187]
    v_mul_f32_dpp v227, v59, v27 row_newbcast:9 row_mask:0xf bank_mask:0xf
    v_mul_f32_dpp v228, v60, v28 row_newbcast:9 row_mask:0xf bank_mask:0xf
    v_mfma_f32_16x16x32_bf16 v[184:187], a[40:43], v[152:155], v[184:187]
    v_mul_f32_dpp v229, v61, v29 row_newbcast:9 row_mask:0xf bank_mask:0xf
    v_mul_f32_dpp v230, v62, v30 row_newbcast:9 row_mask:0xf bank_mask:0xf
    v_mfma_f32_16x16x32_bf16 v[184:187], a[44:47], v[156:159], v[184:187]
    v_mul_f32_dpp v231, v63, v31 row_newbcast:9 row_mask:0xf bank_mask:0xf
    v_cvt_pk_bf16_f32 v208, |v176|, |v177|
    v_smfmac_f32_16x16x64_bf16 v[240:243], a[172:175], v[152:159], v1
    v_cvt_pk_bf16_f32 v209, |v178|, |v179|
    v_mfma_f32_16x16x32_bf16 v[188:191], a[60:63], v[156:159], v[124:127]
    v_cvt_pk_bf16_f32 v164, v224, v225
    v_cvt_pk_bf16_f32 v165, v226, v227
    v_mfma_f32_16x16x32_bf16 v[188:191], a[56:59], v[152:155], v[188:191]
    v_cvt_pk_bf16_f32 v166, v228, v229
    v_cvt_pk_bf16_f32 v167, v230, v231
    v_mfma_f32_16x16x32_bf16 v[188:191], a[52:55], v[148:151], v[188:191]
    v_mul_f32_dpp v224, v64, v32 row_newbcast:9 row_mask:0xf bank_mask:0xf
    v_mul_f32_dpp v225, v65, v33 row_newbcast:9 row_mask:0xf bank_mask:0xf
    v_mfma_f32_16x16x32_bf16 v[188:191], a[48:51], v[144:147], v[188:191]
    v_mul_f32_dpp v226, v66, v34 row_newbcast:9 row_mask:0xf bank_mask:0xf
    v_mul_f32_dpp v227, v67, v35 row_newbcast:9 row_mask:0xf bank_mask:0xf
    v_mfma_f32_16x16x32_bf16 v[192:195], a[64:67], v[144:147], v[128:131]
    v_mul_f32_dpp v228, v68, v36 row_newbcast:9 row_mask:0xf bank_mask:0xf
    v_mul_f32_dpp v229, v69, v37 row_newbcast:9 row_mask:0xf bank_mask:0xf
    v_mfma_f32_16x16x32_bf16 v[192:195], a[68:71], v[148:151], v[192:195]
    v_mul_f32_dpp v230, v70, v38 row_newbcast:9 row_mask:0xf bank_mask:0xf
    v_mul_f32_dpp v231, v71, v39 row_newbcast:9 row_mask:0xf bank_mask:0xf
    v_mfma_f32_16x16x32_bf16 v[192:195], a[72:75], v[152:155], v[192:195]
    v_cvt_pk_bf16_f32 v168, v224, v225
    v_cvt_pk_bf16_f32 v169, v226, v227
    v_mfma_f32_16x16x32_bf16 v[192:195], a[76:79], v[156:159], v[192:195]
    v_cvt_pk_bf16_f32 v170, v228, v229
    v_cvt_pk_bf16_f32 v171, v230, v231
    v_mfma_f32_16x16x32_bf16 v[196:199], a[92:95], v[156:159], v[132:135]
    v_mul_f32_dpp v224, v72, v40 row_newbcast:9 row_mask:0xf bank_mask:0xf
    v_mul_f32_dpp v225, v73, v41 row_newbcast:9 row_mask:0xf bank_mask:0xf
    v_mfma_f32_16x16x32_bf16 v[196:199], a[88:91], v[152:155], v[196:199]
    v_mul_f32_dpp v226, v74, v42 row_newbcast:9 row_mask:0xf bank_mask:0xf
    v_mul_f32_dpp v227, v75, v43 row_newbcast:9 row_mask:0xf bank_mask:0xf
    v_mfma_f32_16x16x32_bf16 v[196:199], a[84:87], v[148:151], v[196:199]
    v_mul_f32_dpp v228, v76, v44 row_newbcast:9 row_mask:0xf bank_mask:0xf
    v_mul_f32_dpp v229, v77, v45 row_newbcast:9 row_mask:0xf bank_mask:0xf
    v_mfma_f32_16x16x32_bf16 v[196:199], a[80:83], v[144:147], v[196:199]
    v_mul_f32_dpp v230, v78, v46 row_newbcast:9 row_mask:0xf bank_mask:0xf
    v_mul_f32_dpp v231, v79, v47 row_newbcast:9 row_mask:0xf bank_mask:0xf
    v_mfma_f32_16x16x32_bf16 v[200:203], a[96:99], v[144:147], v[136:139]
    v_cvt_pk_bf16_f32 v172, v224, v225
    v_cvt_pk_bf16_f32 v173, v226, v227
    v_mfma_f32_16x16x32_bf16 v[200:203], a[100:103], v[148:151], v[200:203]
    v_cvt_pk_bf16_f32 v174, v228, v229
    v_cvt_pk_bf16_f32 v175, v230, v231
    v_mfma_f32_16x16x32_bf16 v[200:203], a[104:107], v[152:155], v[200:203]
    v_cvt_pk_bf16_f32 v210, |v180|, |v181|
    v_cvt_pk_bf16_f32 v211, |v182|, |v183|
    v_mfma_f32_16x16x32_bf16 v[200:203], a[108:111], v[156:159], v[200:203]
    v_cvt_pk_bf16_f32 v212, |v184|, |v185|
    v_cvt_pk_bf16_f32 v213, |v186|, |v187|
    v_mfma_f32_16x16x32_bf16 v[204:207], a[124:127], v[156:159], v[140:143]
    v_cvt_pk_bf16_f32 v214, |v188|, |v189|
    v_cvt_pk_bf16_f32 v215, |v190|, |v191|
    v_mfma_f32_16x16x32_bf16 v[204:207], a[120:123], v[152:155], v[204:207]
    v_cvt_pk_bf16_f32 v216, |v192|, |v193|
    v_cvt_pk_bf16_f32 v217, |v194|, |v195|
    v_mfma_f32_16x16x32_bf16 v[204:207], a[116:119], v[148:151], v[204:207]
    v_cvt_pk_bf16_f32 v218, |v196|, |v197|
    v_cvt_pk_bf16_f32 v219, |v198|, |v199|
    v_mfma_f32_16x16x32_bf16 v[204:207], a[112:115], v[144:147], v[204:207]
    v_cvt_pk_bf16_f32 v220, |v200|, |v201|
    v_cvt_pk_bf16_f32 v221, |v202|, |v203|
    v_smfmac_f32_16x16x64_bf16 v[240:243], a[160:163], v[208:215], v1
    v_mul_f32_dpp v224, v48, v16 row_newbcast:8 row_mask:0xf bank_mask:0xf
    v_mfma_f32_16x16x32_bf16 v[176:179], a[0:3], v[160:163], v[112:115]
    v_mul_f32_dpp v225, v49, v17 row_newbcast:8 row_mask:0xf bank_mask:0xf
    v_mul_f32_dpp v226, v50, v18 row_newbcast:8 row_mask:0xf bank_mask:0xf
    v_mfma_f32_16x16x32_bf16 v[176:179], a[4:7], v[164:167], v[176:179]
    v_cvt_pk_bf16_f32 v222, |v204|, |v205|
    v_cvt_pk_bf16_f32 v223, |v206|, |v207|
    v_mfma_f32_16x16x32_bf16 v[176:179], a[8:11], v[168:171], v[176:179]
    v_mul_f32_dpp v227, v51, v19 row_newbcast:8 row_mask:0xf bank_mask:0xf
    v_mul_f32_dpp v228, v52, v20 row_newbcast:8 row_mask:0xf bank_mask:0xf
    v_mfma_f32_16x16x32_bf16 v[176:179], a[12:15], v[172:175], v[176:179]
    v_mul_f32_dpp v229, v53, v21 row_newbcast:8 row_mask:0xf bank_mask:0xf
    v_mul_f32_dpp v230, v54, v22 row_newbcast:8 row_mask:0xf bank_mask:0xf
    v_smfmac_f32_16x16x64_bf16 v[240:243], a[164:167], v[216:223], v1
    v_mul_f32_dpp v231, v55, v23 row_newbcast:8 row_mask:0xf bank_mask:0xf
    v_mfma_f32_16x16x32_bf16 v[180:183], a[28:31], v[172:175], v[116:119]
    v_cvt_pk_bf16_f32 v144, v224, v225
    v_cvt_pk_bf16_f32 v145, v226, v227
    v_mfma_f32_16x16x32_bf16 v[180:183], a[24:27], v[168:171], v[180:183]
    v_cvt_pk_bf16_f32 v146, v228, v229
    v_cvt_pk_bf16_f32 v147, v230, v231
    v_mfma_f32_16x16x32_bf16 v[180:183], a[20:23], v[164:167], v[180:183]
    v_mul_f32_dpp v224, v56, v24 row_newbcast:8 row_mask:0xf bank_mask:0xf
    v_mul_f32_dpp v225, v57, v25 row_newbcast:8 row_mask:0xf bank_mask:0xf
    v_mfma_f32_16x16x32_bf16 v[180:183], a[16:19], v[160:163], v[180:183]
    v_mul_f32_dpp v226, v58, v26 row_newbcast:8 row_mask:0xf bank_mask:0xf
    v_mul_f32_dpp v227, v59, v27 row_newbcast:8 row_mask:0xf bank_mask:0xf
    v_smfmac_f32_16x16x64_bf16 v[240:243], a[184:187], v[160:167], v1
    v_mul_f32_dpp v228, v60, v28 row_newbcast:8 row_mask:0xf bank_mask:0xf
    v_mfma_f32_16x16x32_bf16 v[184:187], a[32:35], v[160:163], v[120:123]
    v_mul_f32_dpp v229, v61, v29 row_newbcast:8 row_mask:0xf bank_mask:0xf
    v_mul_f32_dpp v230, v62, v30 row_newbcast:8 row_mask:0xf bank_mask:0xf
    v_mfma_f32_16x16x32_bf16 v[184:187], a[36:39], v[164:167], v[184:187]
    v_mul_f32_dpp v231, v63, v31 row_newbcast:8 row_mask:0xf bank_mask:0xf
    v_cvt_pk_bf16_f32 v208, |v176|, |v177|
    v_mfma_f32_16x16x32_bf16 v[184:187], a[40:43], v[168:171], v[184:187]
    v_cvt_pk_bf16_f32 v209, |v178|, |v179|
    v_cvt_pk_bf16_f32 v148, v224, v225
    v_mfma_f32_16x16x32_bf16 v[184:187], a[44:47], v[172:175], v[184:187]
    v_cvt_pk_bf16_f32 v149, v226, v227
    v_cvt_pk_bf16_f32 v150, v228, v229
    v_smfmac_f32_16x16x64_bf16 v[240:243], a[188:191], v[168:175], v1
    v_cvt_pk_bf16_f32 v151, v230, v231
    v_mfma_f32_16x16x32_bf16 v[188:191], a[60:63], v[172:175], v[124:127]
    v_mul_f32_dpp v224, v64, v32 row_newbcast:8 row_mask:0xf bank_mask:0xf
    v_mul_f32_dpp v225, v65, v33 row_newbcast:8 row_mask:0xf bank_mask:0xf
    v_mfma_f32_16x16x32_bf16 v[188:191], a[56:59], v[168:171], v[188:191]
    v_mul_f32_dpp v226, v66, v34 row_newbcast:8 row_mask:0xf bank_mask:0xf
    v_mul_f32_dpp v227, v67, v35 row_newbcast:8 row_mask:0xf bank_mask:0xf
    v_mfma_f32_16x16x32_bf16 v[188:191], a[52:55], v[164:167], v[188:191]
    v_mul_f32_dpp v228, v68, v36 row_newbcast:8 row_mask:0xf bank_mask:0xf
    v_mul_f32_dpp v229, v69, v37 row_newbcast:8 row_mask:0xf bank_mask:0xf
    v_mfma_f32_16x16x32_bf16 v[188:191], a[48:51], v[160:163], v[188:191]
    v_mul_f32_dpp v230, v70, v38 row_newbcast:8 row_mask:0xf bank_mask:0xf
    v_mul_f32_dpp v231, v71, v39 row_newbcast:8 row_mask:0xf bank_mask:0xf
    v_smfmac_f32_16x16x64_bf16 v[244:247], a[136:139], v[144:151], v1
    v_cvt_pk_bf16_f32 v152, v224, v225
    v_mfma_f32_16x16x32_bf16 v[192:195], a[64:67], v[160:163], v[128:131]
    v_cvt_pk_bf16_f32 v153, v226, v227
    v_cvt_pk_bf16_f32 v154, v228, v229
    v_mfma_f32_16x16x32_bf16 v[192:195], a[68:71], v[164:167], v[192:195]
    v_cvt_pk_bf16_f32 v155, v230, v231
    v_mul_f32_dpp v224, v72, v40 row_newbcast:8 row_mask:0xf bank_mask:0xf
    v_mfma_f32_16x16x32_bf16 v[192:195], a[72:75], v[168:171], v[192:195]
    v_mul_f32_dpp v225, v73, v41 row_newbcast:8 row_mask:0xf bank_mask:0xf
    v_mul_f32_dpp v226, v74, v42 row_newbcast:8 row_mask:0xf bank_mask:0xf
    v_mfma_f32_16x16x32_bf16 v[192:195], a[76:79], v[172:175], v[192:195]
    v_mul_f32_dpp v227, v75, v43 row_newbcast:8 row_mask:0xf bank_mask:0xf
    v_mul_f32_dpp v228, v76, v44 row_newbcast:8 row_mask:0xf bank_mask:0xf
    v_mfma_f32_16x16x32_bf16 v[196:199], a[92:95], v[172:175], v[132:135]
    v_mul_f32_dpp v229, v77, v45 row_newbcast:8 row_mask:0xf bank_mask:0xf
    v_mul_f32_dpp v230, v78, v46 row_newbcast:8 row_mask:0xf bank_mask:0xf
    v_mfma_f32_16x16x32_bf16 v[196:199], a[88:91], v[168:171], v[196:199]
    v_mul_f32_dpp v231, v79, v47 row_newbcast:8 row_mask:0xf bank_mask:0xf
    v_cvt_pk_bf16_f32 v156, v224, v225
    v_mfma_f32_16x16x32_bf16 v[196:199], a[84:87], v[164:167], v[196:199]
    v_cvt_pk_bf16_f32 v157, v226, v227
    v_cvt_pk_bf16_f32 v158, v228, v229
    v_mfma_f32_16x16x32_bf16 v[196:199], a[80:83], v[160:163], v[196:199]
    v_cvt_pk_bf16_f32 v159, v230, v231
    v_cvt_pk_bf16_f32 v210, |v180|, |v181|
    v_mfma_f32_16x16x32_bf16 v[200:203], a[96:99], v[160:163], v[136:139]
    v_cvt_pk_bf16_f32 v211, |v182|, |v183|
    v_cvt_pk_bf16_f32 v212, |v184|, |v185|
    v_mfma_f32_16x16x32_bf16 v[200:203], a[100:103], v[164:167], v[200:203]
    v_cvt_pk_bf16_f32 v213, |v186|, |v187|
    v_cvt_pk_bf16_f32 v214, |v188|, |v189|
    v_mfma_f32_16x16x32_bf16 v[200:203], a[104:107], v[168:171], v[200:203]
    v_cvt_pk_bf16_f32 v215, |v190|, |v191|
    v_cvt_pk_bf16_f32 v216, |v192|, |v193|
    v_mfma_f32_16x16x32_bf16 v[200:203], a[108:111], v[172:175], v[200:203]
    v_cvt_pk_bf16_f32 v217, |v194|, |v195|
    v_cvt_pk_bf16_f32 v218, |v196|, |v197|
    v_smfmac_f32_16x16x64_bf16 v[240:243], a[176:179], v[208:215], v1
    v_cvt_pk_bf16_f32 v219, |v198|, |v199|
    v_mfma_f32_16x16x32_bf16 v[204:207], a[124:127], v[172:175], v[140:143]
    v_mul_f32_dpp v224, v48, v16 row_newbcast:0 row_mask:0xf bank_mask:0xf
    v_mul_f32_dpp v225, v49, v17 row_newbcast:0 row_mask:0xf bank_mask:0xf
    v_mfma_f32_16x16x32_bf16 v[204:207], a[120:123], v[168:171], v[204:207]
    v_cvt_pk_bf16_f32 v220, |v200|, |v201|
    v_cvt_pk_bf16_f32 v221, |v202|, |v203|
    v_mfma_f32_16x16x32_bf16 v[204:207], a[116:119], v[164:167], v[204:207]
    v_mul_f32_dpp v226, v50, v18 row_newbcast:0 row_mask:0xf bank_mask:0xf
    v_mul_f32_dpp v227, v51, v19 row_newbcast:0 row_mask:0xf bank_mask:0xf
    v_mfma_f32_16x16x32_bf16 v[204:207], a[112:115], v[160:163], v[204:207]
    v_mul_f32_dpp v228, v52, v20 row_newbcast:0 row_mask:0xf bank_mask:0xf
    v_mul_f32_dpp v229, v53, v21 row_newbcast:0 row_mask:0xf bank_mask:0xf
    v_smfmac_f32_16x16x64_bf16 v[244:247], a[140:143], v[152:159], v1
    v_mul_f32_dpp v230, v54, v22 row_newbcast:0 row_mask:0xf bank_mask:0xf
    v_mfma_f32_16x16x32_bf16 v[176:179], a[0:3], v[144:147], v[112:115]
    v_mul_f32_dpp v231, v55, v23 row_newbcast:0 row_mask:0xf bank_mask:0xf
    v_cvt_pk_bf16_f32 v160, v224, v225
    v_mfma_f32_16x16x32_bf16 v[176:179], a[4:7], v[148:151], v[176:179]
    v_cvt_pk_bf16_f32 v222, |v204|, |v205|
    v_cvt_pk_bf16_f32 v223, |v206|, |v207|
    v_mfma_f32_16x16x32_bf16 v[176:179], a[8:11], v[152:155], v[176:179]
    v_cvt_pk_bf16_f32 v161, v226, v227
    v_cvt_pk_bf16_f32 v162, v228, v229
    v_mfma_f32_16x16x32_bf16 v[176:179], a[12:15], v[156:159], v[176:179]
    v_cvt_pk_bf16_f32 v163, v230, v231
    v_mul_f32_dpp v224, v56, v24 row_newbcast:0 row_mask:0xf bank_mask:0xf
    v_smfmac_f32_16x16x64_bf16 v[240:243], a[180:183], v[216:223], v1
    v_mul_f32_dpp v225, v57, v25 row_newbcast:0 row_mask:0xf bank_mask:0xf
    v_mfma_f32_16x16x32_bf16 v[180:183], a[28:31], v[156:159], v[116:119]
    v_mul_f32_dpp v226, v58, v26 row_newbcast:0 row_mask:0xf bank_mask:0xf
    v_mul_f32_dpp v227, v59, v27 row_newbcast:0 row_mask:0xf bank_mask:0xf
    v_mfma_f32_16x16x32_bf16 v[180:183], a[24:27], v[152:155], v[180:183]
    v_mul_f32_dpp v228, v60, v28 row_newbcast:0 row_mask:0xf bank_mask:0xf
    v_mul_f32_dpp v229, v61, v29 row_newbcast:0 row_mask:0xf bank_mask:0xf
    v_mfma_f32_16x16x32_bf16 v[180:183], a[20:23], v[148:151], v[180:183]
    v_mul_f32_dpp v230, v62, v30 row_newbcast:0 row_mask:0xf bank_mask:0xf
    v_mul_f32_dpp v231, v63, v31 row_newbcast:0 row_mask:0xf bank_mask:0xf
    v_mfma_f32_16x16x32_bf16 v[180:183], a[16:19], v[144:147], v[180:183]
    v_cvt_pk_bf16_f32 v208, |v176|, |v177|
    v_cvt_pk_bf16_f32 v209, |v178|, |v179|
    v_mfma_f32_16x16x32_bf16 v[184:187], a[32:35], v[144:147], v[120:123]
    v_cvt_pk_bf16_f32 v164, v224, v225
    v_cvt_pk_bf16_f32 v165, v226, v227
    v_mfma_f32_16x16x32_bf16 v[184:187], a[36:39], v[148:151], v[184:187]
    v_cvt_pk_bf16_f32 v166, v228, v229
    v_cvt_pk_bf16_f32 v167, v230, v231
    v_mfma_f32_16x16x32_bf16 v[184:187], a[40:43], v[152:155], v[184:187]
    v_mul_f32_dpp v224, v64, v32 row_newbcast:0 row_mask:0xf bank_mask:0xf
    v_mul_f32_dpp v225, v65, v33 row_newbcast:0 row_mask:0xf bank_mask:0xf
    v_mfma_f32_16x16x32_bf16 v[184:187], a[44:47], v[156:159], v[184:187]
    v_mul_f32_dpp v226, v66, v34 row_newbcast:0 row_mask:0xf bank_mask:0xf
    v_mul_f32_dpp v227, v67, v35 row_newbcast:0 row_mask:0xf bank_mask:0xf
    v_mfma_f32_16x16x32_bf16 v[188:191], a[60:63], v[156:159], v[124:127]
    v_mul_f32_dpp v228, v68, v36 row_newbcast:0 row_mask:0xf bank_mask:0xf
    v_mul_f32_dpp v229, v69, v37 row_newbcast:0 row_mask:0xf bank_mask:0xf
    v_mfma_f32_16x16x32_bf16 v[188:191], a[56:59], v[152:155], v[188:191]
    v_mul_f32_dpp v230, v70, v38 row_newbcast:0 row_mask:0xf bank_mask:0xf
    v_mul_f32_dpp v231, v71, v39 row_newbcast:0 row_mask:0xf bank_mask:0xf
    v_mfma_f32_16x16x32_bf16 v[188:191], a[52:55], v[148:151], v[188:191]
    v_cvt_pk_bf16_f32 v168, v224, v225
    v_cvt_pk_bf16_f32 v169, v226, v227
    v_mfma_f32_16x16x32_bf16 v[188:191], a[48:51], v[144:147], v[188:191]
    v_cvt_pk_bf16_f32 v170, v228, v229
    v_cvt_pk_bf16_f32 v171, v230, v231
    v_mfma_f32_16x16x32_bf16 v[192:195], a[64:67], v[144:147], v[128:131]
    v_mul_f32_dpp v224, v72, v40 row_newbcast:0 row_mask:0xf bank_mask:0xf
    v_mul_f32_dpp v225, v73, v41 row_newbcast:0 row_mask:0xf bank_mask:0xf
    v_mfma_f32_16x16x32_bf16 v[192:195], a[68:71], v[148:151], v[192:195]
    v_mul_f32_dpp v226, v74, v42 row_newbcast:0 row_mask:0xf bank_mask:0xf
    v_mul_f32_dpp v227, v75, v43 row_newbcast:0 row_mask:0xf bank_mask:0xf
    v_mfma_f32_16x16x32_bf16 v[192:195], a[72:75], v[152:155], v[192:195]
    v_mul_f32_dpp v228, v76, v44 row_newbcast:0 row_mask:0xf bank_mask:0xf
    v_mul_f32_dpp v229, v77, v45 row_newbcast:0 row_mask:0xf bank_mask:0xf
    v_mfma_f32_16x16x32_bf16 v[192:195], a[76:79], v[156:159], v[192:195]
    v_mul_f32_dpp v230, v78, v46 row_newbcast:0 row_mask:0xf bank_mask:0xf
    v_mul_f32_dpp v231, v79, v47 row_newbcast:0 row_mask:0xf bank_mask:0xf
    v_mfma_f32_16x16x32_bf16 v[196:199], a[92:95], v[156:159], v[132:135]
    v_cvt_pk_bf16_f32 v172, v224, v225
    v_cvt_pk_bf16_f32 v173, v226, v227
    v_mfma_f32_16x16x32_bf16 v[196:199], a[88:91], v[152:155], v[196:199]
    v_cvt_pk_bf16_f32 v174, v228, v229
    v_cvt_pk_bf16_f32 v175, v230, v231
    v_mfma_f32_16x16x32_bf16 v[196:199], a[84:87], v[148:151], v[196:199]
    v_cvt_pk_bf16_f32 v210, |v180|, |v181|
    v_cvt_pk_bf16_f32 v211, |v182|, |v183|
    v_mfma_f32_16x16x32_bf16 v[196:199], a[80:83], v[144:147], v[196:199]
    v_cvt_pk_bf16_f32 v212, |v184|, |v185|
    v_cvt_pk_bf16_f32 v213, |v186|, |v187|
    v_mfma_f32_16x16x32_bf16 v[200:203], a[96:99], v[144:147], v[136:139]
    v_cvt_pk_bf16_f32 v214, |v188|, |v189|
    v_cvt_pk_bf16_f32 v215, |v190|, |v191|
    v_mfma_f32_16x16x32_bf16 v[200:203], a[100:103], v[148:151], v[200:203]
L_stub2:
    s_cbranch_scc1 L_main2
    v_cvt_pk_bf16_f32 v216, |v192|, |v193|
    v_cvt_pk_bf16_f32 v217, |v194|, |v195|
    v_mfma_f32_16x16x32_bf16 v[200:203], a[104:107], v[152:155], v[200:203]
    v_cvt_pk_bf16_f32 v218, |v196|, |v197|
    v_cvt_pk_bf16_f32 v219, |v198|, |v199|
    v_mfma_f32_16x16x32_bf16 v[200:203], a[108:111], v[156:159], v[200:203]
    v_mul_f32_dpp v224, v48, v16 row_newbcast:1 row_mask:0xf bank_mask:0xf
    v_mul_f32_dpp v225, v49, v17 row_newbcast:1 row_mask:0xf bank_mask:0xf
    v_smfmac_f32_16x16x64_bf16 v[244:247], a[128:131], v[208:215], v1
    v_mul_f32_dpp v226, v50, v18 row_newbcast:1 row_mask:0xf bank_mask:0xf
    v_mfma_f32_16x16x32_bf16 v[204:207], a[124:127], v[156:159], v[140:143]
    v_mul_f32_dpp v227, v51, v19 row_newbcast:1 row_mask:0xf bank_mask:0xf
    v_mul_f32_dpp v228, v52, v20 row_newbcast:1 row_mask:0xf bank_mask:0xf
    v_mfma_f32_16x16x32_bf16 v[204:207], a[120:123], v[152:155], v[204:207]
    v_cvt_pk_bf16_f32 v220, |v200|, |v201|
    v_cvt_pk_bf16_f32 v221, |v202|, |v203|
    v_mfma_f32_16x16x32_bf16 v[204:207], a[116:119], v[148:151], v[204:207]
    v_mul_f32_dpp v229, v53, v21 row_newbcast:1 row_mask:0xf bank_mask:0xf
    v_mul_f32_dpp v230, v54, v22 row_newbcast:1 row_mask:0xf bank_mask:0xf
    v_mfma_f32_16x16x32_bf16 v[204:207], a[112:115], v[144:147], v[204:207]
    v_mul_f32_dpp v231, v55, v23 row_newbcast:1 row_mask:0xf bank_mask:0xf
    v_cvt_pk_bf16_f32 v144, v224, v225
    v_mfma_f32_16x16x32_bf16 v[176:179], a[0:3], v[160:163], v[112:115]
    v_cvt_pk_bf16_f32 v145, v226, v227
    v_cvt_pk_bf16_f32 v146, v228, v229
    v_mfma_f32_16x16x32_bf16 v[176:179], a[4:7], v[164:167], v[176:179]
    v_cvt_pk_bf16_f32 v147, v230, v231
    v_mul_f32_dpp v224, v56, v24 row_newbcast:1 row_mask:0xf bank_mask:0xf
    v_mfma_f32_16x16x32_bf16 v[176:179], a[8:11], v[168:171], v[176:179]
    v_cvt_pk_bf16_f32 v222, |v204|, |v205|
    v_cvt_pk_bf16_f32 v223, |v206|, |v207|
    v_mfma_f32_16x16x32_bf16 v[176:179], a[12:15], v[172:175], v[176:179]
    v_mul_f32_dpp v225, v57, v25 row_newbcast:1 row_mask:0xf bank_mask:0xf
    v_mul_f32_dpp v226, v58, v26 row_newbcast:1 row_mask:0xf bank_mask:0xf
    v_smfmac_f32_16x16x64_bf16 v[244:247], a[132:135], v[216:223], v1
    v_mul_f32_dpp v227, v59, v27 row_newbcast:1 row_mask:0xf bank_mask:0xf
    v_mfma_f32_16x16x32_bf16 v[180:183], a[28:31], v[172:175], v[116:119]
    v_mul_f32_dpp v228, v60, v28 row_newbcast:1 row_mask:0xf bank_mask:0xf
    v_mul_f32_dpp v229, v61, v29 row_newbcast:1 row_mask:0xf bank_mask:0xf
    v_mfma_f32_16x16x32_bf16 v[180:183], a[24:27], v[168:171], v[180:183]
    v_mul_f32_dpp v230, v62, v30 row_newbcast:1 row_mask:0xf bank_mask:0xf
    v_mul_f32_dpp v231, v63, v31 row_newbcast:1 row_mask:0xf bank_mask:0xf
    v_mfma_f32_16x16x32_bf16 v[180:183], a[20:23], v[164:167], v[180:183]
    v_cvt_pk_bf16_f32 v208, |v176|, |v177|
    v_cvt_pk_bf16_f32 v209, |v178|, |v179|
    v_mfma_f32_16x16x32_bf16 v[180:183], a[16:19], v[160:163], v[180:183]
    v_cvt_pk_bf16_f32 v148, v224, v225
    v_cvt_pk_bf16_f32 v149, v226, v227
    v_smfmac_f32_16x16x64_bf16 v[244:247], a[152:155], v[160:167], v1
    v_cvt_pk_bf16_f32 v150, v228, v229
    v_mfma_f32_16x16x32_bf16 v[184:187], a[32:35], v[160:163], v[120:123]
    v_cvt_pk_bf16_f32 v151, v230, v231
    v_mul_f32_dpp v224, v64, v32 row_newbcast:1 row_mask:0xf bank_mask:0xf
    v_mfma_f32_16x16x32_bf16 v[184:187], a[36:39], v[164:167], v[184:187]
    v_mul_f32_dpp v225, v65, v33 row_newbcast:1 row_mask:0xf bank_mask:0xf
    v_mul_f32_dpp v226, v66, v34 row_newbcast:1 row_mask:0xf bank_mask:0xf
    v_mfma_f32_16x16x32_bf16 v[184:187], a[40:43], v[168:171], v[184:187]
    v_mul_f32_dpp v227, v67, v35 row_newbcast:1 row_mask:0xf bank_mask:0xf
    v_mul_f32_dpp v228, v68, v36 row_newbcast:1 row_mask:0xf bank_mask:0xf
    v_mfma_f32_16x16x32_bf16 v[184:187], a[44:47], v[172:175], v[184:187]
    v_mul_f32_dpp v229, v69, v37 row_newbcast:1 row_mask:0xf bank_mask:0xf
    v_mul_f32_dpp v230, v70, v38 row_newbcast:1 row_mask:0xf bank_mask:0xf
    v_smfmac_f32_16x16x64_bf16 v[244:247], a[156:159], v[168:175], v1
    v_mul_f32_dpp v231, v71, v39 row_newbcast:1 row_mask:0xf bank_mask:0xf
    v_mfma_f32_16x16x32_bf16 v[188:191], a[60:63], v[172:175], v[124:127]
    v_cvt_pk_bf16_f32 v152, v224, v225
    v_cvt_pk_bf16_f32 v153, v226, v227
    v_mfma_f32_16x16x32_bf16 v[188:191], a[56:59], v[168:171], v[188:191]
    v_cvt_pk_bf16_f32 v154, v228, v229
    v_cvt_pk_bf16_f32 v155, v230, v231
    v_mfma_f32_16x16x32_bf16 v[188:191], a[52:55], v[164:167], v[188:191]
    v_mul_f32_dpp v224, v72, v40 row_newbcast:1 row_mask:0xf bank_mask:0xf
    v_mul_f32_dpp v225, v73, v41 row_newbcast:1 row_mask:0xf bank_mask:0xf
    v_mfma_f32_16x16x32_bf16 v[188:191], a[48:51], v[160:163], v[188:191]
    v_mul_f32_dpp v226, v74, v42 row_newbcast:1 row_mask:0xf bank_mask:0xf
    v_mul_f32_dpp v227, v75, v43 row_newbcast:1 row_mask:0xf bank_mask:0xf
    v_mfma_f32_16x16x32_bf16 v[192:195], a[64:67], v[160:163], v[128:131]
    v_mul_f32_dpp v228, v76, v44 row_newbcast:1 row_mask:0xf bank_mask:0xf
    v_mul_f32_dpp v229, v77, v45 row_newbcast:1 row_mask:0xf bank_mask:0xf
    v_mfma_f32_16x16x32_bf16 v[192:195], a[68:71], v[164:167], v[192:195]
    v_mul_f32_dpp v230, v78, v46 row_newbcast:1 row_mask:0xf bank_mask:0xf
    v_mul_f32_dpp v231, v79, v47 row_newbcast:1 row_mask:0xf bank_mask:0xf
    v_mfma_f32_16x16x32_bf16 v[192:195], a[72:75], v[168:171], v[192:195]
    v_cvt_pk_bf16_f32 v156, v224, v225
    v_cvt_pk_bf16_f32 v157, v226, v227
    v_mfma_f32_16x16x32_bf16 v[192:195], a[76:79], v[172:175], v[192:195]
    v_cvt_pk_bf16_f32 v158, v228, v229
    v_cvt_pk_bf16_f32 v159, v230, v231
    v_mfma_f32_16x16x32_bf16 v[196:199], a[92:95], v[172:175], v[132:135]
    v_cvt_pk_bf16_f32 v210, |v180|, |v181|
    v_cvt_pk_bf16_f32 v211, |v182|, |v183|
    v_mfma_f32_16x16x32_bf16 v[196:199], a[88:91], v[168:171], v[196:199]
    v_cvt_pk_bf16_f32 v212, |v184|, |v185|
    v_cvt_pk_bf16_f32 v213, |v186|, |v187|
    v_mfma_f32_16x16x32_bf16 v[196:199], a[84:87], v[164:167], v[196:199]
    v_cvt_pk_bf16_f32 v214, |v188|, |v189|
    v_cvt_pk_bf16_f32 v215, |v190|, |v191|
    v_mfma_f32_16x16x32_bf16 v[196:199], a[80:83], v[160:163], v[196:199]
    v_cvt_pk_bf16_f32 v216, |v192|, |v193|
    v_cvt_pk_bf16_f32 v217, |v194|, |v195|
    v_smfmac_f32_16x16x64_bf16 v[244:247], a[144:147], v[208:215], v1
    v_mul_f32_dpp v224, v48, v16 row_newbcast:6 row_mask:0xf bank_mask:0xf
    v_mfma_f32_16x16x32_bf16 v[200:203], a[96:99], v[160:163], v[136:139]
    v_mul_f32_dpp v225, v49, v17 row_newbcast:6 row_mask:0xf bank_mask:0xf
    v_mul_f32_dpp v226, v50, v18 row_newbcast:6 row_mask:0xf bank_mask:0xf
    v_mfma_f32_16x16x32_bf16 v[200:203], a[100:103], v[164:167], v[200:203]
    v_cvt_pk_bf16_f32 v218, |v196|, |v197|
    v_cvt_pk_bf16_f32 v219, |v198|, |v199|
    v_mfma_f32_16x16x32_bf16 v[200:203], a[104:107], v[168:171], v[200:203]
    v_mul_f32_dpp v227, v51, v19 row_newbcast:6 row_mask:0xf bank_mask:0xf
    v_mul_f32_dpp v228, v52, v20 row_newbcast:6 row_mask:0xf bank_mask:0xf
    v_mfma_f32_16x16x32_bf16 v[200:203], a[108:111], v[172:175], v[200:203]
    v_mul_f32_dpp v229, v53, v21 row_newbcast:6 row_mask:0xf bank_mask:0xf
    v_mul_f32_dpp v230, v54, v22 row_newbcast:6 row_mask:0xf bank_mask:0xf
    v_mfma_f32_16x16x32_bf16 v[204:207], a[124:127], v[172:175], v[140:143]
    v_mul_f32_dpp v231, v55, v23 row_newbcast:6 row_mask:0xf bank_mask:0xf
    v_lshlrev_b32 v80, 16, v96
    v_mfma_f32_16x16x32_bf16 v[204:207], a[120:123], v[168:171], v[204:207]
    v_and_b32 v81, 0xffff0000, v96
    v_lshlrev_b32 v82, 16, v97
    v_mfma_f32_16x16x32_bf16 v[204:207], a[116:119], v[164:167], v[204:207]
    v_cvt_pk_bf16_f32 v220, |v200|, |v201|
    v_cvt_pk_bf16_f32 v221, |v202|, |v203|
    v_mfma_f32_16x16x32_bf16 v[204:207], a[112:115], v[160:163], v[204:207]
    v_cvt_pk_bf16_f32 v160, v224, v225
    v_cvt_pk_bf16_f32 v161, v226, v227
    v_mfma_f32_16x16x32_bf16 v[176:179], a[0:3], v[144:147], v[112:115]
    v_cvt_pk_bf16_f32 v162, v228, v229
    v_cvt_pk_bf16_f32 v163, v230, v231
    v_mfma_f32_16x16x32_bf16 v[176:179], a[4:7], v[148:151], v[176:179]
    v_mul_f32_dpp v224, v56, v24 row_newbcast:6 row_mask:0xf bank_mask:0xf
    v_mul_f32_dpp v225, v57, v25 row_newbcast:6 row_mask:0xf bank_mask:0xf
    v_mfma_f32_16x16x32_bf16 v[176:179], a[8:11], v[152:155], v[176:179]
    v_cvt_pk_bf16_f32 v222, |v204|, |v205|
    v_cvt_pk_bf16_f32 v223, |v206|, |v207|
    v_mfma_f32_16x16x32_bf16 v[176:179], a[12:15], v[156:159], v[176:179]
    v_mul_f32_dpp v226, v58, v26 row_newbcast:6 row_mask:0xf bank_mask:0xf
    v_mul_f32_dpp v227, v59, v27 row_newbcast:6 row_mask:0xf bank_mask:0xf
    v_smfmac_f32_16x16x64_bf16 v[244:247], a[148:151], v[216:223], v1
    v_mul_f32_dpp v228, v60, v28 row_newbcast:6 row_mask:0xf bank_mask:0xf
    v_mfma_f32_16x16x32_bf16 v[180:183], a[28:31], v[156:159], v[116:119]
    v_mul_f32_dpp v229, v61, v29 row_newbcast:6 row_mask:0xf bank_mask:0xf
    v_mul_f32_dpp v230, v62, v30 row_newbcast:6 row_mask:0xf bank_mask:0xf
    v_mfma_f32_16x16x32_bf16 v[180:183], a[24:27], v[152:155], v[180:183]
    v_mul_f32_dpp v231, v63, v31 row_newbcast:6 row_mask:0xf bank_mask:0xf
    v_cvt_pk_bf16_f32 v208, |v176|, |v177|
    v_mfma_f32_16x16x32_bf16 v[180:183], a[20:23], v[148:151], v[180:183]
    v_cvt_pk_bf16_f32 v209, |v178|, |v179|
    v_cvt_pk_bf16_f32 v164, v224, v225
    v_mfma_f32_16x16x32_bf16 v[180:183], a[16:19], v[144:147], v[180:183]
    v_cvt_pk_bf16_f32 v165, v226, v227
    v_cvt_pk_bf16_f32 v166, v228, v229
    v_smfmac_f32_16x16x64_bf16 v[244:247], a[168:171], v[144:151], v1
    v_cvt_pk_bf16_f32 v167, v230, v231
    v_mfma_f32_16x16x32_bf16 v[184:187], a[32:35], v[144:147], v[120:123]
    v_mul_f32_dpp v224, v64, v32 row_newbcast:6 row_mask:0xf bank_mask:0xf
    v_mul_f32_dpp v225, v65, v33 row_newbcast:6 row_mask:0xf bank_mask:0xf
    v_mfma_f32_16x16x32_bf16 v[184:187], a[36:39], v[148:151], v[184:187]
    v_mul_f32_dpp v226, v66, v34 row_newbcast:6 row_mask:0xf bank_mask:0xf
    v_mul_f32_dpp v227, v67, v35 row_newbcast:6 row_mask:0xf bank_mask:0xf
    v_mfma_f32_16x16x32_bf16 v[184:187], a[40:43], v[152:155], v[184:187]
    v_mul_f32_dpp v228, v68, v36 row_newbcast:6 row_mask:0xf bank_mask:0xf
    v_mul_f32_dpp v229, v69, v37 row_newbcast:6 row_mask:0xf bank_mask:0xf
    v_mfma_f32_16x16x32_bf16 v[184:187], a[44:47], v[156:159], v[184:187]
    v_mul_f32_dpp v230, v70, v38 row_newbcast:6 row_mask:0xf bank_mask:0xf
    v_mul_f32_dpp v231, v71, v39 row_newbcast:6 row_mask:0xf bank_mask:0xf
    v_smfmac_f32_16x16x64_bf16 v[244:247], a[172:175], v[152:159], v1
    v_cvt_pk_bf16_f32 v168, v224, v225
    v_mfma_f32_16x16x32_bf16 v[188:191], a[60:63], v[156:159], v[124:127]
    v_cvt_pk_bf16_f32 v169, v226, v227
    v_cvt_pk_bf16_f32 v170, v228, v229
    v_mfma_f32_16x16x32_bf16 v[188:191], a[56:59], v[152:155], v[188:191]
    v_cvt_pk_bf16_f32 v171, v230, v231
    v_mul_f32_dpp v224, v72, v40 row_newbcast:6 row_mask:0xf bank_mask:0xf
    v_mfma_f32_16x16x32_bf16 v[188:191], a[52:55], v[148:151], v[188:191]
    v_mul_f32_dpp v225, v73, v41 row_newbcast:6 row_mask:0xf bank_mask:0xf
    v_mul_f32_dpp v226, v74, v42 row_newbcast:6 row_mask:0xf bank_mask:0xf
    v_mfma_f32_16x16x32_bf16 v[188:191], a[48:51], v[144:147], v[188:191]
    v_mul_f32_dpp v227, v75, v43 row_newbcast:6 row_mask:0xf bank_mask:0xf
    v_mul_f32_dpp v228, v76, v44 row_newbcast:6 row_mask:0xf bank_mask:0xf
    v_mfma_f32_16x16x32_bf16 v[192:195], a[64:67], v[144:147], v[128:131]
    v_mul_f32_dpp v229, v77, v45 row_newbcast:6 row_mask:0xf bank_mask:0xf
    v_mul_f32_dpp v230, v78, v46 row_newbcast:6 row_mask:0xf bank_mask:0xf
    v_mfma_f32_16x16x32_bf16 v[192:195], a[68:71], v[148:151], v[192:195]
    v_mul_f32_dpp v231, v79, v47 row_newbcast:6 row_mask:0xf bank_mask:0xf
    v_cvt_pk_bf16_f32 v172, v224, v225
    v_mfma_f32_16x16x32_bf16 v[192:195], a[72:75], v[152:155], v[192:195]
    v_cvt_pk_bf16_f32 v173, v226, v227
    v_cvt_pk_bf16_f32 v174, v228, v229
    v_mfma_f32_16x16x32_bf16 v[192:195], a[76:79], v[156:159], v[192:195]
    v_cvt_pk_bf16_f32 v175, v230, v231
    v_cvt_pk_bf16_f32 v210, |v180|, |v181|
    v_mfma_f32_16x16x32_bf16 v[196:199], a[92:95], v[156:159], v[132:135]
    v_cvt_pk_bf16_f32 v211, |v182|, |v183|
    v_cvt_pk_bf16_f32 v212, |v184|, |v185|
    v_mfma_f32_16x16x32_bf16 v[196:199], a[88:91], v[152:155], v[196:199]
    v_cvt_pk_bf16_f32 v213, |v186|, |v187|
    v_cvt_pk_bf16_f32 v214, |v188|, |v189|
    v_mfma_f32_16x16x32_bf16 v[196:199], a[84:87], v[148:151], v[196:199]
    v_cvt_pk_bf16_f32 v215, |v190|, |v191|
    v_cvt_pk_bf16_f32 v216, |v192|, |v193|
    v_mfma_f32_16x16x32_bf16 v[196:199], a[80:83], v[144:147], v[196:199]
    v_cvt_pk_bf16_f32 v217, |v194|, |v195|
    v_mul_f32_dpp v224, v48, v16 row_newbcast:4 row_mask:0xf bank_mask:0xf
    v_smfmac_f32_16x16x64_bf16 v[244:247], a[160:163], v[208:215], v1
    v_mul_f32_dpp v225, v49, v17 row_newbcast:4 row_mask:0xf bank_mask:0xf
    v_mfma_f32_16x16x32_bf16 v[200:203], a[96:99], v[144:147], v[136:139]
    v_mul_f32_dpp v226, v50, v18 row_newbcast:4 row_mask:0xf bank_mask:0xf
    v_mul_f32_dpp v227, v51, v19 row_newbcast:4 row_mask:0xf bank_mask:0xf
    v_mfma_f32_16x16x32_bf16 v[200:203], a[100:103], v[148:151], v[200:203]
    v_cvt_pk_bf16_f32 v218, |v196|, |v197|
    v_cvt_pk_bf16_f32 v219, |v198|, |v199|
    v_mfma_f32_16x16x32_bf16 v[200:203], a[104:107], v[152:155], v[200:203]
    v_mul_f32_dpp v228, v52, v20 row_newbcast:4 row_mask:0xf bank_mask:0xf
    v_mul_f32_dpp v229, v53, v21 row_newbcast:4 row_mask:0xf bank_mask:0xf
    v_mfma_f32_16x16x32_bf16 v[200:203], a[108:111], v[156:159], v[200:203]
    v_mul_f32_dpp v230, v54, v22 row_newbcast:4 row_mask:0xf bank_mask:0xf
    v_mul_f32_dpp v231, v55, v23 row_newbcast:4 row_mask:0xf bank_mask:0xf
    v_mfma_f32_16x16x32_bf16 v[204:207], a[124:127], v[156:159], v[140:143]
    v_and_b32 v83, 0xffff0000, v97
    v_lshlrev_b32 v84, 16, v98
    v_mfma_f32_16x16x32_bf16 v[204:207], a[120:123], v[152:155], v[204:207]
    v_and_b32 v85, 0xffff0000, v98
    v_lshlrev_b32 v86, 16, v99
    v_mfma_f32_16x16x32_bf16 v[204:207], a[116:119], v[148:151], v[204:207]
    v_cvt_pk_bf16_f32 v220, |v200|, |v201|
    v_cvt_pk_bf16_f32 v221, |v202|, |v203|
    v_mfma_f32_16x16x32_bf16 v[204:207], a[112:115], v[144:147], v[204:207]
    v_cvt_pk_bf16_f32 v144, v224, v225
    v_cvt_pk_bf16_f32 v145, v226, v227
    v_mfma_f32_16x16x32_bf16 v[176:179], a[0:3], v[160:163], v[112:115]
    v_cvt_pk_bf16_f32 v146, v228, v229
    v_cvt_pk_bf16_f32 v147, v230, v231
    v_mfma_f32_16x16x32_bf16 v[176:179], a[4:7], v[164:167], v[176:179]
    v_mul_f32_dpp v224, v56, v24 row_newbcast:4 row_mask:0xf bank_mask:0xf
    v_mul_f32_dpp v225, v57, v25 row_newbcast:4 row_mask:0xf bank_mask:0xf
    v_mfma_f32_16x16x32_bf16 v[176:179], a[8:11], v[168:171], v[176:179]
    v_cvt_pk_bf16_f32 v222, |v204|, |v205|
    v_cvt_pk_bf16_f32 v223, |v206|, |v207|
    v_mfma_f32_16x16x32_bf16 v[176:179], a[12:15], v[172:175], v[176:179]
    v_mul_f32_dpp v226, v58, v26 row_newbcast:4 row_mask:0xf bank_mask:0xf
    v_mul_f32_dpp v227, v59, v27 row_newbcast:4 row_mask:0xf bank_mask:0xf
    v_smfmac_f32_16x16x64_bf16 v[244:247], a[164:167], v[216:223], v1
    v_mul_f32_dpp v228, v60, v28 row_newbcast:4 row_mask:0xf bank_mask:0xf
    v_mfma_f32_16x16x32_bf16 v[180:183], a[28:31], v[172:175], v[116:119]
    v_mul_f32_dpp v229, v61, v29 row_newbcast:4 row_mask:0xf bank_mask:0xf
    v_mul_f32_dpp v230, v62, v30 row_newbcast:4 row_mask:0xf bank_mask:0xf
    v_mfma_f32_16x16x32_bf16 v[180:183], a[24:27], v[168:171], v[180:183]
    v_mul_f32_dpp v231, v63, v31 row_newbcast:4 row_mask:0xf bank_mask:0xf
    v_cvt_pk_bf16_f32 v208, |v176|, |v177|
    v_mfma_f32_16x16x32_bf16 v[180:183], a[20:23], v[164:167], v[180:183]
    v_cvt_pk_bf16_f32 v209, |v178|, |v179|
    v_cvt_pk_bf16_f32 v148, v224, v225
    v_mfma_f32_16x16x32_bf16 v[180:183], a[16:19], v[160:163], v[180:183]
    v_cvt_pk_bf16_f32 v149, v226, v227
    v_cvt_pk_bf16_f32 v150, v228, v229
    v_smfmac_f32_16x16x64_bf16 v[244:247], a[184:187], v[160:167], v1
    v_cvt_pk_bf16_f32 v151, v230, v231
    v_mfma_f32_16x16x32_bf16 v[184:187], a[32:35], v[160:163], v[120:123]
    v_mul_f32_dpp v224, v64, v32 row_newbcast:4 row_mask:0xf bank_mask:0xf
    v_mul_f32_dpp v225, v65, v33 row_newbcast:4 row_mask:0xf bank_mask:0xf
    v_mfma_f32_16x16x32_bf16 v[184:187], a[36:39], v[164:167], v[184:187]
    v_mul_f32_dpp v226, v66, v34 row_newbcast:4 row_mask:0xf bank_mask:0xf
    v_mul_f32_dpp v227, v67, v35 row_newbcast:4 row_mask:0xf bank_mask:0xf
    v_mfma_f32_16x16x32_bf16 v[184:187], a[40:43], v[168:171], v[184:187]
    v_mul_f32_dpp v228, v68, v36 row_newbcast:4 row_mask:0xf bank_mask:0xf
    v_mul_f32_dpp v229, v69, v37 row_newbcast:4 row_mask:0xf bank_mask:0xf
    v_mfma_f32_16x16x32_bf16 v[184:187], a[44:47], v[172:175], v[184:187]
    v_mul_f32_dpp v230, v70, v38 row_newbcast:4 row_mask:0xf bank_mask:0xf
    v_mul_f32_dpp v231, v71, v39 row_newbcast:4 row_mask:0xf bank_mask:0xf
    v_smfmac_f32_16x16x64_bf16 v[244:247], a[188:191], v[168:175], v1
    v_cvt_pk_bf16_f32 v152, v224, v225
    v_mfma_f32_16x16x32_bf16 v[188:191], a[60:63], v[172:175], v[124:127]
    v_cvt_pk_bf16_f32 v153, v226, v227
    v_cvt_pk_bf16_f32 v154, v228, v229
    v_mfma_f32_16x16x32_bf16 v[188:191], a[56:59], v[168:171], v[188:191]
    v_cvt_pk_bf16_f32 v155, v230, v231
    v_mul_f32_dpp v224, v72, v40 row_newbcast:4 row_mask:0xf bank_mask:0xf
    v_mfma_f32_16x16x32_bf16 v[188:191], a[52:55], v[164:167], v[188:191]
    v_mul_f32_dpp v225, v73, v41 row_newbcast:4 row_mask:0xf bank_mask:0xf
    v_mul_f32_dpp v226, v74, v42 row_newbcast:4 row_mask:0xf bank_mask:0xf
    v_mfma_f32_16x16x32_bf16 v[188:191], a[48:51], v[160:163], v[188:191]
    v_mul_f32_dpp v227, v75, v43 row_newbcast:4 row_mask:0xf bank_mask:0xf
    v_mul_f32_dpp v228, v76, v44 row_newbcast:4 row_mask:0xf bank_mask:0xf
    v_smfmac_f32_16x16x64_bf16 v[248:251], a[136:139], v[144:151], v1
    v_mul_f32_dpp v229, v77, v45 row_newbcast:4 row_mask:0xf bank_mask:0xf
    v_mfma_f32_16x16x32_bf16 v[192:195], a[64:67], v[160:163], v[128:131]
    v_mul_f32_dpp v230, v78, v46 row_newbcast:4 row_mask:0xf bank_mask:0xf
    v_mul_f32_dpp v231, v79, v47 row_newbcast:4 row_mask:0xf bank_mask:0xf
    v_mfma_f32_16x16x32_bf16 v[192:195], a[68:71], v[164:167], v[192:195]
    v_cvt_pk_bf16_f32 v156, v224, v225
    v_cvt_pk_bf16_f32 v157, v226, v227
    v_mfma_f32_16x16x32_bf16 v[192:195], a[72:75], v[168:171], v[192:195]
    v_cvt_pk_bf16_f32 v158, v228, v229
    v_cvt_pk_bf16_f32 v159, v230, v231
    v_mfma_f32_16x16x32_bf16 v[192:195], a[76:79], v[172:175], v[192:195]
    v_cvt_pk_bf16_f32 v210, |v180|, |v181|
    v_cvt_pk_bf16_f32 v211, |v182|, |v183|
    v_smfmac_f32_16x16x64_bf16 v[248:251], a[140:143], v[152:159], v1
    v_cvt_pk_bf16_f32 v212, |v184|, |v185|
    v_mfma_f32_16x16x32_bf16 v[196:199], a[92:95], v[172:175], v[132:135]
    v_cvt_pk_bf16_f32 v213, |v186|, |v187|
    v_cvt_pk_bf16_f32 v214, |v188|, |v189|
    v_mfma_f32_16x16x32_bf16 v[196:199], a[88:91], v[168:171], v[196:199]
    v_cvt_pk_bf16_f32 v215, |v190|, |v191|
    v_cvt_pk_bf16_f32 v216, |v192|, |v193|
    v_mfma_f32_16x16x32_bf16 v[196:199], a[84:87], v[164:167], v[196:199]
    v_cvt_pk_bf16_f32 v217, |v194|, |v195|
    v_and_b32 v87, 0xffff0000, v99
    v_mfma_f32_16x16x32_bf16 v[196:199], a[80:83], v[160:163], v[196:199]
    v_lshlrev_b32 v88, 16, v100
    v_and_b32 v89, 0xffff0000, v100
    v_smfmac_f32_16x16x64_bf16 v[244:247], a[176:179], v[208:215], v1
    v_lshlrev_b32 v90, 16, v101
    v_mfma_f32_16x16x32_bf16 v[200:203], a[96:99], v[160:163], v[136:139]
    v_and_b32 v91, 0xffff0000, v101
    v_lshlrev_b32 v92, 16, v102
    v_mfma_f32_16x16x32_bf16 v[200:203], a[100:103], v[164:167], v[200:203]
    v_cvt_pk_bf16_f32 v218, |v196|, |v197|
    v_cvt_pk_bf16_f32 v219, |v198|, |v199|
    v_mfma_f32_16x16x32_bf16 v[200:203], a[104:107], v[168:171], v[200:203]
    v_and_b32 v93, 0xffff0000, v102
    v_lshlrev_b32 v94, 16, v103
    v_mfma_f32_16x16x32_bf16 v[200:203], a[108:111], v[172:175], v[200:203]
    v_and_b32 v95, 0xffff0000, v103
    v_mul_f32_dpp v224, v80, v48 row_ror:13 row_mask:0xf bank_mask:0xf
    v_mfma_f32_16x16x32_bf16 v[204:207], a[124:127], v[172:175], v[140:143]
    v_mul_f32_dpp v225, v81, v49 row_ror:13 row_mask:0xf bank_mask:0xf
    v_mul_f32_dpp v226, v82, v50 row_ror:13 row_mask:0xf bank_mask:0xf
    v_mfma_f32_16x16x32_bf16 v[204:207], a[120:123], v[168:171], v[204:207]
    v_mul_f32_dpp v227, v83, v51 row_ror:13 row_mask:0xf bank_mask:0xf
    v_mul_f32_dpp v228, v84, v52 row_ror:13 row_mask:0xf bank_mask:0xf
    v_mfma_f32_16x16x32_bf16 v[204:207], a[116:119], v[164:167], v[204:207]
    v_cvt_pk_bf16_f32 v220, |v200|, |v201|
    v_cvt_pk_bf16_f32 v221, |v202|, |v203|
    v_mfma_f32_16x16x32_bf16 v[204:207], a[112:115], v[160:163], v[204:207]
    v_mul_f32_dpp v229, v85, v53 row_ror:13 row_mask:0xf bank_mask:0xf
    v_mul_f32_dpp v230, v86, v54 row_ror:13 row_mask:0xf bank_mask:0xf
    v_mfma_f32_16x16x32_bf16 v[176:179], a[0:3], v[144:147], v[112:115]
    v_mul_f32_dpp v231, v87, v55 row_ror:13 row_mask:0xf bank_mask:0xf
    v_lshlrev_b32 v96, 16, v104
    v_mfma_f32_16x16x32_bf16 v[176:179], a[4:7], v[148:151], v[176:179]
    v_and_b32 v97, 0xffff0000, v104
    v_lshlrev_b32 v98, 16, v105
    v_mfma_f32_16x16x32_bf16 v[176:179], a[8:11], v[152:155], v[176:179]
    v_cvt_pk_bf16_f32 v222, |v204|, |v205|
    v_cvt_pk_bf16_f32 v223, |v206|, |v207|
    v_mfma_f32_16x16x32_bf16 v[176:179], a[12:15], v[156:159], v[176:179]
    v_and_b32 v99, 0xffff0000, v105
    v_lshlrev_b32 v100, 16, v106
    v_smfmac_f32_16x16x64_bf16 v[244:247], a[180:183], v[216:223], v1
    v_and_b32 v101, 0xffff0000, v106
    v_mfma_f32_16x16x32_bf16 v[180:183], a[28:31], v[156:159], v[116:119]
    v_lshlrev_b32 v102, 16, v107
    v_and_b32 v103, 0xffff0000, v107
    v_mfma_f32_16x16x32_bf16 v[180:183], a[24:27], v[152:155], v[180:183]
    v_cvt_pk_bf16_f32 v160, v224, v225
    v_cvt_pk_bf16_f32 v161, v226, v227
    v_mfma_f32_16x16x32_bf16 v[180:183], a[20:23], v[148:151], v[180:183]
    v_cvt_pk_bf16_f32 v162, v228, v229
    v_cvt_pk_bf16_f32 v163, v230, v231
    v_mfma_f32_16x16x32_bf16 v[180:183], a[16:19], v[144:147], v[180:183]
    v_lshlrev_b32 v104, 16, v108
    v_and_b32 v105, 0xffff0000, v108
    v_mfma_f32_16x16x32_bf16 v[184:187], a[32:35], v[144:147], v[120:123]
    v_lshlrev_b32 v106, 16, v109
    v_and_b32 v107, 0xffff0000, v109
    v_mfma_f32_16x16x32_bf16 v[184:187], a[36:39], v[148:151], v[184:187]
    v_lshlrev_b32 v108, 16, v110
    v_and_b32 v109, 0xffff0000, v110
    v_mfma_f32_16x16x32_bf16 v[184:187], a[40:43], v[152:155], v[184:187]
    v_mul_f32_dpp v224, v88, v56 row_ror:13 row_mask:0xf bank_mask:0xf
    v_mul_f32_dpp v225, v89, v57 row_ror:13 row_mask:0xf bank_mask:0xf
    v_mfma_f32_16x16x32_bf16 v[184:187], a[44:47], v[156:159], v[184:187]
    v_mul_f32_dpp v226, v90, v58 row_ror:13 row_mask:0xf bank_mask:0xf
    v_mul_f32_dpp v227, v91, v59 row_ror:13 row_mask:0xf bank_mask:0xf
    v_mfma_f32_16x16x32_bf16 v[188:191], a[60:63], v[156:159], v[124:127]
    v_mul_f32_dpp v228, v92, v60 row_ror:13 row_mask:0xf bank_mask:0xf
    v_mul_f32_dpp v229, v93, v61 row_ror:13 row_mask:0xf bank_mask:0xf
    v_mfma_f32_16x16x32_bf16 v[188:191], a[56:59], v[152:155], v[188:191]
    v_mul_f32_dpp v230, v94, v62 row_ror:13 row_mask:0xf bank_mask:0xf
    v_mul_f32_dpp v231, v95, v63 row_ror:13 row_mask:0xf bank_mask:0xf
    v_mfma_f32_16x16x32_bf16 v[188:191], a[52:55], v[148:151], v[188:191]
    v_cvt_pk_bf16_f32 v208, |v176|, |v177|
    v_cvt_pk_bf16_f32 v209, |v178|, |v179|
    v_mfma_f32_16x16x32_bf16 v[188:191], a[48:51], v[144:147], v[188:191]
    v_lshlrev_b32 v110, 16, v111
    v_cvt_pk_bf16_f32 v164, v224, v225
    v_mfma_f32_16x16x32_bf16 v[192:195], a[64:67], v[144:147], v[128:131]
    v_cvt_pk_bf16_f32 v165, v226, v227
    v_cvt_pk_bf16_f32 v166, v228, v229
    v_mfma_f32_16x16x32_bf16 v[192:195], a[68:71], v[148:151], v[192:195]
    v_cvt_pk_bf16_f32 v167, v230, v231
    v_and_b32 v111, 0xffff0000, v111
    v_mfma_f32_16x16x32_bf16 v[192:195], a[72:75], v[152:155], v[192:195]
    v_mul_f32_dpp v224, v96, v64 row_ror:13 row_mask:0xf bank_mask:0xf
    v_mul_f32_dpp v225, v97, v65 row_ror:13 row_mask:0xf bank_mask:0xf
    v_mfma_f32_16x16x32_bf16 v[192:195], a[76:79], v[156:159], v[192:195]
    v_mul_f32_dpp v226, v98, v66 row_ror:13 row_mask:0xf bank_mask:0xf
    v_mul_f32_dpp v227, v99, v67 row_ror:13 row_mask:0xf bank_mask:0xf
    v_mfma_f32_16x16x32_bf16 v[196:199], a[92:95], v[156:159], v[132:135]
    v_mul_f32_dpp v228, v100, v68 row_ror:13 row_mask:0xf bank_mask:0xf
    v_mul_f32_dpp v229, v101, v69 row_ror:13 row_mask:0xf bank_mask:0xf
    v_mfma_f32_16x16x32_bf16 v[196:199], a[88:91], v[152:155], v[196:199]
    v_mul_f32_dpp v230, v102, v70 row_ror:13 row_mask:0xf bank_mask:0xf
    v_mul_f32_dpp v231, v103, v71 row_ror:13 row_mask:0xf bank_mask:0xf
    v_mfma_f32_16x16x32_bf16 v[196:199], a[84:87], v[148:151], v[196:199]
    v_cvt_pk_bf16_f32 v168, v224, v225
    v_cvt_pk_bf16_f32 v169, v226, v227
    v_mfma_f32_16x16x32_bf16 v[196:199], a[80:83], v[144:147], v[196:199]
    v_cvt_pk_bf16_f32 v170, v228, v229
    v_cvt_pk_bf16_f32 v171, v230, v231
    v_mfma_f32_16x16x32_bf16 v[200:203], a[96:99], v[144:147], v[136:139]
    v_mul_f32_dpp v224, v104, v72 row_ror:13 row_mask:0xf bank_mask:0xf
    v_mul_f32_dpp v225, v105, v73 row_ror:13 row_mask:0xf bank_mask:0xf
    v_mfma_f32_16x16x32_bf16 v[200:203], a[100:103], v[148:151], v[200:203]
    v_mul_f32_dpp v226, v106, v74 row_ror:13 row_mask:0xf bank_mask:0xf
    v_mul_f32_dpp v227, v107, v75 row_ror:13 row_mask:0xf bank_mask:0xf
    v_mfma_f32_16x16x32_bf16 v[200:203], a[104:107], v[152:155], v[200:203]
    v_mul_f32_dpp v228, v108, v76 row_ror:13 row_mask:0xf bank_mask:0xf
    v_mul_f32_dpp v229, v109, v77 row_ror:13 row_mask:0xf bank_mask:0xf
    v_mfma_f32_16x16x32_bf16 v[200:203], a[108:111], v[156:159], v[200:203]
    v_mul_f32_dpp v230, v110, v78 row_ror:13 row_mask:0xf bank_mask:0xf
    v_mul_f32_dpp v231, v111, v79 row_ror:13 row_mask:0xf bank_mask:0xf
    v_mfma_f32_16x16x32_bf16 v[204:207], a[124:127], v[156:159], v[140:143]
    v_cvt_pk_bf16_f32 v172, v224, v225
    v_cvt_pk_bf16_f32 v173, v226, v227
    v_mfma_f32_16x16x32_bf16 v[204:207], a[120:123], v[152:155], v[204:207]
    v_cvt_pk_bf16_f32 v174, v228, v229
    v_cvt_pk_bf16_f32 v175, v230, v231
    v_mfma_f32_16x16x32_bf16 v[204:207], a[116:119], v[148:151], v[204:207]
    v_cvt_pk_bf16_f32 v210, |v180|, |v181|
    v_cvt_pk_bf16_f32 v211, |v182|, |v183|
    v_mfma_f32_16x16x32_bf16 v[204:207], a[112:115], v[144:147], v[204:207]
    v_cvt_pk_bf16_f32 v212, |v184|, |v185|
    v_cvt_pk_bf16_f32 v213, |v186|, |v187|
    v_mfma_f32_16x16x32_bf16 v[176:179], a[0:3], v[160:163], v[112:115]
    v_cvt_pk_bf16_f32 v214, |v188|, |v189|
    v_cvt_pk_bf16_f32 v215, |v190|, |v191|
    v_mfma_f32_16x16x32_bf16 v[176:179], a[4:7], v[164:167], v[176:179]
    v_cvt_pk_bf16_f32 v216, |v192|, |v193|
    v_cvt_pk_bf16_f32 v217, |v194|, |v195|
    v_mfma_f32_16x16x32_bf16 v[176:179], a[8:11], v[168:171], v[176:179]
    v_cvt_pk_bf16_f32 v218, |v196|, |v197|
    v_cvt_pk_bf16_f32 v219, |v198|, |v199|
    v_mfma_f32_16x16x32_bf16 v[176:179], a[12:15], v[172:175], v[176:179]
    v_cvt_pk_bf16_f32 v220, |v200|, |v201|
    v_cvt_pk_bf16_f32 v221, |v202|, |v203|
    v_smfmac_f32_16x16x64_bf16 v[248:251], a[128:131], v[208:215], v1
    v_cvt_pk_bf16_f32 v222, |v204|, |v205|
    v_mfma_f32_16x16x32_bf16 v[180:183], a[28:31], v[172:175], v[116:119]
    v_cvt_pk_bf16_f32 v223, |v206|, |v207|
    v_mul_f32_dpp v224, v80, v48 row_ror:5 row_mask:0xf bank_mask:0xf
    v_mfma_f32_16x16x32_bf16 v[180:183], a[24:27], v[168:171], v[180:183]
    v_mul_f32_dpp v225, v81, v49 row_ror:5 row_mask:0xf bank_mask:0xf
    v_mul_f32_dpp v226, v82, v50 row_ror:5 row_mask:0xf bank_mask:0xf
    v_mfma_f32_16x16x32_bf16 v[180:183], a[20:23], v[164:167], v[180:183]
    v_mul_f32_dpp v227, v83, v51 row_ror:5 row_mask:0xf bank_mask:0xf
    v_mul_f32_dpp v228, v84, v52 row_ror:5 row_mask:0xf bank_mask:0xf
    v_mfma_f32_16x16x32_bf16 v[180:183], a[16:19], v[160:163], v[180:183]
    v_mul_f32_dpp v229, v85, v53 row_ror:5 row_mask:0xf bank_mask:0xf
    v_mul_f32_dpp v230, v86, v54 row_ror:5 row_mask:0xf bank_mask:0xf
    v_smfmac_f32_16x16x64_bf16 v[248:251], a[132:135], v[216:223], v1
    v_mul_f32_dpp v231, v87, v55 row_ror:5 row_mask:0xf bank_mask:0xf
    v_mfma_f32_16x16x32_bf16 v[184:187], a[32:35], v[160:163], v[120:123]
    v_cvt_pk_bf16_f32 v144, v224, v225
    v_cvt_pk_bf16_f32 v145, v226, v227
    v_mfma_f32_16x16x32_bf16 v[184:187], a[36:39], v[164:167], v[184:187]
    v_cvt_pk_bf16_f32 v146, v228, v229
    v_cvt_pk_bf16_f32 v147, v230, v231
    v_mfma_f32_16x16x32_bf16 v[184:187], a[40:43], v[168:171], v[184:187]
    v_mul_f32_dpp v224, v88, v56 row_ror:5 row_mask:0xf bank_mask:0xf
    v_mul_f32_dpp v225, v89, v57 row_ror:5 row_mask:0xf bank_mask:0xf
    v_mfma_f32_16x16x32_bf16 v[184:187], a[44:47], v[172:175], v[184:187]
    v_mul_f32_dpp v226, v90, v58 row_ror:5 row_mask:0xf bank_mask:0xf
    v_mul_f32_dpp v227, v91, v59 row_ror:5 row_mask:0xf bank_mask:0xf
    v_smfmac_f32_16x16x64_bf16 v[248:251], a[152:155], v[160:167], v1
    v_mul_f32_dpp v228, v92, v60 row_ror:5 row_mask:0xf bank_mask:0xf
    v_mfma_f32_16x16x32_bf16 v[188:191], a[60:63], v[172:175], v[124:127]
    v_mul_f32_dpp v229, v93, v61 row_ror:5 row_mask:0xf bank_mask:0xf
    v_mul_f32_dpp v230, v94, v62 row_ror:5 row_mask:0xf bank_mask:0xf
    v_mfma_f32_16x16x32_bf16 v[188:191], a[56:59], v[168:171], v[188:191]
    v_mul_f32_dpp v231, v95, v63 row_ror:5 row_mask:0xf bank_mask:0xf
    v_cvt_pk_bf16_f32 v208, |v176|, |v177|
    v_mfma_f32_16x16x32_bf16 v[188:191], a[52:55], v[164:167], v[188:191]
    v_cvt_pk_bf16_f32 v209, |v178|, |v179|
    v_cvt_pk_bf16_f32 v148, v224, v225
    v_mfma_f32_16x16x32_bf16 v[188:191], a[48:51], v[160:163], v[188:191]
    v_cvt_pk_bf16_f32 v149, v226, v227
    v_cvt_pk_bf16_f32 v150, v228, v229
    v_smfmac_f32_16x16x64_bf16 v[248:251], a[156:159], v[168:175], v1
    v_cvt_pk_bf16_f32 v151, v230, v231
    v_mfma_f32_16x16x32_bf16 v[192:195], a[64:67], v[160:163], v[128:131]
    v_mul_f32_dpp v224, v96, v64 row_ror:5 row_mask:0xf bank_mask:0xf
    v_mul_f32_dpp v225, v97, v65 row_ror:5 row_mask:0xf bank_mask:0xf
    v_mfma_f32_16x16x32_bf16 v[192:195], a[68:71], v[164:167], v[192:195]
    v_mul_f32_dpp v226, v98, v66 row_ror:5 row_mask:0xf bank_mask:0xf
    v_mul_f32_dpp v227, v99, v67 row_ror:5 row_mask:0xf bank_mask:0xf
    v_mfma_f32_16x16x32_bf16 v[192:195], a[72:75], v[168:171], v[192:195]
    v_mul_f32_dpp v228, v100, v68 row_ror:5 row_mask:0xf bank_mask:0xf
    v_mul_f32_dpp v229, v101, v69 row_ror:5 row_mask:0xf bank_mask:0xf
    v_mfma_f32_16x16x32_bf16 v[192:195], a[76:79], v[172:175], v[192:195]
    v_mul_f32_dpp v230, v102, v70 row_ror:5 row_mask:0xf bank_mask:0xf
    v_mul_f32_dpp v231, v103, v71 row_ror:5 row_mask:0xf bank_mask:0xf
    v_mfma_f32_16x16x32_bf16 v[196:199], a[92:95], v[172:175], v[132:135]
    v_cvt_pk_bf16_f32 v152, v224, v225
    v_cvt_pk_bf16_f32 v153, v226, v227
    v_mfma_f32_16x16x32_bf16 v[196:199], a[88:91], v[168:171], v[196:199]
    v_cvt_pk_bf16_f32 v154, v228, v229
    v_cvt_pk_bf16_f32 v155, v230, v231
    v_mfma_f32_16x16x32_bf16 v[196:199], a[84:87], v[164:167], v[196:199]
    v_mul_f32_dpp v224, v104, v72 row_ror:5 row_mask:0xf bank_mask:0xf
    v_mul_f32_dpp v225, v105, v73 row_ror:5 row_mask:0xf bank_mask:0xf
    v_mfma_f32_16x16x32_bf16 v[196:199], a[80:83], v[160:163], v[196:199]
    v_mul_f32_dpp v226, v106, v74 row_ror:5 row_mask:0xf bank_mask:0xf
    v_mul_f32_dpp v227, v107, v75 row_ror:5 row_mask:0xf bank_mask:0xf
    v_mfma_f32_16x16x32_bf16 v[200:203], a[96:99], v[160:163], v[136:139]
    v_mul_f32_dpp v228, v108, v76 row_ror:5 row_mask:0xf bank_mask:0xf
    v_mul_f32_dpp v229, v109, v77 row_ror:5 row_mask:0xf bank_mask:0xf
    v_mfma_f32_16x16x32_bf16 v[200:203], a[100:103], v[164:167], v[200:203]
L_stub3:
    s_cbranch_scc1 L_main2
    v_mul_f32_dpp v230, v110, v78 row_ror:5 row_mask:0xf bank_mask:0xf
    v_mul_f32_dpp v231, v111, v79 row_ror:5 row_mask:0xf bank_mask:0xf
    v_mfma_f32_16x16x32_bf16 v[200:203], a[104:107], v[168:171], v[200:203]
    v_cvt_pk_bf16_f32 v156, v224, v225
    v_cvt_pk_bf16_f32 v157, v226, v227
    v_mfma_f32_16x16x32_bf16 v[200:203], a[108:111], v[172:175], v[200:203]
    v_cvt_pk_bf16_f32 v158, v228, v229
    v_cvt_pk_bf16_f32 v159, v230, v231
    v_mfma_f32_16x16x32_bf16 v[204:207], a[124:127], v[172:175], v[140:143]
    v_cvt_pk_bf16_f32 v210, |v180|, |v181|
    v_cvt_pk_bf16_f32 v211, |v182|, |v183|
    v_mfma_f32_16x16x32_bf16 v[204:207], a[120:123], v[168:171], v[204:207]
    v_cvt_pk_bf16_f32 v212, |v184|, |v185|
    v_cvt_pk_bf16_f32 v213, |v186|, |v187|
    v_mfma_f32_16x16x32_bf16 v[204:207], a[116:119], v[164:167], v[204:207]
    v_cvt_pk_bf16_f32 v214, |v188|, |v189|
    v_cvt_pk_bf16_f32 v215, |v190|, |v191|
    v_mfma_f32_16x16x32_bf16 v[204:207], a[112:115], v[160:163], v[204:207]
    v_cvt_pk_bf16_f32 v216, |v192|, |v193|
    v_cvt_pk_bf16_f32 v217, |v194|, |v195|
    v_smfmac_f32_16x16x64_bf16 v[248:251], a[144:147], v[208:215], v1
    v_cvt_pk_bf16_f32 v218, |v196|, |v197|
    v_mfma_f32_16x16x32_bf16 v[176:179], a[0:3], v[144:147], v[112:115]
    v_cvt_pk_bf16_f32 v219, |v198|, |v199|
    v_cvt_pk_bf16_f32 v220, |v200|, |v201|
    v_mfma_f32_16x16x32_bf16 v[176:179], a[4:7], v[148:151], v[176:179]
    v_cvt_pk_bf16_f32 v221, |v202|, |v203|
    v_cvt_pk_bf16_f32 v222, |v204|, |v205|
    v_mfma_f32_16x16x32_bf16 v[176:179], a[8:11], v[152:155], v[176:179]
    v_cvt_pk_bf16_f32 v223, |v206|, |v207|
    v_mul_f32 v224, v80, v48
    v_mfma_f32_16x16x32_bf16 v[176:179], a[12:15], v[156:159], v[176:179]
    v_mul_f32 v225, v81, v49
    v_mul_f32 v226, v82, v50
    v_smfmac_f32_16x16x64_bf16 v[248:251], a[148:151], v[216:223], v1
    v_mul_f32 v227, v83, v51
    v_mfma_f32_16x16x32_bf16 v[180:183], a[28:31], v[156:159], v[116:119]
    v_mul_f32 v228, v84, v52
    v_mul_f32 v229, v85, v53
    v_mfma_f32_16x16x32_bf16 v[180:183], a[24:27], v[152:155], v[180:183]
    v_mul_f32 v230, v86, v54
    v_mul_f32 v231, v87, v55
    v_mfma_f32_16x16x32_bf16 v[180:183], a[20:23], v[148:151], v[180:183]
    v_cvt_pk_bf16_f32 v160, v224, v225
    v_cvt_pk_bf16_f32 v161, v226, v227
    v_mfma_f32_16x16x32_bf16 v[180:183], a[16:19], v[144:147], v[180:183]
    v_cvt_pk_bf16_f32 v162, v228, v229
    v_cvt_pk_bf16_f32 v163, v230, v231
    v_smfmac_f32_16x16x64_bf16 v[248:251], a[168:171], v[144:151], v1
    v_mul_f32 v224, v88, v56
    v_mfma_f32_16x16x32_bf16 v[184:187], a[32:35], v[144:147], v[120:123]
    v_mul_f32 v225, v89, v57
    v_mul_f32 v226, v90, v58
    v_mfma_f32_16x16x32_bf16 v[184:187], a[36:39], v[148:151], v[184:187]
    v_mul_f32 v227, v91, v59
    v_mul_f32 v228, v92, v60
    v_mfma_f32_16x16x32_bf16 v[184:187], a[40:43], v[152:155], v[184:187]
    v_mul_f32 v229, v93, v61
    v_mul_f32 v230, v94, v62
    v_mfma_f32_16x16x32_bf16 v[184:187], a[44:47], v[156:159], v[184:187]
    v_mul_f32 v231, v95, v63
    v_cvt_pk_bf16_f32 v208, |v176|, |v177|
    v_smfmac_f32_16x16x64_bf16 v[248:251], a[172:175], v[152:159], v1
    v_cvt_pk_bf16_f32 v209, |v178|, |v179|
    v_mfma_f32_16x16x32_bf16 v[188:191], a[60:63], v[156:159], v[124:127]
    v_cvt_pk_bf16_f32 v164, v224, v225
    v_cvt_pk_bf16_f32 v165, v226, v227
    v_mfma_f32_16x16x32_bf16 v[188:191], a[56:59], v[152:155], v[188:191]
    v_cvt_pk_bf16_f32 v166, v228, v229
    v_cvt_pk_bf16_f32 v167, v230, v231
    v_mfma_f32_16x16x32_bf16 v[188:191], a[52:55], v[148:151], v[188:191]
    v_mul_f32 v224, v96, v64
    v_mul_f32 v225, v97, v65
    v_mfma_f32_16x16x32_bf16 v[188:191], a[48:51], v[144:147], v[188:191]
    v_mul_f32 v226, v98, v66
    v_mul_f32 v227, v99, v67
    v_mfma_f32_16x16x32_bf16 v[192:195], a[64:67], v[144:147], v[128:131]
    v_mul_f32 v228, v100, v68
    v_mul_f32 v229, v101, v69
    v_mfma_f32_16x16x32_bf16 v[192:195], a[68:71], v[148:151], v[192:195]
    v_mul_f32 v230, v102, v70
    v_mul_f32 v231, v103, v71
    v_mfma_f32_16x16x32_bf16 v[192:195], a[72:75], v[152:155], v[192:195]
    v_cvt_pk_bf16_f32 v168, v224, v225
    v_cvt_pk_bf16_f32 v169, v226, v227
    v_mfma_f32_16x16x32_bf16 v[192:195], a[76:79], v[156:159], v[192:195]
    v_cvt_pk_bf16_f32 v170, v228, v229
    v_cvt_pk_bf16_f32 v171, v230, v231
    v_mfma_f32_16x16x32_bf16 v[196:199], a[92:95], v[156:159], v[132:135]
    v_mul_f32 v224, v104, v72
    v_mul_f32 v225, v105, v73
    v_mfma_f32_16x16x32_bf16 v[196:199], a[88:91], v[152:155], v[196:199]
    v_mul_f32 v226, v106, v74
    v_mul_f32 v227, v107, v75
    v_mfma_f32_16x16x32_bf16 v[196:199], a[84:87], v[148:151], v[196:199]
    v_mul_f32 v228, v108, v76
    v_mul_f32 v229, v109, v77
    v_mfma_f32_16x16x32_bf16 v[196:199], a[80:83], v[144:147], v[196:199]
    v_mul_f32 v230, v110, v78
    v_mul_f32 v231, v111, v79
    v_mfma_f32_16x16x32_bf16 v[200:203], a[96:99], v[144:147], v[136:139]
    v_cvt_pk_bf16_f32 v172, v224, v225
    v_cvt_pk_bf16_f32 v173, v226, v227
    v_mfma_f32_16x16x32_bf16 v[200:203], a[100:103], v[148:151], v[200:203]
    v_cvt_pk_bf16_f32 v174, v228, v229
    v_cvt_pk_bf16_f32 v175, v230, v231
    v_mfma_f32_16x16x32_bf16 v[200:203], a[104:107], v[152:155], v[200:203]
    v_cvt_pk_bf16_f32 v210, |v180|, |v181|
    v_cvt_pk_bf16_f32 v211, |v182|, |v183|
    v_mfma_f32_16x16x32_bf16 v[200:203], a[108:111], v[156:159], v[200:203]
    v_cvt_pk_bf16_f32 v212, |v184|, |v185|
    v_cvt_pk_bf16_f32 v213, |v186|, |v187|
    v_mfma_f32_16x16x32_bf16 v[204:207], a[124:127], v[156:159], v[140:143]
    v_cvt_pk_bf16_f32 v214, |v188|, |v189|
    v_cvt_pk_bf16_f32 v215, |v190|, |v191|
    v_mfma_f32_16x16x32_bf16 v[204:207], a[120:123], v[152:155], v[204:207]
    v_cvt_pk_bf16_f32 v216, |v192|, |v193|
    v_cvt_pk_bf16_f32 v217, |v194|, |v195|
    v_mfma_f32_16x16x32_bf16 v[204:207], a[116:119], v[148:151], v[204:207]
    v_cvt_pk_bf16_f32 v218, |v196|, |v197|
    v_cvt_pk_bf16_f32 v219, |v198|, |v199|
    v_mfma_f32_16x16x32_bf16 v[204:207], a[112:115], v[144:147], v[204:207]
    v_cvt_pk_bf16_f32 v220, |v200|, |v201|
    v_cvt_pk_bf16_f32 v221, |v202|, |v203|
    v_smfmac_f32_16x16x64_bf16 v[248:251], a[160:163], v[208:215], v1
    v_mul_f32_dpp v224, v16, v16 row_ror:8 row_mask:0xf bank_mask:0xf
    v_mfma_f32_16x16x32_bf16 v[176:179], a[0:3], v[160:163], v[112:115]
    v_mul_f32_dpp v225, v17, v17 row_ror:8 row_mask:0xf bank_mask:0xf
    v_mul_f32_dpp v226, v18, v18 row_ror:8 row_mask:0xf bank_mask:0xf
    v_mfma_f32_16x16x32_bf16 v[176:179], a[4:7], v[164:167], v[176:179]
    v_cvt_pk_bf16_f32 v222, |v204|, |v205|
    v_cvt_pk_bf16_f32 v223, |v206|, |v207|
    v_mfma_f32_16x16x32_bf16 v[176:179], a[8:11], v[168:171], v[176:179]
    v_mul_f32_dpp v227, v19, v19 row_ror:8 row_mask:0xf bank_mask:0xf
    v_mul_f32_dpp v228, v20, v20 row_ror:8 row_mask:0xf bank_mask:0xf
    v_mfma_f32_16x16x32_bf16 v[176:179], a[12:15], v[172:175], v[176:179]
    v_mul_f32_dpp v229, v21, v21 row_ror:8 row_mask:0xf bank_mask:0xf
    v_mul_f32_dpp v230, v22, v22 row_ror:8 row_mask:0xf bank_mask:0xf
    v_smfmac_f32_16x16x64_bf16 v[248:251], a[164:167], v[216:223], v1
    v_mul_f32_dpp v231, v23, v23 row_ror:8 row_mask:0xf bank_mask:0xf
    v_mfma_f32_16x16x32_bf16 v[180:183], a[28:31], v[172:175], v[116:119]
    v_cvt_pk_bf16_f32 v144, v224, v225
    v_cvt_pk_bf16_f32 v145, v226, v227
    v_mfma_f32_16x16x32_bf16 v[180:183], a[24:27], v[168:171], v[180:183]
    v_cvt_pk_bf16_f32 v146, v228, v229
    v_cvt_pk_bf16_f32 v147, v230, v231
    v_mfma_f32_16x16x32_bf16 v[180:183], a[20:23], v[164:167], v[180:183]
    v_mul_f32_dpp v224, v24, v24 row_ror:8 row_mask:0xf bank_mask:0xf
    v_mul_f32_dpp v225, v25, v25 row_ror:8 row_mask:0xf bank_mask:0xf
    v_mfma_f32_16x16x32_bf16 v[180:183], a[16:19], v[160:163], v[180:183]
    v_mul_f32_dpp v226, v26, v26 row_ror:8 row_mask:0xf bank_mask:0xf
    v_mul_f32_dpp v227, v27, v27 row_ror:8 row_mask:0xf bank_mask:0xf
    v_smfmac_f32_16x16x64_bf16 v[248:251], a[184:187], v[160:167], v1
    v_mul_f32_dpp v228, v28, v28 row_ror:8 row_mask:0xf bank_mask:0xf
    v_mfma_f32_16x16x32_bf16 v[184:187], a[32:35], v[160:163], v[120:123]
    v_mul_f32_dpp v229, v29, v29 row_ror:8 row_mask:0xf bank_mask:0xf
    v_mul_f32_dpp v230, v30, v30 row_ror:8 row_mask:0xf bank_mask:0xf
    v_mfma_f32_16x16x32_bf16 v[184:187], a[36:39], v[164:167], v[184:187]
    v_mul_f32_dpp v231, v31, v31 row_ror:8 row_mask:0xf bank_mask:0xf
    v_cvt_pk_bf16_f32 v208, |v176|, |v177|
    v_mfma_f32_16x16x32_bf16 v[184:187], a[40:43], v[168:171], v[184:187]
    v_cvt_pk_bf16_f32 v209, |v178|, |v179|
    v_cvt_pk_bf16_f32 v148, v224, v225
    v_mfma_f32_16x16x32_bf16 v[184:187], a[44:47], v[172:175], v[184:187]
    v_cvt_pk_bf16_f32 v149, v226, v227
    v_cvt_pk_bf16_f32 v150, v228, v229
    v_smfmac_f32_16x16x64_bf16 v[248:251], a[188:191], v[168:175], v1
    v_cvt_pk_bf16_f32 v151, v230, v231
    v_mfma_f32_16x16x32_bf16 v[188:191], a[60:63], v[172:175], v[124:127]
    v_mul_f32_dpp v224, v32, v32 row_ror:8 row_mask:0xf bank_mask:0xf
    v_mul_f32_dpp v225, v33, v33 row_ror:8 row_mask:0xf bank_mask:0xf
    v_mfma_f32_16x16x32_bf16 v[188:191], a[56:59], v[168:171], v[188:191]
    v_mul_f32_dpp v226, v34, v34 row_ror:8 row_mask:0xf bank_mask:0xf
    v_mul_f32_dpp v227, v35, v35 row_ror:8 row_mask:0xf bank_mask:0xf
    v_mfma_f32_16x16x32_bf16 v[188:191], a[52:55], v[164:167], v[188:191]
    v_mul_f32_dpp v228, v36, v36 row_ror:8 row_mask:0xf bank_mask:0xf
    v_mul_f32_dpp v229, v37, v37 row_ror:8 row_mask:0xf bank_mask:0xf
    v_mfma_f32_16x16x32_bf16 v[188:191], a[48:51], v[160:163], v[188:191]
    v_mul_f32_dpp v230, v38, v38 row_ror:8 row_mask:0xf bank_mask:0xf
    v_mul_f32_dpp v231, v39, v39 row_ror:8 row_mask:0xf bank_mask:0xf
    v_smfmac_f32_16x16x64_bf16 v[252:255], a[136:139], v[144:151], v1
    v_cvt_pk_bf16_f32 v152, v224, v225
    v_mfma_f32_16x16x32_bf16 v[192:195], a[64:67], v[160:163], v[128:131]
    v_cvt_pk_bf16_f32 v153, v226, v227
    v_cvt_pk_bf16_f32 v154, v228, v229
    v_mfma_f32_16x16x32_bf16 v[192:195], a[68:71], v[164:167], v[192:195]
    v_cvt_pk_bf16_f32 v155, v230, v231
    v_mul_f32_dpp v224, v40, v40 row_ror:8 row_mask:0xf bank_mask:0xf
    v_mfma_f32_16x16x32_bf16 v[192:195], a[72:75], v[168:171], v[192:195]
    v_mul_f32_dpp v225, v41, v41 row_ror:8 row_mask:0xf bank_mask:0xf
    v_mul_f32_dpp v226, v42, v42 row_ror:8 row_mask:0xf bank_mask:0xf
    v_mfma_f32_16x16x32_bf16 v[192:195], a[76:79], v[172:175], v[192:195]
    v_mul_f32_dpp v227, v43, v43 row_ror:8 row_mask:0xf bank_mask:0xf
    v_mul_f32_dpp v228, v44, v44 row_ror:8 row_mask:0xf bank_mask:0xf
    v_mfma_f32_16x16x32_bf16 v[196:199], a[92:95], v[172:175], v[132:135]
    v_mul_f32_dpp v229, v45, v45 row_ror:8 row_mask:0xf bank_mask:0xf
    v_mul_f32_dpp v230, v46, v46 row_ror:8 row_mask:0xf bank_mask:0xf
    v_mfma_f32_16x16x32_bf16 v[196:199], a[88:91], v[168:171], v[196:199]
    v_mul_f32_dpp v231, v47, v47 row_ror:8 row_mask:0xf bank_mask:0xf
    v_cvt_pk_bf16_f32 v156, v224, v225
    v_mfma_f32_16x16x32_bf16 v[196:199], a[84:87], v[164:167], v[196:199]
    v_cvt_pk_bf16_f32 v157, v226, v227
    v_cvt_pk_bf16_f32 v158, v228, v229
    v_mfma_f32_16x16x32_bf16 v[196:199], a[80:83], v[160:163], v[196:199]
    v_cvt_pk_bf16_f32 v159, v230, v231
    v_cvt_pk_bf16_f32 v210, |v180|, |v181|
    v_mfma_f32_16x16x32_bf16 v[200:203], a[96:99], v[160:163], v[136:139]
    v_cvt_pk_bf16_f32 v211, |v182|, |v183|
    v_cvt_pk_bf16_f32 v212, |v184|, |v185|
    v_mfma_f32_16x16x32_bf16 v[200:203], a[100:103], v[164:167], v[200:203]
    v_cvt_pk_bf16_f32 v213, |v186|, |v187|
    v_cvt_pk_bf16_f32 v214, |v188|, |v189|
    v_mfma_f32_16x16x32_bf16 v[200:203], a[104:107], v[168:171], v[200:203]
    v_cvt_pk_bf16_f32 v215, |v190|, |v191|
    v_cvt_pk_bf16_f32 v216, |v192|, |v193|
    v_mfma_f32_16x16x32_bf16 v[200:203], a[108:111], v[172:175], v[200:203]
    v_cvt_pk_bf16_f32 v217, |v194|, |v195|
    v_cvt_pk_bf16_f32 v218, |v196|, |v197|
    v_smfmac_f32_16x16x64_bf16 v[248:251], a[176:179], v[208:215], v1
    v_cvt_pk_bf16_f32 v219, |v198|, |v199|
    v_mfma_f32_16x16x32_bf16 v[204:207], a[124:127], v[172:175], v[140:143]
    v_add_f32 v232, v232, v233
    v_add_f32 v236, v236, v237
    v_mfma_f32_16x16x32_bf16 v[204:207], a[120:123], v[168:171], v[204:207]
    v_cvt_pk_bf16_f32 v220, |v200|, |v201|
    v_cvt_pk_bf16_f32 v221, |v202|, |v203|
    v_mfma_f32_16x16x32_bf16 v[204:207], a[116:119], v[164:167], v[204:207]
    v_add_f32 v240, v240, v241
    v_max3_f32 v12, v232, v236, v240
    v_mfma_f32_16x16x32_bf16 v[204:207], a[112:115], v[160:163], v[204:207]
    v_add_f32 v244, v244, v245
    v_add_f32 v234, v234, v235
    v_smfmac_f32_16x16x64_bf16 v[252:255], a[140:143], v[152:159], v1
    v_add_f32 v238, v238, v239
    v_mfma_f32_16x16x32_bf16 v[176:179], a[0:3], v[144:147], v[112:115]
    v_add_f32 v242, v242, v243
    v_add_f32 v246, v246, v247
    v_mfma_f32_16x16x32_bf16 v[176:179], a[4:7], v[148:151], v[176:179]
    v_cvt_pk_bf16_f32 v222, |v204|, |v205|
    v_cvt_pk_bf16_f32 v223, |v206|, |v207|
    v_mfma_f32_16x16x32_bf16 v[176:179], a[8:11], v[152:155], v[176:179]
    v_mfma_f32_16x16x32_bf16 v[176:179], a[12:15], v[156:159], v[176:179]
    v_smfmac_f32_16x16x64_bf16 v[248:251], a[180:183], v[216:223], v1
    v_mfma_f32_16x16x32_bf16 v[180:183], a[28:31], v[156:159], v[116:119]
    v_mfma_f32_16x16x32_bf16 v[180:183], a[24:27], v[152:155], v[180:183]
    v_mfma_f32_16x16x32_bf16 v[180:183], a[20:23], v[148:151], v[180:183]
    v_mfma_f32_16x16x32_bf16 v[180:183], a[16:19], v[144:147], v[180:183]
    v_mfma_f32_16x16x32_bf16 v[184:187], a[32:35], v[144:147], v[120:123]
    v_mfma_f32_16x16x32_bf16 v[184:187], a[36:39], v[148:151], v[184:187]
    v_mfma_f32_16x16x32_bf16 v[184:187], a[40:43], v[152:155], v[184:187]
    v_cvt_pk_bf16_f32 v208, |v176|, |v177|
    v_add_f32 v248, v248, v249
    v_mfma_f32_16x16x32_bf16 v[184:187], a[44:47], v[156:159], v[184:187]
    v_max3_f32 v12, v12, v244, v248
    v_mul_f32 v2, v12, v10
    v_mfma_f32_16x16x32_bf16 v[188:191], a[60:63], v[156:159], v[124:127]
    v_max_f32_dpp v12, v12, v12 row_ror:8 row_mask:0xf bank_mask:0xf
    v_cvt_pk_bf16_f32 v209, |v178|, |v179|
    v_mfma_f32_16x16x32_bf16 v[188:191], a[56:59], v[152:155], v[188:191]
    v_max_f32_dpp v12, v12, v12 row_ror:4 row_mask:0xf bank_mask:0xf
    v_cvt_pk_bf16_f32 v210, |v180|, |v181|
    v_mfma_f32_16x16x32_bf16 v[188:191], a[52:55], v[148:151], v[188:191]
    v_max_f32_dpp v12, v12, v12 row_ror:2 row_mask:0xf bank_mask:0xf
    v_cvt_pk_bf16_f32 v211, |v182|, |v183|
    v_mfma_f32_16x16x32_bf16 v[188:191], a[48:51], v[144:147], v[188:191]
    v_max_f32_dpp v12, v12, v12 row_ror:1 row_mask:0xf bank_mask:0xf
    v_cvt_pk_bf16_f32 v212, |v184|, |v185|
    v_mfma_f32_16x16x32_bf16 v[192:195], a[64:67], v[144:147], v[128:131]
    v_cvt_pk_bf16_f32 v213, |v186|, |v187|
    v_max_f32_dpp v12, v12, v12 row_bcast:15 row_mask:0xa bank_mask:0xf
    v_mfma_f32_16x16x32_bf16 v[192:195], a[68:71], v[148:151], v[192:195]
    v_fma_f32 v232, v232, v10, -v2
    v_max_f32_dpp v12, v12, v12 row_bcast:31 row_mask:0xc bank_mask:0xf
    v_mfma_f32_16x16x32_bf16 v[192:195], a[72:75], v[152:155], v[192:195]
    v_cvt_pk_bf16_f32 v214, |v188|, |v189|
    v_cvt_pk_bf16_f32 v215, |v190|, |v191|
    v_mfma_f32_16x16x32_bf16 v[192:195], a[76:79], v[156:159], v[192:195]
    v_readlane_b32 s14, v12, 63
    v_fma_f32 v236, v236, v10, -v2
    v_smfmac_f32_16x16x64_bf16 v[252:255], a[128:131], v[208:215], v1
    v_exp_f32 v232, v232
    v_mfma_f32_16x16x32_bf16 v[196:199], a[92:95], v[156:159], v[132:135]
    v_exp_f32 v236, v236
    v_mfma_f32_16x16x32_bf16 v[196:199], a[88:91], v[152:155], v[196:199]
    v_fma_f32 v240, v240, v10, -v2
    v_exp_f32 v240, v240
    v_mfma_f32_16x16x32_bf16 v[196:199], a[84:87], v[148:151], v[196:199]
    v_fma_f32 v244, v244, v10, -v2
    v_cvt_pk_bf16_f32 v216, |v192|, |v193|
    v_mfma_f32_16x16x32_bf16 v[196:199], a[80:83], v[144:147], v[196:199]
    v_cvt_pk_bf16_f32 v217, |v194|, |v195|
    v_mul_f32 v13, s14, v10
    v_mfma_f32_16x16x32_bf16 v[200:203], a[96:99], v[144:147], v[136:139]
    v_exp_f32 v244, v244
    v_mfma_f32_16x16x32_bf16 v[200:203], a[100:103], v[148:151], v[200:203]
    v_fma_f32 v248, v248, v10, -v2
    v_add_f32 v14, v232, v236
    v_mfma_f32_16x16x32_bf16 v[200:203], a[104:107], v[152:155], v[200:203]
    v_cvt_pk_bf16_f32 v218, |v196|, |v197|
    v_cvt_pk_bf16_f32 v219, |v198|, |v199|
    v_mfma_f32_16x16x32_bf16 v[200:203], a[108:111], v[156:159], v[200:203]
    v_sub_f32 v3, v2, v13
    v_exp_f32 v248, v248
    v_mfma_f32_16x16x32_bf16 v[204:207], a[124:127], v[156:159], v[140:143]
    v_mul_f32 v15, v232, v234
    v_add_f32 v14, v14, v240
    v_mfma_f32_16x16x32_bf16 v[204:207], a[120:123], v[152:155], v[204:207]
    v_exp_f32 v3, v3
    v_mfma_f32_16x16x32_bf16 v[204:207], a[116:119], v[148:151], v[204:207]
    v_cvt_pk_bf16_f32 v220, |v200|, |v201|
    v_cvt_pk_bf16_f32 v221, |v202|, |v203|
    v_mfma_f32_16x16x32_bf16 v[204:207], a[112:115], v[144:147], v[204:207]
    v_fmac_f32 v15, v236, v238
    v_add_f32 v14, v14, v244
    v_fmac_f32 v15, v240, v242
    v_add_f32 v14, v14, v248
    v_add_f32 v250, v250, v251
    v_fmac_f32 v15, v244, v246
    v_mul_f32 v14, v14, v3
    v_fmac_f32 v15, v248, v250
    v_cvt_pk_bf16_f32 v222, |v204|, |v205|
    v_cvt_pk_bf16_f32 v223, |v206|, |v207|
    v_mul_f32 v15, v15, v3
    v_add_f32_dpp v14, v14, v14 row_ror:8 row_mask:0xf bank_mask:0xf
    v_smfmac_f32_16x16x64_bf16 v[252:255], a[132:135], v[216:223], v1
    v_add_f32_dpp v15, v15, v15 row_ror:8 row_mask:0xf bank_mask:0xf
    v_add_f32_dpp v14, v14, v14 row_ror:4 row_mask:0xf bank_mask:0xf
    s_nop 0
    v_add_f32_dpp v15, v15, v15 row_ror:4 row_mask:0xf bank_mask:0xf
    v_add_f32_dpp v14, v14, v14 row_ror:2 row_mask:0xf bank_mask:0xf
    s_nop 0
    v_add_f32_dpp v15, v15, v15 row_ror:2 row_mask:0xf bank_mask:0xf
    v_add_f32_dpp v14, v14, v14 row_ror:1 row_mask:0xf bank_mask:0xf
    v_add_f32 v252, v252, v253
    v_max_f32 v6, s14, v252
    v_add_f32_dpp v15, v15, v15 row_ror:1 row_mask:0xf bank_mask:0xf
    v_add_f32 v254, v254, v255
    v_max_f32_dpp v6, v6, v6 row_ror:4 row_mask:0xf bank_mask:0xf
    v_add_f32_dpp v14, v14, v14 row_bcast:15 row_mask:0xa bank_mask:0xf
    v_add_f32_dpp v15, v15, v15 row_bcast:15 row_mask:0xa bank_mask:0xf
    v_max_f32_dpp v6, v6, v6 row_ror:2 row_mask:0xf bank_mask:0xf
    v_add_f32_dpp v14, v14, v14 row_bcast:31 row_mask:0xc bank_mask:0xf
    v_add_f32_dpp v15, v15, v15 row_bcast:31 row_mask:0xc bank_mask:0xf
    v_max_f32_dpp v6, v6, v6 row_ror:1 row_mask:0xf bank_mask:0xf
    v_mul_f32 v4, v6, v10
    v_fma_f32 v252, v252, v10, -v4
    v_exp_f32 v252, v252
    v_readlane_b32 s15, v14, 63
    v_mul_f32 v254, v252, v254
    v_add_f32_dpp v252, v252, v252 row_ror:4 row_mask:0xf bank_mask:0xf
    v_sub_f32 v5, v13, v4
    v_add_f32_dpp v254, v254, v254 row_ror:4 row_mask:0xf bank_mask:0xf
    v_add_f32_dpp v252, v252, v252 row_ror:2 row_mask:0xf bank_mask:0xf
    v_exp_f32 v5, v5
    v_add_f32_dpp v254, v254, v254 row_ror:2 row_mask:0xf bank_mask:0xf
    v_readlane_b32 s34, v15, 63
    v_add_f32_dpp v252, v252, v252 row_ror:1 row_mask:0xf bank_mask:0xf
    v_fmac_f32 v252, s15, v5
    v_add_f32_dpp v254, v254, v254 row_ror:1 row_mask:0xf bank_mask:0xf
    v_rcp_f32 v252, v252
    v_fmac_f32 v254, s34, v5
    v_mul_f32 v254, v254, v252
    v_cvt_pk_bf16_f32 v254, v254, v254
    buffer_store_short v254, v11, s[36:39], 0 offen
L_end:
s_endpgm
.section .rodata,"a"
.p2align 6
.amdhsa_kernel standalone__factorization_afm__recsys_kernel
  .amdhsa_next_free_vgpr 448
  .amdhsa_next_free_sgpr 102
  .amdhsa_accum_offset 256
  .amdhsa_group_segment_fixed_size 0
  .amdhsa_kernarg_size 88
  .amdhsa_user_sgpr_count 2
  .amdhsa_user_sgpr_kernarg_segment_ptr 1
  .amdhsa_system_sgpr_workgroup_id_x 1
  .amdhsa_float_denorm_mode_32 3
.end_amdhsa_kernel
```

```asm
; @launch grid=(256,1,1) block=(256,1,1) lds=67200
.amdgcn_target "amdgcn-amd-amdhsa--gfx950"
.text
.globl standalone__factorization_afm__recsys_kernel
.p2align 8
.type standalone__factorization_afm__recsys_kernel,@function
standalone__factorization_afm__recsys_kernel:
    s_load_dwordx16 s[16:31], s[0:1], 0
    s_load_dwordx2 s[36:37], s[0:1], 64
    s_cmp_ge_u32 s2, 256
    s_cbranch_scc1 L_end
    s_getpc_b64 s[10:11]
L_pc:
    s_lshl_b32 s8, s2, 8
    v_lshrrev_b32 v70, 6, v0
    v_and_b32 v69, 3, v0
    v_lshl_or_b32 v69, v70, 2, v69
    s_and_b32 s8, s8, 0x7800
    v_lshl_or_b32 v69, v69, 7, s8
    v_min_u32 v69, L_end-L_pc, v69
    global_load_dword v72, v69, s[10:11]
    v_lshrrev_b32 v70, 6, v0
    v_and_b32 v50, 15, v0
    v_readfirstlane_b32 s3, v70
    v_bfe_u32 v51, v0, 4, 2
    v_and_b32 v52, 63, v0
    s_and_b32 s4, s2, 7
    s_lshl_b32 s4, s4, 7
    s_lshr_b32 s6, s2, 3
    s_lshl_b32 s6, s6, 2
    s_add_u32 s4, s4, s6
    s_add_u32 s4, s4, s3
    s_mul_i32 s6, s4, 104
    v_and_b32 v53, 0x38, v0
    v_add_u32 v53, s6, v53
    v_mul_u32_u24 v62, 12, v51
    v_min_u32 v62, 28, v62
    v_add_u32 v62, s6, v62
    s_mul_i32 s9, s3, 8448
    v_and_b32 v69, 2, v51
    v_add_u32 v69, v69, v51
    v_lshlrev_b32 v70, 4, v50
    v_lshl_add_u32 v56, v69, 10, v70
    s_bfe_u32 s8, s2, 0x30003
    s_mul_i32 s44, s8, 1056
    s_and_b32 s12, s8, 4
    s_add_u32 s12, s12, s8
    s_lshl_b32 s7, s3, 5
    s_add_u32 s12, s12, s7
    s_lshl_b32 s45, s12, 8
    s_add_u32 m0, s44, s9
    v_lshlrev_b32 v54, 2, v52
    s_mul_i32 s5, s3, 7616
    s_add_u32 s5, s5, 36736
    s_mov_b32 s42, 25600000
    s_mov_b32 s43, 0x00020000
    s_mov_b32 s54, 32768
    s_mov_b32 s55, 0x00020000
    s_mov_b32 s38, 2048
    s_mov_b32 s39, 0x00020000
    s_mov_b32 s35, 0xff800000
    v_xor_b32 v69, v50, v51
    v_lshlrev_b32 v57, 4, v69
    v_and_b32 v63, 0x70, v57
    s_movk_i32 s47, 128
    s_lshl_b32 s8, s4, 1
    v_mov_b32 v11, 0x7ffffff0
    v_writelane_b32 v11, s8, 0
    v_lshlrev_b32 v55, 4, v51
    v_lshrrev_b32 v60, 2, v50
    v_and_b32 v61, 3, v50
    s_movk_i32 s12, 1056
    v_and_b32 v69, 2, v60
    v_lshl_add_u32 v69, v69, 1, v61
    v_mad_u32_u24 v69, v69, s12, v55
    v_and_b32 v70, 1, v60
    v_lshl_add_u32 v70, v70, 8, s9
    v_add_u32 v58, v69, v70
    v_and_b32 v69, 1, v51
    v_lshl_add_u32 v69, v69, 2, v60
    v_and_b32 v70, 2, v51
    v_lshlrev_b32 v70, 8, v70
    s_waitcnt lgkmcnt(0)
    global_load_dwordx2 v[208:209], v53, s[16:17] nt
    s_mov_b32 s52, s24
    s_mov_b32 s53, s25
    global_load_dwordx3 v[212:214], v62, s[16:17] offset:64 nt
    global_load_dword v220, v54, s[28:29]
    global_load_dword v223, v54, s[26:27]
    global_load_dword v221, v54, s[30:31]
    buffer_load_dwordx4 v56, s[52:55], s45 offen lds
    s_xor_b32 s46, s44, 1056
    s_add_u32 m0, s46, s9
    s_xor_b32 s46, s45, 256
    v_lshl_add_u32 v70, v61, 3, v70
    v_mad_u32_u24 v59, v69, s12, v70
    v_lshlrev_b32 v67, 3, v52
    v_and_b32 v71, 1, v52
    v_lshlrev_b32 v69, 2, v71
    v_bfe_u32 v70, v52, 1, 2
    v_and_or_b32 v70, v52, 56, v70
    v_add_lshl_u32 v65, v69, v70, 2
    buffer_load_dwordx4 v56, s[52:55], s46 offen lds
    s_xor_b32 s46, s44, 2112
    s_add_u32 m0, s46, s9
    s_xor_b32 s46, s45, 512
    v_bfe_u32 v70, v52, 3, 1
    v_and_or_b32 v70, v52, 50, v70
    v_or_b32 v69, v69, v70
    v_and_b32 v70, 4, v52
    v_lshl_or_b32 v69, v70, 1, v69
    v_lshlrev_b32 v64, 2, v69
    v_and_b32 v69, 2, v50
    s_lshl_b32 s8, s3, 6
    buffer_load_dwordx4 v56, s[52:55], s46 offen lds
    s_xor_b32 s46, s44, 3168
    s_add_u32 m0, s46, s9
    s_xor_b32 s46, s45, 768
    v_lshl_add_u32 v70, v69, 3, s8
    v_lshl_add_u32 v70, v60, 2, v70
    v_lshl_add_u32 v66, v71, 1, v70
    v_lshlrev_b32 v70, 4, v71
    v_lshl_or_b32 v70, v51, 5, v70
    s_movk_i32 s13, 192
    v_mad_u32_u24 v70, v69, s13, v70
    v_and_b32 v69, 2, v51
    buffer_load_dwordx4 v56, s[52:55], s46 offen lds
    s_xor_b32 s46, s44, 4224
    s_add_u32 m0, s46, s9
    s_xor_b32 s46, s45, 2048
    v_lshlrev_b32 v69, 5, v69
    v_sub_u32 v12, 1344, v69
    v_mov_b32_dpp v12, v70 quad_perm:[0,1,2,3] row_mask:0xf bank_mask:0x1
    s_mov_b32 s13, 0xaaaa
    v_mov_b32 v1, 0x4444
    v_mad_u32_u24 v1, v71, s13, v1
    v_mov_b32_dpp v13, v12 row_ror:4 row_mask:0xf bank_mask:0xf
    v_mov_b32_dpp v14, v12 row_ror:8 row_mask:0xf bank_mask:0xf
    buffer_load_dwordx4 v56, s[52:55], s46 offen lds
    s_xor_b32 s46, s44, 5280
    s_add_u32 m0, s46, s9
    s_xor_b32 s46, s45, 2304
    v_mov_b32_dpp v15, v12 row_ror:12 row_mask:0xf bank_mask:0xf
    v_mov_b64 v[232:233], 0
    v_mov_b64 v[234:235], 0
    v_mul_u32_u24 v69, 896, v51
    v_min_u32 v69, 1536, v69
    v_lshl_add_u32 v68, v50, 4, v69
    ds_write_b128 v68, v[232:235] offset:34176
    v_lshl_add_u32 v69, v50, 7, s5
    buffer_load_dwordx4 v56, s[52:55], s46 offen lds
    s_xor_b32 s46, s44, 6336
    s_add_u32 m0, s46, s9
    s_xor_b32 s46, s45, 2560
    v_and_b32 v70, 8, v50
    v_lshl_add_u32 v69, v70, 3, v69
    v_lshlrev_b32 v70, 3, v50
    v_xor_b32 v70, v70, v55
    v_and_or_b32 v216, v70, 48, v69
    v_lshlrev_b32 v71, 2, v50
    s_add_u32 s8, s5, 4352
    s_mov_b32 s12, 0x4a2b9198
    buffer_load_dwordx4 v56, s[52:55], s46 offen lds
    s_xor_b32 s46, s44, 7392
    s_add_u32 m0, s46, s9
    s_xor_b32 s46, s45, 2816
    s_mov_b32 s13, 0x608ab956
    v_lshrrev_b64 v[48:49], v71, s[12:13]
    v_and_b32 v69, 15, v48
    v_lshl_add_u32 v70, v69, 8, s8
    v_bfe_u32 v69, v48, 2, 2
    v_lshl_add_u32 v70, v69, 6, v70
    v_xor_b32 v69, v48, v51
    v_and_b32 v69, 3, v69
    buffer_load_dwordx4 v56, s[52:55], s46 offen lds
    s_mov_b32 s40, s18
    s_mov_b32 s41, s19
    v_lshl_add_u32 v2, v69, 4, v70
    s_mov_b32 s12, 0x6480559
    s_mov_b32 s13, 0x41ab2821
    v_lshrrev_b64 v[48:49], v71, s[12:13]
    v_and_b32 v69, 15, v48
    v_lshl_add_u32 v70, v69, 8, s8
    v_bfe_u32 v69, v48, 2, 2
    v_lshl_add_u32 v70, v69, 6, v70
    v_xor_b32 v69, v48, v51
    v_and_b32 v69, 3, v69
    v_lshl_add_u32 v6, v69, 4, v70
    v_mov_b64 v[236:237], 0
    v_mov_b64 v[238:239], 0
    v_mov_b64 v[240:241], 0
    v_mov_b64 v[242:243], 0
    v_mov_b64 v[244:245], 0
    v_mov_b64 v[246:247], 0
    v_mov_b64 v[248:249], 0
    v_mov_b64 v[250:251], 0
    v_writelane_b32 v248, s35, 29
    v_writelane_b32 v248, s35, 48
    v_writelane_b32 v248, s35, 58
    v_mov_b64 v[252:253], 0
    v_mov_b64 v[254:255], 0
    v_mov_b32 v10, 0x3f38aa3b
    s_mov_b32 m0, s5
    s_waitcnt vmcnt(12)
    v_lshl_add_u32 v208, v208, 8, v63
    buffer_load_dwordx4 v208, s[40:43], 0 offen nt lds
    s_add_u32 m0, s5, 1088
    v_lshl_add_u32 v209, v209, 8, v63
    buffer_load_dwordx4 v209, s[40:43], 0 offen nt lds
    s_cmp_eq_u32 s3, 0
    s_cbranch_scc1 L_stub0
    s_cmp_eq_u32 s3, 1
    s_cbranch_scc1 L_stub1
    s_cmp_eq_u32 s3, 2
    s_cbranch_scc1 L_stub2
    s_cmp_eq_u32 s3, 3
    s_cbranch_scc1 L_stub3
L_back:
    s_branch L_main2
.p2align 12
L_main:
    s_cbranch_scc1 L_back
L_main2:
    s_waitcnt vmcnt(10)
    ds_write_b32 v54, v220 offset:36480
    v_lshlrev_b32 v222, 16, v223
    v_and_b32 v223, 0xffff0000, v223
    ds_write_b64 v67, v[222:223] offset:35968
    ds_write_b32 v64, v220 offset:33792
    ds_write_b32 v65, v221 offset:34816
    ds_read_b128 v[144:147], v55 offset:36480
    ds_read_b128 v[148:151], v55 offset:36544
    ds_read_b128 v[152:155], v55 offset:36608
    ds_read_b128 v[156:159], v55 offset:36672
    ds_read_b128 v[112:115], v55 offset:35968
    ds_read_b128 v[116:119], v55 offset:36032
    ds_read_b128 v[120:123], v55 offset:36096
    ds_read_b128 v[124:127], v55 offset:36160
    ds_read_b128 v[128:131], v55 offset:36224
    ds_read_b128 v[132:135], v55 offset:36288
    ds_read_b128 v[136:139], v55 offset:36352
    ds_read_b128 v[140:143], v55 offset:36416
    ds_read_b128 a[128:131], v12 offset:33792
    ds_read_b128 a[132:135], v12 offset:33920
    s_add_u32 m0, s5, 2176
    s_nop 0
    buffer_load_dwordx4 v208, s[40:43], s47 offen nt lds
    s_add_u32 m0, s5, 3264
    s_nop 0
    buffer_load_dwordx4 v209, s[40:43], s47 offen nt lds
    s_waitcnt vmcnt(4)
    ds_read_b128 v[80:83], v58 offset:0
    ds_read_b128 v[84:87], v58 offset:64
    ds_read_b128 v[88:91], v58 offset:128
    ds_read_b128 v[92:95], v58 offset:192
    ds_read_b128 v[96:99], v58 offset:512
    ds_read_b128 v[100:103], v58 offset:576
    ds_read_b128 v[104:107], v58 offset:640
    ds_read_b128 v[108:111], v58 offset:704
    s_barrier
    ds_read_b64_tr_b16 a[0:1], v59 offset:0
    ds_read_b64_tr_b16 a[2:3], v59 offset:256
    ds_read_b64_tr_b16 a[16:17], v59 offset:32
    ds_read_b64_tr_b16 a[18:19], v59 offset:288
    ds_read_b64_tr_b16 a[32:33], v59 offset:64
    ds_read_b64_tr_b16 a[34:35], v59 offset:320
    ds_read_b64_tr_b16 a[48:49], v59 offset:96
    ds_read_b64_tr_b16 a[50:51], v59 offset:352
    s_waitcnt lgkmcnt(8)
    v_mfma_f32_16x16x32_bf16 v[176:179], v[144:147], v[80:83], 0
    ds_read_b64_tr_b16 a[64:65], v59 offset:128
    ds_read_b64_tr_b16 a[66:67], v59 offset:384
    v_mfma_f32_16x16x32_bf16 v[176:179], v[148:151], v[84:87], v[176:179]
    ds_read_b64_tr_b16 a[80:81], v59 offset:160
    ds_read_b64_tr_b16 a[82:83], v59 offset:416
    v_mfma_f32_16x16x32_bf16 v[176:179], v[152:155], v[88:91], v[176:179]
    ds_read_b64_tr_b16 a[96:97], v59 offset:192
    ds_read_b64_tr_b16 a[98:99], v59 offset:448
    v_mfma_f32_16x16x32_bf16 v[176:179], v[156:159], v[92:95], v[176:179]
    ds_read_b64_tr_b16 a[112:113], v59 offset:224
    ds_read_b64_tr_b16 a[114:115], v59 offset:480
    v_mfma_f32_16x16x32_bf16 v[180:183], v[144:147], v[96:99], 0
    ds_read_b64_tr_b16 a[4:5], v59 offset:8448
    ds_read_b64_tr_b16 a[6:7], v59 offset:8704
    v_mfma_f32_16x16x32_bf16 v[180:183], v[148:151], v[100:103], v[180:183]
    ds_read_b64_tr_b16 a[20:21], v59 offset:8480
    ds_read_b64_tr_b16 a[22:23], v59 offset:8736
    v_mfma_f32_16x16x32_bf16 v[180:183], v[152:155], v[104:107], v[180:183]
    ds_read_b64_tr_b16 a[36:37], v59 offset:8512
    ds_read_b64_tr_b16 a[38:39], v59 offset:8768
    v_mfma_f32_16x16x32_bf16 v[180:183], v[156:159], v[108:111], v[180:183]
    ds_read_b64_tr_b16 a[52:53], v59 offset:8544
    ds_read_b64_tr_b16 a[54:55], v59 offset:8800
    ds_read_b64_tr_b16 a[68:69], v59 offset:8576
    ds_read_b64_tr_b16 a[70:71], v59 offset:8832
    ds_read_b64_tr_b16 a[84:85], v59 offset:8608
    ds_read_b64_tr_b16 a[86:87], v59 offset:8864
    ds_read_b64_tr_b16 a[100:101], v59 offset:8640
    ds_read_b64_tr_b16 a[102:103], v59 offset:8896
    ds_read_b64_tr_b16 a[116:117], v59 offset:8672
    v_cvt_pk_bf16_f32 v71, v176, v180
    ds_write_b16 v66, v71 offset:34432
    ds_write_b16_d16_hi v66, v71 offset:34464
    ds_read_b64_tr_b16 a[118:119], v59 offset:8928
    ds_read_b64_tr_b16 a[8:9], v59 offset:16896
    ds_read_b64_tr_b16 a[10:11], v59 offset:17152
    ds_read_b64_tr_b16 a[24:25], v59 offset:16928
    ds_read_b64_tr_b16 a[26:27], v59 offset:17184
    ds_read_b64_tr_b16 a[40:41], v59 offset:16960
    ds_read_b64_tr_b16 a[42:43], v59 offset:17216
    ds_read_b64_tr_b16 a[56:57], v59 offset:16992
    ds_read_b64_tr_b16 a[58:59], v59 offset:17248
    ds_read_b64_tr_b16 a[72:73], v59 offset:17024
    ds_read_b64_tr_b16 a[74:75], v59 offset:17280
    ds_read_b64_tr_b16 a[88:89], v59 offset:17056
    ds_read_b64_tr_b16 a[90:91], v59 offset:17312
    ds_read_b64_tr_b16 a[104:105], v59 offset:17088
    ds_read_b64_tr_b16 a[106:107], v59 offset:17344
    ds_read_b64_tr_b16 a[120:121], v59 offset:17120
    ds_read_b64_tr_b16 a[122:123], v59 offset:17376
    s_waitcnt lgkmcnt(15)
    s_barrier
    ds_read_b128 a[136:139], v12 offset:34432
    ds_read_b128 a[140:143], v12 offset:34560
    ds_read_b64_tr_b16 a[12:13], v59 offset:25344
    ds_read_b64_tr_b16 a[14:15], v59 offset:25600
    ds_read_b64_tr_b16 a[28:29], v59 offset:25376
    ds_read_b64_tr_b16 a[30:31], v59 offset:25632
    ds_read_b64_tr_b16 a[44:45], v59 offset:25408
    ds_read_b64_tr_b16 a[46:47], v59 offset:25664
    ds_read_b64_tr_b16 a[60:61], v59 offset:25440
    ds_read_b64_tr_b16 a[62:63], v59 offset:25696
    ds_read_b64_tr_b16 a[76:77], v59 offset:25472
    ds_read_b64_tr_b16 a[78:79], v59 offset:25728
    ds_read_b64_tr_b16 a[92:93], v59 offset:25504
    ds_read_b64_tr_b16 a[94:95], v59 offset:25760
    ds_read_b64_tr_b16 a[108:109], v59 offset:25536
    ds_read_b64_tr_b16 a[110:111], v59 offset:25792
    ds_read_b64_tr_b16 a[124:125], v59 offset:25568
    ds_read_b64_tr_b16 a[126:127], v59 offset:25824
    s_waitcnt vmcnt(2)
    ds_read_b128 v[32:35], v216 offset:0
    ds_read_b128 v[36:39], v216 offset:64
    s_mov_b32 exec_hi, 0x0000ffff
    s_add_u32 m0, s5, 4352
    v_lshl_add_u32 v212, v212, 8, v57
    buffer_load_dwordx4 v212, s[40:43], 0 offen nt lds
    s_add_u32 m0, s5, 5440
    v_lshl_add_u32 v213, v213, 8, v57
    buffer_load_dwordx4 v213, s[40:43], 0 offen nt lds
    s_mov_b32 exec_hi, -1
    s_add_u32 m0, s5, 6528
    v_lshl_add_u32 v214, v214, 8, v57
    buffer_load_dwordx4 v214, s[40:43], 0 offen nt lds
    s_cmp_eq_u32 s3, 4
    s_waitcnt lgkmcnt(1)
    v_lshlrev_b32 v16, 16, v32
    v_and_b32 v17, 0xffff0000, v32
    v_lshlrev_b32 v18, 16, v33
    v_and_b32 v19, 0xffff0000, v33
    v_lshlrev_b32 v20, 16, v34
    v_and_b32 v21, 0xffff0000, v34
    v_lshlrev_b32 v22, 16, v35
    v_and_b32 v23, 0xffff0000, v35
    v_mul_f32_dpp v224, v16, v16 row_ror:1 row_mask:0xf bank_mask:0xf
    v_mul_f32_dpp v225, v17, v17 row_ror:1 row_mask:0xf bank_mask:0xf
    v_mul_f32_dpp v226, v18, v18 row_ror:1 row_mask:0xf bank_mask:0xf
    v_mul_f32_dpp v227, v19, v19 row_ror:1 row_mask:0xf bank_mask:0xf
    v_mul_f32_dpp v228, v20, v20 row_ror:1 row_mask:0xf bank_mask:0xf
    v_mul_f32_dpp v229, v21, v21 row_ror:1 row_mask:0xf bank_mask:0xf
    v_mul_f32_dpp v230, v22, v22 row_ror:1 row_mask:0xf bank_mask:0xf
    v_mul_f32_dpp v231, v23, v23 row_ror:1 row_mask:0xf bank_mask:0xf
    v_cvt_pk_bf16_f32 v144, v224, v225
    v_cvt_pk_bf16_f32 v145, v226, v227
    v_cvt_pk_bf16_f32 v146, v228, v229
    v_cvt_pk_bf16_f32 v147, v230, v231
    s_waitcnt lgkmcnt(0)
    v_lshlrev_b32 v24, 16, v36
    v_mfma_f32_16x16x32_bf16 v[176:179], a[0:3], v[144:147], v[112:115]
    v_and_b32 v25, 0xffff0000, v36
    v_lshlrev_b32 v26, 16, v37
    v_mfma_f32_16x16x32_bf16 v[180:183], a[16:19], v[144:147], v[116:119]
    v_and_b32 v27, 0xffff0000, v37
    v_lshlrev_b32 v28, 16, v38
    v_mfma_f32_16x16x32_bf16 v[184:187], a[32:35], v[144:147], v[120:123]
    v_and_b32 v29, 0xffff0000, v38
    v_lshlrev_b32 v30, 16, v39
    v_mfma_f32_16x16x32_bf16 v[188:191], a[48:51], v[144:147], v[124:127]
    v_and_b32 v31, 0xffff0000, v39
    v_mul_f32_dpp v224, v24, v24 row_ror:1 row_mask:0xf bank_mask:0xf
    v_mfma_f32_16x16x32_bf16 v[192:195], a[64:67], v[144:147], v[128:131]
    v_mul_f32_dpp v225, v25, v25 row_ror:1 row_mask:0xf bank_mask:0xf
    v_mul_f32_dpp v226, v26, v26 row_ror:1 row_mask:0xf bank_mask:0xf
    v_mfma_f32_16x16x32_bf16 v[196:199], a[80:83], v[144:147], v[132:135]
    v_mul_f32_dpp v227, v27, v27 row_ror:1 row_mask:0xf bank_mask:0xf
    v_mul_f32_dpp v228, v28, v28 row_ror:1 row_mask:0xf bank_mask:0xf
    v_mfma_f32_16x16x32_bf16 v[200:203], a[96:99], v[144:147], v[136:139]
    v_mul_f32_dpp v229, v29, v29 row_ror:1 row_mask:0xf bank_mask:0xf
    v_mul_f32_dpp v230, v30, v30 row_ror:1 row_mask:0xf bank_mask:0xf
    v_mfma_f32_16x16x32_bf16 v[204:207], a[112:115], v[144:147], v[140:143]
    v_mul_f32_dpp v231, v31, v31 row_ror:1 row_mask:0xf bank_mask:0xf
    v_cvt_pk_bf16_f32 v148, v224, v225
    v_cvt_pk_bf16_f32 v149, v226, v227
    v_cvt_pk_bf16_f32 v150, v228, v229
    v_cvt_pk_bf16_f32 v151, v230, v231
    v_mul_f32_dpp v224, v16, v16 row_ror:2 row_mask:0xf bank_mask:0xf
    v_mul_f32_dpp v225, v17, v17 row_ror:2 row_mask:0xf bank_mask:0xf
    v_mfma_f32_16x16x32_bf16 v[204:207], a[116:119], v[148:151], v[204:207]
    v_mul_f32_dpp v226, v18, v18 row_ror:2 row_mask:0xf bank_mask:0xf
    v_mul_f32_dpp v227, v19, v19 row_ror:2 row_mask:0xf bank_mask:0xf
    v_smfmac_f32_16x16x64_bf16 v[232:235], a[136:139], v[144:151], v1
    v_mul_f32_dpp v228, v20, v20 row_ror:2 row_mask:0xf bank_mask:0xf
    v_mfma_f32_16x16x32_bf16 v[176:179], a[4:7], v[148:151], v[176:179]
    v_mul_f32_dpp v229, v21, v21 row_ror:2 row_mask:0xf bank_mask:0xf
    v_mul_f32_dpp v230, v22, v22 row_ror:2 row_mask:0xf bank_mask:0xf
    v_mfma_f32_16x16x32_bf16 v[180:183], a[20:23], v[148:151], v[180:183]
    s_waitcnt vmcnt(3)
    ds_read_b128 v[40:43], v216 offset:2176
    ds_read_b128 v[44:47], v216 offset:2240
    v_mfma_f32_16x16x32_bf16 v[184:187], a[36:39], v[148:151], v[184:187]
    v_mul_f32_dpp v231, v23, v23 row_ror:2 row_mask:0xf bank_mask:0xf
    v_cvt_pk_bf16_f32 v160, v224, v225
    v_mfma_f32_16x16x32_bf16 v[188:191], a[52:55], v[148:151], v[188:191]
    v_cvt_pk_bf16_f32 v161, v226, v227
    v_cvt_pk_bf16_f32 v162, v228, v229
    v_mfma_f32_16x16x32_bf16 v[192:195], a[68:71], v[148:151], v[192:195]
    v_cvt_pk_bf16_f32 v163, v230, v231
    v_mul_f32_dpp v224, v24, v24 row_ror:2 row_mask:0xf bank_mask:0xf
    v_mfma_f32_16x16x32_bf16 v[196:199], a[84:87], v[148:151], v[196:199]
    v_mul_f32_dpp v225, v25, v25 row_ror:2 row_mask:0xf bank_mask:0xf
    v_mul_f32_dpp v226, v26, v26 row_ror:2 row_mask:0xf bank_mask:0xf
    v_mfma_f32_16x16x32_bf16 v[200:203], a[100:103], v[148:151], v[200:203]
    v_mul_f32_dpp v227, v27, v27 row_ror:2 row_mask:0xf bank_mask:0xf
    v_mul_f32_dpp v228, v28, v28 row_ror:2 row_mask:0xf bank_mask:0xf
    v_mul_f32_dpp v229, v29, v29 row_ror:2 row_mask:0xf bank_mask:0xf
    v_mul_f32_dpp v230, v30, v30 row_ror:2 row_mask:0xf bank_mask:0xf
    v_mul_f32_dpp v231, v31, v31 row_ror:2 row_mask:0xf bank_mask:0xf
    v_cvt_pk_bf16_f32 v164, v224, v225
    v_cvt_pk_bf16_f32 v165, v226, v227
    s_waitcnt lgkmcnt(0)
    v_lshlrev_b32 v32, 16, v40
    v_and_b32 v33, 0xffff0000, v40
    v_lshlrev_b32 v34, 16, v41
    v_and_b32 v35, 0xffff0000, v41
    v_lshlrev_b32 v36, 16, v42
    v_and_b32 v37, 0xffff0000, v42
    v_lshlrev_b32 v38, 16, v43
    v_and_b32 v39, 0xffff0000, v43
    v_cvt_pk_bf16_f32 v166, v228, v229
    v_cvt_pk_bf16_f32 v167, v230, v231
    v_mul_f32_dpp v224, v32, v32 row_ror:1 row_mask:0xf bank_mask:0xf
    v_mul_f32_dpp v225, v33, v33 row_ror:1 row_mask:0xf bank_mask:0xf
    v_mul_f32_dpp v226, v34, v34 row_ror:1 row_mask:0xf bank_mask:0xf
    v_mul_f32_dpp v227, v35, v35 row_ror:1 row_mask:0xf bank_mask:0xf
    v_mul_f32_dpp v228, v36, v36 row_ror:1 row_mask:0xf bank_mask:0xf
    v_mul_f32_dpp v229, v37, v37 row_ror:1 row_mask:0xf bank_mask:0xf
    v_mul_f32_dpp v230, v38, v38 row_ror:1 row_mask:0xf bank_mask:0xf
    v_mul_f32_dpp v231, v39, v39 row_ror:1 row_mask:0xf bank_mask:0xf
    v_cvt_pk_bf16_f32 v152, v224, v225
    v_cvt_pk_bf16_f32 v153, v226, v227
    v_cvt_pk_bf16_f32 v154, v228, v229
    v_cvt_pk_bf16_f32 v155, v230, v231
    v_lshlrev_b32 v40, 16, v44
    v_and_b32 v41, 0xffff0000, v44
    v_mfma_f32_16x16x32_bf16 v[200:203], a[104:107], v[152:155], v[200:203]
    v_lshlrev_b32 v42, 16, v45
    v_and_b32 v43, 0xffff0000, v45
    v_mfma_f32_16x16x32_bf16 v[176:179], a[8:11], v[152:155], v[176:179]
    v_lshlrev_b32 v44, 16, v46
    v_and_b32 v45, 0xffff0000, v46
    v_mfma_f32_16x16x32_bf16 v[180:183], a[24:27], v[152:155], v[180:183]
    v_lshlrev_b32 v46, 16, v47
    v_and_b32 v47, 0xffff0000, v47
    v_mfma_f32_16x16x32_bf16 v[184:187], a[40:43], v[152:155], v[184:187]
    v_mul_f32_dpp v224, v40, v40 row_ror:1 row_mask:0xf bank_mask:0xf
    v_mul_f32_dpp v225, v41, v41 row_ror:1 row_mask:0xf bank_mask:0xf
    v_mfma_f32_16x16x32_bf16 v[188:191], a[56:59], v[152:155], v[188:191]
    ds_read_b128 a[152:155], v13 offset:34432
    v_mul_f32_dpp v226, v42, v42 row_ror:1 row_mask:0xf bank_mask:0xf
    v_mfma_f32_16x16x32_bf16 v[192:195], a[72:75], v[152:155], v[192:195]
    v_mul_f32_dpp v227, v43, v43 row_ror:1 row_mask:0xf bank_mask:0xf
    v_mul_f32_dpp v228, v44, v44 row_ror:1 row_mask:0xf bank_mask:0xf
    v_mfma_f32_16x16x32_bf16 v[196:199], a[88:91], v[152:155], v[196:199]
    v_mul_f32_dpp v229, v45, v45 row_ror:1 row_mask:0xf bank_mask:0xf
    v_mul_f32_dpp v230, v46, v46 row_ror:1 row_mask:0xf bank_mask:0xf
    v_mfma_f32_16x16x32_bf16 v[204:207], a[120:123], v[152:155], v[204:207]
    v_mul_f32_dpp v231, v47, v47 row_ror:1 row_mask:0xf bank_mask:0xf
    v_cvt_pk_bf16_f32 v156, v224, v225
    v_cvt_pk_bf16_f32 v157, v226, v227
    v_cvt_pk_bf16_f32 v158, v228, v229
    v_cvt_pk_bf16_f32 v159, v230, v231
    v_mul_f32_dpp v224, v32, v32 row_ror:2 row_mask:0xf bank_mask:0xf
    v_mul_f32_dpp v225, v33, v33 row_ror:2 row_mask:0xf bank_mask:0xf
    v_mfma_f32_16x16x32_bf16 v[204:207], a[124:127], v[156:159], v[204:207]
    v_mul_f32_dpp v226, v34, v34 row_ror:2 row_mask:0xf bank_mask:0xf
    v_mul_f32_dpp v227, v35, v35 row_ror:2 row_mask:0xf bank_mask:0xf
    v_smfmac_f32_16x16x64_bf16 v[232:235], a[140:143], v[152:159], v1
    v_mul_f32_dpp v228, v36, v36 row_ror:2 row_mask:0xf bank_mask:0xf
    v_mfma_f32_16x16x32_bf16 v[176:179], a[12:15], v[156:159], v[176:179]
    ds_read_b128 a[156:159], v13 offset:34560
    v_mul_f32_dpp v229, v37, v37 row_ror:2 row_mask:0xf bank_mask:0xf
    v_mfma_f32_16x16x32_bf16 v[180:183], a[28:31], v[156:159], v[180:183]
    v_mul_f32_dpp v230, v38, v38 row_ror:2 row_mask:0xf bank_mask:0xf
    v_mul_f32_dpp v231, v39, v39 row_ror:2 row_mask:0xf bank_mask:0xf
    v_mfma_f32_16x16x32_bf16 v[184:187], a[44:47], v[156:159], v[184:187]
    v_cvt_pk_bf16_f32 v168, v224, v225
    v_cvt_pk_bf16_f32 v169, v226, v227
    v_mfma_f32_16x16x32_bf16 v[188:191], a[60:63], v[156:159], v[188:191]
    v_cvt_pk_bf16_f32 v208, |v176|, |v177|
    v_cvt_pk_bf16_f32 v209, |v178|, |v179|
    v_mfma_f32_16x16x32_bf16 v[192:195], a[76:79], v[156:159], v[192:195]
    s_waitcnt lgkmcnt(0)
    v_cvt_pk_bf16_f32 v170, v228, v229
    v_cvt_pk_bf16_f32 v171, v230, v231
    v_mfma_f32_16x16x32_bf16 v[196:199], a[92:95], v[156:159], v[196:199]
    ds_read_b128 a[144:147], v13 offset:33792
    v_mul_f32_dpp v224, v40, v40 row_ror:2 row_mask:0xf bank_mask:0xf
    v_mfma_f32_16x16x32_bf16 v[200:203], a[108:111], v[156:159], v[200:203]
    v_mul_f32_dpp v225, v41, v41 row_ror:2 row_mask:0xf bank_mask:0xf
    v_mul_f32_dpp v226, v42, v42 row_ror:2 row_mask:0xf bank_mask:0xf
    v_mfma_f32_16x16x32_bf16 v[176:179], a[0:3], v[160:163], v[112:115]
    v_mul_f32_dpp v227, v43, v43 row_ror:2 row_mask:0xf bank_mask:0xf
    v_mul_f32_dpp v228, v44, v44 row_ror:2 row_mask:0xf bank_mask:0xf
    v_mfma_f32_16x16x32_bf16 v[176:179], a[4:7], v[164:167], v[176:179]
    v_mul_f32_dpp v229, v45, v45 row_ror:2 row_mask:0xf bank_mask:0xf
    v_mul_f32_dpp v230, v46, v46 row_ror:2 row_mask:0xf bank_mask:0xf
    v_mfma_f32_16x16x32_bf16 v[176:179], a[8:11], v[168:171], v[176:179]
    ds_read_b128 a[148:151], v13 offset:33920
    v_mul_f32_dpp v231, v47, v47 row_ror:2 row_mask:0xf bank_mask:0xf
    v_cvt_pk_bf16_f32 v172, v224, v225
    v_cvt_pk_bf16_f32 v173, v226, v227
    v_cvt_pk_bf16_f32 v174, v228, v229
    v_cvt_pk_bf16_f32 v175, v230, v231
    v_cvt_pk_bf16_f32 v210, |v180|, |v181|
    v_cvt_pk_bf16_f32 v211, |v182|, |v183|
    v_mfma_f32_16x16x32_bf16 v[176:179], a[12:15], v[172:175], v[176:179]
    v_cvt_pk_bf16_f32 v212, |v184|, |v185|
    v_cvt_pk_bf16_f32 v213, |v186|, |v187|
    v_mfma_f32_16x16x32_bf16 v[180:183], a[28:31], v[172:175], v[116:119]
    s_waitcnt lgkmcnt(0)
    v_cvt_pk_bf16_f32 v214, |v188|, |v189|
    v_cvt_pk_bf16_f32 v215, |v190|, |v191|
    v_mfma_f32_16x16x32_bf16 v[180:183], a[24:27], v[168:171], v[180:183]
    v_cvt_pk_bf16_f32 v216, |v192|, |v193|
    v_cvt_pk_bf16_f32 v217, |v194|, |v195|
    v_mfma_f32_16x16x32_bf16 v[180:183], a[20:23], v[164:167], v[180:183]
    v_cvt_pk_bf16_f32 v218, |v196|, |v197|
    v_cvt_pk_bf16_f32 v219, |v198|, |v199|
    v_mfma_f32_16x16x32_bf16 v[180:183], a[16:19], v[160:163], v[180:183]
    ds_read_b128 a[168:171], v14 offset:34432
    v_cvt_pk_bf16_f32 v220, |v200|, |v201|
    v_smfmac_f32_16x16x64_bf16 v[232:235], a[128:131], v[208:215], v1
    v_cvt_pk_bf16_f32 v221, |v202|, |v203|
    v_mfma_f32_16x16x32_bf16 v[184:187], a[32:35], v[160:163], v[120:123]
    v_cvt_pk_bf16_f32 v222, |v204|, |v205|
    v_cvt_pk_bf16_f32 v223, |v206|, |v207|
    v_mfma_f32_16x16x32_bf16 v[184:187], a[36:39], v[164:167], v[184:187]
    v_mul_f32_dpp v224, v16, v16 row_ror:3 row_mask:0xf bank_mask:0xf
    v_mul_f32_dpp v225, v17, v17 row_ror:3 row_mask:0xf bank_mask:0xf
    v_mfma_f32_16x16x32_bf16 v[184:187], a[40:43], v[168:171], v[184:187]
    v_mul_f32_dpp v226, v18, v18 row_ror:3 row_mask:0xf bank_mask:0xf
    v_mul_f32_dpp v227, v19, v19 row_ror:3 row_mask:0xf bank_mask:0xf
    v_mfma_f32_16x16x32_bf16 v[184:187], a[44:47], v[172:175], v[184:187]
    ds_read_b128 a[172:175], v14 offset:34560
    v_mul_f32_dpp v228, v20, v20 row_ror:3 row_mask:0xf bank_mask:0xf
    v_smfmac_f32_16x16x64_bf16 v[232:235], a[132:135], v[216:223], v1
    v_mul_f32_dpp v229, v21, v21 row_ror:3 row_mask:0xf bank_mask:0xf
    v_mfma_f32_16x16x32_bf16 v[188:191], a[60:63], v[172:175], v[124:127]
    v_mul_f32_dpp v230, v22, v22 row_ror:3 row_mask:0xf bank_mask:0xf
    v_mul_f32_dpp v231, v23, v23 row_ror:3 row_mask:0xf bank_mask:0xf
    v_mfma_f32_16x16x32_bf16 v[188:191], a[56:59], v[168:171], v[188:191]
    v_cvt_pk_bf16_f32 v144, v224, v225
    v_cvt_pk_bf16_f32 v145, v226, v227
    v_mfma_f32_16x16x32_bf16 v[188:191], a[52:55], v[164:167], v[188:191]
    s_waitcnt lgkmcnt(0)
    v_cvt_pk_bf16_f32 v146, v228, v229
    v_cvt_pk_bf16_f32 v147, v230, v231
    v_mfma_f32_16x16x32_bf16 v[188:191], a[48:51], v[160:163], v[188:191]
    ds_read_b128 a[160:163], v14 offset:33792
    v_mul_f32_dpp v224, v24, v24 row_ror:3 row_mask:0xf bank_mask:0xf
    v_smfmac_f32_16x16x64_bf16 v[232:235], a[152:155], v[160:167], v1
    v_mul_f32_dpp v225, v25, v25 row_ror:3 row_mask:0xf bank_mask:0xf
    v_mfma_f32_16x16x32_bf16 v[192:195], a[64:67], v[160:163], v[128:131]
    v_mul_f32_dpp v226, v26, v26 row_ror:3 row_mask:0xf bank_mask:0xf
    v_mul_f32_dpp v227, v27, v27 row_ror:3 row_mask:0xf bank_mask:0xf
    v_mfma_f32_16x16x32_bf16 v[192:195], a[68:71], v[164:167], v[192:195]
    v_mul_f32_dpp v228, v28, v28 row_ror:3 row_mask:0xf bank_mask:0xf
    v_mul_f32_dpp v229, v29, v29 row_ror:3 row_mask:0xf bank_mask:0xf
    v_mfma_f32_16x16x32_bf16 v[192:195], a[72:75], v[168:171], v[192:195]
    v_mul_f32_dpp v230, v30, v30 row_ror:3 row_mask:0xf bank_mask:0xf
    v_mul_f32_dpp v231, v31, v31 row_ror:3 row_mask:0xf bank_mask:0xf
    v_mfma_f32_16x16x32_bf16 v[192:195], a[76:79], v[172:175], v[192:195]
    ds_read_b128 a[164:167], v14 offset:33920
    v_cvt_pk_bf16_f32 v208, |v176|, |v177|
    v_smfmac_f32_16x16x64_bf16 v[232:235], a[156:159], v[168:175], v1
    v_cvt_pk_bf16_f32 v209, |v178|, |v179|
    v_mfma_f32_16x16x32_bf16 v[196:199], a[92:95], v[172:175], v[132:135]
    v_cvt_pk_bf16_f32 v148, v224, v225
    v_cvt_pk_bf16_f32 v149, v226, v227
    v_mfma_f32_16x16x32_bf16 v[196:199], a[88:91], v[168:171], v[196:199]
    v_cvt_pk_bf16_f32 v150, v228, v229
    v_cvt_pk_bf16_f32 v151, v230, v231
    v_mfma_f32_16x16x32_bf16 v[196:199], a[84:87], v[164:167], v[196:199]
    s_waitcnt lgkmcnt(0)
    v_mul_f32_dpp v224, v32, v32 row_ror:3 row_mask:0xf bank_mask:0xf
    v_mul_f32_dpp v225, v33, v33 row_ror:3 row_mask:0xf bank_mask:0xf
    v_mfma_f32_16x16x32_bf16 v[196:199], a[80:83], v[160:163], v[196:199]
    ds_read_b128 a[184:187], v15 offset:34432
    v_mul_f32_dpp v226, v34, v34 row_ror:3 row_mask:0xf bank_mask:0xf
    v_mfma_f32_16x16x32_bf16 v[200:203], a[96:99], v[160:163], v[136:139]
    v_mul_f32_dpp v227, v35, v35 row_ror:3 row_mask:0xf bank_mask:0xf
    v_mul_f32_dpp v228, v36, v36 row_ror:3 row_mask:0xf bank_mask:0xf
    v_mfma_f32_16x16x32_bf16 v[200:203], a[100:103], v[164:167], v[200:203]
    v_mul_f32_dpp v229, v37, v37 row_ror:3 row_mask:0xf bank_mask:0xf
    v_mul_f32_dpp v230, v38, v38 row_ror:3 row_mask:0xf bank_mask:0xf
    v_mfma_f32_16x16x32_bf16 v[200:203], a[104:107], v[168:171], v[200:203]
    v_mul_f32_dpp v231, v39, v39 row_ror:3 row_mask:0xf bank_mask:0xf
    v_cvt_pk_bf16_f32 v152, v224, v225
    v_mfma_f32_16x16x32_bf16 v[200:203], a[108:111], v[172:175], v[200:203]
    v_cvt_pk_bf16_f32 v153, v226, v227
    v_cvt_pk_bf16_f32 v154, v228, v229
    v_mfma_f32_16x16x32_bf16 v[204:207], a[124:127], v[172:175], v[140:143]
    ds_read_b128 a[188:191], v15 offset:34560
    v_cvt_pk_bf16_f32 v155, v230, v231
    v_mfma_f32_16x16x32_bf16 v[204:207], a[120:123], v[168:171], v[204:207]
    v_mul_f32_dpp v224, v40, v40 row_ror:3 row_mask:0xf bank_mask:0xf
    v_mul_f32_dpp v225, v41, v41 row_ror:3 row_mask:0xf bank_mask:0xf
    v_mfma_f32_16x16x32_bf16 v[204:207], a[116:119], v[164:167], v[204:207]
    v_mul_f32_dpp v226, v42, v42 row_ror:3 row_mask:0xf bank_mask:0xf
    v_mul_f32_dpp v227, v43, v43 row_ror:3 row_mask:0xf bank_mask:0xf
    v_mfma_f32_16x16x32_bf16 v[204:207], a[112:115], v[160:163], v[204:207]
    v_mul_f32_dpp v228, v44, v44 row_ror:3 row_mask:0xf bank_mask:0xf
    v_mul_f32_dpp v229, v45, v45 row_ror:3 row_mask:0xf bank_mask:0xf
    v_mfma_f32_16x16x32_bf16 v[176:179], a[0:3], v[144:147], v[112:115]
    s_waitcnt lgkmcnt(0)
    v_mul_f32_dpp v230, v46, v46 row_ror:3 row_mask:0xf bank_mask:0xf
    v_mul_f32_dpp v231, v47, v47 row_ror:3 row_mask:0xf bank_mask:0xf
    v_mfma_f32_16x16x32_bf16 v[176:179], a[4:7], v[148:151], v[176:179]
    ds_read_b128 a[176:179], v15 offset:33792
    v_cvt_pk_bf16_f32 v156, v224, v225
    v_mfma_f32_16x16x32_bf16 v[176:179], a[8:11], v[152:155], v[176:179]
    v_cvt_pk_bf16_f32 v157, v226, v227
    v_cvt_pk_bf16_f32 v158, v228, v229
    v_cvt_pk_bf16_f32 v159, v230, v231
    v_cvt_pk_bf16_f32 v210, |v180|, |v181|
    v_cvt_pk_bf16_f32 v211, |v182|, |v183|
    v_mfma_f32_16x16x32_bf16 v[176:179], a[12:15], v[156:159], v[176:179]
    v_cvt_pk_bf16_f32 v212, |v184|, |v185|
    v_cvt_pk_bf16_f32 v213, |v186|, |v187|
    v_mfma_f32_16x16x32_bf16 v[180:183], a[28:31], v[156:159], v[116:119]
    v_cvt_pk_bf16_f32 v214, |v188|, |v189|
    v_cvt_pk_bf16_f32 v215, |v190|, |v191|
    v_mfma_f32_16x16x32_bf16 v[180:183], a[24:27], v[152:155], v[180:183]
    v_cvt_pk_bf16_f32 v216, |v192|, |v193|
    v_cvt_pk_bf16_f32 v217, |v194|, |v195|
    v_mfma_f32_16x16x32_bf16 v[180:183], a[20:23], v[148:151], v[180:183]
    ds_read_b128 a[180:183], v15 offset:33920
    v_cvt_pk_bf16_f32 v218, |v196|, |v197|
    v_mfma_f32_16x16x32_bf16 v[180:183], a[16:19], v[144:147], v[180:183]
    v_cvt_pk_bf16_f32 v219, |v198|, |v199|
    v_cvt_pk_bf16_f32 v220, |v200|, |v201|
    v_smfmac_f32_16x16x64_bf16 v[232:235], a[144:147], v[208:215], v1
    v_cvt_pk_bf16_f32 v221, |v202|, |v203|
    v_mfma_f32_16x16x32_bf16 v[184:187], a[32:35], v[144:147], v[120:123]
    v_cvt_pk_bf16_f32 v222, |v204|, |v205|
    v_cvt_pk_bf16_f32 v223, |v206|, |v207|
    v_mfma_f32_16x16x32_bf16 v[184:187], a[36:39], v[148:151], v[184:187]
    s_waitcnt lgkmcnt(0)
    v_mul_f32_dpp v224, v16, v16 row_ror:4 row_mask:0xf bank_mask:0xf
    v_mul_f32_dpp v225, v17, v17 row_ror:4 row_mask:0xf bank_mask:0xf
    v_mfma_f32_16x16x32_bf16 v[184:187], a[40:43], v[152:155], v[184:187]
    v_mul_f32_dpp v226, v18, v18 row_ror:4 row_mask:0xf bank_mask:0xf
    v_mul_f32_dpp v227, v19, v19 row_ror:4 row_mask:0xf bank_mask:0xf
    v_mfma_f32_16x16x32_bf16 v[184:187], a[44:47], v[156:159], v[184:187]
    v_mul_f32_dpp v228, v20, v20 row_ror:4 row_mask:0xf bank_mask:0xf
    v_mul_f32_dpp v229, v21, v21 row_ror:4 row_mask:0xf bank_mask:0xf
    v_smfmac_f32_16x16x64_bf16 v[232:235], a[148:151], v[216:223], v1
    v_mul_f32_dpp v230, v22, v22 row_ror:4 row_mask:0xf bank_mask:0xf
    v_mfma_f32_16x16x32_bf16 v[188:191], a[60:63], v[156:159], v[124:127]
    v_mul_f32_dpp v231, v23, v23 row_ror:4 row_mask:0xf bank_mask:0xf
    v_cvt_pk_bf16_f32 v160, v224, v225
    v_mfma_f32_16x16x32_bf16 v[188:191], a[56:59], v[152:155], v[188:191]
    v_cvt_pk_bf16_f32 v161, v226, v227
    v_cvt_pk_bf16_f32 v162, v228, v229
    v_mfma_f32_16x16x32_bf16 v[188:191], a[52:55], v[148:151], v[188:191]
    v_cvt_pk_bf16_f32 v163, v230, v231
    v_mul_f32_dpp v224, v24, v24 row_ror:4 row_mask:0xf bank_mask:0xf
    v_mfma_f32_16x16x32_bf16 v[188:191], a[48:51], v[144:147], v[188:191]
    v_mul_f32_dpp v225, v25, v25 row_ror:4 row_mask:0xf bank_mask:0xf
    v_mul_f32_dpp v226, v26, v26 row_ror:4 row_mask:0xf bank_mask:0xf
    v_smfmac_f32_16x16x64_bf16 v[232:235], a[168:171], v[144:151], v1
    v_mul_f32_dpp v227, v27, v27 row_ror:4 row_mask:0xf bank_mask:0xf
    v_mfma_f32_16x16x32_bf16 v[192:195], a[64:67], v[144:147], v[128:131]
    v_mul_f32_dpp v228, v28, v28 row_ror:4 row_mask:0xf bank_mask:0xf
    v_mul_f32_dpp v229, v29, v29 row_ror:4 row_mask:0xf bank_mask:0xf
    v_mfma_f32_16x16x32_bf16 v[192:195], a[68:71], v[148:151], v[192:195]
    v_mul_f32_dpp v230, v30, v30 row_ror:4 row_mask:0xf bank_mask:0xf
    v_mul_f32_dpp v231, v31, v31 row_ror:4 row_mask:0xf bank_mask:0xf
    v_mfma_f32_16x16x32_bf16 v[192:195], a[72:75], v[152:155], v[192:195]
    v_cvt_pk_bf16_f32 v208, |v176|, |v177|
    v_cvt_pk_bf16_f32 v209, |v178|, |v179|
    v_mfma_f32_16x16x32_bf16 v[192:195], a[76:79], v[156:159], v[192:195]
    v_cvt_pk_bf16_f32 v164, v224, v225
    v_cvt_pk_bf16_f32 v165, v226, v227
    v_smfmac_f32_16x16x64_bf16 v[232:235], a[172:175], v[152:159], v1
    v_cvt_pk_bf16_f32 v166, v228, v229
    v_mfma_f32_16x16x32_bf16 v[196:199], a[92:95], v[156:159], v[132:135]
    v_cvt_pk_bf16_f32 v167, v230, v231
    v_mul_f32_dpp v224, v32, v32 row_ror:4 row_mask:0xf bank_mask:0xf
    v_mfma_f32_16x16x32_bf16 v[196:199], a[88:91], v[152:155], v[196:199]
    v_mul_f32_dpp v225, v33, v33 row_ror:4 row_mask:0xf bank_mask:0xf
    v_mul_f32_dpp v226, v34, v34 row_ror:4 row_mask:0xf bank_mask:0xf
    v_mfma_f32_16x16x32_bf16 v[196:199], a[84:87], v[148:151], v[196:199]
    v_mul_f32_dpp v227, v35, v35 row_ror:4 row_mask:0xf bank_mask:0xf
    v_mul_f32_dpp v228, v36, v36 row_ror:4 row_mask:0xf bank_mask:0xf
    v_mfma_f32_16x16x32_bf16 v[196:199], a[80:83], v[144:147], v[196:199]
    v_mul_f32_dpp v229, v37, v37 row_ror:4 row_mask:0xf bank_mask:0xf
    v_mul_f32_dpp v230, v38, v38 row_ror:4 row_mask:0xf bank_mask:0xf
    v_mfma_f32_16x16x32_bf16 v[200:203], a[96:99], v[144:147], v[136:139]
    v_mul_f32_dpp v231, v39, v39 row_ror:4 row_mask:0xf bank_mask:0xf
    v_cvt_pk_bf16_f32 v168, v224, v225
    v_mfma_f32_16x16x32_bf16 v[200:203], a[100:103], v[148:151], v[200:203]
    v_cvt_pk_bf16_f32 v169, v226, v227
    v_cvt_pk_bf16_f32 v170, v228, v229
    v_mfma_f32_16x16x32_bf16 v[200:203], a[104:107], v[152:155], v[200:203]
    v_cvt_pk_bf16_f32 v171, v230, v231
    v_mul_f32_dpp v224, v40, v40 row_ror:4 row_mask:0xf bank_mask:0xf
    v_mfma_f32_16x16x32_bf16 v[200:203], a[108:111], v[156:159], v[200:203]
    v_mul_f32_dpp v225, v41, v41 row_ror:4 row_mask:0xf bank_mask:0xf
    v_mul_f32_dpp v226, v42, v42 row_ror:4 row_mask:0xf bank_mask:0xf
    v_mfma_f32_16x16x32_bf16 v[204:207], a[124:127], v[156:159], v[140:143]
    v_mul_f32_dpp v227, v43, v43 row_ror:4 row_mask:0xf bank_mask:0xf
    v_mul_f32_dpp v228, v44, v44 row_ror:4 row_mask:0xf bank_mask:0xf
    v_mfma_f32_16x16x32_bf16 v[204:207], a[120:123], v[152:155], v[204:207]
    v_mul_f32_dpp v229, v45, v45 row_ror:4 row_mask:0xf bank_mask:0xf
    v_mul_f32_dpp v230, v46, v46 row_ror:4 row_mask:0xf bank_mask:0xf
    v_mfma_f32_16x16x32_bf16 v[204:207], a[116:119], v[148:151], v[204:207]
    v_mul_f32_dpp v231, v47, v47 row_ror:4 row_mask:0xf bank_mask:0xf
    v_cvt_pk_bf16_f32 v172, v224, v225
    v_mfma_f32_16x16x32_bf16 v[204:207], a[112:115], v[144:147], v[204:207]
    v_cvt_pk_bf16_f32 v173, v226, v227
    v_cvt_pk_bf16_f32 v174, v228, v229
    v_mfma_f32_16x16x32_bf16 v[176:179], a[0:3], v[160:163], v[112:115]
    v_cvt_pk_bf16_f32 v175, v230, v231
    v_cvt_pk_bf16_f32 v210, |v180|, |v181|
    v_mfma_f32_16x16x32_bf16 v[176:179], a[4:7], v[164:167], v[176:179]
    v_cvt_pk_bf16_f32 v211, |v182|, |v183|
    v_cvt_pk_bf16_f32 v212, |v184|, |v185|
    v_mfma_f32_16x16x32_bf16 v[176:179], a[8:11], v[168:171], v[176:179]
    v_cvt_pk_bf16_f32 v213, |v186|, |v187|
    v_cvt_pk_bf16_f32 v214, |v188|, |v189|
    v_mfma_f32_16x16x32_bf16 v[176:179], a[12:15], v[172:175], v[176:179]
    v_cvt_pk_bf16_f32 v215, |v190|, |v191|
    v_cvt_pk_bf16_f32 v216, |v192|, |v193|
    v_mfma_f32_16x16x32_bf16 v[180:183], a[28:31], v[172:175], v[116:119]
L_stub0:
    s_cbranch_scc1 L_main2
    v_cvt_pk_bf16_f32 v217, |v194|, |v195|
    v_cvt_pk_bf16_f32 v218, |v196|, |v197|
    v_mfma_f32_16x16x32_bf16 v[180:183], a[24:27], v[168:171], v[180:183]
    v_cvt_pk_bf16_f32 v219, |v198|, |v199|
    v_cvt_pk_bf16_f32 v220, |v200|, |v201|
    v_mfma_f32_16x16x32_bf16 v[180:183], a[20:23], v[164:167], v[180:183]
    v_cvt_pk_bf16_f32 v221, |v202|, |v203|
    v_cvt_pk_bf16_f32 v222, |v204|, |v205|
    v_mfma_f32_16x16x32_bf16 v[180:183], a[16:19], v[160:163], v[180:183]
    v_cvt_pk_bf16_f32 v223, |v206|, |v207|
    v_mul_f32_dpp v224, v16, v16 row_ror:5 row_mask:0xf bank_mask:0xf
    v_smfmac_f32_16x16x64_bf16 v[232:235], a[160:163], v[208:215], v1
    v_mul_f32_dpp v225, v17, v17 row_ror:5 row_mask:0xf bank_mask:0xf
    v_mfma_f32_16x16x32_bf16 v[184:187], a[32:35], v[160:163], v[120:123]
    v_mul_f32_dpp v226, v18, v18 row_ror:5 row_mask:0xf bank_mask:0xf
    v_mul_f32_dpp v227, v19, v19 row_ror:5 row_mask:0xf bank_mask:0xf
    v_mfma_f32_16x16x32_bf16 v[184:187], a[36:39], v[164:167], v[184:187]
    v_mul_f32_dpp v228, v20, v20 row_ror:5 row_mask:0xf bank_mask:0xf
    v_mul_f32_dpp v229, v21, v21 row_ror:5 row_mask:0xf bank_mask:0xf
    v_mfma_f32_16x16x32_bf16 v[184:187], a[40:43], v[168:171], v[184:187]
    v_mul_f32_dpp v230, v22, v22 row_ror:5 row_mask:0xf bank_mask:0xf
    v_mul_f32_dpp v231, v23, v23 row_ror:5 row_mask:0xf bank_mask:0xf
    v_mfma_f32_16x16x32_bf16 v[184:187], a[44:47], v[172:175], v[184:187]
    v_cvt_pk_bf16_f32 v144, v224, v225
    v_cvt_pk_bf16_f32 v145, v226, v227
    v_smfmac_f32_16x16x64_bf16 v[232:235], a[164:167], v[216:223], v1
    v_cvt_pk_bf16_f32 v146, v228, v229
    v_mfma_f32_16x16x32_bf16 v[188:191], a[60:63], v[172:175], v[124:127]
    v_cvt_pk_bf16_f32 v147, v230, v231
    v_mul_f32_dpp v224, v24, v24 row_ror:5 row_mask:0xf bank_mask:0xf
    v_mfma_f32_16x16x32_bf16 v[188:191], a[56:59], v[168:171], v[188:191]
    v_mul_f32_dpp v225, v25, v25 row_ror:5 row_mask:0xf bank_mask:0xf
    v_mul_f32_dpp v226, v26, v26 row_ror:5 row_mask:0xf bank_mask:0xf
    v_mfma_f32_16x16x32_bf16 v[188:191], a[52:55], v[164:167], v[188:191]
    v_mul_f32_dpp v227, v27, v27 row_ror:5 row_mask:0xf bank_mask:0xf
    v_mul_f32_dpp v228, v28, v28 row_ror:5 row_mask:0xf bank_mask:0xf
    v_mfma_f32_16x16x32_bf16 v[188:191], a[48:51], v[160:163], v[188:191]
    v_mul_f32_dpp v229, v29, v29 row_ror:5 row_mask:0xf bank_mask:0xf
    v_mul_f32_dpp v230, v30, v30 row_ror:5 row_mask:0xf bank_mask:0xf
    v_smfmac_f32_16x16x64_bf16 v[232:235], a[184:187], v[160:167], v1
    v_mul_f32_dpp v231, v31, v31 row_ror:5 row_mask:0xf bank_mask:0xf
    v_mfma_f32_16x16x32_bf16 v[192:195], a[64:67], v[160:163], v[128:131]
    v_cvt_pk_bf16_f32 v208, |v176|, |v177|
    v_cvt_pk_bf16_f32 v209, |v178|, |v179|
    v_mfma_f32_16x16x32_bf16 v[192:195], a[68:71], v[164:167], v[192:195]
    v_cvt_pk_bf16_f32 v148, v224, v225
    v_cvt_pk_bf16_f32 v149, v226, v227
    v_mfma_f32_16x16x32_bf16 v[192:195], a[72:75], v[168:171], v[192:195]
    v_cvt_pk_bf16_f32 v150, v228, v229
    v_cvt_pk_bf16_f32 v151, v230, v231
    v_mfma_f32_16x16x32_bf16 v[192:195], a[76:79], v[172:175], v[192:195]
    v_mul_f32_dpp v224, v32, v32 row_ror:5 row_mask:0xf bank_mask:0xf
    v_mul_f32_dpp v225, v33, v33 row_ror:5 row_mask:0xf bank_mask:0xf
    v_smfmac_f32_16x16x64_bf16 v[232:235], a[188:191], v[168:175], v1
    v_mul_f32_dpp v226, v34, v34 row_ror:5 row_mask:0xf bank_mask:0xf
    v_mfma_f32_16x16x32_bf16 v[196:199], a[92:95], v[172:175], v[132:135]
    v_mul_f32_dpp v227, v35, v35 row_ror:5 row_mask:0xf bank_mask:0xf
    v_mul_f32_dpp v228, v36, v36 row_ror:5 row_mask:0xf bank_mask:0xf
    v_mfma_f32_16x16x32_bf16 v[196:199], a[88:91], v[168:171], v[196:199]
    v_mul_f32_dpp v229, v37, v37 row_ror:5 row_mask:0xf bank_mask:0xf
    v_mul_f32_dpp v230, v38, v38 row_ror:5 row_mask:0xf bank_mask:0xf
    v_mfma_f32_16x16x32_bf16 v[196:199], a[84:87], v[164:167], v[196:199]
    v_mul_f32_dpp v231, v39, v39 row_ror:5 row_mask:0xf bank_mask:0xf
    v_cvt_pk_bf16_f32 v152, v224, v225
    v_mfma_f32_16x16x32_bf16 v[196:199], a[80:83], v[160:163], v[196:199]
    v_cvt_pk_bf16_f32 v153, v226, v227
    v_cvt_pk_bf16_f32 v154, v228, v229
    v_smfmac_f32_16x16x64_bf16 v[236:239], a[136:139], v[144:151], v1
    v_cvt_pk_bf16_f32 v155, v230, v231
    v_mfma_f32_16x16x32_bf16 v[200:203], a[96:99], v[160:163], v[136:139]
    v_mul_f32_dpp v224, v40, v40 row_ror:5 row_mask:0xf bank_mask:0xf
    v_mul_f32_dpp v225, v41, v41 row_ror:5 row_mask:0xf bank_mask:0xf
    v_mfma_f32_16x16x32_bf16 v[200:203], a[100:103], v[164:167], v[200:203]
    v_mul_f32_dpp v226, v42, v42 row_ror:5 row_mask:0xf bank_mask:0xf
    v_mul_f32_dpp v227, v43, v43 row_ror:5 row_mask:0xf bank_mask:0xf
    v_mfma_f32_16x16x32_bf16 v[200:203], a[104:107], v[168:171], v[200:203]
    v_mul_f32_dpp v228, v44, v44 row_ror:5 row_mask:0xf bank_mask:0xf
    v_mul_f32_dpp v229, v45, v45 row_ror:5 row_mask:0xf bank_mask:0xf
    v_mfma_f32_16x16x32_bf16 v[200:203], a[108:111], v[172:175], v[200:203]
    v_mul_f32_dpp v230, v46, v46 row_ror:5 row_mask:0xf bank_mask:0xf
    v_mul_f32_dpp v231, v47, v47 row_ror:5 row_mask:0xf bank_mask:0xf
    v_mfma_f32_16x16x32_bf16 v[204:207], a[124:127], v[172:175], v[140:143]
    v_cvt_pk_bf16_f32 v156, v224, v225
    v_cvt_pk_bf16_f32 v157, v226, v227
    v_mfma_f32_16x16x32_bf16 v[204:207], a[120:123], v[168:171], v[204:207]
    v_cvt_pk_bf16_f32 v158, v228, v229
    v_cvt_pk_bf16_f32 v159, v230, v231
    v_mfma_f32_16x16x32_bf16 v[204:207], a[116:119], v[164:167], v[204:207]
    v_cvt_pk_bf16_f32 v210, |v180|, |v181|
    v_cvt_pk_bf16_f32 v211, |v182|, |v183|
    v_mfma_f32_16x16x32_bf16 v[204:207], a[112:115], v[160:163], v[204:207]
    v_cvt_pk_bf16_f32 v212, |v184|, |v185|
    v_cvt_pk_bf16_f32 v213, |v186|, |v187|
    v_smfmac_f32_16x16x64_bf16 v[236:239], a[140:143], v[152:159], v1
    v_cvt_pk_bf16_f32 v214, |v188|, |v189|
    v_mfma_f32_16x16x32_bf16 v[176:179], a[0:3], v[144:147], v[112:115]
    v_cvt_pk_bf16_f32 v215, |v190|, |v191|
    v_cvt_pk_bf16_f32 v216, |v192|, |v193|
    v_mfma_f32_16x16x32_bf16 v[176:179], a[4:7], v[148:151], v[176:179]
    v_cvt_pk_bf16_f32 v217, |v194|, |v195|
    v_cvt_pk_bf16_f32 v218, |v196|, |v197|
    v_mfma_f32_16x16x32_bf16 v[176:179], a[8:11], v[152:155], v[176:179]
    v_cvt_pk_bf16_f32 v219, |v198|, |v199|
    v_cvt_pk_bf16_f32 v220, |v200|, |v201|
    v_mfma_f32_16x16x32_bf16 v[176:179], a[12:15], v[156:159], v[176:179]
    v_cvt_pk_bf16_f32 v221, |v202|, |v203|
    v_cvt_pk_bf16_f32 v222, |v204|, |v205|
    v_smfmac_f32_16x16x64_bf16 v[232:235], a[176:179], v[208:215], v1
    v_cvt_pk_bf16_f32 v223, |v206|, |v207|
    v_mfma_f32_16x16x32_bf16 v[180:183], a[28:31], v[156:159], v[116:119]
    v_mul_f32_dpp v224, v16, v16 row_ror:6 row_mask:0xf bank_mask:0xf
    v_mul_f32_dpp v225, v17, v17 row_ror:6 row_mask:0xf bank_mask:0xf
    v_mfma_f32_16x16x32_bf16 v[180:183], a[24:27], v[152:155], v[180:183]
    v_mul_f32_dpp v226, v18, v18 row_ror:6 row_mask:0xf bank_mask:0xf
    v_mul_f32_dpp v227, v19, v19 row_ror:6 row_mask:0xf bank_mask:0xf
    v_mfma_f32_16x16x32_bf16 v[180:183], a[20:23], v[148:151], v[180:183]
    v_mul_f32_dpp v228, v20, v20 row_ror:6 row_mask:0xf bank_mask:0xf
    v_mul_f32_dpp v229, v21, v21 row_ror:6 row_mask:0xf bank_mask:0xf
    v_mfma_f32_16x16x32_bf16 v[180:183], a[16:19], v[144:147], v[180:183]
    v_mul_f32_dpp v230, v22, v22 row_ror:6 row_mask:0xf bank_mask:0xf
    v_mul_f32_dpp v231, v23, v23 row_ror:6 row_mask:0xf bank_mask:0xf
    v_smfmac_f32_16x16x64_bf16 v[232:235], a[180:183], v[216:223], v1
    v_cvt_pk_bf16_f32 v160, v224, v225
    v_mfma_f32_16x16x32_bf16 v[184:187], a[32:35], v[144:147], v[120:123]
    v_cvt_pk_bf16_f32 v161, v226, v227
    v_cvt_pk_bf16_f32 v162, v228, v229
    v_mfma_f32_16x16x32_bf16 v[184:187], a[36:39], v[148:151], v[184:187]
    v_cvt_pk_bf16_f32 v163, v230, v231
    v_mul_f32_dpp v224, v24, v24 row_ror:6 row_mask:0xf bank_mask:0xf
    v_mfma_f32_16x16x32_bf16 v[184:187], a[40:43], v[152:155], v[184:187]
    v_mul_f32_dpp v225, v25, v25 row_ror:6 row_mask:0xf bank_mask:0xf
    v_mul_f32_dpp v226, v26, v26 row_ror:6 row_mask:0xf bank_mask:0xf
    v_mfma_f32_16x16x32_bf16 v[184:187], a[44:47], v[156:159], v[184:187]
    v_mul_f32_dpp v227, v27, v27 row_ror:6 row_mask:0xf bank_mask:0xf
    v_mul_f32_dpp v228, v28, v28 row_ror:6 row_mask:0xf bank_mask:0xf
    v_mfma_f32_16x16x32_bf16 v[188:191], a[60:63], v[156:159], v[124:127]
    v_mul_f32_dpp v229, v29, v29 row_ror:6 row_mask:0xf bank_mask:0xf
    v_mul_f32_dpp v230, v30, v30 row_ror:6 row_mask:0xf bank_mask:0xf
    v_mfma_f32_16x16x32_bf16 v[188:191], a[56:59], v[152:155], v[188:191]
    v_mul_f32_dpp v231, v31, v31 row_ror:6 row_mask:0xf bank_mask:0xf
    v_cvt_pk_bf16_f32 v208, |v176|, |v177|
    v_mfma_f32_16x16x32_bf16 v[188:191], a[52:55], v[148:151], v[188:191]
    v_cvt_pk_bf16_f32 v209, |v178|, |v179|
    v_cvt_pk_bf16_f32 v164, v224, v225
    v_mfma_f32_16x16x32_bf16 v[188:191], a[48:51], v[144:147], v[188:191]
    v_cvt_pk_bf16_f32 v165, v226, v227
    v_cvt_pk_bf16_f32 v166, v228, v229
    v_mfma_f32_16x16x32_bf16 v[192:195], a[64:67], v[144:147], v[128:131]
    v_cvt_pk_bf16_f32 v167, v230, v231
    v_mul_f32_dpp v224, v32, v32 row_ror:6 row_mask:0xf bank_mask:0xf
    v_mfma_f32_16x16x32_bf16 v[192:195], a[68:71], v[148:151], v[192:195]
    v_mul_f32_dpp v225, v33, v33 row_ror:6 row_mask:0xf bank_mask:0xf
    v_mul_f32_dpp v226, v34, v34 row_ror:6 row_mask:0xf bank_mask:0xf
    v_mfma_f32_16x16x32_bf16 v[192:195], a[72:75], v[152:155], v[192:195]
    v_mul_f32_dpp v227, v35, v35 row_ror:6 row_mask:0xf bank_mask:0xf
    v_mul_f32_dpp v228, v36, v36 row_ror:6 row_mask:0xf bank_mask:0xf
    v_mfma_f32_16x16x32_bf16 v[192:195], a[76:79], v[156:159], v[192:195]
    v_mul_f32_dpp v229, v37, v37 row_ror:6 row_mask:0xf bank_mask:0xf
    v_mul_f32_dpp v230, v38, v38 row_ror:6 row_mask:0xf bank_mask:0xf
    v_mfma_f32_16x16x32_bf16 v[196:199], a[92:95], v[156:159], v[132:135]
    v_mul_f32_dpp v231, v39, v39 row_ror:6 row_mask:0xf bank_mask:0xf
    v_cvt_pk_bf16_f32 v168, v224, v225
    v_mfma_f32_16x16x32_bf16 v[196:199], a[88:91], v[152:155], v[196:199]
    v_cvt_pk_bf16_f32 v169, v226, v227
    v_cvt_pk_bf16_f32 v170, v228, v229
    v_mfma_f32_16x16x32_bf16 v[196:199], a[84:87], v[148:151], v[196:199]
    v_cvt_pk_bf16_f32 v171, v230, v231
    v_mul_f32_dpp v224, v40, v40 row_ror:6 row_mask:0xf bank_mask:0xf
    v_mfma_f32_16x16x32_bf16 v[196:199], a[80:83], v[144:147], v[196:199]
    s_waitcnt vmcnt(0)
    v_mul_f32_dpp v225, v41, v41 row_ror:6 row_mask:0xf bank_mask:0xf
    v_mul_f32_dpp v226, v42, v42 row_ror:6 row_mask:0xf bank_mask:0xf
    v_mfma_f32_16x16x32_bf16 v[200:203], a[96:99], v[144:147], v[136:139]
    ds_read_b128 v[64:67], v2 offset:0
    v_mul_f32_dpp v227, v43, v43 row_ror:6 row_mask:0xf bank_mask:0xf
    v_mfma_f32_16x16x32_bf16 v[200:203], a[100:103], v[148:151], v[200:203]
    ds_read_b128 v[68:71], v2 offset:64
    v_mul_f32_dpp v228, v44, v44 row_ror:6 row_mask:0xf bank_mask:0xf
    v_mfma_f32_16x16x32_bf16 v[200:203], a[104:107], v[152:155], v[200:203]
    ds_read_b128 v[72:75], v2 offset:128
    v_mul_f32_dpp v229, v45, v45 row_ror:6 row_mask:0xf bank_mask:0xf
    v_mfma_f32_16x16x32_bf16 v[200:203], a[108:111], v[156:159], v[200:203]
    ds_read_b128 v[76:79], v2 offset:192
    v_mul_f32_dpp v230, v46, v46 row_ror:6 row_mask:0xf bank_mask:0xf
    v_mfma_f32_16x16x32_bf16 v[204:207], a[124:127], v[156:159], v[140:143]
    v_mul_f32_dpp v231, v47, v47 row_ror:6 row_mask:0xf bank_mask:0xf
    v_cvt_pk_bf16_f32 v172, v224, v225
    v_mfma_f32_16x16x32_bf16 v[204:207], a[120:123], v[152:155], v[204:207]
    v_cvt_pk_bf16_f32 v173, v226, v227
    v_cvt_pk_bf16_f32 v174, v228, v229
    v_mfma_f32_16x16x32_bf16 v[204:207], a[116:119], v[148:151], v[204:207]
    v_cvt_pk_bf16_f32 v175, v230, v231
    v_cvt_pk_bf16_f32 v210, |v180|, |v181|
    v_mfma_f32_16x16x32_bf16 v[204:207], a[112:115], v[144:147], v[204:207]
    v_cvt_pk_bf16_f32 v211, |v182|, |v183|
    v_cvt_pk_bf16_f32 v212, |v184|, |v185|
    v_mfma_f32_16x16x32_bf16 v[176:179], a[0:3], v[160:163], v[112:115]
    v_cvt_pk_bf16_f32 v213, |v186|, |v187|
    v_cvt_pk_bf16_f32 v214, |v188|, |v189|
    v_mfma_f32_16x16x32_bf16 v[176:179], a[4:7], v[164:167], v[176:179]
    v_cvt_pk_bf16_f32 v215, |v190|, |v191|
    v_cvt_pk_bf16_f32 v216, |v192|, |v193|
    v_mfma_f32_16x16x32_bf16 v[176:179], a[8:11], v[168:171], v[176:179]
    v_cvt_pk_bf16_f32 v217, |v194|, |v195|
    v_cvt_pk_bf16_f32 v218, |v196|, |v197|
    v_mfma_f32_16x16x32_bf16 v[176:179], a[12:15], v[172:175], v[176:179]
    v_cvt_pk_bf16_f32 v219, |v198|, |v199|
    v_cvt_pk_bf16_f32 v220, |v200|, |v201|
    v_smfmac_f32_16x16x64_bf16 v[236:239], a[128:131], v[208:215], v1
    v_cvt_pk_bf16_f32 v221, |v202|, |v203|
    v_mfma_f32_16x16x32_bf16 v[180:183], a[28:31], v[172:175], v[116:119]
    s_waitcnt lgkmcnt(0)
    v_cvt_pk_bf16_f32 v222, |v204|, |v205|
    v_cvt_pk_bf16_f32 v223, |v206|, |v207|
    v_mfma_f32_16x16x32_bf16 v[180:183], a[24:27], v[168:171], v[180:183]
    v_mul_f32_dpp v224, v16, v16 row_ror:7 row_mask:0xf bank_mask:0xf
    v_mul_f32_dpp v225, v17, v17 row_ror:7 row_mask:0xf bank_mask:0xf
    v_mfma_f32_16x16x32_bf16 v[180:183], a[20:23], v[164:167], v[180:183]
    v_mul_f32_dpp v226, v18, v18 row_ror:7 row_mask:0xf bank_mask:0xf
    v_mul_f32_dpp v227, v19, v19 row_ror:7 row_mask:0xf bank_mask:0xf
    v_mfma_f32_16x16x32_bf16 v[180:183], a[16:19], v[160:163], v[180:183]
    v_mul_f32_dpp v228, v20, v20 row_ror:7 row_mask:0xf bank_mask:0xf
    v_mul_f32_dpp v229, v21, v21 row_ror:7 row_mask:0xf bank_mask:0xf
    v_smfmac_f32_16x16x64_bf16 v[236:239], a[132:135], v[216:223], v1
    v_mul_f32_dpp v230, v22, v22 row_ror:7 row_mask:0xf bank_mask:0xf
    v_mfma_f32_16x16x32_bf16 v[184:187], a[32:35], v[160:163], v[120:123]
    v_mul_f32_dpp v231, v23, v23 row_ror:7 row_mask:0xf bank_mask:0xf
    v_cvt_pk_bf16_f32 v144, v224, v225
    v_mfma_f32_16x16x32_bf16 v[184:187], a[36:39], v[164:167], v[184:187]
    v_cvt_pk_bf16_f32 v145, v226, v227
    v_cvt_pk_bf16_f32 v146, v228, v229
    v_mfma_f32_16x16x32_bf16 v[184:187], a[40:43], v[168:171], v[184:187]
    v_cvt_pk_bf16_f32 v147, v230, v231
    v_mul_f32_dpp v224, v24, v24 row_ror:7 row_mask:0xf bank_mask:0xf
    v_mfma_f32_16x16x32_bf16 v[184:187], a[44:47], v[172:175], v[184:187]
    v_mul_f32_dpp v225, v25, v25 row_ror:7 row_mask:0xf bank_mask:0xf
    v_mul_f32_dpp v226, v26, v26 row_ror:7 row_mask:0xf bank_mask:0xf
    v_smfmac_f32_16x16x64_bf16 v[236:239], a[152:155], v[160:167], v1
    v_mul_f32_dpp v227, v27, v27 row_ror:7 row_mask:0xf bank_mask:0xf
    v_mfma_f32_16x16x32_bf16 v[188:191], a[60:63], v[172:175], v[124:127]
    v_mul_f32_dpp v228, v28, v28 row_ror:7 row_mask:0xf bank_mask:0xf
    v_mul_f32_dpp v229, v29, v29 row_ror:7 row_mask:0xf bank_mask:0xf
    v_mfma_f32_16x16x32_bf16 v[188:191], a[56:59], v[168:171], v[188:191]
    v_mul_f32_dpp v230, v30, v30 row_ror:7 row_mask:0xf bank_mask:0xf
    v_mul_f32_dpp v231, v31, v31 row_ror:7 row_mask:0xf bank_mask:0xf
    v_mfma_f32_16x16x32_bf16 v[188:191], a[52:55], v[164:167], v[188:191]
    v_cvt_pk_bf16_f32 v208, |v176|, |v177|
    v_cvt_pk_bf16_f32 v209, |v178|, |v179|
    v_mfma_f32_16x16x32_bf16 v[188:191], a[48:51], v[160:163], v[188:191]
    v_cvt_pk_bf16_f32 v148, v224, v225
    v_cvt_pk_bf16_f32 v149, v226, v227
    v_smfmac_f32_16x16x64_bf16 v[236:239], a[156:159], v[168:175], v1
    v_cvt_pk_bf16_f32 v150, v228, v229
    v_mfma_f32_16x16x32_bf16 v[192:195], a[64:67], v[160:163], v[128:131]
    v_cvt_pk_bf16_f32 v151, v230, v231
    v_mul_f32_dpp v224, v32, v32 row_ror:7 row_mask:0xf bank_mask:0xf
    v_mfma_f32_16x16x32_bf16 v[192:195], a[68:71], v[164:167], v[192:195]
    v_mul_f32_dpp v225, v33, v33 row_ror:7 row_mask:0xf bank_mask:0xf
    v_mul_f32_dpp v226, v34, v34 row_ror:7 row_mask:0xf bank_mask:0xf
    v_mfma_f32_16x16x32_bf16 v[192:195], a[72:75], v[168:171], v[192:195]
    v_mul_f32_dpp v227, v35, v35 row_ror:7 row_mask:0xf bank_mask:0xf
    v_mul_f32_dpp v228, v36, v36 row_ror:7 row_mask:0xf bank_mask:0xf
    v_mfma_f32_16x16x32_bf16 v[192:195], a[76:79], v[172:175], v[192:195]
    v_mul_f32_dpp v229, v37, v37 row_ror:7 row_mask:0xf bank_mask:0xf
    v_mul_f32_dpp v230, v38, v38 row_ror:7 row_mask:0xf bank_mask:0xf
    v_mfma_f32_16x16x32_bf16 v[196:199], a[92:95], v[172:175], v[132:135]
    v_mul_f32_dpp v231, v39, v39 row_ror:7 row_mask:0xf bank_mask:0xf
    v_cvt_pk_bf16_f32 v152, v224, v225
    v_mfma_f32_16x16x32_bf16 v[196:199], a[88:91], v[168:171], v[196:199]
    v_cvt_pk_bf16_f32 v153, v226, v227
    v_cvt_pk_bf16_f32 v154, v228, v229
    v_mfma_f32_16x16x32_bf16 v[196:199], a[84:87], v[164:167], v[196:199]
    v_cvt_pk_bf16_f32 v155, v230, v231
    v_mul_f32_dpp v224, v40, v40 row_ror:7 row_mask:0xf bank_mask:0xf
    v_mfma_f32_16x16x32_bf16 v[196:199], a[80:83], v[160:163], v[196:199]
    v_mul_f32_dpp v225, v41, v41 row_ror:7 row_mask:0xf bank_mask:0xf
    v_mul_f32_dpp v226, v42, v42 row_ror:7 row_mask:0xf bank_mask:0xf
    v_mfma_f32_16x16x32_bf16 v[200:203], a[96:99], v[160:163], v[136:139]
    v_mul_f32_dpp v227, v43, v43 row_ror:7 row_mask:0xf bank_mask:0xf
    v_mul_f32_dpp v228, v44, v44 row_ror:7 row_mask:0xf bank_mask:0xf
    v_mfma_f32_16x16x32_bf16 v[200:203], a[100:103], v[164:167], v[200:203]
    v_mul_f32_dpp v229, v45, v45 row_ror:7 row_mask:0xf bank_mask:0xf
    v_mul_f32_dpp v230, v46, v46 row_ror:7 row_mask:0xf bank_mask:0xf
    v_mfma_f32_16x16x32_bf16 v[200:203], a[104:107], v[168:171], v[200:203]
    v_mul_f32_dpp v231, v47, v47 row_ror:7 row_mask:0xf bank_mask:0xf
    v_cvt_pk_bf16_f32 v156, v224, v225
    v_mfma_f32_16x16x32_bf16 v[200:203], a[108:111], v[172:175], v[200:203]
    v_cvt_pk_bf16_f32 v157, v226, v227
    v_cvt_pk_bf16_f32 v158, v228, v229
    v_mfma_f32_16x16x32_bf16 v[204:207], a[124:127], v[172:175], v[140:143]
    v_cvt_pk_bf16_f32 v159, v230, v231
    v_cvt_pk_bf16_f32 v210, |v180|, |v181|
    v_mfma_f32_16x16x32_bf16 v[204:207], a[120:123], v[168:171], v[204:207]
    v_cvt_pk_bf16_f32 v211, |v182|, |v183|
    v_cvt_pk_bf16_f32 v212, |v184|, |v185|
    v_mfma_f32_16x16x32_bf16 v[204:207], a[116:119], v[164:167], v[204:207]
    v_cvt_pk_bf16_f32 v213, |v186|, |v187|
    v_cvt_pk_bf16_f32 v214, |v188|, |v189|
    v_mfma_f32_16x16x32_bf16 v[204:207], a[112:115], v[160:163], v[204:207]
    v_cvt_pk_bf16_f32 v215, |v190|, |v191|
    v_cvt_pk_bf16_f32 v216, |v192|, |v193|
    v_mfma_f32_16x16x32_bf16 v[176:179], a[0:3], v[144:147], v[112:115]
    v_cvt_pk_bf16_f32 v217, |v194|, |v195|
    v_cvt_pk_bf16_f32 v218, |v196|, |v197|
    v_mfma_f32_16x16x32_bf16 v[176:179], a[4:7], v[148:151], v[176:179]
    v_cvt_pk_bf16_f32 v219, |v198|, |v199|
    v_cvt_pk_bf16_f32 v220, |v200|, |v201|
    v_mfma_f32_16x16x32_bf16 v[176:179], a[8:11], v[152:155], v[176:179]
    v_cvt_pk_bf16_f32 v221, |v202|, |v203|
    v_cvt_pk_bf16_f32 v222, |v204|, |v205|
    v_mfma_f32_16x16x32_bf16 v[176:179], a[12:15], v[156:159], v[176:179]
    v_cvt_pk_bf16_f32 v223, |v206|, |v207|
    v_lshlrev_b32 v48, 16, v64
    v_smfmac_f32_16x16x64_bf16 v[236:239], a[144:147], v[208:215], v1
    v_and_b32 v49, 0xffff0000, v64
    v_mfma_f32_16x16x32_bf16 v[180:183], a[28:31], v[156:159], v[116:119]
    v_lshlrev_b32 v50, 16, v65
    v_and_b32 v51, 0xffff0000, v65
    v_mfma_f32_16x16x32_bf16 v[180:183], a[24:27], v[152:155], v[180:183]
    v_lshlrev_b32 v52, 16, v66
    v_and_b32 v53, 0xffff0000, v66
    v_mfma_f32_16x16x32_bf16 v[180:183], a[20:23], v[148:151], v[180:183]
    v_lshlrev_b32 v54, 16, v67
    v_and_b32 v55, 0xffff0000, v67
    v_mfma_f32_16x16x32_bf16 v[180:183], a[16:19], v[144:147], v[180:183]
    v_lshlrev_b32 v56, 16, v68
    v_and_b32 v57, 0xffff0000, v68
    v_smfmac_f32_16x16x64_bf16 v[236:239], a[148:151], v[216:223], v1
    v_lshlrev_b32 v58, 16, v69
    v_mfma_f32_16x16x32_bf16 v[184:187], a[32:35], v[144:147], v[120:123]
    v_and_b32 v59, 0xffff0000, v69
    v_lshlrev_b32 v60, 16, v70
    v_mfma_f32_16x16x32_bf16 v[184:187], a[36:39], v[148:151], v[184:187]
    v_and_b32 v61, 0xffff0000, v70
    v_lshlrev_b32 v62, 16, v71
    v_mfma_f32_16x16x32_bf16 v[184:187], a[40:43], v[152:155], v[184:187]
    v_and_b32 v63, 0xffff0000, v71
    v_mul_f32_dpp v224, v48, v16 row_newbcast:14 row_mask:0xf bank_mask:0xf
    v_mfma_f32_16x16x32_bf16 v[184:187], a[44:47], v[156:159], v[184:187]
    v_mul_f32_dpp v225, v49, v17 row_newbcast:14 row_mask:0xf bank_mask:0xf
    v_mul_f32_dpp v226, v50, v18 row_newbcast:14 row_mask:0xf bank_mask:0xf
    v_smfmac_f32_16x16x64_bf16 v[236:239], a[168:171], v[144:151], v1
    v_mul_f32_dpp v227, v51, v19 row_newbcast:14 row_mask:0xf bank_mask:0xf
    v_mfma_f32_16x16x32_bf16 v[188:191], a[60:63], v[156:159], v[124:127]
    v_mul_f32_dpp v228, v52, v20 row_newbcast:14 row_mask:0xf bank_mask:0xf
    v_mul_f32_dpp v229, v53, v21 row_newbcast:14 row_mask:0xf bank_mask:0xf
    v_mfma_f32_16x16x32_bf16 v[188:191], a[56:59], v[152:155], v[188:191]
    v_mul_f32_dpp v230, v54, v22 row_newbcast:14 row_mask:0xf bank_mask:0xf
    v_mul_f32_dpp v231, v55, v23 row_newbcast:14 row_mask:0xf bank_mask:0xf
    v_mfma_f32_16x16x32_bf16 v[188:191], a[52:55], v[148:151], v[188:191]
    v_lshlrev_b32 v64, 16, v72
    v_and_b32 v65, 0xffff0000, v72
    v_mfma_f32_16x16x32_bf16 v[188:191], a[48:51], v[144:147], v[188:191]
    v_lshlrev_b32 v66, 16, v73
    v_and_b32 v67, 0xffff0000, v73
    v_smfmac_f32_16x16x64_bf16 v[236:239], a[172:175], v[152:159], v1
    v_lshlrev_b32 v68, 16, v74
    v_mfma_f32_16x16x32_bf16 v[192:195], a[64:67], v[144:147], v[128:131]
    v_and_b32 v69, 0xffff0000, v74
    v_lshlrev_b32 v70, 16, v75
    v_mfma_f32_16x16x32_bf16 v[192:195], a[68:71], v[148:151], v[192:195]
    v_and_b32 v71, 0xffff0000, v75
    v_cvt_pk_bf16_f32 v160, v224, v225
    v_mfma_f32_16x16x32_bf16 v[192:195], a[72:75], v[152:155], v[192:195]
    v_cvt_pk_bf16_f32 v161, v226, v227
    v_cvt_pk_bf16_f32 v162, v228, v229
    v_mfma_f32_16x16x32_bf16 v[192:195], a[76:79], v[156:159], v[192:195]
    v_cvt_pk_bf16_f32 v163, v230, v231
    v_lshlrev_b32 v72, 16, v76
    v_mfma_f32_16x16x32_bf16 v[196:199], a[92:95], v[156:159], v[132:135]
    v_and_b32 v73, 0xffff0000, v76
    v_lshlrev_b32 v74, 16, v77
    v_mfma_f32_16x16x32_bf16 v[196:199], a[88:91], v[152:155], v[196:199]
    v_and_b32 v75, 0xffff0000, v77
    v_lshlrev_b32 v76, 16, v78
    v_mfma_f32_16x16x32_bf16 v[196:199], a[84:87], v[148:151], v[196:199]
    v_and_b32 v77, 0xffff0000, v78
    v_mul_f32_dpp v224, v56, v24 row_newbcast:14 row_mask:0xf bank_mask:0xf
    v_mfma_f32_16x16x32_bf16 v[196:199], a[80:83], v[144:147], v[196:199]
    v_mul_f32_dpp v225, v57, v25 row_newbcast:14 row_mask:0xf bank_mask:0xf
    v_mul_f32_dpp v226, v58, v26 row_newbcast:14 row_mask:0xf bank_mask:0xf
    v_mfma_f32_16x16x32_bf16 v[200:203], a[96:99], v[144:147], v[136:139]
    v_mul_f32_dpp v227, v59, v27 row_newbcast:14 row_mask:0xf bank_mask:0xf
    v_mul_f32_dpp v228, v60, v28 row_newbcast:14 row_mask:0xf bank_mask:0xf
    v_mfma_f32_16x16x32_bf16 v[200:203], a[100:103], v[148:151], v[200:203]
    v_mul_f32_dpp v229, v61, v29 row_newbcast:14 row_mask:0xf bank_mask:0xf
    v_mul_f32_dpp v230, v62, v30 row_newbcast:14 row_mask:0xf bank_mask:0xf
    v_mfma_f32_16x16x32_bf16 v[200:203], a[104:107], v[152:155], v[200:203]
    v_mul_f32_dpp v231, v63, v31 row_newbcast:14 row_mask:0xf bank_mask:0xf
    v_cvt_pk_bf16_f32 v208, |v176|, |v177|
    v_mfma_f32_16x16x32_bf16 v[200:203], a[108:111], v[156:159], v[200:203]
    v_cvt_pk_bf16_f32 v209, |v178|, |v179|
    v_lshlrev_b32 v78, 16, v79
    v_mfma_f32_16x16x32_bf16 v[204:207], a[124:127], v[156:159], v[140:143]
    v_cvt_pk_bf16_f32 v164, v224, v225
    v_cvt_pk_bf16_f32 v165, v226, v227
    v_mfma_f32_16x16x32_bf16 v[204:207], a[120:123], v[152:155], v[204:207]
    v_cvt_pk_bf16_f32 v166, v228, v229
    v_cvt_pk_bf16_f32 v167, v230, v231
    v_mfma_f32_16x16x32_bf16 v[204:207], a[116:119], v[148:151], v[204:207]
    v_and_b32 v79, 0xffff0000, v79
    v_mul_f32_dpp v224, v64, v32 row_newbcast:14 row_mask:0xf bank_mask:0xf
    v_mfma_f32_16x16x32_bf16 v[204:207], a[112:115], v[144:147], v[204:207]
    v_mul_f32_dpp v225, v65, v33 row_newbcast:14 row_mask:0xf bank_mask:0xf
    v_mul_f32_dpp v226, v66, v34 row_newbcast:14 row_mask:0xf bank_mask:0xf
    v_mfma_f32_16x16x32_bf16 v[176:179], a[0:3], v[160:163], v[112:115]
    v_mul_f32_dpp v227, v67, v35 row_newbcast:14 row_mask:0xf bank_mask:0xf
    v_mul_f32_dpp v228, v68, v36 row_newbcast:14 row_mask:0xf bank_mask:0xf
    v_mfma_f32_16x16x32_bf16 v[176:179], a[4:7], v[164:167], v[176:179]
    v_mul_f32_dpp v229, v69, v37 row_newbcast:14 row_mask:0xf bank_mask:0xf
    v_mul_f32_dpp v230, v70, v38 row_newbcast:14 row_mask:0xf bank_mask:0xf
    v_mul_f32_dpp v231, v71, v39 row_newbcast:14 row_mask:0xf bank_mask:0xf
    v_cvt_pk_bf16_f32 v168, v224, v225
    v_cvt_pk_bf16_f32 v169, v226, v227
    v_cvt_pk_bf16_f32 v170, v228, v229
    v_cvt_pk_bf16_f32 v171, v230, v231
    v_mul_f32_dpp v224, v72, v40 row_newbcast:14 row_mask:0xf bank_mask:0xf
    v_mul_f32_dpp v225, v73, v41 row_newbcast:14 row_mask:0xf bank_mask:0xf
    v_mfma_f32_16x16x32_bf16 v[176:179], a[8:11], v[168:171], v[176:179]
    v_mul_f32_dpp v226, v74, v42 row_newbcast:14 row_mask:0xf bank_mask:0xf
    v_mul_f32_dpp v227, v75, v43 row_newbcast:14 row_mask:0xf bank_mask:0xf
    v_mul_f32_dpp v228, v76, v44 row_newbcast:14 row_mask:0xf bank_mask:0xf
    v_mul_f32_dpp v229, v77, v45 row_newbcast:14 row_mask:0xf bank_mask:0xf
    v_mul_f32_dpp v230, v78, v46 row_newbcast:14 row_mask:0xf bank_mask:0xf
    v_mul_f32_dpp v231, v79, v47 row_newbcast:14 row_mask:0xf bank_mask:0xf
    v_cvt_pk_bf16_f32 v172, v224, v225
    v_cvt_pk_bf16_f32 v173, v226, v227
    v_cvt_pk_bf16_f32 v174, v228, v229
    v_cvt_pk_bf16_f32 v175, v230, v231
    v_cvt_pk_bf16_f32 v210, |v180|, |v181|
    v_cvt_pk_bf16_f32 v211, |v182|, |v183|
    v_mfma_f32_16x16x32_bf16 v[176:179], a[12:15], v[172:175], v[176:179]
    v_cvt_pk_bf16_f32 v212, |v184|, |v185|
    v_cvt_pk_bf16_f32 v213, |v186|, |v187|
    v_mfma_f32_16x16x32_bf16 v[180:183], a[28:31], v[172:175], v[116:119]
    v_cvt_pk_bf16_f32 v214, |v188|, |v189|
    v_cvt_pk_bf16_f32 v215, |v190|, |v191|
    v_mfma_f32_16x16x32_bf16 v[180:183], a[24:27], v[168:171], v[180:183]
    v_cvt_pk_bf16_f32 v216, |v192|, |v193|
    v_cvt_pk_bf16_f32 v217, |v194|, |v195|
    v_mfma_f32_16x16x32_bf16 v[180:183], a[20:23], v[164:167], v[180:183]
    v_cvt_pk_bf16_f32 v218, |v196|, |v197|
    v_cvt_pk_bf16_f32 v219, |v198|, |v199|
    v_mfma_f32_16x16x32_bf16 v[180:183], a[16:19], v[160:163], v[180:183]
    v_cvt_pk_bf16_f32 v220, |v200|, |v201|
    v_cvt_pk_bf16_f32 v221, |v202|, |v203|
    v_smfmac_f32_16x16x64_bf16 v[236:239], a[160:163], v[208:215], v1
    v_cvt_pk_bf16_f32 v222, |v204|, |v205|
    v_mfma_f32_16x16x32_bf16 v[184:187], a[32:35], v[160:163], v[120:123]
    v_cvt_pk_bf16_f32 v223, |v206|, |v207|
    v_mul_f32_dpp v224, v48, v16 row_newbcast:2 row_mask:0xf bank_mask:0xf
    v_mfma_f32_16x16x32_bf16 v[184:187], a[36:39], v[164:167], v[184:187]
    v_mul_f32_dpp v225, v49, v17 row_newbcast:2 row_mask:0xf bank_mask:0xf
    v_mul_f32_dpp v226, v50, v18 row_newbcast:2 row_mask:0xf bank_mask:0xf
    v_mfma_f32_16x16x32_bf16 v[184:187], a[40:43], v[168:171], v[184:187]
    v_mul_f32_dpp v227, v51, v19 row_newbcast:2 row_mask:0xf bank_mask:0xf
    v_mul_f32_dpp v228, v52, v20 row_newbcast:2 row_mask:0xf bank_mask:0xf
    v_mfma_f32_16x16x32_bf16 v[184:187], a[44:47], v[172:175], v[184:187]
    v_mul_f32_dpp v229, v53, v21 row_newbcast:2 row_mask:0xf bank_mask:0xf
    v_mul_f32_dpp v230, v54, v22 row_newbcast:2 row_mask:0xf bank_mask:0xf
    v_smfmac_f32_16x16x64_bf16 v[236:239], a[164:167], v[216:223], v1
    v_mul_f32_dpp v231, v55, v23 row_newbcast:2 row_mask:0xf bank_mask:0xf
    v_mfma_f32_16x16x32_bf16 v[188:191], a[60:63], v[172:175], v[124:127]
    v_cvt_pk_bf16_f32 v144, v224, v225
    v_cvt_pk_bf16_f32 v145, v226, v227
    v_mfma_f32_16x16x32_bf16 v[188:191], a[56:59], v[168:171], v[188:191]
    v_cvt_pk_bf16_f32 v146, v228, v229
    v_cvt_pk_bf16_f32 v147, v230, v231
    v_mfma_f32_16x16x32_bf16 v[188:191], a[52:55], v[164:167], v[188:191]
    v_mul_f32_dpp v224, v56, v24 row_newbcast:2 row_mask:0xf bank_mask:0xf
    v_mul_f32_dpp v225, v57, v25 row_newbcast:2 row_mask:0xf bank_mask:0xf
    v_mfma_f32_16x16x32_bf16 v[188:191], a[48:51], v[160:163], v[188:191]
    v_mul_f32_dpp v226, v58, v26 row_newbcast:2 row_mask:0xf bank_mask:0xf
    v_mul_f32_dpp v227, v59, v27 row_newbcast:2 row_mask:0xf bank_mask:0xf
    v_smfmac_f32_16x16x64_bf16 v[236:239], a[184:187], v[160:167], v1
    v_mul_f32_dpp v228, v60, v28 row_newbcast:2 row_mask:0xf bank_mask:0xf
    v_mfma_f32_16x16x32_bf16 v[192:195], a[64:67], v[160:163], v[128:131]
    v_mul_f32_dpp v229, v61, v29 row_newbcast:2 row_mask:0xf bank_mask:0xf
    v_mul_f32_dpp v230, v62, v30 row_newbcast:2 row_mask:0xf bank_mask:0xf
    v_mfma_f32_16x16x32_bf16 v[192:195], a[68:71], v[164:167], v[192:195]
    v_mul_f32_dpp v231, v63, v31 row_newbcast:2 row_mask:0xf bank_mask:0xf
    v_cvt_pk_bf16_f32 v208, |v176|, |v177|
    v_mfma_f32_16x16x32_bf16 v[192:195], a[72:75], v[168:171], v[192:195]
    v_cvt_pk_bf16_f32 v209, |v178|, |v179|
    v_cvt_pk_bf16_f32 v148, v224, v225
    v_mfma_f32_16x16x32_bf16 v[192:195], a[76:79], v[172:175], v[192:195]
    v_cvt_pk_bf16_f32 v149, v226, v227
    v_cvt_pk_bf16_f32 v150, v228, v229
    v_smfmac_f32_16x16x64_bf16 v[236:239], a[188:191], v[168:175], v1
    v_cvt_pk_bf16_f32 v151, v230, v231
    v_mfma_f32_16x16x32_bf16 v[196:199], a[92:95], v[172:175], v[132:135]
    v_mul_f32_dpp v224, v64, v32 row_newbcast:2 row_mask:0xf bank_mask:0xf
    v_mul_f32_dpp v225, v65, v33 row_newbcast:2 row_mask:0xf bank_mask:0xf
    v_mfma_f32_16x16x32_bf16 v[196:199], a[88:91], v[168:171], v[196:199]
    v_mul_f32_dpp v226, v66, v34 row_newbcast:2 row_mask:0xf bank_mask:0xf
    v_mul_f32_dpp v227, v67, v35 row_newbcast:2 row_mask:0xf bank_mask:0xf
    v_mfma_f32_16x16x32_bf16 v[196:199], a[84:87], v[164:167], v[196:199]
    v_mul_f32_dpp v228, v68, v36 row_newbcast:2 row_mask:0xf bank_mask:0xf
    v_mul_f32_dpp v229, v69, v37 row_newbcast:2 row_mask:0xf bank_mask:0xf
    v_mfma_f32_16x16x32_bf16 v[196:199], a[80:83], v[160:163], v[196:199]
    v_mul_f32_dpp v230, v70, v38 row_newbcast:2 row_mask:0xf bank_mask:0xf
    v_mul_f32_dpp v231, v71, v39 row_newbcast:2 row_mask:0xf bank_mask:0xf
    v_smfmac_f32_16x16x64_bf16 v[240:243], a[136:139], v[144:151], v1
    v_cvt_pk_bf16_f32 v152, v224, v225
    v_mfma_f32_16x16x32_bf16 v[200:203], a[96:99], v[160:163], v[136:139]
    v_cvt_pk_bf16_f32 v153, v226, v227
    v_cvt_pk_bf16_f32 v154, v228, v229
    v_mfma_f32_16x16x32_bf16 v[200:203], a[100:103], v[164:167], v[200:203]
    v_cvt_pk_bf16_f32 v155, v230, v231
    v_mul_f32_dpp v224, v72, v40 row_newbcast:2 row_mask:0xf bank_mask:0xf
    v_mfma_f32_16x16x32_bf16 v[200:203], a[104:107], v[168:171], v[200:203]
    v_mul_f32_dpp v225, v73, v41 row_newbcast:2 row_mask:0xf bank_mask:0xf
    v_mul_f32_dpp v226, v74, v42 row_newbcast:2 row_mask:0xf bank_mask:0xf
    v_mfma_f32_16x16x32_bf16 v[200:203], a[108:111], v[172:175], v[200:203]
    v_mul_f32_dpp v227, v75, v43 row_newbcast:2 row_mask:0xf bank_mask:0xf
    v_mul_f32_dpp v228, v76, v44 row_newbcast:2 row_mask:0xf bank_mask:0xf
    v_mfma_f32_16x16x32_bf16 v[204:207], a[124:127], v[172:175], v[140:143]
    v_mul_f32_dpp v229, v77, v45 row_newbcast:2 row_mask:0xf bank_mask:0xf
    v_mul_f32_dpp v230, v78, v46 row_newbcast:2 row_mask:0xf bank_mask:0xf
    v_mfma_f32_16x16x32_bf16 v[204:207], a[120:123], v[168:171], v[204:207]
L_stub1:
    s_cbranch_scc1 L_main2
    v_mul_f32_dpp v231, v79, v47 row_newbcast:2 row_mask:0xf bank_mask:0xf
    v_cvt_pk_bf16_f32 v156, v224, v225
    v_mfma_f32_16x16x32_bf16 v[204:207], a[116:119], v[164:167], v[204:207]
    v_cvt_pk_bf16_f32 v157, v226, v227
    v_cvt_pk_bf16_f32 v158, v228, v229
    v_mfma_f32_16x16x32_bf16 v[204:207], a[112:115], v[160:163], v[204:207]
    v_cvt_pk_bf16_f32 v159, v230, v231
    v_cvt_pk_bf16_f32 v210, |v180|, |v181|
    v_mfma_f32_16x16x32_bf16 v[176:179], a[0:3], v[144:147], v[112:115]
    v_cvt_pk_bf16_f32 v211, |v182|, |v183|
    v_cvt_pk_bf16_f32 v212, |v184|, |v185|
    v_mfma_f32_16x16x32_bf16 v[176:179], a[4:7], v[148:151], v[176:179]
    v_cvt_pk_bf16_f32 v213, |v186|, |v187|
    v_cvt_pk_bf16_f32 v214, |v188|, |v189|
    v_mfma_f32_16x16x32_bf16 v[176:179], a[8:11], v[152:155], v[176:179]
    v_cvt_pk_bf16_f32 v215, |v190|, |v191|
    v_cvt_pk_bf16_f32 v216, |v192|, |v193|
    v_mfma_f32_16x16x32_bf16 v[176:179], a[12:15], v[156:159], v[176:179]
    v_cvt_pk_bf16_f32 v217, |v194|, |v195|
    v_cvt_pk_bf16_f32 v218, |v196|, |v197|
    v_smfmac_f32_16x16x64_bf16 v[236:239], a[176:179], v[208:215], v1
    v_cvt_pk_bf16_f32 v219, |v198|, |v199|
    v_mfma_f32_16x16x32_bf16 v[180:183], a[28:31], v[156:159], v[116:119]
    v_cvt_pk_bf16_f32 v220, |v200|, |v201|
    v_cvt_pk_bf16_f32 v221, |v202|, |v203|
    v_mfma_f32_16x16x32_bf16 v[180:183], a[24:27], v[152:155], v[180:183]
    v_cvt_pk_bf16_f32 v222, |v204|, |v205|
    v_cvt_pk_bf16_f32 v223, |v206|, |v207|
    v_mfma_f32_16x16x32_bf16 v[180:183], a[20:23], v[148:151], v[180:183]
    v_mul_f32_dpp v224, v48, v16 row_newbcast:5 row_mask:0xf bank_mask:0xf
    v_mul_f32_dpp v225, v49, v17 row_newbcast:5 row_mask:0xf bank_mask:0xf
    v_mfma_f32_16x16x32_bf16 v[180:183], a[16:19], v[144:147], v[180:183]
    v_mul_f32_dpp v226, v50, v18 row_newbcast:5 row_mask:0xf bank_mask:0xf
    v_mul_f32_dpp v227, v51, v19 row_newbcast:5 row_mask:0xf bank_mask:0xf
    v_smfmac_f32_16x16x64_bf16 v[236:239], a[180:183], v[216:223], v1
    v_mul_f32_dpp v228, v52, v20 row_newbcast:5 row_mask:0xf bank_mask:0xf
    v_mfma_f32_16x16x32_bf16 v[184:187], a[32:35], v[144:147], v[120:123]
    v_mul_f32_dpp v229, v53, v21 row_newbcast:5 row_mask:0xf bank_mask:0xf
    v_mul_f32_dpp v230, v54, v22 row_newbcast:5 row_mask:0xf bank_mask:0xf
    v_mfma_f32_16x16x32_bf16 v[184:187], a[36:39], v[148:151], v[184:187]
    v_mul_f32_dpp v231, v55, v23 row_newbcast:5 row_mask:0xf bank_mask:0xf
    v_cvt_pk_bf16_f32 v160, v224, v225
    v_mfma_f32_16x16x32_bf16 v[184:187], a[40:43], v[152:155], v[184:187]
    s_waitcnt vmcnt(0)
    v_cvt_pk_bf16_f32 v161, v226, v227
    v_cvt_pk_bf16_f32 v162, v228, v229
    v_mfma_f32_16x16x32_bf16 v[184:187], a[44:47], v[156:159], v[184:187]
    ds_read_b128 v[96:99], v6 offset:0
    v_cvt_pk_bf16_f32 v163, v230, v231
    v_smfmac_f32_16x16x64_bf16 v[240:243], a[140:143], v[152:159], v1
    v_mul_f32_dpp v224, v56, v24 row_newbcast:5 row_mask:0xf bank_mask:0xf
    v_mfma_f32_16x16x32_bf16 v[188:191], a[60:63], v[156:159], v[124:127]
    ds_read_b128 v[100:103], v6 offset:64
    v_mul_f32_dpp v225, v57, v25 row_newbcast:5 row_mask:0xf bank_mask:0xf
    v_mfma_f32_16x16x32_bf16 v[188:191], a[56:59], v[152:155], v[188:191]
    ds_read_b128 v[104:107], v6 offset:128
    v_mul_f32_dpp v226, v58, v26 row_newbcast:5 row_mask:0xf bank_mask:0xf
    v_mfma_f32_16x16x32_bf16 v[188:191], a[52:55], v[148:151], v[188:191]
    ds_read_b128 v[108:111], v6 offset:192
    v_mul_f32_dpp v227, v59, v27 row_newbcast:5 row_mask:0xf bank_mask:0xf
    v_mfma_f32_16x16x32_bf16 v[188:191], a[48:51], v[144:147], v[188:191]
    v_mul_f32_dpp v228, v60, v28 row_newbcast:5 row_mask:0xf bank_mask:0xf
    v_mul_f32_dpp v229, v61, v29 row_newbcast:5 row_mask:0xf bank_mask:0xf
    v_mfma_f32_16x16x32_bf16 v[192:195], a[64:67], v[144:147], v[128:131]
    v_mul_f32_dpp v230, v62, v30 row_newbcast:5 row_mask:0xf bank_mask:0xf
    v_mul_f32_dpp v231, v63, v31 row_newbcast:5 row_mask:0xf bank_mask:0xf
    v_mfma_f32_16x16x32_bf16 v[192:195], a[68:71], v[148:151], v[192:195]
    v_cvt_pk_bf16_f32 v208, |v176|, |v177|
    v_cvt_pk_bf16_f32 v209, |v178|, |v179|
    v_mfma_f32_16x16x32_bf16 v[192:195], a[72:75], v[152:155], v[192:195]
    v_cvt_pk_bf16_f32 v164, v224, v225
    v_cvt_pk_bf16_f32 v165, v226, v227
    v_mfma_f32_16x16x32_bf16 v[192:195], a[76:79], v[156:159], v[192:195]
    v_cvt_pk_bf16_f32 v166, v228, v229
    v_cvt_pk_bf16_f32 v167, v230, v231
    v_mfma_f32_16x16x32_bf16 v[196:199], a[92:95], v[156:159], v[132:135]
    v_mul_f32_dpp v224, v64, v32 row_newbcast:5 row_mask:0xf bank_mask:0xf
    v_mul_f32_dpp v225, v65, v33 row_newbcast:5 row_mask:0xf bank_mask:0xf
    v_mfma_f32_16x16x32_bf16 v[196:199], a[88:91], v[152:155], v[196:199]
    v_mul_f32_dpp v226, v66, v34 row_newbcast:5 row_mask:0xf bank_mask:0xf
    v_mul_f32_dpp v227, v67, v35 row_newbcast:5 row_mask:0xf bank_mask:0xf
    v_mfma_f32_16x16x32_bf16 v[196:199], a[84:87], v[148:151], v[196:199]
    v_mul_f32_dpp v228, v68, v36 row_newbcast:5 row_mask:0xf bank_mask:0xf
    v_mul_f32_dpp v229, v69, v37 row_newbcast:5 row_mask:0xf bank_mask:0xf
    v_mfma_f32_16x16x32_bf16 v[196:199], a[80:83], v[144:147], v[196:199]
    s_waitcnt lgkmcnt(0)
    v_mul_f32_dpp v230, v70, v38 row_newbcast:5 row_mask:0xf bank_mask:0xf
    v_mul_f32_dpp v231, v71, v39 row_newbcast:5 row_mask:0xf bank_mask:0xf
    v_mfma_f32_16x16x32_bf16 v[200:203], a[96:99], v[144:147], v[136:139]
    v_cvt_pk_bf16_f32 v168, v224, v225
    v_cvt_pk_bf16_f32 v169, v226, v227
    v_mfma_f32_16x16x32_bf16 v[200:203], a[100:103], v[148:151], v[200:203]
    v_cvt_pk_bf16_f32 v170, v228, v229
    v_cvt_pk_bf16_f32 v171, v230, v231
    v_mfma_f32_16x16x32_bf16 v[200:203], a[104:107], v[152:155], v[200:203]
    v_mul_f32_dpp v224, v72, v40 row_newbcast:5 row_mask:0xf bank_mask:0xf
    v_mul_f32_dpp v225, v73, v41 row_newbcast:5 row_mask:0xf bank_mask:0xf
    v_mfma_f32_16x16x32_bf16 v[200:203], a[108:111], v[156:159], v[200:203]
    v_mul_f32_dpp v226, v74, v42 row_newbcast:5 row_mask:0xf bank_mask:0xf
    v_mul_f32_dpp v227, v75, v43 row_newbcast:5 row_mask:0xf bank_mask:0xf
    v_mfma_f32_16x16x32_bf16 v[204:207], a[124:127], v[156:159], v[140:143]
    v_mul_f32_dpp v228, v76, v44 row_newbcast:5 row_mask:0xf bank_mask:0xf
    v_mul_f32_dpp v229, v77, v45 row_newbcast:5 row_mask:0xf bank_mask:0xf
    v_mfma_f32_16x16x32_bf16 v[204:207], a[120:123], v[152:155], v[204:207]
    v_mul_f32_dpp v230, v78, v46 row_newbcast:5 row_mask:0xf bank_mask:0xf
    v_mul_f32_dpp v231, v79, v47 row_newbcast:5 row_mask:0xf bank_mask:0xf
    v_mfma_f32_16x16x32_bf16 v[204:207], a[116:119], v[148:151], v[204:207]
    v_cvt_pk_bf16_f32 v172, v224, v225
    v_cvt_pk_bf16_f32 v173, v226, v227
    v_mfma_f32_16x16x32_bf16 v[204:207], a[112:115], v[144:147], v[204:207]
    v_cvt_pk_bf16_f32 v174, v228, v229
    v_cvt_pk_bf16_f32 v175, v230, v231
    v_mfma_f32_16x16x32_bf16 v[176:179], a[0:3], v[160:163], v[112:115]
    v_cvt_pk_bf16_f32 v210, |v180|, |v181|
    v_cvt_pk_bf16_f32 v211, |v182|, |v183|
    v_mfma_f32_16x16x32_bf16 v[176:179], a[4:7], v[164:167], v[176:179]
    v_cvt_pk_bf16_f32 v212, |v184|, |v185|
    v_cvt_pk_bf16_f32 v213, |v186|, |v187|
    v_mfma_f32_16x16x32_bf16 v[176:179], a[8:11], v[168:171], v[176:179]
    v_cvt_pk_bf16_f32 v214, |v188|, |v189|
    v_cvt_pk_bf16_f32 v215, |v190|, |v191|
    v_mfma_f32_16x16x32_bf16 v[176:179], a[12:15], v[172:175], v[176:179]
    v_cvt_pk_bf16_f32 v216, |v192|, |v193|
    v_cvt_pk_bf16_f32 v217, |v194|, |v195|
    v_smfmac_f32_16x16x64_bf16 v[240:243], a[128:131], v[208:215], v1
    v_cvt_pk_bf16_f32 v218, |v196|, |v197|
    v_mfma_f32_16x16x32_bf16 v[180:183], a[28:31], v[172:175], v[116:119]
    v_cvt_pk_bf16_f32 v219, |v198|, |v199|
    v_cvt_pk_bf16_f32 v220, |v200|, |v201|
    v_mfma_f32_16x16x32_bf16 v[180:183], a[24:27], v[168:171], v[180:183]
    v_cvt_pk_bf16_f32 v221, |v202|, |v203|
    v_cvt_pk_bf16_f32 v222, |v204|, |v205|
    v_mfma_f32_16x16x32_bf16 v[180:183], a[20:23], v[164:167], v[180:183]
    v_cvt_pk_bf16_f32 v223, |v206|, |v207|
    v_mul_f32_dpp v224, v48, v16 row_newbcast:7 row_mask:0xf bank_mask:0xf
    v_mfma_f32_16x16x32_bf16 v[180:183], a[16:19], v[160:163], v[180:183]
    v_mul_f32_dpp v225, v49, v17 row_newbcast:7 row_mask:0xf bank_mask:0xf
    v_mul_f32_dpp v226, v50, v18 row_newbcast:7 row_mask:0xf bank_mask:0xf
    v_smfmac_f32_16x16x64_bf16 v[240:243], a[132:135], v[216:223], v1
    v_mul_f32_dpp v227, v51, v19 row_newbcast:7 row_mask:0xf bank_mask:0xf
    v_mfma_f32_16x16x32_bf16 v[184:187], a[32:35], v[160:163], v[120:123]
    v_mul_f32_dpp v228, v52, v20 row_newbcast:7 row_mask:0xf bank_mask:0xf
    v_mul_f32_dpp v229, v53, v21 row_newbcast:7 row_mask:0xf bank_mask:0xf
    v_mfma_f32_16x16x32_bf16 v[184:187], a[36:39], v[164:167], v[184:187]
    v_mul_f32_dpp v230, v54, v22 row_newbcast:7 row_mask:0xf bank_mask:0xf
    v_mul_f32_dpp v231, v55, v23 row_newbcast:7 row_mask:0xf bank_mask:0xf
    v_mfma_f32_16x16x32_bf16 v[184:187], a[40:43], v[168:171], v[184:187]
    v_cvt_pk_bf16_f32 v144, v224, v225
    v_cvt_pk_bf16_f32 v145, v226, v227
    v_mfma_f32_16x16x32_bf16 v[184:187], a[44:47], v[172:175], v[184:187]
    v_cvt_pk_bf16_f32 v146, v228, v229
    v_cvt_pk_bf16_f32 v147, v230, v231
    v_smfmac_f32_16x16x64_bf16 v[240:243], a[152:155], v[160:167], v1
    v_mul_f32_dpp v224, v56, v24 row_newbcast:7 row_mask:0xf bank_mask:0xf
    v_mfma_f32_16x16x32_bf16 v[188:191], a[60:63], v[172:175], v[124:127]
    v_mul_f32_dpp v225, v57, v25 row_newbcast:7 row_mask:0xf bank_mask:0xf
    v_mul_f32_dpp v226, v58, v26 row_newbcast:7 row_mask:0xf bank_mask:0xf
    v_mfma_f32_16x16x32_bf16 v[188:191], a[56:59], v[168:171], v[188:191]
    v_mul_f32_dpp v227, v59, v27 row_newbcast:7 row_mask:0xf bank_mask:0xf
    v_mul_f32_dpp v228, v60, v28 row_newbcast:7 row_mask:0xf bank_mask:0xf
    v_mfma_f32_16x16x32_bf16 v[188:191], a[52:55], v[164:167], v[188:191]
    v_mul_f32_dpp v229, v61, v29 row_newbcast:7 row_mask:0xf bank_mask:0xf
    v_mul_f32_dpp v230, v62, v30 row_newbcast:7 row_mask:0xf bank_mask:0xf
    v_mfma_f32_16x16x32_bf16 v[188:191], a[48:51], v[160:163], v[188:191]
    v_mul_f32_dpp v231, v63, v31 row_newbcast:7 row_mask:0xf bank_mask:0xf
    v_cvt_pk_bf16_f32 v208, |v176|, |v177|
    v_smfmac_f32_16x16x64_bf16 v[240:243], a[156:159], v[168:175], v1
    v_cvt_pk_bf16_f32 v209, |v178|, |v179|
    v_mfma_f32_16x16x32_bf16 v[192:195], a[64:67], v[160:163], v[128:131]
    v_cvt_pk_bf16_f32 v148, v224, v225
    v_cvt_pk_bf16_f32 v149, v226, v227
    v_mfma_f32_16x16x32_bf16 v[192:195], a[68:71], v[164:167], v[192:195]
    v_cvt_pk_bf16_f32 v150, v228, v229
    v_cvt_pk_bf16_f32 v151, v230, v231
    v_mfma_f32_16x16x32_bf16 v[192:195], a[72:75], v[168:171], v[192:195]
    v_mul_f32_dpp v224, v64, v32 row_newbcast:7 row_mask:0xf bank_mask:0xf
    v_mul_f32_dpp v225, v65, v33 row_newbcast:7 row_mask:0xf bank_mask:0xf
    v_mfma_f32_16x16x32_bf16 v[192:195], a[76:79], v[172:175], v[192:195]
    v_mul_f32_dpp v226, v66, v34 row_newbcast:7 row_mask:0xf bank_mask:0xf
    v_mul_f32_dpp v227, v67, v35 row_newbcast:7 row_mask:0xf bank_mask:0xf
    v_mfma_f32_16x16x32_bf16 v[196:199], a[92:95], v[172:175], v[132:135]
    v_mul_f32_dpp v228, v68, v36 row_newbcast:7 row_mask:0xf bank_mask:0xf
    v_mul_f32_dpp v229, v69, v37 row_newbcast:7 row_mask:0xf bank_mask:0xf
    v_mfma_f32_16x16x32_bf16 v[196:199], a[88:91], v[168:171], v[196:199]
    v_mul_f32_dpp v230, v70, v38 row_newbcast:7 row_mask:0xf bank_mask:0xf
    v_mul_f32_dpp v231, v71, v39 row_newbcast:7 row_mask:0xf bank_mask:0xf
    v_mfma_f32_16x16x32_bf16 v[196:199], a[84:87], v[164:167], v[196:199]
    v_cvt_pk_bf16_f32 v152, v224, v225
    v_cvt_pk_bf16_f32 v153, v226, v227
    v_mfma_f32_16x16x32_bf16 v[196:199], a[80:83], v[160:163], v[196:199]
    v_cvt_pk_bf16_f32 v154, v228, v229
    v_cvt_pk_bf16_f32 v155, v230, v231
    v_mfma_f32_16x16x32_bf16 v[200:203], a[96:99], v[160:163], v[136:139]
    v_mul_f32_dpp v224, v72, v40 row_newbcast:7 row_mask:0xf bank_mask:0xf
    v_mul_f32_dpp v225, v73, v41 row_newbcast:7 row_mask:0xf bank_mask:0xf
    v_mfma_f32_16x16x32_bf16 v[200:203], a[100:103], v[164:167], v[200:203]
    v_mul_f32_dpp v226, v74, v42 row_newbcast:7 row_mask:0xf bank_mask:0xf
    v_mul_f32_dpp v227, v75, v43 row_newbcast:7 row_mask:0xf bank_mask:0xf
    v_mfma_f32_16x16x32_bf16 v[200:203], a[104:107], v[168:171], v[200:203]
    v_mul_f32_dpp v228, v76, v44 row_newbcast:7 row_mask:0xf bank_mask:0xf
    v_mul_f32_dpp v229, v77, v45 row_newbcast:7 row_mask:0xf bank_mask:0xf
    v_mfma_f32_16x16x32_bf16 v[200:203], a[108:111], v[172:175], v[200:203]
    v_mul_f32_dpp v230, v78, v46 row_newbcast:7 row_mask:0xf bank_mask:0xf
    v_mul_f32_dpp v231, v79, v47 row_newbcast:7 row_mask:0xf bank_mask:0xf
    v_mfma_f32_16x16x32_bf16 v[204:207], a[124:127], v[172:175], v[140:143]
    v_cvt_pk_bf16_f32 v156, v224, v225
    v_cvt_pk_bf16_f32 v157, v226, v227
    v_mfma_f32_16x16x32_bf16 v[204:207], a[120:123], v[168:171], v[204:207]
    v_cvt_pk_bf16_f32 v158, v228, v229
    v_cvt_pk_bf16_f32 v159, v230, v231
    v_mfma_f32_16x16x32_bf16 v[204:207], a[116:119], v[164:167], v[204:207]
    v_cvt_pk_bf16_f32 v210, |v180|, |v181|
    v_cvt_pk_bf16_f32 v211, |v182|, |v183|
    v_mfma_f32_16x16x32_bf16 v[204:207], a[112:115], v[160:163], v[204:207]
    v_cvt_pk_bf16_f32 v212, |v184|, |v185|
    v_cvt_pk_bf16_f32 v213, |v186|, |v187|
    v_mfma_f32_16x16x32_bf16 v[176:179], a[0:3], v[144:147], v[112:115]
    v_cvt_pk_bf16_f32 v214, |v188|, |v189|
    v_cvt_pk_bf16_f32 v215, |v190|, |v191|
    v_mfma_f32_16x16x32_bf16 v[176:179], a[4:7], v[148:151], v[176:179]
    v_cvt_pk_bf16_f32 v216, |v192|, |v193|
    v_cvt_pk_bf16_f32 v217, |v194|, |v195|
    v_mfma_f32_16x16x32_bf16 v[176:179], a[8:11], v[152:155], v[176:179]
    v_cvt_pk_bf16_f32 v218, |v196|, |v197|
    v_cvt_pk_bf16_f32 v219, |v198|, |v199|
    v_mfma_f32_16x16x32_bf16 v[176:179], a[12:15], v[156:159], v[176:179]
    v_cvt_pk_bf16_f32 v220, |v200|, |v201|
    v_cvt_pk_bf16_f32 v221, |v202|, |v203|
    v_smfmac_f32_16x16x64_bf16 v[240:243], a[144:147], v[208:215], v1
    v_cvt_pk_bf16_f32 v222, |v204|, |v205|
    v_mfma_f32_16x16x32_bf16 v[180:183], a[28:31], v[156:159], v[116:119]
    v_cvt_pk_bf16_f32 v223, |v206|, |v207|
    v_mul_f32_dpp v224, v48, v16 row_newbcast:9 row_mask:0xf bank_mask:0xf
    v_mfma_f32_16x16x32_bf16 v[180:183], a[24:27], v[152:155], v[180:183]
    v_mul_f32_dpp v225, v49, v17 row_newbcast:9 row_mask:0xf bank_mask:0xf
    v_mul_f32_dpp v226, v50, v18 row_newbcast:9 row_mask:0xf bank_mask:0xf
    v_mfma_f32_16x16x32_bf16 v[180:183], a[20:23], v[148:151], v[180:183]
    v_mul_f32_dpp v227, v51, v19 row_newbcast:9 row_mask:0xf bank_mask:0xf
    v_mul_f32_dpp v228, v52, v20 row_newbcast:9 row_mask:0xf bank_mask:0xf
    v_mfma_f32_16x16x32_bf16 v[180:183], a[16:19], v[144:147], v[180:183]
    v_mul_f32_dpp v229, v53, v21 row_newbcast:9 row_mask:0xf bank_mask:0xf
    v_mul_f32_dpp v230, v54, v22 row_newbcast:9 row_mask:0xf bank_mask:0xf
    v_smfmac_f32_16x16x64_bf16 v[240:243], a[148:151], v[216:223], v1
    v_mul_f32_dpp v231, v55, v23 row_newbcast:9 row_mask:0xf bank_mask:0xf
    v_mfma_f32_16x16x32_bf16 v[184:187], a[32:35], v[144:147], v[120:123]
    v_cvt_pk_bf16_f32 v160, v224, v225
    v_cvt_pk_bf16_f32 v161, v226, v227
    v_mfma_f32_16x16x32_bf16 v[184:187], a[36:39], v[148:151], v[184:187]
    v_cvt_pk_bf16_f32 v162, v228, v229
    v_cvt_pk_bf16_f32 v163, v230, v231
    v_mfma_f32_16x16x32_bf16 v[184:187], a[40:43], v[152:155], v[184:187]
    v_mul_f32_dpp v224, v56, v24 row_newbcast:9 row_mask:0xf bank_mask:0xf
    v_mul_f32_dpp v225, v57, v25 row_newbcast:9 row_mask:0xf bank_mask:0xf
    v_mfma_f32_16x16x32_bf16 v[184:187], a[44:47], v[156:159], v[184:187]
    v_mul_f32_dpp v226, v58, v26 row_newbcast:9 row_mask:0xf bank_mask:0xf
    v_mul_f32_dpp v227, v59, v27 row_newbcast:9 row_mask:0xf bank_mask:0xf
    v_smfmac_f32_16x16x64_bf16 v[240:243], a[168:171], v[144:151], v1
    v_mul_f32_dpp v228, v60, v28 row_newbcast:9 row_mask:0xf bank_mask:0xf
    v_mfma_f32_16x16x32_bf16 v[188:191], a[60:63], v[156:159], v[124:127]
    v_mul_f32_dpp v229, v61, v29 row_newbcast:9 row_mask:0xf bank_mask:0xf
    v_mul_f32_dpp v230, v62, v30 row_newbcast:9 row_mask:0xf bank_mask:0xf
    v_mfma_f32_16x16x32_bf16 v[188:191], a[56:59], v[152:155], v[188:191]
    v_mul_f32_dpp v231, v63, v31 row_newbcast:9 row_mask:0xf bank_mask:0xf
    v_cvt_pk_bf16_f32 v208, |v176|, |v177|
    v_mfma_f32_16x16x32_bf16 v[188:191], a[52:55], v[148:151], v[188:191]
    v_cvt_pk_bf16_f32 v209, |v178|, |v179|
    v_cvt_pk_bf16_f32 v164, v224, v225
    v_mfma_f32_16x16x32_bf16 v[188:191], a[48:51], v[144:147], v[188:191]
    v_cvt_pk_bf16_f32 v165, v226, v227
    v_cvt_pk_bf16_f32 v166, v228, v229
    v_smfmac_f32_16x16x64_bf16 v[240:243], a[172:175], v[152:159], v1
    v_cvt_pk_bf16_f32 v167, v230, v231
    v_mfma_f32_16x16x32_bf16 v[192:195], a[64:67], v[144:147], v[128:131]
    v_mul_f32_dpp v224, v64, v32 row_newbcast:9 row_mask:0xf bank_mask:0xf
    v_mul_f32_dpp v225, v65, v33 row_newbcast:9 row_mask:0xf bank_mask:0xf
    v_mfma_f32_16x16x32_bf16 v[192:195], a[68:71], v[148:151], v[192:195]
    v_mul_f32_dpp v226, v66, v34 row_newbcast:9 row_mask:0xf bank_mask:0xf
    v_mul_f32_dpp v227, v67, v35 row_newbcast:9 row_mask:0xf bank_mask:0xf
    v_mfma_f32_16x16x32_bf16 v[192:195], a[72:75], v[152:155], v[192:195]
    v_mul_f32_dpp v228, v68, v36 row_newbcast:9 row_mask:0xf bank_mask:0xf
    v_mul_f32_dpp v229, v69, v37 row_newbcast:9 row_mask:0xf bank_mask:0xf
    v_mfma_f32_16x16x32_bf16 v[192:195], a[76:79], v[156:159], v[192:195]
    v_mul_f32_dpp v230, v70, v38 row_newbcast:9 row_mask:0xf bank_mask:0xf
    v_mul_f32_dpp v231, v71, v39 row_newbcast:9 row_mask:0xf bank_mask:0xf
    v_mfma_f32_16x16x32_bf16 v[196:199], a[92:95], v[156:159], v[132:135]
    v_cvt_pk_bf16_f32 v168, v224, v225
    v_cvt_pk_bf16_f32 v169, v226, v227
    v_mfma_f32_16x16x32_bf16 v[196:199], a[88:91], v[152:155], v[196:199]
    v_cvt_pk_bf16_f32 v170, v228, v229
    v_cvt_pk_bf16_f32 v171, v230, v231
    v_mfma_f32_16x16x32_bf16 v[196:199], a[84:87], v[148:151], v[196:199]
    v_mul_f32_dpp v224, v72, v40 row_newbcast:9 row_mask:0xf bank_mask:0xf
    v_mul_f32_dpp v225, v73, v41 row_newbcast:9 row_mask:0xf bank_mask:0xf
    v_mfma_f32_16x16x32_bf16 v[196:199], a[80:83], v[144:147], v[196:199]
    v_mul_f32_dpp v226, v74, v42 row_newbcast:9 row_mask:0xf bank_mask:0xf
    v_mul_f32_dpp v227, v75, v43 row_newbcast:9 row_mask:0xf bank_mask:0xf
    v_mfma_f32_16x16x32_bf16 v[200:203], a[96:99], v[144:147], v[136:139]
    v_mul_f32_dpp v228, v76, v44 row_newbcast:9 row_mask:0xf bank_mask:0xf
    v_mul_f32_dpp v229, v77, v45 row_newbcast:9 row_mask:0xf bank_mask:0xf
    v_mfma_f32_16x16x32_bf16 v[200:203], a[100:103], v[148:151], v[200:203]
    v_mul_f32_dpp v230, v78, v46 row_newbcast:9 row_mask:0xf bank_mask:0xf
    v_mul_f32_dpp v231, v79, v47 row_newbcast:9 row_mask:0xf bank_mask:0xf
    v_mfma_f32_16x16x32_bf16 v[200:203], a[104:107], v[152:155], v[200:203]
    v_cvt_pk_bf16_f32 v172, v224, v225
    v_cvt_pk_bf16_f32 v173, v226, v227
    v_mfma_f32_16x16x32_bf16 v[200:203], a[108:111], v[156:159], v[200:203]
    v_cvt_pk_bf16_f32 v174, v228, v229
    v_cvt_pk_bf16_f32 v175, v230, v231
    v_mfma_f32_16x16x32_bf16 v[204:207], a[124:127], v[156:159], v[140:143]
    v_cvt_pk_bf16_f32 v210, |v180|, |v181|
    v_cvt_pk_bf16_f32 v211, |v182|, |v183|
    v_mfma_f32_16x16x32_bf16 v[204:207], a[120:123], v[152:155], v[204:207]
    v_cvt_pk_bf16_f32 v212, |v184|, |v185|
    v_cvt_pk_bf16_f32 v213, |v186|, |v187|
    v_mfma_f32_16x16x32_bf16 v[204:207], a[116:119], v[148:151], v[204:207]
    v_cvt_pk_bf16_f32 v214, |v188|, |v189|
    v_cvt_pk_bf16_f32 v215, |v190|, |v191|
    v_mfma_f32_16x16x32_bf16 v[204:207], a[112:115], v[144:147], v[204:207]
    v_cvt_pk_bf16_f32 v216, |v192|, |v193|
    v_cvt_pk_bf16_f32 v217, |v194|, |v195|
    v_smfmac_f32_16x16x64_bf16 v[240:243], a[160:163], v[208:215], v1
    v_cvt_pk_bf16_f32 v218, |v196|, |v197|
    v_mfma_f32_16x16x32_bf16 v[176:179], a[0:3], v[160:163], v[112:115]
    v_cvt_pk_bf16_f32 v219, |v198|, |v199|
    v_cvt_pk_bf16_f32 v220, |v200|, |v201|
    v_mfma_f32_16x16x32_bf16 v[176:179], a[4:7], v[164:167], v[176:179]
    v_cvt_pk_bf16_f32 v221, |v202|, |v203|
    v_cvt_pk_bf16_f32 v222, |v204|, |v205|
    v_mfma_f32_16x16x32_bf16 v[176:179], a[8:11], v[168:171], v[176:179]
    v_cvt_pk_bf16_f32 v223, |v206|, |v207|
    v_mul_f32_dpp v224, v48, v16 row_newbcast:8 row_mask:0xf bank_mask:0xf
    v_mfma_f32_16x16x32_bf16 v[176:179], a[12:15], v[172:175], v[176:179]
    v_mul_f32_dpp v225, v49, v17 row_newbcast:8 row_mask:0xf bank_mask:0xf
    v_mul_f32_dpp v226, v50, v18 row_newbcast:8 row_mask:0xf bank_mask:0xf
    v_smfmac_f32_16x16x64_bf16 v[240:243], a[164:167], v[216:223], v1
    v_mul_f32_dpp v227, v51, v19 row_newbcast:8 row_mask:0xf bank_mask:0xf
    v_mfma_f32_16x16x32_bf16 v[180:183], a[28:31], v[172:175], v[116:119]
    v_mul_f32_dpp v228, v52, v20 row_newbcast:8 row_mask:0xf bank_mask:0xf
    v_mul_f32_dpp v229, v53, v21 row_newbcast:8 row_mask:0xf bank_mask:0xf
    v_mfma_f32_16x16x32_bf16 v[180:183], a[24:27], v[168:171], v[180:183]
    v_mul_f32_dpp v230, v54, v22 row_newbcast:8 row_mask:0xf bank_mask:0xf
    v_mul_f32_dpp v231, v55, v23 row_newbcast:8 row_mask:0xf bank_mask:0xf
    v_mfma_f32_16x16x32_bf16 v[180:183], a[20:23], v[164:167], v[180:183]
    v_cvt_pk_bf16_f32 v144, v224, v225
    v_cvt_pk_bf16_f32 v145, v226, v227
    v_mfma_f32_16x16x32_bf16 v[180:183], a[16:19], v[160:163], v[180:183]
    v_cvt_pk_bf16_f32 v146, v228, v229
    v_cvt_pk_bf16_f32 v147, v230, v231
    v_smfmac_f32_16x16x64_bf16 v[240:243], a[184:187], v[160:167], v1
    v_mul_f32_dpp v224, v56, v24 row_newbcast:8 row_mask:0xf bank_mask:0xf
    v_mfma_f32_16x16x32_bf16 v[184:187], a[32:35], v[160:163], v[120:123]
    v_mul_f32_dpp v225, v57, v25 row_newbcast:8 row_mask:0xf bank_mask:0xf
    v_mul_f32_dpp v226, v58, v26 row_newbcast:8 row_mask:0xf bank_mask:0xf
    v_mfma_f32_16x16x32_bf16 v[184:187], a[36:39], v[164:167], v[184:187]
    v_mul_f32_dpp v227, v59, v27 row_newbcast:8 row_mask:0xf bank_mask:0xf
    v_mul_f32_dpp v228, v60, v28 row_newbcast:8 row_mask:0xf bank_mask:0xf
    v_mfma_f32_16x16x32_bf16 v[184:187], a[40:43], v[168:171], v[184:187]
    v_mul_f32_dpp v229, v61, v29 row_newbcast:8 row_mask:0xf bank_mask:0xf
    v_mul_f32_dpp v230, v62, v30 row_newbcast:8 row_mask:0xf bank_mask:0xf
    v_mfma_f32_16x16x32_bf16 v[184:187], a[44:47], v[172:175], v[184:187]
    v_mul_f32_dpp v231, v63, v31 row_newbcast:8 row_mask:0xf bank_mask:0xf
    v_cvt_pk_bf16_f32 v208, |v176|, |v177|
    v_smfmac_f32_16x16x64_bf16 v[240:243], a[188:191], v[168:175], v1
    v_cvt_pk_bf16_f32 v209, |v178|, |v179|
    v_mfma_f32_16x16x32_bf16 v[188:191], a[60:63], v[172:175], v[124:127]
    v_cvt_pk_bf16_f32 v148, v224, v225
    v_cvt_pk_bf16_f32 v149, v226, v227
    v_mfma_f32_16x16x32_bf16 v[188:191], a[56:59], v[168:171], v[188:191]
    v_cvt_pk_bf16_f32 v150, v228, v229
    v_cvt_pk_bf16_f32 v151, v230, v231
    v_mfma_f32_16x16x32_bf16 v[188:191], a[52:55], v[164:167], v[188:191]
    v_mul_f32_dpp v224, v64, v32 row_newbcast:8 row_mask:0xf bank_mask:0xf
    v_mul_f32_dpp v225, v65, v33 row_newbcast:8 row_mask:0xf bank_mask:0xf
    v_mfma_f32_16x16x32_bf16 v[188:191], a[48:51], v[160:163], v[188:191]
    v_mul_f32_dpp v226, v66, v34 row_newbcast:8 row_mask:0xf bank_mask:0xf
    v_mul_f32_dpp v227, v67, v35 row_newbcast:8 row_mask:0xf bank_mask:0xf
    v_smfmac_f32_16x16x64_bf16 v[244:247], a[136:139], v[144:151], v1
    v_mul_f32_dpp v228, v68, v36 row_newbcast:8 row_mask:0xf bank_mask:0xf
    v_mfma_f32_16x16x32_bf16 v[192:195], a[64:67], v[160:163], v[128:131]
    v_mul_f32_dpp v229, v69, v37 row_newbcast:8 row_mask:0xf bank_mask:0xf
    v_mul_f32_dpp v230, v70, v38 row_newbcast:8 row_mask:0xf bank_mask:0xf
    v_mfma_f32_16x16x32_bf16 v[192:195], a[68:71], v[164:167], v[192:195]
    v_mul_f32_dpp v231, v71, v39 row_newbcast:8 row_mask:0xf bank_mask:0xf
    v_cvt_pk_bf16_f32 v152, v224, v225
    v_mfma_f32_16x16x32_bf16 v[192:195], a[72:75], v[168:171], v[192:195]
    v_cvt_pk_bf16_f32 v153, v226, v227
    v_cvt_pk_bf16_f32 v154, v228, v229
    v_mfma_f32_16x16x32_bf16 v[192:195], a[76:79], v[172:175], v[192:195]
    v_cvt_pk_bf16_f32 v155, v230, v231
    v_mul_f32_dpp v224, v72, v40 row_newbcast:8 row_mask:0xf bank_mask:0xf
    v_mfma_f32_16x16x32_bf16 v[196:199], a[92:95], v[172:175], v[132:135]
    v_mul_f32_dpp v225, v73, v41 row_newbcast:8 row_mask:0xf bank_mask:0xf
    v_mul_f32_dpp v226, v74, v42 row_newbcast:8 row_mask:0xf bank_mask:0xf
    v_mfma_f32_16x16x32_bf16 v[196:199], a[88:91], v[168:171], v[196:199]
    v_mul_f32_dpp v227, v75, v43 row_newbcast:8 row_mask:0xf bank_mask:0xf
    v_mul_f32_dpp v228, v76, v44 row_newbcast:8 row_mask:0xf bank_mask:0xf
    v_mfma_f32_16x16x32_bf16 v[196:199], a[84:87], v[164:167], v[196:199]
    v_mul_f32_dpp v229, v77, v45 row_newbcast:8 row_mask:0xf bank_mask:0xf
    v_mul_f32_dpp v230, v78, v46 row_newbcast:8 row_mask:0xf bank_mask:0xf
    v_mfma_f32_16x16x32_bf16 v[196:199], a[80:83], v[160:163], v[196:199]
    v_mul_f32_dpp v231, v79, v47 row_newbcast:8 row_mask:0xf bank_mask:0xf
    v_cvt_pk_bf16_f32 v156, v224, v225
    v_mfma_f32_16x16x32_bf16 v[200:203], a[96:99], v[160:163], v[136:139]
    v_cvt_pk_bf16_f32 v157, v226, v227
    v_cvt_pk_bf16_f32 v158, v228, v229
    v_mfma_f32_16x16x32_bf16 v[200:203], a[100:103], v[164:167], v[200:203]
    v_cvt_pk_bf16_f32 v159, v230, v231
    v_cvt_pk_bf16_f32 v210, |v180|, |v181|
    v_mfma_f32_16x16x32_bf16 v[200:203], a[104:107], v[168:171], v[200:203]
    v_cvt_pk_bf16_f32 v211, |v182|, |v183|
    v_cvt_pk_bf16_f32 v212, |v184|, |v185|
    v_mfma_f32_16x16x32_bf16 v[200:203], a[108:111], v[172:175], v[200:203]
    v_cvt_pk_bf16_f32 v213, |v186|, |v187|
    v_cvt_pk_bf16_f32 v214, |v188|, |v189|
    v_smfmac_f32_16x16x64_bf16 v[244:247], a[140:143], v[152:159], v1
    v_cvt_pk_bf16_f32 v215, |v190|, |v191|
    v_mfma_f32_16x16x32_bf16 v[204:207], a[124:127], v[172:175], v[140:143]
    v_cvt_pk_bf16_f32 v216, |v192|, |v193|
    v_cvt_pk_bf16_f32 v217, |v194|, |v195|
    v_mfma_f32_16x16x32_bf16 v[204:207], a[120:123], v[168:171], v[204:207]
    v_cvt_pk_bf16_f32 v218, |v196|, |v197|
    v_cvt_pk_bf16_f32 v219, |v198|, |v199|
    v_mfma_f32_16x16x32_bf16 v[204:207], a[116:119], v[164:167], v[204:207]
    v_cvt_pk_bf16_f32 v220, |v200|, |v201|
    v_cvt_pk_bf16_f32 v221, |v202|, |v203|
    v_mfma_f32_16x16x32_bf16 v[204:207], a[112:115], v[160:163], v[204:207]
    v_mul_f32_dpp v224, v48, v16 row_newbcast:0 row_mask:0xf bank_mask:0xf
    v_mul_f32_dpp v225, v49, v17 row_newbcast:0 row_mask:0xf bank_mask:0xf
    v_smfmac_f32_16x16x64_bf16 v[240:243], a[176:179], v[208:215], v1
    v_mul_f32_dpp v226, v50, v18 row_newbcast:0 row_mask:0xf bank_mask:0xf
    v_mfma_f32_16x16x32_bf16 v[176:179], a[0:3], v[144:147], v[112:115]
    v_mul_f32_dpp v227, v51, v19 row_newbcast:0 row_mask:0xf bank_mask:0xf
    v_mul_f32_dpp v228, v52, v20 row_newbcast:0 row_mask:0xf bank_mask:0xf
    v_mfma_f32_16x16x32_bf16 v[176:179], a[4:7], v[148:151], v[176:179]
    v_cvt_pk_bf16_f32 v222, |v204|, |v205|
    v_cvt_pk_bf16_f32 v223, |v206|, |v207|
    v_mfma_f32_16x16x32_bf16 v[176:179], a[8:11], v[152:155], v[176:179]
    v_mul_f32_dpp v229, v53, v21 row_newbcast:0 row_mask:0xf bank_mask:0xf
    v_mul_f32_dpp v230, v54, v22 row_newbcast:0 row_mask:0xf bank_mask:0xf
    v_mfma_f32_16x16x32_bf16 v[176:179], a[12:15], v[156:159], v[176:179]
    v_mul_f32_dpp v231, v55, v23 row_newbcast:0 row_mask:0xf bank_mask:0xf
    v_cvt_pk_bf16_f32 v160, v224, v225
    v_smfmac_f32_16x16x64_bf16 v[240:243], a[180:183], v[216:223], v1
    v_cvt_pk_bf16_f32 v161, v226, v227
    v_mfma_f32_16x16x32_bf16 v[180:183], a[28:31], v[156:159], v[116:119]
    v_cvt_pk_bf16_f32 v162, v228, v229
    v_cvt_pk_bf16_f32 v163, v230, v231
    v_mfma_f32_16x16x32_bf16 v[180:183], a[24:27], v[152:155], v[180:183]
    v_mul_f32_dpp v224, v56, v24 row_newbcast:0 row_mask:0xf bank_mask:0xf
    v_mul_f32_dpp v225, v57, v25 row_newbcast:0 row_mask:0xf bank_mask:0xf
    v_mfma_f32_16x16x32_bf16 v[180:183], a[20:23], v[148:151], v[180:183]
    v_mul_f32_dpp v226, v58, v26 row_newbcast:0 row_mask:0xf bank_mask:0xf
    v_mul_f32_dpp v227, v59, v27 row_newbcast:0 row_mask:0xf bank_mask:0xf
    v_mfma_f32_16x16x32_bf16 v[180:183], a[16:19], v[144:147], v[180:183]
    v_mul_f32_dpp v228, v60, v28 row_newbcast:0 row_mask:0xf bank_mask:0xf
    v_mul_f32_dpp v229, v61, v29 row_newbcast:0 row_mask:0xf bank_mask:0xf
    v_mfma_f32_16x16x32_bf16 v[184:187], a[32:35], v[144:147], v[120:123]
    v_mul_f32_dpp v230, v62, v30 row_newbcast:0 row_mask:0xf bank_mask:0xf
    v_mul_f32_dpp v231, v63, v31 row_newbcast:0 row_mask:0xf bank_mask:0xf
    v_mfma_f32_16x16x32_bf16 v[184:187], a[36:39], v[148:151], v[184:187]
    v_cvt_pk_bf16_f32 v208, |v176|, |v177|
    v_cvt_pk_bf16_f32 v209, |v178|, |v179|
    v_mfma_f32_16x16x32_bf16 v[184:187], a[40:43], v[152:155], v[184:187]
    v_cvt_pk_bf16_f32 v164, v224, v225
    v_cvt_pk_bf16_f32 v165, v226, v227
    v_mfma_f32_16x16x32_bf16 v[184:187], a[44:47], v[156:159], v[184:187]
    v_cvt_pk_bf16_f32 v166, v228, v229
    v_cvt_pk_bf16_f32 v167, v230, v231
    v_mfma_f32_16x16x32_bf16 v[188:191], a[60:63], v[156:159], v[124:127]
    v_mul_f32_dpp v224, v64, v32 row_newbcast:0 row_mask:0xf bank_mask:0xf
    v_mul_f32_dpp v225, v65, v33 row_newbcast:0 row_mask:0xf bank_mask:0xf
    v_mfma_f32_16x16x32_bf16 v[188:191], a[56:59], v[152:155], v[188:191]
    v_mul_f32_dpp v226, v66, v34 row_newbcast:0 row_mask:0xf bank_mask:0xf
    v_mul_f32_dpp v227, v67, v35 row_newbcast:0 row_mask:0xf bank_mask:0xf
    v_mfma_f32_16x16x32_bf16 v[188:191], a[52:55], v[148:151], v[188:191]
    v_mul_f32_dpp v228, v68, v36 row_newbcast:0 row_mask:0xf bank_mask:0xf
    v_mul_f32_dpp v229, v69, v37 row_newbcast:0 row_mask:0xf bank_mask:0xf
    v_mfma_f32_16x16x32_bf16 v[188:191], a[48:51], v[144:147], v[188:191]
    v_mul_f32_dpp v230, v70, v38 row_newbcast:0 row_mask:0xf bank_mask:0xf
    v_mul_f32_dpp v231, v71, v39 row_newbcast:0 row_mask:0xf bank_mask:0xf
    v_mfma_f32_16x16x32_bf16 v[192:195], a[64:67], v[144:147], v[128:131]
    v_cvt_pk_bf16_f32 v168, v224, v225
    v_cvt_pk_bf16_f32 v169, v226, v227
    v_mfma_f32_16x16x32_bf16 v[192:195], a[68:71], v[148:151], v[192:195]
    v_cvt_pk_bf16_f32 v170, v228, v229
    v_cvt_pk_bf16_f32 v171, v230, v231
    v_mfma_f32_16x16x32_bf16 v[192:195], a[72:75], v[152:155], v[192:195]
    v_mul_f32_dpp v224, v72, v40 row_newbcast:0 row_mask:0xf bank_mask:0xf
    v_mul_f32_dpp v225, v73, v41 row_newbcast:0 row_mask:0xf bank_mask:0xf
    v_mfma_f32_16x16x32_bf16 v[192:195], a[76:79], v[156:159], v[192:195]
    v_mul_f32_dpp v226, v74, v42 row_newbcast:0 row_mask:0xf bank_mask:0xf
    v_mul_f32_dpp v227, v75, v43 row_newbcast:0 row_mask:0xf bank_mask:0xf
    v_mfma_f32_16x16x32_bf16 v[196:199], a[92:95], v[156:159], v[132:135]
    v_mul_f32_dpp v228, v76, v44 row_newbcast:0 row_mask:0xf bank_mask:0xf
    v_mul_f32_dpp v229, v77, v45 row_newbcast:0 row_mask:0xf bank_mask:0xf
    v_mfma_f32_16x16x32_bf16 v[196:199], a[88:91], v[152:155], v[196:199]
    v_mul_f32_dpp v230, v78, v46 row_newbcast:0 row_mask:0xf bank_mask:0xf
    v_mul_f32_dpp v231, v79, v47 row_newbcast:0 row_mask:0xf bank_mask:0xf
    v_mfma_f32_16x16x32_bf16 v[196:199], a[84:87], v[148:151], v[196:199]
    v_cvt_pk_bf16_f32 v172, v224, v225
    v_cvt_pk_bf16_f32 v173, v226, v227
    v_mfma_f32_16x16x32_bf16 v[196:199], a[80:83], v[144:147], v[196:199]
    v_cvt_pk_bf16_f32 v174, v228, v229
    v_cvt_pk_bf16_f32 v175, v230, v231
    v_mfma_f32_16x16x32_bf16 v[200:203], a[96:99], v[144:147], v[136:139]
    v_cvt_pk_bf16_f32 v210, |v180|, |v181|
    v_cvt_pk_bf16_f32 v211, |v182|, |v183|
    v_mfma_f32_16x16x32_bf16 v[200:203], a[100:103], v[148:151], v[200:203]
    v_cvt_pk_bf16_f32 v212, |v184|, |v185|
    v_cvt_pk_bf16_f32 v213, |v186|, |v187|
    v_mfma_f32_16x16x32_bf16 v[200:203], a[104:107], v[152:155], v[200:203]
    v_cvt_pk_bf16_f32 v214, |v188|, |v189|
    v_cvt_pk_bf16_f32 v215, |v190|, |v191|
    v_mfma_f32_16x16x32_bf16 v[200:203], a[108:111], v[156:159], v[200:203]
L_stub2:
    s_cbranch_scc1 L_main2
    v_cvt_pk_bf16_f32 v216, |v192|, |v193|
    v_cvt_pk_bf16_f32 v217, |v194|, |v195|
    v_smfmac_f32_16x16x64_bf16 v[244:247], a[128:131], v[208:215], v1
    v_cvt_pk_bf16_f32 v218, |v196|, |v197|
    v_mfma_f32_16x16x32_bf16 v[204:207], a[124:127], v[156:159], v[140:143]
    v_cvt_pk_bf16_f32 v219, |v198|, |v199|
    v_mul_f32_dpp v224, v48, v16 row_newbcast:1 row_mask:0xf bank_mask:0xf
    v_mfma_f32_16x16x32_bf16 v[204:207], a[120:123], v[152:155], v[204:207]
    v_cvt_pk_bf16_f32 v220, |v200|, |v201|
    v_cvt_pk_bf16_f32 v221, |v202|, |v203|
    v_mfma_f32_16x16x32_bf16 v[204:207], a[116:119], v[148:151], v[204:207]
    v_mul_f32_dpp v225, v49, v17 row_newbcast:1 row_mask:0xf bank_mask:0xf
    v_mul_f32_dpp v226, v50, v18 row_newbcast:1 row_mask:0xf bank_mask:0xf
    v_mfma_f32_16x16x32_bf16 v[204:207], a[112:115], v[144:147], v[204:207]
    v_mul_f32_dpp v227, v51, v19 row_newbcast:1 row_mask:0xf bank_mask:0xf
    v_mul_f32_dpp v228, v52, v20 row_newbcast:1 row_mask:0xf bank_mask:0xf
    v_mfma_f32_16x16x32_bf16 v[176:179], a[0:3], v[160:163], v[112:115]
    v_mul_f32_dpp v229, v53, v21 row_newbcast:1 row_mask:0xf bank_mask:0xf
    v_mul_f32_dpp v230, v54, v22 row_newbcast:1 row_mask:0xf bank_mask:0xf
    v_mfma_f32_16x16x32_bf16 v[176:179], a[4:7], v[164:167], v[176:179]
    v_mul_f32_dpp v231, v55, v23 row_newbcast:1 row_mask:0xf bank_mask:0xf
    v_cvt_pk_bf16_f32 v144, v224, v225
    v_mfma_f32_16x16x32_bf16 v[176:179], a[8:11], v[168:171], v[176:179]
    v_cvt_pk_bf16_f32 v222, |v204|, |v205|
    v_cvt_pk_bf16_f32 v223, |v206|, |v207|
    v_mfma_f32_16x16x32_bf16 v[176:179], a[12:15], v[172:175], v[176:179]
    v_cvt_pk_bf16_f32 v145, v226, v227
    v_cvt_pk_bf16_f32 v146, v228, v229
    v_smfmac_f32_16x16x64_bf16 v[244:247], a[132:135], v[216:223], v1
    v_cvt_pk_bf16_f32 v147, v230, v231
    v_mfma_f32_16x16x32_bf16 v[180:183], a[28:31], v[172:175], v[116:119]
    v_mul_f32_dpp v224, v56, v24 row_newbcast:1 row_mask:0xf bank_mask:0xf
    v_mul_f32_dpp v225, v57, v25 row_newbcast:1 row_mask:0xf bank_mask:0xf
    v_mfma_f32_16x16x32_bf16 v[180:183], a[24:27], v[168:171], v[180:183]
    v_mul_f32_dpp v226, v58, v26 row_newbcast:1 row_mask:0xf bank_mask:0xf
    v_mul_f32_dpp v227, v59, v27 row_newbcast:1 row_mask:0xf bank_mask:0xf
    v_mfma_f32_16x16x32_bf16 v[180:183], a[20:23], v[164:167], v[180:183]
    v_mul_f32_dpp v228, v60, v28 row_newbcast:1 row_mask:0xf bank_mask:0xf
    v_mul_f32_dpp v229, v61, v29 row_newbcast:1 row_mask:0xf bank_mask:0xf
    v_mfma_f32_16x16x32_bf16 v[180:183], a[16:19], v[160:163], v[180:183]
    v_mul_f32_dpp v230, v62, v30 row_newbcast:1 row_mask:0xf bank_mask:0xf
    v_mul_f32_dpp v231, v63, v31 row_newbcast:1 row_mask:0xf bank_mask:0xf
    v_smfmac_f32_16x16x64_bf16 v[244:247], a[152:155], v[160:167], v1
    v_cvt_pk_bf16_f32 v208, |v176|, |v177|
    v_mfma_f32_16x16x32_bf16 v[184:187], a[32:35], v[160:163], v[120:123]
    v_cvt_pk_bf16_f32 v209, |v178|, |v179|
    v_cvt_pk_bf16_f32 v148, v224, v225
    v_mfma_f32_16x16x32_bf16 v[184:187], a[36:39], v[164:167], v[184:187]
    v_cvt_pk_bf16_f32 v149, v226, v227
    v_cvt_pk_bf16_f32 v150, v228, v229
    v_mfma_f32_16x16x32_bf16 v[184:187], a[40:43], v[168:171], v[184:187]
    v_cvt_pk_bf16_f32 v151, v230, v231
    v_mul_f32_dpp v224, v64, v32 row_newbcast:1 row_mask:0xf bank_mask:0xf
    v_mfma_f32_16x16x32_bf16 v[184:187], a[44:47], v[172:175], v[184:187]
    v_mul_f32_dpp v225, v65, v33 row_newbcast:1 row_mask:0xf bank_mask:0xf
    v_mul_f32_dpp v226, v66, v34 row_newbcast:1 row_mask:0xf bank_mask:0xf
    v_smfmac_f32_16x16x64_bf16 v[244:247], a[156:159], v[168:175], v1
    v_mul_f32_dpp v227, v67, v35 row_newbcast:1 row_mask:0xf bank_mask:0xf
    v_mfma_f32_16x16x32_bf16 v[188:191], a[60:63], v[172:175], v[124:127]
    v_mul_f32_dpp v228, v68, v36 row_newbcast:1 row_mask:0xf bank_mask:0xf
    v_mul_f32_dpp v229, v69, v37 row_newbcast:1 row_mask:0xf bank_mask:0xf
    v_mfma_f32_16x16x32_bf16 v[188:191], a[56:59], v[168:171], v[188:191]
    v_mul_f32_dpp v230, v70, v38 row_newbcast:1 row_mask:0xf bank_mask:0xf
    v_mul_f32_dpp v231, v71, v39 row_newbcast:1 row_mask:0xf bank_mask:0xf
    v_mfma_f32_16x16x32_bf16 v[188:191], a[52:55], v[164:167], v[188:191]
    v_cvt_pk_bf16_f32 v152, v224, v225
    v_cvt_pk_bf16_f32 v153, v226, v227
    v_mfma_f32_16x16x32_bf16 v[188:191], a[48:51], v[160:163], v[188:191]
    v_cvt_pk_bf16_f32 v154, v228, v229
    v_cvt_pk_bf16_f32 v155, v230, v231
    v_mfma_f32_16x16x32_bf16 v[192:195], a[64:67], v[160:163], v[128:131]
    v_mul_f32_dpp v224, v72, v40 row_newbcast:1 row_mask:0xf bank_mask:0xf
    v_mul_f32_dpp v225, v73, v41 row_newbcast:1 row_mask:0xf bank_mask:0xf
    v_mfma_f32_16x16x32_bf16 v[192:195], a[68:71], v[164:167], v[192:195]
    v_mul_f32_dpp v226, v74, v42 row_newbcast:1 row_mask:0xf bank_mask:0xf
    v_mul_f32_dpp v227, v75, v43 row_newbcast:1 row_mask:0xf bank_mask:0xf
    v_mfma_f32_16x16x32_bf16 v[192:195], a[72:75], v[168:171], v[192:195]
    v_mul_f32_dpp v228, v76, v44 row_newbcast:1 row_mask:0xf bank_mask:0xf
    v_mul_f32_dpp v229, v77, v45 row_newbcast:1 row_mask:0xf bank_mask:0xf
    v_mfma_f32_16x16x32_bf16 v[192:195], a[76:79], v[172:175], v[192:195]
    v_mul_f32_dpp v230, v78, v46 row_newbcast:1 row_mask:0xf bank_mask:0xf
    v_mul_f32_dpp v231, v79, v47 row_newbcast:1 row_mask:0xf bank_mask:0xf
    v_mfma_f32_16x16x32_bf16 v[196:199], a[92:95], v[172:175], v[132:135]
    v_cvt_pk_bf16_f32 v156, v224, v225
    v_cvt_pk_bf16_f32 v157, v226, v227
    v_mfma_f32_16x16x32_bf16 v[196:199], a[88:91], v[168:171], v[196:199]
    v_cvt_pk_bf16_f32 v158, v228, v229
    v_cvt_pk_bf16_f32 v159, v230, v231
    v_mfma_f32_16x16x32_bf16 v[196:199], a[84:87], v[164:167], v[196:199]
    v_cvt_pk_bf16_f32 v210, |v180|, |v181|
    v_cvt_pk_bf16_f32 v211, |v182|, |v183|
    v_mfma_f32_16x16x32_bf16 v[196:199], a[80:83], v[160:163], v[196:199]
    v_cvt_pk_bf16_f32 v212, |v184|, |v185|
    v_cvt_pk_bf16_f32 v213, |v186|, |v187|
    v_mfma_f32_16x16x32_bf16 v[200:203], a[96:99], v[160:163], v[136:139]
    v_cvt_pk_bf16_f32 v214, |v188|, |v189|
    v_cvt_pk_bf16_f32 v215, |v190|, |v191|
    v_mfma_f32_16x16x32_bf16 v[200:203], a[100:103], v[164:167], v[200:203]
    v_cvt_pk_bf16_f32 v216, |v192|, |v193|
    v_cvt_pk_bf16_f32 v217, |v194|, |v195|
    v_mfma_f32_16x16x32_bf16 v[200:203], a[104:107], v[168:171], v[200:203]
    v_cvt_pk_bf16_f32 v218, |v196|, |v197|
    v_cvt_pk_bf16_f32 v219, |v198|, |v199|
    v_mfma_f32_16x16x32_bf16 v[200:203], a[108:111], v[172:175], v[200:203]
    v_mul_f32_dpp v224, v48, v16 row_newbcast:6 row_mask:0xf bank_mask:0xf
    v_mul_f32_dpp v225, v49, v17 row_newbcast:6 row_mask:0xf bank_mask:0xf
    v_smfmac_f32_16x16x64_bf16 v[244:247], a[144:147], v[208:215], v1
    v_mul_f32_dpp v226, v50, v18 row_newbcast:6 row_mask:0xf bank_mask:0xf
    v_mfma_f32_16x16x32_bf16 v[204:207], a[124:127], v[172:175], v[140:143]
    v_mul_f32_dpp v227, v51, v19 row_newbcast:6 row_mask:0xf bank_mask:0xf
    v_mul_f32_dpp v228, v52, v20 row_newbcast:6 row_mask:0xf bank_mask:0xf
    v_mfma_f32_16x16x32_bf16 v[204:207], a[120:123], v[168:171], v[204:207]
    v_cvt_pk_bf16_f32 v220, |v200|, |v201|
    v_cvt_pk_bf16_f32 v221, |v202|, |v203|
    v_mfma_f32_16x16x32_bf16 v[204:207], a[116:119], v[164:167], v[204:207]
    v_mul_f32_dpp v229, v53, v21 row_newbcast:6 row_mask:0xf bank_mask:0xf
    v_mul_f32_dpp v230, v54, v22 row_newbcast:6 row_mask:0xf bank_mask:0xf
    v_mfma_f32_16x16x32_bf16 v[204:207], a[112:115], v[160:163], v[204:207]
    v_mul_f32_dpp v231, v55, v23 row_newbcast:6 row_mask:0xf bank_mask:0xf
    v_cvt_pk_bf16_f32 v160, v224, v225
    v_mfma_f32_16x16x32_bf16 v[176:179], a[0:3], v[144:147], v[112:115]
    v_cvt_pk_bf16_f32 v161, v226, v227
    v_cvt_pk_bf16_f32 v162, v228, v229
    v_mfma_f32_16x16x32_bf16 v[176:179], a[4:7], v[148:151], v[176:179]
    v_cvt_pk_bf16_f32 v163, v230, v231
    v_mul_f32_dpp v224, v56, v24 row_newbcast:6 row_mask:0xf bank_mask:0xf
    v_mfma_f32_16x16x32_bf16 v[176:179], a[8:11], v[152:155], v[176:179]
    v_cvt_pk_bf16_f32 v222, |v204|, |v205|
    v_cvt_pk_bf16_f32 v223, |v206|, |v207|
    v_mfma_f32_16x16x32_bf16 v[176:179], a[12:15], v[156:159], v[176:179]
    v_mul_f32_dpp v225, v57, v25 row_newbcast:6 row_mask:0xf bank_mask:0xf
    v_mul_f32_dpp v226, v58, v26 row_newbcast:6 row_mask:0xf bank_mask:0xf
    v_smfmac_f32_16x16x64_bf16 v[244:247], a[148:151], v[216:223], v1
    v_mul_f32_dpp v227, v59, v27 row_newbcast:6 row_mask:0xf bank_mask:0xf
    v_mfma_f32_16x16x32_bf16 v[180:183], a[28:31], v[156:159], v[116:119]
    v_mul_f32_dpp v228, v60, v28 row_newbcast:6 row_mask:0xf bank_mask:0xf
    v_mul_f32_dpp v229, v61, v29 row_newbcast:6 row_mask:0xf bank_mask:0xf
    v_mfma_f32_16x16x32_bf16 v[180:183], a[24:27], v[152:155], v[180:183]
    v_mul_f32_dpp v230, v62, v30 row_newbcast:6 row_mask:0xf bank_mask:0xf
    v_mul_f32_dpp v231, v63, v31 row_newbcast:6 row_mask:0xf bank_mask:0xf
    v_mfma_f32_16x16x32_bf16 v[180:183], a[20:23], v[148:151], v[180:183]
    v_cvt_pk_bf16_f32 v208, |v176|, |v177|
    v_cvt_pk_bf16_f32 v209, |v178|, |v179|
    v_mfma_f32_16x16x32_bf16 v[180:183], a[16:19], v[144:147], v[180:183]
    v_cvt_pk_bf16_f32 v164, v224, v225
    v_cvt_pk_bf16_f32 v165, v226, v227
    v_smfmac_f32_16x16x64_bf16 v[244:247], a[168:171], v[144:151], v1
    v_cvt_pk_bf16_f32 v166, v228, v229
    v_mfma_f32_16x16x32_bf16 v[184:187], a[32:35], v[144:147], v[120:123]
    v_cvt_pk_bf16_f32 v167, v230, v231
    v_mul_f32_dpp v224, v64, v32 row_newbcast:6 row_mask:0xf bank_mask:0xf
    v_mfma_f32_16x16x32_bf16 v[184:187], a[36:39], v[148:151], v[184:187]
    v_mul_f32_dpp v225, v65, v33 row_newbcast:6 row_mask:0xf bank_mask:0xf
    v_mul_f32_dpp v226, v66, v34 row_newbcast:6 row_mask:0xf bank_mask:0xf
    v_mfma_f32_16x16x32_bf16 v[184:187], a[40:43], v[152:155], v[184:187]
    v_mul_f32_dpp v227, v67, v35 row_newbcast:6 row_mask:0xf bank_mask:0xf
    v_mul_f32_dpp v228, v68, v36 row_newbcast:6 row_mask:0xf bank_mask:0xf
    v_mfma_f32_16x16x32_bf16 v[184:187], a[44:47], v[156:159], v[184:187]
    v_mul_f32_dpp v229, v69, v37 row_newbcast:6 row_mask:0xf bank_mask:0xf
    v_mul_f32_dpp v230, v70, v38 row_newbcast:6 row_mask:0xf bank_mask:0xf
    v_smfmac_f32_16x16x64_bf16 v[244:247], a[172:175], v[152:159], v1
    v_mul_f32_dpp v231, v71, v39 row_newbcast:6 row_mask:0xf bank_mask:0xf
    v_mfma_f32_16x16x32_bf16 v[188:191], a[60:63], v[156:159], v[124:127]
    v_cvt_pk_bf16_f32 v168, v224, v225
    v_cvt_pk_bf16_f32 v169, v226, v227
    v_mfma_f32_16x16x32_bf16 v[188:191], a[56:59], v[152:155], v[188:191]
    v_cvt_pk_bf16_f32 v170, v228, v229
    v_cvt_pk_bf16_f32 v171, v230, v231
    v_mfma_f32_16x16x32_bf16 v[188:191], a[52:55], v[148:151], v[188:191]
    v_mul_f32_dpp v224, v72, v40 row_newbcast:6 row_mask:0xf bank_mask:0xf
    v_mul_f32_dpp v225, v73, v41 row_newbcast:6 row_mask:0xf bank_mask:0xf
    v_mfma_f32_16x16x32_bf16 v[188:191], a[48:51], v[144:147], v[188:191]
    v_mul_f32_dpp v226, v74, v42 row_newbcast:6 row_mask:0xf bank_mask:0xf
    v_mul_f32_dpp v227, v75, v43 row_newbcast:6 row_mask:0xf bank_mask:0xf
    v_mfma_f32_16x16x32_bf16 v[192:195], a[64:67], v[144:147], v[128:131]
    v_mul_f32_dpp v228, v76, v44 row_newbcast:6 row_mask:0xf bank_mask:0xf
    v_mul_f32_dpp v229, v77, v45 row_newbcast:6 row_mask:0xf bank_mask:0xf
    v_mfma_f32_16x16x32_bf16 v[192:195], a[68:71], v[148:151], v[192:195]
    v_mul_f32_dpp v230, v78, v46 row_newbcast:6 row_mask:0xf bank_mask:0xf
    v_mul_f32_dpp v231, v79, v47 row_newbcast:6 row_mask:0xf bank_mask:0xf
    v_mfma_f32_16x16x32_bf16 v[192:195], a[72:75], v[152:155], v[192:195]
    v_cvt_pk_bf16_f32 v172, v224, v225
    v_cvt_pk_bf16_f32 v173, v226, v227
    v_mfma_f32_16x16x32_bf16 v[192:195], a[76:79], v[156:159], v[192:195]
    v_cvt_pk_bf16_f32 v174, v228, v229
    v_cvt_pk_bf16_f32 v175, v230, v231
    v_mfma_f32_16x16x32_bf16 v[196:199], a[92:95], v[156:159], v[132:135]
    v_cvt_pk_bf16_f32 v210, |v180|, |v181|
    v_cvt_pk_bf16_f32 v211, |v182|, |v183|
    v_mfma_f32_16x16x32_bf16 v[196:199], a[88:91], v[152:155], v[196:199]
    v_cvt_pk_bf16_f32 v212, |v184|, |v185|
    v_cvt_pk_bf16_f32 v213, |v186|, |v187|
    v_mfma_f32_16x16x32_bf16 v[196:199], a[84:87], v[148:151], v[196:199]
    v_cvt_pk_bf16_f32 v214, |v188|, |v189|
    v_cvt_pk_bf16_f32 v215, |v190|, |v191|
    v_mfma_f32_16x16x32_bf16 v[196:199], a[80:83], v[144:147], v[196:199]
    v_cvt_pk_bf16_f32 v216, |v192|, |v193|
    v_cvt_pk_bf16_f32 v217, |v194|, |v195|
    v_smfmac_f32_16x16x64_bf16 v[244:247], a[160:163], v[208:215], v1
    v_mul_f32_dpp v224, v48, v16 row_newbcast:4 row_mask:0xf bank_mask:0xf
    v_mfma_f32_16x16x32_bf16 v[200:203], a[96:99], v[144:147], v[136:139]
    v_mul_f32_dpp v225, v49, v17 row_newbcast:4 row_mask:0xf bank_mask:0xf
    v_mul_f32_dpp v226, v50, v18 row_newbcast:4 row_mask:0xf bank_mask:0xf
    v_mfma_f32_16x16x32_bf16 v[200:203], a[100:103], v[148:151], v[200:203]
    v_cvt_pk_bf16_f32 v218, |v196|, |v197|
    v_cvt_pk_bf16_f32 v219, |v198|, |v199|
    v_mfma_f32_16x16x32_bf16 v[200:203], a[104:107], v[152:155], v[200:203]
    v_mul_f32_dpp v227, v51, v19 row_newbcast:4 row_mask:0xf bank_mask:0xf
    v_mul_f32_dpp v228, v52, v20 row_newbcast:4 row_mask:0xf bank_mask:0xf
    v_mfma_f32_16x16x32_bf16 v[200:203], a[108:111], v[156:159], v[200:203]
    v_mul_f32_dpp v229, v53, v21 row_newbcast:4 row_mask:0xf bank_mask:0xf
    v_mul_f32_dpp v230, v54, v22 row_newbcast:4 row_mask:0xf bank_mask:0xf
    v_mfma_f32_16x16x32_bf16 v[204:207], a[124:127], v[156:159], v[140:143]
    v_mul_f32_dpp v231, v55, v23 row_newbcast:4 row_mask:0xf bank_mask:0xf
    v_lshlrev_b32 v80, 16, v96
    v_mfma_f32_16x16x32_bf16 v[204:207], a[120:123], v[152:155], v[204:207]
    v_and_b32 v81, 0xffff0000, v96
    v_lshlrev_b32 v82, 16, v97
    v_mfma_f32_16x16x32_bf16 v[204:207], a[116:119], v[148:151], v[204:207]
    v_cvt_pk_bf16_f32 v220, |v200|, |v201|
    v_cvt_pk_bf16_f32 v221, |v202|, |v203|
    v_mfma_f32_16x16x32_bf16 v[204:207], a[112:115], v[144:147], v[204:207]
    v_cvt_pk_bf16_f32 v144, v224, v225
    v_cvt_pk_bf16_f32 v145, v226, v227
    v_mfma_f32_16x16x32_bf16 v[176:179], a[0:3], v[160:163], v[112:115]
    v_cvt_pk_bf16_f32 v146, v228, v229
    v_cvt_pk_bf16_f32 v147, v230, v231
    v_mfma_f32_16x16x32_bf16 v[176:179], a[4:7], v[164:167], v[176:179]
    v_mul_f32_dpp v224, v56, v24 row_newbcast:4 row_mask:0xf bank_mask:0xf
    v_mul_f32_dpp v225, v57, v25 row_newbcast:4 row_mask:0xf bank_mask:0xf
    v_mfma_f32_16x16x32_bf16 v[176:179], a[8:11], v[168:171], v[176:179]
    v_cvt_pk_bf16_f32 v222, |v204|, |v205|
    v_cvt_pk_bf16_f32 v223, |v206|, |v207|
    v_mfma_f32_16x16x32_bf16 v[176:179], a[12:15], v[172:175], v[176:179]
    v_mul_f32_dpp v226, v58, v26 row_newbcast:4 row_mask:0xf bank_mask:0xf
    v_mul_f32_dpp v227, v59, v27 row_newbcast:4 row_mask:0xf bank_mask:0xf
    v_smfmac_f32_16x16x64_bf16 v[244:247], a[164:167], v[216:223], v1
    v_mul_f32_dpp v228, v60, v28 row_newbcast:4 row_mask:0xf bank_mask:0xf
    v_mfma_f32_16x16x32_bf16 v[180:183], a[28:31], v[172:175], v[116:119]
    v_mul_f32_dpp v229, v61, v29 row_newbcast:4 row_mask:0xf bank_mask:0xf
    v_mul_f32_dpp v230, v62, v30 row_newbcast:4 row_mask:0xf bank_mask:0xf
    v_mfma_f32_16x16x32_bf16 v[180:183], a[24:27], v[168:171], v[180:183]
    v_mul_f32_dpp v231, v63, v31 row_newbcast:4 row_mask:0xf bank_mask:0xf
    v_cvt_pk_bf16_f32 v208, |v176|, |v177|
    v_mfma_f32_16x16x32_bf16 v[180:183], a[20:23], v[164:167], v[180:183]
    v_cvt_pk_bf16_f32 v209, |v178|, |v179|
    v_cvt_pk_bf16_f32 v148, v224, v225
    v_mfma_f32_16x16x32_bf16 v[180:183], a[16:19], v[160:163], v[180:183]
    v_cvt_pk_bf16_f32 v149, v226, v227
    v_cvt_pk_bf16_f32 v150, v228, v229
    v_smfmac_f32_16x16x64_bf16 v[244:247], a[184:187], v[160:167], v1
    v_cvt_pk_bf16_f32 v151, v230, v231
    v_mfma_f32_16x16x32_bf16 v[184:187], a[32:35], v[160:163], v[120:123]
    v_mul_f32_dpp v224, v64, v32 row_newbcast:4 row_mask:0xf bank_mask:0xf
    v_mul_f32_dpp v225, v65, v33 row_newbcast:4 row_mask:0xf bank_mask:0xf
    v_mfma_f32_16x16x32_bf16 v[184:187], a[36:39], v[164:167], v[184:187]
    v_mul_f32_dpp v226, v66, v34 row_newbcast:4 row_mask:0xf bank_mask:0xf
    v_mul_f32_dpp v227, v67, v35 row_newbcast:4 row_mask:0xf bank_mask:0xf
    v_mfma_f32_16x16x32_bf16 v[184:187], a[40:43], v[168:171], v[184:187]
    v_mul_f32_dpp v228, v68, v36 row_newbcast:4 row_mask:0xf bank_mask:0xf
    v_mul_f32_dpp v229, v69, v37 row_newbcast:4 row_mask:0xf bank_mask:0xf
    v_mfma_f32_16x16x32_bf16 v[184:187], a[44:47], v[172:175], v[184:187]
    v_mul_f32_dpp v230, v70, v38 row_newbcast:4 row_mask:0xf bank_mask:0xf
    v_mul_f32_dpp v231, v71, v39 row_newbcast:4 row_mask:0xf bank_mask:0xf
    v_smfmac_f32_16x16x64_bf16 v[244:247], a[188:191], v[168:175], v1
    v_cvt_pk_bf16_f32 v152, v224, v225
    v_mfma_f32_16x16x32_bf16 v[188:191], a[60:63], v[172:175], v[124:127]
    v_cvt_pk_bf16_f32 v153, v226, v227
    v_cvt_pk_bf16_f32 v154, v228, v229
    v_mfma_f32_16x16x32_bf16 v[188:191], a[56:59], v[168:171], v[188:191]
    v_cvt_pk_bf16_f32 v155, v230, v231
    v_mul_f32_dpp v224, v72, v40 row_newbcast:4 row_mask:0xf bank_mask:0xf
    v_mfma_f32_16x16x32_bf16 v[188:191], a[52:55], v[164:167], v[188:191]
    v_mul_f32_dpp v225, v73, v41 row_newbcast:4 row_mask:0xf bank_mask:0xf
    v_mul_f32_dpp v226, v74, v42 row_newbcast:4 row_mask:0xf bank_mask:0xf
    v_mfma_f32_16x16x32_bf16 v[188:191], a[48:51], v[160:163], v[188:191]
    v_mul_f32_dpp v227, v75, v43 row_newbcast:4 row_mask:0xf bank_mask:0xf
    v_mul_f32_dpp v228, v76, v44 row_newbcast:4 row_mask:0xf bank_mask:0xf
    v_smfmac_f32_16x16x64_bf16 v[248:251], a[136:139], v[144:151], v1
    v_mul_f32_dpp v229, v77, v45 row_newbcast:4 row_mask:0xf bank_mask:0xf
    v_mfma_f32_16x16x32_bf16 v[192:195], a[64:67], v[160:163], v[128:131]
    v_mul_f32_dpp v230, v78, v46 row_newbcast:4 row_mask:0xf bank_mask:0xf
    v_mul_f32_dpp v231, v79, v47 row_newbcast:4 row_mask:0xf bank_mask:0xf
    v_mfma_f32_16x16x32_bf16 v[192:195], a[68:71], v[164:167], v[192:195]
    v_cvt_pk_bf16_f32 v156, v224, v225
    v_cvt_pk_bf16_f32 v157, v226, v227
    v_mfma_f32_16x16x32_bf16 v[192:195], a[72:75], v[168:171], v[192:195]
    v_cvt_pk_bf16_f32 v158, v228, v229
    v_cvt_pk_bf16_f32 v159, v230, v231
    v_mfma_f32_16x16x32_bf16 v[192:195], a[76:79], v[172:175], v[192:195]
    v_cvt_pk_bf16_f32 v210, |v180|, |v181|
    v_cvt_pk_bf16_f32 v211, |v182|, |v183|
    v_smfmac_f32_16x16x64_bf16 v[248:251], a[140:143], v[152:159], v1
    v_cvt_pk_bf16_f32 v212, |v184|, |v185|
    v_mfma_f32_16x16x32_bf16 v[196:199], a[92:95], v[172:175], v[132:135]
    v_cvt_pk_bf16_f32 v213, |v186|, |v187|
    v_cvt_pk_bf16_f32 v214, |v188|, |v189|
    v_mfma_f32_16x16x32_bf16 v[196:199], a[88:91], v[168:171], v[196:199]
    v_cvt_pk_bf16_f32 v215, |v190|, |v191|
    v_cvt_pk_bf16_f32 v216, |v192|, |v193|
    v_mfma_f32_16x16x32_bf16 v[196:199], a[84:87], v[164:167], v[196:199]
    v_cvt_pk_bf16_f32 v217, |v194|, |v195|
    v_and_b32 v83, 0xffff0000, v97
    v_mfma_f32_16x16x32_bf16 v[196:199], a[80:83], v[160:163], v[196:199]
    v_lshlrev_b32 v84, 16, v98
    v_and_b32 v85, 0xffff0000, v98
    v_smfmac_f32_16x16x64_bf16 v[244:247], a[176:179], v[208:215], v1
    v_lshlrev_b32 v86, 16, v99
    v_mfma_f32_16x16x32_bf16 v[200:203], a[96:99], v[160:163], v[136:139]
    v_and_b32 v87, 0xffff0000, v99
    v_lshlrev_b32 v88, 16, v100
    v_mfma_f32_16x16x32_bf16 v[200:203], a[100:103], v[164:167], v[200:203]
    v_cvt_pk_bf16_f32 v218, |v196|, |v197|
    v_cvt_pk_bf16_f32 v219, |v198|, |v199|
    v_mfma_f32_16x16x32_bf16 v[200:203], a[104:107], v[168:171], v[200:203]
    v_and_b32 v89, 0xffff0000, v100
    v_lshlrev_b32 v90, 16, v101
    v_mfma_f32_16x16x32_bf16 v[200:203], a[108:111], v[172:175], v[200:203]
    v_and_b32 v91, 0xffff0000, v101
    v_lshlrev_b32 v92, 16, v102
    v_mfma_f32_16x16x32_bf16 v[204:207], a[124:127], v[172:175], v[140:143]
    v_and_b32 v93, 0xffff0000, v102
    v_lshlrev_b32 v94, 16, v103
    v_mfma_f32_16x16x32_bf16 v[204:207], a[120:123], v[168:171], v[204:207]
    v_and_b32 v95, 0xffff0000, v103
    v_mul_f32_dpp v224, v80, v48 row_ror:13 row_mask:0xf bank_mask:0xf
    v_mfma_f32_16x16x32_bf16 v[204:207], a[116:119], v[164:167], v[204:207]
    v_cvt_pk_bf16_f32 v220, |v200|, |v201|
    v_cvt_pk_bf16_f32 v221, |v202|, |v203|
    v_mfma_f32_16x16x32_bf16 v[204:207], a[112:115], v[160:163], v[204:207]
    v_mul_f32_dpp v225, v81, v49 row_ror:13 row_mask:0xf bank_mask:0xf
    v_mul_f32_dpp v226, v82, v50 row_ror:13 row_mask:0xf bank_mask:0xf
    v_mfma_f32_16x16x32_bf16 v[176:179], a[0:3], v[144:147], v[112:115]
    v_mul_f32_dpp v227, v83, v51 row_ror:13 row_mask:0xf bank_mask:0xf
    v_mul_f32_dpp v228, v84, v52 row_ror:13 row_mask:0xf bank_mask:0xf
    v_mfma_f32_16x16x32_bf16 v[176:179], a[4:7], v[148:151], v[176:179]
    v_mul_f32_dpp v229, v85, v53 row_ror:13 row_mask:0xf bank_mask:0xf
    v_mul_f32_dpp v230, v86, v54 row_ror:13 row_mask:0xf bank_mask:0xf
    v_mfma_f32_16x16x32_bf16 v[176:179], a[8:11], v[152:155], v[176:179]
    v_cvt_pk_bf16_f32 v222, |v204|, |v205|
    v_cvt_pk_bf16_f32 v223, |v206|, |v207|
    v_mfma_f32_16x16x32_bf16 v[176:179], a[12:15], v[156:159], v[176:179]
    v_mul_f32_dpp v231, v87, v55 row_ror:13 row_mask:0xf bank_mask:0xf
    v_lshlrev_b32 v96, 16, v104
    v_smfmac_f32_16x16x64_bf16 v[244:247], a[180:183], v[216:223], v1
    v_and_b32 v97, 0xffff0000, v104
    v_mfma_f32_16x16x32_bf16 v[180:183], a[28:31], v[156:159], v[116:119]
    v_lshlrev_b32 v98, 16, v105
    v_and_b32 v99, 0xffff0000, v105
    v_mfma_f32_16x16x32_bf16 v[180:183], a[24:27], v[152:155], v[180:183]
    v_lshlrev_b32 v100, 16, v106
    v_and_b32 v101, 0xffff0000, v106
    v_mfma_f32_16x16x32_bf16 v[180:183], a[20:23], v[148:151], v[180:183]
    v_lshlrev_b32 v102, 16, v107
    v_and_b32 v103, 0xffff0000, v107
    v_mfma_f32_16x16x32_bf16 v[180:183], a[16:19], v[144:147], v[180:183]
    v_cvt_pk_bf16_f32 v160, v224, v225
    v_cvt_pk_bf16_f32 v161, v226, v227
    v_mfma_f32_16x16x32_bf16 v[184:187], a[32:35], v[144:147], v[120:123]
    v_cvt_pk_bf16_f32 v162, v228, v229
    v_cvt_pk_bf16_f32 v163, v230, v231
    v_mfma_f32_16x16x32_bf16 v[184:187], a[36:39], v[148:151], v[184:187]
    v_lshlrev_b32 v104, 16, v108
    v_and_b32 v105, 0xffff0000, v108
    v_mfma_f32_16x16x32_bf16 v[184:187], a[40:43], v[152:155], v[184:187]
    v_lshlrev_b32 v106, 16, v109
    v_and_b32 v107, 0xffff0000, v109
    v_mfma_f32_16x16x32_bf16 v[184:187], a[44:47], v[156:159], v[184:187]
    v_lshlrev_b32 v108, 16, v110
    v_and_b32 v109, 0xffff0000, v110
    v_mfma_f32_16x16x32_bf16 v[188:191], a[60:63], v[156:159], v[124:127]
    v_mul_f32_dpp v224, v88, v56 row_ror:13 row_mask:0xf bank_mask:0xf
    v_mul_f32_dpp v225, v89, v57 row_ror:13 row_mask:0xf bank_mask:0xf
    v_mfma_f32_16x16x32_bf16 v[188:191], a[56:59], v[152:155], v[188:191]
    v_mul_f32_dpp v226, v90, v58 row_ror:13 row_mask:0xf bank_mask:0xf
    v_mul_f32_dpp v227, v91, v59 row_ror:13 row_mask:0xf bank_mask:0xf
    v_mfma_f32_16x16x32_bf16 v[188:191], a[52:55], v[148:151], v[188:191]
    v_mul_f32_dpp v228, v92, v60 row_ror:13 row_mask:0xf bank_mask:0xf
    v_mul_f32_dpp v229, v93, v61 row_ror:13 row_mask:0xf bank_mask:0xf
    v_mfma_f32_16x16x32_bf16 v[188:191], a[48:51], v[144:147], v[188:191]
    v_mul_f32_dpp v230, v94, v62 row_ror:13 row_mask:0xf bank_mask:0xf
    v_mul_f32_dpp v231, v95, v63 row_ror:13 row_mask:0xf bank_mask:0xf
    v_mfma_f32_16x16x32_bf16 v[192:195], a[64:67], v[144:147], v[128:131]
    v_cvt_pk_bf16_f32 v208, |v176|, |v177|
    v_cvt_pk_bf16_f32 v209, |v178|, |v179|
    v_mfma_f32_16x16x32_bf16 v[192:195], a[68:71], v[148:151], v[192:195]
    v_lshlrev_b32 v110, 16, v111
    v_cvt_pk_bf16_f32 v164, v224, v225
    v_mfma_f32_16x16x32_bf16 v[192:195], a[72:75], v[152:155], v[192:195]
    v_cvt_pk_bf16_f32 v165, v226, v227
    v_cvt_pk_bf16_f32 v166, v228, v229
    v_mfma_f32_16x16x32_bf16 v[192:195], a[76:79], v[156:159], v[192:195]
    v_cvt_pk_bf16_f32 v167, v230, v231
    v_and_b32 v111, 0xffff0000, v111
    v_mfma_f32_16x16x32_bf16 v[196:199], a[92:95], v[156:159], v[132:135]
    v_mul_f32_dpp v224, v96, v64 row_ror:13 row_mask:0xf bank_mask:0xf
    v_mul_f32_dpp v225, v97, v65 row_ror:13 row_mask:0xf bank_mask:0xf
    v_mfma_f32_16x16x32_bf16 v[196:199], a[88:91], v[152:155], v[196:199]
    v_mul_f32_dpp v226, v98, v66 row_ror:13 row_mask:0xf bank_mask:0xf
    v_mul_f32_dpp v227, v99, v67 row_ror:13 row_mask:0xf bank_mask:0xf
    v_mfma_f32_16x16x32_bf16 v[196:199], a[84:87], v[148:151], v[196:199]
    v_mul_f32_dpp v228, v100, v68 row_ror:13 row_mask:0xf bank_mask:0xf
    v_mul_f32_dpp v229, v101, v69 row_ror:13 row_mask:0xf bank_mask:0xf
    v_mfma_f32_16x16x32_bf16 v[196:199], a[80:83], v[144:147], v[196:199]
    v_mul_f32_dpp v230, v102, v70 row_ror:13 row_mask:0xf bank_mask:0xf
    v_mul_f32_dpp v231, v103, v71 row_ror:13 row_mask:0xf bank_mask:0xf
    v_mfma_f32_16x16x32_bf16 v[200:203], a[96:99], v[144:147], v[136:139]
    v_cvt_pk_bf16_f32 v168, v224, v225
    v_cvt_pk_bf16_f32 v169, v226, v227
    v_mfma_f32_16x16x32_bf16 v[200:203], a[100:103], v[148:151], v[200:203]
    v_cvt_pk_bf16_f32 v170, v228, v229
    v_cvt_pk_bf16_f32 v171, v230, v231
    v_mfma_f32_16x16x32_bf16 v[200:203], a[104:107], v[152:155], v[200:203]
    v_mul_f32_dpp v224, v104, v72 row_ror:13 row_mask:0xf bank_mask:0xf
    v_mul_f32_dpp v225, v105, v73 row_ror:13 row_mask:0xf bank_mask:0xf
    v_mfma_f32_16x16x32_bf16 v[200:203], a[108:111], v[156:159], v[200:203]
    v_mul_f32_dpp v226, v106, v74 row_ror:13 row_mask:0xf bank_mask:0xf
    v_mul_f32_dpp v227, v107, v75 row_ror:13 row_mask:0xf bank_mask:0xf
    v_mfma_f32_16x16x32_bf16 v[204:207], a[124:127], v[156:159], v[140:143]
    v_mul_f32_dpp v228, v108, v76 row_ror:13 row_mask:0xf bank_mask:0xf
    v_mul_f32_dpp v229, v109, v77 row_ror:13 row_mask:0xf bank_mask:0xf
    v_mfma_f32_16x16x32_bf16 v[204:207], a[120:123], v[152:155], v[204:207]
    v_mul_f32_dpp v230, v110, v78 row_ror:13 row_mask:0xf bank_mask:0xf
    v_mul_f32_dpp v231, v111, v79 row_ror:13 row_mask:0xf bank_mask:0xf
    v_mfma_f32_16x16x32_bf16 v[204:207], a[116:119], v[148:151], v[204:207]
    v_cvt_pk_bf16_f32 v172, v224, v225
    v_cvt_pk_bf16_f32 v173, v226, v227
    v_mfma_f32_16x16x32_bf16 v[204:207], a[112:115], v[144:147], v[204:207]
    v_cvt_pk_bf16_f32 v174, v228, v229
    v_cvt_pk_bf16_f32 v175, v230, v231
    v_mfma_f32_16x16x32_bf16 v[176:179], a[0:3], v[160:163], v[112:115]
    v_cvt_pk_bf16_f32 v210, |v180|, |v181|
    v_cvt_pk_bf16_f32 v211, |v182|, |v183|
    v_mfma_f32_16x16x32_bf16 v[176:179], a[4:7], v[164:167], v[176:179]
    v_cvt_pk_bf16_f32 v212, |v184|, |v185|
    v_cvt_pk_bf16_f32 v213, |v186|, |v187|
    v_mfma_f32_16x16x32_bf16 v[176:179], a[8:11], v[168:171], v[176:179]
    v_cvt_pk_bf16_f32 v214, |v188|, |v189|
    v_cvt_pk_bf16_f32 v215, |v190|, |v191|
    v_mfma_f32_16x16x32_bf16 v[176:179], a[12:15], v[172:175], v[176:179]
    v_cvt_pk_bf16_f32 v216, |v192|, |v193|
    v_cvt_pk_bf16_f32 v217, |v194|, |v195|
    v_smfmac_f32_16x16x64_bf16 v[248:251], a[128:131], v[208:215], v1
    v_cvt_pk_bf16_f32 v218, |v196|, |v197|
    v_mfma_f32_16x16x32_bf16 v[180:183], a[28:31], v[172:175], v[116:119]
    v_cvt_pk_bf16_f32 v219, |v198|, |v199|
    v_cvt_pk_bf16_f32 v220, |v200|, |v201|
    v_mfma_f32_16x16x32_bf16 v[180:183], a[24:27], v[168:171], v[180:183]
    v_cvt_pk_bf16_f32 v221, |v202|, |v203|
    v_cvt_pk_bf16_f32 v222, |v204|, |v205|
    v_mfma_f32_16x16x32_bf16 v[180:183], a[20:23], v[164:167], v[180:183]
    v_cvt_pk_bf16_f32 v223, |v206|, |v207|
    v_mul_f32_dpp v224, v80, v48 row_ror:5 row_mask:0xf bank_mask:0xf
    v_mfma_f32_16x16x32_bf16 v[180:183], a[16:19], v[160:163], v[180:183]
    v_mul_f32_dpp v225, v81, v49 row_ror:5 row_mask:0xf bank_mask:0xf
    v_mul_f32_dpp v226, v82, v50 row_ror:5 row_mask:0xf bank_mask:0xf
    v_smfmac_f32_16x16x64_bf16 v[248:251], a[132:135], v[216:223], v1
    v_mul_f32_dpp v227, v83, v51 row_ror:5 row_mask:0xf bank_mask:0xf
    v_mfma_f32_16x16x32_bf16 v[184:187], a[32:35], v[160:163], v[120:123]
    v_mul_f32_dpp v228, v84, v52 row_ror:5 row_mask:0xf bank_mask:0xf
    v_mul_f32_dpp v229, v85, v53 row_ror:5 row_mask:0xf bank_mask:0xf
    v_mfma_f32_16x16x32_bf16 v[184:187], a[36:39], v[164:167], v[184:187]
    v_mul_f32_dpp v230, v86, v54 row_ror:5 row_mask:0xf bank_mask:0xf
    v_mul_f32_dpp v231, v87, v55 row_ror:5 row_mask:0xf bank_mask:0xf
    v_mfma_f32_16x16x32_bf16 v[184:187], a[40:43], v[168:171], v[184:187]
    v_cvt_pk_bf16_f32 v144, v224, v225
    v_cvt_pk_bf16_f32 v145, v226, v227
    v_mfma_f32_16x16x32_bf16 v[184:187], a[44:47], v[172:175], v[184:187]
    v_cvt_pk_bf16_f32 v146, v228, v229
    v_cvt_pk_bf16_f32 v147, v230, v231
    v_smfmac_f32_16x16x64_bf16 v[248:251], a[152:155], v[160:167], v1
    v_mul_f32_dpp v224, v88, v56 row_ror:5 row_mask:0xf bank_mask:0xf
    v_mfma_f32_16x16x32_bf16 v[188:191], a[60:63], v[172:175], v[124:127]
    v_mul_f32_dpp v225, v89, v57 row_ror:5 row_mask:0xf bank_mask:0xf
    v_mul_f32_dpp v226, v90, v58 row_ror:5 row_mask:0xf bank_mask:0xf
    v_mfma_f32_16x16x32_bf16 v[188:191], a[56:59], v[168:171], v[188:191]
    v_mul_f32_dpp v227, v91, v59 row_ror:5 row_mask:0xf bank_mask:0xf
    v_mul_f32_dpp v228, v92, v60 row_ror:5 row_mask:0xf bank_mask:0xf
    v_mfma_f32_16x16x32_bf16 v[188:191], a[52:55], v[164:167], v[188:191]
    v_mul_f32_dpp v229, v93, v61 row_ror:5 row_mask:0xf bank_mask:0xf
    v_mul_f32_dpp v230, v94, v62 row_ror:5 row_mask:0xf bank_mask:0xf
    v_mfma_f32_16x16x32_bf16 v[188:191], a[48:51], v[160:163], v[188:191]
    v_mul_f32_dpp v231, v95, v63 row_ror:5 row_mask:0xf bank_mask:0xf
    v_cvt_pk_bf16_f32 v208, |v176|, |v177|
    v_smfmac_f32_16x16x64_bf16 v[248:251], a[156:159], v[168:175], v1
    v_cvt_pk_bf16_f32 v209, |v178|, |v179|
    v_mfma_f32_16x16x32_bf16 v[192:195], a[64:67], v[160:163], v[128:131]
    v_cvt_pk_bf16_f32 v148, v224, v225
    v_cvt_pk_bf16_f32 v149, v226, v227
    v_mfma_f32_16x16x32_bf16 v[192:195], a[68:71], v[164:167], v[192:195]
    v_cvt_pk_bf16_f32 v150, v228, v229
    v_cvt_pk_bf16_f32 v151, v230, v231
    v_mfma_f32_16x16x32_bf16 v[192:195], a[72:75], v[168:171], v[192:195]
    v_mul_f32_dpp v224, v96, v64 row_ror:5 row_mask:0xf bank_mask:0xf
    v_mul_f32_dpp v225, v97, v65 row_ror:5 row_mask:0xf bank_mask:0xf
    v_mfma_f32_16x16x32_bf16 v[192:195], a[76:79], v[172:175], v[192:195]
    v_mul_f32_dpp v226, v98, v66 row_ror:5 row_mask:0xf bank_mask:0xf
    v_mul_f32_dpp v227, v99, v67 row_ror:5 row_mask:0xf bank_mask:0xf
    v_mfma_f32_16x16x32_bf16 v[196:199], a[92:95], v[172:175], v[132:135]
    v_mul_f32_dpp v228, v100, v68 row_ror:5 row_mask:0xf bank_mask:0xf
    v_mul_f32_dpp v229, v101, v69 row_ror:5 row_mask:0xf bank_mask:0xf
    v_mfma_f32_16x16x32_bf16 v[196:199], a[88:91], v[168:171], v[196:199]
    v_mul_f32_dpp v230, v102, v70 row_ror:5 row_mask:0xf bank_mask:0xf
    v_mul_f32_dpp v231, v103, v71 row_ror:5 row_mask:0xf bank_mask:0xf
    v_mfma_f32_16x16x32_bf16 v[196:199], a[84:87], v[164:167], v[196:199]
    v_cvt_pk_bf16_f32 v152, v224, v225
    v_cvt_pk_bf16_f32 v153, v226, v227
    v_mfma_f32_16x16x32_bf16 v[196:199], a[80:83], v[160:163], v[196:199]
    v_cvt_pk_bf16_f32 v154, v228, v229
    v_cvt_pk_bf16_f32 v155, v230, v231
    v_mfma_f32_16x16x32_bf16 v[200:203], a[96:99], v[160:163], v[136:139]
    v_mul_f32_dpp v224, v104, v72 row_ror:5 row_mask:0xf bank_mask:0xf
    v_mul_f32_dpp v225, v105, v73 row_ror:5 row_mask:0xf bank_mask:0xf
    v_mfma_f32_16x16x32_bf16 v[200:203], a[100:103], v[164:167], v[200:203]
    v_mul_f32_dpp v226, v106, v74 row_ror:5 row_mask:0xf bank_mask:0xf
    v_mul_f32_dpp v227, v107, v75 row_ror:5 row_mask:0xf bank_mask:0xf
    v_mfma_f32_16x16x32_bf16 v[200:203], a[104:107], v[168:171], v[200:203]
L_stub3:
    s_cbranch_scc1 L_main2
    v_mul_f32_dpp v228, v108, v76 row_ror:5 row_mask:0xf bank_mask:0xf
    v_mul_f32_dpp v229, v109, v77 row_ror:5 row_mask:0xf bank_mask:0xf
    v_mfma_f32_16x16x32_bf16 v[200:203], a[108:111], v[172:175], v[200:203]
    v_mul_f32_dpp v230, v110, v78 row_ror:5 row_mask:0xf bank_mask:0xf
    v_mul_f32_dpp v231, v111, v79 row_ror:5 row_mask:0xf bank_mask:0xf
    v_mfma_f32_16x16x32_bf16 v[204:207], a[124:127], v[172:175], v[140:143]
    v_cvt_pk_bf16_f32 v156, v224, v225
    v_cvt_pk_bf16_f32 v157, v226, v227
    v_mfma_f32_16x16x32_bf16 v[204:207], a[120:123], v[168:171], v[204:207]
    v_cvt_pk_bf16_f32 v158, v228, v229
    v_cvt_pk_bf16_f32 v159, v230, v231
    v_mfma_f32_16x16x32_bf16 v[204:207], a[116:119], v[164:167], v[204:207]
    v_cvt_pk_bf16_f32 v210, |v180|, |v181|
    v_cvt_pk_bf16_f32 v211, |v182|, |v183|
    v_mfma_f32_16x16x32_bf16 v[204:207], a[112:115], v[160:163], v[204:207]
    v_cvt_pk_bf16_f32 v212, |v184|, |v185|
    v_cvt_pk_bf16_f32 v213, |v186|, |v187|
    v_mfma_f32_16x16x32_bf16 v[176:179], a[0:3], v[144:147], v[112:115]
    v_cvt_pk_bf16_f32 v214, |v188|, |v189|
    v_cvt_pk_bf16_f32 v215, |v190|, |v191|
    v_mfma_f32_16x16x32_bf16 v[176:179], a[4:7], v[148:151], v[176:179]
    v_cvt_pk_bf16_f32 v216, |v192|, |v193|
    v_cvt_pk_bf16_f32 v217, |v194|, |v195|
    v_mfma_f32_16x16x32_bf16 v[176:179], a[8:11], v[152:155], v[176:179]
    v_cvt_pk_bf16_f32 v218, |v196|, |v197|
    v_cvt_pk_bf16_f32 v219, |v198|, |v199|
    v_mfma_f32_16x16x32_bf16 v[176:179], a[12:15], v[156:159], v[176:179]
    v_cvt_pk_bf16_f32 v220, |v200|, |v201|
    v_cvt_pk_bf16_f32 v221, |v202|, |v203|
    v_smfmac_f32_16x16x64_bf16 v[248:251], a[144:147], v[208:215], v1
    v_cvt_pk_bf16_f32 v222, |v204|, |v205|
    v_mfma_f32_16x16x32_bf16 v[180:183], a[28:31], v[156:159], v[116:119]
    v_cvt_pk_bf16_f32 v223, |v206|, |v207|
    v_mul_f32 v224, v80, v48
    v_mfma_f32_16x16x32_bf16 v[180:183], a[24:27], v[152:155], v[180:183]
    v_mul_f32 v225, v81, v49
    v_mul_f32 v226, v82, v50
    v_mfma_f32_16x16x32_bf16 v[180:183], a[20:23], v[148:151], v[180:183]
    v_mul_f32 v227, v83, v51
    v_mul_f32 v228, v84, v52
    v_mfma_f32_16x16x32_bf16 v[180:183], a[16:19], v[144:147], v[180:183]
    v_mul_f32 v229, v85, v53
    v_mul_f32 v230, v86, v54
    v_smfmac_f32_16x16x64_bf16 v[248:251], a[148:151], v[216:223], v1
    v_mul_f32 v231, v87, v55
    v_mfma_f32_16x16x32_bf16 v[184:187], a[32:35], v[144:147], v[120:123]
    v_cvt_pk_bf16_f32 v160, v224, v225
    v_cvt_pk_bf16_f32 v161, v226, v227
    v_mfma_f32_16x16x32_bf16 v[184:187], a[36:39], v[148:151], v[184:187]
    v_cvt_pk_bf16_f32 v162, v228, v229
    v_cvt_pk_bf16_f32 v163, v230, v231
    v_mfma_f32_16x16x32_bf16 v[184:187], a[40:43], v[152:155], v[184:187]
    v_mul_f32 v224, v88, v56
    v_mul_f32 v225, v89, v57
    v_mfma_f32_16x16x32_bf16 v[184:187], a[44:47], v[156:159], v[184:187]
    v_mul_f32 v226, v90, v58
    v_mul_f32 v227, v91, v59
    v_smfmac_f32_16x16x64_bf16 v[248:251], a[168:171], v[144:151], v1
    v_mul_f32 v228, v92, v60
    v_mfma_f32_16x16x32_bf16 v[188:191], a[60:63], v[156:159], v[124:127]
    v_mul_f32 v229, v93, v61
    v_mul_f32 v230, v94, v62
    v_mfma_f32_16x16x32_bf16 v[188:191], a[56:59], v[152:155], v[188:191]
    v_mul_f32 v231, v95, v63
    v_cvt_pk_bf16_f32 v208, |v176|, |v177|
    v_mfma_f32_16x16x32_bf16 v[188:191], a[52:55], v[148:151], v[188:191]
    v_cvt_pk_bf16_f32 v209, |v178|, |v179|
    v_cvt_pk_bf16_f32 v164, v224, v225
    v_mfma_f32_16x16x32_bf16 v[188:191], a[48:51], v[144:147], v[188:191]
    v_cvt_pk_bf16_f32 v165, v226, v227
    v_cvt_pk_bf16_f32 v166, v228, v229
    v_smfmac_f32_16x16x64_bf16 v[248:251], a[172:175], v[152:159], v1
    v_cvt_pk_bf16_f32 v167, v230, v231
    v_mfma_f32_16x16x32_bf16 v[192:195], a[64:67], v[144:147], v[128:131]
    v_mul_f32 v224, v96, v64
    v_mul_f32 v225, v97, v65
    v_mfma_f32_16x16x32_bf16 v[192:195], a[68:71], v[148:151], v[192:195]
    v_mul_f32 v226, v98, v66
    v_mul_f32 v227, v99, v67
    v_mfma_f32_16x16x32_bf16 v[192:195], a[72:75], v[152:155], v[192:195]
    v_mul_f32 v228, v100, v68
    v_mul_f32 v229, v101, v69
    v_mfma_f32_16x16x32_bf16 v[192:195], a[76:79], v[156:159], v[192:195]
    v_mul_f32 v230, v102, v70
    v_mul_f32 v231, v103, v71
    v_mfma_f32_16x16x32_bf16 v[196:199], a[92:95], v[156:159], v[132:135]
    v_cvt_pk_bf16_f32 v168, v224, v225
    v_cvt_pk_bf16_f32 v169, v226, v227
    v_mfma_f32_16x16x32_bf16 v[196:199], a[88:91], v[152:155], v[196:199]
    v_cvt_pk_bf16_f32 v170, v228, v229
    v_cvt_pk_bf16_f32 v171, v230, v231
    v_mfma_f32_16x16x32_bf16 v[196:199], a[84:87], v[148:151], v[196:199]
    v_mul_f32 v224, v104, v72
    v_mul_f32 v225, v105, v73
    v_mfma_f32_16x16x32_bf16 v[196:199], a[80:83], v[144:147], v[196:199]
    v_mul_f32 v226, v106, v74
    v_mul_f32 v227, v107, v75
    v_mfma_f32_16x16x32_bf16 v[200:203], a[96:99], v[144:147], v[136:139]
    v_mul_f32 v228, v108, v76
    v_mul_f32 v229, v109, v77
    v_mfma_f32_16x16x32_bf16 v[200:203], a[100:103], v[148:151], v[200:203]
    v_mul_f32 v230, v110, v78
    v_mul_f32 v231, v111, v79
    v_mfma_f32_16x16x32_bf16 v[200:203], a[104:107], v[152:155], v[200:203]
    v_cvt_pk_bf16_f32 v172, v224, v225
    v_cvt_pk_bf16_f32 v173, v226, v227
    v_mfma_f32_16x16x32_bf16 v[200:203], a[108:111], v[156:159], v[200:203]
    v_cvt_pk_bf16_f32 v174, v228, v229
    v_cvt_pk_bf16_f32 v175, v230, v231
    v_mfma_f32_16x16x32_bf16 v[204:207], a[124:127], v[156:159], v[140:143]
    v_cvt_pk_bf16_f32 v210, |v180|, |v181|
    v_cvt_pk_bf16_f32 v211, |v182|, |v183|
    v_mfma_f32_16x16x32_bf16 v[204:207], a[120:123], v[152:155], v[204:207]
    v_cvt_pk_bf16_f32 v212, |v184|, |v185|
    v_cvt_pk_bf16_f32 v213, |v186|, |v187|
    v_mfma_f32_16x16x32_bf16 v[204:207], a[116:119], v[148:151], v[204:207]
    v_cvt_pk_bf16_f32 v214, |v188|, |v189|
    v_cvt_pk_bf16_f32 v215, |v190|, |v191|
    v_mfma_f32_16x16x32_bf16 v[204:207], a[112:115], v[144:147], v[204:207]
    v_cvt_pk_bf16_f32 v216, |v192|, |v193|
    v_cvt_pk_bf16_f32 v217, |v194|, |v195|
    v_smfmac_f32_16x16x64_bf16 v[248:251], a[160:163], v[208:215], v1
    v_cvt_pk_bf16_f32 v218, |v196|, |v197|
    v_mfma_f32_16x16x32_bf16 v[176:179], a[0:3], v[160:163], v[112:115]
    v_cvt_pk_bf16_f32 v219, |v198|, |v199|
    v_cvt_pk_bf16_f32 v220, |v200|, |v201|
    v_mfma_f32_16x16x32_bf16 v[176:179], a[4:7], v[164:167], v[176:179]
    v_cvt_pk_bf16_f32 v221, |v202|, |v203|
    v_cvt_pk_bf16_f32 v222, |v204|, |v205|
    v_mfma_f32_16x16x32_bf16 v[176:179], a[8:11], v[168:171], v[176:179]
    v_cvt_pk_bf16_f32 v223, |v206|, |v207|
    v_mul_f32_dpp v224, v16, v16 row_ror:8 row_mask:0xf bank_mask:0xf
    v_mfma_f32_16x16x32_bf16 v[176:179], a[12:15], v[172:175], v[176:179]
    v_mul_f32_dpp v225, v17, v17 row_ror:8 row_mask:0xf bank_mask:0xf
    v_mul_f32_dpp v226, v18, v18 row_ror:8 row_mask:0xf bank_mask:0xf
    v_smfmac_f32_16x16x64_bf16 v[248:251], a[164:167], v[216:223], v1
    v_mul_f32_dpp v227, v19, v19 row_ror:8 row_mask:0xf bank_mask:0xf
    v_mfma_f32_16x16x32_bf16 v[180:183], a[28:31], v[172:175], v[116:119]
    v_mul_f32_dpp v228, v20, v20 row_ror:8 row_mask:0xf bank_mask:0xf
    v_mul_f32_dpp v229, v21, v21 row_ror:8 row_mask:0xf bank_mask:0xf
    v_mfma_f32_16x16x32_bf16 v[180:183], a[24:27], v[168:171], v[180:183]
    v_mul_f32_dpp v230, v22, v22 row_ror:8 row_mask:0xf bank_mask:0xf
    v_mul_f32_dpp v231, v23, v23 row_ror:8 row_mask:0xf bank_mask:0xf
    v_mfma_f32_16x16x32_bf16 v[180:183], a[20:23], v[164:167], v[180:183]
    v_cvt_pk_bf16_f32 v144, v224, v225
    v_cvt_pk_bf16_f32 v145, v226, v227
    v_mfma_f32_16x16x32_bf16 v[180:183], a[16:19], v[160:163], v[180:183]
    v_cvt_pk_bf16_f32 v146, v228, v229
    v_cvt_pk_bf16_f32 v147, v230, v231
    v_smfmac_f32_16x16x64_bf16 v[248:251], a[184:187], v[160:167], v1
    v_mul_f32_dpp v224, v24, v24 row_ror:8 row_mask:0xf bank_mask:0xf
    v_mfma_f32_16x16x32_bf16 v[184:187], a[32:35], v[160:163], v[120:123]
    v_mul_f32_dpp v225, v25, v25 row_ror:8 row_mask:0xf bank_mask:0xf
    v_mul_f32_dpp v226, v26, v26 row_ror:8 row_mask:0xf bank_mask:0xf
    v_mfma_f32_16x16x32_bf16 v[184:187], a[36:39], v[164:167], v[184:187]
    v_mul_f32_dpp v227, v27, v27 row_ror:8 row_mask:0xf bank_mask:0xf
    v_mul_f32_dpp v228, v28, v28 row_ror:8 row_mask:0xf bank_mask:0xf
    v_mfma_f32_16x16x32_bf16 v[184:187], a[40:43], v[168:171], v[184:187]
    v_mul_f32_dpp v229, v29, v29 row_ror:8 row_mask:0xf bank_mask:0xf
    v_mul_f32_dpp v230, v30, v30 row_ror:8 row_mask:0xf bank_mask:0xf
    v_mfma_f32_16x16x32_bf16 v[184:187], a[44:47], v[172:175], v[184:187]
    v_mul_f32_dpp v231, v31, v31 row_ror:8 row_mask:0xf bank_mask:0xf
    v_cvt_pk_bf16_f32 v208, |v176|, |v177|
    v_smfmac_f32_16x16x64_bf16 v[248:251], a[188:191], v[168:175], v1
    v_cvt_pk_bf16_f32 v209, |v178|, |v179|
    v_mfma_f32_16x16x32_bf16 v[188:191], a[60:63], v[172:175], v[124:127]
    v_cvt_pk_bf16_f32 v148, v224, v225
    v_cvt_pk_bf16_f32 v149, v226, v227
    v_mfma_f32_16x16x32_bf16 v[188:191], a[56:59], v[168:171], v[188:191]
    v_cvt_pk_bf16_f32 v150, v228, v229
    v_cvt_pk_bf16_f32 v151, v230, v231
    v_mfma_f32_16x16x32_bf16 v[188:191], a[52:55], v[164:167], v[188:191]
    v_mul_f32_dpp v224, v32, v32 row_ror:8 row_mask:0xf bank_mask:0xf
    v_mul_f32_dpp v225, v33, v33 row_ror:8 row_mask:0xf bank_mask:0xf
    v_mfma_f32_16x16x32_bf16 v[188:191], a[48:51], v[160:163], v[188:191]
    v_mul_f32_dpp v226, v34, v34 row_ror:8 row_mask:0xf bank_mask:0xf
    v_mul_f32_dpp v227, v35, v35 row_ror:8 row_mask:0xf bank_mask:0xf
    v_smfmac_f32_16x16x64_bf16 v[252:255], a[136:139], v[144:151], v1
    v_mul_f32_dpp v228, v36, v36 row_ror:8 row_mask:0xf bank_mask:0xf
    v_mfma_f32_16x16x32_bf16 v[192:195], a[64:67], v[160:163], v[128:131]
    v_mul_f32_dpp v229, v37, v37 row_ror:8 row_mask:0xf bank_mask:0xf
    v_mul_f32_dpp v230, v38, v38 row_ror:8 row_mask:0xf bank_mask:0xf
    v_mfma_f32_16x16x32_bf16 v[192:195], a[68:71], v[164:167], v[192:195]
    v_mul_f32_dpp v231, v39, v39 row_ror:8 row_mask:0xf bank_mask:0xf
    v_cvt_pk_bf16_f32 v152, v224, v225
    v_mfma_f32_16x16x32_bf16 v[192:195], a[72:75], v[168:171], v[192:195]
    v_cvt_pk_bf16_f32 v153, v226, v227
    v_cvt_pk_bf16_f32 v154, v228, v229
    v_mfma_f32_16x16x32_bf16 v[192:195], a[76:79], v[172:175], v[192:195]
    v_cvt_pk_bf16_f32 v155, v230, v231
    v_mul_f32_dpp v224, v40, v40 row_ror:8 row_mask:0xf bank_mask:0xf
    v_mfma_f32_16x16x32_bf16 v[196:199], a[92:95], v[172:175], v[132:135]
    v_mul_f32_dpp v225, v41, v41 row_ror:8 row_mask:0xf bank_mask:0xf
    v_mul_f32_dpp v226, v42, v42 row_ror:8 row_mask:0xf bank_mask:0xf
    v_mfma_f32_16x16x32_bf16 v[196:199], a[88:91], v[168:171], v[196:199]
    v_mul_f32_dpp v227, v43, v43 row_ror:8 row_mask:0xf bank_mask:0xf
    v_mul_f32_dpp v228, v44, v44 row_ror:8 row_mask:0xf bank_mask:0xf
    v_mfma_f32_16x16x32_bf16 v[196:199], a[84:87], v[164:167], v[196:199]
    v_mul_f32_dpp v229, v45, v45 row_ror:8 row_mask:0xf bank_mask:0xf
    v_mul_f32_dpp v230, v46, v46 row_ror:8 row_mask:0xf bank_mask:0xf
    v_mfma_f32_16x16x32_bf16 v[196:199], a[80:83], v[160:163], v[196:199]
    v_mul_f32_dpp v231, v47, v47 row_ror:8 row_mask:0xf bank_mask:0xf
    v_cvt_pk_bf16_f32 v156, v224, v225
    v_mfma_f32_16x16x32_bf16 v[200:203], a[96:99], v[160:163], v[136:139]
    v_cvt_pk_bf16_f32 v157, v226, v227
    v_cvt_pk_bf16_f32 v158, v228, v229
    v_mfma_f32_16x16x32_bf16 v[200:203], a[100:103], v[164:167], v[200:203]
    v_cvt_pk_bf16_f32 v159, v230, v231
    v_cvt_pk_bf16_f32 v210, |v180|, |v181|
    v_mfma_f32_16x16x32_bf16 v[200:203], a[104:107], v[168:171], v[200:203]
    v_cvt_pk_bf16_f32 v211, |v182|, |v183|
    v_cvt_pk_bf16_f32 v212, |v184|, |v185|
    v_mfma_f32_16x16x32_bf16 v[200:203], a[108:111], v[172:175], v[200:203]
    v_cvt_pk_bf16_f32 v213, |v186|, |v187|
    v_cvt_pk_bf16_f32 v214, |v188|, |v189|
    v_smfmac_f32_16x16x64_bf16 v[252:255], a[140:143], v[152:159], v1
    v_cvt_pk_bf16_f32 v215, |v190|, |v191|
    v_mfma_f32_16x16x32_bf16 v[204:207], a[124:127], v[172:175], v[140:143]
    v_cvt_pk_bf16_f32 v216, |v192|, |v193|
    v_cvt_pk_bf16_f32 v217, |v194|, |v195|
    v_mfma_f32_16x16x32_bf16 v[204:207], a[120:123], v[168:171], v[204:207]
    v_cvt_pk_bf16_f32 v218, |v196|, |v197|
    v_cvt_pk_bf16_f32 v219, |v198|, |v199|
    v_mfma_f32_16x16x32_bf16 v[204:207], a[116:119], v[164:167], v[204:207]
    v_cvt_pk_bf16_f32 v220, |v200|, |v201|
    v_cvt_pk_bf16_f32 v221, |v202|, |v203|
    v_mfma_f32_16x16x32_bf16 v[204:207], a[112:115], v[160:163], v[204:207]
    v_add_f32 v232, v232, v233
    v_add_f32 v236, v236, v237
    v_smfmac_f32_16x16x64_bf16 v[248:251], a[176:179], v[208:215], v1
    v_add_f32 v240, v240, v241
    v_mfma_f32_16x16x32_bf16 v[176:179], a[0:3], v[144:147], v[112:115]
    v_max3_f32 v12, v232, v236, v240
    v_add_f32 v244, v244, v245
    v_mfma_f32_16x16x32_bf16 v[176:179], a[4:7], v[148:151], v[176:179]
    v_cvt_pk_bf16_f32 v222, |v204|, |v205|
    v_cvt_pk_bf16_f32 v223, |v206|, |v207|
    v_mfma_f32_16x16x32_bf16 v[176:179], a[8:11], v[152:155], v[176:179]
    v_add_f32 v234, v234, v235
    v_add_f32 v238, v238, v239
    v_mfma_f32_16x16x32_bf16 v[176:179], a[12:15], v[156:159], v[176:179]
    v_add_f32 v242, v242, v243
    v_add_f32 v246, v246, v247
    v_smfmac_f32_16x16x64_bf16 v[248:251], a[180:183], v[216:223], v1
    v_mfma_f32_16x16x32_bf16 v[180:183], a[28:31], v[156:159], v[116:119]
    v_mfma_f32_16x16x32_bf16 v[180:183], a[24:27], v[152:155], v[180:183]
    v_mfma_f32_16x16x32_bf16 v[180:183], a[20:23], v[148:151], v[180:183]
    v_mfma_f32_16x16x32_bf16 v[180:183], a[16:19], v[144:147], v[180:183]
    v_mfma_f32_16x16x32_bf16 v[184:187], a[32:35], v[144:147], v[120:123]
    v_cvt_pk_bf16_f32 v208, |v176|, |v177|
    v_cvt_pk_bf16_f32 v209, |v178|, |v179|
    v_mfma_f32_16x16x32_bf16 v[184:187], a[36:39], v[148:151], v[184:187]
    v_mfma_f32_16x16x32_bf16 v[184:187], a[40:43], v[152:155], v[184:187]
    v_mfma_f32_16x16x32_bf16 v[184:187], a[44:47], v[156:159], v[184:187]
    v_add_f32 v248, v248, v249
    v_max3_f32 v12, v12, v244, v248
    v_mfma_f32_16x16x32_bf16 v[188:191], a[60:63], v[156:159], v[124:127]
    v_mul_f32 v2, v12, v10
    v_max_f32_dpp v12, v12, v12 row_ror:8 row_mask:0xf bank_mask:0xf
    v_mfma_f32_16x16x32_bf16 v[188:191], a[56:59], v[152:155], v[188:191]
    v_cvt_pk_bf16_f32 v210, |v180|, |v181|
    v_max_f32_dpp v12, v12, v12 row_ror:4 row_mask:0xf bank_mask:0xf
    v_mfma_f32_16x16x32_bf16 v[188:191], a[52:55], v[148:151], v[188:191]
    v_cvt_pk_bf16_f32 v211, |v182|, |v183|
    v_max_f32_dpp v12, v12, v12 row_ror:2 row_mask:0xf bank_mask:0xf
    v_mfma_f32_16x16x32_bf16 v[188:191], a[48:51], v[144:147], v[188:191]
    v_cvt_pk_bf16_f32 v212, |v184|, |v185|
    v_max_f32_dpp v12, v12, v12 row_ror:1 row_mask:0xf bank_mask:0xf
    v_mfma_f32_16x16x32_bf16 v[192:195], a[64:67], v[144:147], v[128:131]
    v_cvt_pk_bf16_f32 v213, |v186|, |v187|
    v_max_f32_dpp v12, v12, v12 row_bcast:15 row_mask:0xa bank_mask:0xf
    v_mfma_f32_16x16x32_bf16 v[192:195], a[68:71], v[148:151], v[192:195]
    v_fma_f32 v232, v232, v10, -v2
    v_max_f32_dpp v12, v12, v12 row_bcast:31 row_mask:0xc bank_mask:0xf
    v_mfma_f32_16x16x32_bf16 v[192:195], a[72:75], v[152:155], v[192:195]
    v_cvt_pk_bf16_f32 v214, |v188|, |v189|
    v_cvt_pk_bf16_f32 v215, |v190|, |v191|
    v_mfma_f32_16x16x32_bf16 v[192:195], a[76:79], v[156:159], v[192:195]
    v_readlane_b32 s14, v12, 63
    v_fma_f32 v236, v236, v10, -v2
    v_smfmac_f32_16x16x64_bf16 v[252:255], a[128:131], v[208:215], v1
    v_exp_f32 v232, v232
    v_mfma_f32_16x16x32_bf16 v[196:199], a[92:95], v[156:159], v[132:135]
    v_exp_f32 v236, v236
    v_mfma_f32_16x16x32_bf16 v[196:199], a[88:91], v[152:155], v[196:199]
    v_fma_f32 v240, v240, v10, -v2
    v_exp_f32 v240, v240
    v_mfma_f32_16x16x32_bf16 v[196:199], a[84:87], v[148:151], v[196:199]
    v_fma_f32 v244, v244, v10, -v2
    v_cvt_pk_bf16_f32 v216, |v192|, |v193|
    v_mfma_f32_16x16x32_bf16 v[196:199], a[80:83], v[144:147], v[196:199]
    v_cvt_pk_bf16_f32 v217, |v194|, |v195|
    v_mul_f32 v13, s14, v10
    v_mfma_f32_16x16x32_bf16 v[200:203], a[96:99], v[144:147], v[136:139]
    v_exp_f32 v244, v244
    v_mfma_f32_16x16x32_bf16 v[200:203], a[100:103], v[148:151], v[200:203]
    v_fma_f32 v248, v248, v10, -v2
    v_add_f32 v14, v232, v236
    v_mfma_f32_16x16x32_bf16 v[200:203], a[104:107], v[152:155], v[200:203]
    v_cvt_pk_bf16_f32 v218, |v196|, |v197|
    v_cvt_pk_bf16_f32 v219, |v198|, |v199|
    v_mfma_f32_16x16x32_bf16 v[200:203], a[108:111], v[156:159], v[200:203]
    v_sub_f32 v3, v2, v13
    v_exp_f32 v248, v248
    v_mfma_f32_16x16x32_bf16 v[204:207], a[124:127], v[156:159], v[140:143]
    v_mul_f32 v15, v232, v234
    v_add_f32 v14, v14, v240
    v_mfma_f32_16x16x32_bf16 v[204:207], a[120:123], v[152:155], v[204:207]
    v_exp_f32 v3, v3
    v_mfma_f32_16x16x32_bf16 v[204:207], a[116:119], v[148:151], v[204:207]
    v_cvt_pk_bf16_f32 v220, |v200|, |v201|
    v_cvt_pk_bf16_f32 v221, |v202|, |v203|
    v_mfma_f32_16x16x32_bf16 v[204:207], a[112:115], v[144:147], v[204:207]
    v_fmac_f32 v15, v236, v238
    v_add_f32 v14, v14, v244
    v_fmac_f32 v15, v240, v242
    v_add_f32 v14, v14, v248
    v_add_f32 v250, v250, v251
    v_fmac_f32 v15, v244, v246
    v_mul_f32 v14, v14, v3
    v_fmac_f32 v15, v248, v250
    v_cvt_pk_bf16_f32 v222, |v204|, |v205|
    v_cvt_pk_bf16_f32 v223, |v206|, |v207|
    v_mul_f32 v15, v15, v3
    v_add_f32_dpp v14, v14, v14 row_ror:8 row_mask:0xf bank_mask:0xf
    v_smfmac_f32_16x16x64_bf16 v[252:255], a[132:135], v[216:223], v1
    v_add_f32_dpp v15, v15, v15 row_ror:8 row_mask:0xf bank_mask:0xf
    v_add_f32_dpp v14, v14, v14 row_ror:4 row_mask:0xf bank_mask:0xf
    s_nop 0
    v_add_f32_dpp v15, v15, v15 row_ror:4 row_mask:0xf bank_mask:0xf
    v_add_f32_dpp v14, v14, v14 row_ror:2 row_mask:0xf bank_mask:0xf
    s_nop 0
    v_add_f32_dpp v15, v15, v15 row_ror:2 row_mask:0xf bank_mask:0xf
    v_add_f32_dpp v14, v14, v14 row_ror:1 row_mask:0xf bank_mask:0xf
    s_nop 0
    v_add_f32_dpp v15, v15, v15 row_ror:1 row_mask:0xf bank_mask:0xf
    v_add_f32 v252, v252, v253
    v_max_f32 v6, s14, v252
    v_add_f32 v254, v254, v255
    v_add_f32_dpp v14, v14, v14 row_bcast:15 row_mask:0xa bank_mask:0xf
    v_max_f32_dpp v6, v6, v6 row_ror:4 row_mask:0xf bank_mask:0xf
    v_add_f32_dpp v15, v15, v15 row_bcast:15 row_mask:0xa bank_mask:0xf
    v_add_f32_dpp v14, v14, v14 row_bcast:31 row_mask:0xc bank_mask:0xf
    v_max_f32_dpp v6, v6, v6 row_ror:2 row_mask:0xf bank_mask:0xf
    v_add_f32_dpp v15, v15, v15 row_bcast:31 row_mask:0xc bank_mask:0xf
    v_readlane_b32 s15, v14, 63
    v_max_f32_dpp v6, v6, v6 row_ror:1 row_mask:0xf bank_mask:0xf
    v_mul_f32 v4, v6, v10
    v_fma_f32 v252, v252, v10, -v4
    v_exp_f32 v252, v252
    v_sub_f32 v5, v13, v4
    v_mul_f32 v254, v252, v254
    v_add_f32_dpp v252, v252, v252 row_ror:4 row_mask:0xf bank_mask:0xf
    v_exp_f32 v5, v5
    v_add_f32_dpp v254, v254, v254 row_ror:4 row_mask:0xf bank_mask:0xf
    v_add_f32_dpp v252, v252, v252 row_ror:2 row_mask:0xf bank_mask:0xf
    v_readlane_b32 s34, v15, 63
    v_add_f32_dpp v254, v254, v254 row_ror:2 row_mask:0xf bank_mask:0xf
    v_add_f32_dpp v252, v252, v252 row_ror:1 row_mask:0xf bank_mask:0xf
    v_fmac_f32 v252, s15, v5
    v_add_f32_dpp v254, v254, v254 row_ror:1 row_mask:0xf bank_mask:0xf
    v_rcp_f32 v252, v252
    v_fmac_f32 v254, s34, v5
    v_mul_f32 v254, v254, v252
    v_cvt_pk_bf16_f32 v254, v254, v254
    buffer_store_short v254, v11, s[36:39], 0 offen
L_end:
s_endpgm
.section .rodata,"a"
.p2align 6
.amdhsa_kernel standalone__factorization_afm__recsys_kernel
  .amdhsa_next_free_vgpr 448
  .amdhsa_next_free_sgpr 102
  .amdhsa_accum_offset 256
  .amdhsa_group_segment_fixed_size 0
  .amdhsa_kernarg_size 88
  .amdhsa_user_sgpr_count 2
  .amdhsa_user_sgpr_kernarg_segment_ptr 1
  .amdhsa_system_sgpr_workgroup_id_x 1
  .amdhsa_float_denorm_mode_32 3
.end_amdhsa_kernel
```

```asm
; @launch grid=(256,1,1) block=(256,1,1) lds=67200
.amdgcn_target "amdgcn-amd-amdhsa--gfx950"
.text
.globl standalone__factorization_afm__recsys_kernel
.p2align 8
.type standalone__factorization_afm__recsys_kernel,@function
standalone__factorization_afm__recsys_kernel:
    s_load_dwordx16 s[16:31], s[0:1], 0
    s_load_dwordx2 s[36:37], s[0:1], 64
    s_cmp_ge_u32 s2, 256
    s_cbranch_scc1 L_end
    s_getpc_b64 s[10:11]
L_pc:
    s_lshl_b32 s8, s2, 8
    v_lshrrev_b32 v70, 6, v0
    v_and_b32 v69, 3, v0
    v_lshl_or_b32 v69, v70, 2, v69
    s_and_b32 s8, s8, 0x7800
    v_lshl_or_b32 v69, v69, 7, s8
    v_min_u32 v69, L_end-L_pc, v69
    global_load_dword v72, v69, s[10:11]
    v_lshrrev_b32 v70, 6, v0
    v_and_b32 v50, 15, v0
    v_readfirstlane_b32 s3, v70
    v_bfe_u32 v51, v0, 4, 2
    v_and_b32 v52, 63, v0
    s_and_b32 s4, s2, 7
    s_lshl_b32 s4, s4, 7
    s_lshr_b32 s6, s2, 3
    s_lshl_b32 s6, s6, 2
    s_add_u32 s4, s4, s6
    s_add_u32 s4, s4, s3
    s_mul_i32 s6, s4, 104
    v_and_b32 v53, 0x38, v0
    v_add_u32 v53, s6, v53
    v_mul_u32_u24 v62, 12, v51
    v_min_u32 v62, 28, v62
    v_add_u32 v62, s6, v62
    s_mul_i32 s9, s3, 8448
    v_and_b32 v69, 2, v51
    v_add_u32 v69, v69, v51
    v_lshlrev_b32 v70, 4, v50
    v_lshl_add_u32 v56, v69, 10, v70
    s_bfe_u32 s8, s2, 0x30003
    s_mul_i32 s44, s8, 1056
    s_and_b32 s12, s8, 4
    s_add_u32 s12, s12, s8
    s_lshl_b32 s7, s3, 5
    s_add_u32 s12, s12, s7
    s_lshl_b32 s45, s12, 8
    s_add_u32 m0, s44, s9
    v_lshlrev_b32 v54, 2, v52
    s_mul_i32 s5, s3, 7616
    s_add_u32 s5, s5, 36736
    s_mov_b32 s42, 25600000
    s_mov_b32 s43, 0x00020000
    s_mov_b32 s54, 32768
    s_mov_b32 s55, 0x00020000
    s_mov_b32 s38, 2048
    s_mov_b32 s39, 0x00020000
    s_mov_b32 s35, 0xff800000
    v_xor_b32 v69, v50, v51
    v_lshlrev_b32 v57, 4, v69
    v_and_b32 v63, 0x70, v57
    s_movk_i32 s47, 128
    s_lshl_b32 s8, s4, 1
    v_mov_b32 v11, 0x7ffffff0
    v_writelane_b32 v11, s8, 0
    v_lshlrev_b32 v55, 4, v51
    v_lshrrev_b32 v60, 2, v50
    v_and_b32 v61, 3, v50
    s_movk_i32 s12, 1056
    v_and_b32 v69, 2, v60
    v_lshl_add_u32 v69, v69, 1, v61
    v_mad_u32_u24 v69, v69, s12, v55
    v_and_b32 v70, 1, v60
    v_lshl_add_u32 v70, v70, 8, s9
    v_add_u32 v58, v69, v70
    v_and_b32 v69, 1, v51
    v_lshl_add_u32 v69, v69, 2, v60
    v_and_b32 v70, 2, v51
    v_lshlrev_b32 v70, 8, v70
    s_waitcnt lgkmcnt(0)
    global_load_dwordx2 v[208:209], v53, s[16:17] nt
    s_mov_b32 s52, s24
    s_mov_b32 s53, s25
    global_load_dwordx3 v[212:214], v62, s[16:17] offset:64 nt
    global_load_dword v220, v54, s[28:29]
    global_load_dword v223, v54, s[26:27]
    global_load_dword v221, v54, s[30:31]
    buffer_load_dwordx4 v56, s[52:55], s45 offen lds
    s_xor_b32 s46, s44, 1056
    s_add_u32 m0, s46, s9
    s_xor_b32 s46, s45, 256
    v_lshl_add_u32 v70, v61, 3, v70
    v_mad_u32_u24 v59, v69, s12, v70
    v_lshlrev_b32 v67, 3, v52
    v_and_b32 v71, 1, v52
    v_lshlrev_b32 v69, 2, v71
    v_bfe_u32 v70, v52, 1, 2
    v_and_or_b32 v70, v52, 56, v70
    v_add_lshl_u32 v65, v69, v70, 2
    buffer_load_dwordx4 v56, s[52:55], s46 offen lds
    s_xor_b32 s46, s44, 2112
    s_add_u32 m0, s46, s9
    s_xor_b32 s46, s45, 512
    v_bfe_u32 v70, v52, 3, 1
    v_and_or_b32 v70, v52, 50, v70
    v_or_b32 v69, v69, v70
    v_and_b32 v70, 4, v52
    v_lshl_or_b32 v69, v70, 1, v69
    v_lshlrev_b32 v64, 2, v69
    v_and_b32 v69, 2, v50
    s_lshl_b32 s8, s3, 6
    buffer_load_dwordx4 v56, s[52:55], s46 offen lds
    s_xor_b32 s46, s44, 3168
    s_add_u32 m0, s46, s9
    s_xor_b32 s46, s45, 768
    v_lshl_add_u32 v70, v69, 3, s8
    v_lshl_add_u32 v70, v60, 2, v70
    v_lshl_add_u32 v66, v71, 1, v70
    v_lshlrev_b32 v70, 4, v71
    v_lshl_or_b32 v70, v51, 5, v70
    s_movk_i32 s13, 192
    v_mad_u32_u24 v70, v69, s13, v70
    v_and_b32 v69, 2, v51
    buffer_load_dwordx4 v56, s[52:55], s46 offen lds
    s_xor_b32 s46, s44, 4224
    s_add_u32 m0, s46, s9
    s_xor_b32 s46, s45, 2048
    v_lshlrev_b32 v69, 5, v69
    v_sub_u32 v12, 1344, v69
    v_mov_b32_dpp v12, v70 quad_perm:[0,1,2,3] row_mask:0xf bank_mask:0x1
    s_mov_b32 s13, 0xaaaa
    v_mov_b32 v1, 0x4444
    v_mad_u32_u24 v1, v71, s13, v1
    v_mov_b32_dpp v13, v12 row_ror:4 row_mask:0xf bank_mask:0xf
    v_mov_b32_dpp v14, v12 row_ror:8 row_mask:0xf bank_mask:0xf
    buffer_load_dwordx4 v56, s[52:55], s46 offen lds
    s_xor_b32 s46, s44, 5280
    s_add_u32 m0, s46, s9
    s_xor_b32 s46, s45, 2304
    v_mov_b32_dpp v15, v12 row_ror:12 row_mask:0xf bank_mask:0xf
    v_mov_b64 v[232:233], 0
    v_mov_b64 v[234:235], 0
    v_mul_u32_u24 v69, 896, v51
    v_min_u32 v69, 1536, v69
    v_lshl_add_u32 v68, v50, 4, v69
    ds_write_b128 v68, v[232:235] offset:34176
    v_lshl_add_u32 v69, v50, 7, s5
    buffer_load_dwordx4 v56, s[52:55], s46 offen lds
    s_xor_b32 s46, s44, 6336
    s_add_u32 m0, s46, s9
    s_xor_b32 s46, s45, 2560
    v_and_b32 v70, 8, v50
    v_lshl_add_u32 v69, v70, 3, v69
    v_lshlrev_b32 v70, 3, v50
    v_xor_b32 v70, v70, v55
    v_and_or_b32 v216, v70, 48, v69
    v_lshlrev_b32 v71, 2, v50
    s_add_u32 s8, s5, 4352
    s_mov_b32 s12, 0x4a2b9198
    buffer_load_dwordx4 v56, s[52:55], s46 offen lds
    s_xor_b32 s46, s44, 7392
    s_add_u32 m0, s46, s9
    s_xor_b32 s46, s45, 2816
    s_mov_b32 s13, 0x608ab956
    v_lshrrev_b64 v[48:49], v71, s[12:13]
    v_and_b32 v69, 15, v48
    v_lshl_add_u32 v70, v69, 8, s8
    v_bfe_u32 v69, v48, 2, 2
    v_lshl_add_u32 v70, v69, 6, v70
    v_xor_b32 v69, v48, v51
    v_and_b32 v69, 3, v69
    buffer_load_dwordx4 v56, s[52:55], s46 offen lds
    s_mov_b32 s40, s18
    s_mov_b32 s41, s19
    v_lshl_add_u32 v2, v69, 4, v70
    s_mov_b32 s12, 0x6480559
    s_mov_b32 s13, 0x41ab2821
    v_lshrrev_b64 v[48:49], v71, s[12:13]
    v_and_b32 v69, 15, v48
    v_lshl_add_u32 v70, v69, 8, s8
    v_bfe_u32 v69, v48, 2, 2
    v_lshl_add_u32 v70, v69, 6, v70
    v_xor_b32 v69, v48, v51
    v_and_b32 v69, 3, v69
    v_lshl_add_u32 v6, v69, 4, v70
    v_mov_b64 v[236:237], 0
    v_mov_b64 v[238:239], 0
    v_mov_b64 v[240:241], 0
    v_mov_b64 v[242:243], 0
    v_mov_b64 v[244:245], 0
    v_mov_b64 v[246:247], 0
    v_mov_b64 v[248:249], 0
    v_mov_b64 v[250:251], 0
    v_writelane_b32 v248, s35, 29
    v_writelane_b32 v248, s35, 48
    v_writelane_b32 v248, s35, 58
    v_mov_b64 v[252:253], 0
    v_mov_b64 v[254:255], 0
    v_mov_b32 v10, 0x3f38aa3b
    s_mov_b32 m0, s5
    s_waitcnt vmcnt(12)
    v_lshl_add_u32 v208, v208, 8, v63
    buffer_load_dwordx4 v208, s[40:43], 0 offen nt lds
    s_add_u32 m0, s5, 1088
    v_lshl_add_u32 v209, v209, 8, v63
    buffer_load_dwordx4 v209, s[40:43], 0 offen nt lds
    s_cmp_eq_u32 s3, 0
    s_cbranch_scc1 L_stub0
    s_cmp_eq_u32 s3, 1
    s_cbranch_scc1 L_stub1
    s_cmp_eq_u32 s3, 2
    s_cbranch_scc1 L_stub2
    s_cmp_eq_u32 s3, 3
    s_cbranch_scc1 L_stub3
L_back:
    s_branch L_main2
.p2align 12
L_main:
    s_cbranch_scc1 L_back
L_main2:
    s_waitcnt vmcnt(10)
    ds_write_b32 v54, v220 offset:36480
    v_lshlrev_b32 v222, 16, v223
    v_and_b32 v223, 0xffff0000, v223
    ds_write_b64 v67, v[222:223] offset:35968
    ds_write_b32 v64, v220 offset:33792
    ds_write_b32 v65, v221 offset:34816
    ds_read_b128 v[144:147], v55 offset:36480
    ds_read_b128 v[148:151], v55 offset:36544
    ds_read_b128 v[152:155], v55 offset:36608
    ds_read_b128 v[156:159], v55 offset:36672
    ds_read_b128 v[112:115], v55 offset:35968
    ds_read_b128 v[116:119], v55 offset:36032
    ds_read_b128 v[120:123], v55 offset:36096
    ds_read_b128 v[124:127], v55 offset:36160
    ds_read_b128 v[128:131], v55 offset:36224
    ds_read_b128 v[132:135], v55 offset:36288
    ds_read_b128 v[136:139], v55 offset:36352
    ds_read_b128 v[140:143], v55 offset:36416
    ds_read_b128 a[128:131], v12 offset:33792
    ds_read_b128 a[132:135], v12 offset:33920
    s_add_u32 m0, s5, 2176
    s_nop 0
    buffer_load_dwordx4 v208, s[40:43], s47 offen nt lds
    s_add_u32 m0, s5, 3264
    s_nop 0
    buffer_load_dwordx4 v209, s[40:43], s47 offen nt lds
    s_waitcnt vmcnt(4)
    ds_read_b128 v[80:83], v58 offset:0
    ds_read_b128 v[84:87], v58 offset:64
    ds_read_b128 v[88:91], v58 offset:128
    ds_read_b128 v[92:95], v58 offset:192
    ds_read_b128 v[96:99], v58 offset:512
    ds_read_b128 v[100:103], v58 offset:576
    ds_read_b128 v[104:107], v58 offset:640
    ds_read_b128 v[108:111], v58 offset:704
    s_barrier
    ds_read_b64_tr_b16 a[0:1], v59 offset:0
    ds_read_b64_tr_b16 a[2:3], v59 offset:256
    ds_read_b64_tr_b16 a[16:17], v59 offset:32
    ds_read_b64_tr_b16 a[18:19], v59 offset:288
    ds_read_b64_tr_b16 a[32:33], v59 offset:64
    ds_read_b64_tr_b16 a[34:35], v59 offset:320
    ds_read_b64_tr_b16 a[48:49], v59 offset:96
    ds_read_b64_tr_b16 a[50:51], v59 offset:352
    s_waitcnt lgkmcnt(8)
    v_mfma_f32_16x16x32_bf16 v[176:179], v[144:147], v[80:83], 0
    ds_read_b64_tr_b16 a[64:65], v59 offset:128
    ds_read_b64_tr_b16 a[66:67], v59 offset:384
    v_mfma_f32_16x16x32_bf16 v[176:179], v[148:151], v[84:87], v[176:179]
    ds_read_b64_tr_b16 a[80:81], v59 offset:160
    ds_read_b64_tr_b16 a[82:83], v59 offset:416
    v_mfma_f32_16x16x32_bf16 v[176:179], v[152:155], v[88:91], v[176:179]
    ds_read_b64_tr_b16 a[96:97], v59 offset:192
    ds_read_b64_tr_b16 a[98:99], v59 offset:448
    v_mfma_f32_16x16x32_bf16 v[176:179], v[156:159], v[92:95], v[176:179]
    ds_read_b64_tr_b16 a[112:113], v59 offset:224
    ds_read_b64_tr_b16 a[114:115], v59 offset:480
    v_mfma_f32_16x16x32_bf16 v[180:183], v[144:147], v[96:99], 0
    ds_read_b64_tr_b16 a[4:5], v59 offset:8448
    ds_read_b64_tr_b16 a[6:7], v59 offset:8704
    v_mfma_f32_16x16x32_bf16 v[180:183], v[148:151], v[100:103], v[180:183]
    ds_read_b64_tr_b16 a[20:21], v59 offset:8480
    ds_read_b64_tr_b16 a[22:23], v59 offset:8736
    v_mfma_f32_16x16x32_bf16 v[180:183], v[152:155], v[104:107], v[180:183]
    ds_read_b64_tr_b16 a[36:37], v59 offset:8512
    ds_read_b64_tr_b16 a[38:39], v59 offset:8768
    v_mfma_f32_16x16x32_bf16 v[180:183], v[156:159], v[108:111], v[180:183]
    ds_read_b64_tr_b16 a[52:53], v59 offset:8544
    ds_read_b64_tr_b16 a[54:55], v59 offset:8800
    ds_read_b64_tr_b16 a[68:69], v59 offset:8576
    ds_read_b64_tr_b16 a[70:71], v59 offset:8832
    ds_read_b64_tr_b16 a[84:85], v59 offset:8608
    ds_read_b64_tr_b16 a[86:87], v59 offset:8864
    ds_read_b64_tr_b16 a[100:101], v59 offset:8640
    ds_read_b64_tr_b16 a[102:103], v59 offset:8896
    ds_read_b64_tr_b16 a[116:117], v59 offset:8672
    v_cvt_pk_bf16_f32 v71, v176, v180
    ds_write_b16 v66, v71 offset:34432
    ds_write_b16_d16_hi v66, v71 offset:34464
    ds_read_b64_tr_b16 a[118:119], v59 offset:8928
    ds_read_b64_tr_b16 a[8:9], v59 offset:16896
    ds_read_b64_tr_b16 a[10:11], v59 offset:17152
    ds_read_b64_tr_b16 a[24:25], v59 offset:16928
    ds_read_b64_tr_b16 a[26:27], v59 offset:17184
    ds_read_b64_tr_b16 a[40:41], v59 offset:16960
    ds_read_b64_tr_b16 a[42:43], v59 offset:17216
    ds_read_b64_tr_b16 a[56:57], v59 offset:16992
    ds_read_b64_tr_b16 a[58:59], v59 offset:17248
    ds_read_b64_tr_b16 a[72:73], v59 offset:17024
    ds_read_b64_tr_b16 a[74:75], v59 offset:17280
    ds_read_b64_tr_b16 a[88:89], v59 offset:17056
    ds_read_b64_tr_b16 a[90:91], v59 offset:17312
    ds_read_b64_tr_b16 a[104:105], v59 offset:17088
    ds_read_b64_tr_b16 a[106:107], v59 offset:17344
    ds_read_b64_tr_b16 a[120:121], v59 offset:17120
    ds_read_b64_tr_b16 a[122:123], v59 offset:17376
    s_waitcnt lgkmcnt(15)
    s_barrier
    ds_read_b128 a[136:139], v12 offset:34432
    ds_read_b128 a[140:143], v12 offset:34560
    ds_read_b64_tr_b16 a[12:13], v59 offset:25344
    ds_read_b64_tr_b16 a[14:15], v59 offset:25600
    s_waitcnt vmcnt(2)
    ds_read_b128 v[32:35], v216 offset:0
    ds_read_b128 v[36:39], v216 offset:64
    ds_read_b64_tr_b16 a[28:29], v59 offset:25376
    ds_read_b64_tr_b16 a[30:31], v59 offset:25632
    ds_read_b64_tr_b16 a[44:45], v59 offset:25408
    ds_read_b64_tr_b16 a[46:47], v59 offset:25664
    ds_read_b64_tr_b16 a[60:61], v59 offset:25440
    ds_read_b64_tr_b16 a[62:63], v59 offset:25696
    ds_read_b64_tr_b16 a[76:77], v59 offset:25472
    ds_read_b64_tr_b16 a[78:79], v59 offset:25728
    ds_read_b64_tr_b16 a[92:93], v59 offset:25504
    ds_read_b64_tr_b16 a[94:95], v59 offset:25760
    ds_read_b64_tr_b16 a[108:109], v59 offset:25536
    ds_read_b64_tr_b16 a[110:111], v59 offset:25792
    ds_read_b64_tr_b16 a[124:125], v59 offset:25568
    ds_read_b64_tr_b16 a[126:127], v59 offset:25824
    s_mov_b32 exec_hi, 0x0000ffff
    s_add_u32 m0, s5, 4352
    v_lshl_add_u32 v212, v212, 8, v57
    buffer_load_dwordx4 v212, s[40:43], 0 offen nt lds
    s_add_u32 m0, s5, 5440
    v_lshl_add_u32 v213, v213, 8, v57
    buffer_load_dwordx4 v213, s[40:43], 0 offen nt lds
    s_mov_b32 exec_hi, -1
    s_add_u32 m0, s5, 6528
    v_lshl_add_u32 v214, v214, 8, v57
    buffer_load_dwordx4 v214, s[40:43], 0 offen nt lds
    s_cmp_eq_u32 s3, 4
    s_waitcnt lgkmcnt(15)
    v_lshlrev_b32 v16, 16, v32
    v_and_b32 v17, 0xffff0000, v32
    v_lshlrev_b32 v18, 16, v33
    v_and_b32 v19, 0xffff0000, v33
    v_lshlrev_b32 v20, 16, v34
    v_and_b32 v21, 0xffff0000, v34
    v_lshlrev_b32 v22, 16, v35
    v_and_b32 v23, 0xffff0000, v35
    v_mul_f32_dpp v224, v16, v16 row_ror:1 row_mask:0xf bank_mask:0xf
    v_mul_f32_dpp v225, v17, v17 row_ror:1 row_mask:0xf bank_mask:0xf
    v_mul_f32_dpp v226, v18, v18 row_ror:1 row_mask:0xf bank_mask:0xf
    v_mul_f32_dpp v227, v19, v19 row_ror:1 row_mask:0xf bank_mask:0xf
    v_mul_f32_dpp v228, v20, v20 row_ror:1 row_mask:0xf bank_mask:0xf
    v_mul_f32_dpp v229, v21, v21 row_ror:1 row_mask:0xf bank_mask:0xf
    v_mul_f32_dpp v230, v22, v22 row_ror:1 row_mask:0xf bank_mask:0xf
    v_mul_f32_dpp v231, v23, v23 row_ror:1 row_mask:0xf bank_mask:0xf
    v_cvt_pk_bf16_f32 v144, v224, v225
    v_cvt_pk_bf16_f32 v145, v226, v227
    v_cvt_pk_bf16_f32 v146, v228, v229
    v_cvt_pk_bf16_f32 v147, v230, v231
    s_waitcnt lgkmcnt(14)
    v_lshlrev_b32 v24, 16, v36
    v_mfma_f32_16x16x32_bf16 v[176:179], a[0:3], v[144:147], v[112:115]
    v_and_b32 v25, 0xffff0000, v36
    v_lshlrev_b32 v26, 16, v37
    v_mfma_f32_16x16x32_bf16 v[180:183], a[16:19], v[144:147], v[116:119]
    v_and_b32 v27, 0xffff0000, v37
    v_lshlrev_b32 v28, 16, v38
    v_mfma_f32_16x16x32_bf16 v[184:187], a[32:35], v[144:147], v[120:123]
    v_and_b32 v29, 0xffff0000, v38
    v_lshlrev_b32 v30, 16, v39
    v_mfma_f32_16x16x32_bf16 v[188:191], a[48:51], v[144:147], v[124:127]
    v_and_b32 v31, 0xffff0000, v39
    v_mul_f32_dpp v224, v24, v24 row_ror:1 row_mask:0xf bank_mask:0xf
    v_mfma_f32_16x16x32_bf16 v[192:195], a[64:67], v[144:147], v[128:131]
    v_mul_f32_dpp v225, v25, v25 row_ror:1 row_mask:0xf bank_mask:0xf
    v_mul_f32_dpp v226, v26, v26 row_ror:1 row_mask:0xf bank_mask:0xf
    v_mfma_f32_16x16x32_bf16 v[196:199], a[80:83], v[144:147], v[132:135]
    v_mul_f32_dpp v227, v27, v27 row_ror:1 row_mask:0xf bank_mask:0xf
    v_mul_f32_dpp v228, v28, v28 row_ror:1 row_mask:0xf bank_mask:0xf
    v_mfma_f32_16x16x32_bf16 v[200:203], a[96:99], v[144:147], v[136:139]
    v_mul_f32_dpp v229, v29, v29 row_ror:1 row_mask:0xf bank_mask:0xf
    v_mul_f32_dpp v230, v30, v30 row_ror:1 row_mask:0xf bank_mask:0xf
    v_mfma_f32_16x16x32_bf16 v[204:207], a[112:115], v[144:147], v[140:143]
    v_mul_f32_dpp v231, v31, v31 row_ror:1 row_mask:0xf bank_mask:0xf
    v_cvt_pk_bf16_f32 v148, v224, v225
    v_cvt_pk_bf16_f32 v149, v226, v227
    v_cvt_pk_bf16_f32 v150, v228, v229
    v_cvt_pk_bf16_f32 v151, v230, v231
    v_mul_f32_dpp v224, v16, v16 row_ror:2 row_mask:0xf bank_mask:0xf
    v_mul_f32_dpp v225, v17, v17 row_ror:2 row_mask:0xf bank_mask:0xf
    v_mfma_f32_16x16x32_bf16 v[204:207], a[116:119], v[148:151], v[204:207]
    v_mul_f32_dpp v226, v18, v18 row_ror:2 row_mask:0xf bank_mask:0xf
    v_mul_f32_dpp v227, v19, v19 row_ror:2 row_mask:0xf bank_mask:0xf
    v_smfmac_f32_16x16x64_bf16 v[232:235], a[136:139], v[144:151], v1
    v_mul_f32_dpp v228, v20, v20 row_ror:2 row_mask:0xf bank_mask:0xf
    v_mfma_f32_16x16x32_bf16 v[176:179], a[4:7], v[148:151], v[176:179]
    v_mul_f32_dpp v229, v21, v21 row_ror:2 row_mask:0xf bank_mask:0xf
    v_mul_f32_dpp v230, v22, v22 row_ror:2 row_mask:0xf bank_mask:0xf
    v_mfma_f32_16x16x32_bf16 v[180:183], a[20:23], v[148:151], v[180:183]
    s_waitcnt vmcnt(3)
    ds_read_b128 v[40:43], v216 offset:2176
    ds_read_b128 v[44:47], v216 offset:2240
    v_mfma_f32_16x16x32_bf16 v[184:187], a[36:39], v[148:151], v[184:187]
    v_mul_f32_dpp v231, v23, v23 row_ror:2 row_mask:0xf bank_mask:0xf
    v_cvt_pk_bf16_f32 v160, v224, v225
    v_mfma_f32_16x16x32_bf16 v[188:191], a[52:55], v[148:151], v[188:191]
    v_cvt_pk_bf16_f32 v161, v226, v227
    v_cvt_pk_bf16_f32 v162, v228, v229
    v_mfma_f32_16x16x32_bf16 v[192:195], a[68:71], v[148:151], v[192:195]
    v_cvt_pk_bf16_f32 v163, v230, v231
    v_mul_f32_dpp v224, v24, v24 row_ror:2 row_mask:0xf bank_mask:0xf
    v_mfma_f32_16x16x32_bf16 v[196:199], a[84:87], v[148:151], v[196:199]
    v_mul_f32_dpp v225, v25, v25 row_ror:2 row_mask:0xf bank_mask:0xf
    v_mul_f32_dpp v226, v26, v26 row_ror:2 row_mask:0xf bank_mask:0xf
    v_mfma_f32_16x16x32_bf16 v[200:203], a[100:103], v[148:151], v[200:203]
    v_mul_f32_dpp v227, v27, v27 row_ror:2 row_mask:0xf bank_mask:0xf
    v_mul_f32_dpp v228, v28, v28 row_ror:2 row_mask:0xf bank_mask:0xf
    v_mul_f32_dpp v229, v29, v29 row_ror:2 row_mask:0xf bank_mask:0xf
    v_mul_f32_dpp v230, v30, v30 row_ror:2 row_mask:0xf bank_mask:0xf
    v_mul_f32_dpp v231, v31, v31 row_ror:2 row_mask:0xf bank_mask:0xf
    v_cvt_pk_bf16_f32 v164, v224, v225
    v_cvt_pk_bf16_f32 v165, v226, v227
    s_waitcnt lgkmcnt(0)
    v_lshlrev_b32 v32, 16, v40
    v_and_b32 v33, 0xffff0000, v40
    v_lshlrev_b32 v34, 16, v41
    v_and_b32 v35, 0xffff0000, v41
    v_lshlrev_b32 v36, 16, v42
    v_and_b32 v37, 0xffff0000, v42
    v_lshlrev_b32 v38, 16, v43
    v_and_b32 v39, 0xffff0000, v43
    v_cvt_pk_bf16_f32 v166, v228, v229
    v_cvt_pk_bf16_f32 v167, v230, v231
    v_mul_f32_dpp v224, v32, v32 row_ror:1 row_mask:0xf bank_mask:0xf
    v_mul_f32_dpp v225, v33, v33 row_ror:1 row_mask:0xf bank_mask:0xf
    v_mul_f32_dpp v226, v34, v34 row_ror:1 row_mask:0xf bank_mask:0xf
    v_mul_f32_dpp v227, v35, v35 row_ror:1 row_mask:0xf bank_mask:0xf
    v_mul_f32_dpp v228, v36, v36 row_ror:1 row_mask:0xf bank_mask:0xf
    v_mul_f32_dpp v229, v37, v37 row_ror:1 row_mask:0xf bank_mask:0xf
    v_mul_f32_dpp v230, v38, v38 row_ror:1 row_mask:0xf bank_mask:0xf
    v_mul_f32_dpp v231, v39, v39 row_ror:1 row_mask:0xf bank_mask:0xf
    v_cvt_pk_bf16_f32 v152, v224, v225
    v_cvt_pk_bf16_f32 v153, v226, v227
    v_cvt_pk_bf16_f32 v154, v228, v229
    v_cvt_pk_bf16_f32 v155, v230, v231
    v_lshlrev_b32 v40, 16, v44
    v_and_b32 v41, 0xffff0000, v44
    v_mfma_f32_16x16x32_bf16 v[200:203], a[104:107], v[152:155], v[200:203]
    v_lshlrev_b32 v42, 16, v45
    v_and_b32 v43, 0xffff0000, v45
    v_mfma_f32_16x16x32_bf16 v[176:179], a[8:11], v[152:155], v[176:179]
    v_lshlrev_b32 v44, 16, v46
    v_and_b32 v45, 0xffff0000, v46
    v_mfma_f32_16x16x32_bf16 v[180:183], a[24:27], v[152:155], v[180:183]
    v_lshlrev_b32 v46, 16, v47
    v_and_b32 v47, 0xffff0000, v47
    v_mfma_f32_16x16x32_bf16 v[184:187], a[40:43], v[152:155], v[184:187]
    v_mul_f32_dpp v224, v40, v40 row_ror:1 row_mask:0xf bank_mask:0xf
    v_mul_f32_dpp v225, v41, v41 row_ror:1 row_mask:0xf bank_mask:0xf
    v_mfma_f32_16x16x32_bf16 v[188:191], a[56:59], v[152:155], v[188:191]
    ds_read_b128 a[152:155], v13 offset:34432
    v_mul_f32_dpp v226, v42, v42 row_ror:1 row_mask:0xf bank_mask:0xf
    v_mfma_f32_16x16x32_bf16 v[192:195], a[72:75], v[152:155], v[192:195]
    v_mul_f32_dpp v227, v43, v43 row_ror:1 row_mask:0xf bank_mask:0xf
    v_mul_f32_dpp v228, v44, v44 row_ror:1 row_mask:0xf bank_mask:0xf
    v_mfma_f32_16x16x32_bf16 v[196:199], a[88:91], v[152:155], v[196:199]
    v_mul_f32_dpp v229, v45, v45 row_ror:1 row_mask:0xf bank_mask:0xf
    v_mul_f32_dpp v230, v46, v46 row_ror:1 row_mask:0xf bank_mask:0xf
    v_mfma_f32_16x16x32_bf16 v[204:207], a[120:123], v[152:155], v[204:207]
    v_mul_f32_dpp v231, v47, v47 row_ror:1 row_mask:0xf bank_mask:0xf
    v_cvt_pk_bf16_f32 v156, v224, v225
    v_cvt_pk_bf16_f32 v157, v226, v227
    v_cvt_pk_bf16_f32 v158, v228, v229
    v_cvt_pk_bf16_f32 v159, v230, v231
    v_mul_f32_dpp v224, v32, v32 row_ror:2 row_mask:0xf bank_mask:0xf
    v_mul_f32_dpp v225, v33, v33 row_ror:2 row_mask:0xf bank_mask:0xf
    v_mfma_f32_16x16x32_bf16 v[204:207], a[124:127], v[156:159], v[204:207]
    v_mul_f32_dpp v226, v34, v34 row_ror:2 row_mask:0xf bank_mask:0xf
    v_mul_f32_dpp v227, v35, v35 row_ror:2 row_mask:0xf bank_mask:0xf
    v_smfmac_f32_16x16x64_bf16 v[232:235], a[140:143], v[152:159], v1
    v_mul_f32_dpp v228, v36, v36 row_ror:2 row_mask:0xf bank_mask:0xf
    v_mfma_f32_16x16x32_bf16 v[176:179], a[12:15], v[156:159], v[176:179]
    ds_read_b128 a[156:159], v13 offset:34560
    v_mul_f32_dpp v229, v37, v37 row_ror:2 row_mask:0xf bank_mask:0xf
    v_mfma_f32_16x16x32_bf16 v[180:183], a[28:31], v[156:159], v[180:183]
    v_mul_f32_dpp v230, v38, v38 row_ror:2 row_mask:0xf bank_mask:0xf
    v_mul_f32_dpp v231, v39, v39 row_ror:2 row_mask:0xf bank_mask:0xf
    v_mfma_f32_16x16x32_bf16 v[184:187], a[44:47], v[156:159], v[184:187]
    v_cvt_pk_bf16_f32 v168, v224, v225
    v_cvt_pk_bf16_f32 v169, v226, v227
    v_mfma_f32_16x16x32_bf16 v[188:191], a[60:63], v[156:159], v[188:191]
    v_cvt_pk_bf16_f32 v208, |v176|, |v177|
    v_cvt_pk_bf16_f32 v209, |v178|, |v179|
    v_mfma_f32_16x16x32_bf16 v[192:195], a[76:79], v[156:159], v[192:195]
    s_waitcnt lgkmcnt(0)
    v_cvt_pk_bf16_f32 v170, v228, v229
    v_cvt_pk_bf16_f32 v171, v230, v231
    v_mfma_f32_16x16x32_bf16 v[196:199], a[92:95], v[156:159], v[196:199]
    ds_read_b128 a[144:147], v13 offset:33792
    v_mul_f32_dpp v224, v40, v40 row_ror:2 row_mask:0xf bank_mask:0xf
    v_mfma_f32_16x16x32_bf16 v[200:203], a[108:111], v[156:159], v[200:203]
    v_mul_f32_dpp v225, v41, v41 row_ror:2 row_mask:0xf bank_mask:0xf
    v_mul_f32_dpp v226, v42, v42 row_ror:2 row_mask:0xf bank_mask:0xf
    v_mfma_f32_16x16x32_bf16 v[176:179], a[0:3], v[160:163], v[112:115]
    v_mul_f32_dpp v227, v43, v43 row_ror:2 row_mask:0xf bank_mask:0xf
    v_mul_f32_dpp v228, v44, v44 row_ror:2 row_mask:0xf bank_mask:0xf
    v_mfma_f32_16x16x32_bf16 v[176:179], a[4:7], v[164:167], v[176:179]
    v_mul_f32_dpp v229, v45, v45 row_ror:2 row_mask:0xf bank_mask:0xf
    v_mul_f32_dpp v230, v46, v46 row_ror:2 row_mask:0xf bank_mask:0xf
    v_mfma_f32_16x16x32_bf16 v[176:179], a[8:11], v[168:171], v[176:179]
    ds_read_b128 a[148:151], v13 offset:33920
    v_mul_f32_dpp v231, v47, v47 row_ror:2 row_mask:0xf bank_mask:0xf
    v_cvt_pk_bf16_f32 v172, v224, v225
    v_cvt_pk_bf16_f32 v173, v226, v227
    v_cvt_pk_bf16_f32 v174, v228, v229
    v_cvt_pk_bf16_f32 v175, v230, v231
    v_cvt_pk_bf16_f32 v210, |v180|, |v181|
    v_cvt_pk_bf16_f32 v211, |v182|, |v183|
    v_mfma_f32_16x16x32_bf16 v[176:179], a[12:15], v[172:175], v[176:179]
    v_cvt_pk_bf16_f32 v212, |v184|, |v185|
    v_cvt_pk_bf16_f32 v213, |v186|, |v187|
    v_mfma_f32_16x16x32_bf16 v[180:183], a[28:31], v[172:175], v[116:119]
    s_waitcnt lgkmcnt(0)
    v_cvt_pk_bf16_f32 v214, |v188|, |v189|
    v_cvt_pk_bf16_f32 v215, |v190|, |v191|
    v_mfma_f32_16x16x32_bf16 v[180:183], a[24:27], v[168:171], v[180:183]
    v_cvt_pk_bf16_f32 v216, |v192|, |v193|
    v_cvt_pk_bf16_f32 v217, |v194|, |v195|
    v_mfma_f32_16x16x32_bf16 v[180:183], a[20:23], v[164:167], v[180:183]
    v_cvt_pk_bf16_f32 v218, |v196|, |v197|
    v_cvt_pk_bf16_f32 v219, |v198|, |v199|
    v_mfma_f32_16x16x32_bf16 v[180:183], a[16:19], v[160:163], v[180:183]
    ds_read_b128 a[168:171], v14 offset:34432
    v_cvt_pk_bf16_f32 v220, |v200|, |v201|
    v_smfmac_f32_16x16x64_bf16 v[232:235], a[128:131], v[208:215], v1
    v_cvt_pk_bf16_f32 v221, |v202|, |v203|
    v_mfma_f32_16x16x32_bf16 v[184:187], a[32:35], v[160:163], v[120:123]
    v_cvt_pk_bf16_f32 v222, |v204|, |v205|
    v_cvt_pk_bf16_f32 v223, |v206|, |v207|
    v_mfma_f32_16x16x32_bf16 v[184:187], a[36:39], v[164:167], v[184:187]
    v_mul_f32_dpp v224, v16, v16 row_ror:3 row_mask:0xf bank_mask:0xf
    v_mul_f32_dpp v225, v17, v17 row_ror:3 row_mask:0xf bank_mask:0xf
    v_mfma_f32_16x16x32_bf16 v[184:187], a[40:43], v[168:171], v[184:187]
    v_mul_f32_dpp v226, v18, v18 row_ror:3 row_mask:0xf bank_mask:0xf
    v_mul_f32_dpp v227, v19, v19 row_ror:3 row_mask:0xf bank_mask:0xf
    v_mfma_f32_16x16x32_bf16 v[184:187], a[44:47], v[172:175], v[184:187]
    ds_read_b128 a[172:175], v14 offset:34560
    v_mul_f32_dpp v228, v20, v20 row_ror:3 row_mask:0xf bank_mask:0xf
    v_smfmac_f32_16x16x64_bf16 v[232:235], a[132:135], v[216:223], v1
    v_mul_f32_dpp v229, v21, v21 row_ror:3 row_mask:0xf bank_mask:0xf
    v_mfma_f32_16x16x32_bf16 v[188:191], a[60:63], v[172:175], v[124:127]
    v_mul_f32_dpp v230, v22, v22 row_ror:3 row_mask:0xf bank_mask:0xf
    v_mul_f32_dpp v231, v23, v23 row_ror:3 row_mask:0xf bank_mask:0xf
    v_mfma_f32_16x16x32_bf16 v[188:191], a[56:59], v[168:171], v[188:191]
    v_cvt_pk_bf16_f32 v144, v224, v225
    v_cvt_pk_bf16_f32 v145, v226, v227
    v_mfma_f32_16x16x32_bf16 v[188:191], a[52:55], v[164:167], v[188:191]
    s_waitcnt lgkmcnt(0)
    v_cvt_pk_bf16_f32 v146, v228, v229
    v_cvt_pk_bf16_f32 v147, v230, v231
    v_mfma_f32_16x16x32_bf16 v[188:191], a[48:51], v[160:163], v[188:191]
    ds_read_b128 a[160:163], v14 offset:33792
    v_mul_f32_dpp v224, v24, v24 row_ror:3 row_mask:0xf bank_mask:0xf
    v_smfmac_f32_16x16x64_bf16 v[232:235], a[152:155], v[160:167], v1
    v_mul_f32_dpp v225, v25, v25 row_ror:3 row_mask:0xf bank_mask:0xf
    v_mfma_f32_16x16x32_bf16 v[192:195], a[64:67], v[160:163], v[128:131]
    v_mul_f32_dpp v226, v26, v26 row_ror:3 row_mask:0xf bank_mask:0xf
    v_mul_f32_dpp v227, v27, v27 row_ror:3 row_mask:0xf bank_mask:0xf
    v_mfma_f32_16x16x32_bf16 v[192:195], a[68:71], v[164:167], v[192:195]
    v_mul_f32_dpp v228, v28, v28 row_ror:3 row_mask:0xf bank_mask:0xf
    v_mul_f32_dpp v229, v29, v29 row_ror:3 row_mask:0xf bank_mask:0xf
    v_mfma_f32_16x16x32_bf16 v[192:195], a[72:75], v[168:171], v[192:195]
    v_mul_f32_dpp v230, v30, v30 row_ror:3 row_mask:0xf bank_mask:0xf
    v_mul_f32_dpp v231, v31, v31 row_ror:3 row_mask:0xf bank_mask:0xf
    v_mfma_f32_16x16x32_bf16 v[192:195], a[76:79], v[172:175], v[192:195]
    ds_read_b128 a[164:167], v14 offset:33920
    v_cvt_pk_bf16_f32 v208, |v176|, |v177|
    v_smfmac_f32_16x16x64_bf16 v[232:235], a[156:159], v[168:175], v1
    v_cvt_pk_bf16_f32 v209, |v178|, |v179|
    v_mfma_f32_16x16x32_bf16 v[196:199], a[92:95], v[172:175], v[132:135]
    v_cvt_pk_bf16_f32 v148, v224, v225
    v_cvt_pk_bf16_f32 v149, v226, v227
    v_mfma_f32_16x16x32_bf16 v[196:199], a[88:91], v[168:171], v[196:199]
    v_cvt_pk_bf16_f32 v150, v228, v229
    v_cvt_pk_bf16_f32 v151, v230, v231
    v_mfma_f32_16x16x32_bf16 v[196:199], a[84:87], v[164:167], v[196:199]
    s_waitcnt lgkmcnt(0)
    v_mul_f32_dpp v224, v32, v32 row_ror:3 row_mask:0xf bank_mask:0xf
    v_mul_f32_dpp v225, v33, v33 row_ror:3 row_mask:0xf bank_mask:0xf
    v_mfma_f32_16x16x32_bf16 v[196:199], a[80:83], v[160:163], v[196:199]
    ds_read_b128 a[184:187], v15 offset:34432
    v_mul_f32_dpp v226, v34, v34 row_ror:3 row_mask:0xf bank_mask:0xf
    v_mfma_f32_16x16x32_bf16 v[200:203], a[96:99], v[160:163], v[136:139]
    v_mul_f32_dpp v227, v35, v35 row_ror:3 row_mask:0xf bank_mask:0xf
    v_mul_f32_dpp v228, v36, v36 row_ror:3 row_mask:0xf bank_mask:0xf
    v_mfma_f32_16x16x32_bf16 v[200:203], a[100:103], v[164:167], v[200:203]
    v_mul_f32_dpp v229, v37, v37 row_ror:3 row_mask:0xf bank_mask:0xf
    v_mul_f32_dpp v230, v38, v38 row_ror:3 row_mask:0xf bank_mask:0xf
    v_mfma_f32_16x16x32_bf16 v[200:203], a[104:107], v[168:171], v[200:203]
    v_mul_f32_dpp v231, v39, v39 row_ror:3 row_mask:0xf bank_mask:0xf
    v_cvt_pk_bf16_f32 v152, v224, v225
    v_mfma_f32_16x16x32_bf16 v[200:203], a[108:111], v[172:175], v[200:203]
    v_cvt_pk_bf16_f32 v153, v226, v227
    v_cvt_pk_bf16_f32 v154, v228, v229
    v_mfma_f32_16x16x32_bf16 v[204:207], a[124:127], v[172:175], v[140:143]
    ds_read_b128 a[188:191], v15 offset:34560
    v_cvt_pk_bf16_f32 v155, v230, v231
    v_mfma_f32_16x16x32_bf16 v[204:207], a[120:123], v[168:171], v[204:207]
    v_mul_f32_dpp v224, v40, v40 row_ror:3 row_mask:0xf bank_mask:0xf
    v_mul_f32_dpp v225, v41, v41 row_ror:3 row_mask:0xf bank_mask:0xf
    v_mfma_f32_16x16x32_bf16 v[204:207], a[116:119], v[164:167], v[204:207]
    v_mul_f32_dpp v226, v42, v42 row_ror:3 row_mask:0xf bank_mask:0xf
    v_mul_f32_dpp v227, v43, v43 row_ror:3 row_mask:0xf bank_mask:0xf
    v_mfma_f32_16x16x32_bf16 v[204:207], a[112:115], v[160:163], v[204:207]
    v_mul_f32_dpp v228, v44, v44 row_ror:3 row_mask:0xf bank_mask:0xf
    v_mul_f32_dpp v229, v45, v45 row_ror:3 row_mask:0xf bank_mask:0xf
    v_mfma_f32_16x16x32_bf16 v[176:179], a[0:3], v[144:147], v[112:115]
    s_waitcnt lgkmcnt(0)
    v_mul_f32_dpp v230, v46, v46 row_ror:3 row_mask:0xf bank_mask:0xf
    v_mul_f32_dpp v231, v47, v47 row_ror:3 row_mask:0xf bank_mask:0xf
    v_mfma_f32_16x16x32_bf16 v[176:179], a[4:7], v[148:151], v[176:179]
    ds_read_b128 a[176:179], v15 offset:33792
    v_cvt_pk_bf16_f32 v156, v224, v225
    v_mfma_f32_16x16x32_bf16 v[176:179], a[8:11], v[152:155], v[176:179]
    v_cvt_pk_bf16_f32 v157, v226, v227
    v_cvt_pk_bf16_f32 v158, v228, v229
    v_cvt_pk_bf16_f32 v159, v230, v231
    v_cvt_pk_bf16_f32 v210, |v180|, |v181|
    v_cvt_pk_bf16_f32 v211, |v182|, |v183|
    v_mfma_f32_16x16x32_bf16 v[176:179], a[12:15], v[156:159], v[176:179]
    v_cvt_pk_bf16_f32 v212, |v184|, |v185|
    v_cvt_pk_bf16_f32 v213, |v186|, |v187|
    v_mfma_f32_16x16x32_bf16 v[180:183], a[28:31], v[156:159], v[116:119]
    v_cvt_pk_bf16_f32 v214, |v188|, |v189|
    v_cvt_pk_bf16_f32 v215, |v190|, |v191|
    v_mfma_f32_16x16x32_bf16 v[180:183], a[24:27], v[152:155], v[180:183]
    v_cvt_pk_bf16_f32 v216, |v192|, |v193|
    v_cvt_pk_bf16_f32 v217, |v194|, |v195|
    v_mfma_f32_16x16x32_bf16 v[180:183], a[20:23], v[148:151], v[180:183]
    ds_read_b128 a[180:183], v15 offset:33920
    v_cvt_pk_bf16_f32 v218, |v196|, |v197|
    v_mfma_f32_16x16x32_bf16 v[180:183], a[16:19], v[144:147], v[180:183]
    v_cvt_pk_bf16_f32 v219, |v198|, |v199|
    v_cvt_pk_bf16_f32 v220, |v200|, |v201|
    v_smfmac_f32_16x16x64_bf16 v[232:235], a[144:147], v[208:215], v1
    v_cvt_pk_bf16_f32 v221, |v202|, |v203|
    v_mfma_f32_16x16x32_bf16 v[184:187], a[32:35], v[144:147], v[120:123]
    v_cvt_pk_bf16_f32 v222, |v204|, |v205|
    v_cvt_pk_bf16_f32 v223, |v206|, |v207|
    v_mfma_f32_16x16x32_bf16 v[184:187], a[36:39], v[148:151], v[184:187]
    s_waitcnt lgkmcnt(0)
    v_mul_f32_dpp v224, v16, v16 row_ror:4 row_mask:0xf bank_mask:0xf
    v_mul_f32_dpp v225, v17, v17 row_ror:4 row_mask:0xf bank_mask:0xf
    v_mfma_f32_16x16x32_bf16 v[184:187], a[40:43], v[152:155], v[184:187]
    v_mul_f32_dpp v226, v18, v18 row_ror:4 row_mask:0xf bank_mask:0xf
    v_mul_f32_dpp v227, v19, v19 row_ror:4 row_mask:0xf bank_mask:0xf
    v_mfma_f32_16x16x32_bf16 v[184:187], a[44:47], v[156:159], v[184:187]
    v_mul_f32_dpp v228, v20, v20 row_ror:4 row_mask:0xf bank_mask:0xf
    v_mul_f32_dpp v229, v21, v21 row_ror:4 row_mask:0xf bank_mask:0xf
    v_smfmac_f32_16x16x64_bf16 v[232:235], a[148:151], v[216:223], v1
    v_mul_f32_dpp v230, v22, v22 row_ror:4 row_mask:0xf bank_mask:0xf
    v_mfma_f32_16x16x32_bf16 v[188:191], a[60:63], v[156:159], v[124:127]
    v_mul_f32_dpp v231, v23, v23 row_ror:4 row_mask:0xf bank_mask:0xf
    v_cvt_pk_bf16_f32 v160, v224, v225
    v_mfma_f32_16x16x32_bf16 v[188:191], a[56:59], v[152:155], v[188:191]
    v_cvt_pk_bf16_f32 v161, v226, v227
    v_cvt_pk_bf16_f32 v162, v228, v229
    v_mfma_f32_16x16x32_bf16 v[188:191], a[52:55], v[148:151], v[188:191]
    v_cvt_pk_bf16_f32 v163, v230, v231
    v_mul_f32_dpp v224, v24, v24 row_ror:4 row_mask:0xf bank_mask:0xf
    v_mfma_f32_16x16x32_bf16 v[188:191], a[48:51], v[144:147], v[188:191]
    v_mul_f32_dpp v225, v25, v25 row_ror:4 row_mask:0xf bank_mask:0xf
    v_mul_f32_dpp v226, v26, v26 row_ror:4 row_mask:0xf bank_mask:0xf
    v_smfmac_f32_16x16x64_bf16 v[232:235], a[168:171], v[144:151], v1
    v_mul_f32_dpp v227, v27, v27 row_ror:4 row_mask:0xf bank_mask:0xf
    v_mfma_f32_16x16x32_bf16 v[192:195], a[64:67], v[144:147], v[128:131]
    v_mul_f32_dpp v228, v28, v28 row_ror:4 row_mask:0xf bank_mask:0xf
    v_mul_f32_dpp v229, v29, v29 row_ror:4 row_mask:0xf bank_mask:0xf
    v_mfma_f32_16x16x32_bf16 v[192:195], a[68:71], v[148:151], v[192:195]
    v_mul_f32_dpp v230, v30, v30 row_ror:4 row_mask:0xf bank_mask:0xf
    v_mul_f32_dpp v231, v31, v31 row_ror:4 row_mask:0xf bank_mask:0xf
    v_mfma_f32_16x16x32_bf16 v[192:195], a[72:75], v[152:155], v[192:195]
    v_cvt_pk_bf16_f32 v208, |v176|, |v177|
    v_cvt_pk_bf16_f32 v209, |v178|, |v179|
    v_mfma_f32_16x16x32_bf16 v[192:195], a[76:79], v[156:159], v[192:195]
    v_cvt_pk_bf16_f32 v164, v224, v225
    v_cvt_pk_bf16_f32 v165, v226, v227
    v_smfmac_f32_16x16x64_bf16 v[232:235], a[172:175], v[152:159], v1
    v_cvt_pk_bf16_f32 v166, v228, v229
    v_mfma_f32_16x16x32_bf16 v[196:199], a[92:95], v[156:159], v[132:135]
    v_cvt_pk_bf16_f32 v167, v230, v231
    v_mul_f32_dpp v224, v32, v32 row_ror:4 row_mask:0xf bank_mask:0xf
    v_mfma_f32_16x16x32_bf16 v[196:199], a[88:91], v[152:155], v[196:199]
    v_mul_f32_dpp v225, v33, v33 row_ror:4 row_mask:0xf bank_mask:0xf
    v_mul_f32_dpp v226, v34, v34 row_ror:4 row_mask:0xf bank_mask:0xf
    v_mfma_f32_16x16x32_bf16 v[196:199], a[84:87], v[148:151], v[196:199]
    v_mul_f32_dpp v227, v35, v35 row_ror:4 row_mask:0xf bank_mask:0xf
    v_mul_f32_dpp v228, v36, v36 row_ror:4 row_mask:0xf bank_mask:0xf
    v_mfma_f32_16x16x32_bf16 v[196:199], a[80:83], v[144:147], v[196:199]
    v_mul_f32_dpp v229, v37, v37 row_ror:4 row_mask:0xf bank_mask:0xf
    v_mul_f32_dpp v230, v38, v38 row_ror:4 row_mask:0xf bank_mask:0xf
    v_mfma_f32_16x16x32_bf16 v[200:203], a[96:99], v[144:147], v[136:139]
    v_mul_f32_dpp v231, v39, v39 row_ror:4 row_mask:0xf bank_mask:0xf
    v_cvt_pk_bf16_f32 v168, v224, v225
    v_mfma_f32_16x16x32_bf16 v[200:203], a[100:103], v[148:151], v[200:203]
    v_cvt_pk_bf16_f32 v169, v226, v227
    v_cvt_pk_bf16_f32 v170, v228, v229
    v_mfma_f32_16x16x32_bf16 v[200:203], a[104:107], v[152:155], v[200:203]
    v_cvt_pk_bf16_f32 v171, v230, v231
    v_mul_f32_dpp v224, v40, v40 row_ror:4 row_mask:0xf bank_mask:0xf
    v_mfma_f32_16x16x32_bf16 v[200:203], a[108:111], v[156:159], v[200:203]
    v_mul_f32_dpp v225, v41, v41 row_ror:4 row_mask:0xf bank_mask:0xf
    v_mul_f32_dpp v226, v42, v42 row_ror:4 row_mask:0xf bank_mask:0xf
    v_mfma_f32_16x16x32_bf16 v[204:207], a[124:127], v[156:159], v[140:143]
    v_mul_f32_dpp v227, v43, v43 row_ror:4 row_mask:0xf bank_mask:0xf
    v_mul_f32_dpp v228, v44, v44 row_ror:4 row_mask:0xf bank_mask:0xf
    v_mfma_f32_16x16x32_bf16 v[204:207], a[120:123], v[152:155], v[204:207]
    v_mul_f32_dpp v229, v45, v45 row_ror:4 row_mask:0xf bank_mask:0xf
    v_mul_f32_dpp v230, v46, v46 row_ror:4 row_mask:0xf bank_mask:0xf
    v_mfma_f32_16x16x32_bf16 v[204:207], a[116:119], v[148:151], v[204:207]
    v_mul_f32_dpp v231, v47, v47 row_ror:4 row_mask:0xf bank_mask:0xf
    v_cvt_pk_bf16_f32 v172, v224, v225
    v_mfma_f32_16x16x32_bf16 v[204:207], a[112:115], v[144:147], v[204:207]
    v_cvt_pk_bf16_f32 v173, v226, v227
    v_cvt_pk_bf16_f32 v174, v228, v229
    v_mfma_f32_16x16x32_bf16 v[176:179], a[0:3], v[160:163], v[112:115]
    v_cvt_pk_bf16_f32 v175, v230, v231
    v_cvt_pk_bf16_f32 v210, |v180|, |v181|
    v_mfma_f32_16x16x32_bf16 v[176:179], a[4:7], v[164:167], v[176:179]
    v_cvt_pk_bf16_f32 v211, |v182|, |v183|
    v_cvt_pk_bf16_f32 v212, |v184|, |v185|
    v_mfma_f32_16x16x32_bf16 v[176:179], a[8:11], v[168:171], v[176:179]
    v_cvt_pk_bf16_f32 v213, |v186|, |v187|
    v_cvt_pk_bf16_f32 v214, |v188|, |v189|
    v_mfma_f32_16x16x32_bf16 v[176:179], a[12:15], v[172:175], v[176:179]
    v_cvt_pk_bf16_f32 v215, |v190|, |v191|
    v_cvt_pk_bf16_f32 v216, |v192|, |v193|
    v_mfma_f32_16x16x32_bf16 v[180:183], a[28:31], v[172:175], v[116:119]
L_stub0:
    s_cbranch_scc1 L_main2
    v_cvt_pk_bf16_f32 v217, |v194|, |v195|
    v_cvt_pk_bf16_f32 v218, |v196|, |v197|
    v_mfma_f32_16x16x32_bf16 v[180:183], a[24:27], v[168:171], v[180:183]
    v_cvt_pk_bf16_f32 v219, |v198|, |v199|
    v_cvt_pk_bf16_f32 v220, |v200|, |v201|
    v_mfma_f32_16x16x32_bf16 v[180:183], a[20:23], v[164:167], v[180:183]
    v_cvt_pk_bf16_f32 v221, |v202|, |v203|
    v_cvt_pk_bf16_f32 v222, |v204|, |v205|
    v_mfma_f32_16x16x32_bf16 v[180:183], a[16:19], v[160:163], v[180:183]
    v_cvt_pk_bf16_f32 v223, |v206|, |v207|
    v_mul_f32_dpp v224, v16, v16 row_ror:5 row_mask:0xf bank_mask:0xf
    v_smfmac_f32_16x16x64_bf16 v[232:235], a[160:163], v[208:215], v1
    v_mul_f32_dpp v225, v17, v17 row_ror:5 row_mask:0xf bank_mask:0xf
    v_mfma_f32_16x16x32_bf16 v[184:187], a[32:35], v[160:163], v[120:123]
    v_mul_f32_dpp v226, v18, v18 row_ror:5 row_mask:0xf bank_mask:0xf
    v_mul_f32_dpp v227, v19, v19 row_ror:5 row_mask:0xf bank_mask:0xf
    v_mfma_f32_16x16x32_bf16 v[184:187], a[36:39], v[164:167], v[184:187]
    v_mul_f32_dpp v228, v20, v20 row_ror:5 row_mask:0xf bank_mask:0xf
    v_mul_f32_dpp v229, v21, v21 row_ror:5 row_mask:0xf bank_mask:0xf
    v_mfma_f32_16x16x32_bf16 v[184:187], a[40:43], v[168:171], v[184:187]
    v_mul_f32_dpp v230, v22, v22 row_ror:5 row_mask:0xf bank_mask:0xf
    v_mul_f32_dpp v231, v23, v23 row_ror:5 row_mask:0xf bank_mask:0xf
    v_mfma_f32_16x16x32_bf16 v[184:187], a[44:47], v[172:175], v[184:187]
    v_cvt_pk_bf16_f32 v144, v224, v225
    v_cvt_pk_bf16_f32 v145, v226, v227
    v_smfmac_f32_16x16x64_bf16 v[232:235], a[164:167], v[216:223], v1
    v_cvt_pk_bf16_f32 v146, v228, v229
    v_mfma_f32_16x16x32_bf16 v[188:191], a[60:63], v[172:175], v[124:127]
    v_cvt_pk_bf16_f32 v147, v230, v231
    v_mul_f32_dpp v224, v24, v24 row_ror:5 row_mask:0xf bank_mask:0xf
    v_mfma_f32_16x16x32_bf16 v[188:191], a[56:59], v[168:171], v[188:191]
    v_mul_f32_dpp v225, v25, v25 row_ror:5 row_mask:0xf bank_mask:0xf
    v_mul_f32_dpp v226, v26, v26 row_ror:5 row_mask:0xf bank_mask:0xf
    v_mfma_f32_16x16x32_bf16 v[188:191], a[52:55], v[164:167], v[188:191]
    v_mul_f32_dpp v227, v27, v27 row_ror:5 row_mask:0xf bank_mask:0xf
    v_mul_f32_dpp v228, v28, v28 row_ror:5 row_mask:0xf bank_mask:0xf
    v_mfma_f32_16x16x32_bf16 v[188:191], a[48:51], v[160:163], v[188:191]
    v_mul_f32_dpp v229, v29, v29 row_ror:5 row_mask:0xf bank_mask:0xf
    v_mul_f32_dpp v230, v30, v30 row_ror:5 row_mask:0xf bank_mask:0xf
    v_smfmac_f32_16x16x64_bf16 v[232:235], a[184:187], v[160:167], v1
    v_mul_f32_dpp v231, v31, v31 row_ror:5 row_mask:0xf bank_mask:0xf
    v_mfma_f32_16x16x32_bf16 v[192:195], a[64:67], v[160:163], v[128:131]
    v_cvt_pk_bf16_f32 v208, |v176|, |v177|
    v_cvt_pk_bf16_f32 v209, |v178|, |v179|
    v_mfma_f32_16x16x32_bf16 v[192:195], a[68:71], v[164:167], v[192:195]
    v_cvt_pk_bf16_f32 v148, v224, v225
    v_cvt_pk_bf16_f32 v149, v226, v227
    v_mfma_f32_16x16x32_bf16 v[192:195], a[72:75], v[168:171], v[192:195]
    v_cvt_pk_bf16_f32 v150, v228, v229
    v_cvt_pk_bf16_f32 v151, v230, v231
    v_mfma_f32_16x16x32_bf16 v[192:195], a[76:79], v[172:175], v[192:195]
    v_mul_f32_dpp v224, v32, v32 row_ror:5 row_mask:0xf bank_mask:0xf
    v_mul_f32_dpp v225, v33, v33 row_ror:5 row_mask:0xf bank_mask:0xf
    v_smfmac_f32_16x16x64_bf16 v[232:235], a[188:191], v[168:175], v1
    v_mul_f32_dpp v226, v34, v34 row_ror:5 row_mask:0xf bank_mask:0xf
    v_mfma_f32_16x16x32_bf16 v[196:199], a[92:95], v[172:175], v[132:135]
    v_mul_f32_dpp v227, v35, v35 row_ror:5 row_mask:0xf bank_mask:0xf
    v_mul_f32_dpp v228, v36, v36 row_ror:5 row_mask:0xf bank_mask:0xf
    v_mfma_f32_16x16x32_bf16 v[196:199], a[88:91], v[168:171], v[196:199]
    v_mul_f32_dpp v229, v37, v37 row_ror:5 row_mask:0xf bank_mask:0xf
    v_mul_f32_dpp v230, v38, v38 row_ror:5 row_mask:0xf bank_mask:0xf
    v_mfma_f32_16x16x32_bf16 v[196:199], a[84:87], v[164:167], v[196:199]
    v_mul_f32_dpp v231, v39, v39 row_ror:5 row_mask:0xf bank_mask:0xf
    v_cvt_pk_bf16_f32 v152, v224, v225
    v_mfma_f32_16x16x32_bf16 v[196:199], a[80:83], v[160:163], v[196:199]
    v_cvt_pk_bf16_f32 v153, v226, v227
    v_cvt_pk_bf16_f32 v154, v228, v229
    v_smfmac_f32_16x16x64_bf16 v[236:239], a[136:139], v[144:151], v1
    v_cvt_pk_bf16_f32 v155, v230, v231
    v_mfma_f32_16x16x32_bf16 v[200:203], a[96:99], v[160:163], v[136:139]
    v_mul_f32_dpp v224, v40, v40 row_ror:5 row_mask:0xf bank_mask:0xf
    v_mul_f32_dpp v225, v41, v41 row_ror:5 row_mask:0xf bank_mask:0xf
    v_mfma_f32_16x16x32_bf16 v[200:203], a[100:103], v[164:167], v[200:203]
    v_mul_f32_dpp v226, v42, v42 row_ror:5 row_mask:0xf bank_mask:0xf
    v_mul_f32_dpp v227, v43, v43 row_ror:5 row_mask:0xf bank_mask:0xf
    v_mfma_f32_16x16x32_bf16 v[200:203], a[104:107], v[168:171], v[200:203]
    v_mul_f32_dpp v228, v44, v44 row_ror:5 row_mask:0xf bank_mask:0xf
    v_mul_f32_dpp v229, v45, v45 row_ror:5 row_mask:0xf bank_mask:0xf
    v_mfma_f32_16x16x32_bf16 v[200:203], a[108:111], v[172:175], v[200:203]
    v_mul_f32_dpp v230, v46, v46 row_ror:5 row_mask:0xf bank_mask:0xf
    v_mul_f32_dpp v231, v47, v47 row_ror:5 row_mask:0xf bank_mask:0xf
    v_mfma_f32_16x16x32_bf16 v[204:207], a[124:127], v[172:175], v[140:143]
    v_cvt_pk_bf16_f32 v156, v224, v225
    v_cvt_pk_bf16_f32 v157, v226, v227
    v_mfma_f32_16x16x32_bf16 v[204:207], a[120:123], v[168:171], v[204:207]
    v_cvt_pk_bf16_f32 v158, v228, v229
    v_cvt_pk_bf16_f32 v159, v230, v231
    v_mfma_f32_16x16x32_bf16 v[204:207], a[116:119], v[164:167], v[204:207]
    v_cvt_pk_bf16_f32 v210, |v180|, |v181|
    v_cvt_pk_bf16_f32 v211, |v182|, |v183|
    v_mfma_f32_16x16x32_bf16 v[204:207], a[112:115], v[160:163], v[204:207]
    v_cvt_pk_bf16_f32 v212, |v184|, |v185|
    v_cvt_pk_bf16_f32 v213, |v186|, |v187|
    v_smfmac_f32_16x16x64_bf16 v[236:239], a[140:143], v[152:159], v1
    v_cvt_pk_bf16_f32 v214, |v188|, |v189|
    v_mfma_f32_16x16x32_bf16 v[176:179], a[0:3], v[144:147], v[112:115]
    v_cvt_pk_bf16_f32 v215, |v190|, |v191|
    v_cvt_pk_bf16_f32 v216, |v192|, |v193|
    v_mfma_f32_16x16x32_bf16 v[176:179], a[4:7], v[148:151], v[176:179]
    v_cvt_pk_bf16_f32 v217, |v194|, |v195|
    v_cvt_pk_bf16_f32 v218, |v196|, |v197|
    v_mfma_f32_16x16x32_bf16 v[176:179], a[8:11], v[152:155], v[176:179]
    v_cvt_pk_bf16_f32 v219, |v198|, |v199|
    v_cvt_pk_bf16_f32 v220, |v200|, |v201|
    v_mfma_f32_16x16x32_bf16 v[176:179], a[12:15], v[156:159], v[176:179]
    v_cvt_pk_bf16_f32 v221, |v202|, |v203|
    v_cvt_pk_bf16_f32 v222, |v204|, |v205|
    v_smfmac_f32_16x16x64_bf16 v[232:235], a[176:179], v[208:215], v1
    v_cvt_pk_bf16_f32 v223, |v206|, |v207|
    v_mfma_f32_16x16x32_bf16 v[180:183], a[28:31], v[156:159], v[116:119]
    v_mul_f32_dpp v224, v16, v16 row_ror:6 row_mask:0xf bank_mask:0xf
    v_mul_f32_dpp v225, v17, v17 row_ror:6 row_mask:0xf bank_mask:0xf
    v_mfma_f32_16x16x32_bf16 v[180:183], a[24:27], v[152:155], v[180:183]
    v_mul_f32_dpp v226, v18, v18 row_ror:6 row_mask:0xf bank_mask:0xf
    v_mul_f32_dpp v227, v19, v19 row_ror:6 row_mask:0xf bank_mask:0xf
    v_mfma_f32_16x16x32_bf16 v[180:183], a[20:23], v[148:151], v[180:183]
    v_mul_f32_dpp v228, v20, v20 row_ror:6 row_mask:0xf bank_mask:0xf
    v_mul_f32_dpp v229, v21, v21 row_ror:6 row_mask:0xf bank_mask:0xf
    v_mfma_f32_16x16x32_bf16 v[180:183], a[16:19], v[144:147], v[180:183]
    v_mul_f32_dpp v230, v22, v22 row_ror:6 row_mask:0xf bank_mask:0xf
    v_mul_f32_dpp v231, v23, v23 row_ror:6 row_mask:0xf bank_mask:0xf
    v_smfmac_f32_16x16x64_bf16 v[232:235], a[180:183], v[216:223], v1
    v_cvt_pk_bf16_f32 v160, v224, v225
    v_mfma_f32_16x16x32_bf16 v[184:187], a[32:35], v[144:147], v[120:123]
    v_cvt_pk_bf16_f32 v161, v226, v227
    v_cvt_pk_bf16_f32 v162, v228, v229
    v_mfma_f32_16x16x32_bf16 v[184:187], a[36:39], v[148:151], v[184:187]
    v_cvt_pk_bf16_f32 v163, v230, v231
    v_mul_f32_dpp v224, v24, v24 row_ror:6 row_mask:0xf bank_mask:0xf
    v_mfma_f32_16x16x32_bf16 v[184:187], a[40:43], v[152:155], v[184:187]
    v_mul_f32_dpp v225, v25, v25 row_ror:6 row_mask:0xf bank_mask:0xf
    v_mul_f32_dpp v226, v26, v26 row_ror:6 row_mask:0xf bank_mask:0xf
    v_mfma_f32_16x16x32_bf16 v[184:187], a[44:47], v[156:159], v[184:187]
    v_mul_f32_dpp v227, v27, v27 row_ror:6 row_mask:0xf bank_mask:0xf
    v_mul_f32_dpp v228, v28, v28 row_ror:6 row_mask:0xf bank_mask:0xf
    v_mfma_f32_16x16x32_bf16 v[188:191], a[60:63], v[156:159], v[124:127]
    v_mul_f32_dpp v229, v29, v29 row_ror:6 row_mask:0xf bank_mask:0xf
    v_mul_f32_dpp v230, v30, v30 row_ror:6 row_mask:0xf bank_mask:0xf
    v_mfma_f32_16x16x32_bf16 v[188:191], a[56:59], v[152:155], v[188:191]
    v_mul_f32_dpp v231, v31, v31 row_ror:6 row_mask:0xf bank_mask:0xf
    v_cvt_pk_bf16_f32 v208, |v176|, |v177|
    v_mfma_f32_16x16x32_bf16 v[188:191], a[52:55], v[148:151], v[188:191]
    v_cvt_pk_bf16_f32 v209, |v178|, |v179|
    v_cvt_pk_bf16_f32 v164, v224, v225
    v_mfma_f32_16x16x32_bf16 v[188:191], a[48:51], v[144:147], v[188:191]
    v_cvt_pk_bf16_f32 v165, v226, v227
    v_cvt_pk_bf16_f32 v166, v228, v229
    v_mfma_f32_16x16x32_bf16 v[192:195], a[64:67], v[144:147], v[128:131]
    v_cvt_pk_bf16_f32 v167, v230, v231
    v_mul_f32_dpp v224, v32, v32 row_ror:6 row_mask:0xf bank_mask:0xf
    v_mfma_f32_16x16x32_bf16 v[192:195], a[68:71], v[148:151], v[192:195]
    v_mul_f32_dpp v225, v33, v33 row_ror:6 row_mask:0xf bank_mask:0xf
    v_mul_f32_dpp v226, v34, v34 row_ror:6 row_mask:0xf bank_mask:0xf
    v_mfma_f32_16x16x32_bf16 v[192:195], a[72:75], v[152:155], v[192:195]
    v_mul_f32_dpp v227, v35, v35 row_ror:6 row_mask:0xf bank_mask:0xf
    v_mul_f32_dpp v228, v36, v36 row_ror:6 row_mask:0xf bank_mask:0xf
    v_mfma_f32_16x16x32_bf16 v[192:195], a[76:79], v[156:159], v[192:195]
    v_mul_f32_dpp v229, v37, v37 row_ror:6 row_mask:0xf bank_mask:0xf
    v_mul_f32_dpp v230, v38, v38 row_ror:6 row_mask:0xf bank_mask:0xf
    v_mfma_f32_16x16x32_bf16 v[196:199], a[92:95], v[156:159], v[132:135]
    v_mul_f32_dpp v231, v39, v39 row_ror:6 row_mask:0xf bank_mask:0xf
    v_cvt_pk_bf16_f32 v168, v224, v225
    v_mfma_f32_16x16x32_bf16 v[196:199], a[88:91], v[152:155], v[196:199]
    v_cvt_pk_bf16_f32 v169, v226, v227
    v_cvt_pk_bf16_f32 v170, v228, v229
    v_mfma_f32_16x16x32_bf16 v[196:199], a[84:87], v[148:151], v[196:199]
    v_cvt_pk_bf16_f32 v171, v230, v231
    v_mul_f32_dpp v224, v40, v40 row_ror:6 row_mask:0xf bank_mask:0xf
    v_mfma_f32_16x16x32_bf16 v[196:199], a[80:83], v[144:147], v[196:199]
    s_waitcnt vmcnt(0)
    v_mul_f32_dpp v225, v41, v41 row_ror:6 row_mask:0xf bank_mask:0xf
    v_mul_f32_dpp v226, v42, v42 row_ror:6 row_mask:0xf bank_mask:0xf
    v_mfma_f32_16x16x32_bf16 v[200:203], a[96:99], v[144:147], v[136:139]
    ds_read_b128 v[64:67], v2 offset:0
    v_mul_f32_dpp v227, v43, v43 row_ror:6 row_mask:0xf bank_mask:0xf
    v_mfma_f32_16x16x32_bf16 v[200:203], a[100:103], v[148:151], v[200:203]
    ds_read_b128 v[68:71], v2 offset:64
    v_mul_f32_dpp v228, v44, v44 row_ror:6 row_mask:0xf bank_mask:0xf
    v_mfma_f32_16x16x32_bf16 v[200:203], a[104:107], v[152:155], v[200:203]
    ds_read_b128 v[72:75], v2 offset:128
    v_mul_f32_dpp v229, v45, v45 row_ror:6 row_mask:0xf bank_mask:0xf
    v_mfma_f32_16x16x32_bf16 v[200:203], a[108:111], v[156:159], v[200:203]
    ds_read_b128 v[76:79], v2 offset:192
    v_mul_f32_dpp v230, v46, v46 row_ror:6 row_mask:0xf bank_mask:0xf
    v_mfma_f32_16x16x32_bf16 v[204:207], a[124:127], v[156:159], v[140:143]
    v_mul_f32_dpp v231, v47, v47 row_ror:6 row_mask:0xf bank_mask:0xf
    v_cvt_pk_bf16_f32 v172, v224, v225
    v_mfma_f32_16x16x32_bf16 v[204:207], a[120:123], v[152:155], v[204:207]
    v_cvt_pk_bf16_f32 v173, v226, v227
    v_cvt_pk_bf16_f32 v174, v228, v229
    v_mfma_f32_16x16x32_bf16 v[204:207], a[116:119], v[148:151], v[204:207]
    v_cvt_pk_bf16_f32 v175, v230, v231
    v_cvt_pk_bf16_f32 v210, |v180|, |v181|
    v_mfma_f32_16x16x32_bf16 v[204:207], a[112:115], v[144:147], v[204:207]
    v_cvt_pk_bf16_f32 v211, |v182|, |v183|
    v_cvt_pk_bf16_f32 v212, |v184|, |v185|
    v_mfma_f32_16x16x32_bf16 v[176:179], a[0:3], v[160:163], v[112:115]
    v_cvt_pk_bf16_f32 v213, |v186|, |v187|
    v_cvt_pk_bf16_f32 v214, |v188|, |v189|
    v_mfma_f32_16x16x32_bf16 v[176:179], a[4:7], v[164:167], v[176:179]
    v_cvt_pk_bf16_f32 v215, |v190|, |v191|
    v_cvt_pk_bf16_f32 v216, |v192|, |v193|
    v_mfma_f32_16x16x32_bf16 v[176:179], a[8:11], v[168:171], v[176:179]
    v_cvt_pk_bf16_f32 v217, |v194|, |v195|
    v_cvt_pk_bf16_f32 v218, |v196|, |v197|
    v_mfma_f32_16x16x32_bf16 v[176:179], a[12:15], v[172:175], v[176:179]
    v_cvt_pk_bf16_f32 v219, |v198|, |v199|
    v_cvt_pk_bf16_f32 v220, |v200|, |v201|
    v_smfmac_f32_16x16x64_bf16 v[236:239], a[128:131], v[208:215], v1
    v_cvt_pk_bf16_f32 v221, |v202|, |v203|
    v_mfma_f32_16x16x32_bf16 v[180:183], a[28:31], v[172:175], v[116:119]
    s_waitcnt lgkmcnt(0)
    v_cvt_pk_bf16_f32 v222, |v204|, |v205|
    v_cvt_pk_bf16_f32 v223, |v206|, |v207|
    v_mfma_f32_16x16x32_bf16 v[180:183], a[24:27], v[168:171], v[180:183]
    v_mul_f32_dpp v224, v16, v16 row_ror:7 row_mask:0xf bank_mask:0xf
    v_mul_f32_dpp v225, v17, v17 row_ror:7 row_mask:0xf bank_mask:0xf
    v_mfma_f32_16x16x32_bf16 v[180:183], a[20:23], v[164:167], v[180:183]
    v_mul_f32_dpp v226, v18, v18 row_ror:7 row_mask:0xf bank_mask:0xf
    v_mul_f32_dpp v227, v19, v19 row_ror:7 row_mask:0xf bank_mask:0xf
    v_mfma_f32_16x16x32_bf16 v[180:183], a[16:19], v[160:163], v[180:183]
    v_mul_f32_dpp v228, v20, v20 row_ror:7 row_mask:0xf bank_mask:0xf
    v_mul_f32_dpp v229, v21, v21 row_ror:7 row_mask:0xf bank_mask:0xf
    v_smfmac_f32_16x16x64_bf16 v[236:239], a[132:135], v[216:223], v1
    v_mul_f32_dpp v230, v22, v22 row_ror:7 row_mask:0xf bank_mask:0xf
    v_mfma_f32_16x16x32_bf16 v[184:187], a[32:35], v[160:163], v[120:123]
    v_mul_f32_dpp v231, v23, v23 row_ror:7 row_mask:0xf bank_mask:0xf
    v_cvt_pk_bf16_f32 v144, v224, v225
    v_mfma_f32_16x16x32_bf16 v[184:187], a[36:39], v[164:167], v[184:187]
    v_cvt_pk_bf16_f32 v145, v226, v227
    v_cvt_pk_bf16_f32 v146, v228, v229
    v_mfma_f32_16x16x32_bf16 v[184:187], a[40:43], v[168:171], v[184:187]
    v_cvt_pk_bf16_f32 v147, v230, v231
    v_mul_f32_dpp v224, v24, v24 row_ror:7 row_mask:0xf bank_mask:0xf
    v_mfma_f32_16x16x32_bf16 v[184:187], a[44:47], v[172:175], v[184:187]
    v_mul_f32_dpp v225, v25, v25 row_ror:7 row_mask:0xf bank_mask:0xf
    v_mul_f32_dpp v226, v26, v26 row_ror:7 row_mask:0xf bank_mask:0xf
    v_smfmac_f32_16x16x64_bf16 v[236:239], a[152:155], v[160:167], v1
    v_mul_f32_dpp v227, v27, v27 row_ror:7 row_mask:0xf bank_mask:0xf
    v_mfma_f32_16x16x32_bf16 v[188:191], a[60:63], v[172:175], v[124:127]
    v_mul_f32_dpp v228, v28, v28 row_ror:7 row_mask:0xf bank_mask:0xf
    v_mul_f32_dpp v229, v29, v29 row_ror:7 row_mask:0xf bank_mask:0xf
    v_mfma_f32_16x16x32_bf16 v[188:191], a[56:59], v[168:171], v[188:191]
    v_mul_f32_dpp v230, v30, v30 row_ror:7 row_mask:0xf bank_mask:0xf
    v_mul_f32_dpp v231, v31, v31 row_ror:7 row_mask:0xf bank_mask:0xf
    v_mfma_f32_16x16x32_bf16 v[188:191], a[52:55], v[164:167], v[188:191]
    v_cvt_pk_bf16_f32 v208, |v176|, |v177|
    v_cvt_pk_bf16_f32 v209, |v178|, |v179|
    v_mfma_f32_16x16x32_bf16 v[188:191], a[48:51], v[160:163], v[188:191]
    v_cvt_pk_bf16_f32 v148, v224, v225
    v_cvt_pk_bf16_f32 v149, v226, v227
    v_smfmac_f32_16x16x64_bf16 v[236:239], a[156:159], v[168:175], v1
    v_cvt_pk_bf16_f32 v150, v228, v229
    v_mfma_f32_16x16x32_bf16 v[192:195], a[64:67], v[160:163], v[128:131]
    v_cvt_pk_bf16_f32 v151, v230, v231
    v_mul_f32_dpp v224, v32, v32 row_ror:7 row_mask:0xf bank_mask:0xf
    v_mfma_f32_16x16x32_bf16 v[192:195], a[68:71], v[164:167], v[192:195]
    v_mul_f32_dpp v225, v33, v33 row_ror:7 row_mask:0xf bank_mask:0xf
    v_mul_f32_dpp v226, v34, v34 row_ror:7 row_mask:0xf bank_mask:0xf
    v_mfma_f32_16x16x32_bf16 v[192:195], a[72:75], v[168:171], v[192:195]
    v_mul_f32_dpp v227, v35, v35 row_ror:7 row_mask:0xf bank_mask:0xf
    v_mul_f32_dpp v228, v36, v36 row_ror:7 row_mask:0xf bank_mask:0xf
    v_mfma_f32_16x16x32_bf16 v[192:195], a[76:79], v[172:175], v[192:195]
    v_mul_f32_dpp v229, v37, v37 row_ror:7 row_mask:0xf bank_mask:0xf
    v_mul_f32_dpp v230, v38, v38 row_ror:7 row_mask:0xf bank_mask:0xf
    v_mfma_f32_16x16x32_bf16 v[196:199], a[92:95], v[172:175], v[132:135]
    v_mul_f32_dpp v231, v39, v39 row_ror:7 row_mask:0xf bank_mask:0xf
    v_cvt_pk_bf16_f32 v152, v224, v225
    v_mfma_f32_16x16x32_bf16 v[196:199], a[88:91], v[168:171], v[196:199]
    v_cvt_pk_bf16_f32 v153, v226, v227
    v_cvt_pk_bf16_f32 v154, v228, v229
    v_mfma_f32_16x16x32_bf16 v[196:199], a[84:87], v[164:167], v[196:199]
    v_cvt_pk_bf16_f32 v155, v230, v231
    v_mul_f32_dpp v224, v40, v40 row_ror:7 row_mask:0xf bank_mask:0xf
    v_mfma_f32_16x16x32_bf16 v[196:199], a[80:83], v[160:163], v[196:199]
    v_mul_f32_dpp v225, v41, v41 row_ror:7 row_mask:0xf bank_mask:0xf
    v_mul_f32_dpp v226, v42, v42 row_ror:7 row_mask:0xf bank_mask:0xf
    v_mfma_f32_16x16x32_bf16 v[200:203], a[96:99], v[160:163], v[136:139]
    v_mul_f32_dpp v227, v43, v43 row_ror:7 row_mask:0xf bank_mask:0xf
    v_mul_f32_dpp v228, v44, v44 row_ror:7 row_mask:0xf bank_mask:0xf
    v_mfma_f32_16x16x32_bf16 v[200:203], a[100:103], v[164:167], v[200:203]
    v_mul_f32_dpp v229, v45, v45 row_ror:7 row_mask:0xf bank_mask:0xf
    v_mul_f32_dpp v230, v46, v46 row_ror:7 row_mask:0xf bank_mask:0xf
    v_mfma_f32_16x16x32_bf16 v[200:203], a[104:107], v[168:171], v[200:203]
    v_mul_f32_dpp v231, v47, v47 row_ror:7 row_mask:0xf bank_mask:0xf
    v_cvt_pk_bf16_f32 v156, v224, v225
    v_mfma_f32_16x16x32_bf16 v[200:203], a[108:111], v[172:175], v[200:203]
    v_cvt_pk_bf16_f32 v157, v226, v227
    v_cvt_pk_bf16_f32 v158, v228, v229
    v_mfma_f32_16x16x32_bf16 v[204:207], a[124:127], v[172:175], v[140:143]
    v_cvt_pk_bf16_f32 v159, v230, v231
    v_cvt_pk_bf16_f32 v210, |v180|, |v181|
    v_mfma_f32_16x16x32_bf16 v[204:207], a[120:123], v[168:171], v[204:207]
    v_cvt_pk_bf16_f32 v211, |v182|, |v183|
    v_cvt_pk_bf16_f32 v212, |v184|, |v185|
    v_mfma_f32_16x16x32_bf16 v[204:207], a[116:119], v[164:167], v[204:207]
    v_cvt_pk_bf16_f32 v213, |v186|, |v187|
    v_cvt_pk_bf16_f32 v214, |v188|, |v189|
    v_mfma_f32_16x16x32_bf16 v[204:207], a[112:115], v[160:163], v[204:207]
    v_cvt_pk_bf16_f32 v215, |v190|, |v191|
    v_cvt_pk_bf16_f32 v216, |v192|, |v193|
    v_mfma_f32_16x16x32_bf16 v[176:179], a[0:3], v[144:147], v[112:115]
    v_cvt_pk_bf16_f32 v217, |v194|, |v195|
    v_cvt_pk_bf16_f32 v218, |v196|, |v197|
    v_mfma_f32_16x16x32_bf16 v[176:179], a[4:7], v[148:151], v[176:179]
    v_cvt_pk_bf16_f32 v219, |v198|, |v199|
    v_cvt_pk_bf16_f32 v220, |v200|, |v201|
    v_mfma_f32_16x16x32_bf16 v[176:179], a[8:11], v[152:155], v[176:179]
    v_cvt_pk_bf16_f32 v221, |v202|, |v203|
    v_cvt_pk_bf16_f32 v222, |v204|, |v205|
    v_mfma_f32_16x16x32_bf16 v[176:179], a[12:15], v[156:159], v[176:179]
    v_cvt_pk_bf16_f32 v223, |v206|, |v207|
    v_lshlrev_b32 v48, 16, v64
    v_smfmac_f32_16x16x64_bf16 v[236:239], a[144:147], v[208:215], v1
    v_and_b32 v49, 0xffff0000, v64
    v_mfma_f32_16x16x32_bf16 v[180:183], a[28:31], v[156:159], v[116:119]
    v_lshlrev_b32 v50, 16, v65
    v_and_b32 v51, 0xffff0000, v65
    v_mfma_f32_16x16x32_bf16 v[180:183], a[24:27], v[152:155], v[180:183]
    v_lshlrev_b32 v52, 16, v66
    v_and_b32 v53, 0xffff0000, v66
    v_mfma_f32_16x16x32_bf16 v[180:183], a[20:23], v[148:151], v[180:183]
    v_lshlrev_b32 v54, 16, v67
    v_and_b32 v55, 0xffff0000, v67
    v_mfma_f32_16x16x32_bf16 v[180:183], a[16:19], v[144:147], v[180:183]
    v_lshlrev_b32 v56, 16, v68
    v_and_b32 v57, 0xffff0000, v68
    v_smfmac_f32_16x16x64_bf16 v[236:239], a[148:151], v[216:223], v1
    v_lshlrev_b32 v58, 16, v69
    v_mfma_f32_16x16x32_bf16 v[184:187], a[32:35], v[144:147], v[120:123]
    v_and_b32 v59, 0xffff0000, v69
    v_lshlrev_b32 v60, 16, v70
    v_mfma_f32_16x16x32_bf16 v[184:187], a[36:39], v[148:151], v[184:187]
    v_and_b32 v61, 0xffff0000, v70
    v_lshlrev_b32 v62, 16, v71
    v_mfma_f32_16x16x32_bf16 v[184:187], a[40:43], v[152:155], v[184:187]
    v_and_b32 v63, 0xffff0000, v71
    v_mul_f32_dpp v224, v48, v16 row_newbcast:14 row_mask:0xf bank_mask:0xf
    v_mfma_f32_16x16x32_bf16 v[184:187], a[44:47], v[156:159], v[184:187]
    v_mul_f32_dpp v225, v49, v17 row_newbcast:14 row_mask:0xf bank_mask:0xf
    v_mul_f32_dpp v226, v50, v18 row_newbcast:14 row_mask:0xf bank_mask:0xf
    v_smfmac_f32_16x16x64_bf16 v[236:239], a[168:171], v[144:151], v1
    v_mul_f32_dpp v227, v51, v19 row_newbcast:14 row_mask:0xf bank_mask:0xf
    v_mfma_f32_16x16x32_bf16 v[188:191], a[60:63], v[156:159], v[124:127]
    v_mul_f32_dpp v228, v52, v20 row_newbcast:14 row_mask:0xf bank_mask:0xf
    v_mul_f32_dpp v229, v53, v21 row_newbcast:14 row_mask:0xf bank_mask:0xf
    v_mfma_f32_16x16x32_bf16 v[188:191], a[56:59], v[152:155], v[188:191]
    v_mul_f32_dpp v230, v54, v22 row_newbcast:14 row_mask:0xf bank_mask:0xf
    v_mul_f32_dpp v231, v55, v23 row_newbcast:14 row_mask:0xf bank_mask:0xf
    v_mfma_f32_16x16x32_bf16 v[188:191], a[52:55], v[148:151], v[188:191]
    v_lshlrev_b32 v64, 16, v72
    v_and_b32 v65, 0xffff0000, v72
    v_mfma_f32_16x16x32_bf16 v[188:191], a[48:51], v[144:147], v[188:191]
    v_lshlrev_b32 v66, 16, v73
    v_and_b32 v67, 0xffff0000, v73
    v_smfmac_f32_16x16x64_bf16 v[236:239], a[172:175], v[152:159], v1
    v_lshlrev_b32 v68, 16, v74
    v_mfma_f32_16x16x32_bf16 v[192:195], a[64:67], v[144:147], v[128:131]
    v_and_b32 v69, 0xffff0000, v74
    v_lshlrev_b32 v70, 16, v75
    v_mfma_f32_16x16x32_bf16 v[192:195], a[68:71], v[148:151], v[192:195]
    v_and_b32 v71, 0xffff0000, v75
    v_cvt_pk_bf16_f32 v160, v224, v225
    v_mfma_f32_16x16x32_bf16 v[192:195], a[72:75], v[152:155], v[192:195]
    v_cvt_pk_bf16_f32 v161, v226, v227
    v_cvt_pk_bf16_f32 v162, v228, v229
    v_mfma_f32_16x16x32_bf16 v[192:195], a[76:79], v[156:159], v[192:195]
    v_cvt_pk_bf16_f32 v163, v230, v231
    v_lshlrev_b32 v72, 16, v76
    v_mfma_f32_16x16x32_bf16 v[196:199], a[92:95], v[156:159], v[132:135]
    v_and_b32 v73, 0xffff0000, v76
    v_lshlrev_b32 v74, 16, v77
    v_mfma_f32_16x16x32_bf16 v[196:199], a[88:91], v[152:155], v[196:199]
    v_and_b32 v75, 0xffff0000, v77
    v_lshlrev_b32 v76, 16, v78
    v_mfma_f32_16x16x32_bf16 v[196:199], a[84:87], v[148:151], v[196:199]
    v_and_b32 v77, 0xffff0000, v78
    v_mul_f32_dpp v224, v56, v24 row_newbcast:14 row_mask:0xf bank_mask:0xf
    v_mfma_f32_16x16x32_bf16 v[196:199], a[80:83], v[144:147], v[196:199]
    v_mul_f32_dpp v225, v57, v25 row_newbcast:14 row_mask:0xf bank_mask:0xf
    v_mul_f32_dpp v226, v58, v26 row_newbcast:14 row_mask:0xf bank_mask:0xf
    v_mfma_f32_16x16x32_bf16 v[200:203], a[96:99], v[144:147], v[136:139]
    v_mul_f32_dpp v227, v59, v27 row_newbcast:14 row_mask:0xf bank_mask:0xf
    v_mul_f32_dpp v228, v60, v28 row_newbcast:14 row_mask:0xf bank_mask:0xf
    v_mfma_f32_16x16x32_bf16 v[200:203], a[100:103], v[148:151], v[200:203]
    v_mul_f32_dpp v229, v61, v29 row_newbcast:14 row_mask:0xf bank_mask:0xf
    v_mul_f32_dpp v230, v62, v30 row_newbcast:14 row_mask:0xf bank_mask:0xf
    v_mfma_f32_16x16x32_bf16 v[200:203], a[104:107], v[152:155], v[200:203]
    v_mul_f32_dpp v231, v63, v31 row_newbcast:14 row_mask:0xf bank_mask:0xf
    v_cvt_pk_bf16_f32 v208, |v176|, |v177|
    v_mfma_f32_16x16x32_bf16 v[200:203], a[108:111], v[156:159], v[200:203]
    v_cvt_pk_bf16_f32 v209, |v178|, |v179|
    v_lshlrev_b32 v78, 16, v79
    v_mfma_f32_16x16x32_bf16 v[204:207], a[124:127], v[156:159], v[140:143]
    v_cvt_pk_bf16_f32 v164, v224, v225
    v_cvt_pk_bf16_f32 v165, v226, v227
    v_mfma_f32_16x16x32_bf16 v[204:207], a[120:123], v[152:155], v[204:207]
    v_cvt_pk_bf16_f32 v166, v228, v229
    v_cvt_pk_bf16_f32 v167, v230, v231
    v_mfma_f32_16x16x32_bf16 v[204:207], a[116:119], v[148:151], v[204:207]
    v_and_b32 v79, 0xffff0000, v79
    v_mul_f32_dpp v224, v64, v32 row_newbcast:14 row_mask:0xf bank_mask:0xf
    v_mfma_f32_16x16x32_bf16 v[204:207], a[112:115], v[144:147], v[204:207]
    v_mul_f32_dpp v225, v65, v33 row_newbcast:14 row_mask:0xf bank_mask:0xf
    v_mul_f32_dpp v226, v66, v34 row_newbcast:14 row_mask:0xf bank_mask:0xf
    v_mfma_f32_16x16x32_bf16 v[176:179], a[0:3], v[160:163], v[112:115]
    v_mul_f32_dpp v227, v67, v35 row_newbcast:14 row_mask:0xf bank_mask:0xf
    v_mul_f32_dpp v228, v68, v36 row_newbcast:14 row_mask:0xf bank_mask:0xf
    v_mfma_f32_16x16x32_bf16 v[176:179], a[4:7], v[164:167], v[176:179]
    v_mul_f32_dpp v229, v69, v37 row_newbcast:14 row_mask:0xf bank_mask:0xf
    v_mul_f32_dpp v230, v70, v38 row_newbcast:14 row_mask:0xf bank_mask:0xf
    v_mul_f32_dpp v231, v71, v39 row_newbcast:14 row_mask:0xf bank_mask:0xf
    v_cvt_pk_bf16_f32 v168, v224, v225
    v_cvt_pk_bf16_f32 v169, v226, v227
    v_cvt_pk_bf16_f32 v170, v228, v229
    v_cvt_pk_bf16_f32 v171, v230, v231
    v_mul_f32_dpp v224, v72, v40 row_newbcast:14 row_mask:0xf bank_mask:0xf
    v_mul_f32_dpp v225, v73, v41 row_newbcast:14 row_mask:0xf bank_mask:0xf
    v_mfma_f32_16x16x32_bf16 v[176:179], a[8:11], v[168:171], v[176:179]
    v_mul_f32_dpp v226, v74, v42 row_newbcast:14 row_mask:0xf bank_mask:0xf
    v_mul_f32_dpp v227, v75, v43 row_newbcast:14 row_mask:0xf bank_mask:0xf
    v_mul_f32_dpp v228, v76, v44 row_newbcast:14 row_mask:0xf bank_mask:0xf
    v_mul_f32_dpp v229, v77, v45 row_newbcast:14 row_mask:0xf bank_mask:0xf
    v_mul_f32_dpp v230, v78, v46 row_newbcast:14 row_mask:0xf bank_mask:0xf
    v_mul_f32_dpp v231, v79, v47 row_newbcast:14 row_mask:0xf bank_mask:0xf
    v_cvt_pk_bf16_f32 v172, v224, v225
    v_cvt_pk_bf16_f32 v173, v226, v227
    v_cvt_pk_bf16_f32 v174, v228, v229
    v_cvt_pk_bf16_f32 v175, v230, v231
    v_cvt_pk_bf16_f32 v210, |v180|, |v181|
    v_cvt_pk_bf16_f32 v211, |v182|, |v183|
    v_mfma_f32_16x16x32_bf16 v[176:179], a[12:15], v[172:175], v[176:179]
    v_cvt_pk_bf16_f32 v212, |v184|, |v185|
    v_cvt_pk_bf16_f32 v213, |v186|, |v187|
    v_mfma_f32_16x16x32_bf16 v[180:183], a[28:31], v[172:175], v[116:119]
    v_cvt_pk_bf16_f32 v214, |v188|, |v189|
    v_cvt_pk_bf16_f32 v215, |v190|, |v191|
    v_mfma_f32_16x16x32_bf16 v[180:183], a[24:27], v[168:171], v[180:183]
    v_cvt_pk_bf16_f32 v216, |v192|, |v193|
    v_cvt_pk_bf16_f32 v217, |v194|, |v195|
    v_mfma_f32_16x16x32_bf16 v[180:183], a[20:23], v[164:167], v[180:183]
    v_cvt_pk_bf16_f32 v218, |v196|, |v197|
    v_cvt_pk_bf16_f32 v219, |v198|, |v199|
    v_mfma_f32_16x16x32_bf16 v[180:183], a[16:19], v[160:163], v[180:183]
    v_cvt_pk_bf16_f32 v220, |v200|, |v201|
    v_cvt_pk_bf16_f32 v221, |v202|, |v203|
    v_smfmac_f32_16x16x64_bf16 v[236:239], a[160:163], v[208:215], v1
    v_cvt_pk_bf16_f32 v222, |v204|, |v205|
    v_mfma_f32_16x16x32_bf16 v[184:187], a[32:35], v[160:163], v[120:123]
    v_cvt_pk_bf16_f32 v223, |v206|, |v207|
    v_mul_f32_dpp v224, v48, v16 row_newbcast:2 row_mask:0xf bank_mask:0xf
    v_mfma_f32_16x16x32_bf16 v[184:187], a[36:39], v[164:167], v[184:187]
    v_mul_f32_dpp v225, v49, v17 row_newbcast:2 row_mask:0xf bank_mask:0xf
    v_mul_f32_dpp v226, v50, v18 row_newbcast:2 row_mask:0xf bank_mask:0xf
    v_mfma_f32_16x16x32_bf16 v[184:187], a[40:43], v[168:171], v[184:187]
    v_mul_f32_dpp v227, v51, v19 row_newbcast:2 row_mask:0xf bank_mask:0xf
    v_mul_f32_dpp v228, v52, v20 row_newbcast:2 row_mask:0xf bank_mask:0xf
    v_mfma_f32_16x16x32_bf16 v[184:187], a[44:47], v[172:175], v[184:187]
    v_mul_f32_dpp v229, v53, v21 row_newbcast:2 row_mask:0xf bank_mask:0xf
    v_mul_f32_dpp v230, v54, v22 row_newbcast:2 row_mask:0xf bank_mask:0xf
    v_smfmac_f32_16x16x64_bf16 v[236:239], a[164:167], v[216:223], v1
    v_mul_f32_dpp v231, v55, v23 row_newbcast:2 row_mask:0xf bank_mask:0xf
    v_mfma_f32_16x16x32_bf16 v[188:191], a[60:63], v[172:175], v[124:127]
    v_cvt_pk_bf16_f32 v144, v224, v225
    v_cvt_pk_bf16_f32 v145, v226, v227
    v_mfma_f32_16x16x32_bf16 v[188:191], a[56:59], v[168:171], v[188:191]
    v_cvt_pk_bf16_f32 v146, v228, v229
    v_cvt_pk_bf16_f32 v147, v230, v231
    v_mfma_f32_16x16x32_bf16 v[188:191], a[52:55], v[164:167], v[188:191]
    v_mul_f32_dpp v224, v56, v24 row_newbcast:2 row_mask:0xf bank_mask:0xf
    v_mul_f32_dpp v225, v57, v25 row_newbcast:2 row_mask:0xf bank_mask:0xf
    v_mfma_f32_16x16x32_bf16 v[188:191], a[48:51], v[160:163], v[188:191]
    v_mul_f32_dpp v226, v58, v26 row_newbcast:2 row_mask:0xf bank_mask:0xf
    v_mul_f32_dpp v227, v59, v27 row_newbcast:2 row_mask:0xf bank_mask:0xf
    v_smfmac_f32_16x16x64_bf16 v[236:239], a[184:187], v[160:167], v1
    v_mul_f32_dpp v228, v60, v28 row_newbcast:2 row_mask:0xf bank_mask:0xf
    v_mfma_f32_16x16x32_bf16 v[192:195], a[64:67], v[160:163], v[128:131]
    v_mul_f32_dpp v229, v61, v29 row_newbcast:2 row_mask:0xf bank_mask:0xf
    v_mul_f32_dpp v230, v62, v30 row_newbcast:2 row_mask:0xf bank_mask:0xf
    v_mfma_f32_16x16x32_bf16 v[192:195], a[68:71], v[164:167], v[192:195]
    v_mul_f32_dpp v231, v63, v31 row_newbcast:2 row_mask:0xf bank_mask:0xf
    v_cvt_pk_bf16_f32 v208, |v176|, |v177|
    v_mfma_f32_16x16x32_bf16 v[192:195], a[72:75], v[168:171], v[192:195]
    v_cvt_pk_bf16_f32 v209, |v178|, |v179|
    v_cvt_pk_bf16_f32 v148, v224, v225
    v_mfma_f32_16x16x32_bf16 v[192:195], a[76:79], v[172:175], v[192:195]
    v_cvt_pk_bf16_f32 v149, v226, v227
    v_cvt_pk_bf16_f32 v150, v228, v229
    v_smfmac_f32_16x16x64_bf16 v[236:239], a[188:191], v[168:175], v1
    v_cvt_pk_bf16_f32 v151, v230, v231
    v_mfma_f32_16x16x32_bf16 v[196:199], a[92:95], v[172:175], v[132:135]
    v_mul_f32_dpp v224, v64, v32 row_newbcast:2 row_mask:0xf bank_mask:0xf
    v_mul_f32_dpp v225, v65, v33 row_newbcast:2 row_mask:0xf bank_mask:0xf
    v_mfma_f32_16x16x32_bf16 v[196:199], a[88:91], v[168:171], v[196:199]
    v_mul_f32_dpp v226, v66, v34 row_newbcast:2 row_mask:0xf bank_mask:0xf
    v_mul_f32_dpp v227, v67, v35 row_newbcast:2 row_mask:0xf bank_mask:0xf
    v_mfma_f32_16x16x32_bf16 v[196:199], a[84:87], v[164:167], v[196:199]
    v_mul_f32_dpp v228, v68, v36 row_newbcast:2 row_mask:0xf bank_mask:0xf
    v_mul_f32_dpp v229, v69, v37 row_newbcast:2 row_mask:0xf bank_mask:0xf
    v_mfma_f32_16x16x32_bf16 v[196:199], a[80:83], v[160:163], v[196:199]
    v_mul_f32_dpp v230, v70, v38 row_newbcast:2 row_mask:0xf bank_mask:0xf
    v_mul_f32_dpp v231, v71, v39 row_newbcast:2 row_mask:0xf bank_mask:0xf
    v_smfmac_f32_16x16x64_bf16 v[240:243], a[136:139], v[144:151], v1
    v_cvt_pk_bf16_f32 v152, v224, v225
    v_mfma_f32_16x16x32_bf16 v[200:203], a[96:99], v[160:163], v[136:139]
    v_cvt_pk_bf16_f32 v153, v226, v227
    v_cvt_pk_bf16_f32 v154, v228, v229
    v_mfma_f32_16x16x32_bf16 v[200:203], a[100:103], v[164:167], v[200:203]
    v_cvt_pk_bf16_f32 v155, v230, v231
    v_mul_f32_dpp v224, v72, v40 row_newbcast:2 row_mask:0xf bank_mask:0xf
    v_mfma_f32_16x16x32_bf16 v[200:203], a[104:107], v[168:171], v[200:203]
    v_mul_f32_dpp v225, v73, v41 row_newbcast:2 row_mask:0xf bank_mask:0xf
    v_mul_f32_dpp v226, v74, v42 row_newbcast:2 row_mask:0xf bank_mask:0xf
    v_mfma_f32_16x16x32_bf16 v[200:203], a[108:111], v[172:175], v[200:203]
    v_mul_f32_dpp v227, v75, v43 row_newbcast:2 row_mask:0xf bank_mask:0xf
    v_mul_f32_dpp v228, v76, v44 row_newbcast:2 row_mask:0xf bank_mask:0xf
    v_mfma_f32_16x16x32_bf16 v[204:207], a[124:127], v[172:175], v[140:143]
    v_mul_f32_dpp v229, v77, v45 row_newbcast:2 row_mask:0xf bank_mask:0xf
    v_mul_f32_dpp v230, v78, v46 row_newbcast:2 row_mask:0xf bank_mask:0xf
    v_mfma_f32_16x16x32_bf16 v[204:207], a[120:123], v[168:171], v[204:207]
L_stub1:
    s_cbranch_scc1 L_main2
    v_mul_f32_dpp v231, v79, v47 row_newbcast:2 row_mask:0xf bank_mask:0xf
    v_cvt_pk_bf16_f32 v156, v224, v225
    v_mfma_f32_16x16x32_bf16 v[204:207], a[116:119], v[164:167], v[204:207]
    v_cvt_pk_bf16_f32 v157, v226, v227
    v_cvt_pk_bf16_f32 v158, v228, v229
    v_mfma_f32_16x16x32_bf16 v[204:207], a[112:115], v[160:163], v[204:207]
    v_cvt_pk_bf16_f32 v159, v230, v231
    v_cvt_pk_bf16_f32 v210, |v180|, |v181|
    v_mfma_f32_16x16x32_bf16 v[176:179], a[0:3], v[144:147], v[112:115]
    v_cvt_pk_bf16_f32 v211, |v182|, |v183|
    v_cvt_pk_bf16_f32 v212, |v184|, |v185|
    v_mfma_f32_16x16x32_bf16 v[176:179], a[4:7], v[148:151], v[176:179]
    v_cvt_pk_bf16_f32 v213, |v186|, |v187|
    v_cvt_pk_bf16_f32 v214, |v188|, |v189|
    v_mfma_f32_16x16x32_bf16 v[176:179], a[8:11], v[152:155], v[176:179]
    v_cvt_pk_bf16_f32 v215, |v190|, |v191|
    v_cvt_pk_bf16_f32 v216, |v192|, |v193|
    v_mfma_f32_16x16x32_bf16 v[176:179], a[12:15], v[156:159], v[176:179]
    v_cvt_pk_bf16_f32 v217, |v194|, |v195|
    v_cvt_pk_bf16_f32 v218, |v196|, |v197|
    v_smfmac_f32_16x16x64_bf16 v[236:239], a[176:179], v[208:215], v1
    v_cvt_pk_bf16_f32 v219, |v198|, |v199|
    v_mfma_f32_16x16x32_bf16 v[180:183], a[28:31], v[156:159], v[116:119]
    v_cvt_pk_bf16_f32 v220, |v200|, |v201|
    v_cvt_pk_bf16_f32 v221, |v202|, |v203|
    v_mfma_f32_16x16x32_bf16 v[180:183], a[24:27], v[152:155], v[180:183]
    v_cvt_pk_bf16_f32 v222, |v204|, |v205|
    v_cvt_pk_bf16_f32 v223, |v206|, |v207|
    v_mfma_f32_16x16x32_bf16 v[180:183], a[20:23], v[148:151], v[180:183]
    v_mul_f32_dpp v224, v48, v16 row_newbcast:5 row_mask:0xf bank_mask:0xf
    v_mul_f32_dpp v225, v49, v17 row_newbcast:5 row_mask:0xf bank_mask:0xf
    v_mfma_f32_16x16x32_bf16 v[180:183], a[16:19], v[144:147], v[180:183]
    v_mul_f32_dpp v226, v50, v18 row_newbcast:5 row_mask:0xf bank_mask:0xf
    v_mul_f32_dpp v227, v51, v19 row_newbcast:5 row_mask:0xf bank_mask:0xf
    v_smfmac_f32_16x16x64_bf16 v[236:239], a[180:183], v[216:223], v1
    v_mul_f32_dpp v228, v52, v20 row_newbcast:5 row_mask:0xf bank_mask:0xf
    v_mfma_f32_16x16x32_bf16 v[184:187], a[32:35], v[144:147], v[120:123]
    v_mul_f32_dpp v229, v53, v21 row_newbcast:5 row_mask:0xf bank_mask:0xf
    v_mul_f32_dpp v230, v54, v22 row_newbcast:5 row_mask:0xf bank_mask:0xf
    v_mfma_f32_16x16x32_bf16 v[184:187], a[36:39], v[148:151], v[184:187]
    v_mul_f32_dpp v231, v55, v23 row_newbcast:5 row_mask:0xf bank_mask:0xf
    v_cvt_pk_bf16_f32 v160, v224, v225
    v_mfma_f32_16x16x32_bf16 v[184:187], a[40:43], v[152:155], v[184:187]
    s_waitcnt vmcnt(0)
    v_cvt_pk_bf16_f32 v161, v226, v227
    v_cvt_pk_bf16_f32 v162, v228, v229
    v_mfma_f32_16x16x32_bf16 v[184:187], a[44:47], v[156:159], v[184:187]
    ds_read_b128 v[96:99], v6 offset:0
    v_cvt_pk_bf16_f32 v163, v230, v231
    v_smfmac_f32_16x16x64_bf16 v[240:243], a[140:143], v[152:159], v1
    v_mul_f32_dpp v224, v56, v24 row_newbcast:5 row_mask:0xf bank_mask:0xf
    v_mfma_f32_16x16x32_bf16 v[188:191], a[60:63], v[156:159], v[124:127]
    ds_read_b128 v[100:103], v6 offset:64
    v_mul_f32_dpp v225, v57, v25 row_newbcast:5 row_mask:0xf bank_mask:0xf
    v_mfma_f32_16x16x32_bf16 v[188:191], a[56:59], v[152:155], v[188:191]
    ds_read_b128 v[104:107], v6 offset:128
    v_mul_f32_dpp v226, v58, v26 row_newbcast:5 row_mask:0xf bank_mask:0xf
    v_mfma_f32_16x16x32_bf16 v[188:191], a[52:55], v[148:151], v[188:191]
    ds_read_b128 v[108:111], v6 offset:192
    v_mul_f32_dpp v227, v59, v27 row_newbcast:5 row_mask:0xf bank_mask:0xf
    v_mfma_f32_16x16x32_bf16 v[188:191], a[48:51], v[144:147], v[188:191]
    v_mul_f32_dpp v228, v60, v28 row_newbcast:5 row_mask:0xf bank_mask:0xf
    v_mul_f32_dpp v229, v61, v29 row_newbcast:5 row_mask:0xf bank_mask:0xf
    v_mfma_f32_16x16x32_bf16 v[192:195], a[64:67], v[144:147], v[128:131]
    v_mul_f32_dpp v230, v62, v30 row_newbcast:5 row_mask:0xf bank_mask:0xf
    v_mul_f32_dpp v231, v63, v31 row_newbcast:5 row_mask:0xf bank_mask:0xf
    v_mfma_f32_16x16x32_bf16 v[192:195], a[68:71], v[148:151], v[192:195]
    v_cvt_pk_bf16_f32 v208, |v176|, |v177|
    v_cvt_pk_bf16_f32 v209, |v178|, |v179|
    v_mfma_f32_16x16x32_bf16 v[192:195], a[72:75], v[152:155], v[192:195]
    v_cvt_pk_bf16_f32 v164, v224, v225
    v_cvt_pk_bf16_f32 v165, v226, v227
    v_mfma_f32_16x16x32_bf16 v[192:195], a[76:79], v[156:159], v[192:195]
    v_cvt_pk_bf16_f32 v166, v228, v229
    v_cvt_pk_bf16_f32 v167, v230, v231
    v_mfma_f32_16x16x32_bf16 v[196:199], a[92:95], v[156:159], v[132:135]
    v_mul_f32_dpp v224, v64, v32 row_newbcast:5 row_mask:0xf bank_mask:0xf
    v_mul_f32_dpp v225, v65, v33 row_newbcast:5 row_mask:0xf bank_mask:0xf
    v_mfma_f32_16x16x32_bf16 v[196:199], a[88:91], v[152:155], v[196:199]
    v_mul_f32_dpp v226, v66, v34 row_newbcast:5 row_mask:0xf bank_mask:0xf
    v_mul_f32_dpp v227, v67, v35 row_newbcast:5 row_mask:0xf bank_mask:0xf
    v_mfma_f32_16x16x32_bf16 v[196:199], a[84:87], v[148:151], v[196:199]
    v_mul_f32_dpp v228, v68, v36 row_newbcast:5 row_mask:0xf bank_mask:0xf
    v_mul_f32_dpp v229, v69, v37 row_newbcast:5 row_mask:0xf bank_mask:0xf
    v_mfma_f32_16x16x32_bf16 v[196:199], a[80:83], v[144:147], v[196:199]
    s_waitcnt lgkmcnt(0)
    v_mul_f32_dpp v230, v70, v38 row_newbcast:5 row_mask:0xf bank_mask:0xf
    v_mul_f32_dpp v231, v71, v39 row_newbcast:5 row_mask:0xf bank_mask:0xf
    v_mfma_f32_16x16x32_bf16 v[200:203], a[96:99], v[144:147], v[136:139]
    v_cvt_pk_bf16_f32 v168, v224, v225
    v_cvt_pk_bf16_f32 v169, v226, v227
    v_mfma_f32_16x16x32_bf16 v[200:203], a[100:103], v[148:151], v[200:203]
    v_cvt_pk_bf16_f32 v170, v228, v229
    v_cvt_pk_bf16_f32 v171, v230, v231
    v_mfma_f32_16x16x32_bf16 v[200:203], a[104:107], v[152:155], v[200:203]
    v_mul_f32_dpp v224, v72, v40 row_newbcast:5 row_mask:0xf bank_mask:0xf
    v_mul_f32_dpp v225, v73, v41 row_newbcast:5 row_mask:0xf bank_mask:0xf
    v_mfma_f32_16x16x32_bf16 v[200:203], a[108:111], v[156:159], v[200:203]
    v_mul_f32_dpp v226, v74, v42 row_newbcast:5 row_mask:0xf bank_mask:0xf
    v_mul_f32_dpp v227, v75, v43 row_newbcast:5 row_mask:0xf bank_mask:0xf
    v_mfma_f32_16x16x32_bf16 v[204:207], a[124:127], v[156:159], v[140:143]
    v_mul_f32_dpp v228, v76, v44 row_newbcast:5 row_mask:0xf bank_mask:0xf
    v_mul_f32_dpp v229, v77, v45 row_newbcast:5 row_mask:0xf bank_mask:0xf
    v_mfma_f32_16x16x32_bf16 v[204:207], a[120:123], v[152:155], v[204:207]
    v_mul_f32_dpp v230, v78, v46 row_newbcast:5 row_mask:0xf bank_mask:0xf
    v_mul_f32_dpp v231, v79, v47 row_newbcast:5 row_mask:0xf bank_mask:0xf
    v_mfma_f32_16x16x32_bf16 v[204:207], a[116:119], v[148:151], v[204:207]
    v_cvt_pk_bf16_f32 v172, v224, v225
    v_cvt_pk_bf16_f32 v173, v226, v227
    v_mfma_f32_16x16x32_bf16 v[204:207], a[112:115], v[144:147], v[204:207]
    v_cvt_pk_bf16_f32 v174, v228, v229
    v_cvt_pk_bf16_f32 v175, v230, v231
    v_mfma_f32_16x16x32_bf16 v[176:179], a[0:3], v[160:163], v[112:115]
    v_cvt_pk_bf16_f32 v210, |v180|, |v181|
    v_cvt_pk_bf16_f32 v211, |v182|, |v183|
    v_mfma_f32_16x16x32_bf16 v[176:179], a[4:7], v[164:167], v[176:179]
    v_cvt_pk_bf16_f32 v212, |v184|, |v185|
    v_cvt_pk_bf16_f32 v213, |v186|, |v187|
    v_mfma_f32_16x16x32_bf16 v[176:179], a[8:11], v[168:171], v[176:179]
    v_cvt_pk_bf16_f32 v214, |v188|, |v189|
    v_cvt_pk_bf16_f32 v215, |v190|, |v191|
    v_mfma_f32_16x16x32_bf16 v[176:179], a[12:15], v[172:175], v[176:179]
    v_cvt_pk_bf16_f32 v216, |v192|, |v193|
    v_cvt_pk_bf16_f32 v217, |v194|, |v195|
    v_smfmac_f32_16x16x64_bf16 v[240:243], a[128:131], v[208:215], v1
    v_cvt_pk_bf16_f32 v218, |v196|, |v197|
    v_mfma_f32_16x16x32_bf16 v[180:183], a[28:31], v[172:175], v[116:119]
    v_cvt_pk_bf16_f32 v219, |v198|, |v199|
    v_cvt_pk_bf16_f32 v220, |v200|, |v201|
    v_mfma_f32_16x16x32_bf16 v[180:183], a[24:27], v[168:171], v[180:183]
    v_cvt_pk_bf16_f32 v221, |v202|, |v203|
    v_cvt_pk_bf16_f32 v222, |v204|, |v205|
    v_mfma_f32_16x16x32_bf16 v[180:183], a[20:23], v[164:167], v[180:183]
    v_cvt_pk_bf16_f32 v223, |v206|, |v207|
    v_mul_f32_dpp v224, v48, v16 row_newbcast:7 row_mask:0xf bank_mask:0xf
    v_mfma_f32_16x16x32_bf16 v[180:183], a[16:19], v[160:163], v[180:183]
    v_mul_f32_dpp v225, v49, v17 row_newbcast:7 row_mask:0xf bank_mask:0xf
    v_mul_f32_dpp v226, v50, v18 row_newbcast:7 row_mask:0xf bank_mask:0xf
    v_smfmac_f32_16x16x64_bf16 v[240:243], a[132:135], v[216:223], v1
    v_mul_f32_dpp v227, v51, v19 row_newbcast:7 row_mask:0xf bank_mask:0xf
    v_mfma_f32_16x16x32_bf16 v[184:187], a[32:35], v[160:163], v[120:123]
    v_mul_f32_dpp v228, v52, v20 row_newbcast:7 row_mask:0xf bank_mask:0xf
    v_mul_f32_dpp v229, v53, v21 row_newbcast:7 row_mask:0xf bank_mask:0xf
    v_mfma_f32_16x16x32_bf16 v[184:187], a[36:39], v[164:167], v[184:187]
    v_mul_f32_dpp v230, v54, v22 row_newbcast:7 row_mask:0xf bank_mask:0xf
    v_mul_f32_dpp v231, v55, v23 row_newbcast:7 row_mask:0xf bank_mask:0xf
    v_mfma_f32_16x16x32_bf16 v[184:187], a[40:43], v[168:171], v[184:187]
    v_cvt_pk_bf16_f32 v144, v224, v225
    v_cvt_pk_bf16_f32 v145, v226, v227
    v_mfma_f32_16x16x32_bf16 v[184:187], a[44:47], v[172:175], v[184:187]
    v_cvt_pk_bf16_f32 v146, v228, v229
    v_cvt_pk_bf16_f32 v147, v230, v231
    v_smfmac_f32_16x16x64_bf16 v[240:243], a[152:155], v[160:167], v1
    v_mul_f32_dpp v224, v56, v24 row_newbcast:7 row_mask:0xf bank_mask:0xf
    v_mfma_f32_16x16x32_bf16 v[188:191], a[60:63], v[172:175], v[124:127]
    v_mul_f32_dpp v225, v57, v25 row_newbcast:7 row_mask:0xf bank_mask:0xf
    v_mul_f32_dpp v226, v58, v26 row_newbcast:7 row_mask:0xf bank_mask:0xf
    v_mfma_f32_16x16x32_bf16 v[188:191], a[56:59], v[168:171], v[188:191]
    v_mul_f32_dpp v227, v59, v27 row_newbcast:7 row_mask:0xf bank_mask:0xf
    v_mul_f32_dpp v228, v60, v28 row_newbcast:7 row_mask:0xf bank_mask:0xf
    v_mfma_f32_16x16x32_bf16 v[188:191], a[52:55], v[164:167], v[188:191]
    v_mul_f32_dpp v229, v61, v29 row_newbcast:7 row_mask:0xf bank_mask:0xf
    v_mul_f32_dpp v230, v62, v30 row_newbcast:7 row_mask:0xf bank_mask:0xf
    v_mfma_f32_16x16x32_bf16 v[188:191], a[48:51], v[160:163], v[188:191]
    v_mul_f32_dpp v231, v63, v31 row_newbcast:7 row_mask:0xf bank_mask:0xf
    v_cvt_pk_bf16_f32 v208, |v176|, |v177|
    v_smfmac_f32_16x16x64_bf16 v[240:243], a[156:159], v[168:175], v1
    v_cvt_pk_bf16_f32 v209, |v178|, |v179|
    v_mfma_f32_16x16x32_bf16 v[192:195], a[64:67], v[160:163], v[128:131]
    v_cvt_pk_bf16_f32 v148, v224, v225
    v_cvt_pk_bf16_f32 v149, v226, v227
    v_mfma_f32_16x16x32_bf16 v[192:195], a[68:71], v[164:167], v[192:195]
    v_cvt_pk_bf16_f32 v150, v228, v229
    v_cvt_pk_bf16_f32 v151, v230, v231
    v_mfma_f32_16x16x32_bf16 v[192:195], a[72:75], v[168:171], v[192:195]
    v_mul_f32_dpp v224, v64, v32 row_newbcast:7 row_mask:0xf bank_mask:0xf
    v_mul_f32_dpp v225, v65, v33 row_newbcast:7 row_mask:0xf bank_mask:0xf
    v_mfma_f32_16x16x32_bf16 v[192:195], a[76:79], v[172:175], v[192:195]
    v_mul_f32_dpp v226, v66, v34 row_newbcast:7 row_mask:0xf bank_mask:0xf
    v_mul_f32_dpp v227, v67, v35 row_newbcast:7 row_mask:0xf bank_mask:0xf
    v_mfma_f32_16x16x32_bf16 v[196:199], a[92:95], v[172:175], v[132:135]
    v_mul_f32_dpp v228, v68, v36 row_newbcast:7 row_mask:0xf bank_mask:0xf
    v_mul_f32_dpp v229, v69, v37 row_newbcast:7 row_mask:0xf bank_mask:0xf
    v_mfma_f32_16x16x32_bf16 v[196:199], a[88:91], v[168:171], v[196:199]
    v_mul_f32_dpp v230, v70, v38 row_newbcast:7 row_mask:0xf bank_mask:0xf
    v_mul_f32_dpp v231, v71, v39 row_newbcast:7 row_mask:0xf bank_mask:0xf
    v_mfma_f32_16x16x32_bf16 v[196:199], a[84:87], v[164:167], v[196:199]
    v_cvt_pk_bf16_f32 v152, v224, v225
    v_cvt_pk_bf16_f32 v153, v226, v227
    v_mfma_f32_16x16x32_bf16 v[196:199], a[80:83], v[160:163], v[196:199]
    v_cvt_pk_bf16_f32 v154, v228, v229
    v_cvt_pk_bf16_f32 v155, v230, v231
    v_mfma_f32_16x16x32_bf16 v[200:203], a[96:99], v[160:163], v[136:139]
    v_mul_f32_dpp v224, v72, v40 row_newbcast:7 row_mask:0xf bank_mask:0xf
    v_mul_f32_dpp v225, v73, v41 row_newbcast:7 row_mask:0xf bank_mask:0xf
    v_mfma_f32_16x16x32_bf16 v[200:203], a[100:103], v[164:167], v[200:203]
    v_mul_f32_dpp v226, v74, v42 row_newbcast:7 row_mask:0xf bank_mask:0xf
    v_mul_f32_dpp v227, v75, v43 row_newbcast:7 row_mask:0xf bank_mask:0xf
    v_mfma_f32_16x16x32_bf16 v[200:203], a[104:107], v[168:171], v[200:203]
    v_mul_f32_dpp v228, v76, v44 row_newbcast:7 row_mask:0xf bank_mask:0xf
    v_mul_f32_dpp v229, v77, v45 row_newbcast:7 row_mask:0xf bank_mask:0xf
    v_mfma_f32_16x16x32_bf16 v[200:203], a[108:111], v[172:175], v[200:203]
    v_mul_f32_dpp v230, v78, v46 row_newbcast:7 row_mask:0xf bank_mask:0xf
    v_mul_f32_dpp v231, v79, v47 row_newbcast:7 row_mask:0xf bank_mask:0xf
    v_mfma_f32_16x16x32_bf16 v[204:207], a[124:127], v[172:175], v[140:143]
    v_cvt_pk_bf16_f32 v156, v224, v225
    v_cvt_pk_bf16_f32 v157, v226, v227
    v_mfma_f32_16x16x32_bf16 v[204:207], a[120:123], v[168:171], v[204:207]
    v_cvt_pk_bf16_f32 v158, v228, v229
    v_cvt_pk_bf16_f32 v159, v230, v231
    v_mfma_f32_16x16x32_bf16 v[204:207], a[116:119], v[164:167], v[204:207]
    v_cvt_pk_bf16_f32 v210, |v180|, |v181|
    v_cvt_pk_bf16_f32 v211, |v182|, |v183|
    v_mfma_f32_16x16x32_bf16 v[204:207], a[112:115], v[160:163], v[204:207]
    v_cvt_pk_bf16_f32 v212, |v184|, |v185|
    v_cvt_pk_bf16_f32 v213, |v186|, |v187|
    v_mfma_f32_16x16x32_bf16 v[176:179], a[0:3], v[144:147], v[112:115]
    v_cvt_pk_bf16_f32 v214, |v188|, |v189|
    v_cvt_pk_bf16_f32 v215, |v190|, |v191|
    v_mfma_f32_16x16x32_bf16 v[176:179], a[4:7], v[148:151], v[176:179]
    v_cvt_pk_bf16_f32 v216, |v192|, |v193|
    v_cvt_pk_bf16_f32 v217, |v194|, |v195|
    v_mfma_f32_16x16x32_bf16 v[176:179], a[8:11], v[152:155], v[176:179]
    v_cvt_pk_bf16_f32 v218, |v196|, |v197|
    v_cvt_pk_bf16_f32 v219, |v198|, |v199|
    v_mfma_f32_16x16x32_bf16 v[176:179], a[12:15], v[156:159], v[176:179]
    v_cvt_pk_bf16_f32 v220, |v200|, |v201|
    v_cvt_pk_bf16_f32 v221, |v202|, |v203|
    v_smfmac_f32_16x16x64_bf16 v[240:243], a[144:147], v[208:215], v1
    v_cvt_pk_bf16_f32 v222, |v204|, |v205|
    v_mfma_f32_16x16x32_bf16 v[180:183], a[28:31], v[156:159], v[116:119]
    v_cvt_pk_bf16_f32 v223, |v206|, |v207|
    v_mul_f32_dpp v224, v48, v16 row_newbcast:9 row_mask:0xf bank_mask:0xf
    v_mfma_f32_16x16x32_bf16 v[180:183], a[24:27], v[152:155], v[180:183]
    v_mul_f32_dpp v225, v49, v17 row_newbcast:9 row_mask:0xf bank_mask:0xf
    v_mul_f32_dpp v226, v50, v18 row_newbcast:9 row_mask:0xf bank_mask:0xf
    v_mfma_f32_16x16x32_bf16 v[180:183], a[20:23], v[148:151], v[180:183]
    v_mul_f32_dpp v227, v51, v19 row_newbcast:9 row_mask:0xf bank_mask:0xf
    v_mul_f32_dpp v228, v52, v20 row_newbcast:9 row_mask:0xf bank_mask:0xf
    v_mfma_f32_16x16x32_bf16 v[180:183], a[16:19], v[144:147], v[180:183]
    v_mul_f32_dpp v229, v53, v21 row_newbcast:9 row_mask:0xf bank_mask:0xf
    v_mul_f32_dpp v230, v54, v22 row_newbcast:9 row_mask:0xf bank_mask:0xf
    v_smfmac_f32_16x16x64_bf16 v[240:243], a[148:151], v[216:223], v1
    v_mul_f32_dpp v231, v55, v23 row_newbcast:9 row_mask:0xf bank_mask:0xf
    v_mfma_f32_16x16x32_bf16 v[184:187], a[32:35], v[144:147], v[120:123]
    v_cvt_pk_bf16_f32 v160, v224, v225
    v_cvt_pk_bf16_f32 v161, v226, v227
    v_mfma_f32_16x16x32_bf16 v[184:187], a[36:39], v[148:151], v[184:187]
    v_cvt_pk_bf16_f32 v162, v228, v229
    v_cvt_pk_bf16_f32 v163, v230, v231
    v_mfma_f32_16x16x32_bf16 v[184:187], a[40:43], v[152:155], v[184:187]
    v_mul_f32_dpp v224, v56, v24 row_newbcast:9 row_mask:0xf bank_mask:0xf
    v_mul_f32_dpp v225, v57, v25 row_newbcast:9 row_mask:0xf bank_mask:0xf
    v_mfma_f32_16x16x32_bf16 v[184:187], a[44:47], v[156:159], v[184:187]
    v_mul_f32_dpp v226, v58, v26 row_newbcast:9 row_mask:0xf bank_mask:0xf
    v_mul_f32_dpp v227, v59, v27 row_newbcast:9 row_mask:0xf bank_mask:0xf
    v_smfmac_f32_16x16x64_bf16 v[240:243], a[168:171], v[144:151], v1
    v_mul_f32_dpp v228, v60, v28 row_newbcast:9 row_mask:0xf bank_mask:0xf
    v_mfma_f32_16x16x32_bf16 v[188:191], a[60:63], v[156:159], v[124:127]
    v_mul_f32_dpp v229, v61, v29 row_newbcast:9 row_mask:0xf bank_mask:0xf
    v_mul_f32_dpp v230, v62, v30 row_newbcast:9 row_mask:0xf bank_mask:0xf
    v_mfma_f32_16x16x32_bf16 v[188:191], a[56:59], v[152:155], v[188:191]
    v_mul_f32_dpp v231, v63, v31 row_newbcast:9 row_mask:0xf bank_mask:0xf
    v_cvt_pk_bf16_f32 v208, |v176|, |v177|
    v_mfma_f32_16x16x32_bf16 v[188:191], a[52:55], v[148:151], v[188:191]
    v_cvt_pk_bf16_f32 v209, |v178|, |v179|
    v_cvt_pk_bf16_f32 v164, v224, v225
    v_mfma_f32_16x16x32_bf16 v[188:191], a[48:51], v[144:147], v[188:191]
    v_cvt_pk_bf16_f32 v165, v226, v227
    v_cvt_pk_bf16_f32 v166, v228, v229
    v_smfmac_f32_16x16x64_bf16 v[240:243], a[172:175], v[152:159], v1
    v_cvt_pk_bf16_f32 v167, v230, v231
    v_mfma_f32_16x16x32_bf16 v[192:195], a[64:67], v[144:147], v[128:131]
    v_mul_f32_dpp v224, v64, v32 row_newbcast:9 row_mask:0xf bank_mask:0xf
    v_mul_f32_dpp v225, v65, v33 row_newbcast:9 row_mask:0xf bank_mask:0xf
    v_mfma_f32_16x16x32_bf16 v[192:195], a[68:71], v[148:151], v[192:195]
    v_mul_f32_dpp v226, v66, v34 row_newbcast:9 row_mask:0xf bank_mask:0xf
    v_mul_f32_dpp v227, v67, v35 row_newbcast:9 row_mask:0xf bank_mask:0xf
    v_mfma_f32_16x16x32_bf16 v[192:195], a[72:75], v[152:155], v[192:195]
    v_mul_f32_dpp v228, v68, v36 row_newbcast:9 row_mask:0xf bank_mask:0xf
    v_mul_f32_dpp v229, v69, v37 row_newbcast:9 row_mask:0xf bank_mask:0xf
    v_mfma_f32_16x16x32_bf16 v[192:195], a[76:79], v[156:159], v[192:195]
    v_mul_f32_dpp v230, v70, v38 row_newbcast:9 row_mask:0xf bank_mask:0xf
    v_mul_f32_dpp v231, v71, v39 row_newbcast:9 row_mask:0xf bank_mask:0xf
    v_mfma_f32_16x16x32_bf16 v[196:199], a[92:95], v[156:159], v[132:135]
    v_cvt_pk_bf16_f32 v168, v224, v225
    v_cvt_pk_bf16_f32 v169, v226, v227
    v_mfma_f32_16x16x32_bf16 v[196:199], a[88:91], v[152:155], v[196:199]
    v_cvt_pk_bf16_f32 v170, v228, v229
    v_cvt_pk_bf16_f32 v171, v230, v231
    v_mfma_f32_16x16x32_bf16 v[196:199], a[84:87], v[148:151], v[196:199]
    v_mul_f32_dpp v224, v72, v40 row_newbcast:9 row_mask:0xf bank_mask:0xf
    v_mul_f32_dpp v225, v73, v41 row_newbcast:9 row_mask:0xf bank_mask:0xf
    v_mfma_f32_16x16x32_bf16 v[196:199], a[80:83], v[144:147], v[196:199]
    v_mul_f32_dpp v226, v74, v42 row_newbcast:9 row_mask:0xf bank_mask:0xf
    v_mul_f32_dpp v227, v75, v43 row_newbcast:9 row_mask:0xf bank_mask:0xf
    v_mfma_f32_16x16x32_bf16 v[200:203], a[96:99], v[144:147], v[136:139]
    v_mul_f32_dpp v228, v76, v44 row_newbcast:9 row_mask:0xf bank_mask:0xf
    v_mul_f32_dpp v229, v77, v45 row_newbcast:9 row_mask:0xf bank_mask:0xf
    v_mfma_f32_16x16x32_bf16 v[200:203], a[100:103], v[148:151], v[200:203]
    v_mul_f32_dpp v230, v78, v46 row_newbcast:9 row_mask:0xf bank_mask:0xf
    v_mul_f32_dpp v231, v79, v47 row_newbcast:9 row_mask:0xf bank_mask:0xf
    v_mfma_f32_16x16x32_bf16 v[200:203], a[104:107], v[152:155], v[200:203]
    v_cvt_pk_bf16_f32 v172, v224, v225
    v_cvt_pk_bf16_f32 v173, v226, v227
    v_mfma_f32_16x16x32_bf16 v[200:203], a[108:111], v[156:159], v[200:203]
    v_cvt_pk_bf16_f32 v174, v228, v229
    v_cvt_pk_bf16_f32 v175, v230, v231
    v_mfma_f32_16x16x32_bf16 v[204:207], a[124:127], v[156:159], v[140:143]
    v_cvt_pk_bf16_f32 v210, |v180|, |v181|
    v_cvt_pk_bf16_f32 v211, |v182|, |v183|
    v_mfma_f32_16x16x32_bf16 v[204:207], a[120:123], v[152:155], v[204:207]
    v_cvt_pk_bf16_f32 v212, |v184|, |v185|
    v_cvt_pk_bf16_f32 v213, |v186|, |v187|
    v_mfma_f32_16x16x32_bf16 v[204:207], a[116:119], v[148:151], v[204:207]
    v_cvt_pk_bf16_f32 v214, |v188|, |v189|
    v_cvt_pk_bf16_f32 v215, |v190|, |v191|
    v_mfma_f32_16x16x32_bf16 v[204:207], a[112:115], v[144:147], v[204:207]
    v_cvt_pk_bf16_f32 v216, |v192|, |v193|
    v_cvt_pk_bf16_f32 v217, |v194|, |v195|
    v_smfmac_f32_16x16x64_bf16 v[240:243], a[160:163], v[208:215], v1
    v_cvt_pk_bf16_f32 v218, |v196|, |v197|
    v_mfma_f32_16x16x32_bf16 v[176:179], a[0:3], v[160:163], v[112:115]
    v_cvt_pk_bf16_f32 v219, |v198|, |v199|
    v_cvt_pk_bf16_f32 v220, |v200|, |v201|
    v_mfma_f32_16x16x32_bf16 v[176:179], a[4:7], v[164:167], v[176:179]
    v_cvt_pk_bf16_f32 v221, |v202|, |v203|
    v_cvt_pk_bf16_f32 v222, |v204|, |v205|
    v_mfma_f32_16x16x32_bf16 v[176:179], a[8:11], v[168:171], v[176:179]
    v_cvt_pk_bf16_f32 v223, |v206|, |v207|
    v_mul_f32_dpp v224, v48, v16 row_newbcast:8 row_mask:0xf bank_mask:0xf
    v_mfma_f32_16x16x32_bf16 v[176:179], a[12:15], v[172:175], v[176:179]
    v_mul_f32_dpp v225, v49, v17 row_newbcast:8 row_mask:0xf bank_mask:0xf
    v_mul_f32_dpp v226, v50, v18 row_newbcast:8 row_mask:0xf bank_mask:0xf
    v_smfmac_f32_16x16x64_bf16 v[240:243], a[164:167], v[216:223], v1
    v_mul_f32_dpp v227, v51, v19 row_newbcast:8 row_mask:0xf bank_mask:0xf
    v_mfma_f32_16x16x32_bf16 v[180:183], a[28:31], v[172:175], v[116:119]
    v_mul_f32_dpp v228, v52, v20 row_newbcast:8 row_mask:0xf bank_mask:0xf
    v_mul_f32_dpp v229, v53, v21 row_newbcast:8 row_mask:0xf bank_mask:0xf
    v_mfma_f32_16x16x32_bf16 v[180:183], a[24:27], v[168:171], v[180:183]
    v_mul_f32_dpp v230, v54, v22 row_newbcast:8 row_mask:0xf bank_mask:0xf
    v_mul_f32_dpp v231, v55, v23 row_newbcast:8 row_mask:0xf bank_mask:0xf
    v_mfma_f32_16x16x32_bf16 v[180:183], a[20:23], v[164:167], v[180:183]
    v_cvt_pk_bf16_f32 v144, v224, v225
    v_cvt_pk_bf16_f32 v145, v226, v227
    v_mfma_f32_16x16x32_bf16 v[180:183], a[16:19], v[160:163], v[180:183]
    v_cvt_pk_bf16_f32 v146, v228, v229
    v_cvt_pk_bf16_f32 v147, v230, v231
    v_smfmac_f32_16x16x64_bf16 v[240:243], a[184:187], v[160:167], v1
    v_mul_f32_dpp v224, v56, v24 row_newbcast:8 row_mask:0xf bank_mask:0xf
    v_mfma_f32_16x16x32_bf16 v[184:187], a[32:35], v[160:163], v[120:123]
    v_mul_f32_dpp v225, v57, v25 row_newbcast:8 row_mask:0xf bank_mask:0xf
    v_mul_f32_dpp v226, v58, v26 row_newbcast:8 row_mask:0xf bank_mask:0xf
    v_mfma_f32_16x16x32_bf16 v[184:187], a[36:39], v[164:167], v[184:187]
    v_mul_f32_dpp v227, v59, v27 row_newbcast:8 row_mask:0xf bank_mask:0xf
    v_mul_f32_dpp v228, v60, v28 row_newbcast:8 row_mask:0xf bank_mask:0xf
    v_mfma_f32_16x16x32_bf16 v[184:187], a[40:43], v[168:171], v[184:187]
    v_mul_f32_dpp v229, v61, v29 row_newbcast:8 row_mask:0xf bank_mask:0xf
    v_mul_f32_dpp v230, v62, v30 row_newbcast:8 row_mask:0xf bank_mask:0xf
    v_mfma_f32_16x16x32_bf16 v[184:187], a[44:47], v[172:175], v[184:187]
    v_mul_f32_dpp v231, v63, v31 row_newbcast:8 row_mask:0xf bank_mask:0xf
    v_cvt_pk_bf16_f32 v208, |v176|, |v177|
    v_smfmac_f32_16x16x64_bf16 v[240:243], a[188:191], v[168:175], v1
    v_cvt_pk_bf16_f32 v209, |v178|, |v179|
    v_mfma_f32_16x16x32_bf16 v[188:191], a[60:63], v[172:175], v[124:127]
    v_cvt_pk_bf16_f32 v148, v224, v225
    v_cvt_pk_bf16_f32 v149, v226, v227
    v_mfma_f32_16x16x32_bf16 v[188:191], a[56:59], v[168:171], v[188:191]
    v_cvt_pk_bf16_f32 v150, v228, v229
    v_cvt_pk_bf16_f32 v151, v230, v231
    v_mfma_f32_16x16x32_bf16 v[188:191], a[52:55], v[164:167], v[188:191]
    v_mul_f32_dpp v224, v64, v32 row_newbcast:8 row_mask:0xf bank_mask:0xf
    v_mul_f32_dpp v225, v65, v33 row_newbcast:8 row_mask:0xf bank_mask:0xf
    v_mfma_f32_16x16x32_bf16 v[188:191], a[48:51], v[160:163], v[188:191]
    v_mul_f32_dpp v226, v66, v34 row_newbcast:8 row_mask:0xf bank_mask:0xf
    v_mul_f32_dpp v227, v67, v35 row_newbcast:8 row_mask:0xf bank_mask:0xf
    v_smfmac_f32_16x16x64_bf16 v[244:247], a[136:139], v[144:151], v1
    v_mul_f32_dpp v228, v68, v36 row_newbcast:8 row_mask:0xf bank_mask:0xf
    v_mfma_f32_16x16x32_bf16 v[192:195], a[64:67], v[160:163], v[128:131]
    v_mul_f32_dpp v229, v69, v37 row_newbcast:8 row_mask:0xf bank_mask:0xf
    v_mul_f32_dpp v230, v70, v38 row_newbcast:8 row_mask:0xf bank_mask:0xf
    v_mfma_f32_16x16x32_bf16 v[192:195], a[68:71], v[164:167], v[192:195]
    v_mul_f32_dpp v231, v71, v39 row_newbcast:8 row_mask:0xf bank_mask:0xf
    v_cvt_pk_bf16_f32 v152, v224, v225
    v_mfma_f32_16x16x32_bf16 v[192:195], a[72:75], v[168:171], v[192:195]
    v_cvt_pk_bf16_f32 v153, v226, v227
    v_cvt_pk_bf16_f32 v154, v228, v229
    v_mfma_f32_16x16x32_bf16 v[192:195], a[76:79], v[172:175], v[192:195]
    v_cvt_pk_bf16_f32 v155, v230, v231
    v_mul_f32_dpp v224, v72, v40 row_newbcast:8 row_mask:0xf bank_mask:0xf
    v_mfma_f32_16x16x32_bf16 v[196:199], a[92:95], v[172:175], v[132:135]
    v_mul_f32_dpp v225, v73, v41 row_newbcast:8 row_mask:0xf bank_mask:0xf
    v_mul_f32_dpp v226, v74, v42 row_newbcast:8 row_mask:0xf bank_mask:0xf
    v_mfma_f32_16x16x32_bf16 v[196:199], a[88:91], v[168:171], v[196:199]
    v_mul_f32_dpp v227, v75, v43 row_newbcast:8 row_mask:0xf bank_mask:0xf
    v_mul_f32_dpp v228, v76, v44 row_newbcast:8 row_mask:0xf bank_mask:0xf
    v_mfma_f32_16x16x32_bf16 v[196:199], a[84:87], v[164:167], v[196:199]
    v_mul_f32_dpp v229, v77, v45 row_newbcast:8 row_mask:0xf bank_mask:0xf
    v_mul_f32_dpp v230, v78, v46 row_newbcast:8 row_mask:0xf bank_mask:0xf
    v_mfma_f32_16x16x32_bf16 v[196:199], a[80:83], v[160:163], v[196:199]
    v_mul_f32_dpp v231, v79, v47 row_newbcast:8 row_mask:0xf bank_mask:0xf
    v_cvt_pk_bf16_f32 v156, v224, v225
    v_mfma_f32_16x16x32_bf16 v[200:203], a[96:99], v[160:163], v[136:139]
    v_cvt_pk_bf16_f32 v157, v226, v227
    v_cvt_pk_bf16_f32 v158, v228, v229
    v_mfma_f32_16x16x32_bf16 v[200:203], a[100:103], v[164:167], v[200:203]
    v_cvt_pk_bf16_f32 v159, v230, v231
    v_cvt_pk_bf16_f32 v210, |v180|, |v181|
    v_mfma_f32_16x16x32_bf16 v[200:203], a[104:107], v[168:171], v[200:203]
    v_cvt_pk_bf16_f32 v211, |v182|, |v183|
    v_cvt_pk_bf16_f32 v212, |v184|, |v185|
    v_mfma_f32_16x16x32_bf16 v[200:203], a[108:111], v[172:175], v[200:203]
    v_cvt_pk_bf16_f32 v213, |v186|, |v187|
    v_cvt_pk_bf16_f32 v214, |v188|, |v189|
    v_smfmac_f32_16x16x64_bf16 v[244:247], a[140:143], v[152:159], v1
    v_cvt_pk_bf16_f32 v215, |v190|, |v191|
    v_mfma_f32_16x16x32_bf16 v[204:207], a[124:127], v[172:175], v[140:143]
    v_cvt_pk_bf16_f32 v216, |v192|, |v193|
    v_cvt_pk_bf16_f32 v217, |v194|, |v195|
    v_mfma_f32_16x16x32_bf16 v[204:207], a[120:123], v[168:171], v[204:207]
    v_cvt_pk_bf16_f32 v218, |v196|, |v197|
    v_cvt_pk_bf16_f32 v219, |v198|, |v199|
    v_mfma_f32_16x16x32_bf16 v[204:207], a[116:119], v[164:167], v[204:207]
    v_cvt_pk_bf16_f32 v220, |v200|, |v201|
    v_cvt_pk_bf16_f32 v221, |v202|, |v203|
    v_mfma_f32_16x16x32_bf16 v[204:207], a[112:115], v[160:163], v[204:207]
    v_mul_f32_dpp v224, v48, v16 row_newbcast:0 row_mask:0xf bank_mask:0xf
    v_mul_f32_dpp v225, v49, v17 row_newbcast:0 row_mask:0xf bank_mask:0xf
    v_smfmac_f32_16x16x64_bf16 v[240:243], a[176:179], v[208:215], v1
    v_mul_f32_dpp v226, v50, v18 row_newbcast:0 row_mask:0xf bank_mask:0xf
    v_mfma_f32_16x16x32_bf16 v[176:179], a[0:3], v[144:147], v[112:115]
    v_mul_f32_dpp v227, v51, v19 row_newbcast:0 row_mask:0xf bank_mask:0xf
    v_mul_f32_dpp v228, v52, v20 row_newbcast:0 row_mask:0xf bank_mask:0xf
    v_mfma_f32_16x16x32_bf16 v[176:179], a[4:7], v[148:151], v[176:179]
    v_cvt_pk_bf16_f32 v222, |v204|, |v205|
    v_cvt_pk_bf16_f32 v223, |v206|, |v207|
    v_mfma_f32_16x16x32_bf16 v[176:179], a[8:11], v[152:155], v[176:179]
    v_mul_f32_dpp v229, v53, v21 row_newbcast:0 row_mask:0xf bank_mask:0xf
    v_mul_f32_dpp v230, v54, v22 row_newbcast:0 row_mask:0xf bank_mask:0xf
    v_mfma_f32_16x16x32_bf16 v[176:179], a[12:15], v[156:159], v[176:179]
    v_mul_f32_dpp v231, v55, v23 row_newbcast:0 row_mask:0xf bank_mask:0xf
    v_cvt_pk_bf16_f32 v160, v224, v225
    v_smfmac_f32_16x16x64_bf16 v[240:243], a[180:183], v[216:223], v1
    v_cvt_pk_bf16_f32 v161, v226, v227
    v_mfma_f32_16x16x32_bf16 v[180:183], a[28:31], v[156:159], v[116:119]
    v_cvt_pk_bf16_f32 v162, v228, v229
    v_cvt_pk_bf16_f32 v163, v230, v231
    v_mfma_f32_16x16x32_bf16 v[180:183], a[24:27], v[152:155], v[180:183]
    v_mul_f32_dpp v224, v56, v24 row_newbcast:0 row_mask:0xf bank_mask:0xf
    v_mul_f32_dpp v225, v57, v25 row_newbcast:0 row_mask:0xf bank_mask:0xf
    v_mfma_f32_16x16x32_bf16 v[180:183], a[20:23], v[148:151], v[180:183]
    v_mul_f32_dpp v226, v58, v26 row_newbcast:0 row_mask:0xf bank_mask:0xf
    v_mul_f32_dpp v227, v59, v27 row_newbcast:0 row_mask:0xf bank_mask:0xf
    v_mfma_f32_16x16x32_bf16 v[180:183], a[16:19], v[144:147], v[180:183]
    v_mul_f32_dpp v228, v60, v28 row_newbcast:0 row_mask:0xf bank_mask:0xf
    v_mul_f32_dpp v229, v61, v29 row_newbcast:0 row_mask:0xf bank_mask:0xf
    v_mfma_f32_16x16x32_bf16 v[184:187], a[32:35], v[144:147], v[120:123]
    v_mul_f32_dpp v230, v62, v30 row_newbcast:0 row_mask:0xf bank_mask:0xf
    v_mul_f32_dpp v231, v63, v31 row_newbcast:0 row_mask:0xf bank_mask:0xf
    v_mfma_f32_16x16x32_bf16 v[184:187], a[36:39], v[148:151], v[184:187]
    v_cvt_pk_bf16_f32 v208, |v176|, |v177|
    v_cvt_pk_bf16_f32 v209, |v178|, |v179|
    v_mfma_f32_16x16x32_bf16 v[184:187], a[40:43], v[152:155], v[184:187]
    v_cvt_pk_bf16_f32 v164, v224, v225
    v_cvt_pk_bf16_f32 v165, v226, v227
    v_mfma_f32_16x16x32_bf16 v[184:187], a[44:47], v[156:159], v[184:187]
    v_cvt_pk_bf16_f32 v166, v228, v229
    v_cvt_pk_bf16_f32 v167, v230, v231
    v_mfma_f32_16x16x32_bf16 v[188:191], a[60:63], v[156:159], v[124:127]
    v_mul_f32_dpp v224, v64, v32 row_newbcast:0 row_mask:0xf bank_mask:0xf
    v_mul_f32_dpp v225, v65, v33 row_newbcast:0 row_mask:0xf bank_mask:0xf
    v_mfma_f32_16x16x32_bf16 v[188:191], a[56:59], v[152:155], v[188:191]
    v_mul_f32_dpp v226, v66, v34 row_newbcast:0 row_mask:0xf bank_mask:0xf
    v_mul_f32_dpp v227, v67, v35 row_newbcast:0 row_mask:0xf bank_mask:0xf
    v_mfma_f32_16x16x32_bf16 v[188:191], a[52:55], v[148:151], v[188:191]
    v_mul_f32_dpp v228, v68, v36 row_newbcast:0 row_mask:0xf bank_mask:0xf
    v_mul_f32_dpp v229, v69, v37 row_newbcast:0 row_mask:0xf bank_mask:0xf
    v_mfma_f32_16x16x32_bf16 v[188:191], a[48:51], v[144:147], v[188:191]
    v_mul_f32_dpp v230, v70, v38 row_newbcast:0 row_mask:0xf bank_mask:0xf
    v_mul_f32_dpp v231, v71, v39 row_newbcast:0 row_mask:0xf bank_mask:0xf
    v_mfma_f32_16x16x32_bf16 v[192:195], a[64:67], v[144:147], v[128:131]
    v_cvt_pk_bf16_f32 v168, v224, v225
    v_cvt_pk_bf16_f32 v169, v226, v227
    v_mfma_f32_16x16x32_bf16 v[192:195], a[68:71], v[148:151], v[192:195]
    v_cvt_pk_bf16_f32 v170, v228, v229
    v_cvt_pk_bf16_f32 v171, v230, v231
    v_mfma_f32_16x16x32_bf16 v[192:195], a[72:75], v[152:155], v[192:195]
    v_mul_f32_dpp v224, v72, v40 row_newbcast:0 row_mask:0xf bank_mask:0xf
    v_mul_f32_dpp v225, v73, v41 row_newbcast:0 row_mask:0xf bank_mask:0xf
    v_mfma_f32_16x16x32_bf16 v[192:195], a[76:79], v[156:159], v[192:195]
    v_mul_f32_dpp v226, v74, v42 row_newbcast:0 row_mask:0xf bank_mask:0xf
    v_mul_f32_dpp v227, v75, v43 row_newbcast:0 row_mask:0xf bank_mask:0xf
    v_mfma_f32_16x16x32_bf16 v[196:199], a[92:95], v[156:159], v[132:135]
    v_mul_f32_dpp v228, v76, v44 row_newbcast:0 row_mask:0xf bank_mask:0xf
    v_mul_f32_dpp v229, v77, v45 row_newbcast:0 row_mask:0xf bank_mask:0xf
    v_mfma_f32_16x16x32_bf16 v[196:199], a[88:91], v[152:155], v[196:199]
    v_mul_f32_dpp v230, v78, v46 row_newbcast:0 row_mask:0xf bank_mask:0xf
    v_mul_f32_dpp v231, v79, v47 row_newbcast:0 row_mask:0xf bank_mask:0xf
    v_mfma_f32_16x16x32_bf16 v[196:199], a[84:87], v[148:151], v[196:199]
    v_cvt_pk_bf16_f32 v172, v224, v225
    v_cvt_pk_bf16_f32 v173, v226, v227
    v_mfma_f32_16x16x32_bf16 v[196:199], a[80:83], v[144:147], v[196:199]
    v_cvt_pk_bf16_f32 v174, v228, v229
    v_cvt_pk_bf16_f32 v175, v230, v231
    v_mfma_f32_16x16x32_bf16 v[200:203], a[96:99], v[144:147], v[136:139]
    v_cvt_pk_bf16_f32 v210, |v180|, |v181|
    v_cvt_pk_bf16_f32 v211, |v182|, |v183|
    v_mfma_f32_16x16x32_bf16 v[200:203], a[100:103], v[148:151], v[200:203]
    v_cvt_pk_bf16_f32 v212, |v184|, |v185|
    v_cvt_pk_bf16_f32 v213, |v186|, |v187|
    v_mfma_f32_16x16x32_bf16 v[200:203], a[104:107], v[152:155], v[200:203]
    v_cvt_pk_bf16_f32 v214, |v188|, |v189|
    v_cvt_pk_bf16_f32 v215, |v190|, |v191|
    v_mfma_f32_16x16x32_bf16 v[200:203], a[108:111], v[156:159], v[200:203]
L_stub2:
    s_cbranch_scc1 L_main2
    v_cvt_pk_bf16_f32 v216, |v192|, |v193|
    v_cvt_pk_bf16_f32 v217, |v194|, |v195|
    v_smfmac_f32_16x16x64_bf16 v[244:247], a[128:131], v[208:215], v1
    v_cvt_pk_bf16_f32 v218, |v196|, |v197|
    v_mfma_f32_16x16x32_bf16 v[204:207], a[124:127], v[156:159], v[140:143]
    v_cvt_pk_bf16_f32 v219, |v198|, |v199|
    v_mul_f32_dpp v224, v48, v16 row_newbcast:1 row_mask:0xf bank_mask:0xf
    v_mfma_f32_16x16x32_bf16 v[204:207], a[120:123], v[152:155], v[204:207]
    v_cvt_pk_bf16_f32 v220, |v200|, |v201|
    v_cvt_pk_bf16_f32 v221, |v202|, |v203|
    v_mfma_f32_16x16x32_bf16 v[204:207], a[116:119], v[148:151], v[204:207]
    v_mul_f32_dpp v225, v49, v17 row_newbcast:1 row_mask:0xf bank_mask:0xf
    v_mul_f32_dpp v226, v50, v18 row_newbcast:1 row_mask:0xf bank_mask:0xf
    v_mfma_f32_16x16x32_bf16 v[204:207], a[112:115], v[144:147], v[204:207]
    v_mul_f32_dpp v227, v51, v19 row_newbcast:1 row_mask:0xf bank_mask:0xf
    v_mul_f32_dpp v228, v52, v20 row_newbcast:1 row_mask:0xf bank_mask:0xf
    v_mfma_f32_16x16x32_bf16 v[176:179], a[0:3], v[160:163], v[112:115]
    v_mul_f32_dpp v229, v53, v21 row_newbcast:1 row_mask:0xf bank_mask:0xf
    v_mul_f32_dpp v230, v54, v22 row_newbcast:1 row_mask:0xf bank_mask:0xf
    v_mfma_f32_16x16x32_bf16 v[176:179], a[4:7], v[164:167], v[176:179]
    v_mul_f32_dpp v231, v55, v23 row_newbcast:1 row_mask:0xf bank_mask:0xf
    v_cvt_pk_bf16_f32 v144, v224, v225
    v_mfma_f32_16x16x32_bf16 v[176:179], a[8:11], v[168:171], v[176:179]
    v_cvt_pk_bf16_f32 v222, |v204|, |v205|
    v_cvt_pk_bf16_f32 v223, |v206|, |v207|
    v_mfma_f32_16x16x32_bf16 v[176:179], a[12:15], v[172:175], v[176:179]
    v_cvt_pk_bf16_f32 v145, v226, v227
    v_cvt_pk_bf16_f32 v146, v228, v229
    v_smfmac_f32_16x16x64_bf16 v[244:247], a[132:135], v[216:223], v1
    v_cvt_pk_bf16_f32 v147, v230, v231
    v_mfma_f32_16x16x32_bf16 v[180:183], a[28:31], v[172:175], v[116:119]
    v_mul_f32_dpp v224, v56, v24 row_newbcast:1 row_mask:0xf bank_mask:0xf
    v_mul_f32_dpp v225, v57, v25 row_newbcast:1 row_mask:0xf bank_mask:0xf
    v_mfma_f32_16x16x32_bf16 v[180:183], a[24:27], v[168:171], v[180:183]
    v_mul_f32_dpp v226, v58, v26 row_newbcast:1 row_mask:0xf bank_mask:0xf
    v_mul_f32_dpp v227, v59, v27 row_newbcast:1 row_mask:0xf bank_mask:0xf
    v_mfma_f32_16x16x32_bf16 v[180:183], a[20:23], v[164:167], v[180:183]
    v_mul_f32_dpp v228, v60, v28 row_newbcast:1 row_mask:0xf bank_mask:0xf
    v_mul_f32_dpp v229, v61, v29 row_newbcast:1 row_mask:0xf bank_mask:0xf
    v_mfma_f32_16x16x32_bf16 v[180:183], a[16:19], v[160:163], v[180:183]
    v_mul_f32_dpp v230, v62, v30 row_newbcast:1 row_mask:0xf bank_mask:0xf
    v_mul_f32_dpp v231, v63, v31 row_newbcast:1 row_mask:0xf bank_mask:0xf
    v_smfmac_f32_16x16x64_bf16 v[244:247], a[152:155], v[160:167], v1
    v_cvt_pk_bf16_f32 v208, |v176|, |v177|
    v_mfma_f32_16x16x32_bf16 v[184:187], a[32:35], v[160:163], v[120:123]
    v_cvt_pk_bf16_f32 v209, |v178|, |v179|
    v_cvt_pk_bf16_f32 v148, v224, v225
    v_mfma_f32_16x16x32_bf16 v[184:187], a[36:39], v[164:167], v[184:187]
    v_cvt_pk_bf16_f32 v149, v226, v227
    v_cvt_pk_bf16_f32 v150, v228, v229
    v_mfma_f32_16x16x32_bf16 v[184:187], a[40:43], v[168:171], v[184:187]
    v_cvt_pk_bf16_f32 v151, v230, v231
    v_mul_f32_dpp v224, v64, v32 row_newbcast:1 row_mask:0xf bank_mask:0xf
    v_mfma_f32_16x16x32_bf16 v[184:187], a[44:47], v[172:175], v[184:187]
    v_mul_f32_dpp v225, v65, v33 row_newbcast:1 row_mask:0xf bank_mask:0xf
    v_mul_f32_dpp v226, v66, v34 row_newbcast:1 row_mask:0xf bank_mask:0xf
    v_smfmac_f32_16x16x64_bf16 v[244:247], a[156:159], v[168:175], v1
    v_mul_f32_dpp v227, v67, v35 row_newbcast:1 row_mask:0xf bank_mask:0xf
    v_mfma_f32_16x16x32_bf16 v[188:191], a[60:63], v[172:175], v[124:127]
    v_mul_f32_dpp v228, v68, v36 row_newbcast:1 row_mask:0xf bank_mask:0xf
    v_mul_f32_dpp v229, v69, v37 row_newbcast:1 row_mask:0xf bank_mask:0xf
    v_mfma_f32_16x16x32_bf16 v[188:191], a[56:59], v[168:171], v[188:191]
    v_mul_f32_dpp v230, v70, v38 row_newbcast:1 row_mask:0xf bank_mask:0xf
    v_mul_f32_dpp v231, v71, v39 row_newbcast:1 row_mask:0xf bank_mask:0xf
    v_mfma_f32_16x16x32_bf16 v[188:191], a[52:55], v[164:167], v[188:191]
    v_cvt_pk_bf16_f32 v152, v224, v225
    v_cvt_pk_bf16_f32 v153, v226, v227
    v_mfma_f32_16x16x32_bf16 v[188:191], a[48:51], v[160:163], v[188:191]
    v_cvt_pk_bf16_f32 v154, v228, v229
    v_cvt_pk_bf16_f32 v155, v230, v231
    v_mfma_f32_16x16x32_bf16 v[192:195], a[64:67], v[160:163], v[128:131]
    v_mul_f32_dpp v224, v72, v40 row_newbcast:1 row_mask:0xf bank_mask:0xf
    v_mul_f32_dpp v225, v73, v41 row_newbcast:1 row_mask:0xf bank_mask:0xf
    v_mfma_f32_16x16x32_bf16 v[192:195], a[68:71], v[164:167], v[192:195]
    v_mul_f32_dpp v226, v74, v42 row_newbcast:1 row_mask:0xf bank_mask:0xf
    v_mul_f32_dpp v227, v75, v43 row_newbcast:1 row_mask:0xf bank_mask:0xf
    v_mfma_f32_16x16x32_bf16 v[192:195], a[72:75], v[168:171], v[192:195]
    v_mul_f32_dpp v228, v76, v44 row_newbcast:1 row_mask:0xf bank_mask:0xf
    v_mul_f32_dpp v229, v77, v45 row_newbcast:1 row_mask:0xf bank_mask:0xf
    v_mfma_f32_16x16x32_bf16 v[192:195], a[76:79], v[172:175], v[192:195]
    v_mul_f32_dpp v230, v78, v46 row_newbcast:1 row_mask:0xf bank_mask:0xf
    v_mul_f32_dpp v231, v79, v47 row_newbcast:1 row_mask:0xf bank_mask:0xf
    v_mfma_f32_16x16x32_bf16 v[196:199], a[92:95], v[172:175], v[132:135]
    v_cvt_pk_bf16_f32 v156, v224, v225
    v_cvt_pk_bf16_f32 v157, v226, v227
    v_mfma_f32_16x16x32_bf16 v[196:199], a[88:91], v[168:171], v[196:199]
    v_cvt_pk_bf16_f32 v158, v228, v229
    v_cvt_pk_bf16_f32 v159, v230, v231
    v_mfma_f32_16x16x32_bf16 v[196:199], a[84:87], v[164:167], v[196:199]
    v_cvt_pk_bf16_f32 v210, |v180|, |v181|
    v_cvt_pk_bf16_f32 v211, |v182|, |v183|
    v_mfma_f32_16x16x32_bf16 v[196:199], a[80:83], v[160:163], v[196:199]
    v_cvt_pk_bf16_f32 v212, |v184|, |v185|
    v_cvt_pk_bf16_f32 v213, |v186|, |v187|
    v_mfma_f32_16x16x32_bf16 v[200:203], a[96:99], v[160:163], v[136:139]
    v_cvt_pk_bf16_f32 v214, |v188|, |v189|
    v_cvt_pk_bf16_f32 v215, |v190|, |v191|
    v_mfma_f32_16x16x32_bf16 v[200:203], a[100:103], v[164:167], v[200:203]
    v_cvt_pk_bf16_f32 v216, |v192|, |v193|
    v_cvt_pk_bf16_f32 v217, |v194|, |v195|
    v_mfma_f32_16x16x32_bf16 v[200:203], a[104:107], v[168:171], v[200:203]
    v_cvt_pk_bf16_f32 v218, |v196|, |v197|
    v_cvt_pk_bf16_f32 v219, |v198|, |v199|
    v_mfma_f32_16x16x32_bf16 v[200:203], a[108:111], v[172:175], v[200:203]
    v_mul_f32_dpp v224, v48, v16 row_newbcast:6 row_mask:0xf bank_mask:0xf
    v_mul_f32_dpp v225, v49, v17 row_newbcast:6 row_mask:0xf bank_mask:0xf
    v_smfmac_f32_16x16x64_bf16 v[244:247], a[144:147], v[208:215], v1
    v_mul_f32_dpp v226, v50, v18 row_newbcast:6 row_mask:0xf bank_mask:0xf
    v_mfma_f32_16x16x32_bf16 v[204:207], a[124:127], v[172:175], v[140:143]
    v_mul_f32_dpp v227, v51, v19 row_newbcast:6 row_mask:0xf bank_mask:0xf
    v_mul_f32_dpp v228, v52, v20 row_newbcast:6 row_mask:0xf bank_mask:0xf
    v_mfma_f32_16x16x32_bf16 v[204:207], a[120:123], v[168:171], v[204:207]
    v_cvt_pk_bf16_f32 v220, |v200|, |v201|
    v_cvt_pk_bf16_f32 v221, |v202|, |v203|
    v_mfma_f32_16x16x32_bf16 v[204:207], a[116:119], v[164:167], v[204:207]
    v_mul_f32_dpp v229, v53, v21 row_newbcast:6 row_mask:0xf bank_mask:0xf
    v_mul_f32_dpp v230, v54, v22 row_newbcast:6 row_mask:0xf bank_mask:0xf
    v_mfma_f32_16x16x32_bf16 v[204:207], a[112:115], v[160:163], v[204:207]
    v_mul_f32_dpp v231, v55, v23 row_newbcast:6 row_mask:0xf bank_mask:0xf
    v_cvt_pk_bf16_f32 v160, v224, v225
    v_mfma_f32_16x16x32_bf16 v[176:179], a[0:3], v[144:147], v[112:115]
    v_cvt_pk_bf16_f32 v161, v226, v227
    v_cvt_pk_bf16_f32 v162, v228, v229
    v_mfma_f32_16x16x32_bf16 v[176:179], a[4:7], v[148:151], v[176:179]
    v_cvt_pk_bf16_f32 v163, v230, v231
    v_mul_f32_dpp v224, v56, v24 row_newbcast:6 row_mask:0xf bank_mask:0xf
    v_mfma_f32_16x16x32_bf16 v[176:179], a[8:11], v[152:155], v[176:179]
    v_cvt_pk_bf16_f32 v222, |v204|, |v205|
    v_cvt_pk_bf16_f32 v223, |v206|, |v207|
    v_mfma_f32_16x16x32_bf16 v[176:179], a[12:15], v[156:159], v[176:179]
    v_mul_f32_dpp v225, v57, v25 row_newbcast:6 row_mask:0xf bank_mask:0xf
    v_mul_f32_dpp v226, v58, v26 row_newbcast:6 row_mask:0xf bank_mask:0xf
    v_smfmac_f32_16x16x64_bf16 v[244:247], a[148:151], v[216:223], v1
    v_mul_f32_dpp v227, v59, v27 row_newbcast:6 row_mask:0xf bank_mask:0xf
    v_mfma_f32_16x16x32_bf16 v[180:183], a[28:31], v[156:159], v[116:119]
    v_mul_f32_dpp v228, v60, v28 row_newbcast:6 row_mask:0xf bank_mask:0xf
    v_mul_f32_dpp v229, v61, v29 row_newbcast:6 row_mask:0xf bank_mask:0xf
    v_mfma_f32_16x16x32_bf16 v[180:183], a[24:27], v[152:155], v[180:183]
    v_mul_f32_dpp v230, v62, v30 row_newbcast:6 row_mask:0xf bank_mask:0xf
    v_mul_f32_dpp v231, v63, v31 row_newbcast:6 row_mask:0xf bank_mask:0xf
    v_mfma_f32_16x16x32_bf16 v[180:183], a[20:23], v[148:151], v[180:183]
    v_cvt_pk_bf16_f32 v208, |v176|, |v177|
    v_cvt_pk_bf16_f32 v209, |v178|, |v179|
    v_mfma_f32_16x16x32_bf16 v[180:183], a[16:19], v[144:147], v[180:183]
    v_cvt_pk_bf16_f32 v164, v224, v225
    v_cvt_pk_bf16_f32 v165, v226, v227
    v_smfmac_f32_16x16x64_bf16 v[244:247], a[168:171], v[144:151], v1
    v_cvt_pk_bf16_f32 v166, v228, v229
    v_mfma_f32_16x16x32_bf16 v[184:187], a[32:35], v[144:147], v[120:123]
    v_cvt_pk_bf16_f32 v167, v230, v231
    v_mul_f32_dpp v224, v64, v32 row_newbcast:6 row_mask:0xf bank_mask:0xf
    v_mfma_f32_16x16x32_bf16 v[184:187], a[36:39], v[148:151], v[184:187]
    v_mul_f32_dpp v225, v65, v33 row_newbcast:6 row_mask:0xf bank_mask:0xf
    v_mul_f32_dpp v226, v66, v34 row_newbcast:6 row_mask:0xf bank_mask:0xf
    v_mfma_f32_16x16x32_bf16 v[184:187], a[40:43], v[152:155], v[184:187]
    v_mul_f32_dpp v227, v67, v35 row_newbcast:6 row_mask:0xf bank_mask:0xf
    v_mul_f32_dpp v228, v68, v36 row_newbcast:6 row_mask:0xf bank_mask:0xf
    v_mfma_f32_16x16x32_bf16 v[184:187], a[44:47], v[156:159], v[184:187]
    v_mul_f32_dpp v229, v69, v37 row_newbcast:6 row_mask:0xf bank_mask:0xf
    v_mul_f32_dpp v230, v70, v38 row_newbcast:6 row_mask:0xf bank_mask:0xf
    v_smfmac_f32_16x16x64_bf16 v[244:247], a[172:175], v[152:159], v1
    v_mul_f32_dpp v231, v71, v39 row_newbcast:6 row_mask:0xf bank_mask:0xf
    v_mfma_f32_16x16x32_bf16 v[188:191], a[60:63], v[156:159], v[124:127]
    v_cvt_pk_bf16_f32 v168, v224, v225
    v_cvt_pk_bf16_f32 v169, v226, v227
    v_mfma_f32_16x16x32_bf16 v[188:191], a[56:59], v[152:155], v[188:191]
    v_cvt_pk_bf16_f32 v170, v228, v229
    v_cvt_pk_bf16_f32 v171, v230, v231
    v_mfma_f32_16x16x32_bf16 v[188:191], a[52:55], v[148:151], v[188:191]
    v_mul_f32_dpp v224, v72, v40 row_newbcast:6 row_mask:0xf bank_mask:0xf
    v_mul_f32_dpp v225, v73, v41 row_newbcast:6 row_mask:0xf bank_mask:0xf
    v_mfma_f32_16x16x32_bf16 v[188:191], a[48:51], v[144:147], v[188:191]
    v_mul_f32_dpp v226, v74, v42 row_newbcast:6 row_mask:0xf bank_mask:0xf
    v_mul_f32_dpp v227, v75, v43 row_newbcast:6 row_mask:0xf bank_mask:0xf
    v_mfma_f32_16x16x32_bf16 v[192:195], a[64:67], v[144:147], v[128:131]
    v_mul_f32_dpp v228, v76, v44 row_newbcast:6 row_mask:0xf bank_mask:0xf
    v_mul_f32_dpp v229, v77, v45 row_newbcast:6 row_mask:0xf bank_mask:0xf
    v_mfma_f32_16x16x32_bf16 v[192:195], a[68:71], v[148:151], v[192:195]
    v_mul_f32_dpp v230, v78, v46 row_newbcast:6 row_mask:0xf bank_mask:0xf
    v_mul_f32_dpp v231, v79, v47 row_newbcast:6 row_mask:0xf bank_mask:0xf
    v_mfma_f32_16x16x32_bf16 v[192:195], a[72:75], v[152:155], v[192:195]
    v_cvt_pk_bf16_f32 v172, v224, v225
    v_cvt_pk_bf16_f32 v173, v226, v227
    v_mfma_f32_16x16x32_bf16 v[192:195], a[76:79], v[156:159], v[192:195]
    v_cvt_pk_bf16_f32 v174, v228, v229
    v_cvt_pk_bf16_f32 v175, v230, v231
    v_mfma_f32_16x16x32_bf16 v[196:199], a[92:95], v[156:159], v[132:135]
    v_cvt_pk_bf16_f32 v210, |v180|, |v181|
    v_cvt_pk_bf16_f32 v211, |v182|, |v183|
    v_mfma_f32_16x16x32_bf16 v[196:199], a[88:91], v[152:155], v[196:199]
    v_cvt_pk_bf16_f32 v212, |v184|, |v185|
    v_cvt_pk_bf16_f32 v213, |v186|, |v187|
    v_mfma_f32_16x16x32_bf16 v[196:199], a[84:87], v[148:151], v[196:199]
    v_cvt_pk_bf16_f32 v214, |v188|, |v189|
    v_cvt_pk_bf16_f32 v215, |v190|, |v191|
    v_mfma_f32_16x16x32_bf16 v[196:199], a[80:83], v[144:147], v[196:199]
    v_cvt_pk_bf16_f32 v216, |v192|, |v193|
    v_cvt_pk_bf16_f32 v217, |v194|, |v195|
    v_smfmac_f32_16x16x64_bf16 v[244:247], a[160:163], v[208:215], v1
    v_mul_f32_dpp v224, v48, v16 row_newbcast:4 row_mask:0xf bank_mask:0xf
    v_mfma_f32_16x16x32_bf16 v[200:203], a[96:99], v[144:147], v[136:139]
    v_mul_f32_dpp v225, v49, v17 row_newbcast:4 row_mask:0xf bank_mask:0xf
    v_mul_f32_dpp v226, v50, v18 row_newbcast:4 row_mask:0xf bank_mask:0xf
    v_mfma_f32_16x16x32_bf16 v[200:203], a[100:103], v[148:151], v[200:203]
    v_cvt_pk_bf16_f32 v218, |v196|, |v197|
    v_cvt_pk_bf16_f32 v219, |v198|, |v199|
    v_mfma_f32_16x16x32_bf16 v[200:203], a[104:107], v[152:155], v[200:203]
    v_mul_f32_dpp v227, v51, v19 row_newbcast:4 row_mask:0xf bank_mask:0xf
    v_mul_f32_dpp v228, v52, v20 row_newbcast:4 row_mask:0xf bank_mask:0xf
    v_mfma_f32_16x16x32_bf16 v[200:203], a[108:111], v[156:159], v[200:203]
    v_mul_f32_dpp v229, v53, v21 row_newbcast:4 row_mask:0xf bank_mask:0xf
    v_mul_f32_dpp v230, v54, v22 row_newbcast:4 row_mask:0xf bank_mask:0xf
    v_mfma_f32_16x16x32_bf16 v[204:207], a[124:127], v[156:159], v[140:143]
    v_mul_f32_dpp v231, v55, v23 row_newbcast:4 row_mask:0xf bank_mask:0xf
    v_lshlrev_b32 v80, 16, v96
    v_mfma_f32_16x16x32_bf16 v[204:207], a[120:123], v[152:155], v[204:207]
    v_and_b32 v81, 0xffff0000, v96
    v_lshlrev_b32 v82, 16, v97
    v_mfma_f32_16x16x32_bf16 v[204:207], a[116:119], v[148:151], v[204:207]
    v_cvt_pk_bf16_f32 v220, |v200|, |v201|
    v_cvt_pk_bf16_f32 v221, |v202|, |v203|
    v_mfma_f32_16x16x32_bf16 v[204:207], a[112:115], v[144:147], v[204:207]
    v_cvt_pk_bf16_f32 v144, v224, v225
    v_cvt_pk_bf16_f32 v145, v226, v227
    v_mfma_f32_16x16x32_bf16 v[176:179], a[0:3], v[160:163], v[112:115]
    v_cvt_pk_bf16_f32 v146, v228, v229
    v_cvt_pk_bf16_f32 v147, v230, v231
    v_mfma_f32_16x16x32_bf16 v[176:179], a[4:7], v[164:167], v[176:179]
    v_mul_f32_dpp v224, v56, v24 row_newbcast:4 row_mask:0xf bank_mask:0xf
    v_mul_f32_dpp v225, v57, v25 row_newbcast:4 row_mask:0xf bank_mask:0xf
    v_mfma_f32_16x16x32_bf16 v[176:179], a[8:11], v[168:171], v[176:179]
    v_cvt_pk_bf16_f32 v222, |v204|, |v205|
    v_cvt_pk_bf16_f32 v223, |v206|, |v207|
    v_mfma_f32_16x16x32_bf16 v[176:179], a[12:15], v[172:175], v[176:179]
    v_mul_f32_dpp v226, v58, v26 row_newbcast:4 row_mask:0xf bank_mask:0xf
    v_mul_f32_dpp v227, v59, v27 row_newbcast:4 row_mask:0xf bank_mask:0xf
    v_smfmac_f32_16x16x64_bf16 v[244:247], a[164:167], v[216:223], v1
    v_mul_f32_dpp v228, v60, v28 row_newbcast:4 row_mask:0xf bank_mask:0xf
    v_mfma_f32_16x16x32_bf16 v[180:183], a[28:31], v[172:175], v[116:119]
    v_mul_f32_dpp v229, v61, v29 row_newbcast:4 row_mask:0xf bank_mask:0xf
    v_mul_f32_dpp v230, v62, v30 row_newbcast:4 row_mask:0xf bank_mask:0xf
    v_mfma_f32_16x16x32_bf16 v[180:183], a[24:27], v[168:171], v[180:183]
    v_mul_f32_dpp v231, v63, v31 row_newbcast:4 row_mask:0xf bank_mask:0xf
    v_cvt_pk_bf16_f32 v208, |v176|, |v177|
    v_mfma_f32_16x16x32_bf16 v[180:183], a[20:23], v[164:167], v[180:183]
    v_cvt_pk_bf16_f32 v209, |v178|, |v179|
    v_cvt_pk_bf16_f32 v148, v224, v225
    v_mfma_f32_16x16x32_bf16 v[180:183], a[16:19], v[160:163], v[180:183]
    v_cvt_pk_bf16_f32 v149, v226, v227
    v_cvt_pk_bf16_f32 v150, v228, v229
    v_smfmac_f32_16x16x64_bf16 v[244:247], a[184:187], v[160:167], v1
    v_cvt_pk_bf16_f32 v151, v230, v231
    v_mfma_f32_16x16x32_bf16 v[184:187], a[32:35], v[160:163], v[120:123]
    v_mul_f32_dpp v224, v64, v32 row_newbcast:4 row_mask:0xf bank_mask:0xf
    v_mul_f32_dpp v225, v65, v33 row_newbcast:4 row_mask:0xf bank_mask:0xf
    v_mfma_f32_16x16x32_bf16 v[184:187], a[36:39], v[164:167], v[184:187]
    v_mul_f32_dpp v226, v66, v34 row_newbcast:4 row_mask:0xf bank_mask:0xf
    v_mul_f32_dpp v227, v67, v35 row_newbcast:4 row_mask:0xf bank_mask:0xf
    v_mfma_f32_16x16x32_bf16 v[184:187], a[40:43], v[168:171], v[184:187]
    v_mul_f32_dpp v228, v68, v36 row_newbcast:4 row_mask:0xf bank_mask:0xf
    v_mul_f32_dpp v229, v69, v37 row_newbcast:4 row_mask:0xf bank_mask:0xf
    v_mfma_f32_16x16x32_bf16 v[184:187], a[44:47], v[172:175], v[184:187]
    v_mul_f32_dpp v230, v70, v38 row_newbcast:4 row_mask:0xf bank_mask:0xf
    v_mul_f32_dpp v231, v71, v39 row_newbcast:4 row_mask:0xf bank_mask:0xf
    v_smfmac_f32_16x16x64_bf16 v[244:247], a[188:191], v[168:175], v1
    v_cvt_pk_bf16_f32 v152, v224, v225
    v_mfma_f32_16x16x32_bf16 v[188:191], a[60:63], v[172:175], v[124:127]
    v_cvt_pk_bf16_f32 v153, v226, v227
    v_cvt_pk_bf16_f32 v154, v228, v229
    v_mfma_f32_16x16x32_bf16 v[188:191], a[56:59], v[168:171], v[188:191]
    v_cvt_pk_bf16_f32 v155, v230, v231
    v_mul_f32_dpp v224, v72, v40 row_newbcast:4 row_mask:0xf bank_mask:0xf
    v_mfma_f32_16x16x32_bf16 v[188:191], a[52:55], v[164:167], v[188:191]
    v_mul_f32_dpp v225, v73, v41 row_newbcast:4 row_mask:0xf bank_mask:0xf
    v_mul_f32_dpp v226, v74, v42 row_newbcast:4 row_mask:0xf bank_mask:0xf
    v_mfma_f32_16x16x32_bf16 v[188:191], a[48:51], v[160:163], v[188:191]
    v_mul_f32_dpp v227, v75, v43 row_newbcast:4 row_mask:0xf bank_mask:0xf
    v_mul_f32_dpp v228, v76, v44 row_newbcast:4 row_mask:0xf bank_mask:0xf
    v_smfmac_f32_16x16x64_bf16 v[248:251], a[136:139], v[144:151], v1
    v_mul_f32_dpp v229, v77, v45 row_newbcast:4 row_mask:0xf bank_mask:0xf
    v_mfma_f32_16x16x32_bf16 v[192:195], a[64:67], v[160:163], v[128:131]
    v_mul_f32_dpp v230, v78, v46 row_newbcast:4 row_mask:0xf bank_mask:0xf
    v_mul_f32_dpp v231, v79, v47 row_newbcast:4 row_mask:0xf bank_mask:0xf
    v_mfma_f32_16x16x32_bf16 v[192:195], a[68:71], v[164:167], v[192:195]
    v_cvt_pk_bf16_f32 v156, v224, v225
    v_cvt_pk_bf16_f32 v157, v226, v227
    v_mfma_f32_16x16x32_bf16 v[192:195], a[72:75], v[168:171], v[192:195]
    v_cvt_pk_bf16_f32 v158, v228, v229
    v_cvt_pk_bf16_f32 v159, v230, v231
    v_mfma_f32_16x16x32_bf16 v[192:195], a[76:79], v[172:175], v[192:195]
    v_cvt_pk_bf16_f32 v210, |v180|, |v181|
    v_cvt_pk_bf16_f32 v211, |v182|, |v183|
    v_smfmac_f32_16x16x64_bf16 v[248:251], a[140:143], v[152:159], v1
    v_cvt_pk_bf16_f32 v212, |v184|, |v185|
    v_mfma_f32_16x16x32_bf16 v[196:199], a[92:95], v[172:175], v[132:135]
    v_cvt_pk_bf16_f32 v213, |v186|, |v187|
    v_cvt_pk_bf16_f32 v214, |v188|, |v189|
    v_mfma_f32_16x16x32_bf16 v[196:199], a[88:91], v[168:171], v[196:199]
    v_cvt_pk_bf16_f32 v215, |v190|, |v191|
    v_cvt_pk_bf16_f32 v216, |v192|, |v193|
    v_mfma_f32_16x16x32_bf16 v[196:199], a[84:87], v[164:167], v[196:199]
    v_cvt_pk_bf16_f32 v217, |v194|, |v195|
    v_and_b32 v83, 0xffff0000, v97
    v_mfma_f32_16x16x32_bf16 v[196:199], a[80:83], v[160:163], v[196:199]
    v_lshlrev_b32 v84, 16, v98
    v_and_b32 v85, 0xffff0000, v98
    v_smfmac_f32_16x16x64_bf16 v[244:247], a[176:179], v[208:215], v1
    v_lshlrev_b32 v86, 16, v99
    v_mfma_f32_16x16x32_bf16 v[200:203], a[96:99], v[160:163], v[136:139]
    v_and_b32 v87, 0xffff0000, v99
    v_lshlrev_b32 v88, 16, v100
    v_mfma_f32_16x16x32_bf16 v[200:203], a[100:103], v[164:167], v[200:203]
    v_cvt_pk_bf16_f32 v218, |v196|, |v197|
    v_cvt_pk_bf16_f32 v219, |v198|, |v199|
    v_mfma_f32_16x16x32_bf16 v[200:203], a[104:107], v[168:171], v[200:203]
    v_and_b32 v89, 0xffff0000, v100
    v_lshlrev_b32 v90, 16, v101
    v_mfma_f32_16x16x32_bf16 v[200:203], a[108:111], v[172:175], v[200:203]
    v_and_b32 v91, 0xffff0000, v101
    v_lshlrev_b32 v92, 16, v102
    v_mfma_f32_16x16x32_bf16 v[204:207], a[124:127], v[172:175], v[140:143]
    v_and_b32 v93, 0xffff0000, v102
    v_lshlrev_b32 v94, 16, v103
    v_mfma_f32_16x16x32_bf16 v[204:207], a[120:123], v[168:171], v[204:207]
    v_and_b32 v95, 0xffff0000, v103
    v_mul_f32_dpp v224, v80, v48 row_ror:13 row_mask:0xf bank_mask:0xf
    v_mfma_f32_16x16x32_bf16 v[204:207], a[116:119], v[164:167], v[204:207]
    v_cvt_pk_bf16_f32 v220, |v200|, |v201|
    v_cvt_pk_bf16_f32 v221, |v202|, |v203|
    v_mfma_f32_16x16x32_bf16 v[204:207], a[112:115], v[160:163], v[204:207]
    v_mul_f32_dpp v225, v81, v49 row_ror:13 row_mask:0xf bank_mask:0xf
    v_mul_f32_dpp v226, v82, v50 row_ror:13 row_mask:0xf bank_mask:0xf
    v_mfma_f32_16x16x32_bf16 v[176:179], a[0:3], v[144:147], v[112:115]
    v_mul_f32_dpp v227, v83, v51 row_ror:13 row_mask:0xf bank_mask:0xf
    v_mul_f32_dpp v228, v84, v52 row_ror:13 row_mask:0xf bank_mask:0xf
    v_mfma_f32_16x16x32_bf16 v[176:179], a[4:7], v[148:151], v[176:179]
    v_mul_f32_dpp v229, v85, v53 row_ror:13 row_mask:0xf bank_mask:0xf
    v_mul_f32_dpp v230, v86, v54 row_ror:13 row_mask:0xf bank_mask:0xf
    v_mfma_f32_16x16x32_bf16 v[176:179], a[8:11], v[152:155], v[176:179]
    v_cvt_pk_bf16_f32 v222, |v204|, |v205|
    v_cvt_pk_bf16_f32 v223, |v206|, |v207|
    v_mfma_f32_16x16x32_bf16 v[176:179], a[12:15], v[156:159], v[176:179]
    v_mul_f32_dpp v231, v87, v55 row_ror:13 row_mask:0xf bank_mask:0xf
    v_lshlrev_b32 v96, 16, v104
    v_smfmac_f32_16x16x64_bf16 v[244:247], a[180:183], v[216:223], v1
    v_and_b32 v97, 0xffff0000, v104
    v_mfma_f32_16x16x32_bf16 v[180:183], a[28:31], v[156:159], v[116:119]
    v_lshlrev_b32 v98, 16, v105
    v_and_b32 v99, 0xffff0000, v105
    v_mfma_f32_16x16x32_bf16 v[180:183], a[24:27], v[152:155], v[180:183]
    v_lshlrev_b32 v100, 16, v106
    v_and_b32 v101, 0xffff0000, v106
    v_mfma_f32_16x16x32_bf16 v[180:183], a[20:23], v[148:151], v[180:183]
    v_lshlrev_b32 v102, 16, v107
    v_and_b32 v103, 0xffff0000, v107
    v_mfma_f32_16x16x32_bf16 v[180:183], a[16:19], v[144:147], v[180:183]
    v_cvt_pk_bf16_f32 v160, v224, v225
    v_cvt_pk_bf16_f32 v161, v226, v227
    v_mfma_f32_16x16x32_bf16 v[184:187], a[32:35], v[144:147], v[120:123]
    v_cvt_pk_bf16_f32 v162, v228, v229
    v_cvt_pk_bf16_f32 v163, v230, v231
    v_mfma_f32_16x16x32_bf16 v[184:187], a[36:39], v[148:151], v[184:187]
    v_lshlrev_b32 v104, 16, v108
    v_and_b32 v105, 0xffff0000, v108
    v_mfma_f32_16x16x32_bf16 v[184:187], a[40:43], v[152:155], v[184:187]
    v_lshlrev_b32 v106, 16, v109
    v_and_b32 v107, 0xffff0000, v109
    v_mfma_f32_16x16x32_bf16 v[184:187], a[44:47], v[156:159], v[184:187]
    v_lshlrev_b32 v108, 16, v110
    v_and_b32 v109, 0xffff0000, v110
    v_mfma_f32_16x16x32_bf16 v[188:191], a[60:63], v[156:159], v[124:127]
    v_mul_f32_dpp v224, v88, v56 row_ror:13 row_mask:0xf bank_mask:0xf
    v_mul_f32_dpp v225, v89, v57 row_ror:13 row_mask:0xf bank_mask:0xf
    v_mfma_f32_16x16x32_bf16 v[188:191], a[56:59], v[152:155], v[188:191]
    v_mul_f32_dpp v226, v90, v58 row_ror:13 row_mask:0xf bank_mask:0xf
    v_mul_f32_dpp v227, v91, v59 row_ror:13 row_mask:0xf bank_mask:0xf
    v_mfma_f32_16x16x32_bf16 v[188:191], a[52:55], v[148:151], v[188:191]
    v_mul_f32_dpp v228, v92, v60 row_ror:13 row_mask:0xf bank_mask:0xf
    v_mul_f32_dpp v229, v93, v61 row_ror:13 row_mask:0xf bank_mask:0xf
    v_mfma_f32_16x16x32_bf16 v[188:191], a[48:51], v[144:147], v[188:191]
    v_mul_f32_dpp v230, v94, v62 row_ror:13 row_mask:0xf bank_mask:0xf
    v_mul_f32_dpp v231, v95, v63 row_ror:13 row_mask:0xf bank_mask:0xf
    v_mfma_f32_16x16x32_bf16 v[192:195], a[64:67], v[144:147], v[128:131]
    v_cvt_pk_bf16_f32 v208, |v176|, |v177|
    v_cvt_pk_bf16_f32 v209, |v178|, |v179|
    v_mfma_f32_16x16x32_bf16 v[192:195], a[68:71], v[148:151], v[192:195]
    v_lshlrev_b32 v110, 16, v111
    v_cvt_pk_bf16_f32 v164, v224, v225
    v_mfma_f32_16x16x32_bf16 v[192:195], a[72:75], v[152:155], v[192:195]
    v_cvt_pk_bf16_f32 v165, v226, v227
    v_cvt_pk_bf16_f32 v166, v228, v229
    v_mfma_f32_16x16x32_bf16 v[192:195], a[76:79], v[156:159], v[192:195]
    v_cvt_pk_bf16_f32 v167, v230, v231
    v_and_b32 v111, 0xffff0000, v111
    v_mfma_f32_16x16x32_bf16 v[196:199], a[92:95], v[156:159], v[132:135]
    v_mul_f32_dpp v224, v96, v64 row_ror:13 row_mask:0xf bank_mask:0xf
    v_mul_f32_dpp v225, v97, v65 row_ror:13 row_mask:0xf bank_mask:0xf
    v_mfma_f32_16x16x32_bf16 v[196:199], a[88:91], v[152:155], v[196:199]
    v_mul_f32_dpp v226, v98, v66 row_ror:13 row_mask:0xf bank_mask:0xf
    v_mul_f32_dpp v227, v99, v67 row_ror:13 row_mask:0xf bank_mask:0xf
    v_mfma_f32_16x16x32_bf16 v[196:199], a[84:87], v[148:151], v[196:199]
    v_mul_f32_dpp v228, v100, v68 row_ror:13 row_mask:0xf bank_mask:0xf
    v_mul_f32_dpp v229, v101, v69 row_ror:13 row_mask:0xf bank_mask:0xf
    v_mfma_f32_16x16x32_bf16 v[196:199], a[80:83], v[144:147], v[196:199]
    v_mul_f32_dpp v230, v102, v70 row_ror:13 row_mask:0xf bank_mask:0xf
    v_mul_f32_dpp v231, v103, v71 row_ror:13 row_mask:0xf bank_mask:0xf
    v_mfma_f32_16x16x32_bf16 v[200:203], a[96:99], v[144:147], v[136:139]
    v_cvt_pk_bf16_f32 v168, v224, v225
    v_cvt_pk_bf16_f32 v169, v226, v227
    v_mfma_f32_16x16x32_bf16 v[200:203], a[100:103], v[148:151], v[200:203]
    v_cvt_pk_bf16_f32 v170, v228, v229
    v_cvt_pk_bf16_f32 v171, v230, v231
    v_mfma_f32_16x16x32_bf16 v[200:203], a[104:107], v[152:155], v[200:203]
    v_mul_f32_dpp v224, v104, v72 row_ror:13 row_mask:0xf bank_mask:0xf
    v_mul_f32_dpp v225, v105, v73 row_ror:13 row_mask:0xf bank_mask:0xf
    v_mfma_f32_16x16x32_bf16 v[200:203], a[108:111], v[156:159], v[200:203]
    v_mul_f32_dpp v226, v106, v74 row_ror:13 row_mask:0xf bank_mask:0xf
    v_mul_f32_dpp v227, v107, v75 row_ror:13 row_mask:0xf bank_mask:0xf
    v_mfma_f32_16x16x32_bf16 v[204:207], a[124:127], v[156:159], v[140:143]
    v_mul_f32_dpp v228, v108, v76 row_ror:13 row_mask:0xf bank_mask:0xf
    v_mul_f32_dpp v229, v109, v77 row_ror:13 row_mask:0xf bank_mask:0xf
    v_mfma_f32_16x16x32_bf16 v[204:207], a[120:123], v[152:155], v[204:207]
    v_mul_f32_dpp v230, v110, v78 row_ror:13 row_mask:0xf bank_mask:0xf
    v_mul_f32_dpp v231, v111, v79 row_ror:13 row_mask:0xf bank_mask:0xf
    v_mfma_f32_16x16x32_bf16 v[204:207], a[116:119], v[148:151], v[204:207]
    v_cvt_pk_bf16_f32 v172, v224, v225
    v_cvt_pk_bf16_f32 v173, v226, v227
    v_mfma_f32_16x16x32_bf16 v[204:207], a[112:115], v[144:147], v[204:207]
    v_cvt_pk_bf16_f32 v174, v228, v229
    v_cvt_pk_bf16_f32 v175, v230, v231
    v_mfma_f32_16x16x32_bf16 v[176:179], a[0:3], v[160:163], v[112:115]
    v_cvt_pk_bf16_f32 v210, |v180|, |v181|
    v_cvt_pk_bf16_f32 v211, |v182|, |v183|
    v_mfma_f32_16x16x32_bf16 v[176:179], a[4:7], v[164:167], v[176:179]
    v_cvt_pk_bf16_f32 v212, |v184|, |v185|
    v_cvt_pk_bf16_f32 v213, |v186|, |v187|
    v_mfma_f32_16x16x32_bf16 v[176:179], a[8:11], v[168:171], v[176:179]
    v_cvt_pk_bf16_f32 v214, |v188|, |v189|
    v_cvt_pk_bf16_f32 v215, |v190|, |v191|
    v_mfma_f32_16x16x32_bf16 v[176:179], a[12:15], v[172:175], v[176:179]
    v_cvt_pk_bf16_f32 v216, |v192|, |v193|
    v_cvt_pk_bf16_f32 v217, |v194|, |v195|
    v_smfmac_f32_16x16x64_bf16 v[248:251], a[128:131], v[208:215], v1
    v_cvt_pk_bf16_f32 v218, |v196|, |v197|
    v_mfma_f32_16x16x32_bf16 v[180:183], a[28:31], v[172:175], v[116:119]
    v_cvt_pk_bf16_f32 v219, |v198|, |v199|
    v_cvt_pk_bf16_f32 v220, |v200|, |v201|
    v_mfma_f32_16x16x32_bf16 v[180:183], a[24:27], v[168:171], v[180:183]
    v_cvt_pk_bf16_f32 v221, |v202|, |v203|
    v_cvt_pk_bf16_f32 v222, |v204|, |v205|
    v_mfma_f32_16x16x32_bf16 v[180:183], a[20:23], v[164:167], v[180:183]
    v_cvt_pk_bf16_f32 v223, |v206|, |v207|
    v_mul_f32_dpp v224, v80, v48 row_ror:5 row_mask:0xf bank_mask:0xf
    v_mfma_f32_16x16x32_bf16 v[180:183], a[16:19], v[160:163], v[180:183]
    v_mul_f32_dpp v225, v81, v49 row_ror:5 row_mask:0xf bank_mask:0xf
    v_mul_f32_dpp v226, v82, v50 row_ror:5 row_mask:0xf bank_mask:0xf
    v_smfmac_f32_16x16x64_bf16 v[248:251], a[132:135], v[216:223], v1
    v_mul_f32_dpp v227, v83, v51 row_ror:5 row_mask:0xf bank_mask:0xf
    v_mfma_f32_16x16x32_bf16 v[184:187], a[32:35], v[160:163], v[120:123]
    v_mul_f32_dpp v228, v84, v52 row_ror:5 row_mask:0xf bank_mask:0xf
    v_mul_f32_dpp v229, v85, v53 row_ror:5 row_mask:0xf bank_mask:0xf
    v_mfma_f32_16x16x32_bf16 v[184:187], a[36:39], v[164:167], v[184:187]
    v_mul_f32_dpp v230, v86, v54 row_ror:5 row_mask:0xf bank_mask:0xf
    v_mul_f32_dpp v231, v87, v55 row_ror:5 row_mask:0xf bank_mask:0xf
    v_mfma_f32_16x16x32_bf16 v[184:187], a[40:43], v[168:171], v[184:187]
    v_cvt_pk_bf16_f32 v144, v224, v225
    v_cvt_pk_bf16_f32 v145, v226, v227
    v_mfma_f32_16x16x32_bf16 v[184:187], a[44:47], v[172:175], v[184:187]
    v_cvt_pk_bf16_f32 v146, v228, v229
    v_cvt_pk_bf16_f32 v147, v230, v231
    v_smfmac_f32_16x16x64_bf16 v[248:251], a[152:155], v[160:167], v1
    v_mul_f32_dpp v224, v88, v56 row_ror:5 row_mask:0xf bank_mask:0xf
    v_mfma_f32_16x16x32_bf16 v[188:191], a[60:63], v[172:175], v[124:127]
    v_mul_f32_dpp v225, v89, v57 row_ror:5 row_mask:0xf bank_mask:0xf
    v_mul_f32_dpp v226, v90, v58 row_ror:5 row_mask:0xf bank_mask:0xf
    v_mfma_f32_16x16x32_bf16 v[188:191], a[56:59], v[168:171], v[188:191]
    v_mul_f32_dpp v227, v91, v59 row_ror:5 row_mask:0xf bank_mask:0xf
    v_mul_f32_dpp v228, v92, v60 row_ror:5 row_mask:0xf bank_mask:0xf
    v_mfma_f32_16x16x32_bf16 v[188:191], a[52:55], v[164:167], v[188:191]
    v_mul_f32_dpp v229, v93, v61 row_ror:5 row_mask:0xf bank_mask:0xf
    v_mul_f32_dpp v230, v94, v62 row_ror:5 row_mask:0xf bank_mask:0xf
    v_mfma_f32_16x16x32_bf16 v[188:191], a[48:51], v[160:163], v[188:191]
    v_mul_f32_dpp v231, v95, v63 row_ror:5 row_mask:0xf bank_mask:0xf
    v_cvt_pk_bf16_f32 v208, |v176|, |v177|
    v_smfmac_f32_16x16x64_bf16 v[248:251], a[156:159], v[168:175], v1
    v_cvt_pk_bf16_f32 v209, |v178|, |v179|
    v_mfma_f32_16x16x32_bf16 v[192:195], a[64:67], v[160:163], v[128:131]
    v_cvt_pk_bf16_f32 v148, v224, v225
    v_cvt_pk_bf16_f32 v149, v226, v227
    v_mfma_f32_16x16x32_bf16 v[192:195], a[68:71], v[164:167], v[192:195]
    v_cvt_pk_bf16_f32 v150, v228, v229
    v_cvt_pk_bf16_f32 v151, v230, v231
    v_mfma_f32_16x16x32_bf16 v[192:195], a[72:75], v[168:171], v[192:195]
    v_mul_f32_dpp v224, v96, v64 row_ror:5 row_mask:0xf bank_mask:0xf
    v_mul_f32_dpp v225, v97, v65 row_ror:5 row_mask:0xf bank_mask:0xf
    v_mfma_f32_16x16x32_bf16 v[192:195], a[76:79], v[172:175], v[192:195]
    v_mul_f32_dpp v226, v98, v66 row_ror:5 row_mask:0xf bank_mask:0xf
    v_mul_f32_dpp v227, v99, v67 row_ror:5 row_mask:0xf bank_mask:0xf
    v_mfma_f32_16x16x32_bf16 v[196:199], a[92:95], v[172:175], v[132:135]
    v_mul_f32_dpp v228, v100, v68 row_ror:5 row_mask:0xf bank_mask:0xf
    v_mul_f32_dpp v229, v101, v69 row_ror:5 row_mask:0xf bank_mask:0xf
    v_mfma_f32_16x16x32_bf16 v[196:199], a[88:91], v[168:171], v[196:199]
    v_mul_f32_dpp v230, v102, v70 row_ror:5 row_mask:0xf bank_mask:0xf
    v_mul_f32_dpp v231, v103, v71 row_ror:5 row_mask:0xf bank_mask:0xf
    v_mfma_f32_16x16x32_bf16 v[196:199], a[84:87], v[164:167], v[196:199]
    v_cvt_pk_bf16_f32 v152, v224, v225
    v_cvt_pk_bf16_f32 v153, v226, v227
    v_mfma_f32_16x16x32_bf16 v[196:199], a[80:83], v[160:163], v[196:199]
    v_cvt_pk_bf16_f32 v154, v228, v229
    v_cvt_pk_bf16_f32 v155, v230, v231
    v_mfma_f32_16x16x32_bf16 v[200:203], a[96:99], v[160:163], v[136:139]
    v_mul_f32_dpp v224, v104, v72 row_ror:5 row_mask:0xf bank_mask:0xf
    v_mul_f32_dpp v225, v105, v73 row_ror:5 row_mask:0xf bank_mask:0xf
    v_mfma_f32_16x16x32_bf16 v[200:203], a[100:103], v[164:167], v[200:203]
    v_mul_f32_dpp v226, v106, v74 row_ror:5 row_mask:0xf bank_mask:0xf
    v_mul_f32_dpp v227, v107, v75 row_ror:5 row_mask:0xf bank_mask:0xf
    v_mfma_f32_16x16x32_bf16 v[200:203], a[104:107], v[168:171], v[200:203]
L_stub3:
    s_cbranch_scc1 L_main2
    v_mul_f32_dpp v228, v108, v76 row_ror:5 row_mask:0xf bank_mask:0xf
    v_mul_f32_dpp v229, v109, v77 row_ror:5 row_mask:0xf bank_mask:0xf
    v_mfma_f32_16x16x32_bf16 v[200:203], a[108:111], v[172:175], v[200:203]
    v_mul_f32_dpp v230, v110, v78 row_ror:5 row_mask:0xf bank_mask:0xf
    v_mul_f32_dpp v231, v111, v79 row_ror:5 row_mask:0xf bank_mask:0xf
    v_mfma_f32_16x16x32_bf16 v[204:207], a[124:127], v[172:175], v[140:143]
    v_cvt_pk_bf16_f32 v156, v224, v225
    v_cvt_pk_bf16_f32 v157, v226, v227
    v_mfma_f32_16x16x32_bf16 v[204:207], a[120:123], v[168:171], v[204:207]
    v_cvt_pk_bf16_f32 v158, v228, v229
    v_cvt_pk_bf16_f32 v159, v230, v231
    v_mfma_f32_16x16x32_bf16 v[204:207], a[116:119], v[164:167], v[204:207]
    v_cvt_pk_bf16_f32 v210, |v180|, |v181|
    v_cvt_pk_bf16_f32 v211, |v182|, |v183|
    v_mfma_f32_16x16x32_bf16 v[204:207], a[112:115], v[160:163], v[204:207]
    v_cvt_pk_bf16_f32 v212, |v184|, |v185|
    v_cvt_pk_bf16_f32 v213, |v186|, |v187|
    v_mfma_f32_16x16x32_bf16 v[176:179], a[0:3], v[144:147], v[112:115]
    v_cvt_pk_bf16_f32 v214, |v188|, |v189|
    v_cvt_pk_bf16_f32 v215, |v190|, |v191|
    v_mfma_f32_16x16x32_bf16 v[176:179], a[4:7], v[148:151], v[176:179]
    v_cvt_pk_bf16_f32 v216, |v192|, |v193|
    v_cvt_pk_bf16_f32 v217, |v194|, |v195|
    v_mfma_f32_16x16x32_bf16 v[176:179], a[8:11], v[152:155], v[176:179]
    v_cvt_pk_bf16_f32 v218, |v196|, |v197|
    v_cvt_pk_bf16_f32 v219, |v198|, |v199|
    v_mfma_f32_16x16x32_bf16 v[176:179], a[12:15], v[156:159], v[176:179]
    v_cvt_pk_bf16_f32 v220, |v200|, |v201|
    v_cvt_pk_bf16_f32 v221, |v202|, |v203|
    v_smfmac_f32_16x16x64_bf16 v[248:251], a[144:147], v[208:215], v1
    v_cvt_pk_bf16_f32 v222, |v204|, |v205|
    v_mfma_f32_16x16x32_bf16 v[180:183], a[28:31], v[156:159], v[116:119]
    v_cvt_pk_bf16_f32 v223, |v206|, |v207|
    v_mul_f32 v224, v80, v48
    v_mfma_f32_16x16x32_bf16 v[180:183], a[24:27], v[152:155], v[180:183]
    v_mul_f32 v225, v81, v49
    v_mul_f32 v226, v82, v50
    v_mfma_f32_16x16x32_bf16 v[180:183], a[20:23], v[148:151], v[180:183]
    v_mul_f32 v227, v83, v51
    v_mul_f32 v228, v84, v52
    v_mfma_f32_16x16x32_bf16 v[180:183], a[16:19], v[144:147], v[180:183]
    v_mul_f32 v229, v85, v53
    v_mul_f32 v230, v86, v54
    v_smfmac_f32_16x16x64_bf16 v[248:251], a[148:151], v[216:223], v1
    v_mul_f32 v231, v87, v55
    v_mfma_f32_16x16x32_bf16 v[184:187], a[32:35], v[144:147], v[120:123]
    v_cvt_pk_bf16_f32 v160, v224, v225
    v_cvt_pk_bf16_f32 v161, v226, v227
    v_mfma_f32_16x16x32_bf16 v[184:187], a[36:39], v[148:151], v[184:187]
    v_cvt_pk_bf16_f32 v162, v228, v229
    v_cvt_pk_bf16_f32 v163, v230, v231
    v_mfma_f32_16x16x32_bf16 v[184:187], a[40:43], v[152:155], v[184:187]
    v_mul_f32 v224, v88, v56
    v_mul_f32 v225, v89, v57
    v_mfma_f32_16x16x32_bf16 v[184:187], a[44:47], v[156:159], v[184:187]
    v_mul_f32 v226, v90, v58
    v_mul_f32 v227, v91, v59
    v_smfmac_f32_16x16x64_bf16 v[248:251], a[168:171], v[144:151], v1
    v_mul_f32 v228, v92, v60
    v_mfma_f32_16x16x32_bf16 v[188:191], a[60:63], v[156:159], v[124:127]
    v_mul_f32 v229, v93, v61
    v_mul_f32 v230, v94, v62
    v_mfma_f32_16x16x32_bf16 v[188:191], a[56:59], v[152:155], v[188:191]
    v_mul_f32 v231, v95, v63
    v_cvt_pk_bf16_f32 v208, |v176|, |v177|
    v_mfma_f32_16x16x32_bf16 v[188:191], a[52:55], v[148:151], v[188:191]
    v_cvt_pk_bf16_f32 v209, |v178|, |v179|
    v_cvt_pk_bf16_f32 v164, v224, v225
    v_mfma_f32_16x16x32_bf16 v[188:191], a[48:51], v[144:147], v[188:191]
    v_cvt_pk_bf16_f32 v165, v226, v227
    v_cvt_pk_bf16_f32 v166, v228, v229
    v_smfmac_f32_16x16x64_bf16 v[248:251], a[172:175], v[152:159], v1
    v_cvt_pk_bf16_f32 v167, v230, v231
    v_mfma_f32_16x16x32_bf16 v[192:195], a[64:67], v[144:147], v[128:131]
    v_mul_f32 v224, v96, v64
    v_mul_f32 v225, v97, v65
    v_mfma_f32_16x16x32_bf16 v[192:195], a[68:71], v[148:151], v[192:195]
    v_mul_f32 v226, v98, v66
    v_mul_f32 v227, v99, v67
    v_mfma_f32_16x16x32_bf16 v[192:195], a[72:75], v[152:155], v[192:195]
    v_mul_f32 v228, v100, v68
    v_mul_f32 v229, v101, v69
    v_mfma_f32_16x16x32_bf16 v[192:195], a[76:79], v[156:159], v[192:195]
    v_mul_f32 v230, v102, v70
    v_mul_f32 v231, v103, v71
    v_mfma_f32_16x16x32_bf16 v[196:199], a[92:95], v[156:159], v[132:135]
    v_cvt_pk_bf16_f32 v168, v224, v225
    v_cvt_pk_bf16_f32 v169, v226, v227
    v_mfma_f32_16x16x32_bf16 v[196:199], a[88:91], v[152:155], v[196:199]
    v_cvt_pk_bf16_f32 v170, v228, v229
    v_cvt_pk_bf16_f32 v171, v230, v231
    v_mfma_f32_16x16x32_bf16 v[196:199], a[84:87], v[148:151], v[196:199]
    v_mul_f32 v224, v104, v72
    v_mul_f32 v225, v105, v73
    v_mfma_f32_16x16x32_bf16 v[196:199], a[80:83], v[144:147], v[196:199]
    v_mul_f32 v226, v106, v74
    v_mul_f32 v227, v107, v75
    v_mfma_f32_16x16x32_bf16 v[200:203], a[96:99], v[144:147], v[136:139]
    v_mul_f32 v228, v108, v76
    v_mul_f32 v229, v109, v77
    v_mfma_f32_16x16x32_bf16 v[200:203], a[100:103], v[148:151], v[200:203]
    v_mul_f32 v230, v110, v78
    v_mul_f32 v231, v111, v79
    v_mfma_f32_16x16x32_bf16 v[200:203], a[104:107], v[152:155], v[200:203]
    v_cvt_pk_bf16_f32 v172, v224, v225
    v_cvt_pk_bf16_f32 v173, v226, v227
    v_mfma_f32_16x16x32_bf16 v[200:203], a[108:111], v[156:159], v[200:203]
    v_cvt_pk_bf16_f32 v174, v228, v229
    v_cvt_pk_bf16_f32 v175, v230, v231
    v_mfma_f32_16x16x32_bf16 v[204:207], a[124:127], v[156:159], v[140:143]
    v_cvt_pk_bf16_f32 v210, |v180|, |v181|
    v_cvt_pk_bf16_f32 v211, |v182|, |v183|
    v_mfma_f32_16x16x32_bf16 v[204:207], a[120:123], v[152:155], v[204:207]
    v_cvt_pk_bf16_f32 v212, |v184|, |v185|
    v_cvt_pk_bf16_f32 v213, |v186|, |v187|
    v_mfma_f32_16x16x32_bf16 v[204:207], a[116:119], v[148:151], v[204:207]
    v_cvt_pk_bf16_f32 v214, |v188|, |v189|
    v_cvt_pk_bf16_f32 v215, |v190|, |v191|
    v_mfma_f32_16x16x32_bf16 v[204:207], a[112:115], v[144:147], v[204:207]
    v_cvt_pk_bf16_f32 v216, |v192|, |v193|
    v_cvt_pk_bf16_f32 v217, |v194|, |v195|
    v_smfmac_f32_16x16x64_bf16 v[248:251], a[160:163], v[208:215], v1
    v_cvt_pk_bf16_f32 v218, |v196|, |v197|
    v_mfma_f32_16x16x32_bf16 v[176:179], a[0:3], v[160:163], v[112:115]
    v_cvt_pk_bf16_f32 v219, |v198|, |v199|
    v_cvt_pk_bf16_f32 v220, |v200|, |v201|
    v_mfma_f32_16x16x32_bf16 v[176:179], a[4:7], v[164:167], v[176:179]
    v_cvt_pk_bf16_f32 v221, |v202|, |v203|
    v_cvt_pk_bf16_f32 v222, |v204|, |v205|
    v_mfma_f32_16x16x32_bf16 v[176:179], a[8:11], v[168:171], v[176:179]
    v_cvt_pk_bf16_f32 v223, |v206|, |v207|
    v_mul_f32_dpp v224, v16, v16 row_ror:8 row_mask:0xf bank_mask:0xf
    v_mfma_f32_16x16x32_bf16 v[176:179], a[12:15], v[172:175], v[176:179]
    v_mul_f32_dpp v225, v17, v17 row_ror:8 row_mask:0xf bank_mask:0xf
    v_mul_f32_dpp v226, v18, v18 row_ror:8 row_mask:0xf bank_mask:0xf
    v_smfmac_f32_16x16x64_bf16 v[248:251], a[164:167], v[216:223], v1
    v_mul_f32_dpp v227, v19, v19 row_ror:8 row_mask:0xf bank_mask:0xf
    v_mfma_f32_16x16x32_bf16 v[180:183], a[28:31], v[172:175], v[116:119]
    v_mul_f32_dpp v228, v20, v20 row_ror:8 row_mask:0xf bank_mask:0xf
    v_mul_f32_dpp v229, v21, v21 row_ror:8 row_mask:0xf bank_mask:0xf
    v_mfma_f32_16x16x32_bf16 v[180:183], a[24:27], v[168:171], v[180:183]
    v_mul_f32_dpp v230, v22, v22 row_ror:8 row_mask:0xf bank_mask:0xf
    v_mul_f32_dpp v231, v23, v23 row_ror:8 row_mask:0xf bank_mask:0xf
    v_mfma_f32_16x16x32_bf16 v[180:183], a[20:23], v[164:167], v[180:183]
    v_cvt_pk_bf16_f32 v144, v224, v225
    v_cvt_pk_bf16_f32 v145, v226, v227
    v_mfma_f32_16x16x32_bf16 v[180:183], a[16:19], v[160:163], v[180:183]
    v_cvt_pk_bf16_f32 v146, v228, v229
    v_cvt_pk_bf16_f32 v147, v230, v231
    v_smfmac_f32_16x16x64_bf16 v[248:251], a[184:187], v[160:167], v1
    v_mul_f32_dpp v224, v24, v24 row_ror:8 row_mask:0xf bank_mask:0xf
    v_mfma_f32_16x16x32_bf16 v[184:187], a[32:35], v[160:163], v[120:123]
    v_mul_f32_dpp v225, v25, v25 row_ror:8 row_mask:0xf bank_mask:0xf
    v_mul_f32_dpp v226, v26, v26 row_ror:8 row_mask:0xf bank_mask:0xf
    v_mfma_f32_16x16x32_bf16 v[184:187], a[36:39], v[164:167], v[184:187]
    v_mul_f32_dpp v227, v27, v27 row_ror:8 row_mask:0xf bank_mask:0xf
    v_mul_f32_dpp v228, v28, v28 row_ror:8 row_mask:0xf bank_mask:0xf
    v_mfma_f32_16x16x32_bf16 v[184:187], a[40:43], v[168:171], v[184:187]
    v_mul_f32_dpp v229, v29, v29 row_ror:8 row_mask:0xf bank_mask:0xf
    v_mul_f32_dpp v230, v30, v30 row_ror:8 row_mask:0xf bank_mask:0xf
    v_mfma_f32_16x16x32_bf16 v[184:187], a[44:47], v[172:175], v[184:187]
    v_mul_f32_dpp v231, v31, v31 row_ror:8 row_mask:0xf bank_mask:0xf
    v_cvt_pk_bf16_f32 v208, |v176|, |v177|
    v_smfmac_f32_16x16x64_bf16 v[248:251], a[188:191], v[168:175], v1
    v_cvt_pk_bf16_f32 v209, |v178|, |v179|
    v_mfma_f32_16x16x32_bf16 v[188:191], a[60:63], v[172:175], v[124:127]
    v_cvt_pk_bf16_f32 v148, v224, v225
    v_cvt_pk_bf16_f32 v149, v226, v227
    v_mfma_f32_16x16x32_bf16 v[188:191], a[56:59], v[168:171], v[188:191]
    v_cvt_pk_bf16_f32 v150, v228, v229
    v_cvt_pk_bf16_f32 v151, v230, v231
    v_mfma_f32_16x16x32_bf16 v[188:191], a[52:55], v[164:167], v[188:191]
    v_mul_f32_dpp v224, v32, v32 row_ror:8 row_mask:0xf bank_mask:0xf
    v_mul_f32_dpp v225, v33, v33 row_ror:8 row_mask:0xf bank_mask:0xf
    v_mfma_f32_16x16x32_bf16 v[188:191], a[48:51], v[160:163], v[188:191]
    v_mul_f32_dpp v226, v34, v34 row_ror:8 row_mask:0xf bank_mask:0xf
    v_mul_f32_dpp v227, v35, v35 row_ror:8 row_mask:0xf bank_mask:0xf
    v_smfmac_f32_16x16x64_bf16 v[252:255], a[136:139], v[144:151], v1
    v_mul_f32_dpp v228, v36, v36 row_ror:8 row_mask:0xf bank_mask:0xf
    v_mfma_f32_16x16x32_bf16 v[192:195], a[64:67], v[160:163], v[128:131]
    v_mul_f32_dpp v229, v37, v37 row_ror:8 row_mask:0xf bank_mask:0xf
    v_mul_f32_dpp v230, v38, v38 row_ror:8 row_mask:0xf bank_mask:0xf
    v_mfma_f32_16x16x32_bf16 v[192:195], a[68:71], v[164:167], v[192:195]
    v_mul_f32_dpp v231, v39, v39 row_ror:8 row_mask:0xf bank_mask:0xf
    v_cvt_pk_bf16_f32 v152, v224, v225
    v_mfma_f32_16x16x32_bf16 v[192:195], a[72:75], v[168:171], v[192:195]
    v_cvt_pk_bf16_f32 v153, v226, v227
    v_cvt_pk_bf16_f32 v154, v228, v229
    v_mfma_f32_16x16x32_bf16 v[192:195], a[76:79], v[172:175], v[192:195]
    v_cvt_pk_bf16_f32 v155, v230, v231
    v_mul_f32_dpp v224, v40, v40 row_ror:8 row_mask:0xf bank_mask:0xf
    v_mfma_f32_16x16x32_bf16 v[196:199], a[92:95], v[172:175], v[132:135]
    v_mul_f32_dpp v225, v41, v41 row_ror:8 row_mask:0xf bank_mask:0xf
    v_mul_f32_dpp v226, v42, v42 row_ror:8 row_mask:0xf bank_mask:0xf
    v_mfma_f32_16x16x32_bf16 v[196:199], a[88:91], v[168:171], v[196:199]
    v_mul_f32_dpp v227, v43, v43 row_ror:8 row_mask:0xf bank_mask:0xf
    v_mul_f32_dpp v228, v44, v44 row_ror:8 row_mask:0xf bank_mask:0xf
    v_mfma_f32_16x16x32_bf16 v[196:199], a[84:87], v[164:167], v[196:199]
    v_mul_f32_dpp v229, v45, v45 row_ror:8 row_mask:0xf bank_mask:0xf
    v_mul_f32_dpp v230, v46, v46 row_ror:8 row_mask:0xf bank_mask:0xf
    v_mfma_f32_16x16x32_bf16 v[196:199], a[80:83], v[160:163], v[196:199]
    v_mul_f32_dpp v231, v47, v47 row_ror:8 row_mask:0xf bank_mask:0xf
    v_cvt_pk_bf16_f32 v156, v224, v225
    v_mfma_f32_16x16x32_bf16 v[200:203], a[96:99], v[160:163], v[136:139]
    v_cvt_pk_bf16_f32 v157, v226, v227
    v_cvt_pk_bf16_f32 v158, v228, v229
    v_mfma_f32_16x16x32_bf16 v[200:203], a[100:103], v[164:167], v[200:203]
    v_cvt_pk_bf16_f32 v159, v230, v231
    v_cvt_pk_bf16_f32 v210, |v180|, |v181|
    v_mfma_f32_16x16x32_bf16 v[200:203], a[104:107], v[168:171], v[200:203]
    v_cvt_pk_bf16_f32 v211, |v182|, |v183|
    v_cvt_pk_bf16_f32 v212, |v184|, |v185|
    v_mfma_f32_16x16x32_bf16 v[200:203], a[108:111], v[172:175], v[200:203]
    v_cvt_pk_bf16_f32 v213, |v186|, |v187|
    v_cvt_pk_bf16_f32 v214, |v188|, |v189|
    v_smfmac_f32_16x16x64_bf16 v[252:255], a[140:143], v[152:159], v1
    v_cvt_pk_bf16_f32 v215, |v190|, |v191|
    v_mfma_f32_16x16x32_bf16 v[204:207], a[124:127], v[172:175], v[140:143]
    v_cvt_pk_bf16_f32 v216, |v192|, |v193|
    v_cvt_pk_bf16_f32 v217, |v194|, |v195|
    v_mfma_f32_16x16x32_bf16 v[204:207], a[120:123], v[168:171], v[204:207]
    v_cvt_pk_bf16_f32 v218, |v196|, |v197|
    v_cvt_pk_bf16_f32 v219, |v198|, |v199|
    v_mfma_f32_16x16x32_bf16 v[204:207], a[116:119], v[164:167], v[204:207]
    v_cvt_pk_bf16_f32 v220, |v200|, |v201|
    v_cvt_pk_bf16_f32 v221, |v202|, |v203|
    v_mfma_f32_16x16x32_bf16 v[204:207], a[112:115], v[160:163], v[204:207]
    v_add_f32 v232, v232, v233
    v_add_f32 v236, v236, v237
    v_smfmac_f32_16x16x64_bf16 v[248:251], a[176:179], v[208:215], v1
    v_add_f32 v240, v240, v241
    v_mfma_f32_16x16x32_bf16 v[176:179], a[0:3], v[144:147], v[112:115]
    v_max3_f32 v12, v232, v236, v240
    v_add_f32 v244, v244, v245
    v_mfma_f32_16x16x32_bf16 v[176:179], a[4:7], v[148:151], v[176:179]
    v_cvt_pk_bf16_f32 v222, |v204|, |v205|
    v_cvt_pk_bf16_f32 v223, |v206|, |v207|
    v_mfma_f32_16x16x32_bf16 v[176:179], a[8:11], v[152:155], v[176:179]
    v_add_f32 v234, v234, v235
    v_add_f32 v238, v238, v239
    v_mfma_f32_16x16x32_bf16 v[176:179], a[12:15], v[156:159], v[176:179]
    v_add_f32 v242, v242, v243
    v_add_f32 v246, v246, v247
    v_smfmac_f32_16x16x64_bf16 v[248:251], a[180:183], v[216:223], v1
    v_mfma_f32_16x16x32_bf16 v[180:183], a[28:31], v[156:159], v[116:119]
    v_mfma_f32_16x16x32_bf16 v[180:183], a[24:27], v[152:155], v[180:183]
    v_mfma_f32_16x16x32_bf16 v[180:183], a[20:23], v[148:151], v[180:183]
    v_mfma_f32_16x16x32_bf16 v[180:183], a[16:19], v[144:147], v[180:183]
    v_mfma_f32_16x16x32_bf16 v[184:187], a[32:35], v[144:147], v[120:123]
    v_cvt_pk_bf16_f32 v208, |v176|, |v177|
    v_cvt_pk_bf16_f32 v209, |v178|, |v179|
    v_mfma_f32_16x16x32_bf16 v[184:187], a[36:39], v[148:151], v[184:187]
    v_mfma_f32_16x16x32_bf16 v[184:187], a[40:43], v[152:155], v[184:187]
    v_mfma_f32_16x16x32_bf16 v[184:187], a[44:47], v[156:159], v[184:187]
    v_add_f32 v248, v248, v249
    v_max3_f32 v12, v12, v244, v248
    v_mfma_f32_16x16x32_bf16 v[188:191], a[60:63], v[156:159], v[124:127]
    v_mul_f32 v2, v12, v10
    v_max_f32_dpp v12, v12, v12 row_ror:8 row_mask:0xf bank_mask:0xf
    v_mfma_f32_16x16x32_bf16 v[188:191], a[56:59], v[152:155], v[188:191]
    v_cvt_pk_bf16_f32 v210, |v180|, |v181|
    v_max_f32_dpp v12, v12, v12 row_ror:4 row_mask:0xf bank_mask:0xf
    v_mfma_f32_16x16x32_bf16 v[188:191], a[52:55], v[148:151], v[188:191]
    v_cvt_pk_bf16_f32 v211, |v182|, |v183|
    v_max_f32_dpp v12, v12, v12 row_ror:2 row_mask:0xf bank_mask:0xf
    v_mfma_f32_16x16x32_bf16 v[188:191], a[48:51], v[144:147], v[188:191]
    v_cvt_pk_bf16_f32 v212, |v184|, |v185|
    v_max_f32_dpp v12, v12, v12 row_ror:1 row_mask:0xf bank_mask:0xf
    v_mfma_f32_16x16x32_bf16 v[192:195], a[64:67], v[144:147], v[128:131]
    v_cvt_pk_bf16_f32 v213, |v186|, |v187|
    v_max_f32_dpp v12, v12, v12 row_bcast:15 row_mask:0xa bank_mask:0xf
    v_mfma_f32_16x16x32_bf16 v[192:195], a[68:71], v[148:151], v[192:195]
    v_fma_f32 v232, v232, v10, -v2
    v_max_f32_dpp v12, v12, v12 row_bcast:31 row_mask:0xc bank_mask:0xf
    v_mfma_f32_16x16x32_bf16 v[192:195], a[72:75], v[152:155], v[192:195]
    v_cvt_pk_bf16_f32 v214, |v188|, |v189|
    v_cvt_pk_bf16_f32 v215, |v190|, |v191|
    v_mfma_f32_16x16x32_bf16 v[192:195], a[76:79], v[156:159], v[192:195]
    v_readlane_b32 s14, v12, 63
    v_fma_f32 v236, v236, v10, -v2
    v_smfmac_f32_16x16x64_bf16 v[252:255], a[128:131], v[208:215], v1
    v_exp_f32 v232, v232
    v_mfma_f32_16x16x32_bf16 v[196:199], a[92:95], v[156:159], v[132:135]
    v_exp_f32 v236, v236
    v_mfma_f32_16x16x32_bf16 v[196:199], a[88:91], v[152:155], v[196:199]
    v_fma_f32 v240, v240, v10, -v2
    v_exp_f32 v240, v240
    v_mfma_f32_16x16x32_bf16 v[196:199], a[84:87], v[148:151], v[196:199]
    v_fma_f32 v244, v244, v10, -v2
    v_cvt_pk_bf16_f32 v216, |v192|, |v193|
    v_mfma_f32_16x16x32_bf16 v[196:199], a[80:83], v[144:147], v[196:199]
    v_cvt_pk_bf16_f32 v217, |v194|, |v195|
    v_mul_f32 v13, s14, v10
    v_mfma_f32_16x16x32_bf16 v[200:203], a[96:99], v[144:147], v[136:139]
    v_exp_f32 v244, v244
    v_mfma_f32_16x16x32_bf16 v[200:203], a[100:103], v[148:151], v[200:203]
    v_fma_f32 v248, v248, v10, -v2
    v_add_f32 v14, v232, v236
    v_mfma_f32_16x16x32_bf16 v[200:203], a[104:107], v[152:155], v[200:203]
    v_cvt_pk_bf16_f32 v218, |v196|, |v197|
    v_cvt_pk_bf16_f32 v219, |v198|, |v199|
    v_mfma_f32_16x16x32_bf16 v[200:203], a[108:111], v[156:159], v[200:203]
    v_sub_f32 v3, v2, v13
    v_exp_f32 v248, v248
    v_mfma_f32_16x16x32_bf16 v[204:207], a[124:127], v[156:159], v[140:143]
    v_mul_f32 v15, v232, v234
    v_add_f32 v14, v14, v240
    v_mfma_f32_16x16x32_bf16 v[204:207], a[120:123], v[152:155], v[204:207]
    v_exp_f32 v3, v3
    v_mfma_f32_16x16x32_bf16 v[204:207], a[116:119], v[148:151], v[204:207]
    v_cvt_pk_bf16_f32 v220, |v200|, |v201|
    v_cvt_pk_bf16_f32 v221, |v202|, |v203|
    v_mfma_f32_16x16x32_bf16 v[204:207], a[112:115], v[144:147], v[204:207]
    v_fmac_f32 v15, v236, v238
    v_add_f32 v14, v14, v244
    v_fmac_f32 v15, v240, v242
    v_add_f32 v14, v14, v248
    v_add_f32 v250, v250, v251
    v_fmac_f32 v15, v244, v246
    v_mul_f32 v14, v14, v3
    v_fmac_f32 v15, v248, v250
    v_cvt_pk_bf16_f32 v222, |v204|, |v205|
    v_cvt_pk_bf16_f32 v223, |v206|, |v207|
    v_mul_f32 v15, v15, v3
    v_add_f32_dpp v14, v14, v14 row_ror:8 row_mask:0xf bank_mask:0xf
    v_smfmac_f32_16x16x64_bf16 v[252:255], a[132:135], v[216:223], v1
    v_add_f32_dpp v15, v15, v15 row_ror:8 row_mask:0xf bank_mask:0xf
    v_add_f32_dpp v14, v14, v14 row_ror:4 row_mask:0xf bank_mask:0xf
    s_nop 0
    v_add_f32_dpp v15, v15, v15 row_ror:4 row_mask:0xf bank_mask:0xf
    v_add_f32_dpp v14, v14, v14 row_ror:2 row_mask:0xf bank_mask:0xf
    s_nop 0
    v_add_f32_dpp v15, v15, v15 row_ror:2 row_mask:0xf bank_mask:0xf
    v_add_f32_dpp v14, v14, v14 row_ror:1 row_mask:0xf bank_mask:0xf
    s_nop 0
    v_add_f32_dpp v15, v15, v15 row_ror:1 row_mask:0xf bank_mask:0xf
    v_add_f32 v252, v252, v253
    v_max_f32 v6, s14, v252
    v_add_f32 v254, v254, v255
    v_add_f32_dpp v14, v14, v14 row_bcast:15 row_mask:0xa bank_mask:0xf
    v_max_f32_dpp v6, v6, v6 row_ror:4 row_mask:0xf bank_mask:0xf
    v_add_f32_dpp v15, v15, v15 row_bcast:15 row_mask:0xa bank_mask:0xf
    v_add_f32_dpp v14, v14, v14 row_bcast:31 row_mask:0xc bank_mask:0xf
    v_max_f32_dpp v6, v6, v6 row_ror:2 row_mask:0xf bank_mask:0xf
    v_add_f32_dpp v15, v15, v15 row_bcast:31 row_mask:0xc bank_mask:0xf
    v_readlane_b32 s15, v14, 63
    v_max_f32_dpp v6, v6, v6 row_ror:1 row_mask:0xf bank_mask:0xf
    v_mul_f32 v4, v6, v10
    v_fma_f32 v252, v252, v10, -v4
    v_exp_f32 v252, v252
    v_sub_f32 v5, v13, v4
    v_mul_f32 v254, v252, v254
    v_add_f32_dpp v252, v252, v252 row_ror:4 row_mask:0xf bank_mask:0xf
    v_exp_f32 v5, v5
    v_add_f32_dpp v254, v254, v254 row_ror:4 row_mask:0xf bank_mask:0xf
    v_add_f32_dpp v252, v252, v252 row_ror:2 row_mask:0xf bank_mask:0xf
    v_readlane_b32 s34, v15, 63
    v_add_f32_dpp v254, v254, v254 row_ror:2 row_mask:0xf bank_mask:0xf
    v_add_f32_dpp v252, v252, v252 row_ror:1 row_mask:0xf bank_mask:0xf
    v_fmac_f32 v252, s15, v5
    v_add_f32_dpp v254, v254, v254 row_ror:1 row_mask:0xf bank_mask:0xf
    v_rcp_f32 v252, v252
    v_fmac_f32 v254, s34, v5
    v_mul_f32 v254, v254, v252
    v_cvt_pk_bf16_f32 v254, v254, v254
    buffer_store_short v254, v11, s[36:39], 0 offen
L_end:
s_endpgm
.section .rodata,"a"
.p2align 6
.amdhsa_kernel standalone__factorization_afm__recsys_kernel
  .amdhsa_next_free_vgpr 448
  .amdhsa_next_free_sgpr 102
  .amdhsa_accum_offset 256
  .amdhsa_group_segment_fixed_size 0
  .amdhsa_kernarg_size 88
  .amdhsa_user_sgpr_count 2
  .amdhsa_user_sgpr_kernarg_segment_ptr 1
  .amdhsa_system_sgpr_workgroup_id_x 1
  .amdhsa_float_denorm_mode_32 3
.end_amdhsa_kernel
```

```asm
; @launch grid=(256,1,1) block=(256,1,1) lds=67200
.amdgcn_target "amdgcn-amd-amdhsa--gfx950"
.text
.globl standalone__factorization_afm__recsys_kernel
.p2align 8
.type standalone__factorization_afm__recsys_kernel,@function
standalone__factorization_afm__recsys_kernel:
    s_load_dwordx16 s[16:31], s[0:1], 0
    s_load_dwordx2 s[36:37], s[0:1], 64
    s_cmp_ge_u32 s2, 256
    s_cbranch_scc1 L_end
    s_getpc_b64 s[10:11]
L_pc:
    s_lshl_b32 s8, s2, 8
    v_lshrrev_b32 v70, 6, v0
    v_and_b32 v69, 3, v0
    v_lshl_or_b32 v69, v70, 2, v69
    s_and_b32 s8, s8, 0x7800
    v_lshl_or_b32 v69, v69, 7, s8
    v_min_u32 v69, L_end-L_pc, v69
    global_load_dword v72, v69, s[10:11]
    v_lshrrev_b32 v70, 6, v0
    v_and_b32 v50, 15, v0
    v_readfirstlane_b32 s3, v70
    v_bfe_u32 v51, v0, 4, 2
    v_and_b32 v52, 63, v0
    s_and_b32 s4, s2, 7
    s_lshl_b32 s4, s4, 7
    s_lshr_b32 s6, s2, 3
    s_lshl_b32 s6, s6, 2
    s_add_u32 s4, s4, s6
    s_add_u32 s4, s4, s3
    s_mul_i32 s6, s4, 104
    v_and_b32 v53, 0x38, v0
    v_add_u32 v53, s6, v53
    v_mul_u32_u24 v62, 12, v51
    v_min_u32 v62, 28, v62
    v_add_u32 v62, s6, v62
    s_mul_i32 s9, s3, 8448
    v_and_b32 v69, 2, v51
    v_add_u32 v69, v69, v51
    v_lshlrev_b32 v70, 4, v50
    v_lshl_add_u32 v56, v69, 10, v70
    s_bfe_u32 s8, s2, 0x30003
    s_mul_i32 s44, s8, 1056
    s_and_b32 s12, s8, 4
    s_add_u32 s12, s12, s8
    s_lshl_b32 s7, s3, 5
    s_add_u32 s12, s12, s7
    s_lshl_b32 s45, s12, 8
    s_add_u32 m0, s44, s9
    v_lshlrev_b32 v54, 2, v52
    s_mul_i32 s5, s3, 7616
    s_add_u32 s5, s5, 36736
    s_mov_b32 s42, 25600000
    s_mov_b32 s43, 0x00020000
    s_mov_b32 s54, 32768
    s_mov_b32 s55, 0x00020000
    s_mov_b32 s38, 2048
    s_mov_b32 s39, 0x00020000
    s_mov_b32 s35, 0xff800000
    v_xor_b32 v69, v50, v51
    v_lshlrev_b32 v57, 4, v69
    v_and_b32 v63, 0x70, v57
    s_movk_i32 s47, 128
    s_lshl_b32 s8, s4, 1
    v_mov_b32 v11, 0x7ffffff0
    v_writelane_b32 v11, s8, 0
    v_lshlrev_b32 v55, 4, v51
    v_lshrrev_b32 v60, 2, v50
    v_and_b32 v61, 3, v50
    s_movk_i32 s12, 1056
    v_and_b32 v69, 2, v60
    v_lshl_add_u32 v69, v69, 1, v61
    v_mad_u32_u24 v69, v69, s12, v55
    v_and_b32 v70, 1, v60
    v_lshl_add_u32 v70, v70, 8, s9
    v_add_u32 v58, v69, v70
    v_and_b32 v69, 1, v51
    v_lshl_add_u32 v69, v69, 2, v60
    v_and_b32 v70, 2, v51
    v_lshlrev_b32 v70, 8, v70
    s_waitcnt lgkmcnt(0)
    global_load_dwordx2 v[208:209], v53, s[16:17] nt
    s_mov_b32 s52, s24
    s_mov_b32 s53, s25
    global_load_dwordx3 v[212:214], v62, s[16:17] offset:64 nt
    global_load_dword v220, v54, s[28:29]
    global_load_dword v223, v54, s[26:27]
    global_load_dword v221, v54, s[30:31]
    buffer_load_dwordx4 v56, s[52:55], s45 offen lds
    s_xor_b32 s46, s44, 1056
    s_add_u32 m0, s46, s9
    s_xor_b32 s46, s45, 256
    v_lshl_add_u32 v70, v61, 3, v70
    v_mad_u32_u24 v59, v69, s12, v70
    v_lshlrev_b32 v67, 3, v52
    v_and_b32 v71, 1, v52
    v_lshlrev_b32 v69, 2, v71
    v_bfe_u32 v70, v52, 1, 2
    v_and_or_b32 v70, v52, 56, v70
    v_add_lshl_u32 v65, v69, v70, 2
    buffer_load_dwordx4 v56, s[52:55], s46 offen lds
    s_xor_b32 s46, s44, 2112
    s_add_u32 m0, s46, s9
    s_xor_b32 s46, s45, 512
    v_bfe_u32 v70, v52, 3, 1
    v_and_or_b32 v70, v52, 50, v70
    v_or_b32 v69, v69, v70
    v_and_b32 v70, 4, v52
    v_lshl_or_b32 v69, v70, 1, v69
    v_lshlrev_b32 v64, 2, v69
    v_and_b32 v69, 2, v50
    s_lshl_b32 s8, s3, 6
    buffer_load_dwordx4 v56, s[52:55], s46 offen lds
    s_xor_b32 s46, s44, 3168
    s_add_u32 m0, s46, s9
    s_xor_b32 s46, s45, 768
    v_lshl_add_u32 v70, v69, 3, s8
    v_lshl_add_u32 v70, v60, 2, v70
    v_lshl_add_u32 v66, v71, 1, v70
    v_lshlrev_b32 v70, 4, v71
    v_lshl_or_b32 v70, v51, 5, v70
    s_movk_i32 s13, 192
    v_mad_u32_u24 v70, v69, s13, v70
    v_and_b32 v69, 2, v51
    buffer_load_dwordx4 v56, s[52:55], s46 offen lds
    s_xor_b32 s46, s44, 4224
    s_add_u32 m0, s46, s9
    s_xor_b32 s46, s45, 2048
    v_lshlrev_b32 v69, 5, v69
    v_sub_u32 v12, 1344, v69
    v_mov_b32_dpp v12, v70 quad_perm:[0,1,2,3] row_mask:0xf bank_mask:0x1
    s_mov_b32 s13, 0xaaaa
    v_mov_b32 v1, 0x4444
    v_mad_u32_u24 v1, v71, s13, v1
    v_mov_b32_dpp v13, v12 row_ror:4 row_mask:0xf bank_mask:0xf
    v_mov_b32_dpp v14, v12 row_ror:8 row_mask:0xf bank_mask:0xf
    buffer_load_dwordx4 v56, s[52:55], s46 offen lds
    s_xor_b32 s46, s44, 5280
    s_add_u32 m0, s46, s9
    s_xor_b32 s46, s45, 2304
    v_mov_b32_dpp v15, v12 row_ror:12 row_mask:0xf bank_mask:0xf
    v_mov_b64 v[232:233], 0
    v_mov_b64 v[234:235], 0
    v_mul_u32_u24 v69, 896, v51
    v_min_u32 v69, 1536, v69
    v_lshl_add_u32 v68, v50, 4, v69
    ds_write_b128 v68, v[232:235] offset:34176
    v_lshl_add_u32 v69, v50, 7, s5
    buffer_load_dwordx4 v56, s[52:55], s46 offen lds
    s_xor_b32 s46, s44, 6336
    s_add_u32 m0, s46, s9
    s_xor_b32 s46, s45, 2560
    v_and_b32 v70, 8, v50
    v_lshl_add_u32 v69, v70, 3, v69
    v_lshlrev_b32 v70, 3, v50
    v_xor_b32 v70, v70, v55
    v_and_or_b32 v216, v70, 48, v69
    v_lshlrev_b32 v71, 2, v50
    s_add_u32 s8, s5, 4352
    s_mov_b32 s12, 0x4a2b9198
    buffer_load_dwordx4 v56, s[52:55], s46 offen lds
    s_xor_b32 s46, s44, 7392
    s_add_u32 m0, s46, s9
    s_xor_b32 s46, s45, 2816
    s_mov_b32 s13, 0x608ab956
    v_lshrrev_b64 v[48:49], v71, s[12:13]
    v_and_b32 v69, 15, v48
    v_lshl_add_u32 v70, v69, 8, s8
    v_bfe_u32 v69, v48, 2, 2
    v_lshl_add_u32 v70, v69, 6, v70
    v_xor_b32 v69, v48, v51
    v_and_b32 v69, 3, v69
    buffer_load_dwordx4 v56, s[52:55], s46 offen lds
    s_mov_b32 s40, s18
    s_mov_b32 s41, s19
    v_lshl_add_u32 v2, v69, 4, v70
    s_mov_b32 s12, 0x6480559
    s_mov_b32 s13, 0x41ab2821
    v_lshrrev_b64 v[48:49], v71, s[12:13]
    v_and_b32 v69, 15, v48
    v_lshl_add_u32 v70, v69, 8, s8
    v_bfe_u32 v69, v48, 2, 2
    v_lshl_add_u32 v70, v69, 6, v70
    v_xor_b32 v69, v48, v51
    v_and_b32 v69, 3, v69
    v_lshl_add_u32 v6, v69, 4, v70
    v_mov_b64 v[236:237], 0
    v_mov_b64 v[238:239], 0
    v_mov_b64 v[240:241], 0
    v_mov_b64 v[242:243], 0
    v_mov_b64 v[244:245], 0
    v_mov_b64 v[246:247], 0
    v_mov_b64 v[248:249], 0
    v_mov_b64 v[250:251], 0
    v_writelane_b32 v248, s35, 29
    v_writelane_b32 v248, s35, 48
    v_writelane_b32 v248, s35, 58
    v_mov_b64 v[252:253], 0
    v_mov_b64 v[254:255], 0
    v_mov_b32 v10, 0x3f38aa3b
    s_mov_b32 m0, s5
    s_waitcnt vmcnt(12)
    v_lshl_add_u32 v208, v208, 8, v63
    buffer_load_dwordx4 v208, s[40:43], 0 offen nt lds
    s_add_u32 m0, s5, 1088
    v_lshl_add_u32 v209, v209, 8, v63
    buffer_load_dwordx4 v209, s[40:43], 0 offen nt lds
    s_cmp_eq_u32 s3, 0
    s_cbranch_scc1 L_stub0
    s_cmp_eq_u32 s3, 1
    s_cbranch_scc1 L_stub1
    s_cmp_eq_u32 s3, 2
    s_cbranch_scc1 L_stub2
    s_cmp_eq_u32 s3, 3
    s_cbranch_scc1 L_stub3
L_back:
    s_branch L_main2
.p2align 12
L_main:
    s_cbranch_scc1 L_back
L_main2:
    s_waitcnt vmcnt(10)
    ds_write_b32 v54, v220 offset:36480
    v_lshlrev_b32 v222, 16, v223
    v_and_b32 v223, 0xffff0000, v223
    ds_write_b64 v67, v[222:223] offset:35968
    ds_write_b32 v64, v220 offset:33792
    ds_write_b32 v65, v221 offset:34816
    ds_read_b128 v[144:147], v55 offset:36480
    ds_read_b128 v[148:151], v55 offset:36544
    ds_read_b128 v[152:155], v55 offset:36608
    ds_read_b128 v[156:159], v55 offset:36672
    ds_read_b128 v[112:115], v55 offset:35968
    ds_read_b128 v[116:119], v55 offset:36032
    ds_read_b128 v[120:123], v55 offset:36096
    ds_read_b128 v[124:127], v55 offset:36160
    ds_read_b128 v[128:131], v55 offset:36224
    ds_read_b128 v[132:135], v55 offset:36288
    ds_read_b128 v[136:139], v55 offset:36352
    ds_read_b128 v[140:143], v55 offset:36416
    ds_read_b128 a[128:131], v12 offset:33792
    ds_read_b128 a[132:135], v12 offset:33920
    s_add_u32 m0, s5, 2176
    s_nop 0
    buffer_load_dwordx4 v208, s[40:43], s47 offen nt lds
    s_add_u32 m0, s5, 3264
    s_nop 0
    buffer_load_dwordx4 v209, s[40:43], s47 offen nt lds
    s_waitcnt vmcnt(4)
    ds_read_b128 v[80:83], v58 offset:0
    ds_read_b128 v[84:87], v58 offset:64
    ds_read_b128 v[88:91], v58 offset:128
    ds_read_b128 v[92:95], v58 offset:192
    ds_read_b128 v[96:99], v58 offset:512
    ds_read_b128 v[100:103], v58 offset:576
    ds_read_b128 v[104:107], v58 offset:640
    ds_read_b128 v[108:111], v58 offset:704
    s_barrier
    ds_read_b64_tr_b16 a[0:1], v59 offset:0
    ds_read_b64_tr_b16 a[2:3], v59 offset:256
    ds_read_b64_tr_b16 a[16:17], v59 offset:32
    ds_read_b64_tr_b16 a[18:19], v59 offset:288
    ds_read_b64_tr_b16 a[32:33], v59 offset:64
    ds_read_b64_tr_b16 a[34:35], v59 offset:320
    ds_read_b64_tr_b16 a[48:49], v59 offset:96
    ds_read_b64_tr_b16 a[50:51], v59 offset:352
    s_waitcnt lgkmcnt(8)
    v_mfma_f32_16x16x32_bf16 v[176:179], v[144:147], v[80:83], 0
    ds_read_b64_tr_b16 a[64:65], v59 offset:128
    ds_read_b64_tr_b16 a[66:67], v59 offset:384
    v_mfma_f32_16x16x32_bf16 v[176:179], v[148:151], v[84:87], v[176:179]
    ds_read_b64_tr_b16 a[80:81], v59 offset:160
    ds_read_b64_tr_b16 a[82:83], v59 offset:416
    v_mfma_f32_16x16x32_bf16 v[176:179], v[152:155], v[88:91], v[176:179]
    ds_read_b64_tr_b16 a[96:97], v59 offset:192
    ds_read_b64_tr_b16 a[98:99], v59 offset:448
    v_mfma_f32_16x16x32_bf16 v[176:179], v[156:159], v[92:95], v[176:179]
    ds_read_b64_tr_b16 a[112:113], v59 offset:224
    ds_read_b64_tr_b16 a[114:115], v59 offset:480
    v_mfma_f32_16x16x32_bf16 v[180:183], v[144:147], v[96:99], 0
    ds_read_b64_tr_b16 a[4:5], v59 offset:8448
    ds_read_b64_tr_b16 a[6:7], v59 offset:8704
    v_mfma_f32_16x16x32_bf16 v[180:183], v[148:151], v[100:103], v[180:183]
    ds_read_b64_tr_b16 a[20:21], v59 offset:8480
    ds_read_b64_tr_b16 a[22:23], v59 offset:8736
    v_mfma_f32_16x16x32_bf16 v[180:183], v[152:155], v[104:107], v[180:183]
    ds_read_b64_tr_b16 a[36:37], v59 offset:8512
    ds_read_b64_tr_b16 a[38:39], v59 offset:8768
    v_mfma_f32_16x16x32_bf16 v[180:183], v[156:159], v[108:111], v[180:183]
    ds_read_b64_tr_b16 a[52:53], v59 offset:8544
    ds_read_b64_tr_b16 a[54:55], v59 offset:8800
    ds_read_b64_tr_b16 a[68:69], v59 offset:8576
    ds_read_b64_tr_b16 a[70:71], v59 offset:8832
    ds_read_b64_tr_b16 a[84:85], v59 offset:8608
    ds_read_b64_tr_b16 a[86:87], v59 offset:8864
    ds_read_b64_tr_b16 a[100:101], v59 offset:8640
    ds_read_b64_tr_b16 a[102:103], v59 offset:8896
    ds_read_b64_tr_b16 a[116:117], v59 offset:8672
    v_cvt_pk_bf16_f32 v71, v176, v180
    ds_write_b16 v66, v71 offset:34432
    ds_write_b16_d16_hi v66, v71 offset:34464
    ds_read_b64_tr_b16 a[118:119], v59 offset:8928
    ds_read_b64_tr_b16 a[8:9], v59 offset:16896
    ds_read_b64_tr_b16 a[10:11], v59 offset:17152
    ds_read_b64_tr_b16 a[24:25], v59 offset:16928
    ds_read_b64_tr_b16 a[26:27], v59 offset:17184
    ds_read_b64_tr_b16 a[40:41], v59 offset:16960
    ds_read_b64_tr_b16 a[42:43], v59 offset:17216
    ds_read_b64_tr_b16 a[56:57], v59 offset:16992
    ds_read_b64_tr_b16 a[58:59], v59 offset:17248
    ds_read_b64_tr_b16 a[72:73], v59 offset:17024
    ds_read_b64_tr_b16 a[74:75], v59 offset:17280
    ds_read_b64_tr_b16 a[88:89], v59 offset:17056
    ds_read_b64_tr_b16 a[90:91], v59 offset:17312
    ds_read_b64_tr_b16 a[104:105], v59 offset:17088
    ds_read_b64_tr_b16 a[106:107], v59 offset:17344
    ds_read_b64_tr_b16 a[120:121], v59 offset:17120
    ds_read_b64_tr_b16 a[122:123], v59 offset:17376
    s_waitcnt lgkmcnt(15)
    s_barrier
    ds_read_b128 a[136:139], v12 offset:34432
    ds_read_b128 a[140:143], v12 offset:34560
    ds_read_b64_tr_b16 a[12:13], v59 offset:25344
    ds_read_b64_tr_b16 a[14:15], v59 offset:25600
    ds_read_b64_tr_b16 a[28:29], v59 offset:25376
    ds_read_b64_tr_b16 a[30:31], v59 offset:25632
    ds_read_b64_tr_b16 a[44:45], v59 offset:25408
    ds_read_b64_tr_b16 a[46:47], v59 offset:25664
    ds_read_b64_tr_b16 a[60:61], v59 offset:25440
    ds_read_b64_tr_b16 a[62:63], v59 offset:25696
    ds_read_b64_tr_b16 a[76:77], v59 offset:25472
    ds_read_b64_tr_b16 a[78:79], v59 offset:25728
    ds_read_b64_tr_b16 a[92:93], v59 offset:25504
    ds_read_b64_tr_b16 a[94:95], v59 offset:25760
    ds_read_b64_tr_b16 a[108:109], v59 offset:25536
    ds_read_b64_tr_b16 a[110:111], v59 offset:25792
    ds_read_b64_tr_b16 a[124:125], v59 offset:25568
    ds_read_b64_tr_b16 a[126:127], v59 offset:25824
    s_mov_b32 exec_hi, 0x0000ffff
    s_add_u32 m0, s5, 4352
    v_lshl_add_u32 v212, v212, 8, v57
    buffer_load_dwordx4 v212, s[40:43], 0 offen nt lds
    s_add_u32 m0, s5, 5440
    v_lshl_add_u32 v213, v213, 8, v57
    buffer_load_dwordx4 v213, s[40:43], 0 offen nt lds
    s_mov_b32 exec_hi, -1
    s_add_u32 m0, s5, 6528
    v_lshl_add_u32 v214, v214, 8, v57
    buffer_load_dwordx4 v214, s[40:43], 0 offen nt lds
    s_waitcnt vmcnt(5)
    ds_read_b128 v[32:35], v216 offset:0
    ds_read_b128 v[36:39], v216 offset:64
    s_cmp_eq_u32 s3, 4
    s_waitcnt lgkmcnt(1)
    v_lshlrev_b32 v16, 16, v32
    v_and_b32 v17, 0xffff0000, v32
    v_lshlrev_b32 v18, 16, v33
    v_and_b32 v19, 0xffff0000, v33
    v_lshlrev_b32 v20, 16, v34
    v_and_b32 v21, 0xffff0000, v34
    v_lshlrev_b32 v22, 16, v35
    v_and_b32 v23, 0xffff0000, v35
    v_mul_f32_dpp v224, v16, v16 row_ror:1 row_mask:0xf bank_mask:0xf
    v_mul_f32_dpp v225, v17, v17 row_ror:1 row_mask:0xf bank_mask:0xf
    v_mul_f32_dpp v226, v18, v18 row_ror:1 row_mask:0xf bank_mask:0xf
    v_mul_f32_dpp v227, v19, v19 row_ror:1 row_mask:0xf bank_mask:0xf
    v_mul_f32_dpp v228, v20, v20 row_ror:1 row_mask:0xf bank_mask:0xf
    v_mul_f32_dpp v229, v21, v21 row_ror:1 row_mask:0xf bank_mask:0xf
    v_mul_f32_dpp v230, v22, v22 row_ror:1 row_mask:0xf bank_mask:0xf
    v_mul_f32_dpp v231, v23, v23 row_ror:1 row_mask:0xf bank_mask:0xf
    v_cvt_pk_bf16_f32 v144, v224, v225
    v_cvt_pk_bf16_f32 v145, v226, v227
    v_cvt_pk_bf16_f32 v146, v228, v229
    v_cvt_pk_bf16_f32 v147, v230, v231
    s_waitcnt lgkmcnt(0)
    v_lshlrev_b32 v24, 16, v36
    v_mfma_f32_16x16x32_bf16 v[176:179], a[0:3], v[144:147], v[112:115]
    v_and_b32 v25, 0xffff0000, v36
    v_lshlrev_b32 v26, 16, v37
    v_mfma_f32_16x16x32_bf16 v[180:183], a[16:19], v[144:147], v[116:119]
    v_and_b32 v27, 0xffff0000, v37
    v_lshlrev_b32 v28, 16, v38
    v_mfma_f32_16x16x32_bf16 v[184:187], a[32:35], v[144:147], v[120:123]
    v_and_b32 v29, 0xffff0000, v38
    v_lshlrev_b32 v30, 16, v39
    v_mfma_f32_16x16x32_bf16 v[188:191], a[48:51], v[144:147], v[124:127]
    v_and_b32 v31, 0xffff0000, v39
    v_mul_f32_dpp v224, v24, v24 row_ror:1 row_mask:0xf bank_mask:0xf
    v_mfma_f32_16x16x32_bf16 v[192:195], a[64:67], v[144:147], v[128:131]
    v_mul_f32_dpp v225, v25, v25 row_ror:1 row_mask:0xf bank_mask:0xf
    v_mul_f32_dpp v226, v26, v26 row_ror:1 row_mask:0xf bank_mask:0xf
    v_mfma_f32_16x16x32_bf16 v[196:199], a[80:83], v[144:147], v[132:135]
    v_mul_f32_dpp v227, v27, v27 row_ror:1 row_mask:0xf bank_mask:0xf
    v_mul_f32_dpp v228, v28, v28 row_ror:1 row_mask:0xf bank_mask:0xf
    v_mfma_f32_16x16x32_bf16 v[200:203], a[96:99], v[144:147], v[136:139]
    v_mul_f32_dpp v229, v29, v29 row_ror:1 row_mask:0xf bank_mask:0xf
    v_mul_f32_dpp v230, v30, v30 row_ror:1 row_mask:0xf bank_mask:0xf
    v_mfma_f32_16x16x32_bf16 v[204:207], a[112:115], v[144:147], v[140:143]
    v_mul_f32_dpp v231, v31, v31 row_ror:1 row_mask:0xf bank_mask:0xf
    v_cvt_pk_bf16_f32 v148, v224, v225
    v_cvt_pk_bf16_f32 v149, v226, v227
    v_cvt_pk_bf16_f32 v150, v228, v229
    v_cvt_pk_bf16_f32 v151, v230, v231
    v_mul_f32_dpp v224, v16, v16 row_ror:2 row_mask:0xf bank_mask:0xf
    v_mul_f32_dpp v225, v17, v17 row_ror:2 row_mask:0xf bank_mask:0xf
    v_mfma_f32_16x16x32_bf16 v[204:207], a[116:119], v[148:151], v[204:207]
    v_mul_f32_dpp v226, v18, v18 row_ror:2 row_mask:0xf bank_mask:0xf
    v_mul_f32_dpp v227, v19, v19 row_ror:2 row_mask:0xf bank_mask:0xf
    v_smfmac_f32_16x16x64_bf16 v[232:235], a[136:139], v[144:151], v1
    v_mul_f32_dpp v228, v20, v20 row_ror:2 row_mask:0xf bank_mask:0xf
    v_mfma_f32_16x16x32_bf16 v[176:179], a[4:7], v[148:151], v[176:179]
    v_mul_f32_dpp v229, v21, v21 row_ror:2 row_mask:0xf bank_mask:0xf
    v_mul_f32_dpp v230, v22, v22 row_ror:2 row_mask:0xf bank_mask:0xf
    v_mfma_f32_16x16x32_bf16 v[180:183], a[20:23], v[148:151], v[180:183]
    s_waitcnt vmcnt(3)
    ds_read_b128 v[40:43], v216 offset:2176
    ds_read_b128 v[44:47], v216 offset:2240
    v_mfma_f32_16x16x32_bf16 v[184:187], a[36:39], v[148:151], v[184:187]
    v_mul_f32_dpp v231, v23, v23 row_ror:2 row_mask:0xf bank_mask:0xf
    v_cvt_pk_bf16_f32 v160, v224, v225
    v_mfma_f32_16x16x32_bf16 v[188:191], a[52:55], v[148:151], v[188:191]
    v_cvt_pk_bf16_f32 v161, v226, v227
    v_cvt_pk_bf16_f32 v162, v228, v229
    v_mfma_f32_16x16x32_bf16 v[192:195], a[68:71], v[148:151], v[192:195]
    v_cvt_pk_bf16_f32 v163, v230, v231
    v_mul_f32_dpp v224, v24, v24 row_ror:2 row_mask:0xf bank_mask:0xf
    v_mfma_f32_16x16x32_bf16 v[196:199], a[84:87], v[148:151], v[196:199]
    v_mul_f32_dpp v225, v25, v25 row_ror:2 row_mask:0xf bank_mask:0xf
    v_mul_f32_dpp v226, v26, v26 row_ror:2 row_mask:0xf bank_mask:0xf
    v_mfma_f32_16x16x32_bf16 v[200:203], a[100:103], v[148:151], v[200:203]
    v_mul_f32_dpp v227, v27, v27 row_ror:2 row_mask:0xf bank_mask:0xf
    v_mul_f32_dpp v228, v28, v28 row_ror:2 row_mask:0xf bank_mask:0xf
    v_mul_f32_dpp v229, v29, v29 row_ror:2 row_mask:0xf bank_mask:0xf
    v_mul_f32_dpp v230, v30, v30 row_ror:2 row_mask:0xf bank_mask:0xf
    v_mul_f32_dpp v231, v31, v31 row_ror:2 row_mask:0xf bank_mask:0xf
    v_cvt_pk_bf16_f32 v164, v224, v225
    v_cvt_pk_bf16_f32 v165, v226, v227
    s_waitcnt lgkmcnt(0)
    v_lshlrev_b32 v32, 16, v40
    v_and_b32 v33, 0xffff0000, v40
    v_lshlrev_b32 v34, 16, v41
    v_and_b32 v35, 0xffff0000, v41
    v_lshlrev_b32 v36, 16, v42
    v_and_b32 v37, 0xffff0000, v42
    v_lshlrev_b32 v38, 16, v43
    v_and_b32 v39, 0xffff0000, v43
    v_cvt_pk_bf16_f32 v166, v228, v229
    v_cvt_pk_bf16_f32 v167, v230, v231
    v_mul_f32_dpp v224, v32, v32 row_ror:1 row_mask:0xf bank_mask:0xf
    v_mul_f32_dpp v225, v33, v33 row_ror:1 row_mask:0xf bank_mask:0xf
    v_mul_f32_dpp v226, v34, v34 row_ror:1 row_mask:0xf bank_mask:0xf
    v_mul_f32_dpp v227, v35, v35 row_ror:1 row_mask:0xf bank_mask:0xf
    v_mul_f32_dpp v228, v36, v36 row_ror:1 row_mask:0xf bank_mask:0xf
    v_mul_f32_dpp v229, v37, v37 row_ror:1 row_mask:0xf bank_mask:0xf
    v_mul_f32_dpp v230, v38, v38 row_ror:1 row_mask:0xf bank_mask:0xf
    v_mul_f32_dpp v231, v39, v39 row_ror:1 row_mask:0xf bank_mask:0xf
    v_cvt_pk_bf16_f32 v152, v224, v225
    v_cvt_pk_bf16_f32 v153, v226, v227
    v_cvt_pk_bf16_f32 v154, v228, v229
    v_cvt_pk_bf16_f32 v155, v230, v231
    v_lshlrev_b32 v40, 16, v44
    v_and_b32 v41, 0xffff0000, v44
    v_mfma_f32_16x16x32_bf16 v[200:203], a[104:107], v[152:155], v[200:203]
    v_lshlrev_b32 v42, 16, v45
    v_and_b32 v43, 0xffff0000, v45
    v_mfma_f32_16x16x32_bf16 v[176:179], a[8:11], v[152:155], v[176:179]
    v_lshlrev_b32 v44, 16, v46
    v_and_b32 v45, 0xffff0000, v46
    v_mfma_f32_16x16x32_bf16 v[180:183], a[24:27], v[152:155], v[180:183]
    v_lshlrev_b32 v46, 16, v47
    v_and_b32 v47, 0xffff0000, v47
    v_mfma_f32_16x16x32_bf16 v[184:187], a[40:43], v[152:155], v[184:187]
    v_mul_f32_dpp v224, v40, v40 row_ror:1 row_mask:0xf bank_mask:0xf
    v_mul_f32_dpp v225, v41, v41 row_ror:1 row_mask:0xf bank_mask:0xf
    v_mfma_f32_16x16x32_bf16 v[188:191], a[56:59], v[152:155], v[188:191]
    ds_read_b128 a[152:155], v13 offset:34432
    v_mul_f32_dpp v226, v42, v42 row_ror:1 row_mask:0xf bank_mask:0xf
    v_mfma_f32_16x16x32_bf16 v[192:195], a[72:75], v[152:155], v[192:195]
    v_mul_f32_dpp v227, v43, v43 row_ror:1 row_mask:0xf bank_mask:0xf
    v_mul_f32_dpp v228, v44, v44 row_ror:1 row_mask:0xf bank_mask:0xf
    v_mfma_f32_16x16x32_bf16 v[196:199], a[88:91], v[152:155], v[196:199]
    v_mul_f32_dpp v229, v45, v45 row_ror:1 row_mask:0xf bank_mask:0xf
    v_mul_f32_dpp v230, v46, v46 row_ror:1 row_mask:0xf bank_mask:0xf
    v_mfma_f32_16x16x32_bf16 v[204:207], a[120:123], v[152:155], v[204:207]
    v_mul_f32_dpp v231, v47, v47 row_ror:1 row_mask:0xf bank_mask:0xf
    v_cvt_pk_bf16_f32 v156, v224, v225
    v_cvt_pk_bf16_f32 v157, v226, v227
    v_cvt_pk_bf16_f32 v158, v228, v229
    v_cvt_pk_bf16_f32 v159, v230, v231
    v_mul_f32_dpp v224, v32, v32 row_ror:2 row_mask:0xf bank_mask:0xf
    v_mul_f32_dpp v225, v33, v33 row_ror:2 row_mask:0xf bank_mask:0xf
    v_mfma_f32_16x16x32_bf16 v[204:207], a[124:127], v[156:159], v[204:207]
    v_mul_f32_dpp v226, v34, v34 row_ror:2 row_mask:0xf bank_mask:0xf
    v_mul_f32_dpp v227, v35, v35 row_ror:2 row_mask:0xf bank_mask:0xf
    v_smfmac_f32_16x16x64_bf16 v[232:235], a[140:143], v[152:159], v1
    v_mul_f32_dpp v228, v36, v36 row_ror:2 row_mask:0xf bank_mask:0xf
    v_mfma_f32_16x16x32_bf16 v[176:179], a[12:15], v[156:159], v[176:179]
    ds_read_b128 a[156:159], v13 offset:34560
    v_mul_f32_dpp v229, v37, v37 row_ror:2 row_mask:0xf bank_mask:0xf
    v_mfma_f32_16x16x32_bf16 v[180:183], a[28:31], v[156:159], v[180:183]
    v_mul_f32_dpp v230, v38, v38 row_ror:2 row_mask:0xf bank_mask:0xf
    v_mul_f32_dpp v231, v39, v39 row_ror:2 row_mask:0xf bank_mask:0xf
    v_mfma_f32_16x16x32_bf16 v[184:187], a[44:47], v[156:159], v[184:187]
    v_cvt_pk_bf16_f32 v168, v224, v225
    v_cvt_pk_bf16_f32 v169, v226, v227
    v_mfma_f32_16x16x32_bf16 v[188:191], a[60:63], v[156:159], v[188:191]
    v_cvt_pk_bf16_f32 v208, |v176|, |v177|
    v_cvt_pk_bf16_f32 v209, |v178|, |v179|
    v_mfma_f32_16x16x32_bf16 v[192:195], a[76:79], v[156:159], v[192:195]
    s_waitcnt lgkmcnt(0)
    v_cvt_pk_bf16_f32 v170, v228, v229
    v_cvt_pk_bf16_f32 v171, v230, v231
    v_mfma_f32_16x16x32_bf16 v[196:199], a[92:95], v[156:159], v[196:199]
    ds_read_b128 a[144:147], v13 offset:33792
    v_mul_f32_dpp v224, v40, v40 row_ror:2 row_mask:0xf bank_mask:0xf
    v_mfma_f32_16x16x32_bf16 v[200:203], a[108:111], v[156:159], v[200:203]
    v_mul_f32_dpp v225, v41, v41 row_ror:2 row_mask:0xf bank_mask:0xf
    v_mul_f32_dpp v226, v42, v42 row_ror:2 row_mask:0xf bank_mask:0xf
    v_mfma_f32_16x16x32_bf16 v[176:179], a[0:3], v[160:163], v[112:115]
    v_mul_f32_dpp v227, v43, v43 row_ror:2 row_mask:0xf bank_mask:0xf
    v_mul_f32_dpp v228, v44, v44 row_ror:2 row_mask:0xf bank_mask:0xf
    v_mfma_f32_16x16x32_bf16 v[176:179], a[4:7], v[164:167], v[176:179]
    v_mul_f32_dpp v229, v45, v45 row_ror:2 row_mask:0xf bank_mask:0xf
    v_mul_f32_dpp v230, v46, v46 row_ror:2 row_mask:0xf bank_mask:0xf
    v_mfma_f32_16x16x32_bf16 v[176:179], a[8:11], v[168:171], v[176:179]
    ds_read_b128 a[148:151], v13 offset:33920
    v_mul_f32_dpp v231, v47, v47 row_ror:2 row_mask:0xf bank_mask:0xf
    v_cvt_pk_bf16_f32 v172, v224, v225
    v_cvt_pk_bf16_f32 v173, v226, v227
    v_cvt_pk_bf16_f32 v174, v228, v229
    v_cvt_pk_bf16_f32 v175, v230, v231
    v_cvt_pk_bf16_f32 v210, |v180|, |v181|
    v_cvt_pk_bf16_f32 v211, |v182|, |v183|
    v_mfma_f32_16x16x32_bf16 v[176:179], a[12:15], v[172:175], v[176:179]
    v_cvt_pk_bf16_f32 v212, |v184|, |v185|
    v_cvt_pk_bf16_f32 v213, |v186|, |v187|
    v_mfma_f32_16x16x32_bf16 v[180:183], a[28:31], v[172:175], v[116:119]
    s_waitcnt lgkmcnt(0)
    v_cvt_pk_bf16_f32 v214, |v188|, |v189|
    v_cvt_pk_bf16_f32 v215, |v190|, |v191|
    v_mfma_f32_16x16x32_bf16 v[180:183], a[24:27], v[168:171], v[180:183]
    v_cvt_pk_bf16_f32 v216, |v192|, |v193|
    v_cvt_pk_bf16_f32 v217, |v194|, |v195|
    v_mfma_f32_16x16x32_bf16 v[180:183], a[20:23], v[164:167], v[180:183]
    v_cvt_pk_bf16_f32 v218, |v196|, |v197|
    v_cvt_pk_bf16_f32 v219, |v198|, |v199|
    v_mfma_f32_16x16x32_bf16 v[180:183], a[16:19], v[160:163], v[180:183]
    ds_read_b128 a[168:171], v14 offset:34432
    v_cvt_pk_bf16_f32 v220, |v200|, |v201|
    v_smfmac_f32_16x16x64_bf16 v[232:235], a[128:131], v[208:215], v1
    v_cvt_pk_bf16_f32 v221, |v202|, |v203|
    v_mfma_f32_16x16x32_bf16 v[184:187], a[32:35], v[160:163], v[120:123]
    v_cvt_pk_bf16_f32 v222, |v204|, |v205|
    v_cvt_pk_bf16_f32 v223, |v206|, |v207|
    v_mfma_f32_16x16x32_bf16 v[184:187], a[36:39], v[164:167], v[184:187]
    v_mul_f32_dpp v224, v16, v16 row_ror:3 row_mask:0xf bank_mask:0xf
    v_mul_f32_dpp v225, v17, v17 row_ror:3 row_mask:0xf bank_mask:0xf
    v_mfma_f32_16x16x32_bf16 v[184:187], a[40:43], v[168:171], v[184:187]
    v_mul_f32_dpp v226, v18, v18 row_ror:3 row_mask:0xf bank_mask:0xf
    v_mul_f32_dpp v227, v19, v19 row_ror:3 row_mask:0xf bank_mask:0xf
    v_mfma_f32_16x16x32_bf16 v[184:187], a[44:47], v[172:175], v[184:187]
    ds_read_b128 a[172:175], v14 offset:34560
    v_mul_f32_dpp v228, v20, v20 row_ror:3 row_mask:0xf bank_mask:0xf
    v_smfmac_f32_16x16x64_bf16 v[232:235], a[132:135], v[216:223], v1
    v_mul_f32_dpp v229, v21, v21 row_ror:3 row_mask:0xf bank_mask:0xf
    v_mfma_f32_16x16x32_bf16 v[188:191], a[60:63], v[172:175], v[124:127]
    v_mul_f32_dpp v230, v22, v22 row_ror:3 row_mask:0xf bank_mask:0xf
    v_mul_f32_dpp v231, v23, v23 row_ror:3 row_mask:0xf bank_mask:0xf
    v_mfma_f32_16x16x32_bf16 v[188:191], a[56:59], v[168:171], v[188:191]
    v_cvt_pk_bf16_f32 v144, v224, v225
    v_cvt_pk_bf16_f32 v145, v226, v227
    v_mfma_f32_16x16x32_bf16 v[188:191], a[52:55], v[164:167], v[188:191]
    s_waitcnt lgkmcnt(0)
    v_cvt_pk_bf16_f32 v146, v228, v229
    v_cvt_pk_bf16_f32 v147, v230, v231
    v_mfma_f32_16x16x32_bf16 v[188:191], a[48:51], v[160:163], v[188:191]
    ds_read_b128 a[160:163], v14 offset:33792
    v_mul_f32_dpp v224, v24, v24 row_ror:3 row_mask:0xf bank_mask:0xf
    v_smfmac_f32_16x16x64_bf16 v[232:235], a[152:155], v[160:167], v1
    v_mul_f32_dpp v225, v25, v25 row_ror:3 row_mask:0xf bank_mask:0xf
    v_mfma_f32_16x16x32_bf16 v[192:195], a[64:67], v[160:163], v[128:131]
    v_mul_f32_dpp v226, v26, v26 row_ror:3 row_mask:0xf bank_mask:0xf
    v_mul_f32_dpp v227, v27, v27 row_ror:3 row_mask:0xf bank_mask:0xf
    v_mfma_f32_16x16x32_bf16 v[192:195], a[68:71], v[164:167], v[192:195]
    v_mul_f32_dpp v228, v28, v28 row_ror:3 row_mask:0xf bank_mask:0xf
    v_mul_f32_dpp v229, v29, v29 row_ror:3 row_mask:0xf bank_mask:0xf
    v_mfma_f32_16x16x32_bf16 v[192:195], a[72:75], v[168:171], v[192:195]
    v_mul_f32_dpp v230, v30, v30 row_ror:3 row_mask:0xf bank_mask:0xf
    v_mul_f32_dpp v231, v31, v31 row_ror:3 row_mask:0xf bank_mask:0xf
    v_mfma_f32_16x16x32_bf16 v[192:195], a[76:79], v[172:175], v[192:195]
    ds_read_b128 a[164:167], v14 offset:33920
    v_cvt_pk_bf16_f32 v208, |v176|, |v177|
    v_smfmac_f32_16x16x64_bf16 v[232:235], a[156:159], v[168:175], v1
    v_cvt_pk_bf16_f32 v209, |v178|, |v179|
    v_mfma_f32_16x16x32_bf16 v[196:199], a[92:95], v[172:175], v[132:135]
    v_cvt_pk_bf16_f32 v148, v224, v225
    v_cvt_pk_bf16_f32 v149, v226, v227
    v_mfma_f32_16x16x32_bf16 v[196:199], a[88:91], v[168:171], v[196:199]
    v_cvt_pk_bf16_f32 v150, v228, v229
    v_cvt_pk_bf16_f32 v151, v230, v231
    v_mfma_f32_16x16x32_bf16 v[196:199], a[84:87], v[164:167], v[196:199]
    s_waitcnt lgkmcnt(0)
    v_mul_f32_dpp v224, v32, v32 row_ror:3 row_mask:0xf bank_mask:0xf
    v_mul_f32_dpp v225, v33, v33 row_ror:3 row_mask:0xf bank_mask:0xf
    v_mfma_f32_16x16x32_bf16 v[196:199], a[80:83], v[160:163], v[196:199]
    ds_read_b128 a[184:187], v15 offset:34432
    v_mul_f32_dpp v226, v34, v34 row_ror:3 row_mask:0xf bank_mask:0xf
    v_mfma_f32_16x16x32_bf16 v[200:203], a[96:99], v[160:163], v[136:139]
    v_mul_f32_dpp v227, v35, v35 row_ror:3 row_mask:0xf bank_mask:0xf
    v_mul_f32_dpp v228, v36, v36 row_ror:3 row_mask:0xf bank_mask:0xf
    v_mfma_f32_16x16x32_bf16 v[200:203], a[100:103], v[164:167], v[200:203]
    v_mul_f32_dpp v229, v37, v37 row_ror:3 row_mask:0xf bank_mask:0xf
    v_mul_f32_dpp v230, v38, v38 row_ror:3 row_mask:0xf bank_mask:0xf
    v_mfma_f32_16x16x32_bf16 v[200:203], a[104:107], v[168:171], v[200:203]
    v_mul_f32_dpp v231, v39, v39 row_ror:3 row_mask:0xf bank_mask:0xf
    v_cvt_pk_bf16_f32 v152, v224, v225
    v_mfma_f32_16x16x32_bf16 v[200:203], a[108:111], v[172:175], v[200:203]
    v_cvt_pk_bf16_f32 v153, v226, v227
    v_cvt_pk_bf16_f32 v154, v228, v229
    v_mfma_f32_16x16x32_bf16 v[204:207], a[124:127], v[172:175], v[140:143]
    ds_read_b128 a[188:191], v15 offset:34560
    v_cvt_pk_bf16_f32 v155, v230, v231
    v_mfma_f32_16x16x32_bf16 v[204:207], a[120:123], v[168:171], v[204:207]
    v_mul_f32_dpp v224, v40, v40 row_ror:3 row_mask:0xf bank_mask:0xf
    v_mul_f32_dpp v225, v41, v41 row_ror:3 row_mask:0xf bank_mask:0xf
    v_mfma_f32_16x16x32_bf16 v[204:207], a[116:119], v[164:167], v[204:207]
    v_mul_f32_dpp v226, v42, v42 row_ror:3 row_mask:0xf bank_mask:0xf
    v_mul_f32_dpp v227, v43, v43 row_ror:3 row_mask:0xf bank_mask:0xf
    v_mfma_f32_16x16x32_bf16 v[204:207], a[112:115], v[160:163], v[204:207]
    v_mul_f32_dpp v228, v44, v44 row_ror:3 row_mask:0xf bank_mask:0xf
    v_mul_f32_dpp v229, v45, v45 row_ror:3 row_mask:0xf bank_mask:0xf
    v_mfma_f32_16x16x32_bf16 v[176:179], a[0:3], v[144:147], v[112:115]
    s_waitcnt lgkmcnt(0)
    v_mul_f32_dpp v230, v46, v46 row_ror:3 row_mask:0xf bank_mask:0xf
    v_mul_f32_dpp v231, v47, v47 row_ror:3 row_mask:0xf bank_mask:0xf
    v_mfma_f32_16x16x32_bf16 v[176:179], a[4:7], v[148:151], v[176:179]
    ds_read_b128 a[176:179], v15 offset:33792
    v_cvt_pk_bf16_f32 v156, v224, v225
    v_mfma_f32_16x16x32_bf16 v[176:179], a[8:11], v[152:155], v[176:179]
    v_cvt_pk_bf16_f32 v157, v226, v227
    v_cvt_pk_bf16_f32 v158, v228, v229
    v_cvt_pk_bf16_f32 v159, v230, v231
    v_cvt_pk_bf16_f32 v210, |v180|, |v181|
    v_cvt_pk_bf16_f32 v211, |v182|, |v183|
    v_mfma_f32_16x16x32_bf16 v[176:179], a[12:15], v[156:159], v[176:179]
    v_cvt_pk_bf16_f32 v212, |v184|, |v185|
    v_cvt_pk_bf16_f32 v213, |v186|, |v187|
    v_mfma_f32_16x16x32_bf16 v[180:183], a[28:31], v[156:159], v[116:119]
    v_cvt_pk_bf16_f32 v214, |v188|, |v189|
    v_cvt_pk_bf16_f32 v215, |v190|, |v191|
    v_mfma_f32_16x16x32_bf16 v[180:183], a[24:27], v[152:155], v[180:183]
    v_cvt_pk_bf16_f32 v216, |v192|, |v193|
    v_cvt_pk_bf16_f32 v217, |v194|, |v195|
    v_mfma_f32_16x16x32_bf16 v[180:183], a[20:23], v[148:151], v[180:183]
    ds_read_b128 a[180:183], v15 offset:33920
    v_cvt_pk_bf16_f32 v218, |v196|, |v197|
    v_mfma_f32_16x16x32_bf16 v[180:183], a[16:19], v[144:147], v[180:183]
    v_cvt_pk_bf16_f32 v219, |v198|, |v199|
    v_cvt_pk_bf16_f32 v220, |v200|, |v201|
    v_smfmac_f32_16x16x64_bf16 v[232:235], a[144:147], v[208:215], v1
    v_cvt_pk_bf16_f32 v221, |v202|, |v203|
    v_mfma_f32_16x16x32_bf16 v[184:187], a[32:35], v[144:147], v[120:123]
    v_cvt_pk_bf16_f32 v222, |v204|, |v205|
    v_cvt_pk_bf16_f32 v223, |v206|, |v207|
    v_mfma_f32_16x16x32_bf16 v[184:187], a[36:39], v[148:151], v[184:187]
    s_waitcnt lgkmcnt(0)
    v_mul_f32_dpp v224, v16, v16 row_ror:4 row_mask:0xf bank_mask:0xf
    v_mul_f32_dpp v225, v17, v17 row_ror:4 row_mask:0xf bank_mask:0xf
    v_mfma_f32_16x16x32_bf16 v[184:187], a[40:43], v[152:155], v[184:187]
    v_mul_f32_dpp v226, v18, v18 row_ror:4 row_mask:0xf bank_mask:0xf
    v_mul_f32_dpp v227, v19, v19 row_ror:4 row_mask:0xf bank_mask:0xf
    v_mfma_f32_16x16x32_bf16 v[184:187], a[44:47], v[156:159], v[184:187]
    v_mul_f32_dpp v228, v20, v20 row_ror:4 row_mask:0xf bank_mask:0xf
    v_mul_f32_dpp v229, v21, v21 row_ror:4 row_mask:0xf bank_mask:0xf
    v_smfmac_f32_16x16x64_bf16 v[232:235], a[148:151], v[216:223], v1
    v_mul_f32_dpp v230, v22, v22 row_ror:4 row_mask:0xf bank_mask:0xf
    v_mfma_f32_16x16x32_bf16 v[188:191], a[60:63], v[156:159], v[124:127]
    v_mul_f32_dpp v231, v23, v23 row_ror:4 row_mask:0xf bank_mask:0xf
    v_cvt_pk_bf16_f32 v160, v224, v225
    v_mfma_f32_16x16x32_bf16 v[188:191], a[56:59], v[152:155], v[188:191]
    v_cvt_pk_bf16_f32 v161, v226, v227
    v_cvt_pk_bf16_f32 v162, v228, v229
    v_mfma_f32_16x16x32_bf16 v[188:191], a[52:55], v[148:151], v[188:191]
    v_cvt_pk_bf16_f32 v163, v230, v231
    v_mul_f32_dpp v224, v24, v24 row_ror:4 row_mask:0xf bank_mask:0xf
    v_mfma_f32_16x16x32_bf16 v[188:191], a[48:51], v[144:147], v[188:191]
    v_mul_f32_dpp v225, v25, v25 row_ror:4 row_mask:0xf bank_mask:0xf
    v_mul_f32_dpp v226, v26, v26 row_ror:4 row_mask:0xf bank_mask:0xf
    v_smfmac_f32_16x16x64_bf16 v[232:235], a[168:171], v[144:151], v1
    v_mul_f32_dpp v227, v27, v27 row_ror:4 row_mask:0xf bank_mask:0xf
    v_mfma_f32_16x16x32_bf16 v[192:195], a[64:67], v[144:147], v[128:131]
    v_mul_f32_dpp v228, v28, v28 row_ror:4 row_mask:0xf bank_mask:0xf
    v_mul_f32_dpp v229, v29, v29 row_ror:4 row_mask:0xf bank_mask:0xf
    v_mfma_f32_16x16x32_bf16 v[192:195], a[68:71], v[148:151], v[192:195]
    v_mul_f32_dpp v230, v30, v30 row_ror:4 row_mask:0xf bank_mask:0xf
    v_mul_f32_dpp v231, v31, v31 row_ror:4 row_mask:0xf bank_mask:0xf
    v_mfma_f32_16x16x32_bf16 v[192:195], a[72:75], v[152:155], v[192:195]
    v_cvt_pk_bf16_f32 v208, |v176|, |v177|
    v_cvt_pk_bf16_f32 v209, |v178|, |v179|
    v_mfma_f32_16x16x32_bf16 v[192:195], a[76:79], v[156:159], v[192:195]
    v_cvt_pk_bf16_f32 v164, v224, v225
    v_cvt_pk_bf16_f32 v165, v226, v227
    v_smfmac_f32_16x16x64_bf16 v[232:235], a[172:175], v[152:159], v1
    v_cvt_pk_bf16_f32 v166, v228, v229
    v_mfma_f32_16x16x32_bf16 v[196:199], a[92:95], v[156:159], v[132:135]
    v_cvt_pk_bf16_f32 v167, v230, v231
    v_mul_f32_dpp v224, v32, v32 row_ror:4 row_mask:0xf bank_mask:0xf
    v_mfma_f32_16x16x32_bf16 v[196:199], a[88:91], v[152:155], v[196:199]
    v_mul_f32_dpp v225, v33, v33 row_ror:4 row_mask:0xf bank_mask:0xf
    v_mul_f32_dpp v226, v34, v34 row_ror:4 row_mask:0xf bank_mask:0xf
    v_mfma_f32_16x16x32_bf16 v[196:199], a[84:87], v[148:151], v[196:199]
    v_mul_f32_dpp v227, v35, v35 row_ror:4 row_mask:0xf bank_mask:0xf
    v_mul_f32_dpp v228, v36, v36 row_ror:4 row_mask:0xf bank_mask:0xf
    v_mfma_f32_16x16x32_bf16 v[196:199], a[80:83], v[144:147], v[196:199]
    v_mul_f32_dpp v229, v37, v37 row_ror:4 row_mask:0xf bank_mask:0xf
    v_mul_f32_dpp v230, v38, v38 row_ror:4 row_mask:0xf bank_mask:0xf
    v_mfma_f32_16x16x32_bf16 v[200:203], a[96:99], v[144:147], v[136:139]
    v_mul_f32_dpp v231, v39, v39 row_ror:4 row_mask:0xf bank_mask:0xf
    v_cvt_pk_bf16_f32 v168, v224, v225
    v_mfma_f32_16x16x32_bf16 v[200:203], a[100:103], v[148:151], v[200:203]
    v_cvt_pk_bf16_f32 v169, v226, v227
    v_cvt_pk_bf16_f32 v170, v228, v229
    v_mfma_f32_16x16x32_bf16 v[200:203], a[104:107], v[152:155], v[200:203]
    v_cvt_pk_bf16_f32 v171, v230, v231
    v_mul_f32_dpp v224, v40, v40 row_ror:4 row_mask:0xf bank_mask:0xf
    v_mfma_f32_16x16x32_bf16 v[200:203], a[108:111], v[156:159], v[200:203]
    v_mul_f32_dpp v225, v41, v41 row_ror:4 row_mask:0xf bank_mask:0xf
    v_mul_f32_dpp v226, v42, v42 row_ror:4 row_mask:0xf bank_mask:0xf
    v_mfma_f32_16x16x32_bf16 v[204:207], a[124:127], v[156:159], v[140:143]
    v_mul_f32_dpp v227, v43, v43 row_ror:4 row_mask:0xf bank_mask:0xf
    v_mul_f32_dpp v228, v44, v44 row_ror:4 row_mask:0xf bank_mask:0xf
    v_mfma_f32_16x16x32_bf16 v[204:207], a[120:123], v[152:155], v[204:207]
    v_mul_f32_dpp v229, v45, v45 row_ror:4 row_mask:0xf bank_mask:0xf
    v_mul_f32_dpp v230, v46, v46 row_ror:4 row_mask:0xf bank_mask:0xf
    v_mfma_f32_16x16x32_bf16 v[204:207], a[116:119], v[148:151], v[204:207]
    v_mul_f32_dpp v231, v47, v47 row_ror:4 row_mask:0xf bank_mask:0xf
    v_cvt_pk_bf16_f32 v172, v224, v225
    v_mfma_f32_16x16x32_bf16 v[204:207], a[112:115], v[144:147], v[204:207]
    v_cvt_pk_bf16_f32 v173, v226, v227
    v_cvt_pk_bf16_f32 v174, v228, v229
    v_mfma_f32_16x16x32_bf16 v[176:179], a[0:3], v[160:163], v[112:115]
    v_cvt_pk_bf16_f32 v175, v230, v231
    v_cvt_pk_bf16_f32 v210, |v180|, |v181|
    v_mfma_f32_16x16x32_bf16 v[176:179], a[4:7], v[164:167], v[176:179]
    v_cvt_pk_bf16_f32 v211, |v182|, |v183|
    v_cvt_pk_bf16_f32 v212, |v184|, |v185|
    v_mfma_f32_16x16x32_bf16 v[176:179], a[8:11], v[168:171], v[176:179]
    v_cvt_pk_bf16_f32 v213, |v186|, |v187|
    v_cvt_pk_bf16_f32 v214, |v188|, |v189|
    v_mfma_f32_16x16x32_bf16 v[176:179], a[12:15], v[172:175], v[176:179]
    v_cvt_pk_bf16_f32 v215, |v190|, |v191|
    v_cvt_pk_bf16_f32 v216, |v192|, |v193|
    v_mfma_f32_16x16x32_bf16 v[180:183], a[28:31], v[172:175], v[116:119]
L_stub0:
    s_cbranch_scc1 L_main2
    v_cvt_pk_bf16_f32 v217, |v194|, |v195|
    v_cvt_pk_bf16_f32 v218, |v196|, |v197|
    v_mfma_f32_16x16x32_bf16 v[180:183], a[24:27], v[168:171], v[180:183]
    v_cvt_pk_bf16_f32 v219, |v198|, |v199|
    v_cvt_pk_bf16_f32 v220, |v200|, |v201|
    v_mfma_f32_16x16x32_bf16 v[180:183], a[20:23], v[164:167], v[180:183]
    v_cvt_pk_bf16_f32 v221, |v202|, |v203|
    v_cvt_pk_bf16_f32 v222, |v204|, |v205|
    v_mfma_f32_16x16x32_bf16 v[180:183], a[16:19], v[160:163], v[180:183]
    v_cvt_pk_bf16_f32 v223, |v206|, |v207|
    v_mul_f32_dpp v224, v16, v16 row_ror:5 row_mask:0xf bank_mask:0xf
    v_smfmac_f32_16x16x64_bf16 v[232:235], a[160:163], v[208:215], v1
    v_mul_f32_dpp v225, v17, v17 row_ror:5 row_mask:0xf bank_mask:0xf
    v_mfma_f32_16x16x32_bf16 v[184:187], a[32:35], v[160:163], v[120:123]
    v_mul_f32_dpp v226, v18, v18 row_ror:5 row_mask:0xf bank_mask:0xf
    v_mul_f32_dpp v227, v19, v19 row_ror:5 row_mask:0xf bank_mask:0xf
    v_mfma_f32_16x16x32_bf16 v[184:187], a[36:39], v[164:167], v[184:187]
    v_mul_f32_dpp v228, v20, v20 row_ror:5 row_mask:0xf bank_mask:0xf
    v_mul_f32_dpp v229, v21, v21 row_ror:5 row_mask:0xf bank_mask:0xf
    v_mfma_f32_16x16x32_bf16 v[184:187], a[40:43], v[168:171], v[184:187]
    v_mul_f32_dpp v230, v22, v22 row_ror:5 row_mask:0xf bank_mask:0xf
    v_mul_f32_dpp v231, v23, v23 row_ror:5 row_mask:0xf bank_mask:0xf
    v_mfma_f32_16x16x32_bf16 v[184:187], a[44:47], v[172:175], v[184:187]
    v_cvt_pk_bf16_f32 v144, v224, v225
    v_cvt_pk_bf16_f32 v145, v226, v227
    v_smfmac_f32_16x16x64_bf16 v[232:235], a[164:167], v[216:223], v1
    v_cvt_pk_bf16_f32 v146, v228, v229
    v_mfma_f32_16x16x32_bf16 v[188:191], a[60:63], v[172:175], v[124:127]
    v_cvt_pk_bf16_f32 v147, v230, v231
    v_mul_f32_dpp v224, v24, v24 row_ror:5 row_mask:0xf bank_mask:0xf
    v_mfma_f32_16x16x32_bf16 v[188:191], a[56:59], v[168:171], v[188:191]
    v_mul_f32_dpp v225, v25, v25 row_ror:5 row_mask:0xf bank_mask:0xf
    v_mul_f32_dpp v226, v26, v26 row_ror:5 row_mask:0xf bank_mask:0xf
    v_mfma_f32_16x16x32_bf16 v[188:191], a[52:55], v[164:167], v[188:191]
    v_mul_f32_dpp v227, v27, v27 row_ror:5 row_mask:0xf bank_mask:0xf
    v_mul_f32_dpp v228, v28, v28 row_ror:5 row_mask:0xf bank_mask:0xf
    v_mfma_f32_16x16x32_bf16 v[188:191], a[48:51], v[160:163], v[188:191]
    v_mul_f32_dpp v229, v29, v29 row_ror:5 row_mask:0xf bank_mask:0xf
    v_mul_f32_dpp v230, v30, v30 row_ror:5 row_mask:0xf bank_mask:0xf
    v_smfmac_f32_16x16x64_bf16 v[232:235], a[184:187], v[160:167], v1
    v_mul_f32_dpp v231, v31, v31 row_ror:5 row_mask:0xf bank_mask:0xf
    v_mfma_f32_16x16x32_bf16 v[192:195], a[64:67], v[160:163], v[128:131]
    v_cvt_pk_bf16_f32 v208, |v176|, |v177|
    v_cvt_pk_bf16_f32 v209, |v178|, |v179|
    v_mfma_f32_16x16x32_bf16 v[192:195], a[68:71], v[164:167], v[192:195]
    v_cvt_pk_bf16_f32 v148, v224, v225
    v_cvt_pk_bf16_f32 v149, v226, v227
    v_mfma_f32_16x16x32_bf16 v[192:195], a[72:75], v[168:171], v[192:195]
    v_cvt_pk_bf16_f32 v150, v228, v229
    v_cvt_pk_bf16_f32 v151, v230, v231
    v_mfma_f32_16x16x32_bf16 v[192:195], a[76:79], v[172:175], v[192:195]
    v_mul_f32_dpp v224, v32, v32 row_ror:5 row_mask:0xf bank_mask:0xf
    v_mul_f32_dpp v225, v33, v33 row_ror:5 row_mask:0xf bank_mask:0xf
    v_smfmac_f32_16x16x64_bf16 v[232:235], a[188:191], v[168:175], v1
    v_mul_f32_dpp v226, v34, v34 row_ror:5 row_mask:0xf bank_mask:0xf
    v_mfma_f32_16x16x32_bf16 v[196:199], a[92:95], v[172:175], v[132:135]
    v_mul_f32_dpp v227, v35, v35 row_ror:5 row_mask:0xf bank_mask:0xf
    v_mul_f32_dpp v228, v36, v36 row_ror:5 row_mask:0xf bank_mask:0xf
    v_mfma_f32_16x16x32_bf16 v[196:199], a[88:91], v[168:171], v[196:199]
    v_mul_f32_dpp v229, v37, v37 row_ror:5 row_mask:0xf bank_mask:0xf
    v_mul_f32_dpp v230, v38, v38 row_ror:5 row_mask:0xf bank_mask:0xf
    v_mfma_f32_16x16x32_bf16 v[196:199], a[84:87], v[164:167], v[196:199]
    v_mul_f32_dpp v231, v39, v39 row_ror:5 row_mask:0xf bank_mask:0xf
    v_cvt_pk_bf16_f32 v152, v224, v225
    v_mfma_f32_16x16x32_bf16 v[196:199], a[80:83], v[160:163], v[196:199]
    v_cvt_pk_bf16_f32 v153, v226, v227
    v_cvt_pk_bf16_f32 v154, v228, v229
    v_smfmac_f32_16x16x64_bf16 v[236:239], a[136:139], v[144:151], v1
    v_cvt_pk_bf16_f32 v155, v230, v231
    v_mfma_f32_16x16x32_bf16 v[200:203], a[96:99], v[160:163], v[136:139]
    v_mul_f32_dpp v224, v40, v40 row_ror:5 row_mask:0xf bank_mask:0xf
    v_mul_f32_dpp v225, v41, v41 row_ror:5 row_mask:0xf bank_mask:0xf
    v_mfma_f32_16x16x32_bf16 v[200:203], a[100:103], v[164:167], v[200:203]
    v_mul_f32_dpp v226, v42, v42 row_ror:5 row_mask:0xf bank_mask:0xf
    v_mul_f32_dpp v227, v43, v43 row_ror:5 row_mask:0xf bank_mask:0xf
    v_mfma_f32_16x16x32_bf16 v[200:203], a[104:107], v[168:171], v[200:203]
    v_mul_f32_dpp v228, v44, v44 row_ror:5 row_mask:0xf bank_mask:0xf
    v_mul_f32_dpp v229, v45, v45 row_ror:5 row_mask:0xf bank_mask:0xf
    v_mfma_f32_16x16x32_bf16 v[200:203], a[108:111], v[172:175], v[200:203]
    v_mul_f32_dpp v230, v46, v46 row_ror:5 row_mask:0xf bank_mask:0xf
    v_mul_f32_dpp v231, v47, v47 row_ror:5 row_mask:0xf bank_mask:0xf
    v_mfma_f32_16x16x32_bf16 v[204:207], a[124:127], v[172:175], v[140:143]
    v_cvt_pk_bf16_f32 v156, v224, v225
    v_cvt_pk_bf16_f32 v157, v226, v227
    v_mfma_f32_16x16x32_bf16 v[204:207], a[120:123], v[168:171], v[204:207]
    v_cvt_pk_bf16_f32 v158, v228, v229
    v_cvt_pk_bf16_f32 v159, v230, v231
    v_mfma_f32_16x16x32_bf16 v[204:207], a[116:119], v[164:167], v[204:207]
    v_cvt_pk_bf16_f32 v210, |v180|, |v181|
    v_cvt_pk_bf16_f32 v211, |v182|, |v183|
    v_mfma_f32_16x16x32_bf16 v[204:207], a[112:115], v[160:163], v[204:207]
    v_cvt_pk_bf16_f32 v212, |v184|, |v185|
    v_cvt_pk_bf16_f32 v213, |v186|, |v187|
    v_smfmac_f32_16x16x64_bf16 v[236:239], a[140:143], v[152:159], v1
    v_cvt_pk_bf16_f32 v214, |v188|, |v189|
    v_mfma_f32_16x16x32_bf16 v[176:179], a[0:3], v[144:147], v[112:115]
    v_cvt_pk_bf16_f32 v215, |v190|, |v191|
    v_cvt_pk_bf16_f32 v216, |v192|, |v193|
    v_mfma_f32_16x16x32_bf16 v[176:179], a[4:7], v[148:151], v[176:179]
    v_cvt_pk_bf16_f32 v217, |v194|, |v195|
    v_cvt_pk_bf16_f32 v218, |v196|, |v197|
    v_mfma_f32_16x16x32_bf16 v[176:179], a[8:11], v[152:155], v[176:179]
    v_cvt_pk_bf16_f32 v219, |v198|, |v199|
    v_cvt_pk_bf16_f32 v220, |v200|, |v201|
    v_mfma_f32_16x16x32_bf16 v[176:179], a[12:15], v[156:159], v[176:179]
    v_cvt_pk_bf16_f32 v221, |v202|, |v203|
    v_cvt_pk_bf16_f32 v222, |v204|, |v205|
    v_smfmac_f32_16x16x64_bf16 v[232:235], a[176:179], v[208:215], v1
    v_cvt_pk_bf16_f32 v223, |v206|, |v207|
    v_mfma_f32_16x16x32_bf16 v[180:183], a[28:31], v[156:159], v[116:119]
    v_mul_f32_dpp v224, v16, v16 row_ror:6 row_mask:0xf bank_mask:0xf
    v_mul_f32_dpp v225, v17, v17 row_ror:6 row_mask:0xf bank_mask:0xf
    v_mfma_f32_16x16x32_bf16 v[180:183], a[24:27], v[152:155], v[180:183]
    v_mul_f32_dpp v226, v18, v18 row_ror:6 row_mask:0xf bank_mask:0xf
    v_mul_f32_dpp v227, v19, v19 row_ror:6 row_mask:0xf bank_mask:0xf
    v_mfma_f32_16x16x32_bf16 v[180:183], a[20:23], v[148:151], v[180:183]
    v_mul_f32_dpp v228, v20, v20 row_ror:6 row_mask:0xf bank_mask:0xf
    v_mul_f32_dpp v229, v21, v21 row_ror:6 row_mask:0xf bank_mask:0xf
    v_mfma_f32_16x16x32_bf16 v[180:183], a[16:19], v[144:147], v[180:183]
    v_mul_f32_dpp v230, v22, v22 row_ror:6 row_mask:0xf bank_mask:0xf
    v_mul_f32_dpp v231, v23, v23 row_ror:6 row_mask:0xf bank_mask:0xf
    v_smfmac_f32_16x16x64_bf16 v[232:235], a[180:183], v[216:223], v1
    v_cvt_pk_bf16_f32 v160, v224, v225
    v_mfma_f32_16x16x32_bf16 v[184:187], a[32:35], v[144:147], v[120:123]
    v_cvt_pk_bf16_f32 v161, v226, v227
    v_cvt_pk_bf16_f32 v162, v228, v229
    v_mfma_f32_16x16x32_bf16 v[184:187], a[36:39], v[148:151], v[184:187]
    v_cvt_pk_bf16_f32 v163, v230, v231
    v_mul_f32_dpp v224, v24, v24 row_ror:6 row_mask:0xf bank_mask:0xf
    v_mfma_f32_16x16x32_bf16 v[184:187], a[40:43], v[152:155], v[184:187]
    v_mul_f32_dpp v225, v25, v25 row_ror:6 row_mask:0xf bank_mask:0xf
    v_mul_f32_dpp v226, v26, v26 row_ror:6 row_mask:0xf bank_mask:0xf
    v_mfma_f32_16x16x32_bf16 v[184:187], a[44:47], v[156:159], v[184:187]
    v_mul_f32_dpp v227, v27, v27 row_ror:6 row_mask:0xf bank_mask:0xf
    v_mul_f32_dpp v228, v28, v28 row_ror:6 row_mask:0xf bank_mask:0xf
    v_mfma_f32_16x16x32_bf16 v[188:191], a[60:63], v[156:159], v[124:127]
    v_mul_f32_dpp v229, v29, v29 row_ror:6 row_mask:0xf bank_mask:0xf
    v_mul_f32_dpp v230, v30, v30 row_ror:6 row_mask:0xf bank_mask:0xf
    v_mfma_f32_16x16x32_bf16 v[188:191], a[56:59], v[152:155], v[188:191]
    v_mul_f32_dpp v231, v31, v31 row_ror:6 row_mask:0xf bank_mask:0xf
    v_cvt_pk_bf16_f32 v208, |v176|, |v177|
    v_mfma_f32_16x16x32_bf16 v[188:191], a[52:55], v[148:151], v[188:191]
    v_cvt_pk_bf16_f32 v209, |v178|, |v179|
    v_cvt_pk_bf16_f32 v164, v224, v225
    v_mfma_f32_16x16x32_bf16 v[188:191], a[48:51], v[144:147], v[188:191]
    v_cvt_pk_bf16_f32 v165, v226, v227
    v_cvt_pk_bf16_f32 v166, v228, v229
    v_mfma_f32_16x16x32_bf16 v[192:195], a[64:67], v[144:147], v[128:131]
    v_cvt_pk_bf16_f32 v167, v230, v231
    v_mul_f32_dpp v224, v32, v32 row_ror:6 row_mask:0xf bank_mask:0xf
    v_mfma_f32_16x16x32_bf16 v[192:195], a[68:71], v[148:151], v[192:195]
    v_mul_f32_dpp v225, v33, v33 row_ror:6 row_mask:0xf bank_mask:0xf
    v_mul_f32_dpp v226, v34, v34 row_ror:6 row_mask:0xf bank_mask:0xf
    v_mfma_f32_16x16x32_bf16 v[192:195], a[72:75], v[152:155], v[192:195]
    v_mul_f32_dpp v227, v35, v35 row_ror:6 row_mask:0xf bank_mask:0xf
    v_mul_f32_dpp v228, v36, v36 row_ror:6 row_mask:0xf bank_mask:0xf
    v_mfma_f32_16x16x32_bf16 v[192:195], a[76:79], v[156:159], v[192:195]
    v_mul_f32_dpp v229, v37, v37 row_ror:6 row_mask:0xf bank_mask:0xf
    v_mul_f32_dpp v230, v38, v38 row_ror:6 row_mask:0xf bank_mask:0xf
    v_mfma_f32_16x16x32_bf16 v[196:199], a[92:95], v[156:159], v[132:135]
    v_mul_f32_dpp v231, v39, v39 row_ror:6 row_mask:0xf bank_mask:0xf
    v_cvt_pk_bf16_f32 v168, v224, v225
    v_mfma_f32_16x16x32_bf16 v[196:199], a[88:91], v[152:155], v[196:199]
    v_cvt_pk_bf16_f32 v169, v226, v227
    v_cvt_pk_bf16_f32 v170, v228, v229
    v_mfma_f32_16x16x32_bf16 v[196:199], a[84:87], v[148:151], v[196:199]
    v_cvt_pk_bf16_f32 v171, v230, v231
    v_mul_f32_dpp v224, v40, v40 row_ror:6 row_mask:0xf bank_mask:0xf
    v_mfma_f32_16x16x32_bf16 v[196:199], a[80:83], v[144:147], v[196:199]
    s_waitcnt vmcnt(0)
    v_mul_f32_dpp v225, v41, v41 row_ror:6 row_mask:0xf bank_mask:0xf
    v_mul_f32_dpp v226, v42, v42 row_ror:6 row_mask:0xf bank_mask:0xf
    v_mfma_f32_16x16x32_bf16 v[200:203], a[96:99], v[144:147], v[136:139]
    ds_read_b128 v[64:67], v2 offset:0
    v_mul_f32_dpp v227, v43, v43 row_ror:6 row_mask:0xf bank_mask:0xf
    v_mfma_f32_16x16x32_bf16 v[200:203], a[100:103], v[148:151], v[200:203]
    ds_read_b128 v[68:71], v2 offset:64
    v_mul_f32_dpp v228, v44, v44 row_ror:6 row_mask:0xf bank_mask:0xf
    v_mfma_f32_16x16x32_bf16 v[200:203], a[104:107], v[152:155], v[200:203]
    ds_read_b128 v[72:75], v2 offset:128
    v_mul_f32_dpp v229, v45, v45 row_ror:6 row_mask:0xf bank_mask:0xf
    v_mfma_f32_16x16x32_bf16 v[200:203], a[108:111], v[156:159], v[200:203]
    ds_read_b128 v[76:79], v2 offset:192
    v_mul_f32_dpp v230, v46, v46 row_ror:6 row_mask:0xf bank_mask:0xf
    v_mfma_f32_16x16x32_bf16 v[204:207], a[124:127], v[156:159], v[140:143]
    v_mul_f32_dpp v231, v47, v47 row_ror:6 row_mask:0xf bank_mask:0xf
    v_cvt_pk_bf16_f32 v172, v224, v225
    v_mfma_f32_16x16x32_bf16 v[204:207], a[120:123], v[152:155], v[204:207]
    v_cvt_pk_bf16_f32 v173, v226, v227
    v_cvt_pk_bf16_f32 v174, v228, v229
    v_mfma_f32_16x16x32_bf16 v[204:207], a[116:119], v[148:151], v[204:207]
    v_cvt_pk_bf16_f32 v175, v230, v231
    v_cvt_pk_bf16_f32 v210, |v180|, |v181|
    v_mfma_f32_16x16x32_bf16 v[204:207], a[112:115], v[144:147], v[204:207]
    v_cvt_pk_bf16_f32 v211, |v182|, |v183|
    v_cvt_pk_bf16_f32 v212, |v184|, |v185|
    v_mfma_f32_16x16x32_bf16 v[176:179], a[0:3], v[160:163], v[112:115]
    v_cvt_pk_bf16_f32 v213, |v186|, |v187|
    v_cvt_pk_bf16_f32 v214, |v188|, |v189|
    v_mfma_f32_16x16x32_bf16 v[176:179], a[4:7], v[164:167], v[176:179]
    v_cvt_pk_bf16_f32 v215, |v190|, |v191|
    v_cvt_pk_bf16_f32 v216, |v192|, |v193|
    v_mfma_f32_16x16x32_bf16 v[176:179], a[8:11], v[168:171], v[176:179]
    v_cvt_pk_bf16_f32 v217, |v194|, |v195|
    v_cvt_pk_bf16_f32 v218, |v196|, |v197|
    v_mfma_f32_16x16x32_bf16 v[176:179], a[12:15], v[172:175], v[176:179]
    v_cvt_pk_bf16_f32 v219, |v198|, |v199|
    v_cvt_pk_bf16_f32 v220, |v200|, |v201|
    v_smfmac_f32_16x16x64_bf16 v[236:239], a[128:131], v[208:215], v1
    v_cvt_pk_bf16_f32 v221, |v202|, |v203|
    v_mfma_f32_16x16x32_bf16 v[180:183], a[28:31], v[172:175], v[116:119]
    s_waitcnt lgkmcnt(0)
    v_cvt_pk_bf16_f32 v222, |v204|, |v205|
    v_cvt_pk_bf16_f32 v223, |v206|, |v207|
    v_mfma_f32_16x16x32_bf16 v[180:183], a[24:27], v[168:171], v[180:183]
    v_mul_f32_dpp v224, v16, v16 row_ror:7 row_mask:0xf bank_mask:0xf
    v_mul_f32_dpp v225, v17, v17 row_ror:7 row_mask:0xf bank_mask:0xf
    v_mfma_f32_16x16x32_bf16 v[180:183], a[20:23], v[164:167], v[180:183]
    v_mul_f32_dpp v226, v18, v18 row_ror:7 row_mask:0xf bank_mask:0xf
    v_mul_f32_dpp v227, v19, v19 row_ror:7 row_mask:0xf bank_mask:0xf
    v_mfma_f32_16x16x32_bf16 v[180:183], a[16:19], v[160:163], v[180:183]
    v_mul_f32_dpp v228, v20, v20 row_ror:7 row_mask:0xf bank_mask:0xf
    v_mul_f32_dpp v229, v21, v21 row_ror:7 row_mask:0xf bank_mask:0xf
    v_smfmac_f32_16x16x64_bf16 v[236:239], a[132:135], v[216:223], v1
    v_mul_f32_dpp v230, v22, v22 row_ror:7 row_mask:0xf bank_mask:0xf
    v_mfma_f32_16x16x32_bf16 v[184:187], a[32:35], v[160:163], v[120:123]
    v_mul_f32_dpp v231, v23, v23 row_ror:7 row_mask:0xf bank_mask:0xf
    v_cvt_pk_bf16_f32 v144, v224, v225
    v_mfma_f32_16x16x32_bf16 v[184:187], a[36:39], v[164:167], v[184:187]
    v_cvt_pk_bf16_f32 v145, v226, v227
    v_cvt_pk_bf16_f32 v146, v228, v229
    v_mfma_f32_16x16x32_bf16 v[184:187], a[40:43], v[168:171], v[184:187]
    v_cvt_pk_bf16_f32 v147, v230, v231
    v_mul_f32_dpp v224, v24, v24 row_ror:7 row_mask:0xf bank_mask:0xf
    v_mfma_f32_16x16x32_bf16 v[184:187], a[44:47], v[172:175], v[184:187]
    v_mul_f32_dpp v225, v25, v25 row_ror:7 row_mask:0xf bank_mask:0xf
    v_mul_f32_dpp v226, v26, v26 row_ror:7 row_mask:0xf bank_mask:0xf
    v_smfmac_f32_16x16x64_bf16 v[236:239], a[152:155], v[160:167], v1
    v_mul_f32_dpp v227, v27, v27 row_ror:7 row_mask:0xf bank_mask:0xf
    v_mfma_f32_16x16x32_bf16 v[188:191], a[60:63], v[172:175], v[124:127]
    v_mul_f32_dpp v228, v28, v28 row_ror:7 row_mask:0xf bank_mask:0xf
    v_mul_f32_dpp v229, v29, v29 row_ror:7 row_mask:0xf bank_mask:0xf
    v_mfma_f32_16x16x32_bf16 v[188:191], a[56:59], v[168:171], v[188:191]
    v_mul_f32_dpp v230, v30, v30 row_ror:7 row_mask:0xf bank_mask:0xf
    v_mul_f32_dpp v231, v31, v31 row_ror:7 row_mask:0xf bank_mask:0xf
    v_mfma_f32_16x16x32_bf16 v[188:191], a[52:55], v[164:167], v[188:191]
    v_cvt_pk_bf16_f32 v208, |v176|, |v177|
    v_cvt_pk_bf16_f32 v209, |v178|, |v179|
    v_mfma_f32_16x16x32_bf16 v[188:191], a[48:51], v[160:163], v[188:191]
    v_cvt_pk_bf16_f32 v148, v224, v225
    v_cvt_pk_bf16_f32 v149, v226, v227
    v_smfmac_f32_16x16x64_bf16 v[236:239], a[156:159], v[168:175], v1
    v_cvt_pk_bf16_f32 v150, v228, v229
    v_mfma_f32_16x16x32_bf16 v[192:195], a[64:67], v[160:163], v[128:131]
    v_cvt_pk_bf16_f32 v151, v230, v231
    v_mul_f32_dpp v224, v32, v32 row_ror:7 row_mask:0xf bank_mask:0xf
    v_mfma_f32_16x16x32_bf16 v[192:195], a[68:71], v[164:167], v[192:195]
    v_mul_f32_dpp v225, v33, v33 row_ror:7 row_mask:0xf bank_mask:0xf
    v_mul_f32_dpp v226, v34, v34 row_ror:7 row_mask:0xf bank_mask:0xf
    v_mfma_f32_16x16x32_bf16 v[192:195], a[72:75], v[168:171], v[192:195]
    v_mul_f32_dpp v227, v35, v35 row_ror:7 row_mask:0xf bank_mask:0xf
    v_mul_f32_dpp v228, v36, v36 row_ror:7 row_mask:0xf bank_mask:0xf
    v_mfma_f32_16x16x32_bf16 v[192:195], a[76:79], v[172:175], v[192:195]
    v_mul_f32_dpp v229, v37, v37 row_ror:7 row_mask:0xf bank_mask:0xf
    v_mul_f32_dpp v230, v38, v38 row_ror:7 row_mask:0xf bank_mask:0xf
    v_mfma_f32_16x16x32_bf16 v[196:199], a[92:95], v[172:175], v[132:135]
    v_mul_f32_dpp v231, v39, v39 row_ror:7 row_mask:0xf bank_mask:0xf
    v_cvt_pk_bf16_f32 v152, v224, v225
    v_mfma_f32_16x16x32_bf16 v[196:199], a[88:91], v[168:171], v[196:199]
    v_cvt_pk_bf16_f32 v153, v226, v227
    v_cvt_pk_bf16_f32 v154, v228, v229
    v_mfma_f32_16x16x32_bf16 v[196:199], a[84:87], v[164:167], v[196:199]
    v_cvt_pk_bf16_f32 v155, v230, v231
    v_mul_f32_dpp v224, v40, v40 row_ror:7 row_mask:0xf bank_mask:0xf
    v_mfma_f32_16x16x32_bf16 v[196:199], a[80:83], v[160:163], v[196:199]
    v_mul_f32_dpp v225, v41, v41 row_ror:7 row_mask:0xf bank_mask:0xf
    v_mul_f32_dpp v226, v42, v42 row_ror:7 row_mask:0xf bank_mask:0xf
    v_mfma_f32_16x16x32_bf16 v[200:203], a[96:99], v[160:163], v[136:139]
    v_mul_f32_dpp v227, v43, v43 row_ror:7 row_mask:0xf bank_mask:0xf
    v_mul_f32_dpp v228, v44, v44 row_ror:7 row_mask:0xf bank_mask:0xf
    v_mfma_f32_16x16x32_bf16 v[200:203], a[100:103], v[164:167], v[200:203]
    v_mul_f32_dpp v229, v45, v45 row_ror:7 row_mask:0xf bank_mask:0xf
    v_mul_f32_dpp v230, v46, v46 row_ror:7 row_mask:0xf bank_mask:0xf
    v_mfma_f32_16x16x32_bf16 v[200:203], a[104:107], v[168:171], v[200:203]
    v_mul_f32_dpp v231, v47, v47 row_ror:7 row_mask:0xf bank_mask:0xf
    v_cvt_pk_bf16_f32 v156, v224, v225
    v_mfma_f32_16x16x32_bf16 v[200:203], a[108:111], v[172:175], v[200:203]
    v_cvt_pk_bf16_f32 v157, v226, v227
    v_cvt_pk_bf16_f32 v158, v228, v229
    v_mfma_f32_16x16x32_bf16 v[204:207], a[124:127], v[172:175], v[140:143]
    v_cvt_pk_bf16_f32 v159, v230, v231
    v_cvt_pk_bf16_f32 v210, |v180|, |v181|
    v_mfma_f32_16x16x32_bf16 v[204:207], a[120:123], v[168:171], v[204:207]
    v_cvt_pk_bf16_f32 v211, |v182|, |v183|
    v_cvt_pk_bf16_f32 v212, |v184|, |v185|
    v_mfma_f32_16x16x32_bf16 v[204:207], a[116:119], v[164:167], v[204:207]
    v_cvt_pk_bf16_f32 v213, |v186|, |v187|
    v_cvt_pk_bf16_f32 v214, |v188|, |v189|
    v_mfma_f32_16x16x32_bf16 v[204:207], a[112:115], v[160:163], v[204:207]
    v_cvt_pk_bf16_f32 v215, |v190|, |v191|
    v_cvt_pk_bf16_f32 v216, |v192|, |v193|
    v_mfma_f32_16x16x32_bf16 v[176:179], a[0:3], v[144:147], v[112:115]
    v_cvt_pk_bf16_f32 v217, |v194|, |v195|
    v_cvt_pk_bf16_f32 v218, |v196|, |v197|
    v_mfma_f32_16x16x32_bf16 v[176:179], a[4:7], v[148:151], v[176:179]
    v_cvt_pk_bf16_f32 v219, |v198|, |v199|
    v_cvt_pk_bf16_f32 v220, |v200|, |v201|
    v_mfma_f32_16x16x32_bf16 v[176:179], a[8:11], v[152:155], v[176:179]
    v_cvt_pk_bf16_f32 v221, |v202|, |v203|
    v_cvt_pk_bf16_f32 v222, |v204|, |v205|
    v_mfma_f32_16x16x32_bf16 v[176:179], a[12:15], v[156:159], v[176:179]
    v_cvt_pk_bf16_f32 v223, |v206|, |v207|
    v_lshlrev_b32 v48, 16, v64
    v_smfmac_f32_16x16x64_bf16 v[236:239], a[144:147], v[208:215], v1
    v_and_b32 v49, 0xffff0000, v64
    v_mfma_f32_16x16x32_bf16 v[180:183], a[28:31], v[156:159], v[116:119]
    v_lshlrev_b32 v50, 16, v65
    v_and_b32 v51, 0xffff0000, v65
    v_mfma_f32_16x16x32_bf16 v[180:183], a[24:27], v[152:155], v[180:183]
    v_lshlrev_b32 v52, 16, v66
    v_and_b32 v53, 0xffff0000, v66
    v_mfma_f32_16x16x32_bf16 v[180:183], a[20:23], v[148:151], v[180:183]
    v_lshlrev_b32 v54, 16, v67
    v_and_b32 v55, 0xffff0000, v67
    v_mfma_f32_16x16x32_bf16 v[180:183], a[16:19], v[144:147], v[180:183]
    v_lshlrev_b32 v56, 16, v68
    v_and_b32 v57, 0xffff0000, v68
    v_smfmac_f32_16x16x64_bf16 v[236:239], a[148:151], v[216:223], v1
    v_lshlrev_b32 v58, 16, v69
    v_mfma_f32_16x16x32_bf16 v[184:187], a[32:35], v[144:147], v[120:123]
    v_and_b32 v59, 0xffff0000, v69
    v_lshlrev_b32 v60, 16, v70
    v_mfma_f32_16x16x32_bf16 v[184:187], a[36:39], v[148:151], v[184:187]
    v_and_b32 v61, 0xffff0000, v70
    v_lshlrev_b32 v62, 16, v71
    v_mfma_f32_16x16x32_bf16 v[184:187], a[40:43], v[152:155], v[184:187]
    v_and_b32 v63, 0xffff0000, v71
    v_mul_f32_dpp v224, v48, v16 row_newbcast:14 row_mask:0xf bank_mask:0xf
    v_mfma_f32_16x16x32_bf16 v[184:187], a[44:47], v[156:159], v[184:187]
    v_mul_f32_dpp v225, v49, v17 row_newbcast:14 row_mask:0xf bank_mask:0xf
    v_mul_f32_dpp v226, v50, v18 row_newbcast:14 row_mask:0xf bank_mask:0xf
    v_smfmac_f32_16x16x64_bf16 v[236:239], a[168:171], v[144:151], v1
    v_mul_f32_dpp v227, v51, v19 row_newbcast:14 row_mask:0xf bank_mask:0xf
    v_mfma_f32_16x16x32_bf16 v[188:191], a[60:63], v[156:159], v[124:127]
    v_mul_f32_dpp v228, v52, v20 row_newbcast:14 row_mask:0xf bank_mask:0xf
    v_mul_f32_dpp v229, v53, v21 row_newbcast:14 row_mask:0xf bank_mask:0xf
    v_mfma_f32_16x16x32_bf16 v[188:191], a[56:59], v[152:155], v[188:191]
    v_mul_f32_dpp v230, v54, v22 row_newbcast:14 row_mask:0xf bank_mask:0xf
    v_mul_f32_dpp v231, v55, v23 row_newbcast:14 row_mask:0xf bank_mask:0xf
    v_mfma_f32_16x16x32_bf16 v[188:191], a[52:55], v[148:151], v[188:191]
    v_lshlrev_b32 v64, 16, v72
    v_and_b32 v65, 0xffff0000, v72
    v_mfma_f32_16x16x32_bf16 v[188:191], a[48:51], v[144:147], v[188:191]
    v_lshlrev_b32 v66, 16, v73
    v_and_b32 v67, 0xffff0000, v73
    v_smfmac_f32_16x16x64_bf16 v[236:239], a[172:175], v[152:159], v1
    v_lshlrev_b32 v68, 16, v74
    v_mfma_f32_16x16x32_bf16 v[192:195], a[64:67], v[144:147], v[128:131]
    v_and_b32 v69, 0xffff0000, v74
    v_lshlrev_b32 v70, 16, v75
    v_mfma_f32_16x16x32_bf16 v[192:195], a[68:71], v[148:151], v[192:195]
    v_and_b32 v71, 0xffff0000, v75
    v_cvt_pk_bf16_f32 v160, v224, v225
    v_mfma_f32_16x16x32_bf16 v[192:195], a[72:75], v[152:155], v[192:195]
    v_cvt_pk_bf16_f32 v161, v226, v227
    v_cvt_pk_bf16_f32 v162, v228, v229
    v_mfma_f32_16x16x32_bf16 v[192:195], a[76:79], v[156:159], v[192:195]
    v_cvt_pk_bf16_f32 v163, v230, v231
    v_lshlrev_b32 v72, 16, v76
    v_mfma_f32_16x16x32_bf16 v[196:199], a[92:95], v[156:159], v[132:135]
    v_and_b32 v73, 0xffff0000, v76
    v_lshlrev_b32 v74, 16, v77
    v_mfma_f32_16x16x32_bf16 v[196:199], a[88:91], v[152:155], v[196:199]
    v_and_b32 v75, 0xffff0000, v77
    v_lshlrev_b32 v76, 16, v78
    v_mfma_f32_16x16x32_bf16 v[196:199], a[84:87], v[148:151], v[196:199]
    v_and_b32 v77, 0xffff0000, v78
    v_mul_f32_dpp v224, v56, v24 row_newbcast:14 row_mask:0xf bank_mask:0xf
    v_mfma_f32_16x16x32_bf16 v[196:199], a[80:83], v[144:147], v[196:199]
    v_mul_f32_dpp v225, v57, v25 row_newbcast:14 row_mask:0xf bank_mask:0xf
    v_mul_f32_dpp v226, v58, v26 row_newbcast:14 row_mask:0xf bank_mask:0xf
    v_mfma_f32_16x16x32_bf16 v[200:203], a[96:99], v[144:147], v[136:139]
    v_mul_f32_dpp v227, v59, v27 row_newbcast:14 row_mask:0xf bank_mask:0xf
    v_mul_f32_dpp v228, v60, v28 row_newbcast:14 row_mask:0xf bank_mask:0xf
    v_mfma_f32_16x16x32_bf16 v[200:203], a[100:103], v[148:151], v[200:203]
    v_mul_f32_dpp v229, v61, v29 row_newbcast:14 row_mask:0xf bank_mask:0xf
    v_mul_f32_dpp v230, v62, v30 row_newbcast:14 row_mask:0xf bank_mask:0xf
    v_mfma_f32_16x16x32_bf16 v[200:203], a[104:107], v[152:155], v[200:203]
    v_mul_f32_dpp v231, v63, v31 row_newbcast:14 row_mask:0xf bank_mask:0xf
    v_cvt_pk_bf16_f32 v208, |v176|, |v177|
    v_mfma_f32_16x16x32_bf16 v[200:203], a[108:111], v[156:159], v[200:203]
    v_cvt_pk_bf16_f32 v209, |v178|, |v179|
    v_lshlrev_b32 v78, 16, v79
    v_mfma_f32_16x16x32_bf16 v[204:207], a[124:127], v[156:159], v[140:143]
    v_cvt_pk_bf16_f32 v164, v224, v225
    v_cvt_pk_bf16_f32 v165, v226, v227
    v_mfma_f32_16x16x32_bf16 v[204:207], a[120:123], v[152:155], v[204:207]
    v_cvt_pk_bf16_f32 v166, v228, v229
    v_cvt_pk_bf16_f32 v167, v230, v231
    v_mfma_f32_16x16x32_bf16 v[204:207], a[116:119], v[148:151], v[204:207]
    v_and_b32 v79, 0xffff0000, v79
    v_mul_f32_dpp v224, v64, v32 row_newbcast:14 row_mask:0xf bank_mask:0xf
    v_mfma_f32_16x16x32_bf16 v[204:207], a[112:115], v[144:147], v[204:207]
    v_mul_f32_dpp v225, v65, v33 row_newbcast:14 row_mask:0xf bank_mask:0xf
    v_mul_f32_dpp v226, v66, v34 row_newbcast:14 row_mask:0xf bank_mask:0xf
    v_mfma_f32_16x16x32_bf16 v[176:179], a[0:3], v[160:163], v[112:115]
    v_mul_f32_dpp v227, v67, v35 row_newbcast:14 row_mask:0xf bank_mask:0xf
    v_mul_f32_dpp v228, v68, v36 row_newbcast:14 row_mask:0xf bank_mask:0xf
    v_mfma_f32_16x16x32_bf16 v[176:179], a[4:7], v[164:167], v[176:179]
    v_mul_f32_dpp v229, v69, v37 row_newbcast:14 row_mask:0xf bank_mask:0xf
    v_mul_f32_dpp v230, v70, v38 row_newbcast:14 row_mask:0xf bank_mask:0xf
    v_mul_f32_dpp v231, v71, v39 row_newbcast:14 row_mask:0xf bank_mask:0xf
    v_cvt_pk_bf16_f32 v168, v224, v225
    v_cvt_pk_bf16_f32 v169, v226, v227
    v_cvt_pk_bf16_f32 v170, v228, v229
    v_cvt_pk_bf16_f32 v171, v230, v231
    v_mul_f32_dpp v224, v72, v40 row_newbcast:14 row_mask:0xf bank_mask:0xf
    v_mul_f32_dpp v225, v73, v41 row_newbcast:14 row_mask:0xf bank_mask:0xf
    v_mfma_f32_16x16x32_bf16 v[176:179], a[8:11], v[168:171], v[176:179]
    v_mul_f32_dpp v226, v74, v42 row_newbcast:14 row_mask:0xf bank_mask:0xf
    v_mul_f32_dpp v227, v75, v43 row_newbcast:14 row_mask:0xf bank_mask:0xf
    v_mul_f32_dpp v228, v76, v44 row_newbcast:14 row_mask:0xf bank_mask:0xf
    v_mul_f32_dpp v229, v77, v45 row_newbcast:14 row_mask:0xf bank_mask:0xf
    v_mul_f32_dpp v230, v78, v46 row_newbcast:14 row_mask:0xf bank_mask:0xf
    v_mul_f32_dpp v231, v79, v47 row_newbcast:14 row_mask:0xf bank_mask:0xf
    v_cvt_pk_bf16_f32 v172, v224, v225
    v_cvt_pk_bf16_f32 v173, v226, v227
    v_cvt_pk_bf16_f32 v174, v228, v229
    v_cvt_pk_bf16_f32 v175, v230, v231
    v_cvt_pk_bf16_f32 v210, |v180|, |v181|
    v_cvt_pk_bf16_f32 v211, |v182|, |v183|
    v_mfma_f32_16x16x32_bf16 v[176:179], a[12:15], v[172:175], v[176:179]
    v_cvt_pk_bf16_f32 v212, |v184|, |v185|
    v_cvt_pk_bf16_f32 v213, |v186|, |v187|
    v_mfma_f32_16x16x32_bf16 v[180:183], a[28:31], v[172:175], v[116:119]
    v_cvt_pk_bf16_f32 v214, |v188|, |v189|
    v_cvt_pk_bf16_f32 v215, |v190|, |v191|
    v_mfma_f32_16x16x32_bf16 v[180:183], a[24:27], v[168:171], v[180:183]
    v_cvt_pk_bf16_f32 v216, |v192|, |v193|
    v_cvt_pk_bf16_f32 v217, |v194|, |v195|
    v_mfma_f32_16x16x32_bf16 v[180:183], a[20:23], v[164:167], v[180:183]
    v_cvt_pk_bf16_f32 v218, |v196|, |v197|
    v_cvt_pk_bf16_f32 v219, |v198|, |v199|
    v_mfma_f32_16x16x32_bf16 v[180:183], a[16:19], v[160:163], v[180:183]
    v_cvt_pk_bf16_f32 v220, |v200|, |v201|
    v_cvt_pk_bf16_f32 v221, |v202|, |v203|
    v_smfmac_f32_16x16x64_bf16 v[236:239], a[160:163], v[208:215], v1
    v_cvt_pk_bf16_f32 v222, |v204|, |v205|
    v_mfma_f32_16x16x32_bf16 v[184:187], a[32:35], v[160:163], v[120:123]
    v_cvt_pk_bf16_f32 v223, |v206|, |v207|
    v_mul_f32_dpp v224, v48, v16 row_newbcast:2 row_mask:0xf bank_mask:0xf
    v_mfma_f32_16x16x32_bf16 v[184:187], a[36:39], v[164:167], v[184:187]
    v_mul_f32_dpp v225, v49, v17 row_newbcast:2 row_mask:0xf bank_mask:0xf
    v_mul_f32_dpp v226, v50, v18 row_newbcast:2 row_mask:0xf bank_mask:0xf
    v_mfma_f32_16x16x32_bf16 v[184:187], a[40:43], v[168:171], v[184:187]
    v_mul_f32_dpp v227, v51, v19 row_newbcast:2 row_mask:0xf bank_mask:0xf
    v_mul_f32_dpp v228, v52, v20 row_newbcast:2 row_mask:0xf bank_mask:0xf
    v_mfma_f32_16x16x32_bf16 v[184:187], a[44:47], v[172:175], v[184:187]
    v_mul_f32_dpp v229, v53, v21 row_newbcast:2 row_mask:0xf bank_mask:0xf
    v_mul_f32_dpp v230, v54, v22 row_newbcast:2 row_mask:0xf bank_mask:0xf
    v_smfmac_f32_16x16x64_bf16 v[236:239], a[164:167], v[216:223], v1
    v_mul_f32_dpp v231, v55, v23 row_newbcast:2 row_mask:0xf bank_mask:0xf
    v_mfma_f32_16x16x32_bf16 v[188:191], a[60:63], v[172:175], v[124:127]
    v_cvt_pk_bf16_f32 v144, v224, v225
    v_cvt_pk_bf16_f32 v145, v226, v227
    v_mfma_f32_16x16x32_bf16 v[188:191], a[56:59], v[168:171], v[188:191]
    v_cvt_pk_bf16_f32 v146, v228, v229
    v_cvt_pk_bf16_f32 v147, v230, v231
    v_mfma_f32_16x16x32_bf16 v[188:191], a[52:55], v[164:167], v[188:191]
    v_mul_f32_dpp v224, v56, v24 row_newbcast:2 row_mask:0xf bank_mask:0xf
    v_mul_f32_dpp v225, v57, v25 row_newbcast:2 row_mask:0xf bank_mask:0xf
    v_mfma_f32_16x16x32_bf16 v[188:191], a[48:51], v[160:163], v[188:191]
    v_mul_f32_dpp v226, v58, v26 row_newbcast:2 row_mask:0xf bank_mask:0xf
    v_mul_f32_dpp v227, v59, v27 row_newbcast:2 row_mask:0xf bank_mask:0xf
    v_smfmac_f32_16x16x64_bf16 v[236:239], a[184:187], v[160:167], v1
    v_mul_f32_dpp v228, v60, v28 row_newbcast:2 row_mask:0xf bank_mask:0xf
    v_mfma_f32_16x16x32_bf16 v[192:195], a[64:67], v[160:163], v[128:131]
    v_mul_f32_dpp v229, v61, v29 row_newbcast:2 row_mask:0xf bank_mask:0xf
    v_mul_f32_dpp v230, v62, v30 row_newbcast:2 row_mask:0xf bank_mask:0xf
    v_mfma_f32_16x16x32_bf16 v[192:195], a[68:71], v[164:167], v[192:195]
    v_mul_f32_dpp v231, v63, v31 row_newbcast:2 row_mask:0xf bank_mask:0xf
    v_cvt_pk_bf16_f32 v208, |v176|, |v177|
    v_mfma_f32_16x16x32_bf16 v[192:195], a[72:75], v[168:171], v[192:195]
    v_cvt_pk_bf16_f32 v209, |v178|, |v179|
    v_cvt_pk_bf16_f32 v148, v224, v225
    v_mfma_f32_16x16x32_bf16 v[192:195], a[76:79], v[172:175], v[192:195]
    v_cvt_pk_bf16_f32 v149, v226, v227
    v_cvt_pk_bf16_f32 v150, v228, v229
    v_smfmac_f32_16x16x64_bf16 v[236:239], a[188:191], v[168:175], v1
    v_cvt_pk_bf16_f32 v151, v230, v231
    v_mfma_f32_16x16x32_bf16 v[196:199], a[92:95], v[172:175], v[132:135]
    v_mul_f32_dpp v224, v64, v32 row_newbcast:2 row_mask:0xf bank_mask:0xf
    v_mul_f32_dpp v225, v65, v33 row_newbcast:2 row_mask:0xf bank_mask:0xf
    v_mfma_f32_16x16x32_bf16 v[196:199], a[88:91], v[168:171], v[196:199]
    v_mul_f32_dpp v226, v66, v34 row_newbcast:2 row_mask:0xf bank_mask:0xf
    v_mul_f32_dpp v227, v67, v35 row_newbcast:2 row_mask:0xf bank_mask:0xf
    v_mfma_f32_16x16x32_bf16 v[196:199], a[84:87], v[164:167], v[196:199]
    v_mul_f32_dpp v228, v68, v36 row_newbcast:2 row_mask:0xf bank_mask:0xf
    v_mul_f32_dpp v229, v69, v37 row_newbcast:2 row_mask:0xf bank_mask:0xf
    v_mfma_f32_16x16x32_bf16 v[196:199], a[80:83], v[160:163], v[196:199]
    v_mul_f32_dpp v230, v70, v38 row_newbcast:2 row_mask:0xf bank_mask:0xf
    v_mul_f32_dpp v231, v71, v39 row_newbcast:2 row_mask:0xf bank_mask:0xf
    v_smfmac_f32_16x16x64_bf16 v[240:243], a[136:139], v[144:151], v1
    v_cvt_pk_bf16_f32 v152, v224, v225
    v_mfma_f32_16x16x32_bf16 v[200:203], a[96:99], v[160:163], v[136:139]
    v_cvt_pk_bf16_f32 v153, v226, v227
    v_cvt_pk_bf16_f32 v154, v228, v229
    v_mfma_f32_16x16x32_bf16 v[200:203], a[100:103], v[164:167], v[200:203]
    v_cvt_pk_bf16_f32 v155, v230, v231
    v_mul_f32_dpp v224, v72, v40 row_newbcast:2 row_mask:0xf bank_mask:0xf
    v_mfma_f32_16x16x32_bf16 v[200:203], a[104:107], v[168:171], v[200:203]
    v_mul_f32_dpp v225, v73, v41 row_newbcast:2 row_mask:0xf bank_mask:0xf
    v_mul_f32_dpp v226, v74, v42 row_newbcast:2 row_mask:0xf bank_mask:0xf
    v_mfma_f32_16x16x32_bf16 v[200:203], a[108:111], v[172:175], v[200:203]
    v_mul_f32_dpp v227, v75, v43 row_newbcast:2 row_mask:0xf bank_mask:0xf
    v_mul_f32_dpp v228, v76, v44 row_newbcast:2 row_mask:0xf bank_mask:0xf
    v_mfma_f32_16x16x32_bf16 v[204:207], a[124:127], v[172:175], v[140:143]
    v_mul_f32_dpp v229, v77, v45 row_newbcast:2 row_mask:0xf bank_mask:0xf
    v_mul_f32_dpp v230, v78, v46 row_newbcast:2 row_mask:0xf bank_mask:0xf
    v_mfma_f32_16x16x32_bf16 v[204:207], a[120:123], v[168:171], v[204:207]
L_stub1:
    s_cbranch_scc1 L_main2
    v_mul_f32_dpp v231, v79, v47 row_newbcast:2 row_mask:0xf bank_mask:0xf
    v_cvt_pk_bf16_f32 v156, v224, v225
    v_mfma_f32_16x16x32_bf16 v[204:207], a[116:119], v[164:167], v[204:207]
    v_cvt_pk_bf16_f32 v157, v226, v227
    v_cvt_pk_bf16_f32 v158, v228, v229
    v_mfma_f32_16x16x32_bf16 v[204:207], a[112:115], v[160:163], v[204:207]
    v_cvt_pk_bf16_f32 v159, v230, v231
    v_cvt_pk_bf16_f32 v210, |v180|, |v181|
    v_mfma_f32_16x16x32_bf16 v[176:179], a[0:3], v[144:147], v[112:115]
    v_cvt_pk_bf16_f32 v211, |v182|, |v183|
    v_cvt_pk_bf16_f32 v212, |v184|, |v185|
    v_mfma_f32_16x16x32_bf16 v[176:179], a[4:7], v[148:151], v[176:179]
    v_cvt_pk_bf16_f32 v213, |v186|, |v187|
    v_cvt_pk_bf16_f32 v214, |v188|, |v189|
    v_mfma_f32_16x16x32_bf16 v[176:179], a[8:11], v[152:155], v[176:179]
    v_cvt_pk_bf16_f32 v215, |v190|, |v191|
    v_cvt_pk_bf16_f32 v216, |v192|, |v193|
    v_mfma_f32_16x16x32_bf16 v[176:179], a[12:15], v[156:159], v[176:179]
    v_cvt_pk_bf16_f32 v217, |v194|, |v195|
    v_cvt_pk_bf16_f32 v218, |v196|, |v197|
    v_smfmac_f32_16x16x64_bf16 v[236:239], a[176:179], v[208:215], v1
    v_cvt_pk_bf16_f32 v219, |v198|, |v199|
    v_mfma_f32_16x16x32_bf16 v[180:183], a[28:31], v[156:159], v[116:119]
    v_cvt_pk_bf16_f32 v220, |v200|, |v201|
    v_cvt_pk_bf16_f32 v221, |v202|, |v203|
    v_mfma_f32_16x16x32_bf16 v[180:183], a[24:27], v[152:155], v[180:183]
    v_cvt_pk_bf16_f32 v222, |v204|, |v205|
    v_cvt_pk_bf16_f32 v223, |v206|, |v207|
    v_mfma_f32_16x16x32_bf16 v[180:183], a[20:23], v[148:151], v[180:183]
    v_mul_f32_dpp v224, v48, v16 row_newbcast:5 row_mask:0xf bank_mask:0xf
    v_mul_f32_dpp v225, v49, v17 row_newbcast:5 row_mask:0xf bank_mask:0xf
    v_mfma_f32_16x16x32_bf16 v[180:183], a[16:19], v[144:147], v[180:183]
    v_mul_f32_dpp v226, v50, v18 row_newbcast:5 row_mask:0xf bank_mask:0xf
    v_mul_f32_dpp v227, v51, v19 row_newbcast:5 row_mask:0xf bank_mask:0xf
    v_smfmac_f32_16x16x64_bf16 v[236:239], a[180:183], v[216:223], v1
    v_mul_f32_dpp v228, v52, v20 row_newbcast:5 row_mask:0xf bank_mask:0xf
    v_mfma_f32_16x16x32_bf16 v[184:187], a[32:35], v[144:147], v[120:123]
    v_mul_f32_dpp v229, v53, v21 row_newbcast:5 row_mask:0xf bank_mask:0xf
    v_mul_f32_dpp v230, v54, v22 row_newbcast:5 row_mask:0xf bank_mask:0xf
    v_mfma_f32_16x16x32_bf16 v[184:187], a[36:39], v[148:151], v[184:187]
    v_mul_f32_dpp v231, v55, v23 row_newbcast:5 row_mask:0xf bank_mask:0xf
    v_cvt_pk_bf16_f32 v160, v224, v225
    v_mfma_f32_16x16x32_bf16 v[184:187], a[40:43], v[152:155], v[184:187]
    s_waitcnt vmcnt(0)
    v_cvt_pk_bf16_f32 v161, v226, v227
    v_cvt_pk_bf16_f32 v162, v228, v229
    v_mfma_f32_16x16x32_bf16 v[184:187], a[44:47], v[156:159], v[184:187]
    ds_read_b128 v[96:99], v6 offset:0
    v_cvt_pk_bf16_f32 v163, v230, v231
    v_smfmac_f32_16x16x64_bf16 v[240:243], a[140:143], v[152:159], v1
    v_mul_f32_dpp v224, v56, v24 row_newbcast:5 row_mask:0xf bank_mask:0xf
    v_mfma_f32_16x16x32_bf16 v[188:191], a[60:63], v[156:159], v[124:127]
    ds_read_b128 v[100:103], v6 offset:64
    v_mul_f32_dpp v225, v57, v25 row_newbcast:5 row_mask:0xf bank_mask:0xf
    v_mfma_f32_16x16x32_bf16 v[188:191], a[56:59], v[152:155], v[188:191]
    ds_read_b128 v[104:107], v6 offset:128
    v_mul_f32_dpp v226, v58, v26 row_newbcast:5 row_mask:0xf bank_mask:0xf
    v_mfma_f32_16x16x32_bf16 v[188:191], a[52:55], v[148:151], v[188:191]
    ds_read_b128 v[108:111], v6 offset:192
    v_mul_f32_dpp v227, v59, v27 row_newbcast:5 row_mask:0xf bank_mask:0xf
    v_mfma_f32_16x16x32_bf16 v[188:191], a[48:51], v[144:147], v[188:191]
    v_mul_f32_dpp v228, v60, v28 row_newbcast:5 row_mask:0xf bank_mask:0xf
    v_mul_f32_dpp v229, v61, v29 row_newbcast:5 row_mask:0xf bank_mask:0xf
    v_mfma_f32_16x16x32_bf16 v[192:195], a[64:67], v[144:147], v[128:131]
    v_mul_f32_dpp v230, v62, v30 row_newbcast:5 row_mask:0xf bank_mask:0xf
    v_mul_f32_dpp v231, v63, v31 row_newbcast:5 row_mask:0xf bank_mask:0xf
    v_mfma_f32_16x16x32_bf16 v[192:195], a[68:71], v[148:151], v[192:195]
    v_cvt_pk_bf16_f32 v208, |v176|, |v177|
    v_cvt_pk_bf16_f32 v209, |v178|, |v179|
    v_mfma_f32_16x16x32_bf16 v[192:195], a[72:75], v[152:155], v[192:195]
    v_cvt_pk_bf16_f32 v164, v224, v225
    v_cvt_pk_bf16_f32 v165, v226, v227
    v_mfma_f32_16x16x32_bf16 v[192:195], a[76:79], v[156:159], v[192:195]
    v_cvt_pk_bf16_f32 v166, v228, v229
    v_cvt_pk_bf16_f32 v167, v230, v231
    v_mfma_f32_16x16x32_bf16 v[196:199], a[92:95], v[156:159], v[132:135]
    v_mul_f32_dpp v224, v64, v32 row_newbcast:5 row_mask:0xf bank_mask:0xf
    v_mul_f32_dpp v225, v65, v33 row_newbcast:5 row_mask:0xf bank_mask:0xf
    v_mfma_f32_16x16x32_bf16 v[196:199], a[88:91], v[152:155], v[196:199]
    v_mul_f32_dpp v226, v66, v34 row_newbcast:5 row_mask:0xf bank_mask:0xf
    v_mul_f32_dpp v227, v67, v35 row_newbcast:5 row_mask:0xf bank_mask:0xf
    v_mfma_f32_16x16x32_bf16 v[196:199], a[84:87], v[148:151], v[196:199]
    v_mul_f32_dpp v228, v68, v36 row_newbcast:5 row_mask:0xf bank_mask:0xf
    v_mul_f32_dpp v229, v69, v37 row_newbcast:5 row_mask:0xf bank_mask:0xf
    v_mfma_f32_16x16x32_bf16 v[196:199], a[80:83], v[144:147], v[196:199]
    s_waitcnt lgkmcnt(0)
    v_mul_f32_dpp v230, v70, v38 row_newbcast:5 row_mask:0xf bank_mask:0xf
    v_mul_f32_dpp v231, v71, v39 row_newbcast:5 row_mask:0xf bank_mask:0xf
    v_mfma_f32_16x16x32_bf16 v[200:203], a[96:99], v[144:147], v[136:139]
    v_cvt_pk_bf16_f32 v168, v224, v225
    v_cvt_pk_bf16_f32 v169, v226, v227
    v_mfma_f32_16x16x32_bf16 v[200:203], a[100:103], v[148:151], v[200:203]
    v_cvt_pk_bf16_f32 v170, v228, v229
    v_cvt_pk_bf16_f32 v171, v230, v231
    v_mfma_f32_16x16x32_bf16 v[200:203], a[104:107], v[152:155], v[200:203]
    v_mul_f32_dpp v224, v72, v40 row_newbcast:5 row_mask:0xf bank_mask:0xf
    v_mul_f32_dpp v225, v73, v41 row_newbcast:5 row_mask:0xf bank_mask:0xf
    v_mfma_f32_16x16x32_bf16 v[200:203], a[108:111], v[156:159], v[200:203]
    v_mul_f32_dpp v226, v74, v42 row_newbcast:5 row_mask:0xf bank_mask:0xf
    v_mul_f32_dpp v227, v75, v43 row_newbcast:5 row_mask:0xf bank_mask:0xf
    v_mfma_f32_16x16x32_bf16 v[204:207], a[124:127], v[156:159], v[140:143]
    v_mul_f32_dpp v228, v76, v44 row_newbcast:5 row_mask:0xf bank_mask:0xf
    v_mul_f32_dpp v229, v77, v45 row_newbcast:5 row_mask:0xf bank_mask:0xf
    v_mfma_f32_16x16x32_bf16 v[204:207], a[120:123], v[152:155], v[204:207]
    v_mul_f32_dpp v230, v78, v46 row_newbcast:5 row_mask:0xf bank_mask:0xf
    v_mul_f32_dpp v231, v79, v47 row_newbcast:5 row_mask:0xf bank_mask:0xf
    v_mfma_f32_16x16x32_bf16 v[204:207], a[116:119], v[148:151], v[204:207]
    v_cvt_pk_bf16_f32 v172, v224, v225
    v_cvt_pk_bf16_f32 v173, v226, v227
    v_mfma_f32_16x16x32_bf16 v[204:207], a[112:115], v[144:147], v[204:207]
    v_cvt_pk_bf16_f32 v174, v228, v229
    v_cvt_pk_bf16_f32 v175, v230, v231
    v_mfma_f32_16x16x32_bf16 v[176:179], a[0:3], v[160:163], v[112:115]
    v_cvt_pk_bf16_f32 v210, |v180|, |v181|
    v_cvt_pk_bf16_f32 v211, |v182|, |v183|
    v_mfma_f32_16x16x32_bf16 v[176:179], a[4:7], v[164:167], v[176:179]
    v_cvt_pk_bf16_f32 v212, |v184|, |v185|
    v_cvt_pk_bf16_f32 v213, |v186|, |v187|
    v_mfma_f32_16x16x32_bf16 v[176:179], a[8:11], v[168:171], v[176:179]
    v_cvt_pk_bf16_f32 v214, |v188|, |v189|
    v_cvt_pk_bf16_f32 v215, |v190|, |v191|
    v_mfma_f32_16x16x32_bf16 v[176:179], a[12:15], v[172:175], v[176:179]
    v_cvt_pk_bf16_f32 v216, |v192|, |v193|
    v_cvt_pk_bf16_f32 v217, |v194|, |v195|
    v_smfmac_f32_16x16x64_bf16 v[240:243], a[128:131], v[208:215], v1
    v_cvt_pk_bf16_f32 v218, |v196|, |v197|
    v_mfma_f32_16x16x32_bf16 v[180:183], a[28:31], v[172:175], v[116:119]
    v_cvt_pk_bf16_f32 v219, |v198|, |v199|
    v_cvt_pk_bf16_f32 v220, |v200|, |v201|
    v_mfma_f32_16x16x32_bf16 v[180:183], a[24:27], v[168:171], v[180:183]
    v_cvt_pk_bf16_f32 v221, |v202|, |v203|
    v_cvt_pk_bf16_f32 v222, |v204|, |v205|
    v_mfma_f32_16x16x32_bf16 v[180:183], a[20:23], v[164:167], v[180:183]
    v_cvt_pk_bf16_f32 v223, |v206|, |v207|
    v_mul_f32_dpp v224, v48, v16 row_newbcast:7 row_mask:0xf bank_mask:0xf
    v_mfma_f32_16x16x32_bf16 v[180:183], a[16:19], v[160:163], v[180:183]
    v_mul_f32_dpp v225, v49, v17 row_newbcast:7 row_mask:0xf bank_mask:0xf
    v_mul_f32_dpp v226, v50, v18 row_newbcast:7 row_mask:0xf bank_mask:0xf
    v_smfmac_f32_16x16x64_bf16 v[240:243], a[132:135], v[216:223], v1
    v_mul_f32_dpp v227, v51, v19 row_newbcast:7 row_mask:0xf bank_mask:0xf
    v_mfma_f32_16x16x32_bf16 v[184:187], a[32:35], v[160:163], v[120:123]
    v_mul_f32_dpp v228, v52, v20 row_newbcast:7 row_mask:0xf bank_mask:0xf
    v_mul_f32_dpp v229, v53, v21 row_newbcast:7 row_mask:0xf bank_mask:0xf
    v_mfma_f32_16x16x32_bf16 v[184:187], a[36:39], v[164:167], v[184:187]
    v_mul_f32_dpp v230, v54, v22 row_newbcast:7 row_mask:0xf bank_mask:0xf
    v_mul_f32_dpp v231, v55, v23 row_newbcast:7 row_mask:0xf bank_mask:0xf
    v_mfma_f32_16x16x32_bf16 v[184:187], a[40:43], v[168:171], v[184:187]
    v_cvt_pk_bf16_f32 v144, v224, v225
    v_cvt_pk_bf16_f32 v145, v226, v227
    v_mfma_f32_16x16x32_bf16 v[184:187], a[44:47], v[172:175], v[184:187]
    v_cvt_pk_bf16_f32 v146, v228, v229
    v_cvt_pk_bf16_f32 v147, v230, v231
    v_smfmac_f32_16x16x64_bf16 v[240:243], a[152:155], v[160:167], v1
    v_mul_f32_dpp v224, v56, v24 row_newbcast:7 row_mask:0xf bank_mask:0xf
    v_mfma_f32_16x16x32_bf16 v[188:191], a[60:63], v[172:175], v[124:127]
    v_mul_f32_dpp v225, v57, v25 row_newbcast:7 row_mask:0xf bank_mask:0xf
    v_mul_f32_dpp v226, v58, v26 row_newbcast:7 row_mask:0xf bank_mask:0xf
    v_mfma_f32_16x16x32_bf16 v[188:191], a[56:59], v[168:171], v[188:191]
    v_mul_f32_dpp v227, v59, v27 row_newbcast:7 row_mask:0xf bank_mask:0xf
    v_mul_f32_dpp v228, v60, v28 row_newbcast:7 row_mask:0xf bank_mask:0xf
    v_mfma_f32_16x16x32_bf16 v[188:191], a[52:55], v[164:167], v[188:191]
    v_mul_f32_dpp v229, v61, v29 row_newbcast:7 row_mask:0xf bank_mask:0xf
    v_mul_f32_dpp v230, v62, v30 row_newbcast:7 row_mask:0xf bank_mask:0xf
    v_mfma_f32_16x16x32_bf16 v[188:191], a[48:51], v[160:163], v[188:191]
    v_mul_f32_dpp v231, v63, v31 row_newbcast:7 row_mask:0xf bank_mask:0xf
    v_cvt_pk_bf16_f32 v208, |v176|, |v177|
    v_smfmac_f32_16x16x64_bf16 v[240:243], a[156:159], v[168:175], v1
    v_cvt_pk_bf16_f32 v209, |v178|, |v179|
    v_mfma_f32_16x16x32_bf16 v[192:195], a[64:67], v[160:163], v[128:131]
    v_cvt_pk_bf16_f32 v148, v224, v225
    v_cvt_pk_bf16_f32 v149, v226, v227
    v_mfma_f32_16x16x32_bf16 v[192:195], a[68:71], v[164:167], v[192:195]
    v_cvt_pk_bf16_f32 v150, v228, v229
    v_cvt_pk_bf16_f32 v151, v230, v231
    v_mfma_f32_16x16x32_bf16 v[192:195], a[72:75], v[168:171], v[192:195]
    v_mul_f32_dpp v224, v64, v32 row_newbcast:7 row_mask:0xf bank_mask:0xf
    v_mul_f32_dpp v225, v65, v33 row_newbcast:7 row_mask:0xf bank_mask:0xf
    v_mfma_f32_16x16x32_bf16 v[192:195], a[76:79], v[172:175], v[192:195]
    v_mul_f32_dpp v226, v66, v34 row_newbcast:7 row_mask:0xf bank_mask:0xf
    v_mul_f32_dpp v227, v67, v35 row_newbcast:7 row_mask:0xf bank_mask:0xf
    v_mfma_f32_16x16x32_bf16 v[196:199], a[92:95], v[172:175], v[132:135]
    v_mul_f32_dpp v228, v68, v36 row_newbcast:7 row_mask:0xf bank_mask:0xf
    v_mul_f32_dpp v229, v69, v37 row_newbcast:7 row_mask:0xf bank_mask:0xf
    v_mfma_f32_16x16x32_bf16 v[196:199], a[88:91], v[168:171], v[196:199]
    v_mul_f32_dpp v230, v70, v38 row_newbcast:7 row_mask:0xf bank_mask:0xf
    v_mul_f32_dpp v231, v71, v39 row_newbcast:7 row_mask:0xf bank_mask:0xf
    v_mfma_f32_16x16x32_bf16 v[196:199], a[84:87], v[164:167], v[196:199]
    v_cvt_pk_bf16_f32 v152, v224, v225
    v_cvt_pk_bf16_f32 v153, v226, v227
    v_mfma_f32_16x16x32_bf16 v[196:199], a[80:83], v[160:163], v[196:199]
    v_cvt_pk_bf16_f32 v154, v228, v229
    v_cvt_pk_bf16_f32 v155, v230, v231
    v_mfma_f32_16x16x32_bf16 v[200:203], a[96:99], v[160:163], v[136:139]
    v_mul_f32_dpp v224, v72, v40 row_newbcast:7 row_mask:0xf bank_mask:0xf
    v_mul_f32_dpp v225, v73, v41 row_newbcast:7 row_mask:0xf bank_mask:0xf
    v_mfma_f32_16x16x32_bf16 v[200:203], a[100:103], v[164:167], v[200:203]
    v_mul_f32_dpp v226, v74, v42 row_newbcast:7 row_mask:0xf bank_mask:0xf
    v_mul_f32_dpp v227, v75, v43 row_newbcast:7 row_mask:0xf bank_mask:0xf
    v_mfma_f32_16x16x32_bf16 v[200:203], a[104:107], v[168:171], v[200:203]
    v_mul_f32_dpp v228, v76, v44 row_newbcast:7 row_mask:0xf bank_mask:0xf
    v_mul_f32_dpp v229, v77, v45 row_newbcast:7 row_mask:0xf bank_mask:0xf
    v_mfma_f32_16x16x32_bf16 v[200:203], a[108:111], v[172:175], v[200:203]
    v_mul_f32_dpp v230, v78, v46 row_newbcast:7 row_mask:0xf bank_mask:0xf
    v_mul_f32_dpp v231, v79, v47 row_newbcast:7 row_mask:0xf bank_mask:0xf
    v_mfma_f32_16x16x32_bf16 v[204:207], a[124:127], v[172:175], v[140:143]
    v_cvt_pk_bf16_f32 v156, v224, v225
    v_cvt_pk_bf16_f32 v157, v226, v227
    v_mfma_f32_16x16x32_bf16 v[204:207], a[120:123], v[168:171], v[204:207]
    v_cvt_pk_bf16_f32 v158, v228, v229
    v_cvt_pk_bf16_f32 v159, v230, v231
    v_mfma_f32_16x16x32_bf16 v[204:207], a[116:119], v[164:167], v[204:207]
    v_cvt_pk_bf16_f32 v210, |v180|, |v181|
    v_cvt_pk_bf16_f32 v211, |v182|, |v183|
    v_mfma_f32_16x16x32_bf16 v[204:207], a[112:115], v[160:163], v[204:207]
    v_cvt_pk_bf16_f32 v212, |v184|, |v185|
    v_cvt_pk_bf16_f32 v213, |v186|, |v187|
    v_mfma_f32_16x16x32_bf16 v[176:179], a[0:3], v[144:147], v[112:115]
    v_cvt_pk_bf16_f32 v214, |v188|, |v189|
    v_cvt_pk_bf16_f32 v215, |v190|, |v191|
    v_mfma_f32_16x16x32_bf16 v[176:179], a[4:7], v[148:151], v[176:179]
    v_cvt_pk_bf16_f32 v216, |v192|, |v193|
    v_cvt_pk_bf16_f32 v217, |v194|, |v195|
    v_mfma_f32_16x16x32_bf16 v[176:179], a[8:11], v[152:155], v[176:179]
    v_cvt_pk_bf16_f32 v218, |v196|, |v197|
    v_cvt_pk_bf16_f32 v219, |v198|, |v199|
    v_mfma_f32_16x16x32_bf16 v[176:179], a[12:15], v[156:159], v[176:179]
    v_cvt_pk_bf16_f32 v220, |v200|, |v201|
    v_cvt_pk_bf16_f32 v221, |v202|, |v203|
    v_smfmac_f32_16x16x64_bf16 v[240:243], a[144:147], v[208:215], v1
    v_cvt_pk_bf16_f32 v222, |v204|, |v205|
    v_mfma_f32_16x16x32_bf16 v[180:183], a[28:31], v[156:159], v[116:119]
    v_cvt_pk_bf16_f32 v223, |v206|, |v207|
    v_mul_f32_dpp v224, v48, v16 row_newbcast:9 row_mask:0xf bank_mask:0xf
    v_mfma_f32_16x16x32_bf16 v[180:183], a[24:27], v[152:155], v[180:183]
    v_mul_f32_dpp v225, v49, v17 row_newbcast:9 row_mask:0xf bank_mask:0xf
    v_mul_f32_dpp v226, v50, v18 row_newbcast:9 row_mask:0xf bank_mask:0xf
    v_mfma_f32_16x16x32_bf16 v[180:183], a[20:23], v[148:151], v[180:183]
    v_mul_f32_dpp v227, v51, v19 row_newbcast:9 row_mask:0xf bank_mask:0xf
    v_mul_f32_dpp v228, v52, v20 row_newbcast:9 row_mask:0xf bank_mask:0xf
    v_mfma_f32_16x16x32_bf16 v[180:183], a[16:19], v[144:147], v[180:183]
    v_mul_f32_dpp v229, v53, v21 row_newbcast:9 row_mask:0xf bank_mask:0xf
    v_mul_f32_dpp v230, v54, v22 row_newbcast:9 row_mask:0xf bank_mask:0xf
    v_smfmac_f32_16x16x64_bf16 v[240:243], a[148:151], v[216:223], v1
    v_mul_f32_dpp v231, v55, v23 row_newbcast:9 row_mask:0xf bank_mask:0xf
    v_mfma_f32_16x16x32_bf16 v[184:187], a[32:35], v[144:147], v[120:123]
    v_cvt_pk_bf16_f32 v160, v224, v225
    v_cvt_pk_bf16_f32 v161, v226, v227
    v_mfma_f32_16x16x32_bf16 v[184:187], a[36:39], v[148:151], v[184:187]
    v_cvt_pk_bf16_f32 v162, v228, v229
    v_cvt_pk_bf16_f32 v163, v230, v231
    v_mfma_f32_16x16x32_bf16 v[184:187], a[40:43], v[152:155], v[184:187]
    v_mul_f32_dpp v224, v56, v24 row_newbcast:9 row_mask:0xf bank_mask:0xf
    v_mul_f32_dpp v225, v57, v25 row_newbcast:9 row_mask:0xf bank_mask:0xf
    v_mfma_f32_16x16x32_bf16 v[184:187], a[44:47], v[156:159], v[184:187]
    v_mul_f32_dpp v226, v58, v26 row_newbcast:9 row_mask:0xf bank_mask:0xf
    v_mul_f32_dpp v227, v59, v27 row_newbcast:9 row_mask:0xf bank_mask:0xf
    v_smfmac_f32_16x16x64_bf16 v[240:243], a[168:171], v[144:151], v1
    v_mul_f32_dpp v228, v60, v28 row_newbcast:9 row_mask:0xf bank_mask:0xf
    v_mfma_f32_16x16x32_bf16 v[188:191], a[60:63], v[156:159], v[124:127]
    v_mul_f32_dpp v229, v61, v29 row_newbcast:9 row_mask:0xf bank_mask:0xf
    v_mul_f32_dpp v230, v62, v30 row_newbcast:9 row_mask:0xf bank_mask:0xf
    v_mfma_f32_16x16x32_bf16 v[188:191], a[56:59], v[152:155], v[188:191]
    v_mul_f32_dpp v231, v63, v31 row_newbcast:9 row_mask:0xf bank_mask:0xf
    v_cvt_pk_bf16_f32 v208, |v176|, |v177|
    v_mfma_f32_16x16x32_bf16 v[188:191], a[52:55], v[148:151], v[188:191]
    v_cvt_pk_bf16_f32 v209, |v178|, |v179|
    v_cvt_pk_bf16_f32 v164, v224, v225
    v_mfma_f32_16x16x32_bf16 v[188:191], a[48:51], v[144:147], v[188:191]
    v_cvt_pk_bf16_f32 v165, v226, v227
    v_cvt_pk_bf16_f32 v166, v228, v229
    v_smfmac_f32_16x16x64_bf16 v[240:243], a[172:175], v[152:159], v1
    v_cvt_pk_bf16_f32 v167, v230, v231
    v_mfma_f32_16x16x32_bf16 v[192:195], a[64:67], v[144:147], v[128:131]
    v_mul_f32_dpp v224, v64, v32 row_newbcast:9 row_mask:0xf bank_mask:0xf
    v_mul_f32_dpp v225, v65, v33 row_newbcast:9 row_mask:0xf bank_mask:0xf
    v_mfma_f32_16x16x32_bf16 v[192:195], a[68:71], v[148:151], v[192:195]
    v_mul_f32_dpp v226, v66, v34 row_newbcast:9 row_mask:0xf bank_mask:0xf
    v_mul_f32_dpp v227, v67, v35 row_newbcast:9 row_mask:0xf bank_mask:0xf
    v_mfma_f32_16x16x32_bf16 v[192:195], a[72:75], v[152:155], v[192:195]
    v_mul_f32_dpp v228, v68, v36 row_newbcast:9 row_mask:0xf bank_mask:0xf
    v_mul_f32_dpp v229, v69, v37 row_newbcast:9 row_mask:0xf bank_mask:0xf
    v_mfma_f32_16x16x32_bf16 v[192:195], a[76:79], v[156:159], v[192:195]
    v_mul_f32_dpp v230, v70, v38 row_newbcast:9 row_mask:0xf bank_mask:0xf
    v_mul_f32_dpp v231, v71, v39 row_newbcast:9 row_mask:0xf bank_mask:0xf
    v_mfma_f32_16x16x32_bf16 v[196:199], a[92:95], v[156:159], v[132:135]
    v_cvt_pk_bf16_f32 v168, v224, v225
    v_cvt_pk_bf16_f32 v169, v226, v227
    v_mfma_f32_16x16x32_bf16 v[196:199], a[88:91], v[152:155], v[196:199]
    v_cvt_pk_bf16_f32 v170, v228, v229
    v_cvt_pk_bf16_f32 v171, v230, v231
    v_mfma_f32_16x16x32_bf16 v[196:199], a[84:87], v[148:151], v[196:199]
    v_mul_f32_dpp v224, v72, v40 row_newbcast:9 row_mask:0xf bank_mask:0xf
    v_mul_f32_dpp v225, v73, v41 row_newbcast:9 row_mask:0xf bank_mask:0xf
    v_mfma_f32_16x16x32_bf16 v[196:199], a[80:83], v[144:147], v[196:199]
    v_mul_f32_dpp v226, v74, v42 row_newbcast:9 row_mask:0xf bank_mask:0xf
    v_mul_f32_dpp v227, v75, v43 row_newbcast:9 row_mask:0xf bank_mask:0xf
    v_mfma_f32_16x16x32_bf16 v[200:203], a[96:99], v[144:147], v[136:139]
    v_mul_f32_dpp v228, v76, v44 row_newbcast:9 row_mask:0xf bank_mask:0xf
    v_mul_f32_dpp v229, v77, v45 row_newbcast:9 row_mask:0xf bank_mask:0xf
    v_mfma_f32_16x16x32_bf16 v[200:203], a[100:103], v[148:151], v[200:203]
    v_mul_f32_dpp v230, v78, v46 row_newbcast:9 row_mask:0xf bank_mask:0xf
    v_mul_f32_dpp v231, v79, v47 row_newbcast:9 row_mask:0xf bank_mask:0xf
    v_mfma_f32_16x16x32_bf16 v[200:203], a[104:107], v[152:155], v[200:203]
    v_cvt_pk_bf16_f32 v172, v224, v225
    v_cvt_pk_bf16_f32 v173, v226, v227
    v_mfma_f32_16x16x32_bf16 v[200:203], a[108:111], v[156:159], v[200:203]
    v_cvt_pk_bf16_f32 v174, v228, v229
    v_cvt_pk_bf16_f32 v175, v230, v231
    v_mfma_f32_16x16x32_bf16 v[204:207], a[124:127], v[156:159], v[140:143]
    v_cvt_pk_bf16_f32 v210, |v180|, |v181|
    v_cvt_pk_bf16_f32 v211, |v182|, |v183|
    v_mfma_f32_16x16x32_bf16 v[204:207], a[120:123], v[152:155], v[204:207]
    v_cvt_pk_bf16_f32 v212, |v184|, |v185|
    v_cvt_pk_bf16_f32 v213, |v186|, |v187|
    v_mfma_f32_16x16x32_bf16 v[204:207], a[116:119], v[148:151], v[204:207]
    v_cvt_pk_bf16_f32 v214, |v188|, |v189|
    v_cvt_pk_bf16_f32 v215, |v190|, |v191|
    v_mfma_f32_16x16x32_bf16 v[204:207], a[112:115], v[144:147], v[204:207]
    v_cvt_pk_bf16_f32 v216, |v192|, |v193|
    v_cvt_pk_bf16_f32 v217, |v194|, |v195|
    v_smfmac_f32_16x16x64_bf16 v[240:243], a[160:163], v[208:215], v1
    v_cvt_pk_bf16_f32 v218, |v196|, |v197|
    v_mfma_f32_16x16x32_bf16 v[176:179], a[0:3], v[160:163], v[112:115]
    v_cvt_pk_bf16_f32 v219, |v198|, |v199|
    v_cvt_pk_bf16_f32 v220, |v200|, |v201|
    v_mfma_f32_16x16x32_bf16 v[176:179], a[4:7], v[164:167], v[176:179]
    v_cvt_pk_bf16_f32 v221, |v202|, |v203|
    v_cvt_pk_bf16_f32 v222, |v204|, |v205|
    v_mfma_f32_16x16x32_bf16 v[176:179], a[8:11], v[168:171], v[176:179]
    v_cvt_pk_bf16_f32 v223, |v206|, |v207|
    v_mul_f32_dpp v224, v48, v16 row_newbcast:8 row_mask:0xf bank_mask:0xf
    v_mfma_f32_16x16x32_bf16 v[176:179], a[12:15], v[172:175], v[176:179]
    v_mul_f32_dpp v225, v49, v17 row_newbcast:8 row_mask:0xf bank_mask:0xf
    v_mul_f32_dpp v226, v50, v18 row_newbcast:8 row_mask:0xf bank_mask:0xf
    v_smfmac_f32_16x16x64_bf16 v[240:243], a[164:167], v[216:223], v1
    v_mul_f32_dpp v227, v51, v19 row_newbcast:8 row_mask:0xf bank_mask:0xf
    v_mfma_f32_16x16x32_bf16 v[180:183], a[28:31], v[172:175], v[116:119]
    v_mul_f32_dpp v228, v52, v20 row_newbcast:8 row_mask:0xf bank_mask:0xf
    v_mul_f32_dpp v229, v53, v21 row_newbcast:8 row_mask:0xf bank_mask:0xf
    v_mfma_f32_16x16x32_bf16 v[180:183], a[24:27], v[168:171], v[180:183]
    v_mul_f32_dpp v230, v54, v22 row_newbcast:8 row_mask:0xf bank_mask:0xf
    v_mul_f32_dpp v231, v55, v23 row_newbcast:8 row_mask:0xf bank_mask:0xf
    v_mfma_f32_16x16x32_bf16 v[180:183], a[20:23], v[164:167], v[180:183]
    v_cvt_pk_bf16_f32 v144, v224, v225
    v_cvt_pk_bf16_f32 v145, v226, v227
    v_mfma_f32_16x16x32_bf16 v[180:183], a[16:19], v[160:163], v[180:183]
    v_cvt_pk_bf16_f32 v146, v228, v229
    v_cvt_pk_bf16_f32 v147, v230, v231
    v_smfmac_f32_16x16x64_bf16 v[240:243], a[184:187], v[160:167], v1
    v_mul_f32_dpp v224, v56, v24 row_newbcast:8 row_mask:0xf bank_mask:0xf
    v_mfma_f32_16x16x32_bf16 v[184:187], a[32:35], v[160:163], v[120:123]
    v_mul_f32_dpp v225, v57, v25 row_newbcast:8 row_mask:0xf bank_mask:0xf
    v_mul_f32_dpp v226, v58, v26 row_newbcast:8 row_mask:0xf bank_mask:0xf
    v_mfma_f32_16x16x32_bf16 v[184:187], a[36:39], v[164:167], v[184:187]
    v_mul_f32_dpp v227, v59, v27 row_newbcast:8 row_mask:0xf bank_mask:0xf
    v_mul_f32_dpp v228, v60, v28 row_newbcast:8 row_mask:0xf bank_mask:0xf
    v_mfma_f32_16x16x32_bf16 v[184:187], a[40:43], v[168:171], v[184:187]
    v_mul_f32_dpp v229, v61, v29 row_newbcast:8 row_mask:0xf bank_mask:0xf
    v_mul_f32_dpp v230, v62, v30 row_newbcast:8 row_mask:0xf bank_mask:0xf
    v_mfma_f32_16x16x32_bf16 v[184:187], a[44:47], v[172:175], v[184:187]
    v_mul_f32_dpp v231, v63, v31 row_newbcast:8 row_mask:0xf bank_mask:0xf
    v_cvt_pk_bf16_f32 v208, |v176|, |v177|
    v_smfmac_f32_16x16x64_bf16 v[240:243], a[188:191], v[168:175], v1
    v_cvt_pk_bf16_f32 v209, |v178|, |v179|
    v_mfma_f32_16x16x32_bf16 v[188:191], a[60:63], v[172:175], v[124:127]
    v_cvt_pk_bf16_f32 v148, v224, v225
    v_cvt_pk_bf16_f32 v149, v226, v227
    v_mfma_f32_16x16x32_bf16 v[188:191], a[56:59], v[168:171], v[188:191]
    v_cvt_pk_bf16_f32 v150, v228, v229
    v_cvt_pk_bf16_f32 v151, v230, v231
    v_mfma_f32_16x16x32_bf16 v[188:191], a[52:55], v[164:167], v[188:191]
    v_mul_f32_dpp v224, v64, v32 row_newbcast:8 row_mask:0xf bank_mask:0xf
    v_mul_f32_dpp v225, v65, v33 row_newbcast:8 row_mask:0xf bank_mask:0xf
    v_mfma_f32_16x16x32_bf16 v[188:191], a[48:51], v[160:163], v[188:191]
    v_mul_f32_dpp v226, v66, v34 row_newbcast:8 row_mask:0xf bank_mask:0xf
    v_mul_f32_dpp v227, v67, v35 row_newbcast:8 row_mask:0xf bank_mask:0xf
    v_smfmac_f32_16x16x64_bf16 v[244:247], a[136:139], v[144:151], v1
    v_mul_f32_dpp v228, v68, v36 row_newbcast:8 row_mask:0xf bank_mask:0xf
    v_mfma_f32_16x16x32_bf16 v[192:195], a[64:67], v[160:163], v[128:131]
    v_mul_f32_dpp v229, v69, v37 row_newbcast:8 row_mask:0xf bank_mask:0xf
    v_mul_f32_dpp v230, v70, v38 row_newbcast:8 row_mask:0xf bank_mask:0xf
    v_mfma_f32_16x16x32_bf16 v[192:195], a[68:71], v[164:167], v[192:195]
    v_mul_f32_dpp v231, v71, v39 row_newbcast:8 row_mask:0xf bank_mask:0xf
    v_cvt_pk_bf16_f32 v152, v224, v225
    v_mfma_f32_16x16x32_bf16 v[192:195], a[72:75], v[168:171], v[192:195]
    v_cvt_pk_bf16_f32 v153, v226, v227
    v_cvt_pk_bf16_f32 v154, v228, v229
    v_mfma_f32_16x16x32_bf16 v[192:195], a[76:79], v[172:175], v[192:195]
    v_cvt_pk_bf16_f32 v155, v230, v231
    v_mul_f32_dpp v224, v72, v40 row_newbcast:8 row_mask:0xf bank_mask:0xf
    v_mfma_f32_16x16x32_bf16 v[196:199], a[92:95], v[172:175], v[132:135]
    v_mul_f32_dpp v225, v73, v41 row_newbcast:8 row_mask:0xf bank_mask:0xf
    v_mul_f32_dpp v226, v74, v42 row_newbcast:8 row_mask:0xf bank_mask:0xf
    v_mfma_f32_16x16x32_bf16 v[196:199], a[88:91], v[168:171], v[196:199]
    v_mul_f32_dpp v227, v75, v43 row_newbcast:8 row_mask:0xf bank_mask:0xf
    v_mul_f32_dpp v228, v76, v44 row_newbcast:8 row_mask:0xf bank_mask:0xf
    v_mfma_f32_16x16x32_bf16 v[196:199], a[84:87], v[164:167], v[196:199]
    v_mul_f32_dpp v229, v77, v45 row_newbcast:8 row_mask:0xf bank_mask:0xf
    v_mul_f32_dpp v230, v78, v46 row_newbcast:8 row_mask:0xf bank_mask:0xf
    v_mfma_f32_16x16x32_bf16 v[196:199], a[80:83], v[160:163], v[196:199]
    v_mul_f32_dpp v231, v79, v47 row_newbcast:8 row_mask:0xf bank_mask:0xf
    v_cvt_pk_bf16_f32 v156, v224, v225
    v_mfma_f32_16x16x32_bf16 v[200:203], a[96:99], v[160:163], v[136:139]
    v_cvt_pk_bf16_f32 v157, v226, v227
    v_cvt_pk_bf16_f32 v158, v228, v229
    v_mfma_f32_16x16x32_bf16 v[200:203], a[100:103], v[164:167], v[200:203]
    v_cvt_pk_bf16_f32 v159, v230, v231
    v_cvt_pk_bf16_f32 v210, |v180|, |v181|
    v_mfma_f32_16x16x32_bf16 v[200:203], a[104:107], v[168:171], v[200:203]
    v_cvt_pk_bf16_f32 v211, |v182|, |v183|
    v_cvt_pk_bf16_f32 v212, |v184|, |v185|
    v_mfma_f32_16x16x32_bf16 v[200:203], a[108:111], v[172:175], v[200:203]
    v_cvt_pk_bf16_f32 v213, |v186|, |v187|
    v_cvt_pk_bf16_f32 v214, |v188|, |v189|
    v_smfmac_f32_16x16x64_bf16 v[244:247], a[140:143], v[152:159], v1
    v_cvt_pk_bf16_f32 v215, |v190|, |v191|
    v_mfma_f32_16x16x32_bf16 v[204:207], a[124:127], v[172:175], v[140:143]
    v_cvt_pk_bf16_f32 v216, |v192|, |v193|
    v_cvt_pk_bf16_f32 v217, |v194|, |v195|
    v_mfma_f32_16x16x32_bf16 v[204:207], a[120:123], v[168:171], v[204:207]
    v_cvt_pk_bf16_f32 v218, |v196|, |v197|
    v_cvt_pk_bf16_f32 v219, |v198|, |v199|
    v_mfma_f32_16x16x32_bf16 v[204:207], a[116:119], v[164:167], v[204:207]
    v_cvt_pk_bf16_f32 v220, |v200|, |v201|
    v_cvt_pk_bf16_f32 v221, |v202|, |v203|
    v_mfma_f32_16x16x32_bf16 v[204:207], a[112:115], v[160:163], v[204:207]
    v_mul_f32_dpp v224, v48, v16 row_newbcast:0 row_mask:0xf bank_mask:0xf
    v_mul_f32_dpp v225, v49, v17 row_newbcast:0 row_mask:0xf bank_mask:0xf
    v_smfmac_f32_16x16x64_bf16 v[240:243], a[176:179], v[208:215], v1
    v_mul_f32_dpp v226, v50, v18 row_newbcast:0 row_mask:0xf bank_mask:0xf
    v_mfma_f32_16x16x32_bf16 v[176:179], a[0:3], v[144:147], v[112:115]
    v_mul_f32_dpp v227, v51, v19 row_newbcast:0 row_mask:0xf bank_mask:0xf
    v_mul_f32_dpp v228, v52, v20 row_newbcast:0 row_mask:0xf bank_mask:0xf
    v_mfma_f32_16x16x32_bf16 v[176:179], a[4:7], v[148:151], v[176:179]
    v_cvt_pk_bf16_f32 v222, |v204|, |v205|
    v_cvt_pk_bf16_f32 v223, |v206|, |v207|
    v_mfma_f32_16x16x32_bf16 v[176:179], a[8:11], v[152:155], v[176:179]
    v_mul_f32_dpp v229, v53, v21 row_newbcast:0 row_mask:0xf bank_mask:0xf
    v_mul_f32_dpp v230, v54, v22 row_newbcast:0 row_mask:0xf bank_mask:0xf
    v_mfma_f32_16x16x32_bf16 v[176:179], a[12:15], v[156:159], v[176:179]
    v_mul_f32_dpp v231, v55, v23 row_newbcast:0 row_mask:0xf bank_mask:0xf
    v_cvt_pk_bf16_f32 v160, v224, v225
    v_smfmac_f32_16x16x64_bf16 v[240:243], a[180:183], v[216:223], v1
    v_cvt_pk_bf16_f32 v161, v226, v227
    v_mfma_f32_16x16x32_bf16 v[180:183], a[28:31], v[156:159], v[116:119]
    v_cvt_pk_bf16_f32 v162, v228, v229
    v_cvt_pk_bf16_f32 v163, v230, v231
    v_mfma_f32_16x16x32_bf16 v[180:183], a[24:27], v[152:155], v[180:183]
    v_mul_f32_dpp v224, v56, v24 row_newbcast:0 row_mask:0xf bank_mask:0xf
    v_mul_f32_dpp v225, v57, v25 row_newbcast:0 row_mask:0xf bank_mask:0xf
    v_mfma_f32_16x16x32_bf16 v[180:183], a[20:23], v[148:151], v[180:183]
    v_mul_f32_dpp v226, v58, v26 row_newbcast:0 row_mask:0xf bank_mask:0xf
    v_mul_f32_dpp v227, v59, v27 row_newbcast:0 row_mask:0xf bank_mask:0xf
    v_mfma_f32_16x16x32_bf16 v[180:183], a[16:19], v[144:147], v[180:183]
    v_mul_f32_dpp v228, v60, v28 row_newbcast:0 row_mask:0xf bank_mask:0xf
    v_mul_f32_dpp v229, v61, v29 row_newbcast:0 row_mask:0xf bank_mask:0xf
    v_mfma_f32_16x16x32_bf16 v[184:187], a[32:35], v[144:147], v[120:123]
    v_mul_f32_dpp v230, v62, v30 row_newbcast:0 row_mask:0xf bank_mask:0xf
    v_mul_f32_dpp v231, v63, v31 row_newbcast:0 row_mask:0xf bank_mask:0xf
    v_mfma_f32_16x16x32_bf16 v[184:187], a[36:39], v[148:151], v[184:187]
    v_cvt_pk_bf16_f32 v208, |v176|, |v177|
    v_cvt_pk_bf16_f32 v209, |v178|, |v179|
    v_mfma_f32_16x16x32_bf16 v[184:187], a[40:43], v[152:155], v[184:187]
    v_cvt_pk_bf16_f32 v164, v224, v225
    v_cvt_pk_bf16_f32 v165, v226, v227
    v_mfma_f32_16x16x32_bf16 v[184:187], a[44:47], v[156:159], v[184:187]
    v_cvt_pk_bf16_f32 v166, v228, v229
    v_cvt_pk_bf16_f32 v167, v230, v231
    v_mfma_f32_16x16x32_bf16 v[188:191], a[60:63], v[156:159], v[124:127]
    v_mul_f32_dpp v224, v64, v32 row_newbcast:0 row_mask:0xf bank_mask:0xf
    v_mul_f32_dpp v225, v65, v33 row_newbcast:0 row_mask:0xf bank_mask:0xf
    v_mfma_f32_16x16x32_bf16 v[188:191], a[56:59], v[152:155], v[188:191]
    v_mul_f32_dpp v226, v66, v34 row_newbcast:0 row_mask:0xf bank_mask:0xf
    v_mul_f32_dpp v227, v67, v35 row_newbcast:0 row_mask:0xf bank_mask:0xf
    v_mfma_f32_16x16x32_bf16 v[188:191], a[52:55], v[148:151], v[188:191]
    v_mul_f32_dpp v228, v68, v36 row_newbcast:0 row_mask:0xf bank_mask:0xf
    v_mul_f32_dpp v229, v69, v37 row_newbcast:0 row_mask:0xf bank_mask:0xf
    v_mfma_f32_16x16x32_bf16 v[188:191], a[48:51], v[144:147], v[188:191]
    v_mul_f32_dpp v230, v70, v38 row_newbcast:0 row_mask:0xf bank_mask:0xf
    v_mul_f32_dpp v231, v71, v39 row_newbcast:0 row_mask:0xf bank_mask:0xf
    v_mfma_f32_16x16x32_bf16 v[192:195], a[64:67], v[144:147], v[128:131]
    v_cvt_pk_bf16_f32 v168, v224, v225
    v_cvt_pk_bf16_f32 v169, v226, v227
    v_mfma_f32_16x16x32_bf16 v[192:195], a[68:71], v[148:151], v[192:195]
    v_cvt_pk_bf16_f32 v170, v228, v229
    v_cvt_pk_bf16_f32 v171, v230, v231
    v_mfma_f32_16x16x32_bf16 v[192:195], a[72:75], v[152:155], v[192:195]
    v_mul_f32_dpp v224, v72, v40 row_newbcast:0 row_mask:0xf bank_mask:0xf
    v_mul_f32_dpp v225, v73, v41 row_newbcast:0 row_mask:0xf bank_mask:0xf
    v_mfma_f32_16x16x32_bf16 v[192:195], a[76:79], v[156:159], v[192:195]
    v_mul_f32_dpp v226, v74, v42 row_newbcast:0 row_mask:0xf bank_mask:0xf
    v_mul_f32_dpp v227, v75, v43 row_newbcast:0 row_mask:0xf bank_mask:0xf
    v_mfma_f32_16x16x32_bf16 v[196:199], a[92:95], v[156:159], v[132:135]
    v_mul_f32_dpp v228, v76, v44 row_newbcast:0 row_mask:0xf bank_mask:0xf
    v_mul_f32_dpp v229, v77, v45 row_newbcast:0 row_mask:0xf bank_mask:0xf
    v_mfma_f32_16x16x32_bf16 v[196:199], a[88:91], v[152:155], v[196:199]
    v_mul_f32_dpp v230, v78, v46 row_newbcast:0 row_mask:0xf bank_mask:0xf
    v_mul_f32_dpp v231, v79, v47 row_newbcast:0 row_mask:0xf bank_mask:0xf
    v_mfma_f32_16x16x32_bf16 v[196:199], a[84:87], v[148:151], v[196:199]
    v_cvt_pk_bf16_f32 v172, v224, v225
    v_cvt_pk_bf16_f32 v173, v226, v227
    v_mfma_f32_16x16x32_bf16 v[196:199], a[80:83], v[144:147], v[196:199]
    v_cvt_pk_bf16_f32 v174, v228, v229
    v_cvt_pk_bf16_f32 v175, v230, v231
    v_mfma_f32_16x16x32_bf16 v[200:203], a[96:99], v[144:147], v[136:139]
    v_cvt_pk_bf16_f32 v210, |v180|, |v181|
    v_cvt_pk_bf16_f32 v211, |v182|, |v183|
    v_mfma_f32_16x16x32_bf16 v[200:203], a[100:103], v[148:151], v[200:203]
    v_cvt_pk_bf16_f32 v212, |v184|, |v185|
    v_cvt_pk_bf16_f32 v213, |v186|, |v187|
    v_mfma_f32_16x16x32_bf16 v[200:203], a[104:107], v[152:155], v[200:203]
    v_cvt_pk_bf16_f32 v214, |v188|, |v189|
    v_cvt_pk_bf16_f32 v215, |v190|, |v191|
    v_mfma_f32_16x16x32_bf16 v[200:203], a[108:111], v[156:159], v[200:203]
L_stub2:
    s_cbranch_scc1 L_main2
    v_cvt_pk_bf16_f32 v216, |v192|, |v193|
    v_cvt_pk_bf16_f32 v217, |v194|, |v195|
    v_smfmac_f32_16x16x64_bf16 v[244:247], a[128:131], v[208:215], v1
    v_cvt_pk_bf16_f32 v218, |v196|, |v197|
    v_mfma_f32_16x16x32_bf16 v[204:207], a[124:127], v[156:159], v[140:143]
    v_cvt_pk_bf16_f32 v219, |v198|, |v199|
    v_mul_f32_dpp v224, v48, v16 row_newbcast:1 row_mask:0xf bank_mask:0xf
    v_mfma_f32_16x16x32_bf16 v[204:207], a[120:123], v[152:155], v[204:207]
    v_cvt_pk_bf16_f32 v220, |v200|, |v201|
    v_cvt_pk_bf16_f32 v221, |v202|, |v203|
    v_mfma_f32_16x16x32_bf16 v[204:207], a[116:119], v[148:151], v[204:207]
    v_mul_f32_dpp v225, v49, v17 row_newbcast:1 row_mask:0xf bank_mask:0xf
    v_mul_f32_dpp v226, v50, v18 row_newbcast:1 row_mask:0xf bank_mask:0xf
    v_mfma_f32_16x16x32_bf16 v[204:207], a[112:115], v[144:147], v[204:207]
    v_mul_f32_dpp v227, v51, v19 row_newbcast:1 row_mask:0xf bank_mask:0xf
    v_mul_f32_dpp v228, v52, v20 row_newbcast:1 row_mask:0xf bank_mask:0xf
    v_mfma_f32_16x16x32_bf16 v[176:179], a[0:3], v[160:163], v[112:115]
    v_mul_f32_dpp v229, v53, v21 row_newbcast:1 row_mask:0xf bank_mask:0xf
    v_mul_f32_dpp v230, v54, v22 row_newbcast:1 row_mask:0xf bank_mask:0xf
    v_mfma_f32_16x16x32_bf16 v[176:179], a[4:7], v[164:167], v[176:179]
    v_mul_f32_dpp v231, v55, v23 row_newbcast:1 row_mask:0xf bank_mask:0xf
    v_cvt_pk_bf16_f32 v144, v224, v225
    v_mfma_f32_16x16x32_bf16 v[176:179], a[8:11], v[168:171], v[176:179]
    v_cvt_pk_bf16_f32 v222, |v204|, |v205|
    v_cvt_pk_bf16_f32 v223, |v206|, |v207|
    v_mfma_f32_16x16x32_bf16 v[176:179], a[12:15], v[172:175], v[176:179]
    v_cvt_pk_bf16_f32 v145, v226, v227
    v_cvt_pk_bf16_f32 v146, v228, v229
    v_smfmac_f32_16x16x64_bf16 v[244:247], a[132:135], v[216:223], v1
    v_cvt_pk_bf16_f32 v147, v230, v231
    v_mfma_f32_16x16x32_bf16 v[180:183], a[28:31], v[172:175], v[116:119]
    v_mul_f32_dpp v224, v56, v24 row_newbcast:1 row_mask:0xf bank_mask:0xf
    v_mul_f32_dpp v225, v57, v25 row_newbcast:1 row_mask:0xf bank_mask:0xf
    v_mfma_f32_16x16x32_bf16 v[180:183], a[24:27], v[168:171], v[180:183]
    v_mul_f32_dpp v226, v58, v26 row_newbcast:1 row_mask:0xf bank_mask:0xf
    v_mul_f32_dpp v227, v59, v27 row_newbcast:1 row_mask:0xf bank_mask:0xf
    v_mfma_f32_16x16x32_bf16 v[180:183], a[20:23], v[164:167], v[180:183]
    v_mul_f32_dpp v228, v60, v28 row_newbcast:1 row_mask:0xf bank_mask:0xf
    v_mul_f32_dpp v229, v61, v29 row_newbcast:1 row_mask:0xf bank_mask:0xf
    v_mfma_f32_16x16x32_bf16 v[180:183], a[16:19], v[160:163], v[180:183]
    v_mul_f32_dpp v230, v62, v30 row_newbcast:1 row_mask:0xf bank_mask:0xf
    v_mul_f32_dpp v231, v63, v31 row_newbcast:1 row_mask:0xf bank_mask:0xf
    v_smfmac_f32_16x16x64_bf16 v[244:247], a[152:155], v[160:167], v1
    v_cvt_pk_bf16_f32 v208, |v176|, |v177|
    v_mfma_f32_16x16x32_bf16 v[184:187], a[32:35], v[160:163], v[120:123]
    v_cvt_pk_bf16_f32 v209, |v178|, |v179|
    v_cvt_pk_bf16_f32 v148, v224, v225
    v_mfma_f32_16x16x32_bf16 v[184:187], a[36:39], v[164:167], v[184:187]
    v_cvt_pk_bf16_f32 v149, v226, v227
    v_cvt_pk_bf16_f32 v150, v228, v229
    v_mfma_f32_16x16x32_bf16 v[184:187], a[40:43], v[168:171], v[184:187]
    v_cvt_pk_bf16_f32 v151, v230, v231
    v_mul_f32_dpp v224, v64, v32 row_newbcast:1 row_mask:0xf bank_mask:0xf
    v_mfma_f32_16x16x32_bf16 v[184:187], a[44:47], v[172:175], v[184:187]
    v_mul_f32_dpp v225, v65, v33 row_newbcast:1 row_mask:0xf bank_mask:0xf
    v_mul_f32_dpp v226, v66, v34 row_newbcast:1 row_mask:0xf bank_mask:0xf
    v_smfmac_f32_16x16x64_bf16 v[244:247], a[156:159], v[168:175], v1
    v_mul_f32_dpp v227, v67, v35 row_newbcast:1 row_mask:0xf bank_mask:0xf
    v_mfma_f32_16x16x32_bf16 v[188:191], a[60:63], v[172:175], v[124:127]
    v_mul_f32_dpp v228, v68, v36 row_newbcast:1 row_mask:0xf bank_mask:0xf
    v_mul_f32_dpp v229, v69, v37 row_newbcast:1 row_mask:0xf bank_mask:0xf
    v_mfma_f32_16x16x32_bf16 v[188:191], a[56:59], v[168:171], v[188:191]
    v_mul_f32_dpp v230, v70, v38 row_newbcast:1 row_mask:0xf bank_mask:0xf
    v_mul_f32_dpp v231, v71, v39 row_newbcast:1 row_mask:0xf bank_mask:0xf
    v_mfma_f32_16x16x32_bf16 v[188:191], a[52:55], v[164:167], v[188:191]
    v_cvt_pk_bf16_f32 v152, v224, v225
    v_cvt_pk_bf16_f32 v153, v226, v227
    v_mfma_f32_16x16x32_bf16 v[188:191], a[48:51], v[160:163], v[188:191]
    v_cvt_pk_bf16_f32 v154, v228, v229
    v_cvt_pk_bf16_f32 v155, v230, v231
    v_mfma_f32_16x16x32_bf16 v[192:195], a[64:67], v[160:163], v[128:131]
    v_mul_f32_dpp v224, v72, v40 row_newbcast:1 row_mask:0xf bank_mask:0xf
    v_mul_f32_dpp v225, v73, v41 row_newbcast:1 row_mask:0xf bank_mask:0xf
    v_mfma_f32_16x16x32_bf16 v[192:195], a[68:71], v[164:167], v[192:195]
    v_mul_f32_dpp v226, v74, v42 row_newbcast:1 row_mask:0xf bank_mask:0xf
    v_mul_f32_dpp v227, v75, v43 row_newbcast:1 row_mask:0xf bank_mask:0xf
    v_mfma_f32_16x16x32_bf16 v[192:195], a[72:75], v[168:171], v[192:195]
    v_mul_f32_dpp v228, v76, v44 row_newbcast:1 row_mask:0xf bank_mask:0xf
    v_mul_f32_dpp v229, v77, v45 row_newbcast:1 row_mask:0xf bank_mask:0xf
    v_mfma_f32_16x16x32_bf16 v[192:195], a[76:79], v[172:175], v[192:195]
    v_mul_f32_dpp v230, v78, v46 row_newbcast:1 row_mask:0xf bank_mask:0xf
    v_mul_f32_dpp v231, v79, v47 row_newbcast:1 row_mask:0xf bank_mask:0xf
    v_mfma_f32_16x16x32_bf16 v[196:199], a[92:95], v[172:175], v[132:135]
    v_cvt_pk_bf16_f32 v156, v224, v225
    v_cvt_pk_bf16_f32 v157, v226, v227
    v_mfma_f32_16x16x32_bf16 v[196:199], a[88:91], v[168:171], v[196:199]
    v_cvt_pk_bf16_f32 v158, v228, v229
    v_cvt_pk_bf16_f32 v159, v230, v231
    v_mfma_f32_16x16x32_bf16 v[196:199], a[84:87], v[164:167], v[196:199]
    v_cvt_pk_bf16_f32 v210, |v180|, |v181|
    v_cvt_pk_bf16_f32 v211, |v182|, |v183|
    v_mfma_f32_16x16x32_bf16 v[196:199], a[80:83], v[160:163], v[196:199]
    v_cvt_pk_bf16_f32 v212, |v184|, |v185|
    v_cvt_pk_bf16_f32 v213, |v186|, |v187|
    v_mfma_f32_16x16x32_bf16 v[200:203], a[96:99], v[160:163], v[136:139]
    v_cvt_pk_bf16_f32 v214, |v188|, |v189|
    v_cvt_pk_bf16_f32 v215, |v190|, |v191|
    v_mfma_f32_16x16x32_bf16 v[200:203], a[100:103], v[164:167], v[200:203]
    v_cvt_pk_bf16_f32 v216, |v192|, |v193|
    v_cvt_pk_bf16_f32 v217, |v194|, |v195|
    v_mfma_f32_16x16x32_bf16 v[200:203], a[104:107], v[168:171], v[200:203]
    v_cvt_pk_bf16_f32 v218, |v196|, |v197|
    v_cvt_pk_bf16_f32 v219, |v198|, |v199|
    v_mfma_f32_16x16x32_bf16 v[200:203], a[108:111], v[172:175], v[200:203]
    v_mul_f32_dpp v224, v48, v16 row_newbcast:6 row_mask:0xf bank_mask:0xf
    v_mul_f32_dpp v225, v49, v17 row_newbcast:6 row_mask:0xf bank_mask:0xf
    v_smfmac_f32_16x16x64_bf16 v[244:247], a[144:147], v[208:215], v1
    v_mul_f32_dpp v226, v50, v18 row_newbcast:6 row_mask:0xf bank_mask:0xf
    v_mfma_f32_16x16x32_bf16 v[204:207], a[124:127], v[172:175], v[140:143]
    v_mul_f32_dpp v227, v51, v19 row_newbcast:6 row_mask:0xf bank_mask:0xf
    v_mul_f32_dpp v228, v52, v20 row_newbcast:6 row_mask:0xf bank_mask:0xf
    v_mfma_f32_16x16x32_bf16 v[204:207], a[120:123], v[168:171], v[204:207]
    v_cvt_pk_bf16_f32 v220, |v200|, |v201|
    v_cvt_pk_bf16_f32 v221, |v202|, |v203|
    v_mfma_f32_16x16x32_bf16 v[204:207], a[116:119], v[164:167], v[204:207]
    v_mul_f32_dpp v229, v53, v21 row_newbcast:6 row_mask:0xf bank_mask:0xf
    v_mul_f32_dpp v230, v54, v22 row_newbcast:6 row_mask:0xf bank_mask:0xf
    v_mfma_f32_16x16x32_bf16 v[204:207], a[112:115], v[160:163], v[204:207]
    v_mul_f32_dpp v231, v55, v23 row_newbcast:6 row_mask:0xf bank_mask:0xf
    v_cvt_pk_bf16_f32 v160, v224, v225
    v_mfma_f32_16x16x32_bf16 v[176:179], a[0:3], v[144:147], v[112:115]
    v_cvt_pk_bf16_f32 v161, v226, v227
    v_cvt_pk_bf16_f32 v162, v228, v229
    v_mfma_f32_16x16x32_bf16 v[176:179], a[4:7], v[148:151], v[176:179]
    v_cvt_pk_bf16_f32 v163, v230, v231
    v_mul_f32_dpp v224, v56, v24 row_newbcast:6 row_mask:0xf bank_mask:0xf
    v_mfma_f32_16x16x32_bf16 v[176:179], a[8:11], v[152:155], v[176:179]
    v_cvt_pk_bf16_f32 v222, |v204|, |v205|
    v_cvt_pk_bf16_f32 v223, |v206|, |v207|
    v_mfma_f32_16x16x32_bf16 v[176:179], a[12:15], v[156:159], v[176:179]
    v_mul_f32_dpp v225, v57, v25 row_newbcast:6 row_mask:0xf bank_mask:0xf
    v_mul_f32_dpp v226, v58, v26 row_newbcast:6 row_mask:0xf bank_mask:0xf
    v_smfmac_f32_16x16x64_bf16 v[244:247], a[148:151], v[216:223], v1
    v_mul_f32_dpp v227, v59, v27 row_newbcast:6 row_mask:0xf bank_mask:0xf
    v_mfma_f32_16x16x32_bf16 v[180:183], a[28:31], v[156:159], v[116:119]
    v_mul_f32_dpp v228, v60, v28 row_newbcast:6 row_mask:0xf bank_mask:0xf
    v_mul_f32_dpp v229, v61, v29 row_newbcast:6 row_mask:0xf bank_mask:0xf
    v_mfma_f32_16x16x32_bf16 v[180:183], a[24:27], v[152:155], v[180:183]
    v_mul_f32_dpp v230, v62, v30 row_newbcast:6 row_mask:0xf bank_mask:0xf
    v_mul_f32_dpp v231, v63, v31 row_newbcast:6 row_mask:0xf bank_mask:0xf
    v_mfma_f32_16x16x32_bf16 v[180:183], a[20:23], v[148:151], v[180:183]
    v_cvt_pk_bf16_f32 v208, |v176|, |v177|
    v_cvt_pk_bf16_f32 v209, |v178|, |v179|
    v_mfma_f32_16x16x32_bf16 v[180:183], a[16:19], v[144:147], v[180:183]
    v_cvt_pk_bf16_f32 v164, v224, v225
    v_cvt_pk_bf16_f32 v165, v226, v227
    v_smfmac_f32_16x16x64_bf16 v[244:247], a[168:171], v[144:151], v1
    v_cvt_pk_bf16_f32 v166, v228, v229
    v_mfma_f32_16x16x32_bf16 v[184:187], a[32:35], v[144:147], v[120:123]
    v_cvt_pk_bf16_f32 v167, v230, v231
    v_mul_f32_dpp v224, v64, v32 row_newbcast:6 row_mask:0xf bank_mask:0xf
    v_mfma_f32_16x16x32_bf16 v[184:187], a[36:39], v[148:151], v[184:187]
    v_mul_f32_dpp v225, v65, v33 row_newbcast:6 row_mask:0xf bank_mask:0xf
    v_mul_f32_dpp v226, v66, v34 row_newbcast:6 row_mask:0xf bank_mask:0xf
    v_mfma_f32_16x16x32_bf16 v[184:187], a[40:43], v[152:155], v[184:187]
    v_mul_f32_dpp v227, v67, v35 row_newbcast:6 row_mask:0xf bank_mask:0xf
    v_mul_f32_dpp v228, v68, v36 row_newbcast:6 row_mask:0xf bank_mask:0xf
    v_mfma_f32_16x16x32_bf16 v[184:187], a[44:47], v[156:159], v[184:187]
    v_mul_f32_dpp v229, v69, v37 row_newbcast:6 row_mask:0xf bank_mask:0xf
    v_mul_f32_dpp v230, v70, v38 row_newbcast:6 row_mask:0xf bank_mask:0xf
    v_smfmac_f32_16x16x64_bf16 v[244:247], a[172:175], v[152:159], v1
    v_mul_f32_dpp v231, v71, v39 row_newbcast:6 row_mask:0xf bank_mask:0xf
    v_mfma_f32_16x16x32_bf16 v[188:191], a[60:63], v[156:159], v[124:127]
    v_cvt_pk_bf16_f32 v168, v224, v225
    v_cvt_pk_bf16_f32 v169, v226, v227
    v_mfma_f32_16x16x32_bf16 v[188:191], a[56:59], v[152:155], v[188:191]
    v_cvt_pk_bf16_f32 v170, v228, v229
    v_cvt_pk_bf16_f32 v171, v230, v231
    v_mfma_f32_16x16x32_bf16 v[188:191], a[52:55], v[148:151], v[188:191]
    v_mul_f32_dpp v224, v72, v40 row_newbcast:6 row_mask:0xf bank_mask:0xf
    v_mul_f32_dpp v225, v73, v41 row_newbcast:6 row_mask:0xf bank_mask:0xf
    v_mfma_f32_16x16x32_bf16 v[188:191], a[48:51], v[144:147], v[188:191]
    v_mul_f32_dpp v226, v74, v42 row_newbcast:6 row_mask:0xf bank_mask:0xf
    v_mul_f32_dpp v227, v75, v43 row_newbcast:6 row_mask:0xf bank_mask:0xf
    v_mfma_f32_16x16x32_bf16 v[192:195], a[64:67], v[144:147], v[128:131]
    v_mul_f32_dpp v228, v76, v44 row_newbcast:6 row_mask:0xf bank_mask:0xf
    v_mul_f32_dpp v229, v77, v45 row_newbcast:6 row_mask:0xf bank_mask:0xf
    v_mfma_f32_16x16x32_bf16 v[192:195], a[68:71], v[148:151], v[192:195]
    v_mul_f32_dpp v230, v78, v46 row_newbcast:6 row_mask:0xf bank_mask:0xf
    v_mul_f32_dpp v231, v79, v47 row_newbcast:6 row_mask:0xf bank_mask:0xf
    v_mfma_f32_16x16x32_bf16 v[192:195], a[72:75], v[152:155], v[192:195]
    v_cvt_pk_bf16_f32 v172, v224, v225
    v_cvt_pk_bf16_f32 v173, v226, v227
    v_mfma_f32_16x16x32_bf16 v[192:195], a[76:79], v[156:159], v[192:195]
    v_cvt_pk_bf16_f32 v174, v228, v229
    v_cvt_pk_bf16_f32 v175, v230, v231
    v_mfma_f32_16x16x32_bf16 v[196:199], a[92:95], v[156:159], v[132:135]
    v_cvt_pk_bf16_f32 v210, |v180|, |v181|
    v_cvt_pk_bf16_f32 v211, |v182|, |v183|
    v_mfma_f32_16x16x32_bf16 v[196:199], a[88:91], v[152:155], v[196:199]
    v_cvt_pk_bf16_f32 v212, |v184|, |v185|
    v_cvt_pk_bf16_f32 v213, |v186|, |v187|
    v_mfma_f32_16x16x32_bf16 v[196:199], a[84:87], v[148:151], v[196:199]
    v_cvt_pk_bf16_f32 v214, |v188|, |v189|
    v_cvt_pk_bf16_f32 v215, |v190|, |v191|
    v_mfma_f32_16x16x32_bf16 v[196:199], a[80:83], v[144:147], v[196:199]
    v_cvt_pk_bf16_f32 v216, |v192|, |v193|
    v_cvt_pk_bf16_f32 v217, |v194|, |v195|
    v_smfmac_f32_16x16x64_bf16 v[244:247], a[160:163], v[208:215], v1
    v_mul_f32_dpp v224, v48, v16 row_newbcast:4 row_mask:0xf bank_mask:0xf
    v_mfma_f32_16x16x32_bf16 v[200:203], a[96:99], v[144:147], v[136:139]
    v_mul_f32_dpp v225, v49, v17 row_newbcast:4 row_mask:0xf bank_mask:0xf
    v_mul_f32_dpp v226, v50, v18 row_newbcast:4 row_mask:0xf bank_mask:0xf
    v_mfma_f32_16x16x32_bf16 v[200:203], a[100:103], v[148:151], v[200:203]
    v_cvt_pk_bf16_f32 v218, |v196|, |v197|
    v_cvt_pk_bf16_f32 v219, |v198|, |v199|
    v_mfma_f32_16x16x32_bf16 v[200:203], a[104:107], v[152:155], v[200:203]
    v_mul_f32_dpp v227, v51, v19 row_newbcast:4 row_mask:0xf bank_mask:0xf
    v_mul_f32_dpp v228, v52, v20 row_newbcast:4 row_mask:0xf bank_mask:0xf
    v_mfma_f32_16x16x32_bf16 v[200:203], a[108:111], v[156:159], v[200:203]
    v_mul_f32_dpp v229, v53, v21 row_newbcast:4 row_mask:0xf bank_mask:0xf
    v_mul_f32_dpp v230, v54, v22 row_newbcast:4 row_mask:0xf bank_mask:0xf
    v_mfma_f32_16x16x32_bf16 v[204:207], a[124:127], v[156:159], v[140:143]
    v_mul_f32_dpp v231, v55, v23 row_newbcast:4 row_mask:0xf bank_mask:0xf
    v_lshlrev_b32 v80, 16, v96
    v_mfma_f32_16x16x32_bf16 v[204:207], a[120:123], v[152:155], v[204:207]
    v_and_b32 v81, 0xffff0000, v96
    v_lshlrev_b32 v82, 16, v97
    v_mfma_f32_16x16x32_bf16 v[204:207], a[116:119], v[148:151], v[204:207]
    v_cvt_pk_bf16_f32 v220, |v200|, |v201|
    v_cvt_pk_bf16_f32 v221, |v202|, |v203|
    v_mfma_f32_16x16x32_bf16 v[204:207], a[112:115], v[144:147], v[204:207]
    v_cvt_pk_bf16_f32 v144, v224, v225
    v_cvt_pk_bf16_f32 v145, v226, v227
    v_mfma_f32_16x16x32_bf16 v[176:179], a[0:3], v[160:163], v[112:115]
    v_cvt_pk_bf16_f32 v146, v228, v229
    v_cvt_pk_bf16_f32 v147, v230, v231
    v_mfma_f32_16x16x32_bf16 v[176:179], a[4:7], v[164:167], v[176:179]
    v_mul_f32_dpp v224, v56, v24 row_newbcast:4 row_mask:0xf bank_mask:0xf
    v_mul_f32_dpp v225, v57, v25 row_newbcast:4 row_mask:0xf bank_mask:0xf
    v_mfma_f32_16x16x32_bf16 v[176:179], a[8:11], v[168:171], v[176:179]
    v_cvt_pk_bf16_f32 v222, |v204|, |v205|
    v_cvt_pk_bf16_f32 v223, |v206|, |v207|
    v_mfma_f32_16x16x32_bf16 v[176:179], a[12:15], v[172:175], v[176:179]
    v_mul_f32_dpp v226, v58, v26 row_newbcast:4 row_mask:0xf bank_mask:0xf
    v_mul_f32_dpp v227, v59, v27 row_newbcast:4 row_mask:0xf bank_mask:0xf
    v_smfmac_f32_16x16x64_bf16 v[244:247], a[164:167], v[216:223], v1
    v_mul_f32_dpp v228, v60, v28 row_newbcast:4 row_mask:0xf bank_mask:0xf
    v_mfma_f32_16x16x32_bf16 v[180:183], a[28:31], v[172:175], v[116:119]
    v_mul_f32_dpp v229, v61, v29 row_newbcast:4 row_mask:0xf bank_mask:0xf
    v_mul_f32_dpp v230, v62, v30 row_newbcast:4 row_mask:0xf bank_mask:0xf
    v_mfma_f32_16x16x32_bf16 v[180:183], a[24:27], v[168:171], v[180:183]
    v_mul_f32_dpp v231, v63, v31 row_newbcast:4 row_mask:0xf bank_mask:0xf
    v_cvt_pk_bf16_f32 v208, |v176|, |v177|
    v_mfma_f32_16x16x32_bf16 v[180:183], a[20:23], v[164:167], v[180:183]
    v_cvt_pk_bf16_f32 v209, |v178|, |v179|
    v_cvt_pk_bf16_f32 v148, v224, v225
    v_mfma_f32_16x16x32_bf16 v[180:183], a[16:19], v[160:163], v[180:183]
    v_cvt_pk_bf16_f32 v149, v226, v227
    v_cvt_pk_bf16_f32 v150, v228, v229
    v_smfmac_f32_16x16x64_bf16 v[244:247], a[184:187], v[160:167], v1
    v_cvt_pk_bf16_f32 v151, v230, v231
    v_mfma_f32_16x16x32_bf16 v[184:187], a[32:35], v[160:163], v[120:123]
    v_mul_f32_dpp v224, v64, v32 row_newbcast:4 row_mask:0xf bank_mask:0xf
    v_mul_f32_dpp v225, v65, v33 row_newbcast:4 row_mask:0xf bank_mask:0xf
    v_mfma_f32_16x16x32_bf16 v[184:187], a[36:39], v[164:167], v[184:187]
    v_mul_f32_dpp v226, v66, v34 row_newbcast:4 row_mask:0xf bank_mask:0xf
    v_mul_f32_dpp v227, v67, v35 row_newbcast:4 row_mask:0xf bank_mask:0xf
    v_mfma_f32_16x16x32_bf16 v[184:187], a[40:43], v[168:171], v[184:187]
    v_mul_f32_dpp v228, v68, v36 row_newbcast:4 row_mask:0xf bank_mask:0xf
    v_mul_f32_dpp v229, v69, v37 row_newbcast:4 row_mask:0xf bank_mask:0xf
    v_mfma_f32_16x16x32_bf16 v[184:187], a[44:47], v[172:175], v[184:187]
    v_mul_f32_dpp v230, v70, v38 row_newbcast:4 row_mask:0xf bank_mask:0xf
    v_mul_f32_dpp v231, v71, v39 row_newbcast:4 row_mask:0xf bank_mask:0xf
    v_smfmac_f32_16x16x64_bf16 v[244:247], a[188:191], v[168:175], v1
    v_cvt_pk_bf16_f32 v152, v224, v225
    v_mfma_f32_16x16x32_bf16 v[188:191], a[60:63], v[172:175], v[124:127]
    v_cvt_pk_bf16_f32 v153, v226, v227
    v_cvt_pk_bf16_f32 v154, v228, v229
    v_mfma_f32_16x16x32_bf16 v[188:191], a[56:59], v[168:171], v[188:191]
    v_cvt_pk_bf16_f32 v155, v230, v231
    v_mul_f32_dpp v224, v72, v40 row_newbcast:4 row_mask:0xf bank_mask:0xf
    v_mfma_f32_16x16x32_bf16 v[188:191], a[52:55], v[164:167], v[188:191]
    v_mul_f32_dpp v225, v73, v41 row_newbcast:4 row_mask:0xf bank_mask:0xf
    v_mul_f32_dpp v226, v74, v42 row_newbcast:4 row_mask:0xf bank_mask:0xf
    v_mfma_f32_16x16x32_bf16 v[188:191], a[48:51], v[160:163], v[188:191]
    v_mul_f32_dpp v227, v75, v43 row_newbcast:4 row_mask:0xf bank_mask:0xf
    v_mul_f32_dpp v228, v76, v44 row_newbcast:4 row_mask:0xf bank_mask:0xf
    v_smfmac_f32_16x16x64_bf16 v[248:251], a[136:139], v[144:151], v1
    v_mul_f32_dpp v229, v77, v45 row_newbcast:4 row_mask:0xf bank_mask:0xf
    v_mfma_f32_16x16x32_bf16 v[192:195], a[64:67], v[160:163], v[128:131]
    v_mul_f32_dpp v230, v78, v46 row_newbcast:4 row_mask:0xf bank_mask:0xf
    v_mul_f32_dpp v231, v79, v47 row_newbcast:4 row_mask:0xf bank_mask:0xf
    v_mfma_f32_16x16x32_bf16 v[192:195], a[68:71], v[164:167], v[192:195]
    v_cvt_pk_bf16_f32 v156, v224, v225
    v_cvt_pk_bf16_f32 v157, v226, v227
    v_mfma_f32_16x16x32_bf16 v[192:195], a[72:75], v[168:171], v[192:195]
    v_cvt_pk_bf16_f32 v158, v228, v229
    v_cvt_pk_bf16_f32 v159, v230, v231
    v_mfma_f32_16x16x32_bf16 v[192:195], a[76:79], v[172:175], v[192:195]
    v_cvt_pk_bf16_f32 v210, |v180|, |v181|
    v_cvt_pk_bf16_f32 v211, |v182|, |v183|
    v_smfmac_f32_16x16x64_bf16 v[248:251], a[140:143], v[152:159], v1
    v_cvt_pk_bf16_f32 v212, |v184|, |v185|
    v_mfma_f32_16x16x32_bf16 v[196:199], a[92:95], v[172:175], v[132:135]
    v_cvt_pk_bf16_f32 v213, |v186|, |v187|
    v_cvt_pk_bf16_f32 v214, |v188|, |v189|
    v_mfma_f32_16x16x32_bf16 v[196:199], a[88:91], v[168:171], v[196:199]
    v_cvt_pk_bf16_f32 v215, |v190|, |v191|
    v_cvt_pk_bf16_f32 v216, |v192|, |v193|
    v_mfma_f32_16x16x32_bf16 v[196:199], a[84:87], v[164:167], v[196:199]
    v_cvt_pk_bf16_f32 v217, |v194|, |v195|
    v_and_b32 v83, 0xffff0000, v97
    v_mfma_f32_16x16x32_bf16 v[196:199], a[80:83], v[160:163], v[196:199]
    v_lshlrev_b32 v84, 16, v98
    v_and_b32 v85, 0xffff0000, v98
    v_smfmac_f32_16x16x64_bf16 v[244:247], a[176:179], v[208:215], v1
    v_lshlrev_b32 v86, 16, v99
    v_mfma_f32_16x16x32_bf16 v[200:203], a[96:99], v[160:163], v[136:139]
    v_and_b32 v87, 0xffff0000, v99
    v_lshlrev_b32 v88, 16, v100
    v_mfma_f32_16x16x32_bf16 v[200:203], a[100:103], v[164:167], v[200:203]
    v_cvt_pk_bf16_f32 v218, |v196|, |v197|
    v_cvt_pk_bf16_f32 v219, |v198|, |v199|
    v_mfma_f32_16x16x32_bf16 v[200:203], a[104:107], v[168:171], v[200:203]
    v_and_b32 v89, 0xffff0000, v100
    v_lshlrev_b32 v90, 16, v101
    v_mfma_f32_16x16x32_bf16 v[200:203], a[108:111], v[172:175], v[200:203]
    v_and_b32 v91, 0xffff0000, v101
    v_lshlrev_b32 v92, 16, v102
    v_mfma_f32_16x16x32_bf16 v[204:207], a[124:127], v[172:175], v[140:143]
    v_and_b32 v93, 0xffff0000, v102
    v_lshlrev_b32 v94, 16, v103
    v_mfma_f32_16x16x32_bf16 v[204:207], a[120:123], v[168:171], v[204:207]
    v_and_b32 v95, 0xffff0000, v103
    v_mul_f32_dpp v224, v80, v48 row_ror:13 row_mask:0xf bank_mask:0xf
    v_mfma_f32_16x16x32_bf16 v[204:207], a[116:119], v[164:167], v[204:207]
    v_cvt_pk_bf16_f32 v220, |v200|, |v201|
    v_cvt_pk_bf16_f32 v221, |v202|, |v203|
    v_mfma_f32_16x16x32_bf16 v[204:207], a[112:115], v[160:163], v[204:207]
    v_mul_f32_dpp v225, v81, v49 row_ror:13 row_mask:0xf bank_mask:0xf
    v_mul_f32_dpp v226, v82, v50 row_ror:13 row_mask:0xf bank_mask:0xf
    v_mfma_f32_16x16x32_bf16 v[176:179], a[0:3], v[144:147], v[112:115]
    v_mul_f32_dpp v227, v83, v51 row_ror:13 row_mask:0xf bank_mask:0xf
    v_mul_f32_dpp v228, v84, v52 row_ror:13 row_mask:0xf bank_mask:0xf
    v_mfma_f32_16x16x32_bf16 v[176:179], a[4:7], v[148:151], v[176:179]
    v_mul_f32_dpp v229, v85, v53 row_ror:13 row_mask:0xf bank_mask:0xf
    v_mul_f32_dpp v230, v86, v54 row_ror:13 row_mask:0xf bank_mask:0xf
    v_mfma_f32_16x16x32_bf16 v[176:179], a[8:11], v[152:155], v[176:179]
    v_cvt_pk_bf16_f32 v222, |v204|, |v205|
    v_cvt_pk_bf16_f32 v223, |v206|, |v207|
    v_mfma_f32_16x16x32_bf16 v[176:179], a[12:15], v[156:159], v[176:179]
    v_mul_f32_dpp v231, v87, v55 row_ror:13 row_mask:0xf bank_mask:0xf
    v_lshlrev_b32 v96, 16, v104
    v_smfmac_f32_16x16x64_bf16 v[244:247], a[180:183], v[216:223], v1
    v_and_b32 v97, 0xffff0000, v104
    v_mfma_f32_16x16x32_bf16 v[180:183], a[28:31], v[156:159], v[116:119]
    v_lshlrev_b32 v98, 16, v105
    v_and_b32 v99, 0xffff0000, v105
    v_mfma_f32_16x16x32_bf16 v[180:183], a[24:27], v[152:155], v[180:183]
    v_lshlrev_b32 v100, 16, v106
    v_and_b32 v101, 0xffff0000, v106
    v_mfma_f32_16x16x32_bf16 v[180:183], a[20:23], v[148:151], v[180:183]
    v_lshlrev_b32 v102, 16, v107
    v_and_b32 v103, 0xffff0000, v107
    v_mfma_f32_16x16x32_bf16 v[180:183], a[16:19], v[144:147], v[180:183]
    v_cvt_pk_bf16_f32 v160, v224, v225
    v_cvt_pk_bf16_f32 v161, v226, v227
    v_mfma_f32_16x16x32_bf16 v[184:187], a[32:35], v[144:147], v[120:123]
    v_cvt_pk_bf16_f32 v162, v228, v229
    v_cvt_pk_bf16_f32 v163, v230, v231
    v_mfma_f32_16x16x32_bf16 v[184:187], a[36:39], v[148:151], v[184:187]
    v_lshlrev_b32 v104, 16, v108
    v_and_b32 v105, 0xffff0000, v108
    v_mfma_f32_16x16x32_bf16 v[184:187], a[40:43], v[152:155], v[184:187]
    v_lshlrev_b32 v106, 16, v109
    v_and_b32 v107, 0xffff0000, v109
    v_mfma_f32_16x16x32_bf16 v[184:187], a[44:47], v[156:159], v[184:187]
    v_lshlrev_b32 v108, 16, v110
    v_and_b32 v109, 0xffff0000, v110
    v_mfma_f32_16x16x32_bf16 v[188:191], a[60:63], v[156:159], v[124:127]
    v_mul_f32_dpp v224, v88, v56 row_ror:13 row_mask:0xf bank_mask:0xf
    v_mul_f32_dpp v225, v89, v57 row_ror:13 row_mask:0xf bank_mask:0xf
    v_mfma_f32_16x16x32_bf16 v[188:191], a[56:59], v[152:155], v[188:191]
    v_mul_f32_dpp v226, v90, v58 row_ror:13 row_mask:0xf bank_mask:0xf
    v_mul_f32_dpp v227, v91, v59 row_ror:13 row_mask:0xf bank_mask:0xf
    v_mfma_f32_16x16x32_bf16 v[188:191], a[52:55], v[148:151], v[188:191]
    v_mul_f32_dpp v228, v92, v60 row_ror:13 row_mask:0xf bank_mask:0xf
    v_mul_f32_dpp v229, v93, v61 row_ror:13 row_mask:0xf bank_mask:0xf
    v_mfma_f32_16x16x32_bf16 v[188:191], a[48:51], v[144:147], v[188:191]
    v_mul_f32_dpp v230, v94, v62 row_ror:13 row_mask:0xf bank_mask:0xf
    v_mul_f32_dpp v231, v95, v63 row_ror:13 row_mask:0xf bank_mask:0xf
    v_mfma_f32_16x16x32_bf16 v[192:195], a[64:67], v[144:147], v[128:131]
    v_cvt_pk_bf16_f32 v208, |v176|, |v177|
    v_cvt_pk_bf16_f32 v209, |v178|, |v179|
    v_mfma_f32_16x16x32_bf16 v[192:195], a[68:71], v[148:151], v[192:195]
    v_lshlrev_b32 v110, 16, v111
    v_cvt_pk_bf16_f32 v164, v224, v225
    v_mfma_f32_16x16x32_bf16 v[192:195], a[72:75], v[152:155], v[192:195]
    v_cvt_pk_bf16_f32 v165, v226, v227
    v_cvt_pk_bf16_f32 v166, v228, v229
    v_mfma_f32_16x16x32_bf16 v[192:195], a[76:79], v[156:159], v[192:195]
    v_cvt_pk_bf16_f32 v167, v230, v231
    v_and_b32 v111, 0xffff0000, v111
    v_mfma_f32_16x16x32_bf16 v[196:199], a[92:95], v[156:159], v[132:135]
    v_mul_f32_dpp v224, v96, v64 row_ror:13 row_mask:0xf bank_mask:0xf
    v_mul_f32_dpp v225, v97, v65 row_ror:13 row_mask:0xf bank_mask:0xf
    v_mfma_f32_16x16x32_bf16 v[196:199], a[88:91], v[152:155], v[196:199]
    v_mul_f32_dpp v226, v98, v66 row_ror:13 row_mask:0xf bank_mask:0xf
    v_mul_f32_dpp v227, v99, v67 row_ror:13 row_mask:0xf bank_mask:0xf
    v_mfma_f32_16x16x32_bf16 v[196:199], a[84:87], v[148:151], v[196:199]
    v_mul_f32_dpp v228, v100, v68 row_ror:13 row_mask:0xf bank_mask:0xf
    v_mul_f32_dpp v229, v101, v69 row_ror:13 row_mask:0xf bank_mask:0xf
    v_mfma_f32_16x16x32_bf16 v[196:199], a[80:83], v[144:147], v[196:199]
    v_mul_f32_dpp v230, v102, v70 row_ror:13 row_mask:0xf bank_mask:0xf
    v_mul_f32_dpp v231, v103, v71 row_ror:13 row_mask:0xf bank_mask:0xf
    v_mfma_f32_16x16x32_bf16 v[200:203], a[96:99], v[144:147], v[136:139]
    v_cvt_pk_bf16_f32 v168, v224, v225
    v_cvt_pk_bf16_f32 v169, v226, v227
    v_mfma_f32_16x16x32_bf16 v[200:203], a[100:103], v[148:151], v[200:203]
    v_cvt_pk_bf16_f32 v170, v228, v229
    v_cvt_pk_bf16_f32 v171, v230, v231
    v_mfma_f32_16x16x32_bf16 v[200:203], a[104:107], v[152:155], v[200:203]
    v_mul_f32_dpp v224, v104, v72 row_ror:13 row_mask:0xf bank_mask:0xf
    v_mul_f32_dpp v225, v105, v73 row_ror:13 row_mask:0xf bank_mask:0xf
    v_mfma_f32_16x16x32_bf16 v[200:203], a[108:111], v[156:159], v[200:203]
    v_mul_f32_dpp v226, v106, v74 row_ror:13 row_mask:0xf bank_mask:0xf
    v_mul_f32_dpp v227, v107, v75 row_ror:13 row_mask:0xf bank_mask:0xf
    v_mfma_f32_16x16x32_bf16 v[204:207], a[124:127], v[156:159], v[140:143]
    v_mul_f32_dpp v228, v108, v76 row_ror:13 row_mask:0xf bank_mask:0xf
    v_mul_f32_dpp v229, v109, v77 row_ror:13 row_mask:0xf bank_mask:0xf
    v_mfma_f32_16x16x32_bf16 v[204:207], a[120:123], v[152:155], v[204:207]
    v_mul_f32_dpp v230, v110, v78 row_ror:13 row_mask:0xf bank_mask:0xf
    v_mul_f32_dpp v231, v111, v79 row_ror:13 row_mask:0xf bank_mask:0xf
    v_mfma_f32_16x16x32_bf16 v[204:207], a[116:119], v[148:151], v[204:207]
    v_cvt_pk_bf16_f32 v172, v224, v225
    v_cvt_pk_bf16_f32 v173, v226, v227
    v_mfma_f32_16x16x32_bf16 v[204:207], a[112:115], v[144:147], v[204:207]
    v_cvt_pk_bf16_f32 v174, v228, v229
    v_cvt_pk_bf16_f32 v175, v230, v231
    v_mfma_f32_16x16x32_bf16 v[176:179], a[0:3], v[160:163], v[112:115]
    v_cvt_pk_bf16_f32 v210, |v180|, |v181|
    v_cvt_pk_bf16_f32 v211, |v182|, |v183|
    v_mfma_f32_16x16x32_bf16 v[176:179], a[4:7], v[164:167], v[176:179]
    v_cvt_pk_bf16_f32 v212, |v184|, |v185|
    v_cvt_pk_bf16_f32 v213, |v186|, |v187|
    v_mfma_f32_16x16x32_bf16 v[176:179], a[8:11], v[168:171], v[176:179]
    v_cvt_pk_bf16_f32 v214, |v188|, |v189|
    v_cvt_pk_bf16_f32 v215, |v190|, |v191|
    v_mfma_f32_16x16x32_bf16 v[176:179], a[12:15], v[172:175], v[176:179]
    v_cvt_pk_bf16_f32 v216, |v192|, |v193|
    v_cvt_pk_bf16_f32 v217, |v194|, |v195|
    v_smfmac_f32_16x16x64_bf16 v[248:251], a[128:131], v[208:215], v1
    v_cvt_pk_bf16_f32 v218, |v196|, |v197|
    v_mfma_f32_16x16x32_bf16 v[180:183], a[28:31], v[172:175], v[116:119]
    v_cvt_pk_bf16_f32 v219, |v198|, |v199|
    v_cvt_pk_bf16_f32 v220, |v200|, |v201|
    v_mfma_f32_16x16x32_bf16 v[180:183], a[24:27], v[168:171], v[180:183]
    v_cvt_pk_bf16_f32 v221, |v202|, |v203|
    v_cvt_pk_bf16_f32 v222, |v204|, |v205|
    v_mfma_f32_16x16x32_bf16 v[180:183], a[20:23], v[164:167], v[180:183]
    v_cvt_pk_bf16_f32 v223, |v206|, |v207|
    v_mul_f32_dpp v224, v80, v48 row_ror:5 row_mask:0xf bank_mask:0xf
    v_mfma_f32_16x16x32_bf16 v[180:183], a[16:19], v[160:163], v[180:183]
    v_mul_f32_dpp v225, v81, v49 row_ror:5 row_mask:0xf bank_mask:0xf
    v_mul_f32_dpp v226, v82, v50 row_ror:5 row_mask:0xf bank_mask:0xf
    v_smfmac_f32_16x16x64_bf16 v[248:251], a[132:135], v[216:223], v1
    v_mul_f32_dpp v227, v83, v51 row_ror:5 row_mask:0xf bank_mask:0xf
    v_mfma_f32_16x16x32_bf16 v[184:187], a[32:35], v[160:163], v[120:123]
    v_mul_f32_dpp v228, v84, v52 row_ror:5 row_mask:0xf bank_mask:0xf
    v_mul_f32_dpp v229, v85, v53 row_ror:5 row_mask:0xf bank_mask:0xf
    v_mfma_f32_16x16x32_bf16 v[184:187], a[36:39], v[164:167], v[184:187]
    v_mul_f32_dpp v230, v86, v54 row_ror:5 row_mask:0xf bank_mask:0xf
    v_mul_f32_dpp v231, v87, v55 row_ror:5 row_mask:0xf bank_mask:0xf
    v_mfma_f32_16x16x32_bf16 v[184:187], a[40:43], v[168:171], v[184:187]
    v_cvt_pk_bf16_f32 v144, v224, v225
    v_cvt_pk_bf16_f32 v145, v226, v227
    v_mfma_f32_16x16x32_bf16 v[184:187], a[44:47], v[172:175], v[184:187]
    v_cvt_pk_bf16_f32 v146, v228, v229
    v_cvt_pk_bf16_f32 v147, v230, v231
    v_smfmac_f32_16x16x64_bf16 v[248:251], a[152:155], v[160:167], v1
    v_mul_f32_dpp v224, v88, v56 row_ror:5 row_mask:0xf bank_mask:0xf
    v_mfma_f32_16x16x32_bf16 v[188:191], a[60:63], v[172:175], v[124:127]
    v_mul_f32_dpp v225, v89, v57 row_ror:5 row_mask:0xf bank_mask:0xf
    v_mul_f32_dpp v226, v90, v58 row_ror:5 row_mask:0xf bank_mask:0xf
    v_mfma_f32_16x16x32_bf16 v[188:191], a[56:59], v[168:171], v[188:191]
    v_mul_f32_dpp v227, v91, v59 row_ror:5 row_mask:0xf bank_mask:0xf
    v_mul_f32_dpp v228, v92, v60 row_ror:5 row_mask:0xf bank_mask:0xf
    v_mfma_f32_16x16x32_bf16 v[188:191], a[52:55], v[164:167], v[188:191]
    v_mul_f32_dpp v229, v93, v61 row_ror:5 row_mask:0xf bank_mask:0xf
    v_mul_f32_dpp v230, v94, v62 row_ror:5 row_mask:0xf bank_mask:0xf
    v_mfma_f32_16x16x32_bf16 v[188:191], a[48:51], v[160:163], v[188:191]
    v_mul_f32_dpp v231, v95, v63 row_ror:5 row_mask:0xf bank_mask:0xf
    v_cvt_pk_bf16_f32 v208, |v176|, |v177|
    v_smfmac_f32_16x16x64_bf16 v[248:251], a[156:159], v[168:175], v1
    v_cvt_pk_bf16_f32 v209, |v178|, |v179|
    v_mfma_f32_16x16x32_bf16 v[192:195], a[64:67], v[160:163], v[128:131]
    v_cvt_pk_bf16_f32 v148, v224, v225
    v_cvt_pk_bf16_f32 v149, v226, v227
    v_mfma_f32_16x16x32_bf16 v[192:195], a[68:71], v[164:167], v[192:195]
    v_cvt_pk_bf16_f32 v150, v228, v229
    v_cvt_pk_bf16_f32 v151, v230, v231
    v_mfma_f32_16x16x32_bf16 v[192:195], a[72:75], v[168:171], v[192:195]
    v_mul_f32_dpp v224, v96, v64 row_ror:5 row_mask:0xf bank_mask:0xf
    v_mul_f32_dpp v225, v97, v65 row_ror:5 row_mask:0xf bank_mask:0xf
    v_mfma_f32_16x16x32_bf16 v[192:195], a[76:79], v[172:175], v[192:195]
    v_mul_f32_dpp v226, v98, v66 row_ror:5 row_mask:0xf bank_mask:0xf
    v_mul_f32_dpp v227, v99, v67 row_ror:5 row_mask:0xf bank_mask:0xf
    v_mfma_f32_16x16x32_bf16 v[196:199], a[92:95], v[172:175], v[132:135]
    v_mul_f32_dpp v228, v100, v68 row_ror:5 row_mask:0xf bank_mask:0xf
    v_mul_f32_dpp v229, v101, v69 row_ror:5 row_mask:0xf bank_mask:0xf
    v_mfma_f32_16x16x32_bf16 v[196:199], a[88:91], v[168:171], v[196:199]
    v_mul_f32_dpp v230, v102, v70 row_ror:5 row_mask:0xf bank_mask:0xf
    v_mul_f32_dpp v231, v103, v71 row_ror:5 row_mask:0xf bank_mask:0xf
    v_mfma_f32_16x16x32_bf16 v[196:199], a[84:87], v[164:167], v[196:199]
    v_cvt_pk_bf16_f32 v152, v224, v225
    v_cvt_pk_bf16_f32 v153, v226, v227
    v_mfma_f32_16x16x32_bf16 v[196:199], a[80:83], v[160:163], v[196:199]
    v_cvt_pk_bf16_f32 v154, v228, v229
    v_cvt_pk_bf16_f32 v155, v230, v231
    v_mfma_f32_16x16x32_bf16 v[200:203], a[96:99], v[160:163], v[136:139]
    v_mul_f32_dpp v224, v104, v72 row_ror:5 row_mask:0xf bank_mask:0xf
    v_mul_f32_dpp v225, v105, v73 row_ror:5 row_mask:0xf bank_mask:0xf
    v_mfma_f32_16x16x32_bf16 v[200:203], a[100:103], v[164:167], v[200:203]
    v_mul_f32_dpp v226, v106, v74 row_ror:5 row_mask:0xf bank_mask:0xf
    v_mul_f32_dpp v227, v107, v75 row_ror:5 row_mask:0xf bank_mask:0xf
    v_mfma_f32_16x16x32_bf16 v[200:203], a[104:107], v[168:171], v[200:203]
L_stub3:
    s_cbranch_scc1 L_main2
    v_mul_f32_dpp v228, v108, v76 row_ror:5 row_mask:0xf bank_mask:0xf
    v_mul_f32_dpp v229, v109, v77 row_ror:5 row_mask:0xf bank_mask:0xf
    v_mfma_f32_16x16x32_bf16 v[200:203], a[108:111], v[172:175], v[200:203]
    v_mul_f32_dpp v230, v110, v78 row_ror:5 row_mask:0xf bank_mask:0xf
    v_mul_f32_dpp v231, v111, v79 row_ror:5 row_mask:0xf bank_mask:0xf
    v_mfma_f32_16x16x32_bf16 v[204:207], a[124:127], v[172:175], v[140:143]
    v_cvt_pk_bf16_f32 v156, v224, v225
    v_cvt_pk_bf16_f32 v157, v226, v227
    v_mfma_f32_16x16x32_bf16 v[204:207], a[120:123], v[168:171], v[204:207]
    v_cvt_pk_bf16_f32 v158, v228, v229
    v_cvt_pk_bf16_f32 v159, v230, v231
    v_mfma_f32_16x16x32_bf16 v[204:207], a[116:119], v[164:167], v[204:207]
    v_cvt_pk_bf16_f32 v210, |v180|, |v181|
    v_cvt_pk_bf16_f32 v211, |v182|, |v183|
    v_mfma_f32_16x16x32_bf16 v[204:207], a[112:115], v[160:163], v[204:207]
    v_cvt_pk_bf16_f32 v212, |v184|, |v185|
    v_cvt_pk_bf16_f32 v213, |v186|, |v187|
    v_mfma_f32_16x16x32_bf16 v[176:179], a[0:3], v[144:147], v[112:115]
    v_cvt_pk_bf16_f32 v214, |v188|, |v189|
    v_cvt_pk_bf16_f32 v215, |v190|, |v191|
    v_mfma_f32_16x16x32_bf16 v[176:179], a[4:7], v[148:151], v[176:179]
    v_cvt_pk_bf16_f32 v216, |v192|, |v193|
    v_cvt_pk_bf16_f32 v217, |v194|, |v195|
    v_mfma_f32_16x16x32_bf16 v[176:179], a[8:11], v[152:155], v[176:179]
    v_cvt_pk_bf16_f32 v218, |v196|, |v197|
    v_cvt_pk_bf16_f32 v219, |v198|, |v199|
    v_mfma_f32_16x16x32_bf16 v[176:179], a[12:15], v[156:159], v[176:179]
    v_cvt_pk_bf16_f32 v220, |v200|, |v201|
    v_cvt_pk_bf16_f32 v221, |v202|, |v203|
    v_smfmac_f32_16x16x64_bf16 v[248:251], a[144:147], v[208:215], v1
    v_cvt_pk_bf16_f32 v222, |v204|, |v205|
    v_mfma_f32_16x16x32_bf16 v[180:183], a[28:31], v[156:159], v[116:119]
    v_cvt_pk_bf16_f32 v223, |v206|, |v207|
    v_mul_f32 v224, v80, v48
    v_mfma_f32_16x16x32_bf16 v[180:183], a[24:27], v[152:155], v[180:183]
    v_mul_f32 v225, v81, v49
    v_mul_f32 v226, v82, v50
    v_mfma_f32_16x16x32_bf16 v[180:183], a[20:23], v[148:151], v[180:183]
    v_mul_f32 v227, v83, v51
    v_mul_f32 v228, v84, v52
    v_mfma_f32_16x16x32_bf16 v[180:183], a[16:19], v[144:147], v[180:183]
    v_mul_f32 v229, v85, v53
    v_mul_f32 v230, v86, v54
    v_smfmac_f32_16x16x64_bf16 v[248:251], a[148:151], v[216:223], v1
    v_mul_f32 v231, v87, v55
    v_mfma_f32_16x16x32_bf16 v[184:187], a[32:35], v[144:147], v[120:123]
    v_cvt_pk_bf16_f32 v160, v224, v225
    v_cvt_pk_bf16_f32 v161, v226, v227
    v_mfma_f32_16x16x32_bf16 v[184:187], a[36:39], v[148:151], v[184:187]
    v_cvt_pk_bf16_f32 v162, v228, v229
    v_cvt_pk_bf16_f32 v163, v230, v231
    v_mfma_f32_16x16x32_bf16 v[184:187], a[40:43], v[152:155], v[184:187]
    v_mul_f32 v224, v88, v56
    v_mul_f32 v225, v89, v57
    v_mfma_f32_16x16x32_bf16 v[184:187], a[44:47], v[156:159], v[184:187]
    v_mul_f32 v226, v90, v58
    v_mul_f32 v227, v91, v59
    v_smfmac_f32_16x16x64_bf16 v[248:251], a[168:171], v[144:151], v1
    v_mul_f32 v228, v92, v60
    v_mfma_f32_16x16x32_bf16 v[188:191], a[60:63], v[156:159], v[124:127]
    v_mul_f32 v229, v93, v61
    v_mul_f32 v230, v94, v62
    v_mfma_f32_16x16x32_bf16 v[188:191], a[56:59], v[152:155], v[188:191]
    v_mul_f32 v231, v95, v63
    v_cvt_pk_bf16_f32 v208, |v176|, |v177|
    v_mfma_f32_16x16x32_bf16 v[188:191], a[52:55], v[148:151], v[188:191]
    v_cvt_pk_bf16_f32 v209, |v178|, |v179|
    v_cvt_pk_bf16_f32 v164, v224, v225
    v_mfma_f32_16x16x32_bf16 v[188:191], a[48:51], v[144:147], v[188:191]
    v_cvt_pk_bf16_f32 v165, v226, v227
    v_cvt_pk_bf16_f32 v166, v228, v229
    v_smfmac_f32_16x16x64_bf16 v[248:251], a[172:175], v[152:159], v1
    v_cvt_pk_bf16_f32 v167, v230, v231
    v_mfma_f32_16x16x32_bf16 v[192:195], a[64:67], v[144:147], v[128:131]
    v_mul_f32 v224, v96, v64
    v_mul_f32 v225, v97, v65
    v_mfma_f32_16x16x32_bf16 v[192:195], a[68:71], v[148:151], v[192:195]
    v_mul_f32 v226, v98, v66
    v_mul_f32 v227, v99, v67
    v_mfma_f32_16x16x32_bf16 v[192:195], a[72:75], v[152:155], v[192:195]
    v_mul_f32 v228, v100, v68
    v_mul_f32 v229, v101, v69
    v_mfma_f32_16x16x32_bf16 v[192:195], a[76:79], v[156:159], v[192:195]
    v_mul_f32 v230, v102, v70
    v_mul_f32 v231, v103, v71
    v_mfma_f32_16x16x32_bf16 v[196:199], a[92:95], v[156:159], v[132:135]
    v_cvt_pk_bf16_f32 v168, v224, v225
    v_cvt_pk_bf16_f32 v169, v226, v227
    v_mfma_f32_16x16x32_bf16 v[196:199], a[88:91], v[152:155], v[196:199]
    v_cvt_pk_bf16_f32 v170, v228, v229
    v_cvt_pk_bf16_f32 v171, v230, v231
    v_mfma_f32_16x16x32_bf16 v[196:199], a[84:87], v[148:151], v[196:199]
    v_mul_f32 v224, v104, v72
    v_mul_f32 v225, v105, v73
    v_mfma_f32_16x16x32_bf16 v[196:199], a[80:83], v[144:147], v[196:199]
    v_mul_f32 v226, v106, v74
    v_mul_f32 v227, v107, v75
    v_mfma_f32_16x16x32_bf16 v[200:203], a[96:99], v[144:147], v[136:139]
    v_mul_f32 v228, v108, v76
    v_mul_f32 v229, v109, v77
    v_mfma_f32_16x16x32_bf16 v[200:203], a[100:103], v[148:151], v[200:203]
    v_mul_f32 v230, v110, v78
    v_mul_f32 v231, v111, v79
    v_mfma_f32_16x16x32_bf16 v[200:203], a[104:107], v[152:155], v[200:203]
    v_cvt_pk_bf16_f32 v172, v224, v225
    v_cvt_pk_bf16_f32 v173, v226, v227
    v_mfma_f32_16x16x32_bf16 v[200:203], a[108:111], v[156:159], v[200:203]
    v_cvt_pk_bf16_f32 v174, v228, v229
    v_cvt_pk_bf16_f32 v175, v230, v231
    v_mfma_f32_16x16x32_bf16 v[204:207], a[124:127], v[156:159], v[140:143]
    v_cvt_pk_bf16_f32 v210, |v180|, |v181|
    v_cvt_pk_bf16_f32 v211, |v182|, |v183|
    v_mfma_f32_16x16x32_bf16 v[204:207], a[120:123], v[152:155], v[204:207]
    v_cvt_pk_bf16_f32 v212, |v184|, |v185|
    v_cvt_pk_bf16_f32 v213, |v186|, |v187|
    v_mfma_f32_16x16x32_bf16 v[204:207], a[116:119], v[148:151], v[204:207]
    v_cvt_pk_bf16_f32 v214, |v188|, |v189|
    v_cvt_pk_bf16_f32 v215, |v190|, |v191|
    v_mfma_f32_16x16x32_bf16 v[204:207], a[112:115], v[144:147], v[204:207]
    v_cvt_pk_bf16_f32 v216, |v192|, |v193|
    v_cvt_pk_bf16_f32 v217, |v194|, |v195|
    v_smfmac_f32_16x16x64_bf16 v[248:251], a[160:163], v[208:215], v1
    v_cvt_pk_bf16_f32 v218, |v196|, |v197|
    v_mfma_f32_16x16x32_bf16 v[176:179], a[0:3], v[160:163], v[112:115]
    v_cvt_pk_bf16_f32 v219, |v198|, |v199|
    v_cvt_pk_bf16_f32 v220, |v200|, |v201|
    v_mfma_f32_16x16x32_bf16 v[176:179], a[4:7], v[164:167], v[176:179]
    v_cvt_pk_bf16_f32 v221, |v202|, |v203|
    v_cvt_pk_bf16_f32 v222, |v204|, |v205|
    v_mfma_f32_16x16x32_bf16 v[176:179], a[8:11], v[168:171], v[176:179]
    v_cvt_pk_bf16_f32 v223, |v206|, |v207|
    v_mul_f32_dpp v224, v16, v16 row_ror:8 row_mask:0xf bank_mask:0xf
    v_mfma_f32_16x16x32_bf16 v[176:179], a[12:15], v[172:175], v[176:179]
    v_mul_f32_dpp v225, v17, v17 row_ror:8 row_mask:0xf bank_mask:0xf
    v_mul_f32_dpp v226, v18, v18 row_ror:8 row_mask:0xf bank_mask:0xf
    v_smfmac_f32_16x16x64_bf16 v[248:251], a[164:167], v[216:223], v1
    v_mul_f32_dpp v227, v19, v19 row_ror:8 row_mask:0xf bank_mask:0xf
    v_mfma_f32_16x16x32_bf16 v[180:183], a[28:31], v[172:175], v[116:119]
    v_mul_f32_dpp v228, v20, v20 row_ror:8 row_mask:0xf bank_mask:0xf
    v_mul_f32_dpp v229, v21, v21 row_ror:8 row_mask:0xf bank_mask:0xf
    v_mfma_f32_16x16x32_bf16 v[180:183], a[24:27], v[168:171], v[180:183]
    v_mul_f32_dpp v230, v22, v22 row_ror:8 row_mask:0xf bank_mask:0xf
    v_mul_f32_dpp v231, v23, v23 row_ror:8 row_mask:0xf bank_mask:0xf
    v_mfma_f32_16x16x32_bf16 v[180:183], a[20:23], v[164:167], v[180:183]
    v_cvt_pk_bf16_f32 v144, v224, v225
    v_cvt_pk_bf16_f32 v145, v226, v227
    v_mfma_f32_16x16x32_bf16 v[180:183], a[16:19], v[160:163], v[180:183]
    v_cvt_pk_bf16_f32 v146, v228, v229
    v_cvt_pk_bf16_f32 v147, v230, v231
    v_smfmac_f32_16x16x64_bf16 v[248:251], a[184:187], v[160:167], v1
    v_mul_f32_dpp v224, v24, v24 row_ror:8 row_mask:0xf bank_mask:0xf
    v_mfma_f32_16x16x32_bf16 v[184:187], a[32:35], v[160:163], v[120:123]
    v_mul_f32_dpp v225, v25, v25 row_ror:8 row_mask:0xf bank_mask:0xf
    v_mul_f32_dpp v226, v26, v26 row_ror:8 row_mask:0xf bank_mask:0xf
    v_mfma_f32_16x16x32_bf16 v[184:187], a[36:39], v[164:167], v[184:187]
    v_mul_f32_dpp v227, v27, v27 row_ror:8 row_mask:0xf bank_mask:0xf
    v_mul_f32_dpp v228, v28, v28 row_ror:8 row_mask:0xf bank_mask:0xf
    v_mfma_f32_16x16x32_bf16 v[184:187], a[40:43], v[168:171], v[184:187]
    v_mul_f32_dpp v229, v29, v29 row_ror:8 row_mask:0xf bank_mask:0xf
    v_mul_f32_dpp v230, v30, v30 row_ror:8 row_mask:0xf bank_mask:0xf
    v_mfma_f32_16x16x32_bf16 v[184:187], a[44:47], v[172:175], v[184:187]
    v_mul_f32_dpp v231, v31, v31 row_ror:8 row_mask:0xf bank_mask:0xf
    v_cvt_pk_bf16_f32 v208, |v176|, |v177|
    v_smfmac_f32_16x16x64_bf16 v[248:251], a[188:191], v[168:175], v1
    v_cvt_pk_bf16_f32 v209, |v178|, |v179|
    v_mfma_f32_16x16x32_bf16 v[188:191], a[60:63], v[172:175], v[124:127]
    v_cvt_pk_bf16_f32 v148, v224, v225
    v_cvt_pk_bf16_f32 v149, v226, v227
    v_mfma_f32_16x16x32_bf16 v[188:191], a[56:59], v[168:171], v[188:191]
    v_cvt_pk_bf16_f32 v150, v228, v229
    v_cvt_pk_bf16_f32 v151, v230, v231
    v_mfma_f32_16x16x32_bf16 v[188:191], a[52:55], v[164:167], v[188:191]
    v_mul_f32_dpp v224, v32, v32 row_ror:8 row_mask:0xf bank_mask:0xf
    v_mul_f32_dpp v225, v33, v33 row_ror:8 row_mask:0xf bank_mask:0xf
    v_mfma_f32_16x16x32_bf16 v[188:191], a[48:51], v[160:163], v[188:191]
    v_mul_f32_dpp v226, v34, v34 row_ror:8 row_mask:0xf bank_mask:0xf
    v_mul_f32_dpp v227, v35, v35 row_ror:8 row_mask:0xf bank_mask:0xf
    v_smfmac_f32_16x16x64_bf16 v[252:255], a[136:139], v[144:151], v1
    v_mul_f32_dpp v228, v36, v36 row_ror:8 row_mask:0xf bank_mask:0xf
    v_mfma_f32_16x16x32_bf16 v[192:195], a[64:67], v[160:163], v[128:131]
    v_mul_f32_dpp v229, v37, v37 row_ror:8 row_mask:0xf bank_mask:0xf
    v_mul_f32_dpp v230, v38, v38 row_ror:8 row_mask:0xf bank_mask:0xf
    v_mfma_f32_16x16x32_bf16 v[192:195], a[68:71], v[164:167], v[192:195]
    v_mul_f32_dpp v231, v39, v39 row_ror:8 row_mask:0xf bank_mask:0xf
    v_cvt_pk_bf16_f32 v152, v224, v225
    v_mfma_f32_16x16x32_bf16 v[192:195], a[72:75], v[168:171], v[192:195]
    v_cvt_pk_bf16_f32 v153, v226, v227
    v_cvt_pk_bf16_f32 v154, v228, v229
    v_mfma_f32_16x16x32_bf16 v[192:195], a[76:79], v[172:175], v[192:195]
    v_cvt_pk_bf16_f32 v155, v230, v231
    v_mul_f32_dpp v224, v40, v40 row_ror:8 row_mask:0xf bank_mask:0xf
    v_mfma_f32_16x16x32_bf16 v[196:199], a[92:95], v[172:175], v[132:135]
    v_mul_f32_dpp v225, v41, v41 row_ror:8 row_mask:0xf bank_mask:0xf
    v_mul_f32_dpp v226, v42, v42 row_ror:8 row_mask:0xf bank_mask:0xf
    v_mfma_f32_16x16x32_bf16 v[196:199], a[88:91], v[168:171], v[196:199]
    v_mul_f32_dpp v227, v43, v43 row_ror:8 row_mask:0xf bank_mask:0xf
    v_mul_f32_dpp v228, v44, v44 row_ror:8 row_mask:0xf bank_mask:0xf
    v_mfma_f32_16x16x32_bf16 v[196:199], a[84:87], v[164:167], v[196:199]
    v_mul_f32_dpp v229, v45, v45 row_ror:8 row_mask:0xf bank_mask:0xf
    v_mul_f32_dpp v230, v46, v46 row_ror:8 row_mask:0xf bank_mask:0xf
    v_mfma_f32_16x16x32_bf16 v[196:199], a[80:83], v[160:163], v[196:199]
    v_mul_f32_dpp v231, v47, v47 row_ror:8 row_mask:0xf bank_mask:0xf
    v_cvt_pk_bf16_f32 v156, v224, v225
    v_mfma_f32_16x16x32_bf16 v[200:203], a[96:99], v[160:163], v[136:139]
    v_cvt_pk_bf16_f32 v157, v226, v227
    v_cvt_pk_bf16_f32 v158, v228, v229
    v_mfma_f32_16x16x32_bf16 v[200:203], a[100:103], v[164:167], v[200:203]
    v_cvt_pk_bf16_f32 v159, v230, v231
    v_cvt_pk_bf16_f32 v210, |v180|, |v181|
    v_mfma_f32_16x16x32_bf16 v[200:203], a[104:107], v[168:171], v[200:203]
    v_cvt_pk_bf16_f32 v211, |v182|, |v183|
    v_cvt_pk_bf16_f32 v212, |v184|, |v185|
    v_mfma_f32_16x16x32_bf16 v[200:203], a[108:111], v[172:175], v[200:203]
    v_cvt_pk_bf16_f32 v213, |v186|, |v187|
    v_cvt_pk_bf16_f32 v214, |v188|, |v189|
    v_smfmac_f32_16x16x64_bf16 v[252:255], a[140:143], v[152:159], v1
    v_cvt_pk_bf16_f32 v215, |v190|, |v191|
    v_mfma_f32_16x16x32_bf16 v[204:207], a[124:127], v[172:175], v[140:143]
    v_cvt_pk_bf16_f32 v216, |v192|, |v193|
    v_cvt_pk_bf16_f32 v217, |v194|, |v195|
    v_mfma_f32_16x16x32_bf16 v[204:207], a[120:123], v[168:171], v[204:207]
    v_cvt_pk_bf16_f32 v218, |v196|, |v197|
    v_cvt_pk_bf16_f32 v219, |v198|, |v199|
    v_mfma_f32_16x16x32_bf16 v[204:207], a[116:119], v[164:167], v[204:207]
    v_cvt_pk_bf16_f32 v220, |v200|, |v201|
    v_cvt_pk_bf16_f32 v221, |v202|, |v203|
    v_mfma_f32_16x16x32_bf16 v[204:207], a[112:115], v[160:163], v[204:207]
    v_add_f32 v232, v232, v233
    v_add_f32 v236, v236, v237
    v_smfmac_f32_16x16x64_bf16 v[248:251], a[176:179], v[208:215], v1
    v_add_f32 v240, v240, v241
    v_mfma_f32_16x16x32_bf16 v[176:179], a[0:3], v[144:147], v[112:115]
    v_max3_f32 v12, v232, v236, v240
    v_add_f32 v244, v244, v245
    v_mfma_f32_16x16x32_bf16 v[176:179], a[4:7], v[148:151], v[176:179]
    v_cvt_pk_bf16_f32 v222, |v204|, |v205|
    v_cvt_pk_bf16_f32 v223, |v206|, |v207|
    v_mfma_f32_16x16x32_bf16 v[176:179], a[8:11], v[152:155], v[176:179]
    v_add_f32 v234, v234, v235
    v_add_f32 v238, v238, v239
    v_mfma_f32_16x16x32_bf16 v[176:179], a[12:15], v[156:159], v[176:179]
    v_add_f32 v242, v242, v243
    v_add_f32 v246, v246, v247
    v_smfmac_f32_16x16x64_bf16 v[248:251], a[180:183], v[216:223], v1
    v_mfma_f32_16x16x32_bf16 v[180:183], a[28:31], v[156:159], v[116:119]
    v_mfma_f32_16x16x32_bf16 v[180:183], a[24:27], v[152:155], v[180:183]
    v_mfma_f32_16x16x32_bf16 v[180:183], a[20:23], v[148:151], v[180:183]
    v_mfma_f32_16x16x32_bf16 v[180:183], a[16:19], v[144:147], v[180:183]
    v_mfma_f32_16x16x32_bf16 v[184:187], a[32:35], v[144:147], v[120:123]
    v_cvt_pk_bf16_f32 v208, |v176|, |v177|
    v_cvt_pk_bf16_f32 v209, |v178|, |v179|
    v_mfma_f32_16x16x32_bf16 v[184:187], a[36:39], v[148:151], v[184:187]
    v_mfma_f32_16x16x32_bf16 v[184:187], a[40:43], v[152:155], v[184:187]
    v_mfma_f32_16x16x32_bf16 v[184:187], a[44:47], v[156:159], v[184:187]
    v_add_f32 v248, v248, v249
    v_max3_f32 v12, v12, v244, v248
    v_mfma_f32_16x16x32_bf16 v[188:191], a[60:63], v[156:159], v[124:127]
    v_mul_f32 v2, v12, v10
    v_max_f32_dpp v12, v12, v12 row_ror:8 row_mask:0xf bank_mask:0xf
    v_mfma_f32_16x16x32_bf16 v[188:191], a[56:59], v[152:155], v[188:191]
    v_cvt_pk_bf16_f32 v210, |v180|, |v181|
    v_max_f32_dpp v12, v12, v12 row_ror:4 row_mask:0xf bank_mask:0xf
    v_mfma_f32_16x16x32_bf16 v[188:191], a[52:55], v[148:151], v[188:191]
    v_cvt_pk_bf16_f32 v211, |v182|, |v183|
    v_max_f32_dpp v12, v12, v12 row_ror:2 row_mask:0xf bank_mask:0xf
    v_mfma_f32_16x16x32_bf16 v[188:191], a[48:51], v[144:147], v[188:191]
    v_cvt_pk_bf16_f32 v212, |v184|, |v185|
    v_max_f32_dpp v12, v12, v12 row_ror:1 row_mask:0xf bank_mask:0xf
    v_mfma_f32_16x16x32_bf16 v[192:195], a[64:67], v[144:147], v[128:131]
    v_cvt_pk_bf16_f32 v213, |v186|, |v187|
    v_max_f32_dpp v12, v12, v12 row_bcast:15 row_mask:0xa bank_mask:0xf
    v_mfma_f32_16x16x32_bf16 v[192:195], a[68:71], v[148:151], v[192:195]
    v_fma_f32 v232, v232, v10, -v2
    v_max_f32_dpp v12, v12, v12 row_bcast:31 row_mask:0xc bank_mask:0xf
    v_mfma_f32_16x16x32_bf16 v[192:195], a[72:75], v[152:155], v[192:195]
    v_cvt_pk_bf16_f32 v214, |v188|, |v189|
    v_cvt_pk_bf16_f32 v215, |v190|, |v191|
    v_mfma_f32_16x16x32_bf16 v[192:195], a[76:79], v[156:159], v[192:195]
    v_readlane_b32 s14, v12, 63
    v_fma_f32 v236, v236, v10, -v2
    v_smfmac_f32_16x16x64_bf16 v[252:255], a[128:131], v[208:215], v1
    v_exp_f32 v232, v232
    v_mfma_f32_16x16x32_bf16 v[196:199], a[92:95], v[156:159], v[132:135]
    v_exp_f32 v236, v236
    v_mfma_f32_16x16x32_bf16 v[196:199], a[88:91], v[152:155], v[196:199]
    v_fma_f32 v240, v240, v10, -v2
    v_exp_f32 v240, v240
    v_mfma_f32_16x16x32_bf16 v[196:199], a[84:87], v[148:151], v[196:199]
    v_fma_f32 v244, v244, v10, -v2
    v_cvt_pk_bf16_f32 v216, |v192|, |v193|
    v_mfma_f32_16x16x32_bf16 v[196:199], a[80:83], v[144:147], v[196:199]
    v_cvt_pk_bf16_f32 v217, |v194|, |v195|
    v_mul_f32 v13, s14, v10
    v_mfma_f32_16x16x32_bf16 v[200:203], a[96:99], v[144:147], v[136:139]
    v_exp_f32 v244, v244
    v_mfma_f32_16x16x32_bf16 v[200:203], a[100:103], v[148:151], v[200:203]
    v_fma_f32 v248, v248, v10, -v2
    v_add_f32 v14, v232, v236
    v_mfma_f32_16x16x32_bf16 v[200:203], a[104:107], v[152:155], v[200:203]
    v_cvt_pk_bf16_f32 v218, |v196|, |v197|
    v_cvt_pk_bf16_f32 v219, |v198|, |v199|
    v_mfma_f32_16x16x32_bf16 v[200:203], a[108:111], v[156:159], v[200:203]
    v_sub_f32 v3, v2, v13
    v_exp_f32 v248, v248
    v_mfma_f32_16x16x32_bf16 v[204:207], a[124:127], v[156:159], v[140:143]
    v_mul_f32 v15, v232, v234
    v_add_f32 v14, v14, v240
    v_mfma_f32_16x16x32_bf16 v[204:207], a[120:123], v[152:155], v[204:207]
    v_exp_f32 v3, v3
    v_mfma_f32_16x16x32_bf16 v[204:207], a[116:119], v[148:151], v[204:207]
    v_cvt_pk_bf16_f32 v220, |v200|, |v201|
    v_cvt_pk_bf16_f32 v221, |v202|, |v203|
    v_mfma_f32_16x16x32_bf16 v[204:207], a[112:115], v[144:147], v[204:207]
    v_fmac_f32 v15, v236, v238
    v_add_f32 v14, v14, v244
    v_fmac_f32 v15, v240, v242
    v_add_f32 v14, v14, v248
    v_add_f32 v250, v250, v251
    v_fmac_f32 v15, v244, v246
    v_mul_f32 v14, v14, v3
    v_fmac_f32 v15, v248, v250
    v_cvt_pk_bf16_f32 v222, |v204|, |v205|
    v_cvt_pk_bf16_f32 v223, |v206|, |v207|
    v_mul_f32 v15, v15, v3
    v_add_f32_dpp v14, v14, v14 row_ror:8 row_mask:0xf bank_mask:0xf
    v_smfmac_f32_16x16x64_bf16 v[252:255], a[132:135], v[216:223], v1
    v_add_f32_dpp v15, v15, v15 row_ror:8 row_mask:0xf bank_mask:0xf
    v_add_f32_dpp v14, v14, v14 row_ror:4 row_mask:0xf bank_mask:0xf
    s_nop 0
    v_add_f32_dpp v15, v15, v15 row_ror:4 row_mask:0xf bank_mask:0xf
    v_add_f32_dpp v14, v14, v14 row_ror:2 row_mask:0xf bank_mask:0xf
    s_nop 0
    v_add_f32_dpp v15, v15, v15 row_ror:2 row_mask:0xf bank_mask:0xf
    v_add_f32_dpp v14, v14, v14 row_ror:1 row_mask:0xf bank_mask:0xf
    s_nop 0
    v_add_f32_dpp v15, v15, v15 row_ror:1 row_mask:0xf bank_mask:0xf
    v_add_f32 v252, v252, v253
    v_max_f32 v6, s14, v252
    v_add_f32 v254, v254, v255
    v_add_f32_dpp v14, v14, v14 row_bcast:15 row_mask:0xa bank_mask:0xf
    v_max_f32_dpp v6, v6, v6 row_ror:4 row_mask:0xf bank_mask:0xf
    v_add_f32_dpp v15, v15, v15 row_bcast:15 row_mask:0xa bank_mask:0xf
    v_add_f32_dpp v14, v14, v14 row_bcast:31 row_mask:0xc bank_mask:0xf
    v_max_f32_dpp v6, v6, v6 row_ror:2 row_mask:0xf bank_mask:0xf
    v_add_f32_dpp v15, v15, v15 row_bcast:31 row_mask:0xc bank_mask:0xf
    v_readlane_b32 s15, v14, 63
    v_max_f32_dpp v6, v6, v6 row_ror:1 row_mask:0xf bank_mask:0xf
    v_mul_f32 v4, v6, v10
    v_fma_f32 v252, v252, v10, -v4
    v_exp_f32 v252, v252
    v_sub_f32 v5, v13, v4
    v_mul_f32 v254, v252, v254
    v_add_f32_dpp v252, v252, v252 row_ror:4 row_mask:0xf bank_mask:0xf
    v_exp_f32 v5, v5
    v_add_f32_dpp v254, v254, v254 row_ror:4 row_mask:0xf bank_mask:0xf
    v_add_f32_dpp v252, v252, v252 row_ror:2 row_mask:0xf bank_mask:0xf
    v_readlane_b32 s34, v15, 63
    v_add_f32_dpp v254, v254, v254 row_ror:2 row_mask:0xf bank_mask:0xf
    v_add_f32_dpp v252, v252, v252 row_ror:1 row_mask:0xf bank_mask:0xf
    v_fmac_f32 v252, s15, v5
    v_add_f32_dpp v254, v254, v254 row_ror:1 row_mask:0xf bank_mask:0xf
    v_rcp_f32 v252, v252
    v_fmac_f32 v254, s34, v5
    v_mul_f32 v254, v254, v252
    v_cvt_pk_bf16_f32 v254, v254, v254
    buffer_store_short v254, v11, s[36:39], 0 offen
L_end:
s_endpgm
.section .rodata,"a"
.p2align 6
.amdhsa_kernel standalone__factorization_afm__recsys_kernel
  .amdhsa_next_free_vgpr 448
  .amdhsa_next_free_sgpr 102
  .amdhsa_accum_offset 256
  .amdhsa_group_segment_fixed_size 0
  .amdhsa_kernarg_size 88
  .amdhsa_user_sgpr_count 2
  .amdhsa_user_sgpr_kernarg_segment_ptr 1
  .amdhsa_system_sgpr_workgroup_id_x 1
  .amdhsa_float_denorm_mode_32 3
.end_amdhsa_kernel
```
